```python
import torch

def _softmax(x, axis=-1):
    return torch.softmax(x, dim=axis)
def _gelu(x):
    return torch.nn.functional.gelu(x, approximate="tanh")
def _silu(x):
    return torch.nn.functional.silu(x)
def _sigmoid(x):
    return torch.sigmoid(x)
def _layernorm(x, axis=-1, eps=1e-5):
    m = x.mean(dim=axis, keepdim=True)
    v = x.var(dim=axis, keepdim=True, unbiased=False)
    return (x - m) / torch.sqrt(v + eps)
def _scatter_add(tgt, idx, src, axis=0):
    return tgt.clone().index_add_(axis, idx, src)
def _segment_sum(src, seg, n):
    out = torch.zeros((n,) + src.shape[1:], dtype=src.dtype)
    return out.index_add_(0, seg, src)
def _pad(x, pw):
    flat = tuple(v for pair in reversed(pw) for v in pair)
    return torch.nn.functional.pad(x, flat)

kernel_name = 'interleave_layers__sliding_block__moe_arch_mod__prompt'

def setup_inputs():

    _w = (lambda a: (lambda t: t.to(torch.bfloat16) if t.is_floating_point() else t)(torch.as_tensor(a)))
    def _A_setup():
        B, S, D = 1, 2048, 1024
        return {
            "x": _w((lambda *s: torch.randn(*s, dtype=torch.bfloat16) * 0.05)(B, S, D)),
            "wqkv": _w((lambda *s: torch.randn(*s, dtype=torch.bfloat16) * 0.05)(D, 3 * D)),
            "wo": _w((lambda *s: torch.randn(*s, dtype=torch.bfloat16) * 0.05)(D, D)),
        }
    _A_in = _A_setup()

    def _B_setup():
        B, S, D, F, C = 1, 2048, 1024, 3584, 1
        return {
            "x": _w((lambda *s: torch.randn(*s, dtype=torch.bfloat16) * 0.05)(B, S, D)),
            "w_r": _w((lambda *s: torch.randn(*s, dtype=torch.bfloat16) * 1.6)(D)),
            "w_gate": _w((lambda *s: torch.randn(*s, dtype=torch.bfloat16) * 0.1)(D, F)),
            "w_up": _w((lambda *s: torch.randn(*s, dtype=torch.bfloat16) * 0.1)(D, F)),
            "w_down": _w((lambda *s: torch.randn(*s, dtype=torch.bfloat16) * 0.1)(F, D)),
        }
    _B_in = _B_setup()

    return {
        "A_x": _A_in["x"],
        "A_wqkv": _A_in["wqkv"],
        "A_wo": _A_in["wo"],
        "B_x": _B_in["x"],
        "B_w_r": _B_in["w_r"],
        "B_w_gate": _B_in["w_gate"],
        "B_w_up": _B_in["w_up"],
        "B_w_down": _B_in["w_down"],
    }

def reference(A_x, A_wqkv, A_wo, B_x, B_w_r, B_w_gate, B_w_up, B_w_down):
    def _A_ref(x, wqkv, wo):
        B, S, D = x.shape
        H = 32; Dh = D // H; W = 256
        qkv = (lambda x, *d: x.permute(*d))((x @ wqkv).reshape(B, S, 3, H, Dh), 2, 0, 3, 1, 4)
        q, k, v = qkv[0], qkv[1], qkv[2]
        scores = torch.einsum("bhqd,bhkd->bhqk", q, k) * (Dh ** -0.5)
        idx = torch.arange(S)
        mask = (idx[:, None] - idx[None, :] >= 0) & (idx[:, None] - idx[None, :] < W)
        scores = torch.where(mask[None, None], scores, -1e9)
        p = _softmax(scores, axis=-1)
        o = torch.einsum("bhqk,bhkd->bhqd", p, v)
        return (lambda x, *d: x.permute(*d))(o, 0, 2, 1, 3).reshape(B, S, D) @ wo

    def _B_ref(x, w_r, w_gate, w_up, w_down):
        B, S, D = x.shape
        C = 1
        r = x @ w_r
        idx = torch.argsort(-r, axis=-1)[:, :C]
        idx_e = (lambda x, n, axis: torch.repeat_interleave(x, n, dim=axis))(idx.reshape(B, C, 1), D, axis=2)
        x_sel = (lambda x, i, axis: torch.take_along_dim(x, i, dim=axis))(x, idx_e, axis=1)
        g = _silu(x_sel @ w_gate)
        u = x_sel @ w_up
        y = (g * u) @ w_down
        r_sel = _sigmoid((lambda x, i, axis: torch.take_along_dim(x, i, dim=axis))(r, idx, axis=1))
        y = y * r_sel.reshape(B, C, 1)
        b_off = (torch.arange(B) * S).reshape(B, 1)
        flat_idx = (idx + b_off).reshape(B * C)
        zero = (x * 0.0).reshape(B * S, D)
        upd = _scatter_add(zero, flat_idx, y.reshape(B * C, D), axis=0)
        return x + upd.reshape(B, S, D)

    x = A_x
    x = x + _A_ref(_layernorm(x, axis=-1), A_wqkv, A_wo)
    x = x + _B_ref(_layernorm(x, axis=-1), B_w_r, B_w_gate, B_w_up, B_w_down)
    x = x + _A_ref(_layernorm(x, axis=-1), A_wqkv, A_wo)
    x = x + _B_ref(_layernorm(x, axis=-1), B_w_r, B_w_gate, B_w_up, B_w_down)
    return x
```

```asm
; @launch grid=(256,1,1) block=(512,1,1) lds=163840
.amdgcn_target "amdgcn-amd-amdhsa--gfx950"
.text
.globl interleave_layers__sliding_block__moe_arch_mod__prompt_kernel
.p2align 8
.type interleave_layers__sliding_block__moe_arch_mod__prompt_kernel,@function
interleave_layers__sliding_block__moe_arch_mod__prompt_kernel:
s_cmp_ge_u32 s2, 256
s_cbranch_scc1 L_fin
s_load_dwordx16 s[36:51], s[0:1], 0
s_load_dwordx4 s[52:55], s[0:1], 64
s_load_dwordx2 s[56:57], s[0:1], 80
v_lshrrev_b32 v1, 6, v0
v_and_b32 v0, 63, v0
s_and_b32 s64, s2, 7
v_readfirstlane_b32 s79, v1
s_lshr_b32 s65, s2, 3
s_and_b32 s66, s65, 3
s_and_b32 s67, s64, 1
s_lshl2_add_u32 s59, s67, s66
s_lshr_b32 s62, s65, 2
s_lshr_b32 s67, s64, 1
s_lshl3_add_u32 s60, s67, s62
s_lshl2_add_u32 s61, s64, s66
s_mul_i32 s35, s64, 28
s_add_u32 s35, s35, s65
s_mov_b32 s63, 0
s_mov_b32 s32, 30000
s_mov_b32 s33, -1
s_and_b32 s58, s79, 3
s_waitcnt lgkmcnt(0)
s_mov_b32 s8, s36
s_mov_b32 s9, s37
s_mov_b32 s10, 0x400000
s_mov_b32 s11, 0x00020000
s_mov_b32 s12, s38
s_mov_b32 s13, s39
s_mov_b32 s14, 0x600000
s_mov_b32 s15, 0x00020000
s_mov_b32 s16, s40
s_mov_b32 s17, s41
s_mov_b32 s18, 0x200000
s_mov_b32 s19, 0x00020000
s_mov_b32 s20, s56
s_mov_b32 s21, s57
s_mov_b32 s22, 0x2100000
s_mov_b32 s23, 0x00020000
s_add_u32 s24, s56, 29360128
s_addc_u32 s25, s57, 0
s_mov_b32 s26, 3145728
s_mov_b32 s27, 0x00020000
s_mov_b32 s28, s52
s_mov_b32 s29, s53
s_mov_b32 s30, 0x400000
s_mov_b32 s31, 0x00020000
s_cmp_ge_u32 s79, 4
s_cbranch_scc0 L_m
s_mov_b32 s43, 0
s_mov_b32 s3, 0
s_mov_b32 s4, s54
s_mov_b32 s5, s55
s_mov_b32 s6, 0x100
s_mov_b32 s7, 0x00020000
v_mov_b32 v7, 0
v_mov_b32 v8, 0
v_mov_b32 v12, 0
v_mov_b32 v14, 0
v_mov_b32 v15, 0
L_htop:
v_lshlrev_b32 v13, 4, v0
s_lshl_b32 s69, s58, 12
s_mul_i32 s70, s58, 1536
s_add_u32 s70, s70, 16384
s_sub_u32 s72, 7, s58
v_lshrrev_b32 v20, 2, v0
v_and_b32 v21, 3, v0
s_mul_i32 s73, s58, 24
v_add_u32 v22, s73, v20
v_add_u32 v23, 16, v22
s_cmp_eq_u32 s63, 0
s_cbranch_scc0 ha_1
s_mov_b32 s68, 64
v_bfe_u32 v24, v0, 4, 2
v_xor_b32 v24, v24, v21
v_lshlrev_b32 v24, 4, v24
v_lshl_add_u32 v24, v20, 11, v24
s_lshl_b32 s73, s59, 19
s_lshl_b32 s74, s58, 16
s_add_u32 s74, s74, s73
v_add_u32 v1, s74, v24
v_add_u32 v2, 31744, v1
s_lshl_b32 s74, s72, 16
s_add_u32 s74, s74, s73
s_sub_u32 s74, s74, 2048
v_add_u32 v3, s74, v24
v_add_u32 v4, 31744, v3
s_branch ha_2
ha_1:
s_mov_b32 s68, 2048
s_mov_b32 s8, s56
s_mov_b32 s9, s57
s_mov_b32 s10, 0x2000000
s_mov_b32 s11, 0x00020000
s_lshl_b32 s73, s59, 19
s_add_u32 s73, s73, 25165824
v_lshrrev_b32 v24, 5, v0
v_lshlrev_b32 v24, 4, v24
v_add_u32 v24, 30605312, v24
v_and_b32 v25, 31, v0
s_lshl_b32 s75, s59, 8
s_sub_u32 s75, s33, s75
s_lshl_b32 s74, s58, 16
s_add_u32 s74, s74, s73
v_add_u32 v1, s74, v13
s_lshl_b32 s74, s58, 5
s_sub_u32 s74, s75, s74
v_cmp_eq_u32 vcc, s74, v25
s_nop 1
v_cndmask_b32 v1, v1, v24, vcc
v_mov_b32 v2, v1
s_lshl_b32 s74, s72, 16
s_add_u32 s74, s74, s73
v_add_u32 v3, s74, v13
s_lshl_b32 s74, s72, 5
s_sub_u32 s74, s75, s74
v_cmp_eq_u32 vcc, s74, v25
s_nop 1
v_cndmask_b32 v3, v3, v24, vcc
v_subrev_u32 v3, 2048, v3
v_mov_b32 v4, v3
v_lshrrev_b32 v24, 1, v22
v_xor_b32 v24, v24, v22
v_and_b32 v24, 4, v24
v_mul_u32_u24 v24, 3, v24
v_xor_b32 v22, v24, v22
v_lshrrev_b32 v24, 1, v23
v_xor_b32 v24, v24, v23
v_and_b32 v24, 4, v24
v_mul_u32_u24 v24, 3, v24
v_xor_b32 v23, v24, v23
ha_2:
s_lshl_b32 s73, s60, 6
v_lshl_add_u32 v21, v21, 4, s73
v_and_b32 v24, 31, v22
v_lshrrev_b32 v25, 5, v22
v_mul_u32_u24 v24, 6144, v24
v_lshl_add_u32 v24, v25, 11, v24
v_add_u32 v5, v24, v21
v_and_b32 v24, 31, v23
v_lshrrev_b32 v25, 5, v23
v_mul_u32_u24 v24, 6144, v24
v_lshl_add_u32 v24, v25, 11, v24
v_add_u32 v6, v24, v21
v_subrev_u32 v6, 1024, v6
s_lshr_b32 s72, s2, 3
s_and_b32 s73, s72, 3
s_lshl_b32 s73, s73, 3
s_and_b32 s72, s72, 28
s_add_u32 s72, s72, s73
s_and_b32 s64, s72, 31
s_lshr_b32 s71, s64, 1
s_mov_b32 s65, 4096
s_mov_b32 s66, 4096
s_mov_b32 s67, -5
hq_3:
s_cmp_lt_i32 s67, 0
s_cbranch_scc1 hq_4
s_waitcnt vmcnt(24)
s_barrier
hq_4:
s_mul_i32 s72, s64, s68
s_mul_i32 s73, s64, 196608
s_add_u32 m0, s65, s69
s_add_u32 s64, s64, 1
buffer_load_dwordx4 v1, s[8:11], s72 offen offset:0 sc1 lds
buffer_load_dwordx4 v2, s[8:11], s72 offen offset:1024 sc1 lds
buffer_load_dwordx4 v3, s[8:11], s72 offen offset:2048 sc1 lds
buffer_load_dwordx4 v4, s[8:11], s72 offen offset:3072 sc1 lds
s_add_u32 m0, s65, s70
s_and_b32 s64, s64, 31
buffer_load_dwordx4 v5, s[12:15], s73 offen lds
s_mov_b32 exec_hi, 0
buffer_load_dwordx4 v6, s[12:15], s73 offen offset:1024 lds
s_mov_b32 exec_hi, -1
s_add_u32 s65, s65, 22528
s_cmp_eq_u32 s65, 139264
s_cselect_b32 s65, 4096, s65
s_cmp_lg_u32 s63, 0
s_cbranch_scc1 hq_5
s_cmp_eq_i32 s67, -1
s_cbranch_scc1 trig_6
s_cmp_eq_i32 s67, 0
s_cbranch_scc1 trig_7
s_cmp_eq_i32 s67, 6
s_cbranch_scc1 trig_8
s_cmp_eq_i32 s67, 14
s_cbranch_scc1 trig_9
s_cmp_eq_i32 s67, 19
s_cbranch_scc1 trig_10
s_cmp_lt_i32 s67, 0
s_cbranch_scc1 hq_5
hcs_11:
v_add_u32 v20, s66, v12
ds_read_b64_tr_b16 v[22:23], v20 offset:0
ds_read_b64_tr_b16 v[24:25], v20 offset:2048
ds_read_b64_tr_b16 v[26:27], v20 offset:4096
s_add_u32 s66, s66, 22528
s_cmp_eq_u32 s66, 139264
s_cselect_b32 s66, 4096, s66
s_waitcnt lgkmcnt(2)
v_lshlrev_b32 v21, 16, v22
v_and_b32 v22, 0xffff0000, v22
v_add_f32 v9, v9, v21
v_add_f32 v9, v9, v22
v_lshlrev_b32 v21, 16, v23
v_and_b32 v23, 0xffff0000, v23
v_add_f32 v9, v9, v21
v_add_f32 v9, v9, v23
s_waitcnt lgkmcnt(1)
v_lshlrev_b32 v21, 16, v24
v_and_b32 v24, 0xffff0000, v24
v_add_f32 v10, v10, v21
v_add_f32 v10, v10, v24
v_lshlrev_b32 v21, 16, v25
v_and_b32 v25, 0xffff0000, v25
v_add_f32 v10, v10, v21
v_add_f32 v10, v10, v25
s_waitcnt lgkmcnt(0)
v_lshlrev_b32 v21, 16, v26
v_and_b32 v26, 0xffff0000, v26
v_add_f32 v11, v11, v21
v_add_f32 v11, v11, v26
v_lshlrev_b32 v21, 16, v27
v_and_b32 v27, 0xffff0000, v27
v_add_f32 v11, v11, v21
v_add_f32 v11, v11, v27
hq_5:
s_add_u32 s67, s67, 1
s_cmp_lt_i32 s67, 27
s_cbranch_scc1 hq_3
s_branch hqt_12
trig_6:
v_lshrrev_b32 v20, 4, v0
v_bfe_u32 v21, v0, 2, 2
v_and_b32 v22, 3, v0
v_xor_b32 v23, v21, v20
v_lshlrev_b32 v23, 6, v23
v_lshl_add_u32 v23, v22, 4, v23
v_lshl_add_u32 v23, v20, 11, v23
s_lshl_b32 s72, s62, 8
s_lshl_b32 s73, s58, 15
s_add_u32 s72, s72, s73
v_add_u32 v7, s72, v23
s_lshr_b32 s72, s58, 1
s_lshl_b32 s73, s61, 1
s_add_u32 s72, s72, s73
s_lshl_b32 s72, s72, 16
s_and_b32 s73, s58, 1
s_lshl_b32 s73, s73, 11
s_add_u32 s72, s72, s73
s_add_u32 s72, s72, 16777216
v_add_u32 v8, s72, v13
v_lshrrev_b32 v23, 5, v0
v_lshl_add_u32 v23, v23, 2, v21
v_lshlrev_b32 v23, 6, v23
v_and_b32 v20, 1, v20
v_lshl_add_u32 v23, v20, 5, v23
v_lshl_add_u32 v23, v22, 3, v23
s_lshl_b32 s72, s58, 9
s_add_u32 s72, s72, 16384
v_add_u32 v12, s72, v23
v_mov_b32 v9, 0
v_mov_b32 v10, 0
v_mov_b32 v11, 0
s_branch hq_5
trig_7:
s_lshl_b32 s72, s59, 8
s_lshl_b32 s73, s60, 3
s_add_u32 s72, s72, s73
s_lshl_b32 s73, s58, 1
s_add_u32 s72, s72, s73
v_lshrrev_b32 v20, 5, v0
v_add_u32 v14, s72, v20
v_and_b32 v21, 31, v0
v_lshlrev_b32 v21, 4, v21
v_lshl_add_u32 v21, v14, 11, v21
buffer_load_dwordx4 v[32:35], v21, s[8:11], 0 offen offset:0
buffer_load_dwordx4 v[36:39], v21, s[8:11], 0 offen offset:512
buffer_load_dwordx4 v[40:43], v21, s[8:11], 0 offen offset:1024
buffer_load_dwordx4 v[44:47], v21, s[8:11], 0 offen offset:1536
s_mov_b32 s4, s44
s_mov_b32 s5, s45
s_mov_b32 s6, 0x800
s_mov_b32 s7, 0x00020000
buffer_load_dwordx4 v[52:55], v13, s[4:7], 0 offen offset:0
buffer_load_dwordx4 v[56:59], v13, s[4:7], 0 offen offset:1024
v_mov_b32 v48, 0
v_mov_b32 v49, 0
v_mov_b32 v50, 0
v_mov_b32 v51, 0
s_mul_i32 s72, s2, 12288
s_mul_i32 s73, s58, 3072
s_add_u32 s72, s72, s73
buffer_store_dwordx4 v[48:51], v13, s[24:27], s72 offen offset:0 sc1
buffer_store_dwordx4 v[48:51], v13, s[24:27], s72 offen offset:1024 sc1
buffer_store_dwordx4 v[48:51], v13, s[24:27], s72 offen offset:2048 sc1
s_mov_b32 s4, s54
s_mov_b32 s5, s55
s_mov_b32 s6, 0x100
s_mov_b32 s7, 0x00020000
s_branch hcs_11
trig_8:
s_cmp_lg_u32 s58, 0
s_cbranch_scc1 hq_13
s_and_b32 s72, s2, 3
s_lshl_b32 s72, s72, 6
v_mov_b32 v20, 1
s_mov_b64 exec, 1
buffer_atomic_add v20, off, s[4:7], s72 sc1
s_mov_b64 exec, -1
hq_13:
s_mov_b32 s72, 0x3f803f80
v_mov_b32 v16, 0
v_mov_b32 v17, 0
v_mov_b32 v18, 0
v_dot2c_f32_bf16 v16, s72, v32
v_dot2c_f32_bf16 v17, v32, v32
v_dot2c_f32_bf16 v18, s72, v52
v_dot2c_f32_bf16 v16, s72, v33
v_dot2c_f32_bf16 v17, v33, v33
v_dot2c_f32_bf16 v18, s72, v53
v_dot2c_f32_bf16 v16, s72, v34
v_dot2c_f32_bf16 v17, v34, v34
v_dot2c_f32_bf16 v18, s72, v54
v_dot2c_f32_bf16 v16, s72, v35
v_dot2c_f32_bf16 v17, v35, v35
v_dot2c_f32_bf16 v18, s72, v55
v_dot2c_f32_bf16 v16, s72, v36
v_dot2c_f32_bf16 v17, v36, v36
v_dot2c_f32_bf16 v18, s72, v56
v_dot2c_f32_bf16 v16, s72, v37
v_dot2c_f32_bf16 v17, v37, v37
v_dot2c_f32_bf16 v18, s72, v57
v_dot2c_f32_bf16 v16, s72, v38
v_dot2c_f32_bf16 v17, v38, v38
v_dot2c_f32_bf16 v18, s72, v58
v_dot2c_f32_bf16 v16, s72, v39
v_dot2c_f32_bf16 v17, v39, v39
v_dot2c_f32_bf16 v18, s72, v59
v_dot2c_f32_bf16 v16, s72, v40
v_dot2c_f32_bf16 v17, v40, v40
v_dot2c_f32_bf16 v16, s72, v41
v_dot2c_f32_bf16 v17, v41, v41
v_dot2c_f32_bf16 v16, s72, v42
v_dot2c_f32_bf16 v17, v42, v42
v_dot2c_f32_bf16 v16, s72, v43
v_dot2c_f32_bf16 v17, v43, v43
v_dot2c_f32_bf16 v16, s72, v44
v_dot2c_f32_bf16 v17, v44, v44
v_dot2c_f32_bf16 v16, s72, v45
v_dot2c_f32_bf16 v17, v45, v45
v_dot2c_f32_bf16 v16, s72, v46
v_dot2c_f32_bf16 v17, v46, v46
v_dot2c_f32_bf16 v16, s72, v47
v_dot2c_f32_bf16 v17, v47, v47
s_nop 1
v_add_f32_dpp v16, v16, v16 row_ror:1 row_mask:0xf bank_mask:0xf
v_add_f32_dpp v17, v17, v17 row_ror:1 row_mask:0xf bank_mask:0xf
v_add_f32_dpp v18, v18, v18 row_ror:1 row_mask:0xf bank_mask:0xf
v_add_f32_dpp v16, v16, v16 row_ror:2 row_mask:0xf bank_mask:0xf
v_add_f32_dpp v17, v17, v17 row_ror:2 row_mask:0xf bank_mask:0xf
v_add_f32_dpp v18, v18, v18 row_ror:2 row_mask:0xf bank_mask:0xf
v_add_f32_dpp v16, v16, v16 row_ror:4 row_mask:0xf bank_mask:0xf
v_add_f32_dpp v17, v17, v17 row_ror:4 row_mask:0xf bank_mask:0xf
v_add_f32_dpp v18, v18, v18 row_ror:4 row_mask:0xf bank_mask:0xf
v_add_f32_dpp v16, v16, v16 row_ror:8 row_mask:0xf bank_mask:0xf
v_add_f32_dpp v17, v17, v17 row_ror:8 row_mask:0xf bank_mask:0xf
v_add_f32_dpp v18, v18, v18 row_ror:8 row_mask:0xf bank_mask:0xf
v_mov_b32 v20, v16
v_mov_b32 v21, v17
v_mov_b32 v22, v18
v_permlane16_swap_b32 v20, v16
v_permlane16_swap_b32 v21, v17
v_permlane16_swap_b32 v22, v18
v_add_f32 v16, v16, v20
v_add_f32 v17, v17, v21
v_add_f32 v18, v18, v22
s_nop 0
v_readlane_b32 s72, v18, 0
v_readlane_b32 s73, v18, 32
v_mul_f32 v20, 0xba800000, v16
v_mul_f32 v17, 0x3a800000, v17
v_mov_b32 v18, s72
v_add_f32 v18, s73, v18
v_fma_f32 v17, -v20, v20, v17
v_max_f32 v17, 0, v17
v_add_f32 v17, 0x3727c5ac, v17
v_rsq_f32 v16, v17
v_readfirstlane_b32 s34, v18
v_mul_f32 v17, v20, v16
v_or_b32 v16, 1, v16
v_or_b32 v17, 1, v17
s_branch hcs_11
trig_9:
v_and_b32 v15, 3, v0
v_lshlrev_b32 v15, 6, v15
buffer_load_dword v18, v15, s[4:7], 0 offen sc1
s_branch hcs_11
trig_10:
s_waitcnt vmcnt(30)
s_branch pchk_15
poll_14:
buffer_load_dword v18, v15, s[4:7], 0 offen sc1
s_waitcnt vmcnt(0)
pchk_15:
v_cmp_gt_u32 vcc, 64, v18
s_cbranch_vccz pdone_16
s_sub_u32 s32, s32, 1
s_cmp_gt_i32 s32, 0
s_cbranch_scc1 poll_14
pdone_16:
v_lshlrev_b32 v14, 3, v14
s_mov_b32 s72, 1376256
s_mov_b32 exec_lo, 1
s_mov_b32 exec_hi, 1
buffer_store_dwordx2 v[16:17], v14, s[24:27], s72 offen sc1
s_mov_b64 exec, -1
s_branch hcs_11
hqt_12:
s_lshl_b32 s74, s59, 11
s_lshl_b32 s72, s58, 9
s_add_u32 s74, s74, s72
s_add_u32 s74, s74, 1376256
v_lshlrev_b32 v15, 3, v0
s_add_u32 s75, s69, 49152
s_mov_b32 s72, s71
hqt_17:
s_waitcnt vmcnt(16)
s_barrier
s_mov_b32 m0, s75
s_lshl_b32 s73, s72, 17
buffer_load_dwordx4 v7, s[16:19], s73 offen offset:0 lds
s_add_u32 s73, s73, 7168
buffer_load_dwordx4 v7, s[16:19], s73 offen offset:1024 lds
s_add_u32 s73, s73, 7168
buffer_load_dwordx4 v7, s[16:19], s73 offen offset:2048 lds
s_add_u32 s73, s73, 7168
buffer_load_dwordx4 v7, s[16:19], s73 offen offset:3072 lds
s_add_u32 s75, s75, 16384
s_add_u32 s72, s72, 1
s_and_b32 s72, s72, 15
s_cmp_eq_u32 s67, 27
s_cbranch_scc0 hqt_18
buffer_load_dwordx2 v[16:17], v15, s[24:27], s74 offen sc1
hqt_18:
s_cmp_lg_u32 s63, 0
s_cbranch_scc1 hqt_19
v_add_u32 v20, s66, v12
ds_read_b64_tr_b16 v[22:23], v20 offset:0
ds_read_b64_tr_b16 v[24:25], v20 offset:2048
ds_read_b64_tr_b16 v[26:27], v20 offset:4096
s_add_u32 s66, s66, 22528
s_cmp_eq_u32 s66, 139264
s_cselect_b32 s66, 4096, s66
s_waitcnt lgkmcnt(2)
v_lshlrev_b32 v21, 16, v22
v_and_b32 v22, 0xffff0000, v22
v_add_f32 v9, v9, v21
v_add_f32 v9, v9, v22
v_lshlrev_b32 v21, 16, v23
v_and_b32 v23, 0xffff0000, v23
v_add_f32 v9, v9, v21
v_add_f32 v9, v9, v23
s_waitcnt lgkmcnt(1)
v_lshlrev_b32 v21, 16, v24
v_and_b32 v24, 0xffff0000, v24
v_add_f32 v10, v10, v21
v_add_f32 v10, v10, v24
v_lshlrev_b32 v21, 16, v25
v_and_b32 v25, 0xffff0000, v25
v_add_f32 v10, v10, v21
v_add_f32 v10, v10, v25
s_waitcnt lgkmcnt(0)
v_lshlrev_b32 v21, 16, v26
v_and_b32 v26, 0xffff0000, v26
v_add_f32 v11, v11, v21
v_add_f32 v11, v11, v26
v_lshlrev_b32 v21, 16, v27
v_and_b32 v27, 0xffff0000, v27
v_add_f32 v11, v11, v21
v_add_f32 v11, v11, v27
hqt_19:
s_add_u32 s67, s67, 1
s_cmp_lt_u32 s67, 32
s_cbranch_scc1 hqt_17
s_cmp_lg_u32 s63, 0
s_cbranch_scc1 hqt_20
v_and_b32 v20, 31, v0
v_lshlrev_b32 v20, 2, v20
ds_add_f32 v20, v9 offset:0
ds_add_f32 v20, v10 offset:128
ds_add_f32 v20, v11 offset:256
hqt_20:
s_waitcnt vmcnt(16)
s_branch pchk_22
poll_21:
buffer_load_dwordx2 v[16:17], v15, s[24:27], s74 offen sc1
s_waitcnt vmcnt(0)
pchk_22:
v_min_u32 v20, v16, v17
v_cmp_eq_u32 vcc, 0, v20
s_cbranch_vccz pdone_23
s_sub_u32 s32, s32, 1
s_cmp_gt_i32 s32, 0
s_cbranch_scc1 poll_21
pdone_23:
s_lshl_b32 s72, s59, 8
s_lshl_b32 s73, s58, 6
s_add_u32 s72, s72, s73
s_sub_u32 s72, s33, s72
v_cmp_eq_u32 vcc, s72, v0
v_mov_b32 v20, s43
v_mov_b32 v21, s3
v_cndmask_b32 v16, v16, v20, vcc
v_cndmask_b32 v17, v17, v21, vcc
s_lshl_b32 s73, s73, 2
v_lshl_add_u32 v20, v0, 2, s73
ds_write_b32 v20, v16 offset:2048
ds_write_b32 v20, v17 offset:3072
s_waitcnt lgkmcnt(0)
s_barrier
s_lshl_b32 s72, s59, 5
s_add_u32 s72, s72, s60
s_lshl_b32 s73, s72, 2
s_add_u32 s73, s73, s58
s_lshl_b32 s74, s73, 13
s_lshl_b32 s75, s63, 23
s_add_u32 s74, s74, s75
s_add_u32 s75, s74, 4096
s_lshl_b32 s73, s73, 6
s_add_u32 s73, s73, 1310720
s_lshl_b32 s76, s58, 13
v_add_u32 v20, s76, v13
v_mov_b32 v21, 0
v_lshlrev_b32 v22, 2, v0
s_barrier
ds_write_b32 v22, v21 offset:512
s_cmp_eq_u32 s59, 7
s_cbranch_scc1 nopub_24
ds_read_b128 v[32:35], v20 offset:4096
ds_read_b128 v[36:39], v20 offset:5120
ds_read_b128 v[40:43], v20 offset:6144
ds_read_b128 v[44:47], v20 offset:7168
ds_read_b128 v[48:51], v20 offset:8192
ds_read_b128 v[52:55], v20 offset:9216
ds_read_b128 v[56:59], v20 offset:10240
ds_read_b128 v[60:63], v20 offset:11264
s_waitcnt lgkmcnt(7)
buffer_store_dwordx4 v[32:35], v13, s[20:23], s74 offen offset:0 sc1
s_waitcnt lgkmcnt(6)
buffer_store_dwordx4 v[36:39], v13, s[20:23], s74 offen offset:1024 sc1
s_waitcnt lgkmcnt(5)
buffer_store_dwordx4 v[40:43], v13, s[20:23], s74 offen offset:2048 sc1
s_waitcnt lgkmcnt(4)
buffer_store_dwordx4 v[44:47], v13, s[20:23], s74 offen offset:3072 sc1
s_waitcnt lgkmcnt(3)
buffer_store_dwordx4 v[48:51], v13, s[20:23], s75 offen offset:0 sc1
s_waitcnt lgkmcnt(2)
buffer_store_dwordx4 v[52:55], v13, s[20:23], s75 offen offset:1024 sc1
s_waitcnt lgkmcnt(1)
buffer_store_dwordx4 v[56:59], v13, s[20:23], s75 offen offset:2048 sc1
s_waitcnt lgkmcnt(0)
buffer_store_dwordx4 v[60:63], v13, s[20:23], s75 offen offset:3072 sc1
v_mov_b32 v21, 1
s_mov_b64 exec, 1
s_waitcnt vmcnt(0)
buffer_store_dword v21, off, s[24:27], s73 sc1
s_mov_b64 exec, -1
nopub_24:
s_cmp_eq_u32 s59, 0
s_cbranch_scc1 nokvb_25
s_sub_u32 s73, s73, 8192
s_sub_u32 s74, s74, 1048576
s_sub_u32 s75, s75, 1048576
s_add_u32 s76, s76, 131072
poll_26:
buffer_load_dword v21, off, s[24:27], s73 sc1
s_waitcnt vmcnt(0)
pchk_27:
v_cmp_eq_u32 vcc, 0, v21
s_cbranch_vccz pdone_28
s_sub_u32 s32, s32, 1
s_cmp_gt_i32 s32, 0
s_cbranch_scc1 poll_26
pdone_28:
s_add_u32 m0, s76, 0
s_nop 0
buffer_load_dwordx4 v13, s[20:23], s74 offen offset:0 sc1 lds
buffer_load_dwordx4 v13, s[20:23], s74 offen offset:1024 sc1 lds
buffer_load_dwordx4 v13, s[20:23], s74 offen offset:2048 sc1 lds
buffer_load_dwordx4 v13, s[20:23], s74 offen offset:3072 sc1 lds
s_add_u32 m0, s76, 4096
s_nop 0
buffer_load_dwordx4 v13, s[20:23], s75 offen offset:0 sc1 lds
buffer_load_dwordx4 v13, s[20:23], s75 offen offset:1024 sc1 lds
buffer_load_dwordx4 v13, s[20:23], s75 offen offset:2048 sc1 lds
buffer_load_dwordx4 v13, s[20:23], s75 offen offset:3072 sc1 lds
nokvb_25:
s_cmp_lg_u32 s63, 0
s_cbranch_scc1 now_29
s_cmp_ge_u32 s2, 224
s_cbranch_scc1 now_29
s_cmp_ge_u32 s58, 2
s_cselect_b32 s4, s48, s46
s_cselect_b32 s5, s49, s47
s_mov_b32 s6, 7340032
s_mov_b32 s7, 0x00020000
s_and_b32 s72, s58, 1
s_lshl_b32 s72, s72, 5
v_lshrrev_b32 v20, 1, v0
v_add_u32 v20, s72, v20
v_mul_u32_u24 v20, 114688, v20
v_and_b32 v21, 1, v0
v_lshl_add_u32 v20, v21, 4, v20
s_lshl_b32 s72, s35, 5
buffer_load_dwordx4 v[32:35], v20, s[4:7], s72 offen
s_add_u32 s72, s72, 7168
buffer_load_dwordx4 v[36:39], v20, s[4:7], s72 offen
s_add_u32 s72, s72, 7168
buffer_load_dwordx4 v[40:43], v20, s[4:7], s72 offen
s_add_u32 s72, s72, 7168
buffer_load_dwordx4 v[44:47], v20, s[4:7], s72 offen
s_add_u32 s72, s72, 7168
buffer_load_dwordx4 v[48:51], v20, s[4:7], s72 offen
s_add_u32 s72, s72, 7168
buffer_load_dwordx4 v[52:55], v20, s[4:7], s72 offen
s_add_u32 s72, s72, 7168
buffer_load_dwordx4 v[56:59], v20, s[4:7], s72 offen
s_add_u32 s72, s72, 7168
buffer_load_dwordx4 v[60:63], v20, s[4:7], s72 offen
s_add_u32 s72, s72, 7168
buffer_load_dwordx4 v[64:67], v20, s[4:7], s72 offen
s_add_u32 s72, s72, 7168
buffer_load_dwordx4 v[68:71], v20, s[4:7], s72 offen
s_add_u32 s72, s72, 7168
buffer_load_dwordx4 v[72:75], v20, s[4:7], s72 offen
s_add_u32 s72, s72, 7168
buffer_load_dwordx4 v[76:79], v20, s[4:7], s72 offen
s_add_u32 s72, s72, 7168
buffer_load_dwordx4 v[80:83], v20, s[4:7], s72 offen
s_add_u32 s72, s72, 7168
buffer_load_dwordx4 v[84:87], v20, s[4:7], s72 offen
s_add_u32 s72, s72, 7168
buffer_load_dwordx4 v[88:91], v20, s[4:7], s72 offen
s_add_u32 s72, s72, 7168
buffer_load_dwordx4 v[92:95], v20, s[4:7], s72 offen
s_mov_b32 s4, s50
s_mov_b32 s5, s51
s_mov_b32 s6, 0x700000
s_mov_b32 s7, 0x00020000
s_lshl_b32 s72, s35, 15
s_lshl_b32 s73, s58, 9
s_add_u32 s72, s72, s73
v_lshlrev_b32 v20, 3, v0
buffer_load_dwordx2 v[96:97], v20, s[4:7], s72 offen offset:0
buffer_load_dwordx2 v[98:99], v20, s[4:7], s72 offen offset:2048
s_add_u32 s72, s72, 4096
buffer_load_dwordx2 v[100:101], v20, s[4:7], s72 offen offset:0
buffer_load_dwordx2 v[102:103], v20, s[4:7], s72 offen offset:2048
s_add_u32 s72, s72, 4096
buffer_load_dwordx2 v[104:105], v20, s[4:7], s72 offen offset:0
buffer_load_dwordx2 v[106:107], v20, s[4:7], s72 offen offset:2048
s_add_u32 s72, s72, 4096
buffer_load_dwordx2 v[108:109], v20, s[4:7], s72 offen offset:0
buffer_load_dwordx2 v[110:111], v20, s[4:7], s72 offen offset:2048
s_add_u32 s72, s72, 4096
buffer_load_dwordx2 v[112:113], v20, s[4:7], s72 offen offset:0
buffer_load_dwordx2 v[114:115], v20, s[4:7], s72 offen offset:2048
s_add_u32 s72, s72, 4096
buffer_load_dwordx2 v[116:117], v20, s[4:7], s72 offen offset:0
buffer_load_dwordx2 v[118:119], v20, s[4:7], s72 offen offset:2048
s_add_u32 s72, s72, 4096
buffer_load_dwordx2 v[120:121], v20, s[4:7], s72 offen offset:0
buffer_load_dwordx2 v[122:123], v20, s[4:7], s72 offen offset:2048
s_add_u32 s72, s72, 4096
buffer_load_dwordx2 v[124:125], v20, s[4:7], s72 offen offset:0
buffer_load_dwordx2 v[126:127], v20, s[4:7], s72 offen offset:2048
s_waitcnt vmcnt(32)
s_barrier
s_mov_b32 s72, 0x05040100
s_mov_b32 s73, 0x07060302
s_waitcnt vmcnt(30)
v_perm_b32 v160, v36, v32, s72
v_perm_b32 v161, v36, v32, s73
v_perm_b32 v162, v37, v33, s72
v_perm_b32 v163, v37, v33, s73
v_perm_b32 v164, v38, v34, s72
v_perm_b32 v165, v38, v34, s73
v_perm_b32 v166, v39, v35, s72
v_perm_b32 v167, v39, v35, s73
s_waitcnt vmcnt(28)
v_perm_b32 v168, v44, v40, s72
v_perm_b32 v169, v44, v40, s73
v_perm_b32 v170, v45, v41, s72
v_perm_b32 v171, v45, v41, s73
v_perm_b32 v172, v46, v42, s72
v_perm_b32 v173, v46, v42, s73
v_perm_b32 v174, v47, v43, s72
v_perm_b32 v175, v47, v43, s73
s_waitcnt vmcnt(26)
v_perm_b32 v176, v52, v48, s72
v_perm_b32 v177, v52, v48, s73
v_perm_b32 v178, v53, v49, s72
v_perm_b32 v179, v53, v49, s73
v_perm_b32 v180, v54, v50, s72
v_perm_b32 v181, v54, v50, s73
v_perm_b32 v182, v55, v51, s72
v_perm_b32 v183, v55, v51, s73
s_waitcnt vmcnt(24)
v_perm_b32 v184, v60, v56, s72
v_perm_b32 v185, v60, v56, s73
v_perm_b32 v186, v61, v57, s72
v_perm_b32 v187, v61, v57, s73
v_perm_b32 v188, v62, v58, s72
v_perm_b32 v189, v62, v58, s73
v_perm_b32 v190, v63, v59, s72
v_perm_b32 v191, v63, v59, s73
s_waitcnt vmcnt(22)
v_perm_b32 v192, v68, v64, s72
v_perm_b32 v193, v68, v64, s73
v_perm_b32 v194, v69, v65, s72
v_perm_b32 v195, v69, v65, s73
v_perm_b32 v196, v70, v66, s72
v_perm_b32 v197, v70, v66, s73
v_perm_b32 v198, v71, v67, s72
v_perm_b32 v199, v71, v67, s73
s_waitcnt vmcnt(20)
v_perm_b32 v200, v76, v72, s72
v_perm_b32 v201, v76, v72, s73
v_perm_b32 v202, v77, v73, s72
v_perm_b32 v203, v77, v73, s73
v_perm_b32 v204, v78, v74, s72
v_perm_b32 v205, v78, v74, s73
v_perm_b32 v206, v79, v75, s72
v_perm_b32 v207, v79, v75, s73
s_waitcnt vmcnt(18)
v_perm_b32 v208, v84, v80, s72
v_perm_b32 v209, v84, v80, s73
v_perm_b32 v210, v85, v81, s72
v_perm_b32 v211, v85, v81, s73
v_perm_b32 v212, v86, v82, s72
v_perm_b32 v213, v86, v82, s73
v_perm_b32 v214, v87, v83, s72
v_perm_b32 v215, v87, v83, s73
s_waitcnt vmcnt(16)
v_perm_b32 v216, v92, v88, s72
v_perm_b32 v217, v92, v88, s73
v_perm_b32 v218, v93, v89, s72
v_perm_b32 v219, v93, v89, s73
v_perm_b32 v220, v94, v90, s72
v_perm_b32 v221, v94, v90, s73
v_perm_b32 v222, v95, v91, s72
v_perm_b32 v223, v95, v91, s73
s_waitcnt vmcnt(14)
v_perm_b32 v224, v98, v96, s72
v_perm_b32 v225, v98, v96, s73
v_perm_b32 v226, v99, v97, s72
v_perm_b32 v227, v99, v97, s73
s_waitcnt vmcnt(12)
v_perm_b32 v228, v102, v100, s72
v_perm_b32 v229, v102, v100, s73
v_perm_b32 v230, v103, v101, s72
v_perm_b32 v231, v103, v101, s73
s_waitcnt vmcnt(10)
v_perm_b32 v232, v106, v104, s72
v_perm_b32 v233, v106, v104, s73
v_perm_b32 v234, v107, v105, s72
v_perm_b32 v235, v107, v105, s73
s_waitcnt vmcnt(8)
v_perm_b32 v236, v110, v108, s72
v_perm_b32 v237, v110, v108, s73
v_perm_b32 v238, v111, v109, s72
v_perm_b32 v239, v111, v109, s73
s_waitcnt vmcnt(6)
v_perm_b32 v240, v114, v112, s72
v_perm_b32 v241, v114, v112, s73
v_perm_b32 v242, v115, v113, s72
v_perm_b32 v243, v115, v113, s73
s_waitcnt vmcnt(4)
v_perm_b32 v244, v118, v116, s72
v_perm_b32 v245, v118, v116, s73
v_perm_b32 v246, v119, v117, s72
v_perm_b32 v247, v119, v117, s73
s_waitcnt vmcnt(2)
v_perm_b32 v248, v122, v120, s72
v_perm_b32 v249, v122, v120, s73
v_perm_b32 v250, v123, v121, s72
v_perm_b32 v251, v123, v121, s73
s_waitcnt vmcnt(0)
v_perm_b32 v252, v126, v124, s72
v_perm_b32 v253, v126, v124, s73
v_perm_b32 v254, v127, v125, s72
v_perm_b32 v255, v127, v125, s73
s_branch now_30
now_29:
s_waitcnt vmcnt(0)
s_barrier
now_30:
s_lshl_b32 s74, s61, 8
s_add_u32 s74, s74, 1392640
v_lshlrev_b32 v20, 2, v0
s_lshl_b32 s75, s58, 11
s_lshl_b32 s76, s63, 22
s_barrier
s_add_u32 s72, s71, 5
s_and_b32 s72, s72, 15
s_add_u32 m0, s69, 131072
s_lshl_b32 s73, s72, 17
buffer_load_dwordx4 v7, s[16:19], s73 offen offset:0 lds
s_add_u32 s73, s73, 7168
buffer_load_dwordx4 v7, s[16:19], s73 offen offset:1024 lds
s_add_u32 s73, s73, 7168
buffer_load_dwordx4 v7, s[16:19], s73 offen offset:2048 lds
s_add_u32 s73, s73, 7168
buffer_load_dwordx4 v7, s[16:19], s73 offen offset:3072 lds
poll_31:
buffer_load_dword v21, v20, s[24:27], s74 offen sc1
s_waitcnt vmcnt(0)
pchk_32:
v_cmp_eq_u32 vcc, 0, v21
s_cbranch_vccz pdone_33
s_sub_u32 s32, s32, 1
s_cmp_gt_i32 s32, 0
s_cbranch_scc1 poll_31
pdone_33:
s_add_u32 s72, s71, 0
s_and_b32 s72, s72, 15
s_add_u32 m0, s75, 4096
s_lshl_b32 s72, s72, 12
s_add_u32 s72, s72, s76
buffer_load_dwordx4 v8, s[20:23], s72 offen offset:0 sc1 lds
buffer_load_dwordx4 v8, s[20:23], s72 offen offset:1024 sc1 lds
s_add_u32 s72, s71, 1
s_and_b32 s72, s72, 15
s_add_u32 m0, s75, 12288
s_lshl_b32 s72, s72, 12
s_add_u32 s72, s72, s76
buffer_load_dwordx4 v8, s[20:23], s72 offen offset:0 sc1 lds
buffer_load_dwordx4 v8, s[20:23], s72 offen offset:1024 sc1 lds
s_add_u32 s72, s71, 2
s_and_b32 s72, s72, 15
s_add_u32 m0, s75, 20480
s_lshl_b32 s72, s72, 12
s_add_u32 s72, s72, s76
buffer_load_dwordx4 v8, s[20:23], s72 offen offset:0 sc1 lds
buffer_load_dwordx4 v8, s[20:23], s72 offen offset:1024 sc1 lds
s_add_u32 s72, s71, 3
s_and_b32 s72, s72, 15
s_add_u32 m0, s75, 28672
s_lshl_b32 s72, s72, 12
s_add_u32 s72, s72, s76
buffer_load_dwordx4 v8, s[20:23], s72 offen offset:0 sc1 lds
buffer_load_dwordx4 v8, s[20:23], s72 offen offset:1024 sc1 lds
s_barrier
s_waitcnt vmcnt(6)
s_barrier
s_add_u32 s72, s71, 4
s_and_b32 s72, s72, 15
s_add_u32 m0, s75, 36864
s_lshl_b32 s72, s72, 12
s_add_u32 s72, s72, s76
buffer_load_dwordx4 v8, s[20:23], s72 offen offset:0 sc1 lds
buffer_load_dwordx4 v8, s[20:23], s72 offen offset:1024 sc1 lds
s_add_u32 s72, s71, 6
s_and_b32 s72, s72, 15
s_add_u32 m0, s69, 147456
s_lshl_b32 s73, s72, 17
buffer_load_dwordx4 v7, s[16:19], s73 offen offset:0 lds
s_add_u32 s73, s73, 7168
buffer_load_dwordx4 v7, s[16:19], s73 offen offset:1024 lds
s_add_u32 s73, s73, 7168
buffer_load_dwordx4 v7, s[16:19], s73 offen offset:2048 lds
s_add_u32 s73, s73, 7168
buffer_load_dwordx4 v7, s[16:19], s73 offen offset:3072 lds
s_waitcnt vmcnt(10)
s_barrier
s_add_u32 s72, s71, 5
s_and_b32 s72, s72, 15
s_add_u32 m0, s75, 4096
s_lshl_b32 s72, s72, 12
s_add_u32 s72, s72, s76
buffer_load_dwordx4 v8, s[20:23], s72 offen offset:0 sc1 lds
buffer_load_dwordx4 v8, s[20:23], s72 offen offset:1024 sc1 lds
s_add_u32 s72, s71, 7
s_and_b32 s72, s72, 15
s_add_u32 m0, s69, 49152
s_lshl_b32 s73, s72, 17
buffer_load_dwordx4 v7, s[16:19], s73 offen offset:0 lds
s_add_u32 s73, s73, 7168
buffer_load_dwordx4 v7, s[16:19], s73 offen offset:1024 lds
s_add_u32 s73, s73, 7168
buffer_load_dwordx4 v7, s[16:19], s73 offen offset:2048 lds
s_add_u32 s73, s73, 7168
buffer_load_dwordx4 v7, s[16:19], s73 offen offset:3072 lds
s_waitcnt vmcnt(14)
s_barrier
s_add_u32 s72, s71, 6
s_and_b32 s72, s72, 15
s_add_u32 m0, s75, 12288
s_lshl_b32 s72, s72, 12
s_add_u32 s72, s72, s76
buffer_load_dwordx4 v8, s[20:23], s72 offen offset:0 sc1 lds
buffer_load_dwordx4 v8, s[20:23], s72 offen offset:1024 sc1 lds
s_add_u32 s72, s71, 8
s_and_b32 s72, s72, 15
s_add_u32 m0, s69, 65536
s_lshl_b32 s73, s72, 17
buffer_load_dwordx4 v7, s[16:19], s73 offen offset:0 lds
s_add_u32 s73, s73, 7168
buffer_load_dwordx4 v7, s[16:19], s73 offen offset:1024 lds
s_add_u32 s73, s73, 7168
buffer_load_dwordx4 v7, s[16:19], s73 offen offset:2048 lds
s_add_u32 s73, s73, 7168
buffer_load_dwordx4 v7, s[16:19], s73 offen offset:3072 lds
s_waitcnt vmcnt(18)
s_barrier
s_add_u32 s72, s71, 7
s_and_b32 s72, s72, 15
s_add_u32 m0, s75, 20480
s_lshl_b32 s72, s72, 12
s_add_u32 s72, s72, s76
buffer_load_dwordx4 v8, s[20:23], s72 offen offset:0 sc1 lds
buffer_load_dwordx4 v8, s[20:23], s72 offen offset:1024 sc1 lds
s_add_u32 s72, s71, 9
s_and_b32 s72, s72, 15
s_add_u32 m0, s69, 81920
s_lshl_b32 s73, s72, 17
buffer_load_dwordx4 v7, s[16:19], s73 offen offset:0 lds
s_add_u32 s73, s73, 7168
buffer_load_dwordx4 v7, s[16:19], s73 offen offset:1024 lds
s_add_u32 s73, s73, 7168
buffer_load_dwordx4 v7, s[16:19], s73 offen offset:2048 lds
s_add_u32 s73, s73, 7168
buffer_load_dwordx4 v7, s[16:19], s73 offen offset:3072 lds
s_waitcnt vmcnt(22)
s_barrier
s_add_u32 s72, s71, 8
s_and_b32 s72, s72, 15
s_add_u32 m0, s75, 28672
s_lshl_b32 s72, s72, 12
s_add_u32 s72, s72, s76
buffer_load_dwordx4 v8, s[20:23], s72 offen offset:0 sc1 lds
buffer_load_dwordx4 v8, s[20:23], s72 offen offset:1024 sc1 lds
s_add_u32 s72, s71, 10
s_and_b32 s72, s72, 15
s_add_u32 m0, s69, 98304
s_lshl_b32 s73, s72, 17
buffer_load_dwordx4 v7, s[16:19], s73 offen offset:0 lds
s_add_u32 s73, s73, 7168
buffer_load_dwordx4 v7, s[16:19], s73 offen offset:1024 lds
s_add_u32 s73, s73, 7168
buffer_load_dwordx4 v7, s[16:19], s73 offen offset:2048 lds
s_add_u32 s73, s73, 7168
buffer_load_dwordx4 v7, s[16:19], s73 offen offset:3072 lds
s_waitcnt vmcnt(22)
s_barrier
s_add_u32 s72, s71, 9
s_and_b32 s72, s72, 15
s_add_u32 m0, s75, 36864
s_lshl_b32 s72, s72, 12
s_add_u32 s72, s72, s76
buffer_load_dwordx4 v8, s[20:23], s72 offen offset:0 sc1 lds
buffer_load_dwordx4 v8, s[20:23], s72 offen offset:1024 sc1 lds
s_add_u32 s72, s71, 11
s_and_b32 s72, s72, 15
s_add_u32 m0, s69, 114688
s_lshl_b32 s73, s72, 17
buffer_load_dwordx4 v7, s[16:19], s73 offen offset:0 lds
s_add_u32 s73, s73, 7168
buffer_load_dwordx4 v7, s[16:19], s73 offen offset:1024 lds
s_add_u32 s73, s73, 7168
buffer_load_dwordx4 v7, s[16:19], s73 offen offset:2048 lds
s_add_u32 s73, s73, 7168
buffer_load_dwordx4 v7, s[16:19], s73 offen offset:3072 lds
s_waitcnt vmcnt(22)
s_barrier
s_add_u32 s72, s71, 10
s_and_b32 s72, s72, 15
s_add_u32 m0, s75, 4096
s_lshl_b32 s72, s72, 12
s_add_u32 s72, s72, s76
buffer_load_dwordx4 v8, s[20:23], s72 offen offset:0 sc1 lds
buffer_load_dwordx4 v8, s[20:23], s72 offen offset:1024 sc1 lds
s_add_u32 s72, s71, 12
s_and_b32 s72, s72, 15
s_add_u32 m0, s69, 131072
s_lshl_b32 s73, s72, 17
buffer_load_dwordx4 v7, s[16:19], s73 offen offset:0 lds
s_add_u32 s73, s73, 7168
buffer_load_dwordx4 v7, s[16:19], s73 offen offset:1024 lds
s_add_u32 s73, s73, 7168
buffer_load_dwordx4 v7, s[16:19], s73 offen offset:2048 lds
s_add_u32 s73, s73, 7168
buffer_load_dwordx4 v7, s[16:19], s73 offen offset:3072 lds
s_waitcnt vmcnt(22)
s_barrier
s_add_u32 s72, s71, 11
s_and_b32 s72, s72, 15
s_add_u32 m0, s75, 12288
s_lshl_b32 s72, s72, 12
s_add_u32 s72, s72, s76
buffer_load_dwordx4 v8, s[20:23], s72 offen offset:0 sc1 lds
buffer_load_dwordx4 v8, s[20:23], s72 offen offset:1024 sc1 lds
s_add_u32 s72, s71, 13
s_and_b32 s72, s72, 15
s_add_u32 m0, s69, 147456
s_lshl_b32 s73, s72, 17
buffer_load_dwordx4 v7, s[16:19], s73 offen offset:0 lds
s_add_u32 s73, s73, 7168
buffer_load_dwordx4 v7, s[16:19], s73 offen offset:1024 lds
s_add_u32 s73, s73, 7168
buffer_load_dwordx4 v7, s[16:19], s73 offen offset:2048 lds
s_add_u32 s73, s73, 7168
buffer_load_dwordx4 v7, s[16:19], s73 offen offset:3072 lds
s_waitcnt vmcnt(22)
s_barrier
s_add_u32 s72, s71, 12
s_and_b32 s72, s72, 15
s_add_u32 m0, s75, 20480
s_lshl_b32 s72, s72, 12
s_add_u32 s72, s72, s76
buffer_load_dwordx4 v8, s[20:23], s72 offen offset:0 sc1 lds
buffer_load_dwordx4 v8, s[20:23], s72 offen offset:1024 sc1 lds
s_add_u32 s72, s71, 14
s_and_b32 s72, s72, 15
s_add_u32 m0, s69, 49152
s_lshl_b32 s73, s72, 17
buffer_load_dwordx4 v7, s[16:19], s73 offen offset:0 lds
s_add_u32 s73, s73, 7168
buffer_load_dwordx4 v7, s[16:19], s73 offen offset:1024 lds
s_add_u32 s73, s73, 7168
buffer_load_dwordx4 v7, s[16:19], s73 offen offset:2048 lds
s_add_u32 s73, s73, 7168
buffer_load_dwordx4 v7, s[16:19], s73 offen offset:3072 lds
s_waitcnt vmcnt(22)
s_barrier
s_add_u32 s72, s71, 13
s_and_b32 s72, s72, 15
s_add_u32 m0, s75, 28672
s_lshl_b32 s72, s72, 12
s_add_u32 s72, s72, s76
buffer_load_dwordx4 v8, s[20:23], s72 offen offset:0 sc1 lds
buffer_load_dwordx4 v8, s[20:23], s72 offen offset:1024 sc1 lds
s_add_u32 s72, s71, 15
s_and_b32 s72, s72, 15
s_add_u32 m0, s69, 65536
s_lshl_b32 s73, s72, 17
buffer_load_dwordx4 v7, s[16:19], s73 offen offset:0 lds
s_add_u32 s73, s73, 7168
buffer_load_dwordx4 v7, s[16:19], s73 offen offset:1024 lds
s_add_u32 s73, s73, 7168
buffer_load_dwordx4 v7, s[16:19], s73 offen offset:2048 lds
s_add_u32 s73, s73, 7168
buffer_load_dwordx4 v7, s[16:19], s73 offen offset:3072 lds
s_waitcnt vmcnt(22)
s_barrier
s_add_u32 s72, s71, 14
s_and_b32 s72, s72, 15
s_add_u32 m0, s75, 36864
s_lshl_b32 s72, s72, 12
s_add_u32 s72, s72, s76
buffer_load_dwordx4 v8, s[20:23], s72 offen offset:0 sc1 lds
buffer_load_dwordx4 v8, s[20:23], s72 offen offset:1024 sc1 lds
s_waitcnt vmcnt(18)
s_barrier
s_add_u32 s72, s71, 15
s_and_b32 s72, s72, 15
s_add_u32 m0, s75, 4096
s_lshl_b32 s72, s72, 12
s_add_u32 s72, s72, s76
buffer_load_dwordx4 v8, s[20:23], s72 offen offset:0 sc1 lds
buffer_load_dwordx4 v8, s[20:23], s72 offen offset:1024 sc1 lds
s_waitcnt vmcnt(14)
s_barrier
s_waitcnt vmcnt(8)
s_barrier
s_waitcnt vmcnt(2)
s_barrier
s_waitcnt vmcnt(0)
s_barrier
s_barrier
s_lshl_b32 s74, s61, 13
s_add_u32 s74, s74, 917504
s_add_u32 s75, s74, 4096
s_lshl_b32 s76, s62, 10
s_add_u32 s76, s76, s74
s_barrier
s_cmp_lg_u32 s58, 0
s_cbranch_scc1 s2_34
ds_read_b96 v[32:34], v13 offset:4096
ds_read_b96 v[36:38], v13 offset:5120
ds_read_b96 v[40:42], v13 offset:6144
ds_read_b96 v[44:46], v13 offset:7168
v_mov_b32 v35, 1
s_waitcnt lgkmcnt(2)
v_add_f32 v32, v32, v36
v_add_f32 v33, v33, v37
v_add_f32 v34, v34, v38
s_waitcnt lgkmcnt(1)
v_add_f32 v32, v32, v40
v_add_f32 v33, v33, v41
v_add_f32 v34, v34, v42
s_waitcnt lgkmcnt(0)
v_add_f32 v32, v32, v44
v_add_f32 v33, v33, v45
v_add_f32 v34, v34, v46
v_or_b32 v32, 1, v32
v_or_b32 v33, 1, v33
v_or_b32 v34, 1, v34
buffer_store_dwordx4 v[32:35], v13, s[24:27], s76 offen sc1
poll_35:
buffer_load_dwordx4 v[36:39], v13, s[24:27], s74 offen offset:0 sc1
buffer_load_dwordx4 v[40:43], v13, s[24:27], s74 offen offset:1024 sc1
buffer_load_dwordx4 v[44:47], v13, s[24:27], s74 offen offset:2048 sc1
buffer_load_dwordx4 v[48:51], v13, s[24:27], s74 offen offset:3072 sc1
buffer_load_dwordx4 v[52:55], v13, s[24:27], s75 offen offset:0 sc1
buffer_load_dwordx4 v[56:59], v13, s[24:27], s75 offen offset:1024 sc1
buffer_load_dwordx4 v[60:63], v13, s[24:27], s75 offen offset:2048 sc1
buffer_load_dwordx4 v[64:67], v13, s[24:27], s75 offen offset:3072 sc1
s_waitcnt vmcnt(0)
pchk_36:
v_min3_u32 v20, v36, v37, v38
v_min3_u32 v20, v20, v40, v41
v_min3_u32 v20, v20, v42, v44
v_min3_u32 v20, v20, v45, v46
v_min3_u32 v20, v20, v48, v49
v_min3_u32 v20, v20, v50, v52
v_min3_u32 v20, v20, v53, v54
v_min3_u32 v20, v20, v56, v57
v_min3_u32 v20, v20, v58, v60
v_min3_u32 v20, v20, v61, v62
v_min3_u32 v20, v20, v64, v65
v_min_u32 v20, v20, v66
v_cmp_eq_u32 vcc, 0, v20
s_cbranch_vccz pdone_37
s_sub_u32 s32, s32, 1
s_cmp_gt_i32 s32, 0
s_cbranch_scc1 poll_35
pdone_37:
v_add_f32 v36, v36, v40
v_add_f32 v37, v37, v41
v_add_f32 v38, v38, v42
v_add_f32 v36, v36, v44
v_add_f32 v37, v37, v45
v_add_f32 v38, v38, v46
v_add_f32 v36, v36, v48
v_add_f32 v37, v37, v49
v_add_f32 v38, v38, v50
v_add_f32 v36, v36, v52
v_add_f32 v37, v37, v53
v_add_f32 v38, v38, v54
v_add_f32 v36, v36, v56
v_add_f32 v37, v37, v57
v_add_f32 v38, v38, v58
v_add_f32 v36, v36, v60
v_add_f32 v37, v37, v61
v_add_f32 v38, v38, v62
v_add_f32 v36, v36, v64
v_add_f32 v37, v37, v65
v_add_f32 v38, v38, v66
v_mul_f32 v42, 0x3a800000, v36
v_mul_f32 v37, 0x3a800000, v37
v_fma_f32 v37, -v42, v42, v37
v_max_f32 v37, 0, v37
v_add_f32 v20, 0x3727c5ac, v37
v_rsq_f32 v43, v20
v_fma_f32 v38, -v42, s34, v38
v_mul_f32 v40, v43, v38
v_or_b32 v40, 1, v40
v_mov_b32 v20, v40
s_nop 1
v_max_f32_dpp v20, v20, v20 row_ror:1 row_mask:0xf bank_mask:0xf
s_nop 1
v_max_f32_dpp v20, v20, v20 row_ror:2 row_mask:0xf bank_mask:0xf
s_nop 1
v_max_f32_dpp v20, v20, v20 row_ror:4 row_mask:0xf bank_mask:0xf
s_nop 1
v_max_f32_dpp v20, v20, v20 row_ror:8 row_mask:0xf bank_mask:0xf
v_mov_b32 v21, v20
s_nop 1
v_permlane16_swap_b32 v21, v20
v_max_f32 v20, v20, v21
v_mov_b32 v21, v20
s_nop 1
v_permlane32_swap_b32 v21, v20
v_max_f32 v20, v20, v21
v_cmp_eq_f32 vcc, v20, v40
s_ff1_i32_b64 s72, vcc
s_and_b32 s72, s72, 63
s_lshl_b32 s73, s61, 6
s_add_u32 s73, s73, 1
v_add_u32 v41, s73, v0
v_or_b32 v42, 1, v42
s_mul_i32 s73, s72, 272
s_add_u32 s73, s73, 139264
v_add_u32 v20, s73, v13
ds_read_b128 v[32:35], v20
s_lshl_b32 s74, s62, 9
s_lshl_b32 s75, s61, 4
s_add_u32 s74, s74, s75
s_add_u32 s74, s74, 1400832
s_lshl_b64 exec, 1, s72
buffer_store_dwordx4 v[40:43], off, s[24:27], s74 sc1
s_mov_b64 exec, -1
s_lshl_b32 s74, s61, 11
s_lshl_b32 s75, s62, 8
s_add_u32 s74, s74, s75
s_add_u32 s74, s74, 1179648
s_brev_b32 s75, 1
v_mov_b32 v21, s75
s_waitcnt lgkmcnt(0)
v_cmp_eq_u32 vcc, 0, v32
s_nop 1
v_cndmask_b32 v32, v32, v21, vcc
v_cmp_eq_u32 vcc, 0, v33
s_nop 1
v_cndmask_b32 v33, v33, v21, vcc
v_cmp_eq_u32 vcc, 0, v34
s_nop 1
v_cndmask_b32 v34, v34, v21, vcc
v_cmp_eq_u32 vcc, 0, v35
s_nop 1
v_cndmask_b32 v35, v35, v21, vcc
s_mov_b64 exec, 0xffff
buffer_store_dwordx4 v[32:35], v13, s[24:27], s74 offen sc1
s_mov_b64 exec, -1
v_add_f32 v44, 1.0, v43
v_mul_f32 v45, -v42, v43
v_lshlrev_b32 v20, 3, v0
ds_write_b64 v20, v[44:45] offset:1024
s_or_b32 s74, s63, s62
s_cbranch_scc1 s2_34
v_mul_f32 v46, v44, v44
v_mul_f32 v46, v46, v37
v_add_f32 v46, 0x3727c5ac, v46
v_rsq_f32 v46, v46
s_lshl_b32 s74, s61, 9
s_add_u32 s74, s74, 2949120
v_mul_f32 v46, v46, v44
v_mul_f32 v47, -v42, v46
v_or_b32 v46, 1, v46
v_or_b32 v47, 1, v47
buffer_store_dwordx2 v[46:47], v20, s[24:27], s74 offen sc1
s2_34:
s_lshl_b32 s74, s62, 9
s_add_u32 s74, s74, 1400832
v_and_b32 v22, 31, v0
v_lshlrev_b32 v22, 4, v22
s_and_b32 s72, s58, 1
s_lshl_b32 s72, s72, 10
v_and_b32 v23, 62, v0
v_lshl_add_u32 v23, v23, 4, s72
s_and_b32 s77, s2, 7
s_lshl_b32 s77, s77, 5
s_lshr_b32 s72, s2, 3
s_add_u32 s77, s77, s72
poll_38:
buffer_load_dwordx4 v[32:35], v22, s[24:27], s74 offen sc1
s_waitcnt vmcnt(0)
pchk_39:
v_min3_u32 v20, v32, v33, v34
v_min_u32 v20, v20, v35
v_cmp_eq_u32 vcc, 0, v20
s_cbranch_vccz pdone_40
s_sub_u32 s32, s32, 1
s_cmp_gt_i32 s32, 0
s_cbranch_scc1 poll_38
pdone_40:
v_mov_b32 v20, v32
s_nop 1
v_max_f32_dpp v20, v20, v20 row_ror:1 row_mask:0xf bank_mask:0xf
s_nop 1
v_max_f32_dpp v20, v20, v20 row_ror:2 row_mask:0xf bank_mask:0xf
s_nop 1
v_max_f32_dpp v20, v20, v20 row_ror:4 row_mask:0xf bank_mask:0xf
s_nop 1
v_max_f32_dpp v20, v20, v20 row_ror:8 row_mask:0xf bank_mask:0xf
v_mov_b32 v21, v20
s_nop 1
v_permlane16_swap_b32 v21, v20
v_max_f32 v20, v20, v21
v_mov_b32 v21, v20
s_nop 1
v_permlane32_swap_b32 v21, v20
v_max_f32 v20, v20, v21
v_cmp_eq_f32 vcc, v20, v32
s_ff1_i32_b64 s72, vcc
s_and_b32 s72, s72, 63
v_readlane_b32 s33, v33, s72
v_readlane_b32 s42, v32, s72
v_readlane_b32 s78, v34, s72
v_readlane_b32 s79, v35, s72
s_sub_u32 s33, s33, 1
s_and_b32 s33, s33, 2047
s_lshr_b32 s74, s33, 6
s_lshl_b32 s74, s74, 11
s_add_u32 s74, s74, 1179648
s_lshl_b32 s75, s77, 3
s_add_u32 s75, s75, s74
buffer_load_dwordx4 v[32:35], v23, s[24:27], s74 offen offset:0 sc1
buffer_load_dwordx4 v[36:39], v23, s[24:27], s74 offen offset:16 sc1
buffer_load_dwordx2 v[40:41], off, s[24:27], s75 sc1
v_mov_b32 v20, 0
v_mov_b32 v21, s33
ds_write_b32 v20, v21 offset:640
v_mov_b32 v24, s79
v_mul_f32 v25, s78, v24
v_sub_f32 v25, 0, v25
s_waitcnt vmcnt(0)
s_branch pchk_42
poll_41:
buffer_load_dwordx4 v[32:35], v23, s[24:27], s74 offen offset:0 sc1
buffer_load_dwordx4 v[36:39], v23, s[24:27], s74 offen offset:16 sc1
buffer_load_dwordx2 v[40:41], off, s[24:27], s75 sc1
s_waitcnt vmcnt(0)
pchk_42:
v_min3_u32 v20, v32, v33, v34
v_min3_u32 v20, v20, v35, v36
v_min3_u32 v20, v20, v37, v38
v_min3_u32 v20, v20, v39, v40
v_min_u32 v20, v20, v41
v_cmp_eq_u32 vcc, 0, v20
s_cbranch_vccz pdone_43
s_sub_u32 s32, s32, 1
s_cmp_gt_i32 s32, 0
s_cbranch_scc1 poll_41
pdone_43:
s_cmp_ge_u32 s2, 224
s_cbranch_scc1 nogu_44
v_lshlrev_b32 v48, 16, v32
v_and_b32 v49, 0xffff0000, v32
v_lshlrev_b32 v50, 16, v33
v_and_b32 v51, 0xffff0000, v33
v_lshlrev_b32 v52, 16, v34
v_and_b32 v53, 0xffff0000, v34
v_lshlrev_b32 v54, 16, v35
v_and_b32 v55, 0xffff0000, v35
v_lshlrev_b32 v56, 16, v36
v_and_b32 v57, 0xffff0000, v36
v_lshlrev_b32 v58, 16, v37
v_and_b32 v59, 0xffff0000, v37
v_lshlrev_b32 v60, 16, v38
v_and_b32 v61, 0xffff0000, v38
v_lshlrev_b32 v62, 16, v39
v_and_b32 v63, 0xffff0000, v39
v_pk_fma_f32 v[48:49], v[48:49], v[24:25], v[24:25] op_sel:[0,0,1] op_sel_hi:[1,0,1]
v_pk_fma_f32 v[50:51], v[50:51], v[24:25], v[24:25] op_sel:[0,0,1] op_sel_hi:[1,0,1]
v_pk_fma_f32 v[52:53], v[52:53], v[24:25], v[24:25] op_sel:[0,0,1] op_sel_hi:[1,0,1]
v_pk_fma_f32 v[54:55], v[54:55], v[24:25], v[24:25] op_sel:[0,0,1] op_sel_hi:[1,0,1]
v_pk_fma_f32 v[56:57], v[56:57], v[24:25], v[24:25] op_sel:[0,0,1] op_sel_hi:[1,0,1]
v_pk_fma_f32 v[58:59], v[58:59], v[24:25], v[24:25] op_sel:[0,0,1] op_sel_hi:[1,0,1]
v_pk_fma_f32 v[60:61], v[60:61], v[24:25], v[24:25] op_sel:[0,0,1] op_sel_hi:[1,0,1]
v_pk_fma_f32 v[62:63], v[62:63], v[24:25], v[24:25] op_sel:[0,0,1] op_sel_hi:[1,0,1]
v_cvt_pk_bf16_f32 v32, v48, v49
v_cvt_pk_bf16_f32 v33, v50, v51
v_cvt_pk_bf16_f32 v34, v52, v53
v_cvt_pk_bf16_f32 v35, v54, v55
v_cvt_pk_bf16_f32 v36, v56, v57
v_cvt_pk_bf16_f32 v37, v58, v59
v_cvt_pk_bf16_f32 v38, v60, v61
v_cvt_pk_bf16_f32 v39, v62, v63
v_mov_b32 v48, 0
v_mov_b32 v49, 0
v_mov_b32 v50, 0
v_mov_b32 v51, 0
v_mov_b32 v52, 0
v_mov_b32 v53, 0
v_mov_b32 v54, 0
v_mov_b32 v55, 0
v_dot2c_f32_bf16 v48, v32, v160
v_dot2c_f32_bf16 v49, v32, v161
v_dot2c_f32_bf16 v50, v32, v162
v_dot2c_f32_bf16 v51, v32, v163
v_dot2c_f32_bf16 v52, v32, v164
v_dot2c_f32_bf16 v53, v32, v165
v_dot2c_f32_bf16 v54, v32, v166
v_dot2c_f32_bf16 v55, v32, v167
v_dot2c_f32_bf16 v48, v33, v168
v_dot2c_f32_bf16 v49, v33, v169
v_dot2c_f32_bf16 v50, v33, v170
v_dot2c_f32_bf16 v51, v33, v171
v_dot2c_f32_bf16 v52, v33, v172
v_dot2c_f32_bf16 v53, v33, v173
v_dot2c_f32_bf16 v54, v33, v174
v_dot2c_f32_bf16 v55, v33, v175
v_dot2c_f32_bf16 v48, v34, v176
v_dot2c_f32_bf16 v49, v34, v177
v_dot2c_f32_bf16 v50, v34, v178
v_dot2c_f32_bf16 v51, v34, v179
v_dot2c_f32_bf16 v52, v34, v180
v_dot2c_f32_bf16 v53, v34, v181
v_dot2c_f32_bf16 v54, v34, v182
v_dot2c_f32_bf16 v55, v34, v183
v_dot2c_f32_bf16 v48, v35, v184
v_dot2c_f32_bf16 v49, v35, v185
v_dot2c_f32_bf16 v50, v35, v186
v_dot2c_f32_bf16 v51, v35, v187
v_dot2c_f32_bf16 v52, v35, v188
v_dot2c_f32_bf16 v53, v35, v189
v_dot2c_f32_bf16 v54, v35, v190
v_dot2c_f32_bf16 v55, v35, v191
v_dot2c_f32_bf16 v48, v36, v192
v_dot2c_f32_bf16 v49, v36, v193
v_dot2c_f32_bf16 v50, v36, v194
v_dot2c_f32_bf16 v51, v36, v195
v_dot2c_f32_bf16 v52, v36, v196
v_dot2c_f32_bf16 v53, v36, v197
v_dot2c_f32_bf16 v54, v36, v198
v_dot2c_f32_bf16 v55, v36, v199
v_dot2c_f32_bf16 v48, v37, v200
v_dot2c_f32_bf16 v49, v37, v201
v_dot2c_f32_bf16 v50, v37, v202
v_dot2c_f32_bf16 v51, v37, v203
v_dot2c_f32_bf16 v52, v37, v204
v_dot2c_f32_bf16 v53, v37, v205
v_dot2c_f32_bf16 v54, v37, v206
v_dot2c_f32_bf16 v55, v37, v207
v_dot2c_f32_bf16 v48, v38, v208
v_dot2c_f32_bf16 v49, v38, v209
v_dot2c_f32_bf16 v50, v38, v210
v_dot2c_f32_bf16 v51, v38, v211
v_dot2c_f32_bf16 v52, v38, v212
v_dot2c_f32_bf16 v53, v38, v213
v_dot2c_f32_bf16 v54, v38, v214
v_dot2c_f32_bf16 v55, v38, v215
v_dot2c_f32_bf16 v48, v39, v216
v_dot2c_f32_bf16 v49, v39, v217
v_dot2c_f32_bf16 v50, v39, v218
v_dot2c_f32_bf16 v51, v39, v219
v_dot2c_f32_bf16 v52, v39, v220
v_dot2c_f32_bf16 v53, v39, v221
v_dot2c_f32_bf16 v54, v39, v222
v_dot2c_f32_bf16 v55, v39, v223
v_add_f32_dpp v56, v48, v48 row_ror:8 row_mask:0xf bank_mask:0x3
s_nop 1
v_add_f32_dpp v56, v52, v52 row_ror:8 row_mask:0xf bank_mask:0xc
v_add_f32_dpp v57, v49, v49 row_ror:8 row_mask:0xf bank_mask:0x3
s_nop 1
v_add_f32_dpp v57, v53, v53 row_ror:8 row_mask:0xf bank_mask:0xc
v_add_f32_dpp v58, v50, v50 row_ror:8 row_mask:0xf bank_mask:0x3
s_nop 1
v_add_f32_dpp v58, v54, v54 row_ror:8 row_mask:0xf bank_mask:0xc
v_add_f32_dpp v59, v51, v51 row_ror:8 row_mask:0xf bank_mask:0x3
s_nop 1
v_add_f32_dpp v59, v55, v55 row_ror:8 row_mask:0xf bank_mask:0xc
v_add_f32_dpp v48, v56, v56 row_shl:4 row_mask:0xf bank_mask:0x5
s_nop 1
v_add_f32_dpp v48, v58, v58 row_shr:4 row_mask:0xf bank_mask:0xa
v_add_f32_dpp v49, v57, v57 row_shl:4 row_mask:0xf bank_mask:0x5
s_nop 1
v_add_f32_dpp v49, v59, v59 row_shr:4 row_mask:0xf bank_mask:0xa
v_add_f32_dpp v50, v48, v48 quad_perm:[2,3,0,1] row_mask:0xf bank_mask:0xf
s_nop 0
v_add_f32_dpp v51, v49, v49 quad_perm:[2,3,0,1] row_mask:0xf bank_mask:0xf
v_and_b32 v20, 2, v0
v_cmp_eq_u32 vcc, 0, v20
s_nop 1
v_cndmask_b32 v50, v51, v50, vcc
v_bfe_u32 v20, v0, 1, 3
v_and_b32 v21, 1, v0
v_lshl_add_u32 v20, v21, 3, v20
s_lshr_b32 s72, s58, 1
s_lshl_b32 s72, s72, 6
v_lshl_add_u32 v20, v20, 2, s72
ds_add_f32 v20, v50 offset:512
nogu_44:
s_waitcnt lgkmcnt(0)
s_barrier
s_cmp_ge_u32 s2, 224
s_cbranch_scc1 nodn_45
v_and_b32 v20, 7, v0
v_lshlrev_b32 v20, 3, v20
ds_read_b64 v[32:33], v20 offset:512
ds_read_b64 v[34:35], v20 offset:576
s_lshl_b32 s74, s35, 12
s_lshl_b32 s75, s58, 10
s_add_u32 s74, s74, s75
v_mov_b32 v48, 0
v_mov_b32 v49, 0
v_mov_b32 v50, 0
v_mov_b32 v51, 0
s_waitcnt lgkmcnt(0)
v_mul_f32 v36, 0xbfb8aa3b, v32
v_mul_f32 v37, 0xbfb8aa3b, v33
v_exp_f32 v36, v36
v_exp_f32 v37, v37
v_mul_f32 v32, v32, v34
v_mul_f32 v33, v33, v35
v_add_f32 v36, 1.0, v36
v_add_f32 v37, 1.0, v37
v_rcp_f32 v36, v36
v_rcp_f32 v37, v37
v_mul_f32 v32, v32, v36
v_mul_f32 v33, v33, v37
v_cvt_pk_bf16_f32 v32, v32, v33
s_nop 0
v_readlane_b32 s64, v32, 0
v_readlane_b32 s65, v32, 1
v_readlane_b32 s66, v32, 2
v_readlane_b32 s67, v32, 3
v_readlane_b32 s68, v32, 4
v_readlane_b32 s69, v32, 5
v_readlane_b32 s70, v32, 6
v_readlane_b32 s71, v32, 7
v_dot2c_f32_bf16 v48, s64, v224
v_dot2c_f32_bf16 v49, s64, v225
v_dot2c_f32_bf16 v50, s64, v226
v_dot2c_f32_bf16 v51, s64, v227
v_dot2c_f32_bf16 v48, s65, v228
v_dot2c_f32_bf16 v49, s65, v229
v_dot2c_f32_bf16 v50, s65, v230
v_dot2c_f32_bf16 v51, s65, v231
v_dot2c_f32_bf16 v48, s66, v232
v_dot2c_f32_bf16 v49, s66, v233
v_dot2c_f32_bf16 v50, s66, v234
v_dot2c_f32_bf16 v51, s66, v235
v_dot2c_f32_bf16 v48, s67, v236
v_dot2c_f32_bf16 v49, s67, v237
v_dot2c_f32_bf16 v50, s67, v238
v_dot2c_f32_bf16 v51, s67, v239
v_dot2c_f32_bf16 v48, s68, v240
v_dot2c_f32_bf16 v49, s68, v241
v_dot2c_f32_bf16 v50, s68, v242
v_dot2c_f32_bf16 v51, s68, v243
v_dot2c_f32_bf16 v48, s69, v244
v_dot2c_f32_bf16 v49, s69, v245
v_dot2c_f32_bf16 v50, s69, v246
v_dot2c_f32_bf16 v51, s69, v247
v_dot2c_f32_bf16 v48, s70, v248
v_dot2c_f32_bf16 v49, s70, v249
v_dot2c_f32_bf16 v50, s70, v250
v_dot2c_f32_bf16 v51, s70, v251
v_dot2c_f32_bf16 v48, s71, v252
v_dot2c_f32_bf16 v49, s71, v253
v_dot2c_f32_bf16 v50, s71, v254
v_dot2c_f32_bf16 v51, s71, v255
v_or_b32 v48, 1, v48
v_or_b32 v49, 1, v49
v_or_b32 v50, 1, v50
v_or_b32 v51, 1, v51
buffer_store_dwordx4 v[48:51], v13, s[24:27], s74 offen sc1
nodn_45:
s_cmp_lg_u32 s58, 0
s_cbranch_scc1 s4_46
v_min_u32 v22, 55, v0
v_lshlrev_b32 v22, 12, v22
s_lshl_b32 s72, s77, 4
s_add_u32 s73, s72, 229376
s_add_u32 s74, s72, 458752
s_add_u32 s75, s72, 688128
buffer_load_dwordx4 v[48:51], v22, s[24:27], s72 offen sc1
buffer_load_dwordx4 v[52:55], v22, s[24:27], s73 offen sc1
buffer_load_dwordx4 v[56:59], v22, s[24:27], s74 offen sc1
buffer_load_dwordx4 v[60:63], v22, s[24:27], s75 offen sc1
v_mov_b32 v26, s42
v_mul_f32 v26, 0xbfb8aa3b, v26
v_exp_f32 v26, v26
v_add_f32 v24, 1.0, v24
v_lshlrev_b32 v44, 16, v40
v_and_b32 v45, 0xffff0000, v40
v_lshlrev_b32 v46, 16, v41
v_and_b32 v47, 0xffff0000, v41
v_add_f32 v26, 1.0, v26
v_rcp_f32 v26, v26
v_fma_f32 v44, v44, v24, v25
v_fma_f32 v45, v45, v24, v25
v_fma_f32 v46, v46, v24, v25
v_fma_f32 v47, v47, v24, v25
v_cmp_gt_u32 vcc, 56, v0
s_nop 1
v_cndmask_b32 v26, 0, v26, vcc
s_waitcnt vmcnt(0)
s_branch pchk_48
poll_47:
buffer_load_dwordx4 v[48:51], v22, s[24:27], s72 offen sc1
buffer_load_dwordx4 v[52:55], v22, s[24:27], s73 offen sc1
buffer_load_dwordx4 v[56:59], v22, s[24:27], s74 offen sc1
buffer_load_dwordx4 v[60:63], v22, s[24:27], s75 offen sc1
s_waitcnt vmcnt(0)
pchk_48:
v_min3_u32 v20, v48, v49, v50
v_min3_u32 v20, v20, v51, v52
v_min3_u32 v20, v20, v53, v54
v_min3_u32 v20, v20, v55, v56
v_min3_u32 v20, v20, v57, v58
v_min3_u32 v20, v20, v59, v60
v_min3_u32 v20, v20, v61, v62
v_min_u32 v20, v20, v63
v_cmp_eq_u32 vcc, 0, v20
s_cbranch_vccz pdone_49
s_sub_u32 s32, s32, 1
s_cmp_gt_i32 s32, 0
s_cbranch_scc1 poll_47
pdone_49:
v_add_f32 v48, v48, v52
v_add_f32 v56, v56, v60
v_add_f32 v49, v49, v53
v_add_f32 v57, v57, v61
v_add_f32 v50, v50, v54
v_add_f32 v58, v58, v62
v_add_f32 v51, v51, v55
v_add_f32 v59, v59, v63
v_add_f32 v48, v48, v56
v_add_f32 v49, v49, v57
v_add_f32 v50, v50, v58
v_add_f32 v51, v51, v59
v_mul_f32 v48, v48, v26
v_mul_f32 v49, v49, v26
v_mul_f32 v50, v50, v26
v_mul_f32 v51, v51, v26
v_add_f32_dpp v48, v48, v48 row_ror:1 row_mask:0xf bank_mask:0xf
v_add_f32_dpp v49, v49, v49 row_ror:1 row_mask:0xf bank_mask:0xf
v_add_f32_dpp v50, v50, v50 row_ror:1 row_mask:0xf bank_mask:0xf
v_add_f32_dpp v51, v51, v51 row_ror:1 row_mask:0xf bank_mask:0xf
v_add_f32_dpp v48, v48, v48 row_ror:2 row_mask:0xf bank_mask:0xf
v_add_f32_dpp v49, v49, v49 row_ror:2 row_mask:0xf bank_mask:0xf
v_add_f32_dpp v50, v50, v50 row_ror:2 row_mask:0xf bank_mask:0xf
v_add_f32_dpp v51, v51, v51 row_ror:2 row_mask:0xf bank_mask:0xf
v_add_f32_dpp v48, v48, v48 row_ror:4 row_mask:0xf bank_mask:0xf
v_add_f32_dpp v49, v49, v49 row_ror:4 row_mask:0xf bank_mask:0xf
v_add_f32_dpp v50, v50, v50 row_ror:4 row_mask:0xf bank_mask:0xf
v_add_f32_dpp v51, v51, v51 row_ror:4 row_mask:0xf bank_mask:0xf
v_add_f32_dpp v48, v48, v48 row_ror:8 row_mask:0xf bank_mask:0xf
v_add_f32_dpp v49, v49, v49 row_ror:8 row_mask:0xf bank_mask:0xf
v_add_f32_dpp v50, v50, v50 row_ror:8 row_mask:0xf bank_mask:0xf
v_add_f32_dpp v51, v51, v51 row_ror:8 row_mask:0xf bank_mask:0xf
v_mov_b32 v52, v48
v_mov_b32 v53, v49
v_mov_b32 v54, v50
v_mov_b32 v55, v51
v_permlane16_swap_b32 v52, v48
v_permlane16_swap_b32 v53, v49
v_permlane16_swap_b32 v54, v50
v_permlane16_swap_b32 v55, v51
v_add_f32 v48, v48, v52
v_add_f32 v49, v49, v53
v_add_f32 v50, v50, v54
v_add_f32 v51, v51, v55
v_mov_b32 v52, v48
v_mov_b32 v53, v49
v_mov_b32 v54, v50
v_mov_b32 v55, v51
v_permlane32_swap_b32 v52, v48
v_permlane32_swap_b32 v53, v49
v_permlane32_swap_b32 v54, v50
v_permlane32_swap_b32 v55, v51
v_add_f32 v48, v48, v52
v_add_f32 v49, v49, v53
v_add_f32 v50, v50, v54
v_add_f32 v51, v51, v55
v_add_f32 v48, v48, v44
v_add_f32 v49, v49, v45
v_add_f32 v50, v50, v46
v_add_f32 v51, v51, v47
v_cvt_pk_bf16_f32 v48, v48, v49
v_cvt_pk_bf16_f32 v49, v50, v51
s_cmp_eq_u32 s63, 0
s_cbranch_scc1 s3_50
s_lshl_b32 s72, s33, 11
s_lshl_b32 s73, s77, 3
s_add_u32 s72, s72, s73
s_mov_b64 exec, 1
buffer_store_dwordx2 v[48:49], off, s[28:31], s72
s_mov_b64 exec, -1
s_branch s4_46
s3_50:
s_lshr_b32 s72, s77, 2
s_lshl_b32 s72, s72, 10
s_and_b32 s73, s77, 1
s_lshl_b32 s73, s73, 4
s_add_u32 s72, s72, s73
s_and_b32 s73, s77, 2
s_lshl_b32 s73, s73, 2
s_add_u32 s72, s72, s73
s_add_u32 s72, s72, 1245184
s_brev_b32 s73, 1
v_mov_b32 v21, s73
v_cmp_eq_u32 vcc, 0, v48
s_nop 1
v_cndmask_b32 v48, v48, v21, vcc
v_cmp_eq_u32 vcc, 0, v49
s_nop 1
v_cndmask_b32 v49, v49, v21, vcc
s_mov_b64 exec, 1
buffer_store_dwordx2 v[48:49], off, s[24:27], s72 sc1
s_mov_b64 exec, -1
s_lshl_b32 s72, s61, 6
s_sub_u32 s72, s33, s72
v_cmp_eq_u32 vcc, s72, v0
v_lshlrev_b32 v20, 3, v0
v_mov_b32 v22, 1.0
v_mov_b32 v23, 0
s_mov_b64 exec, vcc
ds_write_b64 v20, v[22:23] offset:1024
s_mov_b64 exec, -1
s4_46:
s_cmp_lg_u32 s63, 0
s_cbranch_scc1 L_end
v_lshlrev_b32 v22, 10, v0
s_mov_b32 s72, 1245184
poll_51:
buffer_load_dwordx4 v[32:35], v22, s[24:27], s72 offen offset:0 sc1
buffer_load_dwordx4 v[36:39], v22, s[24:27], s72 offen offset:16 sc1
s_waitcnt vmcnt(0)
pchk_52:
v_min3_u32 v20, v32, v33, v34
v_min3_u32 v20, v20, v35, v36
v_min3_u32 v20, v20, v37, v38
v_min_u32 v20, v20, v39
v_cmp_eq_u32 vcc, 0, v20
s_cbranch_vccz pdone_53
s_sub_u32 s32, s32, 1
s_cmp_gt_i32 s32, 0
s_cbranch_scc1 poll_51
pdone_53:
s_waitcnt lgkmcnt(0)
s_barrier
s_mov_b32 s72, 0x3f803f80
v_mov_b32 v16, 0
v_mov_b32 v17, 0
v_dot2c_f32_bf16 v16, s72, v32
v_dot2c_f32_bf16 v17, v32, v32
v_dot2c_f32_bf16 v16, s72, v33
v_dot2c_f32_bf16 v17, v33, v33
v_dot2c_f32_bf16 v16, s72, v34
v_dot2c_f32_bf16 v17, v34, v34
v_dot2c_f32_bf16 v16, s72, v35
v_dot2c_f32_bf16 v17, v35, v35
v_dot2c_f32_bf16 v16, s72, v36
v_dot2c_f32_bf16 v17, v36, v36
v_dot2c_f32_bf16 v16, s72, v37
v_dot2c_f32_bf16 v17, v37, v37
v_dot2c_f32_bf16 v16, s72, v38
v_dot2c_f32_bf16 v17, v38, v38
v_dot2c_f32_bf16 v16, s72, v39
v_dot2c_f32_bf16 v17, v39, v39
s_nop 1
v_add_f32_dpp v16, v16, v16 row_ror:1 row_mask:0xf bank_mask:0xf
v_add_f32_dpp v17, v17, v17 row_ror:1 row_mask:0xf bank_mask:0xf
s_nop 0
v_add_f32_dpp v16, v16, v16 row_ror:2 row_mask:0xf bank_mask:0xf
v_add_f32_dpp v17, v17, v17 row_ror:2 row_mask:0xf bank_mask:0xf
s_nop 0
v_add_f32_dpp v16, v16, v16 row_ror:4 row_mask:0xf bank_mask:0xf
v_add_f32_dpp v17, v17, v17 row_ror:4 row_mask:0xf bank_mask:0xf
s_nop 0
v_add_f32_dpp v16, v16, v16 row_ror:8 row_mask:0xf bank_mask:0xf
v_add_f32_dpp v17, v17, v17 row_ror:8 row_mask:0xf bank_mask:0xf
v_mov_b32 v20, v16
v_mov_b32 v21, v17
s_nop 0
v_permlane16_swap_b32 v20, v16
v_permlane16_swap_b32 v21, v17
v_add_f32 v16, v16, v20
v_add_f32 v17, v17, v21
v_mov_b32 v20, v16
v_mov_b32 v21, v17
s_nop 0
v_permlane32_swap_b32 v20, v16
v_permlane32_swap_b32 v21, v17
v_add_f32 v16, v16, v20
v_add_f32 v17, v17, v21
v_mul_f32 v20, 0xba800000, v16
v_mul_f32 v17, 0x3a800000, v17
v_fma_f32 v17, -v20, v20, v17
v_max_f32 v17, 0, v17
v_add_f32 v17, 0x3727c5ac, v17
v_rsq_f32 v16, v17
s_mov_b32 s63, 1
v_mul_f32 v17, v20, v16
v_readfirstlane_b32 s43, v16
v_readfirstlane_b32 s3, v17
s_add_u32 s24, s24, 1572864
s_addc_u32 s25, s25, 0
s_mov_b32 s26, 1572864
s_branch L_htop
L_m:
s_setprio 2
v_and_b32 v10, 31, v0
v_lshrrev_b32 v11, 5, v0
s_lshl_b32 s64, s61, 17
s_lshl_b32 s65, s62, 8
s_lshl_b32 s66, s58, 6
s_add_u32 s65, s65, s66
v_lshl_add_u32 v12, v11, 3, s65
v_lshl_add_u32 v13, v10, 11, v12
s_add_u32 s66, s64, 0x10000
buffer_load_dwordx2 v[240:241], v13, s[8:11], s64 offen offset:0
buffer_load_dwordx2 v[242:243], v13, s[8:11], s64 offen offset:16
buffer_load_dwordx2 v[244:245], v13, s[8:11], s64 offen offset:32
buffer_load_dwordx2 v[246:247], v13, s[8:11], s64 offen offset:48
buffer_load_dwordx2 v[248:249], v13, s[8:11], s66 offen offset:0
buffer_load_dwordx2 v[250:251], v13, s[8:11], s66 offen offset:16
buffer_load_dwordx2 v[252:253], v13, s[8:11], s66 offen offset:32
buffer_load_dwordx2 v[254:255], v13, s[8:11], s66 offen offset:48
s_mov_b32 s4, s44
s_mov_b32 s5, s45
s_mov_b32 s6, 0x800
s_mov_b32 s7, 0x00020000
buffer_load_dwordx2 v[232:233], v12, s[4:7], 0 offen offset:0
buffer_load_dwordx2 v[234:235], v12, s[4:7], 0 offen offset:16
buffer_load_dwordx2 v[236:237], v12, s[4:7], 0 offen offset:32
buffer_load_dwordx2 v[238:239], v12, s[4:7], 0 offen offset:48
v_mov_b32 v14, 0
v_mov_b32 v15, 0
v_lshlrev_b32 v12, 3, v0
ds_write_b64 v12, v[14:15] offset:0
v_mov_b32 v14, 1.0
ds_write_b64 v12, v[14:15] offset:1024
L_mtop:
v_and_b32 v10, 31, v0
v_lshrrev_b32 v11, 5, v0
s_lshl_b32 s64, s58, 12
s_cmp_eq_u32 s63, 0
s_cbranch_scc0 mq_54
v_bfe_u32 v12, v0, 2, 2
v_xor_b32 v12, v12, v11
v_lshlrev_b32 v12, 4, v12
v_lshl_add_u32 v1, v10, 6, v12
v_xor_b32 v2, 32, v1
s_branch mq_55
mq_54:
v_lshlrev_b32 v1, 4, v0
v_add_u32 v2, 1024, v1
mq_55:
v_add_u32 v1, s64, v1
v_add_u32 v2, s64, v2
v_bfe_u32 v12, v0, 2, 2
v_lshl_add_u32 v12, v11, 3, v12
v_lshlrev_b32 v12, 6, v12
v_bfe_u32 v13, v0, 4, 1
v_lshl_add_u32 v12, v13, 5, v12
v_and_b32 v13, 3, v0
v_lshl_add_u32 v12, v13, 3, v12
v_add_u32 v3, 16384, v12
s_mov_b32 s64, 4096
s_mov_b32 s65, 32
v_add_u32 v4, s64, v1
v_add_u32 v5, s64, v2
v_add_u32 v6, s64, v3
v_mov_b32 v16, 0
v_mov_b32 v17, 0
v_mov_b32 v18, 0
v_mov_b32 v19, 0
v_mov_b32 v20, 0
v_mov_b32 v21, 0
v_mov_b32 v22, 0
v_mov_b32 v23, 0
v_mov_b32 v24, 0
v_mov_b32 v25, 0
v_mov_b32 v26, 0
v_mov_b32 v27, 0
v_mov_b32 v28, 0
v_mov_b32 v29, 0
v_mov_b32 v30, 0
v_mov_b32 v31, 0
v_mov_b32 v32, 0
v_mov_b32 v33, 0
v_mov_b32 v34, 0
v_mov_b32 v35, 0
v_mov_b32 v36, 0
v_mov_b32 v37, 0
v_mov_b32 v38, 0
v_mov_b32 v39, 0
v_mov_b32 v40, 0
v_mov_b32 v41, 0
v_mov_b32 v42, 0
v_mov_b32 v43, 0
v_mov_b32 v44, 0
v_mov_b32 v45, 0
v_mov_b32 v46, 0
v_mov_b32 v47, 0
v_mov_b32 v48, 0
v_mov_b32 v49, 0
v_mov_b32 v50, 0
v_mov_b32 v51, 0
v_mov_b32 v52, 0
v_mov_b32 v53, 0
v_mov_b32 v54, 0
v_mov_b32 v55, 0
v_mov_b32 v56, 0
v_mov_b32 v57, 0
v_mov_b32 v58, 0
v_mov_b32 v59, 0
v_mov_b32 v60, 0
v_mov_b32 v61, 0
v_mov_b32 v62, 0
v_mov_b32 v63, 0
v_mov_b32 v64, 0
v_mov_b32 v65, 0
v_mov_b32 v66, 0
v_mov_b32 v67, 0
v_mov_b32 v68, 0
v_mov_b32 v69, 0
v_mov_b32 v70, 0
v_mov_b32 v71, 0
v_mov_b32 v72, 0
v_mov_b32 v73, 0
v_mov_b32 v74, 0
v_mov_b32 v75, 0
v_mov_b32 v76, 0
v_mov_b32 v77, 0
v_mov_b32 v78, 0
v_mov_b32 v79, 0
v_mov_b32 v80, 0
v_mov_b32 v81, 0
v_mov_b32 v82, 0
v_mov_b32 v83, 0
v_mov_b32 v84, 0
v_mov_b32 v85, 0
v_mov_b32 v86, 0
v_mov_b32 v87, 0
v_mov_b32 v88, 0
v_mov_b32 v89, 0
v_mov_b32 v90, 0
v_mov_b32 v91, 0
v_mov_b32 v92, 0
v_mov_b32 v93, 0
v_mov_b32 v94, 0
v_mov_b32 v95, 0
v_mov_b32 v96, 0
v_mov_b32 v97, 0
v_mov_b32 v98, 0
v_mov_b32 v99, 0
v_mov_b32 v100, 0
v_mov_b32 v101, 0
v_mov_b32 v102, 0
v_mov_b32 v103, 0
v_mov_b32 v104, 0
v_mov_b32 v105, 0
v_mov_b32 v106, 0
v_mov_b32 v107, 0
v_mov_b32 v108, 0
v_mov_b32 v109, 0
v_mov_b32 v110, 0
v_mov_b32 v111, 0
s_waitcnt lgkmcnt(0)
s_barrier
ds_read_b128 v[124:127], v4 offset:0
ds_read_b64_tr_b16 v[116:117], v6 offset:2048
ds_read_b64_tr_b16 v[118:119], v6 offset:2304
ds_read_b128 v[128:131], v4 offset:2048
ds_read_b64_tr_b16 v[120:121], v6 offset:4096
ds_read_b64_tr_b16 v[122:123], v6 offset:4352
ds_read_b64_tr_b16 v[112:113], v6 offset:0
ds_read_b64_tr_b16 v[114:115], v6 offset:256
.p2align 6
mqkv_56:
s_waitcnt lgkmcnt(0)
v_mfma_f32_32x32x16_bf16 v[32:47], v[116:119], v[124:127], v[32:47]
ds_read_b128 v[144:147], v5 offset:0
ds_read_b64_tr_b16 v[136:137], v6 offset:3072
ds_read_b64_tr_b16 v[138:139], v6 offset:3328
v_mfma_f32_32x32x16_bf16 v[80:95], v[116:119], v[128:131], v[80:95]
ds_read_b128 v[148:151], v5 offset:2048
ds_read_b64_tr_b16 v[140:141], v6 offset:5120
ds_read_b64_tr_b16 v[142:143], v6 offset:5376
v_mfma_f32_32x32x16_bf16 v[48:63], v[124:127], v[120:123], v[48:63]
ds_read_b64_tr_b16 v[132:133], v6 offset:1024
ds_read_b64_tr_b16 v[134:135], v6 offset:1280
v_mfma_f32_32x32x16_bf16 v[96:111], v[128:131], v[120:123], v[96:111]
s_add_u32 s64, s64, 22528
s_cmp_eq_u32 s64, 139264
s_cselect_b32 s64, 4096, s64
v_mfma_f32_32x32x16_bf16 v[16:31], v[112:115], v[124:127], v[16:31]
v_add_u32 v4, s64, v1
v_add_u32 v5, s64, v2
v_add_u32 v6, s64, v3
v_mfma_f32_32x32x16_bf16 v[64:79], v[112:115], v[128:131], v[64:79]
s_waitcnt lgkmcnt(0)
s_barrier
v_mfma_f32_32x32x16_bf16 v[32:47], v[136:139], v[144:147], v[32:47]
ds_read_b128 v[124:127], v4 offset:0
ds_read_b64_tr_b16 v[116:117], v6 offset:2048
ds_read_b64_tr_b16 v[118:119], v6 offset:2304
v_mfma_f32_32x32x16_bf16 v[80:95], v[136:139], v[148:151], v[80:95]
ds_read_b128 v[128:131], v4 offset:2048
ds_read_b64_tr_b16 v[120:121], v6 offset:4096
ds_read_b64_tr_b16 v[122:123], v6 offset:4352
v_mfma_f32_32x32x16_bf16 v[48:63], v[144:147], v[140:143], v[48:63]
ds_read_b64_tr_b16 v[112:113], v6 offset:0
ds_read_b64_tr_b16 v[114:115], v6 offset:256
v_mfma_f32_32x32x16_bf16 v[96:111], v[148:151], v[140:143], v[96:111]
v_mfma_f32_32x32x16_bf16 v[16:31], v[132:135], v[144:147], v[16:31]
s_sub_u32 s65, s65, 1
s_cmp_eq_u32 s65, 0
v_mfma_f32_32x32x16_bf16 v[64:79], v[132:135], v[148:151], v[64:79]
s_cbranch_scc0 mqkv_56
v_lshlrev_b32 v4, 4, v11
v_lshlrev_b32 v5, 2, v10
s_lshl_b32 s64, s58, 7
s_sub_u32 s65, 896, s64
v_add_u32 v12, s64, v5
v_add_u32 v13, s65, v5
v_add_u32 v14, s64, v4
v_add_u32 v15, s65, v4
ds_read_b32 v8, v12 offset:2048
ds_read_b32 v9, v12 offset:3072
ds_read_b32 v10, v13 offset:2048
ds_read_b32 v11, v13 offset:3072
ds_read_b128 v[168:171], v4 offset:128
ds_read_b128 v[172:175], v4 offset:160
ds_read_b128 v[176:179], v4 offset:192
ds_read_b128 v[180:183], v4 offset:224
ds_read_b32 v7, v5 offset:256
ds_read_b128 v[184:187], v14 offset:2048
ds_read_b128 v[188:191], v14 offset:2080
ds_read_b128 v[192:195], v14 offset:2112
ds_read_b128 v[196:199], v14 offset:2144
s_waitcnt lgkmcnt(5)
ds_read_b128 v[200:203], v14 offset:3072
ds_read_b128 v[204:207], v14 offset:3104
ds_read_b128 v[208:211], v14 offset:3136
ds_read_b128 v[212:215], v14 offset:3168
s_lshl_b32 s64, s58, 12
s_sub_u32 s65, 28672, s64
v_lshlrev_b32 v1, 4, v0
v_add_u32 v2, s64, v1
v_add_u32 v3, s65, v1
v_pk_mul_f32 v[32:33], v[32:33], v[8:9] op_sel:[0,0] op_sel_hi:[1,0]
v_pk_mul_f32 v[34:35], v[34:35], v[8:9] op_sel:[0,0] op_sel_hi:[1,0]
v_pk_mul_f32 v[36:37], v[36:37], v[8:9] op_sel:[0,0] op_sel_hi:[1,0]
v_pk_mul_f32 v[38:39], v[38:39], v[8:9] op_sel:[0,0] op_sel_hi:[1,0]
v_pk_mul_f32 v[40:41], v[40:41], v[8:9] op_sel:[0,0] op_sel_hi:[1,0]
v_pk_mul_f32 v[42:43], v[42:43], v[8:9] op_sel:[0,0] op_sel_hi:[1,0]
v_pk_mul_f32 v[44:45], v[44:45], v[8:9] op_sel:[0,0] op_sel_hi:[1,0]
v_pk_mul_f32 v[46:47], v[46:47], v[8:9] op_sel:[0,0] op_sel_hi:[1,0]
v_pk_fma_f32 v[32:33], v[168:169], v[8:9], v[32:33] op_sel:[0,1,0] op_sel_hi:[1,1,1]
v_pk_fma_f32 v[34:35], v[170:171], v[8:9], v[34:35] op_sel:[0,1,0] op_sel_hi:[1,1,1]
v_pk_fma_f32 v[36:37], v[172:173], v[8:9], v[36:37] op_sel:[0,1,0] op_sel_hi:[1,1,1]
v_pk_fma_f32 v[38:39], v[174:175], v[8:9], v[38:39] op_sel:[0,1,0] op_sel_hi:[1,1,1]
v_pk_fma_f32 v[40:41], v[176:177], v[8:9], v[40:41] op_sel:[0,1,0] op_sel_hi:[1,1,1]
v_pk_fma_f32 v[42:43], v[178:179], v[8:9], v[42:43] op_sel:[0,1,0] op_sel_hi:[1,1,1]
v_pk_fma_f32 v[44:45], v[180:181], v[8:9], v[44:45] op_sel:[0,1,0] op_sel_hi:[1,1,1]
v_pk_fma_f32 v[46:47], v[182:183], v[8:9], v[46:47] op_sel:[0,1,0] op_sel_hi:[1,1,1]
v_cvt_pk_bf16_f32 v32, v32, v33
v_cvt_pk_bf16_f32 v33, v34, v35
v_cvt_pk_bf16_f32 v34, v36, v37
v_cvt_pk_bf16_f32 v35, v38, v39
v_cvt_pk_bf16_f32 v36, v40, v41
v_cvt_pk_bf16_f32 v37, v42, v43
v_cvt_pk_bf16_f32 v38, v44, v45
v_cvt_pk_bf16_f32 v39, v46, v47
s_waitcnt lgkmcnt(0)
ds_read_b128 v[216:219], v15 offset:2048
ds_read_b128 v[220:223], v15 offset:2080
ds_read_b128 v[224:227], v15 offset:2112
ds_read_b128 v[228:231], v15 offset:2144
ds_read_b128 v[112:115], v15 offset:3072
ds_read_b128 v[116:119], v15 offset:3104
ds_read_b128 v[120:123], v15 offset:3136
ds_read_b128 v[124:127], v15 offset:3168
ds_read_b128 v[152:155], v4 offset:0
ds_read_b128 v[156:159], v4 offset:32
ds_read_b128 v[160:163], v4 offset:64
ds_read_b128 v[164:167], v4 offset:96
ds_write_b128 v2, v[32:35] offset:4096
ds_write_b128 v2, v[36:39] offset:5120
v_pk_mul_f32 v[80:81], v[80:81], v[10:11] op_sel:[0,0] op_sel_hi:[1,0]
v_pk_mul_f32 v[82:83], v[82:83], v[10:11] op_sel:[0,0] op_sel_hi:[1,0]
v_pk_mul_f32 v[84:85], v[84:85], v[10:11] op_sel:[0,0] op_sel_hi:[1,0]
v_pk_mul_f32 v[86:87], v[86:87], v[10:11] op_sel:[0,0] op_sel_hi:[1,0]
v_pk_mul_f32 v[88:89], v[88:89], v[10:11] op_sel:[0,0] op_sel_hi:[1,0]
v_pk_mul_f32 v[90:91], v[90:91], v[10:11] op_sel:[0,0] op_sel_hi:[1,0]
v_pk_mul_f32 v[92:93], v[92:93], v[10:11] op_sel:[0,0] op_sel_hi:[1,0]
v_pk_mul_f32 v[94:95], v[94:95], v[10:11] op_sel:[0,0] op_sel_hi:[1,0]
v_pk_fma_f32 v[80:81], v[168:169], v[10:11], v[80:81] op_sel:[0,1,0] op_sel_hi:[1,1,1]
v_pk_fma_f32 v[82:83], v[170:171], v[10:11], v[82:83] op_sel:[0,1,0] op_sel_hi:[1,1,1]
v_pk_fma_f32 v[84:85], v[172:173], v[10:11], v[84:85] op_sel:[0,1,0] op_sel_hi:[1,1,1]
v_pk_fma_f32 v[86:87], v[174:175], v[10:11], v[86:87] op_sel:[0,1,0] op_sel_hi:[1,1,1]
v_pk_fma_f32 v[88:89], v[176:177], v[10:11], v[88:89] op_sel:[0,1,0] op_sel_hi:[1,1,1]
v_pk_fma_f32 v[90:91], v[178:179], v[10:11], v[90:91] op_sel:[0,1,0] op_sel_hi:[1,1,1]
v_pk_fma_f32 v[92:93], v[180:181], v[10:11], v[92:93] op_sel:[0,1,0] op_sel_hi:[1,1,1]
v_pk_fma_f32 v[94:95], v[182:183], v[10:11], v[94:95] op_sel:[0,1,0] op_sel_hi:[1,1,1]
v_cvt_pk_bf16_f32 v80, v80, v81
v_cvt_pk_bf16_f32 v81, v82, v83
v_cvt_pk_bf16_f32 v82, v84, v85
v_cvt_pk_bf16_f32 v83, v86, v87
v_cvt_pk_bf16_f32 v84, v88, v89
v_cvt_pk_bf16_f32 v85, v90, v91
v_cvt_pk_bf16_f32 v86, v92, v93
v_cvt_pk_bf16_f32 v87, v94, v95
s_waitcnt lgkmcnt(0)
ds_write_b128 v3, v[80:83] offset:4096
ds_write_b128 v3, v[84:87] offset:5120
v_pk_mul_f32 v[48:49], v[48:49], v[184:185]
v_pk_mul_f32 v[50:51], v[50:51], v[186:187]
v_pk_mul_f32 v[52:53], v[52:53], v[188:189]
v_pk_mul_f32 v[54:55], v[54:55], v[190:191]
v_pk_mul_f32 v[56:57], v[56:57], v[192:193]
v_pk_mul_f32 v[58:59], v[58:59], v[194:195]
v_pk_mul_f32 v[60:61], v[60:61], v[196:197]
v_pk_mul_f32 v[62:63], v[62:63], v[198:199]
v_pk_fma_f32 v[48:49], v[200:201], v[6:7], v[48:49] op_sel:[0,1,0] op_sel_hi:[1,1,1]
v_pk_fma_f32 v[50:51], v[202:203], v[6:7], v[50:51] op_sel:[0,1,0] op_sel_hi:[1,1,1]
v_pk_fma_f32 v[52:53], v[204:205], v[6:7], v[52:53] op_sel:[0,1,0] op_sel_hi:[1,1,1]
v_pk_fma_f32 v[54:55], v[206:207], v[6:7], v[54:55] op_sel:[0,1,0] op_sel_hi:[1,1,1]
v_pk_fma_f32 v[56:57], v[208:209], v[6:7], v[56:57] op_sel:[0,1,0] op_sel_hi:[1,1,1]
v_pk_fma_f32 v[58:59], v[210:211], v[6:7], v[58:59] op_sel:[0,1,0] op_sel_hi:[1,1,1]
v_pk_fma_f32 v[60:61], v[212:213], v[6:7], v[60:61] op_sel:[0,1,0] op_sel_hi:[1,1,1]
v_pk_fma_f32 v[62:63], v[214:215], v[6:7], v[62:63] op_sel:[0,1,0] op_sel_hi:[1,1,1]
v_cvt_pk_bf16_f32 v48, v48, v49
v_cvt_pk_bf16_f32 v49, v50, v51
v_cvt_pk_bf16_f32 v50, v52, v53
v_cvt_pk_bf16_f32 v51, v54, v55
v_cvt_pk_bf16_f32 v52, v56, v57
v_cvt_pk_bf16_f32 v53, v58, v59
v_cvt_pk_bf16_f32 v54, v60, v61
v_cvt_pk_bf16_f32 v55, v62, v63
ds_write_b128 v2, v[48:51] offset:6144
ds_write_b128 v2, v[52:55] offset:7168
v_pk_mul_f32 v[96:97], v[96:97], v[216:217]
v_pk_mul_f32 v[98:99], v[98:99], v[218:219]
v_pk_mul_f32 v[100:101], v[100:101], v[220:221]
v_pk_mul_f32 v[102:103], v[102:103], v[222:223]
v_pk_mul_f32 v[104:105], v[104:105], v[224:225]
v_pk_mul_f32 v[106:107], v[106:107], v[226:227]
v_pk_mul_f32 v[108:109], v[108:109], v[228:229]
v_pk_mul_f32 v[110:111], v[110:111], v[230:231]
v_pk_fma_f32 v[96:97], v[112:113], v[6:7], v[96:97] op_sel:[0,1,0] op_sel_hi:[1,1,1]
v_pk_fma_f32 v[98:99], v[114:115], v[6:7], v[98:99] op_sel:[0,1,0] op_sel_hi:[1,1,1]
v_pk_fma_f32 v[100:101], v[116:117], v[6:7], v[100:101] op_sel:[0,1,0] op_sel_hi:[1,1,1]
v_pk_fma_f32 v[102:103], v[118:119], v[6:7], v[102:103] op_sel:[0,1,0] op_sel_hi:[1,1,1]
v_pk_fma_f32 v[104:105], v[120:121], v[6:7], v[104:105] op_sel:[0,1,0] op_sel_hi:[1,1,1]
v_pk_fma_f32 v[106:107], v[122:123], v[6:7], v[106:107] op_sel:[0,1,0] op_sel_hi:[1,1,1]
v_pk_fma_f32 v[108:109], v[124:125], v[6:7], v[108:109] op_sel:[0,1,0] op_sel_hi:[1,1,1]
v_pk_fma_f32 v[110:111], v[126:127], v[6:7], v[110:111] op_sel:[0,1,0] op_sel_hi:[1,1,1]
v_cvt_pk_bf16_f32 v96, v96, v97
v_cvt_pk_bf16_f32 v97, v98, v99
v_cvt_pk_bf16_f32 v98, v100, v101
v_cvt_pk_bf16_f32 v99, v102, v103
v_cvt_pk_bf16_f32 v100, v104, v105
v_cvt_pk_bf16_f32 v101, v106, v107
v_cvt_pk_bf16_f32 v102, v108, v109
v_cvt_pk_bf16_f32 v103, v110, v111
ds_write_b128 v3, v[96:99] offset:6144
ds_write_b128 v3, v[100:103] offset:7168
s_mov_b32 s64, 0x3e8293ee
v_mul_f32 v8, s64, v8
v_mul_f32 v9, s64, v9
v_mul_f32 v10, s64, v10
v_mul_f32 v11, s64, v11
v_pk_mul_f32 v[16:17], v[16:17], v[8:9] op_sel:[0,0] op_sel_hi:[1,0]
v_pk_mul_f32 v[18:19], v[18:19], v[8:9] op_sel:[0,0] op_sel_hi:[1,0]
v_pk_mul_f32 v[20:21], v[20:21], v[8:9] op_sel:[0,0] op_sel_hi:[1,0]
v_pk_mul_f32 v[22:23], v[22:23], v[8:9] op_sel:[0,0] op_sel_hi:[1,0]
v_pk_mul_f32 v[24:25], v[24:25], v[8:9] op_sel:[0,0] op_sel_hi:[1,0]
v_pk_mul_f32 v[26:27], v[26:27], v[8:9] op_sel:[0,0] op_sel_hi:[1,0]
v_pk_mul_f32 v[28:29], v[28:29], v[8:9] op_sel:[0,0] op_sel_hi:[1,0]
v_pk_mul_f32 v[30:31], v[30:31], v[8:9] op_sel:[0,0] op_sel_hi:[1,0]
v_pk_fma_f32 v[16:17], v[152:153], v[8:9], v[16:17] op_sel:[0,1,0] op_sel_hi:[1,1,1]
v_pk_fma_f32 v[18:19], v[154:155], v[8:9], v[18:19] op_sel:[0,1,0] op_sel_hi:[1,1,1]
v_pk_fma_f32 v[20:21], v[156:157], v[8:9], v[20:21] op_sel:[0,1,0] op_sel_hi:[1,1,1]
v_pk_fma_f32 v[22:23], v[158:159], v[8:9], v[22:23] op_sel:[0,1,0] op_sel_hi:[1,1,1]
v_pk_fma_f32 v[24:25], v[160:161], v[8:9], v[24:25] op_sel:[0,1,0] op_sel_hi:[1,1,1]
v_pk_fma_f32 v[26:27], v[162:163], v[8:9], v[26:27] op_sel:[0,1,0] op_sel_hi:[1,1,1]
v_pk_fma_f32 v[28:29], v[164:165], v[8:9], v[28:29] op_sel:[0,1,0] op_sel_hi:[1,1,1]
v_pk_fma_f32 v[30:31], v[166:167], v[8:9], v[30:31] op_sel:[0,1,0] op_sel_hi:[1,1,1]
v_cvt_pk_bf16_f32 v16, v16, v17
v_cvt_pk_bf16_f32 v17, v18, v19
v_cvt_pk_bf16_f32 v18, v20, v21
v_cvt_pk_bf16_f32 v19, v22, v23
v_cvt_pk_bf16_f32 v20, v24, v25
v_cvt_pk_bf16_f32 v21, v26, v27
v_cvt_pk_bf16_f32 v22, v28, v29
v_cvt_pk_bf16_f32 v23, v30, v31
s_waitcnt lgkmcnt(0)
s_barrier
v_pk_mul_f32 v[64:65], v[64:65], v[10:11] op_sel:[0,0] op_sel_hi:[1,0]
v_pk_mul_f32 v[66:67], v[66:67], v[10:11] op_sel:[0,0] op_sel_hi:[1,0]
v_pk_mul_f32 v[68:69], v[68:69], v[10:11] op_sel:[0,0] op_sel_hi:[1,0]
v_pk_mul_f32 v[70:71], v[70:71], v[10:11] op_sel:[0,0] op_sel_hi:[1,0]
v_pk_mul_f32 v[72:73], v[72:73], v[10:11] op_sel:[0,0] op_sel_hi:[1,0]
v_pk_mul_f32 v[74:75], v[74:75], v[10:11] op_sel:[0,0] op_sel_hi:[1,0]
v_pk_mul_f32 v[76:77], v[76:77], v[10:11] op_sel:[0,0] op_sel_hi:[1,0]
v_pk_mul_f32 v[78:79], v[78:79], v[10:11] op_sel:[0,0] op_sel_hi:[1,0]
v_pk_fma_f32 v[64:65], v[152:153], v[10:11], v[64:65] op_sel:[0,1,0] op_sel_hi:[1,1,1]
v_pk_fma_f32 v[66:67], v[154:155], v[10:11], v[66:67] op_sel:[0,1,0] op_sel_hi:[1,1,1]
v_pk_fma_f32 v[68:69], v[156:157], v[10:11], v[68:69] op_sel:[0,1,0] op_sel_hi:[1,1,1]
v_pk_fma_f32 v[70:71], v[158:159], v[10:11], v[70:71] op_sel:[0,1,0] op_sel_hi:[1,1,1]
v_pk_fma_f32 v[72:73], v[160:161], v[10:11], v[72:73] op_sel:[0,1,0] op_sel_hi:[1,1,1]
v_pk_fma_f32 v[74:75], v[162:163], v[10:11], v[74:75] op_sel:[0,1,0] op_sel_hi:[1,1,1]
v_pk_fma_f32 v[76:77], v[164:165], v[10:11], v[76:77] op_sel:[0,1,0] op_sel_hi:[1,1,1]
v_pk_fma_f32 v[78:79], v[166:167], v[10:11], v[78:79] op_sel:[0,1,0] op_sel_hi:[1,1,1]
v_cvt_pk_bf16_f32 v64, v64, v65
v_cvt_pk_bf16_f32 v65, v66, v67
v_cvt_pk_bf16_f32 v66, v68, v69
v_cvt_pk_bf16_f32 v67, v70, v71
v_cvt_pk_bf16_f32 v68, v72, v73
v_cvt_pk_bf16_f32 v69, v74, v75
v_cvt_pk_bf16_f32 v70, v76, v77
v_cvt_pk_bf16_f32 v71, v78, v79
v_and_b32 v10, 31, v0
v_lshrrev_b32 v11, 5, v0
v_lshlrev_b32 v11, 2, v11
v_sub_u32 v10, v10, v11
v_mov_b32 v8, 0xf149f2ca
v_mov_b32 v9, 0xf149f2ca
v_cmp_gt_i32 vcc, 0, v10
s_nop 1
v_cndmask_b32 v192, 0, v8, vcc
v_cmp_gt_i32 vcc, 1, v10
s_nop 1
v_cndmask_b32 v193, 0, v8, vcc
v_cmp_gt_i32 vcc, 2, v10
s_nop 1
v_cndmask_b32 v194, 0, v8, vcc
v_cmp_gt_i32 vcc, 3, v10
s_nop 1
v_cndmask_b32 v195, 0, v8, vcc
v_cmp_gt_i32 vcc, 8, v10
s_nop 1
v_cndmask_b32 v196, 0, v8, vcc
v_cmp_gt_i32 vcc, 9, v10
s_nop 1
v_cndmask_b32 v197, 0, v8, vcc
v_cmp_gt_i32 vcc, 10, v10
s_nop 1
v_cndmask_b32 v198, 0, v8, vcc
v_cmp_gt_i32 vcc, 11, v10
s_nop 1
v_cndmask_b32 v199, 0, v8, vcc
v_cmp_gt_i32 vcc, 16, v10
s_nop 1
v_cndmask_b32 v200, 0, v8, vcc
v_cmp_gt_i32 vcc, 17, v10
s_nop 1
v_cndmask_b32 v201, 0, v8, vcc
v_cmp_gt_i32 vcc, 18, v10
s_nop 1
v_cndmask_b32 v202, 0, v8, vcc
v_cmp_gt_i32 vcc, 19, v10
s_nop 1
v_cndmask_b32 v203, 0, v8, vcc
v_cmp_gt_i32 vcc, 24, v10
s_nop 1
v_cndmask_b32 v204, 0, v8, vcc
v_cmp_gt_i32 vcc, 25, v10
s_nop 1
v_cndmask_b32 v205, 0, v8, vcc
v_cmp_gt_i32 vcc, 26, v10
s_nop 1
v_cndmask_b32 v206, 0, v8, vcc
v_cmp_gt_i32 vcc, 27, v10
s_nop 1
v_cndmask_b32 v207, 0, v8, vcc
v_mov_b32 v208, 0x3f803f80
v_mov_b32 v209, 0x3f803f80
v_mov_b32 v210, 0x3f803f80
v_mov_b32 v211, 0x3f803f80
s_lshl_b32 s76, s63, 22
s_add_u32 s76, s76, 16777216
s_lshl_b32 s77, s59, 19
s_add_u32 s76, s76, s77
s_lshl_b32 s77, s60, 11
s_add_u32 s76, s76, s77
s_lshl_b32 s78, s58, 16
s_add_u32 s77, s76, 458752
s_sub_u32 s77, s77, s78
s_add_u32 s76, s76, s78
s_sub_u32 s65, 7, s58
s_mov_b32 s66, 4096
s_mov_b32 s64, 0
s_cmp_eq_u32 s59, 0
s_cselect_b32 s75, 0, 1
chunk_57:
s_add_u32 s67, s58, 1
s_cmp_eq_u32 s64, 0
s_cselect_b32 s67, 0, s67
s_cselect_b32 s68, s58, s65
s_lshl_b32 s69, s58, 12
s_add_u32 s69, s69, s66
v_add_u32 v2, s69, v1
ds_read_b128 v[176:179], v2 offset:0
ds_read_b128 v[180:183], v2 offset:1024
s_lshl_b32 s70, s67, 12
s_add_u32 s70, s70, s66
s_lshl_b32 s71, s68, 12
s_add_u32 s71, s71, s70
s_sub_u32 s71, s71, 4096
s_min_u32 s72, s70, s71
v_add_u32 v3, s72, v1
ds_read_b128 v[168:171], v3 offset:0
ds_read_b128 v[172:175], v3 offset:1024
s_add_u32 s72, s70, 4096
s_min_u32 s73, s72, s71
v_add_u32 v4, s73, v1
v_mov_b32 v10, v8
v_mov_b32 v11, v8
s_add_u32 s74, s68, 1
s_lshr_b32 s74, s74, 1
s_waitcnt lgkmcnt(2)
v_mfma_f32_32x32x16_bf16 v[128:143], v[176:179], v[16:19], v[192:207]
v_mfma_f32_32x32x16_bf16 v[128:143], v[180:183], v[20:23], v[128:143]
ds_read_b128 v[176:179], v4 offset:0
ds_read_b128 v[180:183], v4 offset:1024
s_cmp_eq_u32 s74, 0
s_cbranch_scc1 p1e_61
p1_60:
s_waitcnt lgkmcnt(2)
v_mfma_f32_32x32x16_bf16 v[112:127], v[168:171], v[16:19], 0
s_add_u32 s72, s72, 4096
s_min_u32 s73, s72, s71
v_add_u32 v3, s73, v1
v_mfma_f32_32x32x16_bf16 v[112:127], v[172:175], v[20:23], v[112:127]
ds_read_b128 v[168:171], v3 offset:0
ds_read_b128 v[172:175], v3 offset:1024
v_max3_f32 v10, v10, v128, v129
v_max3_f32 v11, v11, v130, v131
v_max3_f32 v10, v10, v132, v133
v_max3_f32 v11, v11, v134, v135
v_max3_f32 v10, v10, v136, v137
v_max3_f32 v11, v11, v138, v139
v_max3_f32 v10, v10, v140, v141
v_max3_f32 v11, v11, v142, v143
s_waitcnt lgkmcnt(2)
v_mfma_f32_32x32x16_bf16 v[128:143], v[176:179], v[16:19], 0
s_add_u32 s72, s72, 4096
s_min_u32 s73, s72, s71
v_add_u32 v4, s73, v1
s_sub_u32 s74, s74, 1
v_mfma_f32_32x32x16_bf16 v[128:143], v[180:183], v[20:23], v[128:143]
ds_read_b128 v[176:179], v4 offset:0
ds_read_b128 v[180:183], v4 offset:1024
v_max3_f32 v10, v10, v112, v113
v_max3_f32 v11, v11, v114, v115
v_max3_f32 v10, v10, v116, v117
v_max3_f32 v11, v11, v118, v119
v_max3_f32 v10, v10, v120, v121
v_max3_f32 v11, v11, v122, v123
v_max3_f32 v10, v10, v124, v125
v_max3_f32 v11, v11, v126, v127
s_cmp_eq_u32 s74, 0
s_cbranch_scc0 p1_60
p1e_61:
ds_read_b128 v[168:171], v2 offset:0
ds_read_b128 v[172:175], v2 offset:1024
v_add_u32 v3, s70, v1
s_nop 4
v_max3_f32 v10, v10, v128, v129
v_max3_f32 v11, v11, v130, v131
v_max3_f32 v10, v10, v132, v133
v_max3_f32 v11, v11, v134, v135
v_max3_f32 v10, v10, v136, v137
v_max3_f32 v11, v11, v138, v139
v_max3_f32 v10, v10, v140, v141
v_max3_f32 v11, v11, v142, v143
v_max_f32 v10, v10, v11
v_mov_b32 v11, v10
s_nop 1
v_permlane32_swap_b32 v11, v10
v_max_f32 v10, v10, v11
v_sub_f32 v12, v8, v10
v_exp_f32 v12, v12
v_mov_b32 v8, v10
v_sub_f32 v112, v192, v10
v_sub_f32 v113, v193, v10
v_sub_f32 v114, v194, v10
v_sub_f32 v115, v195, v10
v_sub_f32 v116, v196, v10
v_sub_f32 v117, v197, v10
v_sub_f32 v118, v198, v10
v_sub_f32 v119, v199, v10
v_sub_f32 v120, v200, v10
v_sub_f32 v121, v201, v10
v_sub_f32 v122, v202, v10
v_sub_f32 v123, v203, v10
v_sub_f32 v124, v204, v10
v_sub_f32 v125, v205, v10
v_sub_f32 v126, v206, v10
v_sub_f32 v127, v207, v10
s_waitcnt lgkmcnt(0)
s_nop 0
v_mfma_f32_32x32x16_bf16 v[112:127], v[168:171], v[16:19], v[112:127]
ds_read_b128 v[184:187], v2 offset:2048
ds_read_b128 v[188:191], v2 offset:3072
v_sub_f32 v128, 0, v10
v_sub_f32 v129, 0, v10
v_sub_f32 v130, 0, v10
v_sub_f32 v131, 0, v10
v_sub_f32 v132, 0, v10
v_sub_f32 v133, 0, v10
v_mfma_f32_32x32x16_bf16 v[112:127], v[172:175], v[20:23], v[112:127]
ds_read_b128 v[168:171], v3 offset:0
ds_read_b128 v[172:175], v3 offset:1024
v_sub_f32 v134, 0, v10
v_sub_f32 v135, 0, v10
v_sub_f32 v136, 0, v10
v_sub_f32 v137, 0, v10
v_sub_f32 v138, 0, v10
v_sub_f32 v139, 0, v10
v_sub_f32 v140, 0, v10
v_sub_f32 v141, 0, v10
v_sub_f32 v142, 0, v10
v_sub_f32 v143, 0, v10
v_mul_f32 v48, v12, v48
v_mul_f32 v32, v12, v32
v_mul_f32 v33, v12, v33
v_mul_f32 v34, v12, v34
v_mul_f32 v35, v12, v35
v_mul_f32 v36, v12, v36
v_mul_f32 v37, v12, v37
v_mul_f32 v38, v12, v38
v_mul_f32 v39, v12, v39
v_mul_f32 v40, v12, v40
v_mul_f32 v41, v12, v41
v_mul_f32 v42, v12, v42
v_mul_f32 v43, v12, v43
v_mul_f32 v44, v12, v44
v_mul_f32 v45, v12, v45
v_mul_f32 v46, v12, v46
v_mul_f32 v47, v12, v47
v_exp_f32 v144, v112
v_exp_f32 v145, v113
v_exp_f32 v146, v114
v_exp_f32 v147, v115
v_exp_f32 v148, v116
v_exp_f32 v149, v117
v_exp_f32 v150, v118
v_exp_f32 v151, v119
v_exp_f32 v152, v120
v_exp_f32 v153, v121
v_exp_f32 v154, v122
v_exp_f32 v155, v123
v_exp_f32 v156, v124
v_exp_f32 v157, v125
v_exp_f32 v158, v126
v_exp_f32 v159, v127
s_mov_b32 s74, s68
s_cmp_eq_u32 s74, 0
s_cbranch_scc1 p2e_63
p2_62:
s_waitcnt lgkmcnt(0)
v_mfma_f32_32x32x16_bf16 v[112:127], v[168:171], v[16:19], v[128:143]
v_cvt_pk_bf16_f32 v160, v144, v145
v_cvt_pk_bf16_f32 v161, v146, v147
v_cvt_pk_bf16_f32 v162, v148, v149
v_cvt_pk_bf16_f32 v163, v150, v151
v_mov_b32 v4, v3
v_add_u32 v3, 4096, v3
v_mfma_f32_32x32x16_bf16 v[112:127], v[172:175], v[20:23], v[112:127]
v_cvt_pk_bf16_f32 v164, v152, v153
v_cvt_pk_bf16_f32 v165, v154, v155
v_cvt_pk_bf16_f32 v166, v156, v157
v_cvt_pk_bf16_f32 v167, v158, v159
ds_read_b128 v[168:171], v3 offset:0
ds_read_b128 v[172:175], v3 offset:1024
v_mfma_f32_32x32x16_bf16 v[32:47], v[184:187], v[160:163], v[32:47]
ds_read_b128 v[184:187], v4 offset:2048
s_sub_u32 s74, s74, 1
s_cmp_eq_u32 s74, 0
s_nop 1
v_exp_f32 v144, v112
v_exp_f32 v145, v113
v_mfma_f32_32x32x16_bf16 v[48:63], v[208:211], v[160:163], v[48:63]
v_exp_f32 v146, v114
v_exp_f32 v147, v115
v_exp_f32 v148, v116
v_mfma_f32_32x32x16_bf16 v[32:47], v[188:191], v[164:167], v[32:47]
ds_read_b128 v[188:191], v4 offset:3072
v_exp_f32 v149, v117
v_exp_f32 v150, v118
v_exp_f32 v151, v119
v_mfma_f32_32x32x16_bf16 v[48:63], v[208:211], v[164:167], v[48:63]
v_exp_f32 v152, v120
v_exp_f32 v153, v121
v_exp_f32 v154, v122
v_exp_f32 v155, v123
v_exp_f32 v156, v124
v_exp_f32 v157, v125
v_exp_f32 v158, v126
v_exp_f32 v159, v127
s_cbranch_scc0 p2_62
p2e_63:
v_cvt_pk_bf16_f32 v160, v144, v145
v_cvt_pk_bf16_f32 v161, v146, v147
v_cvt_pk_bf16_f32 v162, v148, v149
v_cvt_pk_bf16_f32 v163, v150, v151
s_waitcnt lgkmcnt(0)
s_nop 0
v_mfma_f32_32x32x16_bf16 v[48:63], v[208:211], v[160:163], v[48:63]
v_cvt_pk_bf16_f32 v164, v152, v153
v_cvt_pk_bf16_f32 v165, v154, v155
v_cvt_pk_bf16_f32 v166, v156, v157
v_cvt_pk_bf16_f32 v167, v158, v159
v_mfma_f32_32x32x16_bf16 v[32:47], v[184:187], v[160:163], v[32:47]
s_nop 0
v_mfma_f32_32x32x16_bf16 v[48:63], v[208:211], v[164:167], v[48:63]
v_mfma_f32_32x32x16_bf16 v[32:47], v[188:191], v[164:167], v[32:47]
s_cmp_eq_u32 s64, s75
s_cbranch_scc0 nofin_58
s_nop 8
v_rcp_f32 v12, v48
s_nop 0
v_pk_mul_f32 v[32:33], v[32:33], v[12:13] op_sel:[0,0] op_sel_hi:[1,0]
v_pk_mul_f32 v[34:35], v[34:35], v[12:13] op_sel:[0,0] op_sel_hi:[1,0]
v_pk_mul_f32 v[36:37], v[36:37], v[12:13] op_sel:[0,0] op_sel_hi:[1,0]
v_pk_mul_f32 v[38:39], v[38:39], v[12:13] op_sel:[0,0] op_sel_hi:[1,0]
v_pk_mul_f32 v[40:41], v[40:41], v[12:13] op_sel:[0,0] op_sel_hi:[1,0]
v_pk_mul_f32 v[42:43], v[42:43], v[12:13] op_sel:[0,0] op_sel_hi:[1,0]
v_pk_mul_f32 v[44:45], v[44:45], v[12:13] op_sel:[0,0] op_sel_hi:[1,0]
v_pk_mul_f32 v[46:47], v[46:47], v[12:13] op_sel:[0,0] op_sel_hi:[1,0]
v_cvt_pk_bf16_f32 v32, v32, v33
v_cvt_pk_bf16_f32 v33, v34, v35
v_cvt_pk_bf16_f32 v34, v36, v37
v_cvt_pk_bf16_f32 v35, v38, v39
v_cvt_pk_bf16_f32 v36, v40, v41
v_cvt_pk_bf16_f32 v37, v42, v43
v_cvt_pk_bf16_f32 v38, v44, v45
v_cvt_pk_bf16_f32 v39, v46, v47
buffer_store_dwordx4 v[32:35], v1, s[20:23], s76 offen offset:0 sc1
buffer_store_dwordx4 v[36:39], v1, s[20:23], s76 offen offset:1024 sc1
nofin_58:
s_add_u32 s67, s65, 1
s_cmp_eq_u32 s64, 0
s_cselect_b32 s67, 0, s67
s_cselect_b32 s68, s65, s58
s_lshl_b32 s69, s65, 12
s_add_u32 s69, s69, s66
v_add_u32 v2, s69, v1
ds_read_b128 v[176:179], v2 offset:0
ds_read_b128 v[180:183], v2 offset:1024
s_lshl_b32 s70, s67, 12
s_add_u32 s70, s70, s66
s_lshl_b32 s71, s68, 12
s_add_u32 s71, s71, s70
s_sub_u32 s71, s71, 4096
s_min_u32 s72, s70, s71
v_add_u32 v3, s72, v1
ds_read_b128 v[168:171], v3 offset:0
ds_read_b128 v[172:175], v3 offset:1024
s_add_u32 s72, s70, 4096
s_min_u32 s73, s72, s71
v_add_u32 v4, s73, v1
v_mov_b32 v10, v9
v_mov_b32 v11, v9
s_add_u32 s74, s68, 1
s_lshr_b32 s74, s74, 1
s_waitcnt lgkmcnt(2)
v_mfma_f32_32x32x16_bf16 v[128:143], v[176:179], v[64:67], v[192:207]
v_mfma_f32_32x32x16_bf16 v[128:143], v[180:183], v[68:71], v[128:143]
ds_read_b128 v[176:179], v4 offset:0
ds_read_b128 v[180:183], v4 offset:1024
s_cmp_eq_u32 s74, 0
s_cbranch_scc1 p1e_65
p1_64:
s_waitcnt lgkmcnt(2)
v_mfma_f32_32x32x16_bf16 v[112:127], v[168:171], v[64:67], 0
s_add_u32 s72, s72, 4096
s_min_u32 s73, s72, s71
v_add_u32 v3, s73, v1
v_mfma_f32_32x32x16_bf16 v[112:127], v[172:175], v[68:71], v[112:127]
ds_read_b128 v[168:171], v3 offset:0
ds_read_b128 v[172:175], v3 offset:1024
v_max3_f32 v10, v10, v128, v129
v_max3_f32 v11, v11, v130, v131
v_max3_f32 v10, v10, v132, v133
v_max3_f32 v11, v11, v134, v135
v_max3_f32 v10, v10, v136, v137
v_max3_f32 v11, v11, v138, v139
v_max3_f32 v10, v10, v140, v141
v_max3_f32 v11, v11, v142, v143
s_waitcnt lgkmcnt(2)
v_mfma_f32_32x32x16_bf16 v[128:143], v[176:179], v[64:67], 0
s_add_u32 s72, s72, 4096
s_min_u32 s73, s72, s71
v_add_u32 v4, s73, v1
s_sub_u32 s74, s74, 1
v_mfma_f32_32x32x16_bf16 v[128:143], v[180:183], v[68:71], v[128:143]
ds_read_b128 v[176:179], v4 offset:0
ds_read_b128 v[180:183], v4 offset:1024
v_max3_f32 v10, v10, v112, v113
v_max3_f32 v11, v11, v114, v115
v_max3_f32 v10, v10, v116, v117
v_max3_f32 v11, v11, v118, v119
v_max3_f32 v10, v10, v120, v121
v_max3_f32 v11, v11, v122, v123
v_max3_f32 v10, v10, v124, v125
v_max3_f32 v11, v11, v126, v127
s_cmp_eq_u32 s74, 0
s_cbranch_scc0 p1_64
p1e_65:
ds_read_b128 v[168:171], v2 offset:0
ds_read_b128 v[172:175], v2 offset:1024
v_add_u32 v3, s70, v1
s_nop 4
v_max3_f32 v10, v10, v128, v129
v_max3_f32 v11, v11, v130, v131
v_max3_f32 v10, v10, v132, v133
v_max3_f32 v11, v11, v134, v135
v_max3_f32 v10, v10, v136, v137
v_max3_f32 v11, v11, v138, v139
v_max3_f32 v10, v10, v140, v141
v_max3_f32 v11, v11, v142, v143
v_max_f32 v10, v10, v11
v_mov_b32 v11, v10
s_nop 1
v_permlane32_swap_b32 v11, v10
v_max_f32 v10, v10, v11
v_sub_f32 v12, v9, v10
v_exp_f32 v12, v12
v_mov_b32 v9, v10
v_sub_f32 v112, v192, v10
v_sub_f32 v113, v193, v10
v_sub_f32 v114, v194, v10
v_sub_f32 v115, v195, v10
v_sub_f32 v116, v196, v10
v_sub_f32 v117, v197, v10
v_sub_f32 v118, v198, v10
v_sub_f32 v119, v199, v10
v_sub_f32 v120, v200, v10
v_sub_f32 v121, v201, v10
v_sub_f32 v122, v202, v10
v_sub_f32 v123, v203, v10
v_sub_f32 v124, v204, v10
v_sub_f32 v125, v205, v10
v_sub_f32 v126, v206, v10
v_sub_f32 v127, v207, v10
s_waitcnt lgkmcnt(0)
s_nop 0
v_mfma_f32_32x32x16_bf16 v[112:127], v[168:171], v[64:67], v[112:127]
ds_read_b128 v[184:187], v2 offset:2048
ds_read_b128 v[188:191], v2 offset:3072
v_sub_f32 v128, 0, v10
v_sub_f32 v129, 0, v10
v_sub_f32 v130, 0, v10
v_sub_f32 v131, 0, v10
v_sub_f32 v132, 0, v10
v_sub_f32 v133, 0, v10
v_mfma_f32_32x32x16_bf16 v[112:127], v[172:175], v[68:71], v[112:127]
ds_read_b128 v[168:171], v3 offset:0
ds_read_b128 v[172:175], v3 offset:1024
v_sub_f32 v134, 0, v10
v_sub_f32 v135, 0, v10
v_sub_f32 v136, 0, v10
v_sub_f32 v137, 0, v10
v_sub_f32 v138, 0, v10
v_sub_f32 v139, 0, v10
v_sub_f32 v140, 0, v10
v_sub_f32 v141, 0, v10
v_sub_f32 v142, 0, v10
v_sub_f32 v143, 0, v10
v_mul_f32 v96, v12, v96
v_mul_f32 v80, v12, v80
v_mul_f32 v81, v12, v81
v_mul_f32 v82, v12, v82
v_mul_f32 v83, v12, v83
v_mul_f32 v84, v12, v84
v_mul_f32 v85, v12, v85
v_mul_f32 v86, v12, v86
v_mul_f32 v87, v12, v87
v_mul_f32 v88, v12, v88
v_mul_f32 v89, v12, v89
v_mul_f32 v90, v12, v90
v_mul_f32 v91, v12, v91
v_mul_f32 v92, v12, v92
v_mul_f32 v93, v12, v93
v_mul_f32 v94, v12, v94
v_mul_f32 v95, v12, v95
v_exp_f32 v144, v112
v_exp_f32 v145, v113
v_exp_f32 v146, v114
v_exp_f32 v147, v115
v_exp_f32 v148, v116
v_exp_f32 v149, v117
v_exp_f32 v150, v118
v_exp_f32 v151, v119
v_exp_f32 v152, v120
v_exp_f32 v153, v121
v_exp_f32 v154, v122
v_exp_f32 v155, v123
v_exp_f32 v156, v124
v_exp_f32 v157, v125
v_exp_f32 v158, v126
v_exp_f32 v159, v127
s_mov_b32 s74, s68
s_cmp_eq_u32 s74, 0
s_cbranch_scc1 p2e_67
p2_66:
s_waitcnt lgkmcnt(0)
v_mfma_f32_32x32x16_bf16 v[112:127], v[168:171], v[64:67], v[128:143]
v_cvt_pk_bf16_f32 v160, v144, v145
v_cvt_pk_bf16_f32 v161, v146, v147
v_cvt_pk_bf16_f32 v162, v148, v149
v_cvt_pk_bf16_f32 v163, v150, v151
v_mov_b32 v4, v3
v_add_u32 v3, 4096, v3
v_mfma_f32_32x32x16_bf16 v[112:127], v[172:175], v[68:71], v[112:127]
v_cvt_pk_bf16_f32 v164, v152, v153
v_cvt_pk_bf16_f32 v165, v154, v155
v_cvt_pk_bf16_f32 v166, v156, v157
v_cvt_pk_bf16_f32 v167, v158, v159
ds_read_b128 v[168:171], v3 offset:0
ds_read_b128 v[172:175], v3 offset:1024
v_mfma_f32_32x32x16_bf16 v[80:95], v[184:187], v[160:163], v[80:95]
ds_read_b128 v[184:187], v4 offset:2048
s_sub_u32 s74, s74, 1
s_cmp_eq_u32 s74, 0
s_nop 1
v_exp_f32 v144, v112
v_exp_f32 v145, v113
v_mfma_f32_32x32x16_bf16 v[96:111], v[208:211], v[160:163], v[96:111]
v_exp_f32 v146, v114
v_exp_f32 v147, v115
v_exp_f32 v148, v116
v_mfma_f32_32x32x16_bf16 v[80:95], v[188:191], v[164:167], v[80:95]
ds_read_b128 v[188:191], v4 offset:3072
v_exp_f32 v149, v117
v_exp_f32 v150, v118
v_exp_f32 v151, v119
v_mfma_f32_32x32x16_bf16 v[96:111], v[208:211], v[164:167], v[96:111]
v_exp_f32 v152, v120
v_exp_f32 v153, v121
v_exp_f32 v154, v122
v_exp_f32 v155, v123
v_exp_f32 v156, v124
v_exp_f32 v157, v125
v_exp_f32 v158, v126
v_exp_f32 v159, v127
s_cbranch_scc0 p2_66
p2e_67:
v_cvt_pk_bf16_f32 v160, v144, v145
v_cvt_pk_bf16_f32 v161, v146, v147
v_cvt_pk_bf16_f32 v162, v148, v149
v_cvt_pk_bf16_f32 v163, v150, v151
s_waitcnt lgkmcnt(0)
s_nop 0
v_mfma_f32_32x32x16_bf16 v[96:111], v[208:211], v[160:163], v[96:111]
v_cvt_pk_bf16_f32 v164, v152, v153
v_cvt_pk_bf16_f32 v165, v154, v155
v_cvt_pk_bf16_f32 v166, v156, v157
v_cvt_pk_bf16_f32 v167, v158, v159
v_mfma_f32_32x32x16_bf16 v[80:95], v[184:187], v[160:163], v[80:95]
s_nop 0
v_mfma_f32_32x32x16_bf16 v[96:111], v[208:211], v[164:167], v[96:111]
v_mfma_f32_32x32x16_bf16 v[80:95], v[188:191], v[164:167], v[80:95]
s_cmp_eq_u32 s64, 1
s_cbranch_scc1 attend_59
s_barrier
s_cmp_eq_u32 s75, 0
s_cbranch_scc1 attend_59
v_mov_b32 v12, 0xf149f2ca
v_xor_b32 v192, v12, v192
v_xor_b32 v193, v12, v193
v_xor_b32 v194, v12, v194
v_xor_b32 v195, v12, v195
v_xor_b32 v196, v12, v196
v_xor_b32 v197, v12, v197
v_xor_b32 v198, v12, v198
v_xor_b32 v199, v12, v199
v_xor_b32 v200, v12, v200
v_xor_b32 v201, v12, v201
v_xor_b32 v202, v12, v202
v_xor_b32 v203, v12, v203
v_xor_b32 v204, v12, v204
v_xor_b32 v205, v12, v205
v_xor_b32 v206, v12, v206
v_xor_b32 v207, v12, v207
s_mov_b32 s64, 1
s_mov_b32 s66, 131072
s_branch chunk_57
attend_59:
s_barrier
s_nop 7
v_rcp_f32 v12, v96
s_nop 0
v_pk_mul_f32 v[80:81], v[80:81], v[12:13] op_sel:[0,0] op_sel_hi:[1,0]
v_pk_mul_f32 v[82:83], v[82:83], v[12:13] op_sel:[0,0] op_sel_hi:[1,0]
v_pk_mul_f32 v[84:85], v[84:85], v[12:13] op_sel:[0,0] op_sel_hi:[1,0]
v_pk_mul_f32 v[86:87], v[86:87], v[12:13] op_sel:[0,0] op_sel_hi:[1,0]
v_pk_mul_f32 v[88:89], v[88:89], v[12:13] op_sel:[0,0] op_sel_hi:[1,0]
v_pk_mul_f32 v[90:91], v[90:91], v[12:13] op_sel:[0,0] op_sel_hi:[1,0]
v_pk_mul_f32 v[92:93], v[92:93], v[12:13] op_sel:[0,0] op_sel_hi:[1,0]
v_pk_mul_f32 v[94:95], v[94:95], v[12:13] op_sel:[0,0] op_sel_hi:[1,0]
v_cvt_pk_bf16_f32 v80, v80, v81
v_cvt_pk_bf16_f32 v81, v82, v83
v_cvt_pk_bf16_f32 v82, v84, v85
v_cvt_pk_bf16_f32 v83, v86, v87
v_cvt_pk_bf16_f32 v84, v88, v89
v_cvt_pk_bf16_f32 v85, v90, v91
v_cvt_pk_bf16_f32 v86, v92, v93
v_cvt_pk_bf16_f32 v87, v94, v95
buffer_store_dwordx4 v[80:83], v1, s[20:23], s77 offen offset:0 sc1
buffer_store_dwordx4 v[84:87], v1, s[20:23], s77 offen offset:1024 sc1
s_lshl_b32 s64, s59, 10
s_lshl_b32 s66, s60, 2
s_add_u32 s64, s64, s66
s_add_u32 s64, s64, 1392640
s_lshl_b32 s66, s58, 7
s_lshl_b32 s67, s65, 7
v_mov_b32 v2, s66
v_mov_b32 v3, s67
v_cmp_eq_u32 vcc, 1, v0
s_nop 1
v_cndmask_b32 v2, v2, v3, vcc
v_mov_b32 v3, 1
s_mov_b64 exec, 3
s_waitcnt vmcnt(0)
buffer_store_dword v3, v2, s[24:27], s64 offen sc1
s_mov_b64 exec, -1
v_and_b32 v10, 31, v0
v_lshrrev_b32 v11, 5, v0
v_lshlrev_b32 v12, 3, v10
ds_read_b64 v[6:7], v12 offset:1024
ds_read_b64 v[8:9], v12 offset:1280
v_bfe_u32 v13, v0, 2, 2
v_lshl_add_u32 v14, v11, 2, v13
v_lshlrev_b32 v14, 8, v14
v_xor_b32 v13, s58, v13
v_lshl_add_u32 v14, v13, 6, v14
v_bfe_u32 v13, v0, 4, 1
v_lshl_add_u32 v14, v13, 5, v14
v_and_b32 v13, 3, v0
v_lshl_add_u32 v2, v13, 3, v14
s_mov_b32 s64, 49152
s_mov_b32 s65, 4096
s_mov_b32 s66, 15
v_add_u32 v3, s64, v2
v_add_u32 v4, s65, v1
v_lshlrev_b32 v16, 16, v240
v_and_b32 v17, 0xffff0000, v240
v_lshlrev_b32 v18, 16, v241
v_and_b32 v19, 0xffff0000, v241
v_lshlrev_b32 v20, 16, v242
v_and_b32 v21, 0xffff0000, v242
v_lshlrev_b32 v22, 16, v243
v_and_b32 v23, 0xffff0000, v243
v_lshlrev_b32 v24, 16, v244
v_and_b32 v25, 0xffff0000, v244
v_lshlrev_b32 v26, 16, v245
v_and_b32 v27, 0xffff0000, v245
v_lshlrev_b32 v28, 16, v246
v_and_b32 v29, 0xffff0000, v246
v_lshlrev_b32 v30, 16, v247
v_and_b32 v31, 0xffff0000, v247
v_lshlrev_b32 v32, 16, v248
v_and_b32 v33, 0xffff0000, v248
v_lshlrev_b32 v34, 16, v249
v_and_b32 v35, 0xffff0000, v249
v_lshlrev_b32 v36, 16, v250
v_and_b32 v37, 0xffff0000, v250
v_lshlrev_b32 v38, 16, v251
v_and_b32 v39, 0xffff0000, v251
v_lshlrev_b32 v40, 16, v252
v_and_b32 v41, 0xffff0000, v252
v_lshlrev_b32 v42, 16, v253
v_and_b32 v43, 0xffff0000, v253
v_lshlrev_b32 v44, 16, v254
v_and_b32 v45, 0xffff0000, v254
v_lshlrev_b32 v46, 16, v255
v_and_b32 v47, 0xffff0000, v255
s_waitcnt lgkmcnt(0)
v_pk_fma_f32 v[16:17], v[16:17], v[6:7], v[6:7] op_sel:[0,0,1] op_sel_hi:[1,0,1]
v_pk_fma_f32 v[18:19], v[18:19], v[6:7], v[6:7] op_sel:[0,0,1] op_sel_hi:[1,0,1]
v_pk_fma_f32 v[20:21], v[20:21], v[6:7], v[6:7] op_sel:[0,0,1] op_sel_hi:[1,0,1]
v_pk_fma_f32 v[22:23], v[22:23], v[6:7], v[6:7] op_sel:[0,0,1] op_sel_hi:[1,0,1]
v_pk_fma_f32 v[24:25], v[24:25], v[6:7], v[6:7] op_sel:[0,0,1] op_sel_hi:[1,0,1]
v_pk_fma_f32 v[26:27], v[26:27], v[6:7], v[6:7] op_sel:[0,0,1] op_sel_hi:[1,0,1]
v_pk_fma_f32 v[28:29], v[28:29], v[6:7], v[6:7] op_sel:[0,0,1] op_sel_hi:[1,0,1]
v_pk_fma_f32 v[30:31], v[30:31], v[6:7], v[6:7] op_sel:[0,0,1] op_sel_hi:[1,0,1]
v_pk_fma_f32 v[32:33], v[32:33], v[8:9], v[8:9] op_sel:[0,0,1] op_sel_hi:[1,0,1]
v_pk_fma_f32 v[34:35], v[34:35], v[8:9], v[8:9] op_sel:[0,0,1] op_sel_hi:[1,0,1]
v_pk_fma_f32 v[36:37], v[36:37], v[8:9], v[8:9] op_sel:[0,0,1] op_sel_hi:[1,0,1]
v_pk_fma_f32 v[38:39], v[38:39], v[8:9], v[8:9] op_sel:[0,0,1] op_sel_hi:[1,0,1]
v_pk_fma_f32 v[40:41], v[40:41], v[8:9], v[8:9] op_sel:[0,0,1] op_sel_hi:[1,0,1]
v_pk_fma_f32 v[42:43], v[42:43], v[8:9], v[8:9] op_sel:[0,0,1] op_sel_hi:[1,0,1]
v_pk_fma_f32 v[44:45], v[44:45], v[8:9], v[8:9] op_sel:[0,0,1] op_sel_hi:[1,0,1]
v_pk_fma_f32 v[46:47], v[46:47], v[8:9], v[8:9] op_sel:[0,0,1] op_sel_hi:[1,0,1]
s_barrier
s_barrier
ds_read_b64_tr_b16 v[48:49], v3 offset:0
ds_read_b64_tr_b16 v[50:51], v3 offset:2048
ds_read_b128 v[52:55], v4 offset:0
ds_read_b128 v[56:59], v4 offset:4096
ds_read_b64_tr_b16 v[60:61], v3 offset:4096
ds_read_b64_tr_b16 v[62:63], v3 offset:6144
ds_read_b128 v[64:67], v4 offset:1024
ds_read_b128 v[68:71], v4 offset:5120
ds_read_b64_tr_b16 v[72:73], v3 offset:8192
ds_read_b64_tr_b16 v[74:75], v3 offset:10240
ds_read_b128 v[76:79], v4 offset:2048
ds_read_b128 v[80:83], v4 offset:6144
s_branch mopm_69
.p2align 6
mop_68:
v_mfma_f32_32x32x16_bf16 v[16:31], v[72:75], v[76:79], v[16:31]
ds_read_b64_tr_b16 v[48:49], v3 offset:0
ds_read_b64_tr_b16 v[50:51], v3 offset:2048
ds_read_b128 v[52:55], v4 offset:0
v_mfma_f32_32x32x16_bf16 v[32:47], v[72:75], v[80:83], v[32:47]
ds_read_b128 v[56:59], v4 offset:4096
ds_read_b64_tr_b16 v[60:61], v3 offset:4096
ds_read_b64_tr_b16 v[62:63], v3 offset:6144
v_mfma_f32_32x32x16_bf16 v[16:31], v[84:87], v[88:91], v[16:31]
ds_read_b128 v[64:67], v4 offset:1024
ds_read_b128 v[68:71], v4 offset:5120
ds_read_b64_tr_b16 v[72:73], v3 offset:8192
v_mfma_f32_32x32x16_bf16 v[32:47], v[84:87], v[92:95], v[32:47]
ds_read_b64_tr_b16 v[74:75], v3 offset:10240
ds_read_b128 v[76:79], v4 offset:2048
ds_read_b128 v[80:83], v4 offset:6144
s_sub_u32 s66, s66, 1
mopm_69:
s_waitcnt lgkmcnt(8)
v_mfma_f32_32x32x16_bf16 v[16:31], v[48:51], v[52:55], v[16:31]
ds_read_b64_tr_b16 v[84:85], v3 offset:12288
ds_read_b64_tr_b16 v[86:87], v3 offset:14336
s_add_u32 s64, s64, 16384
s_cmp_eq_u32 s64, 163840
s_cselect_b32 s64, 49152, s64
v_mfma_f32_32x32x16_bf16 v[32:47], v[48:51], v[56:59], v[32:47]
ds_read_b128 v[88:91], v4 offset:3072
ds_read_b128 v[92:95], v4 offset:7168
s_add_u32 s65, s65, 8192
s_cmp_eq_u32 s65, 45056
s_cselect_b32 s65, 4096, s65
s_waitcnt lgkmcnt(8)
v_mfma_f32_32x32x16_bf16 v[16:31], v[60:63], v[64:67], v[16:31]
v_add_u32 v3, s64, v2
v_add_u32 v4, s65, v1
v_mfma_f32_32x32x16_bf16 v[32:47], v[60:63], v[68:71], v[32:47]
s_waitcnt lgkmcnt(0)
s_barrier
s_cmp_eq_u32 s66, 0
s_cbranch_scc0 mop_68
v_mfma_f32_32x32x16_bf16 v[16:31], v[72:75], v[76:79], v[16:31]
v_mfma_f32_32x32x16_bf16 v[32:47], v[72:75], v[80:83], v[32:47]
v_mfma_f32_32x32x16_bf16 v[16:31], v[84:87], v[88:91], v[16:31]
v_mfma_f32_32x32x16_bf16 v[32:47], v[84:87], v[92:95], v[32:47]
s_lshl_b32 s64, s61, 17
s_lshl_b32 s65, s62, 13
s_add_u32 s64, s64, s65
s_lshl_b32 s65, s58, 11
s_add_u32 s64, s64, s65
s_add_u32 s64, s64, 25165824
s_add_u32 s65, s64, 0x10000
s_lshl_b32 s66, s58, 6
s_add_u32 s66, s66, 139264
v_mul_u32_u24 v2, 272, v10
v_lshl_add_u32 v2, v11, 3, v2
v_add_u32 v2, s66, v2
s_lshl_b32 s66, s58, 10
v_add_u32 v3, s66, v1
s_mov_b32 s67, 0x3f803f80
v_mov_b32 v4, 0
v_mov_b32 v5, 0
v_mov_b32 v6, 0
v_mov_b32 v7, 0
v_mov_b32 v8, 0
v_mov_b32 v9, 0
v_cvt_pk_bf16_f32 v240, v16, v17
v_cvt_pk_bf16_f32 v241, v18, v19
v_cvt_pk_bf16_f32 v242, v20, v21
v_cvt_pk_bf16_f32 v243, v22, v23
v_cvt_pk_bf16_f32 v244, v24, v25
v_cvt_pk_bf16_f32 v245, v26, v27
v_cvt_pk_bf16_f32 v246, v28, v29
v_cvt_pk_bf16_f32 v247, v30, v31
v_cvt_pk_bf16_f32 v248, v32, v33
v_cvt_pk_bf16_f32 v249, v34, v35
v_cvt_pk_bf16_f32 v250, v36, v37
v_cvt_pk_bf16_f32 v251, v38, v39
v_cvt_pk_bf16_f32 v252, v40, v41
v_cvt_pk_bf16_f32 v253, v42, v43
v_cvt_pk_bf16_f32 v254, v44, v45
v_cvt_pk_bf16_f32 v255, v46, v47
s_cmp_eq_u32 s63, 0
s_cbranch_scc0 nox1_70
buffer_store_dwordx4 v[240:243], v1, s[20:23], s64 offen offset:0 sc1
buffer_store_dwordx4 v[244:247], v1, s[20:23], s64 offen offset:1024 sc1
buffer_store_dwordx4 v[248:251], v1, s[20:23], s65 offen offset:0 sc1
buffer_store_dwordx4 v[252:255], v1, s[20:23], s65 offen offset:1024 sc1
nox1_70:
v_dot2c_f32_bf16 v4, s67, v240
v_dot2c_f32_bf16 v5, v240, v240
v_dot2c_f32_bf16 v6, v232, v240
v_dot2c_f32_bf16 v7, s67, v248
v_dot2c_f32_bf16 v8, v248, v248
v_dot2c_f32_bf16 v9, v232, v248
v_dot2c_f32_bf16 v4, s67, v241
v_dot2c_f32_bf16 v5, v241, v241
v_dot2c_f32_bf16 v6, v233, v241
v_dot2c_f32_bf16 v7, s67, v249
v_dot2c_f32_bf16 v8, v249, v249
v_dot2c_f32_bf16 v9, v233, v249
v_dot2c_f32_bf16 v4, s67, v242
v_dot2c_f32_bf16 v5, v242, v242
v_dot2c_f32_bf16 v6, v234, v242
v_dot2c_f32_bf16 v7, s67, v250
v_dot2c_f32_bf16 v8, v250, v250
v_dot2c_f32_bf16 v9, v234, v250
v_dot2c_f32_bf16 v4, s67, v243
v_dot2c_f32_bf16 v5, v243, v243
v_dot2c_f32_bf16 v6, v235, v243
v_dot2c_f32_bf16 v7, s67, v251
v_dot2c_f32_bf16 v8, v251, v251
v_dot2c_f32_bf16 v9, v235, v251
v_dot2c_f32_bf16 v4, s67, v244
v_dot2c_f32_bf16 v5, v244, v244
v_dot2c_f32_bf16 v6, v236, v244
v_dot2c_f32_bf16 v7, s67, v252
v_dot2c_f32_bf16 v8, v252, v252
v_dot2c_f32_bf16 v9, v236, v252
v_dot2c_f32_bf16 v4, s67, v245
v_dot2c_f32_bf16 v5, v245, v245
v_dot2c_f32_bf16 v6, v237, v245
v_dot2c_f32_bf16 v7, s67, v253
v_dot2c_f32_bf16 v8, v253, v253
v_dot2c_f32_bf16 v9, v237, v253
v_dot2c_f32_bf16 v4, s67, v246
v_dot2c_f32_bf16 v5, v246, v246
v_dot2c_f32_bf16 v6, v238, v246
v_dot2c_f32_bf16 v7, s67, v254
v_dot2c_f32_bf16 v8, v254, v254
v_dot2c_f32_bf16 v9, v238, v254
v_dot2c_f32_bf16 v4, s67, v247
v_dot2c_f32_bf16 v5, v247, v247
v_dot2c_f32_bf16 v6, v239, v247
v_dot2c_f32_bf16 v7, s67, v255
v_dot2c_f32_bf16 v8, v255, v255
v_dot2c_f32_bf16 v9, v239, v255
s_nop 0
v_permlane32_swap_b32 v4, v7
v_permlane32_swap_b32 v5, v8
v_permlane32_swap_b32 v6, v9
v_add_f32 v4, v4, v7
v_add_f32 v5, v5, v8
v_add_f32 v6, v6, v9
ds_write_b96 v3, v[4:6] offset:4096
ds_write_b64 v2, v[240:241] offset:0
ds_write_b64 v2, v[242:243] offset:16
ds_write_b64 v2, v[244:245] offset:32
ds_write_b64 v2, v[246:247] offset:48
ds_write_b64 v2, v[248:249] offset:8704
ds_write_b64 v2, v[250:251] offset:8720
ds_write_b64 v2, v[252:253] offset:8736
ds_write_b64 v2, v[254:255] offset:8752
s_waitcnt lgkmcnt(0)
s_barrier
s_waitcnt vmcnt(0)
s_barrier
v_mov_b32 v2, 0
ds_read_b32 v2, v2 offset:640
s_cmp_eq_u32 s63, 0
s_cbranch_scc0 mout_71
s_lshl_b32 s64, s61, 6
v_and_b32 v10, 31, v0
v_lshrrev_b32 v11, 5, v0
v_add_u32 v10, s64, v10
v_lshlrev_b32 v3, 4, v11
s_lshl_b32 s65, s62, 13
s_lshl_b32 s66, s58, 11
s_add_u32 s65, s65, s66
s_add_u32 s65, s65, 1245184
s_waitcnt lgkmcnt(0)
v_sub_u32 v10, v2, v10
s_barrier
v_cmp_eq_u32 vcc, 0, v10
s_mov_b64 exec, vcc
buffer_load_dwordx4 v[240:243], v3, s[24:27], s65 offen offset:0 sc1
buffer_load_dwordx4 v[244:247], v3, s[24:27], s65 offen offset:1024 sc1
s_mov_b64 exec, -1
v_cmp_eq_u32 vcc, 32, v10
s_mov_b64 exec, vcc
buffer_load_dwordx4 v[248:251], v3, s[24:27], s65 offen offset:0 sc1
buffer_load_dwordx4 v[252:255], v3, s[24:27], s65 offen offset:1024 sc1
s_mov_b64 exec, -1
s_mov_b32 s63, 1
s_add_u32 s24, s24, 1572864
s_addc_u32 s25, s25, 0
s_mov_b32 s26, 1572864
s_branch L_mtop
mout_71:
v_lshrrev_b32 v10, 4, v0
v_and_b32 v11, 15, v0
s_lshl_b32 s64, s58, 4
v_add_u32 v10, s64, v10
v_mul_u32_u24 v3, 272, v10
v_lshl_add_u32 v3, v11, 4, v3
v_add_u32 v3, 139264, v3
v_lshlrev_b32 v4, 3, v10
ds_read_b128 v[16:19], v3 offset:0
ds_read_b64 v[32:33], v4 offset:1024
ds_read_b128 v[20:23], v3 offset:1088
ds_read_b64 v[34:35], v4 offset:1056
ds_read_b128 v[24:27], v3 offset:2176
ds_read_b64 v[36:37], v4 offset:1088
ds_read_b128 v[28:31], v3 offset:3264
ds_read_b64 v[38:39], v4 offset:1120
s_lshl_b32 s64, s61, 6
v_add_u32 v10, s64, v10
v_lshlrev_b32 v5, 11, v10
v_lshl_add_u32 v5, v11, 4, v5
s_lshl_b32 s64, s62, 8
s_waitcnt lgkmcnt(6)
v_sub_u32 v10, v2, v10
v_lshlrev_b32 v40, 16, v16
v_and_b32 v41, 0xffff0000, v16
v_lshlrev_b32 v42, 16, v17
v_and_b32 v43, 0xffff0000, v17
v_lshlrev_b32 v44, 16, v18
v_and_b32 v45, 0xffff0000, v18
v_lshlrev_b32 v46, 16, v19
v_and_b32 v47, 0xffff0000, v19
v_pk_fma_f32 v[40:41], v[40:41], v[32:33], v[32:33] op_sel:[0,0,1] op_sel_hi:[1,0,1]
v_pk_fma_f32 v[42:43], v[42:43], v[32:33], v[32:33] op_sel:[0,0,1] op_sel_hi:[1,0,1]
v_pk_fma_f32 v[44:45], v[44:45], v[32:33], v[32:33] op_sel:[0,0,1] op_sel_hi:[1,0,1]
v_pk_fma_f32 v[46:47], v[46:47], v[32:33], v[32:33] op_sel:[0,0,1] op_sel_hi:[1,0,1]
v_cvt_pk_bf16_f32 v16, v40, v41
v_cvt_pk_bf16_f32 v17, v42, v43
v_cvt_pk_bf16_f32 v18, v44, v45
v_cvt_pk_bf16_f32 v19, v46, v47
v_cmp_ne_u32 vcc, 0, v10
s_mov_b64 exec, vcc
buffer_store_dwordx4 v[16:19], v5, s[28:31], s64 offen
s_mov_b64 exec, -1
s_add_u32 s64, s64, 8192
s_waitcnt lgkmcnt(4)
v_lshlrev_b32 v40, 16, v20
v_and_b32 v41, 0xffff0000, v20
v_lshlrev_b32 v42, 16, v21
v_and_b32 v43, 0xffff0000, v21
v_lshlrev_b32 v44, 16, v22
v_and_b32 v45, 0xffff0000, v22
v_lshlrev_b32 v46, 16, v23
v_and_b32 v47, 0xffff0000, v23
v_pk_fma_f32 v[40:41], v[40:41], v[34:35], v[34:35] op_sel:[0,0,1] op_sel_hi:[1,0,1]
v_pk_fma_f32 v[42:43], v[42:43], v[34:35], v[34:35] op_sel:[0,0,1] op_sel_hi:[1,0,1]
v_pk_fma_f32 v[44:45], v[44:45], v[34:35], v[34:35] op_sel:[0,0,1] op_sel_hi:[1,0,1]
v_pk_fma_f32 v[46:47], v[46:47], v[34:35], v[34:35] op_sel:[0,0,1] op_sel_hi:[1,0,1]
v_cvt_pk_bf16_f32 v20, v40, v41
v_cvt_pk_bf16_f32 v21, v42, v43
v_cvt_pk_bf16_f32 v22, v44, v45
v_cvt_pk_bf16_f32 v23, v46, v47
v_cmp_ne_u32 vcc, 4, v10
s_mov_b64 exec, vcc
buffer_store_dwordx4 v[20:23], v5, s[28:31], s64 offen
s_mov_b64 exec, -1
s_add_u32 s64, s64, 8192
s_waitcnt lgkmcnt(2)
v_lshlrev_b32 v40, 16, v24
v_and_b32 v41, 0xffff0000, v24
v_lshlrev_b32 v42, 16, v25
v_and_b32 v43, 0xffff0000, v25
v_lshlrev_b32 v44, 16, v26
v_and_b32 v45, 0xffff0000, v26
v_lshlrev_b32 v46, 16, v27
v_and_b32 v47, 0xffff0000, v27
v_pk_fma_f32 v[40:41], v[40:41], v[36:37], v[36:37] op_sel:[0,0,1] op_sel_hi:[1,0,1]
v_pk_fma_f32 v[42:43], v[42:43], v[36:37], v[36:37] op_sel:[0,0,1] op_sel_hi:[1,0,1]
v_pk_fma_f32 v[44:45], v[44:45], v[36:37], v[36:37] op_sel:[0,0,1] op_sel_hi:[1,0,1]
v_pk_fma_f32 v[46:47], v[46:47], v[36:37], v[36:37] op_sel:[0,0,1] op_sel_hi:[1,0,1]
v_cvt_pk_bf16_f32 v24, v40, v41
v_cvt_pk_bf16_f32 v25, v42, v43
v_cvt_pk_bf16_f32 v26, v44, v45
v_cvt_pk_bf16_f32 v27, v46, v47
v_cmp_ne_u32 vcc, 8, v10
s_mov_b64 exec, vcc
buffer_store_dwordx4 v[24:27], v5, s[28:31], s64 offen
s_mov_b64 exec, -1
s_add_u32 s64, s64, 8192
s_waitcnt lgkmcnt(0)
v_lshlrev_b32 v40, 16, v28
v_and_b32 v41, 0xffff0000, v28
v_lshlrev_b32 v42, 16, v29
v_and_b32 v43, 0xffff0000, v29
v_lshlrev_b32 v44, 16, v30
v_and_b32 v45, 0xffff0000, v30
v_lshlrev_b32 v46, 16, v31
v_and_b32 v47, 0xffff0000, v31
v_pk_fma_f32 v[40:41], v[40:41], v[38:39], v[38:39] op_sel:[0,0,1] op_sel_hi:[1,0,1]
v_pk_fma_f32 v[42:43], v[42:43], v[38:39], v[38:39] op_sel:[0,0,1] op_sel_hi:[1,0,1]
v_pk_fma_f32 v[44:45], v[44:45], v[38:39], v[38:39] op_sel:[0,0,1] op_sel_hi:[1,0,1]
v_pk_fma_f32 v[46:47], v[46:47], v[38:39], v[38:39] op_sel:[0,0,1] op_sel_hi:[1,0,1]
v_cvt_pk_bf16_f32 v28, v40, v41
v_cvt_pk_bf16_f32 v29, v42, v43
v_cvt_pk_bf16_f32 v30, v44, v45
v_cvt_pk_bf16_f32 v31, v46, v47
v_cmp_ne_u32 vcc, 12, v10
s_mov_b64 exec, vcc
buffer_store_dwordx4 v[28:31], v5, s[28:31], s64 offen
s_mov_b64 exec, -1
s_add_u32 s64, s64, 8192
s_branch L_end
L_end:
L_fin:
s_endpgm
.section .rodata,"a"
.p2align 6
.amdhsa_kernel interleave_layers__sliding_block__moe_arch_mod__prompt_kernel
  .amdhsa_next_free_vgpr 256
  .amdhsa_next_free_sgpr 102
  .amdhsa_accum_offset 256
  .amdhsa_group_segment_fixed_size 0
  .amdhsa_kernarg_size 88
  .amdhsa_user_sgpr_count 2
  .amdhsa_user_sgpr_kernarg_segment_ptr 1
  .amdhsa_system_sgpr_workgroup_id_x 1
  .amdhsa_float_denorm_mode_32 3
.end_amdhsa_kernel
```

```asm
; @launch grid=(256,1,1) block=(512,1,1) lds=163840
.amdgcn_target "amdgcn-amd-amdhsa--gfx950"
.text
.globl interleave_layers__sliding_block__moe_arch_mod__prompt_kernel
.p2align 8
.type interleave_layers__sliding_block__moe_arch_mod__prompt_kernel,@function
interleave_layers__sliding_block__moe_arch_mod__prompt_kernel:
s_cmp_ge_u32 s2, 256
s_cbranch_scc1 L_fin
s_load_dwordx16 s[36:51], s[0:1], 0
s_load_dwordx4 s[52:55], s[0:1], 64
s_load_dwordx2 s[56:57], s[0:1], 80
v_lshrrev_b32 v1, 6, v0
v_and_b32 v0, 63, v0
s_and_b32 s64, s2, 7
v_readfirstlane_b32 s3, v1
s_lshr_b32 s65, s2, 3
s_and_b32 s66, s65, 7
s_and_b32 s67, s64, 1
s_lshl3_add_u32 s59, s67, s66
s_lshr_b32 s66, s65, 3
s_lshr_b32 s67, s64, 1
s_lshl2_add_u32 s60, s67, s66
s_and_b32 s66, s65, 1
s_lshl1_add_u32 s61, s64, s66
s_lshr_b32 s62, s65, 1
s_mov_b32 s63, 0
s_mov_b32 s34, 0
s_mov_b32 s32, 200000
s_mov_b32 s33, -1
s_cmp_ge_u32 s3, 4
s_cselect_b32 s66, 3, 1
s_and_b32 s58, s3, s66
s_waitcnt lgkmcnt(0)
s_mov_b32 s8, s36
s_mov_b32 s9, s37
s_mov_b32 s10, 0x400000
s_mov_b32 s11, 0x00020000
s_mov_b32 s12, s38
s_mov_b32 s13, s39
s_mov_b32 s14, 0x600000
s_mov_b32 s15, 0x00020000
s_mov_b32 s16, s40
s_mov_b32 s17, s41
s_mov_b32 s18, 0x200000
s_mov_b32 s19, 0x00020000
s_mov_b32 s20, s56
s_mov_b32 s21, s57
s_mov_b32 s22, 0x2300000
s_mov_b32 s23, 0x00020000
s_add_u32 s24, s56, 30408704
s_addc_u32 s25, s57, 0
s_mov_b32 s26, 4718592
s_mov_b32 s27, 0x00020000
s_mov_b32 s28, s52
s_mov_b32 s29, s53
s_mov_b32 s30, 0x400000
s_mov_b32 s31, 0x00020000
s_cmp_ge_u32 s3, 4
s_cbranch_scc1 L_m
s_cmp_ge_u32 s3, 2
s_cbranch_scc1 L_f
s_setprio 1
v_and_b32 v22, 7, v0
v_lshrrev_b32 v23, 4, v0
v_lshrrev_b32 v6, 3, v0
v_xor_b32 v7, v22, v23
v_lshlrev_b32 v7, 4, v7
v_lshl_add_u32 v8, v6, 11, v7
v_xor_b32 v7, 64, v8
v_add_u32 v9, 15360, v7
v_add_u32 v10, 30720, v8
v_add_u32 v11, 46080, v7
s_lshl_b32 s70, s59, 18
s_lshl_b32 s71, s58, 16
s_add_u32 s68, s70, s71
s_sub_u32 s69, s70, s71
s_add_u32 s69, s69, 196608
s_mov_b32 s67, 128
s_lshl_b32 s75, s58, 13
s_mov_b32 s65, 86016
s_lshr_b32 s70, s59, 3
s_lshl1_add_u32 s70, s59, s70
s_lshr_b32 s71, s60, 2
s_lshl2_add_u32 s71, s60, s71
s_add_u32 s70, s70, s71
s_and_b32 s64, s70, 15
s_mul_i32 s70, s64, s67
s_add_u32 m0, s65, s75
s_add_u32 s71, s70, s68
buffer_load_dwordx4 v8, s[8:11], s71 offen offset:0 sc1 lds
buffer_load_dwordx4 v9, s[8:11], s71 offen offset:1024 sc1 lds
buffer_load_dwordx4 v10, s[8:11], s71 offen offset:2048 sc1 lds
buffer_load_dwordx4 v11, s[8:11], s71 offen offset:3072 sc1 lds
s_add_u32 m0, m0, 4096
s_add_u32 s71, s70, s69
buffer_load_dwordx4 v8, s[8:11], s71 offen offset:0 sc1 lds
buffer_load_dwordx4 v9, s[8:11], s71 offen offset:1024 sc1 lds
buffer_load_dwordx4 v10, s[8:11], s71 offen offset:2048 sc1 lds
buffer_load_dwordx4 v11, s[8:11], s71 offen offset:3072 sc1 lds
v_and_b32 v7, 2, v6
v_xor_b32 v7, v7, v22
v_mul_u32_u24 v6, 6144, v6
v_lshl_add_u32 v12, v7, 4, v6
v_xor_b32 v6, 64, v12
v_add_u32 v13, 48128, v6
v_add_u32 v14, 96256, v12
v_add_u32 v15, 144384, v6
s_mul_i32 s76, s58, 12288
s_add_u32 s76, s76, 16384
s_lshl_b32 s70, s60, 7
s_cmp_eq_u32 s58, 0
s_mov_b32 s71, 198656
s_cselect_b32 s72, 0, s71
s_mov_b32 s71, 4096
s_cselect_b32 s73, 196608, s71
s_mov_b32 s71, 200704
s_cselect_b32 s74, 2048, s71
s_add_u32 s72, s72, s70
s_add_u32 s73, s73, s70
s_add_u32 s74, s74, s70
s_mul_i32 s70, s64, 393216
s_add_u32 m0, s65, s76
s_add_u32 s71, s70, s72
buffer_load_dwordx4 v12, s[12:15], s71 offen offset:0 lds
buffer_load_dwordx4 v13, s[12:15], s71 offen offset:1024 lds
buffer_load_dwordx4 v14, s[12:15], s71 offen offset:2048 lds
buffer_load_dwordx4 v15, s[12:15], s71 offen offset:3072 lds
s_add_u32 m0, m0, 4096
s_add_u32 s71, s70, s73
buffer_load_dwordx4 v12, s[12:15], s71 offen offset:0 lds
buffer_load_dwordx4 v13, s[12:15], s71 offen offset:1024 lds
buffer_load_dwordx4 v14, s[12:15], s71 offen offset:2048 lds
buffer_load_dwordx4 v15, s[12:15], s71 offen offset:3072 lds
s_add_u32 m0, m0, 4096
s_add_u32 s71, s70, s74
buffer_load_dwordx4 v12, s[12:15], s71 offen offset:0 lds
buffer_load_dwordx4 v13, s[12:15], s71 offen offset:1024 lds
buffer_load_dwordx4 v14, s[12:15], s71 offen offset:2048 lds
buffer_load_dwordx4 v15, s[12:15], s71 offen offset:3072 lds
s_add_u32 s64, s64, 1
s_and_b32 s64, s64, 15
s_sub_u32 s65, s65, 40960
s_cselect_b32 s65, 86016, s65
v_and_b32 v1, 3, v0
v_lshlrev_b32 v1, 2, v1
v_and_b32 v2, 4, v1
s_lshl2_add_u32 s35, s58, 16
v_mov_b32 v3, s35
v_lshlrev_b32 v20, 4, v0
v_lshrrev_b32 v6, 2, v0
v_lshl_add_u32 v21, v6, 7, v1
v_lshrrev_b32 v6, 3, v0
v_lshlrev_b32 v23, 1, v23
v_xor_b32 v23, v23, v22
v_lshlrev_b32 v23, 4, v23
v_lshl_add_u32 v23, v6, 11, v23
s_lshl_b32 s70, s62, 7
s_lshl_b32 s71, s58, 16
s_add_u32 s70, s70, s71
v_add_u32 v16, s70, v23
v_add_u32 v17, 15360, v16
v_add_u32 v18, 30720, v16
v_add_u32 v19, 46080, v16
s_add_u32 s77, s61, s62
s_lshl_b32 s77, s77, 17
s_lshl_b32 s78, s58, 12
s_mov_b32 s66, -2
s_barrier
.p2align 4
lq_1:
s_add_u32 s35, s66, 1
lw_4:
ds_read_b32 v5, v1 offset:0
s_waitcnt lgkmcnt(0)
v_cmp_gt_i32 vcc, s35, v5
s_cbranch_vccz lwd_5
s_sub_u32 s32, s32, 1
s_cmp_gt_i32 s32, 0
s_cbranch_scc1 lw_4
lwd_5:
s_cmp_eq_u32 s66, 0
s_cbranch_scc1 lcs_2
lcb_3:
s_mul_i32 s70, s64, s67
s_add_u32 m0, s65, s75
s_add_u32 s71, s70, s68
buffer_load_dwordx4 v8, s[8:11], s71 offen offset:0 sc1 lds
buffer_load_dwordx4 v9, s[8:11], s71 offen offset:1024 sc1 lds
buffer_load_dwordx4 v10, s[8:11], s71 offen offset:2048 sc1 lds
buffer_load_dwordx4 v11, s[8:11], s71 offen offset:3072 sc1 lds
s_add_u32 m0, m0, 4096
s_add_u32 s71, s70, s69
buffer_load_dwordx4 v8, s[8:11], s71 offen offset:0 sc1 lds
buffer_load_dwordx4 v9, s[8:11], s71 offen offset:1024 sc1 lds
buffer_load_dwordx4 v10, s[8:11], s71 offen offset:2048 sc1 lds
buffer_load_dwordx4 v11, s[8:11], s71 offen offset:3072 sc1 lds
s_mul_i32 s70, s64, 393216
s_add_u32 m0, s65, s76
s_add_u32 s71, s70, s72
buffer_load_dwordx4 v12, s[12:15], s71 offen offset:0 lds
buffer_load_dwordx4 v13, s[12:15], s71 offen offset:1024 lds
buffer_load_dwordx4 v14, s[12:15], s71 offen offset:2048 lds
buffer_load_dwordx4 v15, s[12:15], s71 offen offset:3072 lds
v_add_u32 v5, s66, 3
s_mov_b64 exec, 1
s_waitcnt vmcnt(12)
ds_write_b32 v3, v5
s_mov_b64 exec, -1
s_mul_i32 s70, s64, 393216
s_add_u32 m0, m0, 4096
s_add_u32 s71, s70, s73
buffer_load_dwordx4 v12, s[12:15], s71 offen offset:0 lds
buffer_load_dwordx4 v13, s[12:15], s71 offen offset:1024 lds
buffer_load_dwordx4 v14, s[12:15], s71 offen offset:2048 lds
buffer_load_dwordx4 v15, s[12:15], s71 offen offset:3072 lds
s_add_u32 m0, m0, 4096
s_add_u32 s71, s70, s74
buffer_load_dwordx4 v12, s[12:15], s71 offen offset:0 lds
buffer_load_dwordx4 v13, s[12:15], s71 offen offset:1024 lds
buffer_load_dwordx4 v14, s[12:15], s71 offen offset:2048 lds
buffer_load_dwordx4 v15, s[12:15], s71 offen offset:3072 lds
s_add_u32 s64, s64, 1
s_and_b32 s64, s64, 15
s_sub_u32 s65, s65, 40960
s_cselect_b32 s65, 86016, s65
s_add_u32 s66, s66, 1
s_and_b32 s70, s66, 31
s_cmp_eq_u32 s70, 13
s_cbranch_scc0 lq_1
s_waitcnt vmcnt(0)
v_add_u32 v5, s34, 16
s_mov_b64 exec, 1
ds_write_b32 v3, v5
s_mov_b64 exec, -1
s_add_u32 s35, s34, 14
lw_6:
ds_read_b32 v5, v1 offset:0
s_waitcnt lgkmcnt(0)
v_cmp_gt_i32 vcc, s35, v5
s_cbranch_vccz lwd_7
s_sleep 1
s_sub_u32 s32, s32, 1
s_cmp_gt_i32 s32, 0
s_cbranch_scc1 lw_6
lwd_7:
s_add_u32 s70, s77, 262144
s_add_u32 m0, s78, 49152
s_and_b32 s70, s70, 0x1fffff
buffer_load_dwordx4 v16, s[16:19], s70 offen offset:0 lds
buffer_load_dwordx4 v17, s[16:19], s70 offen offset:1024 lds
buffer_load_dwordx4 v18, s[16:19], s70 offen offset:2048 lds
buffer_load_dwordx4 v19, s[16:19], s70 offen offset:3072 lds
s_add_u32 s70, s77, 393216
s_add_u32 m0, s78, 57344
s_and_b32 s70, s70, 0x1fffff
buffer_load_dwordx4 v16, s[16:19], s70 offen offset:0 lds
buffer_load_dwordx4 v17, s[16:19], s70 offen offset:1024 lds
buffer_load_dwordx4 v18, s[16:19], s70 offen offset:2048 lds
buffer_load_dwordx4 v19, s[16:19], s70 offen offset:3072 lds
s_add_u32 s70, s77, 524288
s_add_u32 m0, s78, 65536
s_and_b32 s70, s70, 0x1fffff
buffer_load_dwordx4 v16, s[16:19], s70 offen offset:0 lds
buffer_load_dwordx4 v17, s[16:19], s70 offen offset:1024 lds
buffer_load_dwordx4 v18, s[16:19], s70 offen offset:2048 lds
buffer_load_dwordx4 v19, s[16:19], s70 offen offset:3072 lds
s_add_u32 s70, s77, 655360
s_add_u32 m0, s78, 73728
s_and_b32 s70, s70, 0x1fffff
buffer_load_dwordx4 v16, s[16:19], s70 offen offset:0 lds
buffer_load_dwordx4 v17, s[16:19], s70 offen offset:1024 lds
buffer_load_dwordx4 v18, s[16:19], s70 offen offset:2048 lds
buffer_load_dwordx4 v19, s[16:19], s70 offen offset:3072 lds
s_sub_u32 s70, s59, s58
s_lshl4_add_u32 s70, s70, s60
s_sub_u32 s70, s70, 16
s_lshl_b32 s66, s70, 7
s_add_u32 s66, s66, 294912
s_lshl_b32 s70, s70, 15
s_lshl_b32 s71, s63, 23
s_add_u32 s70, s70, s71
s_add_u32 s64, s70, 1077248
s_mul_i32 s65, s58, -94208
s_add_u32 s35, s34, 16
lw_8:
ds_read_b32 v5, v1 offset:0
s_waitcnt lgkmcnt(0)
v_cmp_gt_i32 vcc, s35, v5
s_cbranch_vccz lwd_9
s_sleep 1
s_sub_u32 s32, s32, 1
s_cmp_gt_i32 s32, 0
s_cbranch_scc1 lw_8
lwd_9:
s_add_u32 s70, s77, 131072
s_add_u32 m0, s78, 40960
s_and_b32 s70, s70, 0x1fffff
buffer_load_dwordx4 v16, s[16:19], s70 offen offset:0 lds
buffer_load_dwordx4 v17, s[16:19], s70 offen offset:1024 lds
buffer_load_dwordx4 v18, s[16:19], s70 offen offset:2048 lds
buffer_load_dwordx4 v19, s[16:19], s70 offen offset:3072 lds
s_add_u32 s70, s77, 786432
s_add_u32 m0, s78, 81920
s_and_b32 s70, s70, 0x1fffff
buffer_load_dwordx4 v16, s[16:19], s70 offen offset:0 lds
buffer_load_dwordx4 v17, s[16:19], s70 offen offset:1024 lds
buffer_load_dwordx4 v18, s[16:19], s70 offen offset:2048 lds
buffer_load_dwordx4 v19, s[16:19], s70 offen offset:3072 lds
s_add_u32 s70, s77, 917504
s_add_u32 m0, s78, 90112
s_and_b32 s70, s70, 0x1fffff
buffer_load_dwordx4 v16, s[16:19], s70 offen offset:0 lds
buffer_load_dwordx4 v17, s[16:19], s70 offen offset:1024 lds
buffer_load_dwordx4 v18, s[16:19], s70 offen offset:2048 lds
buffer_load_dwordx4 v19, s[16:19], s70 offen offset:3072 lds
s_cmp_gt_u32 s59, s58
s_cbranch_scc0 nokv_10
s_add_u32 s35, s34, 17
lw_11:
ds_read_b32 v5, v1 offset:0
s_waitcnt lgkmcnt(0)
v_cmp_gt_i32 vcc, s35, v5
s_cbranch_vccz lwd_12
s_sleep 1
s_sub_u32 s32, s32, 1
s_cmp_gt_i32 s32, 0
s_cbranch_scc1 lw_11
lwd_12:
poll_13:
buffer_load_dword v6, v1, s[24:27], s66 offen sc1
pchk_14:
s_waitcnt vmcnt(0)
v_cmp_eq_u32 vcc, 0, v6
s_cbranch_vccz pdone_15
s_sub_u32 s32, s32, 1
s_cmp_gt_i32 s32, 0
s_cbranch_scc1 poll_13
pdone_15:
s_add_u32 m0, s65, 126976
s_nop 0
buffer_load_dwordx4 v20, s[20:23], s64 offen offset:0 sc1 lds
buffer_load_dwordx4 v20, s[20:23], s64 offen offset:1024 sc1 lds
buffer_load_dwordx4 v20, s[20:23], s64 offen offset:2048 sc1 lds
buffer_load_dwordx4 v20, s[20:23], s64 offen offset:3072 sc1 lds
s_add_u32 m0, s65, 122880
s_sub_u32 s64, s64, 4096
buffer_load_dwordx4 v20, s[20:23], s64 offen offset:0 sc1 lds
buffer_load_dwordx4 v20, s[20:23], s64 offen offset:1024 sc1 lds
buffer_load_dwordx4 v20, s[20:23], s64 offen offset:2048 sc1 lds
buffer_load_dwordx4 v20, s[20:23], s64 offen offset:3072 sc1 lds
s_add_u32 m0, s65, 118784
s_sub_u32 s64, s64, 4096
buffer_load_dwordx4 v20, s[20:23], s64 offen offset:0 sc1 lds
buffer_load_dwordx4 v20, s[20:23], s64 offen offset:1024 sc1 lds
buffer_load_dwordx4 v20, s[20:23], s64 offen offset:2048 sc1 lds
buffer_load_dwordx4 v20, s[20:23], s64 offen offset:3072 sc1 lds
s_add_u32 m0, s65, 114688
s_sub_u32 s64, s64, 4096
buffer_load_dwordx4 v20, s[20:23], s64 offen offset:0 sc1 lds
buffer_load_dwordx4 v20, s[20:23], s64 offen offset:1024 sc1 lds
buffer_load_dwordx4 v20, s[20:23], s64 offen offset:2048 sc1 lds
buffer_load_dwordx4 v20, s[20:23], s64 offen offset:3072 sc1 lds
s_add_u32 m0, s65, 110592
s_sub_u32 s64, s64, 4096
buffer_load_dwordx4 v20, s[20:23], s64 offen offset:0 sc1 lds
buffer_load_dwordx4 v20, s[20:23], s64 offen offset:1024 sc1 lds
buffer_load_dwordx4 v20, s[20:23], s64 offen offset:2048 sc1 lds
buffer_load_dwordx4 v20, s[20:23], s64 offen offset:3072 sc1 lds
s_add_u32 m0, s65, 106496
s_sub_u32 s64, s64, 4096
buffer_load_dwordx4 v20, s[20:23], s64 offen offset:0 sc1 lds
buffer_load_dwordx4 v20, s[20:23], s64 offen offset:1024 sc1 lds
buffer_load_dwordx4 v20, s[20:23], s64 offen offset:2048 sc1 lds
buffer_load_dwordx4 v20, s[20:23], s64 offen offset:3072 sc1 lds
s_add_u32 m0, s65, 102400
s_sub_u32 s64, s64, 4096
buffer_load_dwordx4 v20, s[20:23], s64 offen offset:0 sc1 lds
buffer_load_dwordx4 v20, s[20:23], s64 offen offset:1024 sc1 lds
buffer_load_dwordx4 v20, s[20:23], s64 offen offset:2048 sc1 lds
buffer_load_dwordx4 v20, s[20:23], s64 offen offset:3072 sc1 lds
s_add_u32 m0, s65, 98304
s_sub_u32 s64, s64, 4096
buffer_load_dwordx4 v20, s[20:23], s64 offen offset:0 sc1 lds
buffer_load_dwordx4 v20, s[20:23], s64 offen offset:1024 sc1 lds
buffer_load_dwordx4 v20, s[20:23], s64 offen offset:2048 sc1 lds
buffer_load_dwordx4 v20, s[20:23], s64 offen offset:3072 sc1 lds
s_waitcnt vmcnt(0)
nokv_10:
v_add_u32 v5, s34, 17
s_mov_b64 exec, 1
ds_write_b32 v3, v5
s_mov_b64 exec, -1
s_add_u32 s35, s34, 18
lw_16:
ds_read_b32 v5, v1 offset:0
s_waitcnt lgkmcnt(0)
v_cmp_gt_i32 vcc, s35, v5
s_cbranch_vccz lwd_17
s_sleep 1
s_sub_u32 s32, s32, 1
s_cmp_gt_i32 s32, 0
s_cbranch_scc1 lw_16
lwd_17:
s_add_u32 s70, s77, 1572864
s_add_u32 m0, s78, 131072
s_and_b32 s70, s70, 0x1fffff
buffer_load_dwordx4 v16, s[16:19], s70 offen offset:0 lds
buffer_load_dwordx4 v17, s[16:19], s70 offen offset:1024 lds
buffer_load_dwordx4 v18, s[16:19], s70 offen offset:2048 lds
buffer_load_dwordx4 v19, s[16:19], s70 offen offset:3072 lds
s_add_u32 s70, s77, 1703936
s_add_u32 m0, s78, 139264
s_and_b32 s70, s70, 0x1fffff
buffer_load_dwordx4 v16, s[16:19], s70 offen offset:0 lds
buffer_load_dwordx4 v17, s[16:19], s70 offen offset:1024 lds
buffer_load_dwordx4 v18, s[16:19], s70 offen offset:2048 lds
buffer_load_dwordx4 v19, s[16:19], s70 offen offset:3072 lds
s_add_u32 s70, s77, 1835008
s_add_u32 m0, s78, 147456
s_and_b32 s70, s70, 0x1fffff
buffer_load_dwordx4 v16, s[16:19], s70 offen offset:0 lds
buffer_load_dwordx4 v17, s[16:19], s70 offen offset:1024 lds
buffer_load_dwordx4 v18, s[16:19], s70 offen offset:2048 lds
buffer_load_dwordx4 v19, s[16:19], s70 offen offset:3072 lds
s_add_u32 s70, s77, 1966080
s_add_u32 m0, s78, 155648
s_and_b32 s70, s70, 0x1fffff
buffer_load_dwordx4 v16, s[16:19], s70 offen offset:0 lds
buffer_load_dwordx4 v17, s[16:19], s70 offen offset:1024 lds
buffer_load_dwordx4 v18, s[16:19], s70 offen offset:2048 lds
buffer_load_dwordx4 v19, s[16:19], s70 offen offset:3072 lds
s_add_u32 s35, s34, 19
lw_18:
ds_read_b32 v5, v1 offset:0
s_waitcnt lgkmcnt(0)
v_cmp_gt_i32 vcc, s35, v5
s_cbranch_vccz lwd_19
s_sleep 2
s_sub_u32 s32, s32, 1
s_cmp_gt_i32 s32, 0
s_cbranch_scc1 lw_18
lwd_19:
s_add_u32 s70, s77, 1048576
s_add_u32 m0, s78, 98304
s_and_b32 s70, s70, 0x1fffff
buffer_load_dwordx4 v16, s[16:19], s70 offen offset:0 lds
buffer_load_dwordx4 v17, s[16:19], s70 offen offset:1024 lds
buffer_load_dwordx4 v18, s[16:19], s70 offen offset:2048 lds
buffer_load_dwordx4 v19, s[16:19], s70 offen offset:3072 lds
s_add_u32 s70, s77, 1179648
s_add_u32 m0, s78, 106496
s_and_b32 s70, s70, 0x1fffff
buffer_load_dwordx4 v16, s[16:19], s70 offen offset:0 lds
buffer_load_dwordx4 v17, s[16:19], s70 offen offset:1024 lds
buffer_load_dwordx4 v18, s[16:19], s70 offen offset:2048 lds
buffer_load_dwordx4 v19, s[16:19], s70 offen offset:3072 lds
s_add_u32 s70, s77, 1310720
s_add_u32 m0, s78, 114688
s_and_b32 s70, s70, 0x1fffff
buffer_load_dwordx4 v16, s[16:19], s70 offen offset:0 lds
buffer_load_dwordx4 v17, s[16:19], s70 offen offset:1024 lds
buffer_load_dwordx4 v18, s[16:19], s70 offen offset:2048 lds
buffer_load_dwordx4 v19, s[16:19], s70 offen offset:3072 lds
s_add_u32 s70, s77, 1441792
s_add_u32 m0, s78, 122880
s_and_b32 s70, s70, 0x1fffff
buffer_load_dwordx4 v16, s[16:19], s70 offen offset:0 lds
buffer_load_dwordx4 v17, s[16:19], s70 offen offset:1024 lds
buffer_load_dwordx4 v18, s[16:19], s70 offen offset:2048 lds
buffer_load_dwordx4 v19, s[16:19], s70 offen offset:3072 lds
s_add_u32 s35, s34, 20
lw_20:
ds_read_b32 v5, v1 offset:0
s_waitcnt lgkmcnt(0)
v_cmp_gt_i32 vcc, s35, v5
s_cbranch_vccz lwd_21
s_sleep 2
s_sub_u32 s32, s32, 1
s_cmp_gt_i32 s32, 0
s_cbranch_scc1 lw_20
lwd_21:
s_add_u32 s70, s77, 0
s_add_u32 m0, s78, 32768
s_and_b32 s70, s70, 0x1fffff
buffer_load_dwordx4 v16, s[16:19], s70 offen offset:0 lds
buffer_load_dwordx4 v17, s[16:19], s70 offen offset:1024 lds
buffer_load_dwordx4 v18, s[16:19], s70 offen offset:2048 lds
buffer_load_dwordx4 v19, s[16:19], s70 offen offset:3072 lds
s_lshl_b32 s66, s61, 11
s_add_u32 s66, s66, 327680
s_cmp_eq_u32 s58, 0
s_cbranch_scc0 nofo_22
s_add_u32 s35, s34, 21
lw_23:
ds_read_b32 v5, v1 offset:0
s_waitcnt lgkmcnt(0)
v_cmp_gt_i32 vcc, s35, v5
s_cbranch_vccz lwd_24
s_sleep 1
s_sub_u32 s32, s32, 1
s_cmp_gt_i32 s32, 0
s_cbranch_scc1 lw_23
lwd_24:
poll_25:
buffer_load_dword v6, v21, s[24:27], s66 offen sc1
pchk_26:
s_waitcnt vmcnt(0)
v_cmp_eq_u32 vcc, 0, v6
s_cbranch_vccz pdone_27
s_sub_u32 s32, s32, 1
s_cmp_gt_i32 s32, 0
s_cbranch_scc1 poll_25
pdone_27:
nofo_22:
s_waitcnt vmcnt(0)
v_add_u32 v5, s34, 18
s_mov_b64 exec, 1
ds_write_b32 v3, v5
s_mov_b64 exec, -1
s_cmp_eq_u32 s63, 0
s_cbranch_scc0 L_end
v_bfe_u32 v6, v0, 3, 2
v_and_b32 v7, 2, v6
v_xor_b32 v7, v7, v22
v_lshrrev_b32 v23, 5, v0
v_lshl_add_u32 v6, v23, 4, v6
v_mul_u32_u24 v6, 6144, v6
v_lshl_add_u32 v12, v7, 4, v6
v_xor_b32 v6, 64, v12
v_add_u32 v13, 23552, v6
v_add_u32 v14, 47104, v12
v_add_u32 v15, 70656, v6
v_mov_b32 v8, v20
v_mov_b32 v9, v20
v_mov_b32 v10, v20
v_mov_b32 v11, v20
s_mov_b32 s8, s56
s_mov_b32 s9, s57
s_mov_b32 s10, 0x2300000
s_mov_b32 s11, 0x00020000
s_lshl_b32 s70, s59, 18
s_add_u32 s70, s70, 26214400
s_add_u32 s68, s70, s78
s_sub_u32 s69, s70, s78
s_add_u32 s69, s69, 12288
s_mov_b32 s67, 16384
s_lshl_b32 s66, s59, 11
s_add_u32 s66, s66, 360448
s_and_b32 s64, s61, 14
s_mov_b32 s65, 86016
s_add_u32 s35, s34, 22
lw_28:
ds_read_b32 v5, v1 offset:0
s_waitcnt lgkmcnt(0)
v_cmp_gt_i32 vcc, s35, v5
s_cbranch_vccz lwd_29
s_sleep 2
s_sub_u32 s32, s32, 1
s_cmp_gt_i32 s32, 0
s_cbranch_scc1 lw_28
lwd_29:
s_mul_i32 s70, s64, 393216
s_add_u32 m0, s65, s76
s_add_u32 s71, s70, s72
buffer_load_dwordx4 v12, s[12:15], s71 offen offset:0 lds
buffer_load_dwordx4 v13, s[12:15], s71 offen offset:1024 lds
buffer_load_dwordx4 v14, s[12:15], s71 offen offset:2048 lds
buffer_load_dwordx4 v15, s[12:15], s71 offen offset:3072 lds
s_add_u32 m0, m0, 4096
s_add_u32 s71, s70, s73
buffer_load_dwordx4 v12, s[12:15], s71 offen offset:0 lds
buffer_load_dwordx4 v13, s[12:15], s71 offen offset:1024 lds
buffer_load_dwordx4 v14, s[12:15], s71 offen offset:2048 lds
buffer_load_dwordx4 v15, s[12:15], s71 offen offset:3072 lds
s_add_u32 m0, m0, 4096
s_add_u32 s71, s70, s74
buffer_load_dwordx4 v12, s[12:15], s71 offen offset:0 lds
buffer_load_dwordx4 v13, s[12:15], s71 offen offset:1024 lds
buffer_load_dwordx4 v14, s[12:15], s71 offen offset:2048 lds
buffer_load_dwordx4 v15, s[12:15], s71 offen offset:3072 lds
s_add_u32 s64, s64, 1
s_and_b32 s64, s64, 15
s_sub_u32 s65, s65, 40960
s_cselect_b32 s65, 86016, s65
s_mul_i32 s70, s64, 393216
s_add_u32 m0, s65, s76
s_add_u32 s71, s70, s72
buffer_load_dwordx4 v12, s[12:15], s71 offen offset:0 lds
buffer_load_dwordx4 v13, s[12:15], s71 offen offset:1024 lds
buffer_load_dwordx4 v14, s[12:15], s71 offen offset:2048 lds
buffer_load_dwordx4 v15, s[12:15], s71 offen offset:3072 lds
s_add_u32 m0, m0, 4096
s_add_u32 s71, s70, s73
buffer_load_dwordx4 v12, s[12:15], s71 offen offset:0 lds
buffer_load_dwordx4 v13, s[12:15], s71 offen offset:1024 lds
buffer_load_dwordx4 v14, s[12:15], s71 offen offset:2048 lds
buffer_load_dwordx4 v15, s[12:15], s71 offen offset:3072 lds
s_add_u32 m0, m0, 4096
s_add_u32 s71, s70, s74
buffer_load_dwordx4 v12, s[12:15], s71 offen offset:0 lds
buffer_load_dwordx4 v13, s[12:15], s71 offen offset:1024 lds
buffer_load_dwordx4 v14, s[12:15], s71 offen offset:2048 lds
buffer_load_dwordx4 v15, s[12:15], s71 offen offset:3072 lds
s_add_u32 s64, s64, 1
s_and_b32 s64, s64, 15
s_sub_u32 s65, s65, 40960
s_cselect_b32 s65, 86016, s65
s_mul_i32 s70, s64, 393216
s_add_u32 m0, s65, s76
s_add_u32 s71, s70, s72
buffer_load_dwordx4 v12, s[12:15], s71 offen offset:0 lds
buffer_load_dwordx4 v13, s[12:15], s71 offen offset:1024 lds
buffer_load_dwordx4 v14, s[12:15], s71 offen offset:2048 lds
buffer_load_dwordx4 v15, s[12:15], s71 offen offset:3072 lds
s_add_u32 m0, m0, 4096
s_add_u32 s71, s70, s73
buffer_load_dwordx4 v12, s[12:15], s71 offen offset:0 lds
buffer_load_dwordx4 v13, s[12:15], s71 offen offset:1024 lds
buffer_load_dwordx4 v14, s[12:15], s71 offen offset:2048 lds
buffer_load_dwordx4 v15, s[12:15], s71 offen offset:3072 lds
s_add_u32 m0, m0, 4096
s_add_u32 s71, s70, s74
buffer_load_dwordx4 v12, s[12:15], s71 offen offset:0 lds
buffer_load_dwordx4 v13, s[12:15], s71 offen offset:1024 lds
buffer_load_dwordx4 v14, s[12:15], s71 offen offset:2048 lds
buffer_load_dwordx4 v15, s[12:15], s71 offen offset:3072 lds
s_add_u32 s64, s64, 1
s_and_b32 s64, s64, 15
s_sub_u32 s65, s65, 40960
s_cselect_b32 s65, 86016, s65
s_mov_b32 s64, s59
s_mov_b32 s65, 114688
s_mul_i32 s70, s64, 393216
s_add_u32 m0, s65, s76
s_add_u32 s71, s70, s72
buffer_load_dwordx4 v12, s[12:15], s71 offen offset:0 lds
buffer_load_dwordx4 v13, s[12:15], s71 offen offset:1024 lds
buffer_load_dwordx4 v14, s[12:15], s71 offen offset:2048 lds
buffer_load_dwordx4 v15, s[12:15], s71 offen offset:3072 lds
s_add_u32 m0, m0, 4096
s_add_u32 s71, s70, s73
buffer_load_dwordx4 v12, s[12:15], s71 offen offset:0 lds
buffer_load_dwordx4 v13, s[12:15], s71 offen offset:1024 lds
buffer_load_dwordx4 v14, s[12:15], s71 offen offset:2048 lds
buffer_load_dwordx4 v15, s[12:15], s71 offen offset:3072 lds
s_add_u32 m0, m0, 4096
s_add_u32 s71, s70, s74
buffer_load_dwordx4 v12, s[12:15], s71 offen offset:0 lds
buffer_load_dwordx4 v13, s[12:15], s71 offen offset:1024 lds
buffer_load_dwordx4 v14, s[12:15], s71 offen offset:2048 lds
buffer_load_dwordx4 v15, s[12:15], s71 offen offset:3072 lds
s_and_b32 s64, s61, 14
s_mov_b32 s65, 86016
s_add_u32 s35, s34, 23
lw_30:
ds_read_b32 v5, v1 offset:0
s_waitcnt lgkmcnt(0)
v_cmp_gt_i32 vcc, s35, v5
s_cbranch_vccz lwd_31
s_sleep 1
s_sub_u32 s32, s32, 1
s_cmp_gt_i32 s32, 0
s_cbranch_scc1 lw_30
lwd_31:
poll_32:
buffer_load_dword v6, v21, s[24:27], s66 offen sc1
pchk_33:
s_waitcnt vmcnt(0)
v_cmp_eq_u32 vcc, 0, v6
s_cbranch_vccz pdone_34
s_sub_u32 s32, s32, 1
s_cmp_gt_i32 s32, 0
s_cbranch_scc1 poll_32
pdone_34:
s_mul_i32 s70, s64, s67
s_add_u32 m0, s65, s75
s_add_u32 s71, s70, s68
buffer_load_dwordx4 v8, s[8:11], s71 offen offset:0 sc1 lds
buffer_load_dwordx4 v9, s[8:11], s71 offen offset:1024 sc1 lds
buffer_load_dwordx4 v10, s[8:11], s71 offen offset:2048 sc1 lds
buffer_load_dwordx4 v11, s[8:11], s71 offen offset:3072 sc1 lds
s_add_u32 m0, m0, 4096
s_add_u32 s71, s70, s69
buffer_load_dwordx4 v8, s[8:11], s71 offen offset:0 sc1 lds
buffer_load_dwordx4 v9, s[8:11], s71 offen offset:1024 sc1 lds
buffer_load_dwordx4 v10, s[8:11], s71 offen offset:2048 sc1 lds
buffer_load_dwordx4 v11, s[8:11], s71 offen offset:3072 sc1 lds
s_add_u32 s64, s64, 1
s_and_b32 s64, s64, 15
s_sub_u32 s65, s65, 40960
s_cselect_b32 s65, 86016, s65
s_mul_i32 s70, s64, s67
s_add_u32 m0, s65, s75
s_add_u32 s71, s70, s68
buffer_load_dwordx4 v8, s[8:11], s71 offen offset:0 sc1 lds
buffer_load_dwordx4 v9, s[8:11], s71 offen offset:1024 sc1 lds
buffer_load_dwordx4 v10, s[8:11], s71 offen offset:2048 sc1 lds
buffer_load_dwordx4 v11, s[8:11], s71 offen offset:3072 sc1 lds
s_add_u32 m0, m0, 4096
s_add_u32 s71, s70, s69
buffer_load_dwordx4 v8, s[8:11], s71 offen offset:0 sc1 lds
buffer_load_dwordx4 v9, s[8:11], s71 offen offset:1024 sc1 lds
buffer_load_dwordx4 v10, s[8:11], s71 offen offset:2048 sc1 lds
buffer_load_dwordx4 v11, s[8:11], s71 offen offset:3072 sc1 lds
s_add_u32 s64, s64, 1
s_and_b32 s64, s64, 15
s_sub_u32 s65, s65, 40960
s_cselect_b32 s65, 86016, s65
s_mul_i32 s70, s64, s67
s_add_u32 m0, s65, s75
s_add_u32 s71, s70, s68
buffer_load_dwordx4 v8, s[8:11], s71 offen offset:0 sc1 lds
buffer_load_dwordx4 v9, s[8:11], s71 offen offset:1024 sc1 lds
buffer_load_dwordx4 v10, s[8:11], s71 offen offset:2048 sc1 lds
buffer_load_dwordx4 v11, s[8:11], s71 offen offset:3072 sc1 lds
s_add_u32 m0, m0, 4096
s_add_u32 s71, s70, s69
buffer_load_dwordx4 v8, s[8:11], s71 offen offset:0 sc1 lds
buffer_load_dwordx4 v9, s[8:11], s71 offen offset:1024 sc1 lds
buffer_load_dwordx4 v10, s[8:11], s71 offen offset:2048 sc1 lds
buffer_load_dwordx4 v11, s[8:11], s71 offen offset:3072 sc1 lds
s_add_u32 s64, s64, 1
s_and_b32 s64, s64, 15
s_sub_u32 s65, s65, 40960
s_cselect_b32 s65, 86016, s65
s_mov_b32 s63, 1
s_mov_b32 s34, 32
s_add_u32 s24, s24, 2359296
s_addc_u32 s25, s25, 0
s_mov_b32 s26, 2359296
s_waitcnt vmcnt(16)
v_add_u32 v5, s34, 1
s_mov_b64 exec, 1
ds_write_b32 v3, v5
s_mov_b64 exec, -1
s_waitcnt vmcnt(8)
v_add_u32 v5, s34, 2
s_mov_b64 exec, 1
ds_write_b32 v3, v5
s_mov_b64 exec, -1
s_mov_b32 s66, 32
s_branch lq_1
lcs_2:
s_add_u32 s35, s34, 1
lw_35:
ds_read_b32 v5, v2 offset:24
s_waitcnt lgkmcnt(0)
v_cmp_gt_i32 vcc, s35, v5
s_cbranch_vccz lwd_36
s_sub_u32 s32, s32, 1
s_cmp_gt_i32 s32, 0
s_cbranch_scc1 lw_35
lwd_36:
s_branch lcb_3
L_f:
v_lshlrev_b32 v6, 4, v0
s_cmp_eq_u32 s58, 0
s_cbranch_scc0 fz_37
v_mov_b32 v16, 0
v_mov_b32 v17, 0
v_mov_b32 v18, 0
v_mov_b32 v19, 0
s_mul_i32 s70, s2, 18432
buffer_store_dwordx4 v[16:19], v6, s[24:27], s70 offen offset:0 sc1
buffer_store_dwordx4 v[16:19], v6, s[24:27], s70 offen offset:1024 sc1
buffer_store_dwordx4 v[16:19], v6, s[24:27], s70 offen offset:2048 sc1
buffer_store_dwordx4 v[16:19], v6, s[24:27], s70 offen offset:3072 sc1
s_add_u32 s70, s70, 4096
buffer_store_dwordx4 v[16:19], v6, s[24:27], s70 offen offset:0 sc1
buffer_store_dwordx4 v[16:19], v6, s[24:27], s70 offen offset:1024 sc1
buffer_store_dwordx4 v[16:19], v6, s[24:27], s70 offen offset:2048 sc1
buffer_store_dwordx4 v[16:19], v6, s[24:27], s70 offen offset:3072 sc1
s_add_u32 s70, s70, 4096
buffer_store_dwordx4 v[16:19], v6, s[24:27], s70 offen offset:0 sc1
buffer_store_dwordx4 v[16:19], v6, s[24:27], s70 offen offset:1024 sc1
buffer_store_dwordx4 v[16:19], v6, s[24:27], s70 offen offset:2048 sc1
buffer_store_dwordx4 v[16:19], v6, s[24:27], s70 offen offset:3072 sc1
s_add_u32 s70, s70, 4096
buffer_store_dwordx4 v[16:19], v6, s[24:27], s70 offen offset:0 sc1
buffer_store_dwordx4 v[16:19], v6, s[24:27], s70 offen offset:1024 sc1
buffer_store_dwordx4 v[16:19], v6, s[24:27], s70 offen offset:2048 sc1
buffer_store_dwordx4 v[16:19], v6, s[24:27], s70 offen offset:3072 sc1
s_add_u32 s70, s70, 4096
buffer_store_dwordx4 v[16:19], v6, s[24:27], s70 offen offset:0 sc1
buffer_store_dwordx4 v[16:19], v6, s[24:27], s70 offen offset:1024 sc1
fz_37:
v_and_b32 v1, 3, v0
v_lshlrev_b32 v1, 2, v1
v_and_b32 v2, 4, v1
s_lshl2_add_u32 s35, s58, 24
v_mov_b32 v3, s35
s_mov_b32 s4, s54
s_mov_b32 s5, s55
s_mov_b32 s6, 0x100
s_mov_b32 s7, 0x00020000
s_and_b32 s70, s2, 7
s_lshr_b32 s71, s2, 3
s_mul_i32 s64, s70, 28
s_add_u32 s64, s64, s71
s_lshl_b32 s65, s70, 5
s_add_u32 s65, s65, s71
s_and_b32 s66, s71, 3
s_mov_b32 s69, 0x3f803f80
v_mov_b32 v8, s69
v_mov_b32 v9, s69
v_mov_b32 v10, s69
v_mov_b32 v11, s69
v_mov_b32 v12, s69
v_mov_b32 v13, s69
v_mov_b32 v14, s69
v_mov_b32 v15, s69
s_barrier
s_and_b32 s70, s2, 3
s_lshl_b32 s70, s70, 6
v_mov_b32 v7, 1
s_sub_u32 exec_lo, 1, s58
s_mov_b32 exec_hi, 0
s_waitcnt vmcnt(0)
buffer_atomic_add v7, off, s[4:7], s70 sc1
s_mov_b64 exec, -1
s_mov_b32 s70, 102400
ftop_38:
v_lshrrev_b32 v6, 4, v0
v_bfe_u32 v7, v0, 2, 2
v_lshl_add_u32 v6, v6, 3, v7
v_bfe_u32 v7, v0, 3, 2
s_lshl_b32 s71, s58, 1
v_xor_b32 v7, s71, v7
v_lshl_add_u32 v7, v7, 5, s70
v_lshl_add_u32 v6, v6, 7, v7
v_lshl_add_u32 v6, v1, 1, v6
v_xor_b32 v7, 32, v6
v_mov_b32 v16, 0
v_mov_b32 v17, 0
v_mov_b32 v18, 0
v_mov_b32 v19, 0
v_mov_b32 v20, 0
v_mov_b32 v21, 0
v_mov_b32 v22, 0
v_mov_b32 v23, 0
s_add_u32 s35, s34, 1
lw_39:
ds_read_b32 v5, v2 offset:16
s_waitcnt lgkmcnt(0)
v_cmp_gt_i32 vcc, s35, v5
s_cbranch_vccz lwd_40
s_sleep 1
s_sub_u32 s32, s32, 1
s_cmp_gt_i32 s32, 0
s_cbranch_scc1 lw_39
lwd_40:
ds_read_b64_tr_b16 v[24:25], v6 offset:0
ds_read_b64_tr_b16 v[26:27], v6 offset:512
ds_read_b64_tr_b16 v[28:29], v6 offset:4096
ds_read_b64_tr_b16 v[30:31], v6 offset:4608
ds_read_b64_tr_b16 v[32:33], v7 offset:0
ds_read_b64_tr_b16 v[34:35], v7 offset:512
ds_read_b64_tr_b16 v[36:37], v7 offset:4096
ds_read_b64_tr_b16 v[38:39], v7 offset:4608
ds_read_b64_tr_b16 v[40:41], v6 offset:8192
ds_read_b64_tr_b16 v[42:43], v6 offset:8704
ds_read_b64_tr_b16 v[44:45], v6 offset:12288
ds_read_b64_tr_b16 v[46:47], v6 offset:12800
ds_read_b64_tr_b16 v[48:49], v7 offset:8192
ds_read_b64_tr_b16 v[50:51], v7 offset:8704
ds_read_b64_tr_b16 v[52:53], v7 offset:12288
ds_read_b64_tr_b16 v[54:55], v7 offset:12800
v_dot2c_f32_bf16 v22, s69, v8
v_dot2c_f32_bf16 v23, v8, v8
v_dot2c_f32_bf16 v22, s69, v9
v_dot2c_f32_bf16 v23, v9, v9
v_dot2c_f32_bf16 v22, s69, v10
v_dot2c_f32_bf16 v23, v10, v10
v_dot2c_f32_bf16 v22, s69, v11
v_dot2c_f32_bf16 v23, v11, v11
v_dot2c_f32_bf16 v22, s69, v12
v_dot2c_f32_bf16 v23, v12, v12
v_dot2c_f32_bf16 v22, s69, v13
v_dot2c_f32_bf16 v23, v13, v13
v_dot2c_f32_bf16 v22, s69, v14
v_dot2c_f32_bf16 v23, v14, v14
v_dot2c_f32_bf16 v22, s69, v15
v_dot2c_f32_bf16 v23, v15, v15
s_waitcnt lgkmcnt(14)
v_dot2c_f32_bf16 v16, v8, v24
s_waitcnt lgkmcnt(11)
v_dot2c_f32_bf16 v17, v8, v32
v_dot2c_f32_bf16 v16, v9, v25
v_dot2c_f32_bf16 v17, v9, v33
v_dot2c_f32_bf16 v16, v10, v26
s_waitcnt lgkmcnt(10)
v_dot2c_f32_bf16 v17, v10, v34
v_dot2c_f32_bf16 v16, v11, v27
v_dot2c_f32_bf16 v17, v11, v35
v_dot2c_f32_bf16 v16, v12, v28
s_waitcnt lgkmcnt(9)
v_dot2c_f32_bf16 v17, v12, v36
v_dot2c_f32_bf16 v16, v13, v29
v_dot2c_f32_bf16 v17, v13, v37
v_dot2c_f32_bf16 v16, v14, v30
s_waitcnt lgkmcnt(8)
v_dot2c_f32_bf16 v17, v14, v38
v_dot2c_f32_bf16 v16, v15, v31
v_dot2c_f32_bf16 v17, v15, v39
ds_read_b64_tr_b16 v[24:25], v6 offset:16384
ds_read_b64_tr_b16 v[26:27], v6 offset:16896
ds_read_b64_tr_b16 v[28:29], v6 offset:20480
ds_read_b64_tr_b16 v[30:31], v6 offset:20992
ds_read_b64_tr_b16 v[32:33], v7 offset:16384
ds_read_b64_tr_b16 v[34:35], v7 offset:16896
ds_read_b64_tr_b16 v[36:37], v7 offset:20480
ds_read_b64_tr_b16 v[38:39], v7 offset:20992
v_add_u32 v5, s34, 1
s_mov_b64 exec, 1
ds_write_b32 v3, v5
s_mov_b64 exec, -1
s_waitcnt lgkmcnt(14)
v_dot2c_f32_bf16 v18, v8, v40
s_waitcnt lgkmcnt(12)
v_dot2c_f32_bf16 v19, v8, v48
v_dot2c_f32_bf16 v18, v9, v41
v_dot2c_f32_bf16 v19, v9, v49
v_dot2c_f32_bf16 v18, v10, v42
s_waitcnt lgkmcnt(11)
v_dot2c_f32_bf16 v19, v10, v50
v_dot2c_f32_bf16 v18, v11, v43
v_dot2c_f32_bf16 v19, v11, v51
v_dot2c_f32_bf16 v18, v12, v44
s_waitcnt lgkmcnt(10)
v_dot2c_f32_bf16 v19, v12, v52
v_dot2c_f32_bf16 v18, v13, v45
v_dot2c_f32_bf16 v19, v13, v53
v_dot2c_f32_bf16 v18, v14, v46
s_waitcnt lgkmcnt(9)
v_dot2c_f32_bf16 v19, v14, v54
v_dot2c_f32_bf16 v18, v15, v47
v_dot2c_f32_bf16 v19, v15, v55
s_waitcnt lgkmcnt(8)
v_dot2c_f32_bf16 v20, v8, v24
s_waitcnt lgkmcnt(4)
v_dot2c_f32_bf16 v21, v8, v32
v_dot2c_f32_bf16 v20, v9, v25
v_dot2c_f32_bf16 v21, v9, v33
v_dot2c_f32_bf16 v20, v10, v26
s_waitcnt lgkmcnt(3)
v_dot2c_f32_bf16 v21, v10, v34
v_dot2c_f32_bf16 v20, v11, v27
v_dot2c_f32_bf16 v21, v11, v35
v_dot2c_f32_bf16 v20, v12, v28
s_waitcnt lgkmcnt(2)
v_dot2c_f32_bf16 v21, v12, v36
v_dot2c_f32_bf16 v20, v13, v29
v_dot2c_f32_bf16 v21, v13, v37
v_dot2c_f32_bf16 v20, v14, v30
s_waitcnt lgkmcnt(1)
v_dot2c_f32_bf16 v21, v14, v38
v_dot2c_f32_bf16 v20, v15, v31
v_dot2c_f32_bf16 v21, v15, v39
s_lshl_b32 s72, s60, 14
s_lshl_b32 s70, s58, 9
s_add_u32 s72, s72, s70
s_lshl_b32 s70, s59, 10
s_add_u32 s71, s72, s70
v_lshlrev_b32 v6, 3, v0
v_permlane32_swap_b32 v16, v20
v_permlane32_swap_b32 v17, v21
v_permlane32_swap_b32 v18, v22
v_permlane32_swap_b32 v19, v23
v_pk_add_f32 v[16:17], v[16:17], v[20:21]
v_pk_add_f32 v[18:19], v[18:19], v[22:23]
s_nop 1
v_permlane16_swap_b32 v16, v18
v_permlane16_swap_b32 v17, v19
v_pk_add_f32 v[16:17], v[16:17], v[18:19]
s_lshl_b32 s76, s59, 11
s_add_u32 s76, s76, 262144
v_max_u32 v16, 1, v16
v_max_u32 v17, 1, v17
s_cmp_eq_u32 s63, 0
s_cbranch_scc1 fst_41
fsb_42:
buffer_store_dwordx2 v[16:17], v6, s[24:27], s71 offen sc1
s_add_u32 s73, s72, 4096
s_add_u32 s74, s72, 8192
s_add_u32 s75, s72, 12288
v_lshrrev_b32 v7, 2, v0
v_lshlrev_b32 v7, 7, v7
v_lshl_add_u32 v7, v1, 2, v7
v_lshrrev_b32 v8, 5, v0
v_lshrrev_b32 v9, 4, v0
v_xor_b32 v10, v8, v9
v_and_b32 v10, 1, v10
v_lshl_add_u32 v8, v10, 1, v8
v_and_b32 v10, 15, v0
v_lshlrev_b32 v8, 7, v8
v_lshl_add_u32 v8, v10, 3, v8
v_add_u32 v8, 1280, v8
s_mul_i32 s70, s58, 384
s_lshl_b32 s71, s63, 10
s_add_u32 s70, s70, s71
s_add_u32 s70, s70, 2304
v_lshl_add_u32 v9, v9, 7, s70
v_lshl_add_u32 v9, v10, 2, v9
s_mov_b32 s70, 0
s_add_u32 s35, s70, 10
lw_43:
ds_read_b32 v5, v2 offset:16
s_waitcnt lgkmcnt(0)
v_cmp_gt_i32 vcc, s35, v5
s_cbranch_vccz lwd_44
s_sleep 4
s_sub_u32 s32, s32, 1
s_cmp_gt_i32 s32, 0
s_cbranch_scc1 lw_43
lwd_44:
poll_45:
buffer_load_dwordx4 v[12:15], v7, s[24:27], s76 offen sc1
pchk_46:
s_waitcnt vmcnt(0)
v_min3_u32 v10, v12, v13, v14
v_min_u32 v10, v10, v15
v_cmp_eq_u32 vcc, 0, v10
s_cbranch_vccz pdone_47
s_sub_u32 s32, s32, 1
s_cmp_gt_i32 s32, 0
s_cbranch_scc1 poll_45
pdone_47:
s_lshr_b32 s70, s33, 7
s_sub_u32 s70, s70, s59
s_mul_i32 s70, s70, s63
s_cmp_eq_u32 s70, 0
s_cbranch_scc0 fng_48
poll_49:
buffer_load_dwordx2 v[24:25], v6, s[24:27], s72 offen offset:0 sc1
buffer_load_dwordx2 v[26:27], v6, s[24:27], s72 offen offset:1024 sc1
buffer_load_dwordx2 v[28:29], v6, s[24:27], s72 offen offset:2048 sc1
buffer_load_dwordx2 v[30:31], v6, s[24:27], s72 offen offset:3072 sc1
buffer_load_dwordx2 v[32:33], v6, s[24:27], s73 offen offset:0 sc1
buffer_load_dwordx2 v[34:35], v6, s[24:27], s73 offen offset:1024 sc1
buffer_load_dwordx2 v[36:37], v6, s[24:27], s73 offen offset:2048 sc1
buffer_load_dwordx2 v[38:39], v6, s[24:27], s73 offen offset:3072 sc1
buffer_load_dwordx2 v[40:41], v6, s[24:27], s74 offen offset:0 sc1
buffer_load_dwordx2 v[42:43], v6, s[24:27], s74 offen offset:1024 sc1
buffer_load_dwordx2 v[44:45], v6, s[24:27], s74 offen offset:2048 sc1
buffer_load_dwordx2 v[46:47], v6, s[24:27], s74 offen offset:3072 sc1
buffer_load_dwordx2 v[48:49], v6, s[24:27], s75 offen offset:0 sc1
buffer_load_dwordx2 v[50:51], v6, s[24:27], s75 offen offset:1024 sc1
buffer_load_dwordx2 v[52:53], v6, s[24:27], s75 offen offset:2048 sc1
buffer_load_dwordx2 v[54:55], v6, s[24:27], s75 offen offset:3072 sc1
pchk_50:
s_waitcnt vmcnt(14)
v_min3_u32 v10, v24, v25, v26
s_waitcnt vmcnt(13)
v_min3_u32 v10, v10, v27, v28
s_waitcnt vmcnt(12)
v_min3_u32 v10, v10, v29, v30
s_waitcnt vmcnt(11)
v_min3_u32 v10, v10, v31, v32
s_waitcnt vmcnt(10)
v_min3_u32 v10, v10, v33, v34
s_waitcnt vmcnt(9)
v_min3_u32 v10, v10, v35, v36
s_waitcnt vmcnt(8)
v_min3_u32 v10, v10, v37, v38
s_waitcnt vmcnt(7)
v_min3_u32 v10, v10, v39, v40
s_waitcnt vmcnt(6)
v_min3_u32 v10, v10, v41, v42
s_waitcnt vmcnt(5)
v_min3_u32 v10, v10, v43, v44
s_waitcnt vmcnt(4)
v_min3_u32 v10, v10, v45, v46
s_waitcnt vmcnt(3)
v_min3_u32 v10, v10, v47, v48
s_waitcnt vmcnt(2)
v_min3_u32 v10, v10, v49, v50
s_waitcnt vmcnt(1)
v_min3_u32 v10, v10, v51, v52
s_waitcnt vmcnt(0)
v_min3_u32 v10, v10, v53, v54
v_min_u32 v10, v10, v55
v_cmp_eq_u32 vcc, 0, v10
s_cbranch_vccz pdone_51
s_sub_u32 s32, s32, 1
s_cmp_gt_i32 s32, 0
s_cbranch_scc1 poll_49
pdone_51:
v_pk_add_f32 v[24:25], v[24:25], v[40:41]
v_pk_add_f32 v[26:27], v[26:27], v[42:43]
v_pk_add_f32 v[28:29], v[28:29], v[44:45]
v_pk_add_f32 v[30:31], v[30:31], v[46:47]
v_pk_add_f32 v[32:33], v[32:33], v[48:49]
v_pk_add_f32 v[34:35], v[34:35], v[50:51]
v_pk_add_f32 v[36:37], v[36:37], v[52:53]
v_pk_add_f32 v[38:39], v[38:39], v[54:55]
v_pk_add_f32 v[24:25], v[24:25], v[32:33]
v_pk_add_f32 v[26:27], v[26:27], v[34:35]
v_pk_add_f32 v[28:29], v[28:29], v[36:37]
v_pk_add_f32 v[30:31], v[30:31], v[38:39]
v_pk_add_f32 v[24:25], v[24:25], v[28:29]
v_pk_add_f32 v[26:27], v[26:27], v[30:31]
v_pk_add_f32 v[24:25], v[24:25], v[26:27]
s_mov_b32 exec_hi, 0xffff
ds_write2_b32 v9, v24, v25 offset1:16
s_mov_b32 exec_hi, -1
v_mul_f32 v5, 0xba800000, v24
v_mul_f32 v25, 0x3a800000, v25
v_fma_f32 v25, -v5, v5, v25
v_max_f32 v25, 0, v25
v_add_f32 v25, 0x3727c5ac, v25
v_rsq_f32 v24, v25
s_nop 0
v_mul_f32 v25, v5, v24
s_lshl_b32 s70, s59, 7
s_sub_u32 s70, s33, s70
v_lshlrev_b32 v10, 1, v0
v_sub_u32 v10, s70, v10
v_readlane_b32 s70, v24, 48
v_readlane_b32 s71, v25, 48
v_cmp_eq_u32 vcc, 0, v10
s_mov_b64 exec, vcc
v_mov_b32 v12, s70
v_mov_b32 v13, s71
s_mov_b64 exec, -1
v_cmp_eq_u32 vcc, 1, v10
s_mov_b64 exec, vcc
v_mov_b32 v14, s70
v_mov_b32 v15, s71
s_mov_b64 exec, -1
fng_48:
ds_write2_b32 v8, v12, v14 offset1:1
ds_write2_b32 v8, v13, v15 offset0:128 offset1:129
v_add_u32 v5, s34, 2
s_mov_b64 exec, 1
ds_write_b32 v3, v5
s_mov_b64 exec, -1
s_lshl_b32 s70, s63, 8
s_add_u32 s70, s70, s2
s_cmp_lt_u32 s70, 224
s_cbranch_scc0 fnw_52
s_cmp_eq_u32 s58, 0
s_cselect_b32 s4, s46, s48
s_cselect_b32 s5, s47, s49
s_mov_b32 s6, 7340032
s_mov_b32 s12, s50
s_mov_b32 s13, s51
s_mov_b32 s14, 0x700000
s_mov_b32 s15, 0x00020000
v_lshrrev_b32 v6, 2, v0
v_bfe_u32 v7, v0, 1, 1
v_lshl_add_u32 v6, v6, 3, v7
v_mul_u32_u24 v6, 57344, v6
v_and_b32 v7, 1, v0
v_lshl_add_u32 v6, v7, 4, v6
s_lshl_b32 s70, s64, 5
v_add_u32 v6, s70, v6
s_lshl_b32 s70, s64, 15
s_lshl_b32 s71, s58, 10
s_add_u32 s72, s70, s71
v_lshlrev_b32 v7, 4, v0
s_add_u32 s35, s34, 15
lw_53:
ds_read_b32 v5, v2 offset:16
s_waitcnt lgkmcnt(0)
v_cmp_gt_i32 vcc, s35, v5
s_cbranch_vccz lwd_54
s_sleep 4
s_sub_u32 s32, s32, 1
s_cmp_gt_i32 s32, 0
s_cbranch_scc1 lw_53
lwd_54:
s_add_u32 s70, s66, 0
s_bfe_u32 s71, s70, 0x10001
s_and_b32 s70, s70, 1
s_lshl3_add_u32 s70, s70, s71
s_mul_i32 s70, s70, 28672
buffer_load_dwordx4 v[64:67], v6, s[4:7], s70 offen
s_add_u32 s70, s70, 7168
buffer_load_dwordx4 v[68:71], v6, s[4:7], s70 offen
s_add_u32 s70, s70, 7168
buffer_load_dwordx4 v[72:75], v6, s[4:7], s70 offen
s_add_u32 s70, s70, 7168
buffer_load_dwordx4 v[76:79], v6, s[4:7], s70 offen
s_add_u32 s70, s70, 93184
buffer_load_dwordx4 v[80:83], v6, s[4:7], s70 offen
s_add_u32 s70, s70, 7168
buffer_load_dwordx4 v[84:87], v6, s[4:7], s70 offen
s_add_u32 s70, s70, 7168
buffer_load_dwordx4 v[88:91], v6, s[4:7], s70 offen
s_add_u32 s70, s70, 7168
buffer_load_dwordx4 v[92:95], v6, s[4:7], s70 offen
buffer_load_dwordx4 v[192:195], v7, s[12:15], s72 offen offset:0
buffer_load_dwordx4 v[196:199], v7, s[12:15], s72 offen offset:2048
s_add_u32 s72, s72, 4096
buffer_load_dwordx4 v[200:203], v7, s[12:15], s72 offen offset:0
buffer_load_dwordx4 v[204:207], v7, s[12:15], s72 offen offset:2048
s_add_u32 s72, s72, 4096
buffer_load_dwordx4 v[208:211], v7, s[12:15], s72 offen offset:0
buffer_load_dwordx4 v[212:215], v7, s[12:15], s72 offen offset:2048
s_add_u32 s72, s72, 4096
buffer_load_dwordx4 v[216:219], v7, s[12:15], s72 offen offset:0
buffer_load_dwordx4 v[220:223], v7, s[12:15], s72 offen offset:2048
s_add_u32 s72, s72, 4096
s_add_u32 s35, s34, 17
lw_55:
ds_read_b32 v5, v2 offset:16
s_waitcnt lgkmcnt(0)
v_cmp_gt_i32 vcc, s35, v5
s_cbranch_vccz lwd_56
s_sleep 4
s_sub_u32 s32, s32, 1
s_cmp_gt_i32 s32, 0
s_cbranch_scc1 lw_55
lwd_56:
s_add_u32 s70, s66, 1
s_bfe_u32 s71, s70, 0x10001
s_and_b32 s70, s70, 1
s_lshl3_add_u32 s70, s70, s71
s_mul_i32 s70, s70, 28672
buffer_load_dwordx4 v[96:99], v6, s[4:7], s70 offen
s_add_u32 s70, s70, 7168
buffer_load_dwordx4 v[100:103], v6, s[4:7], s70 offen
s_add_u32 s70, s70, 7168
buffer_load_dwordx4 v[104:107], v6, s[4:7], s70 offen
s_add_u32 s70, s70, 7168
buffer_load_dwordx4 v[108:111], v6, s[4:7], s70 offen
s_add_u32 s70, s70, 93184
buffer_load_dwordx4 v[112:115], v6, s[4:7], s70 offen
s_add_u32 s70, s70, 7168
buffer_load_dwordx4 v[116:119], v6, s[4:7], s70 offen
s_add_u32 s70, s70, 7168
buffer_load_dwordx4 v[120:123], v6, s[4:7], s70 offen
s_add_u32 s70, s70, 7168
buffer_load_dwordx4 v[124:127], v6, s[4:7], s70 offen
buffer_load_dwordx4 v[224:227], v7, s[12:15], s72 offen offset:0
buffer_load_dwordx4 v[228:231], v7, s[12:15], s72 offen offset:2048
s_add_u32 s72, s72, 4096
buffer_load_dwordx4 v[232:235], v7, s[12:15], s72 offen offset:0
buffer_load_dwordx4 v[236:239], v7, s[12:15], s72 offen offset:2048
s_add_u32 s72, s72, 4096
buffer_load_dwordx4 v[240:243], v7, s[12:15], s72 offen offset:0
buffer_load_dwordx4 v[244:247], v7, s[12:15], s72 offen offset:2048
s_add_u32 s72, s72, 4096
buffer_load_dwordx4 v[248:251], v7, s[12:15], s72 offen offset:0
buffer_load_dwordx4 v[252:255], v7, s[12:15], s72 offen offset:2048
s_add_u32 s72, s72, 4096
s_add_u32 s70, s66, 2
s_bfe_u32 s71, s70, 0x10001
s_and_b32 s70, s70, 1
s_lshl3_add_u32 s70, s70, s71
s_mul_i32 s70, s70, 28672
buffer_load_dwordx4 v[128:131], v6, s[4:7], s70 offen
s_add_u32 s70, s70, 7168
buffer_load_dwordx4 v[132:135], v6, s[4:7], s70 offen
s_add_u32 s70, s70, 7168
buffer_load_dwordx4 v[136:139], v6, s[4:7], s70 offen
s_add_u32 s70, s70, 7168
buffer_load_dwordx4 v[140:143], v6, s[4:7], s70 offen
s_add_u32 s70, s70, 93184
buffer_load_dwordx4 v[144:147], v6, s[4:7], s70 offen
s_add_u32 s70, s70, 7168
buffer_load_dwordx4 v[148:151], v6, s[4:7], s70 offen
s_add_u32 s70, s70, 7168
buffer_load_dwordx4 v[152:155], v6, s[4:7], s70 offen
s_add_u32 s70, s70, 7168
buffer_load_dwordx4 v[156:159], v6, s[4:7], s70 offen
s_add_u32 s70, s66, 3
s_bfe_u32 s71, s70, 0x10001
s_and_b32 s70, s70, 1
s_lshl3_add_u32 s70, s70, s71
s_mul_i32 s70, s70, 28672
buffer_load_dwordx4 v[160:163], v6, s[4:7], s70 offen
s_add_u32 s70, s70, 7168
buffer_load_dwordx4 v[164:167], v6, s[4:7], s70 offen
s_add_u32 s70, s70, 7168
buffer_load_dwordx4 v[168:171], v6, s[4:7], s70 offen
s_add_u32 s70, s70, 7168
buffer_load_dwordx4 v[172:175], v6, s[4:7], s70 offen
s_add_u32 s70, s70, 93184
buffer_load_dwordx4 v[176:179], v6, s[4:7], s70 offen
s_add_u32 s70, s70, 7168
buffer_load_dwordx4 v[180:183], v6, s[4:7], s70 offen
s_add_u32 s70, s70, 7168
buffer_load_dwordx4 v[184:187], v6, s[4:7], s70 offen
s_add_u32 s70, s70, 7168
buffer_load_dwordx4 v[188:191], v6, s[4:7], s70 offen
s_mov_b32 s70, 0x05040100
s_mov_b32 s71, 0x07060302
s_waitcnt vmcnt(0)
s_add_u32 s35, s34, 21
lw_57:
ds_read_b32 v5, v1 offset:0
s_waitcnt lgkmcnt(0)
v_cmp_gt_i32 vcc, s35, v5
s_cbranch_vccz lwd_58
s_sleep 4
s_sub_u32 s32, s32, 1
s_cmp_gt_i32 s32, 0
s_cbranch_scc1 lw_57
lwd_58:
v_perm_b32 v56, v68, v64, s70
v_perm_b32 v57, v68, v64, s71
v_perm_b32 v58, v69, v65, s70
v_perm_b32 v59, v69, v65, s71
v_perm_b32 v60, v70, v66, s70
v_perm_b32 v61, v70, v66, s71
v_perm_b32 v62, v71, v67, s70
v_perm_b32 v63, v71, v67, s71
v_perm_b32 v64, v76, v72, s70
v_perm_b32 v65, v76, v72, s71
v_perm_b32 v66, v77, v73, s70
v_perm_b32 v67, v77, v73, s71
v_perm_b32 v68, v78, v74, s70
v_perm_b32 v69, v78, v74, s71
v_perm_b32 v70, v79, v75, s70
v_perm_b32 v71, v79, v75, s71
v_perm_b32 v72, v84, v80, s70
v_perm_b32 v73, v84, v80, s71
v_perm_b32 v74, v85, v81, s70
v_perm_b32 v75, v85, v81, s71
v_perm_b32 v76, v86, v82, s70
v_perm_b32 v77, v86, v82, s71
v_perm_b32 v78, v87, v83, s70
v_perm_b32 v79, v87, v83, s71
v_perm_b32 v80, v92, v88, s70
v_perm_b32 v81, v92, v88, s71
v_perm_b32 v82, v93, v89, s70
v_perm_b32 v83, v93, v89, s71
v_perm_b32 v84, v94, v90, s70
v_perm_b32 v85, v94, v90, s71
v_perm_b32 v86, v95, v91, s70
v_perm_b32 v87, v95, v91, s71
v_perm_b32 v88, v100, v96, s70
v_perm_b32 v89, v100, v96, s71
v_perm_b32 v90, v101, v97, s70
v_perm_b32 v91, v101, v97, s71
v_perm_b32 v92, v102, v98, s70
v_perm_b32 v93, v102, v98, s71
v_perm_b32 v94, v103, v99, s70
v_perm_b32 v95, v103, v99, s71
v_perm_b32 v96, v108, v104, s70
v_perm_b32 v97, v108, v104, s71
v_perm_b32 v98, v109, v105, s70
v_perm_b32 v99, v109, v105, s71
v_perm_b32 v100, v110, v106, s70
v_perm_b32 v101, v110, v106, s71
v_perm_b32 v102, v111, v107, s70
v_perm_b32 v103, v111, v107, s71
v_perm_b32 v104, v116, v112, s70
v_perm_b32 v105, v116, v112, s71
v_perm_b32 v106, v117, v113, s70
v_perm_b32 v107, v117, v113, s71
v_perm_b32 v108, v118, v114, s70
v_perm_b32 v109, v118, v114, s71
v_perm_b32 v110, v119, v115, s70
v_perm_b32 v111, v119, v115, s71
v_perm_b32 v112, v124, v120, s70
v_perm_b32 v113, v124, v120, s71
v_perm_b32 v114, v125, v121, s70
v_perm_b32 v115, v125, v121, s71
v_perm_b32 v116, v126, v122, s70
v_perm_b32 v117, v126, v122, s71
v_perm_b32 v118, v127, v123, s70
v_perm_b32 v119, v127, v123, s71
v_perm_b32 v120, v132, v128, s70
v_perm_b32 v121, v132, v128, s71
v_perm_b32 v122, v133, v129, s70
v_perm_b32 v123, v133, v129, s71
v_perm_b32 v124, v134, v130, s70
v_perm_b32 v125, v134, v130, s71
v_perm_b32 v126, v135, v131, s70
v_perm_b32 v127, v135, v131, s71
v_perm_b32 v128, v140, v136, s70
v_perm_b32 v129, v140, v136, s71
v_perm_b32 v130, v141, v137, s70
v_perm_b32 v131, v141, v137, s71
v_perm_b32 v132, v142, v138, s70
v_perm_b32 v133, v142, v138, s71
v_perm_b32 v134, v143, v139, s70
v_perm_b32 v135, v143, v139, s71
v_perm_b32 v136, v148, v144, s70
v_perm_b32 v137, v148, v144, s71
v_perm_b32 v138, v149, v145, s70
v_perm_b32 v139, v149, v145, s71
v_perm_b32 v140, v150, v146, s70
v_perm_b32 v141, v150, v146, s71
v_perm_b32 v142, v151, v147, s70
v_perm_b32 v143, v151, v147, s71
v_perm_b32 v144, v156, v152, s70
v_perm_b32 v145, v156, v152, s71
v_perm_b32 v146, v157, v153, s70
v_perm_b32 v147, v157, v153, s71
v_perm_b32 v148, v158, v154, s70
v_perm_b32 v149, v158, v154, s71
v_perm_b32 v150, v159, v155, s70
v_perm_b32 v151, v159, v155, s71
v_perm_b32 v152, v164, v160, s70
v_perm_b32 v153, v164, v160, s71
v_perm_b32 v154, v165, v161, s70
v_perm_b32 v155, v165, v161, s71
v_perm_b32 v156, v166, v162, s70
v_perm_b32 v157, v166, v162, s71
v_perm_b32 v158, v167, v163, s70
v_perm_b32 v159, v167, v163, s71
v_perm_b32 v160, v172, v168, s70
v_perm_b32 v161, v172, v168, s71
v_perm_b32 v162, v173, v169, s70
v_perm_b32 v163, v173, v169, s71
v_perm_b32 v164, v174, v170, s70
v_perm_b32 v165, v174, v170, s71
v_perm_b32 v166, v175, v171, s70
v_perm_b32 v167, v175, v171, s71
v_perm_b32 v168, v180, v176, s70
v_perm_b32 v169, v180, v176, s71
v_perm_b32 v170, v181, v177, s70
v_perm_b32 v171, v181, v177, s71
v_perm_b32 v172, v182, v178, s70
v_perm_b32 v173, v182, v178, s71
v_perm_b32 v174, v183, v179, s70
v_perm_b32 v175, v183, v179, s71
v_perm_b32 v176, v188, v184, s70
v_perm_b32 v177, v188, v184, s71
v_perm_b32 v178, v189, v185, s70
v_perm_b32 v179, v189, v185, s71
v_perm_b32 v180, v190, v186, s70
v_perm_b32 v181, v190, v186, s71
v_perm_b32 v182, v191, v187, s70
v_perm_b32 v183, v191, v187, s71
v_perm_b32 v184, v196, v192, s70
v_perm_b32 v185, v196, v192, s71
v_perm_b32 v186, v197, v193, s70
v_perm_b32 v187, v197, v193, s71
v_perm_b32 v188, v198, v194, s70
v_perm_b32 v189, v198, v194, s71
v_perm_b32 v190, v199, v195, s70
v_perm_b32 v191, v199, v195, s71
v_perm_b32 v192, v204, v200, s70
v_perm_b32 v193, v204, v200, s71
v_perm_b32 v194, v205, v201, s70
v_perm_b32 v195, v205, v201, s71
v_perm_b32 v196, v206, v202, s70
v_perm_b32 v197, v206, v202, s71
v_perm_b32 v198, v207, v203, s70
v_perm_b32 v199, v207, v203, s71
v_perm_b32 v200, v212, v208, s70
v_perm_b32 v201, v212, v208, s71
v_perm_b32 v202, v213, v209, s70
v_perm_b32 v203, v213, v209, s71
v_perm_b32 v204, v214, v210, s70
v_perm_b32 v205, v214, v210, s71
v_perm_b32 v206, v215, v211, s70
v_perm_b32 v207, v215, v211, s71
v_perm_b32 v208, v220, v216, s70
v_perm_b32 v209, v220, v216, s71
v_perm_b32 v210, v221, v217, s70
v_perm_b32 v211, v221, v217, s71
v_perm_b32 v212, v222, v218, s70
v_perm_b32 v213, v222, v218, s71
v_perm_b32 v214, v223, v219, s70
v_perm_b32 v215, v223, v219, s71
v_perm_b32 v216, v228, v224, s70
v_perm_b32 v217, v228, v224, s71
v_perm_b32 v218, v229, v225, s70
v_perm_b32 v219, v229, v225, s71
v_perm_b32 v220, v230, v226, s70
v_perm_b32 v221, v230, v226, s71
v_perm_b32 v222, v231, v227, s70
v_perm_b32 v223, v231, v227, s71
v_perm_b32 v224, v236, v232, s70
v_perm_b32 v225, v236, v232, s71
v_perm_b32 v226, v237, v233, s70
v_perm_b32 v227, v237, v233, s71
v_perm_b32 v228, v238, v234, s70
v_perm_b32 v229, v238, v234, s71
v_perm_b32 v230, v239, v235, s70
v_perm_b32 v231, v239, v235, s71
v_perm_b32 v232, v244, v240, s70
v_perm_b32 v233, v244, v240, s71
v_perm_b32 v234, v245, v241, s70
v_perm_b32 v235, v245, v241, s71
v_perm_b32 v236, v246, v242, s70
v_perm_b32 v237, v246, v242, s71
v_perm_b32 v238, v247, v243, s70
v_perm_b32 v239, v247, v243, s71
v_perm_b32 v240, v252, v248, s70
v_perm_b32 v241, v252, v248, s71
v_perm_b32 v242, v253, v249, s70
v_perm_b32 v243, v253, v249, s71
v_perm_b32 v244, v254, v250, s70
v_perm_b32 v245, v254, v250, s71
v_perm_b32 v246, v255, v251, s70
v_perm_b32 v247, v255, v251, s71
fnw_52:
s_and_b32 s70, s2, 7
s_lshl_b32 s70, s70, 13
s_add_u32 s70, s70, 425984
v_lshlrev_b32 v6, 7, v0
v_and_b32 v7, 62, v0
v_lshlrev_b32 v7, 5, v7
s_add_u32 s71, s66, 0
s_and_b32 s71, s71, 3
s_lshl4_add_u32 s72, s71, 1966080
s_add_u32 s71, s66, 1
s_and_b32 s71, s71, 3
s_lshl4_add_u32 s73, s71, 1966080
s_add_u32 s71, s66, 2
s_and_b32 s71, s71, 3
s_lshl4_add_u32 s74, s71, 1966080
s_add_u32 s71, s66, 3
s_and_b32 s71, s71, 3
s_lshl4_add_u32 s75, s71, 1966080
v_mov_b32 v16, 0
v_mov_b32 v17, 0
v_mov_b32 v18, 0
v_mov_b32 v19, 0
v_mov_b32 v20, 0
v_mov_b32 v21, 0
v_mov_b32 v22, 0
v_mov_b32 v23, 0
v_and_b32 v12, 1, v0
v_lshrrev_b32 v13, 3, v0
v_lshl_add_u32 v12, v12, 3, v13
s_lshl1_add_u32 s71, s63, s58
s_lshl_b32 s71, s71, 6
v_lshl_add_u32 v12, v12, 2, s71
v_and_b32 v13, 7, v0
s_lshl_b32 s71, s63, 7
v_lshl_add_u32 v13, v13, 3, s71
s_add_u32 s35, s34, 24
lw_59:
ds_read_b32 v5, v1 offset:0
s_waitcnt lgkmcnt(0)
v_cmp_gt_i32 vcc, s35, v5
s_cbranch_vccz lwd_60
s_sleep 2
s_sub_u32 s32, s32, 1
s_cmp_gt_i32 s32, 0
s_cbranch_scc1 lw_59
lwd_60:
poll_61:
buffer_load_dwordx2 v[8:9], v6, s[24:27], s70 offen sc1
pchk_62:
s_waitcnt vmcnt(0)
v_min_u32 v10, v8, v9
v_cmp_eq_u32 vcc, 0, v10
s_cbranch_vccz pdone_63
s_sub_u32 s32, s32, 1
s_cmp_gt_i32 s32, 0
s_cbranch_scc1 poll_61
pdone_63:
v_mov_b32 v10, v8
s_nop 1
v_max_f32_dpp v10, v10, v10 row_ror:1 row_mask:0xf bank_mask:0xf
s_nop 1
v_max_f32_dpp v10, v10, v10 row_ror:2 row_mask:0xf bank_mask:0xf
s_nop 1
v_max_f32_dpp v10, v10, v10 row_ror:4 row_mask:0xf bank_mask:0xf
s_nop 1
v_max_f32_dpp v10, v10, v10 row_ror:8 row_mask:0xf bank_mask:0xf
v_mov_b32 v11, v10
s_nop 1
v_permlane16_swap_b32 v11, v10
v_max_f32 v10, v10, v11
v_mov_b32 v11, v10
s_nop 1
v_permlane32_swap_b32 v11, v10
v_max_f32 v10, v10, v11
v_cmp_eq_f32 vcc, v10, v8
s_ff1_i32_b64 s68, vcc
s_and_b32 s68, s68, 63
s_lshl_b32 s71, s68, 11
v_add_u32 v7, s71, v7
buffer_load_dwordx4 v[24:27], v7, s[24:27], s72 offen sc1
buffer_load_dwordx4 v[28:31], v7, s[24:27], s73 offen sc1
buffer_load_dwordx4 v[32:35], v7, s[24:27], s74 offen sc1
buffer_load_dwordx4 v[36:39], v7, s[24:27], s75 offen sc1
v_readlane_b32 s33, v9, s68
v_readlane_b32 s67, v8, s68
s_nop 0
v_mov_b32 v11, s33
ds_write_b32 v16, v11 offset:32
v_add_u32 v5, s34, 3
s_mov_b64 exec, 1
ds_write_b32 v3, v5
s_mov_b64 exec, -1
s_sub_u32 s33, s33, 1
s_and_b32 s33, s33, 2047
s_cmp_lt_u32 s2, 224
s_cbranch_scc0 fnd_64
s_branch pchk_66
poll_65:
buffer_load_dwordx4 v[24:27], v7, s[24:27], s72 offen sc1
buffer_load_dwordx4 v[28:31], v7, s[24:27], s73 offen sc1
buffer_load_dwordx4 v[32:35], v7, s[24:27], s74 offen sc1
buffer_load_dwordx4 v[36:39], v7, s[24:27], s75 offen sc1
pchk_66:
s_waitcnt vmcnt(3)
v_min3_u32 v10, v24, v25, v26
s_waitcnt vmcnt(2)
v_min3_u32 v10, v10, v27, v28
v_min3_u32 v10, v10, v29, v30
s_waitcnt vmcnt(1)
v_min3_u32 v10, v10, v31, v32
v_min3_u32 v10, v10, v33, v34
s_waitcnt vmcnt(0)
v_min3_u32 v10, v10, v35, v36
v_min3_u32 v10, v10, v37, v38
v_min_u32 v10, v10, v39
v_cmp_eq_u32 vcc, 0, v10
s_cbranch_vccz pdone_67
s_sub_u32 s32, s32, 1
s_cmp_gt_i32 s32, 0
s_cbranch_scc1 poll_65
pdone_67:
v_dot2c_f32_bf16 v16, v24, v56
v_dot2c_f32_bf16 v17, v24, v57
v_dot2c_f32_bf16 v18, v24, v58
v_dot2c_f32_bf16 v19, v24, v59
v_dot2c_f32_bf16 v20, v24, v60
v_dot2c_f32_bf16 v21, v24, v61
v_dot2c_f32_bf16 v22, v24, v62
v_dot2c_f32_bf16 v23, v24, v63
v_dot2c_f32_bf16 v16, v25, v64
v_dot2c_f32_bf16 v17, v25, v65
v_dot2c_f32_bf16 v18, v25, v66
v_dot2c_f32_bf16 v19, v25, v67
v_dot2c_f32_bf16 v20, v25, v68
v_dot2c_f32_bf16 v21, v25, v69
v_dot2c_f32_bf16 v22, v25, v70
v_dot2c_f32_bf16 v23, v25, v71
v_dot2c_f32_bf16 v16, v26, v72
v_dot2c_f32_bf16 v17, v26, v73
v_dot2c_f32_bf16 v18, v26, v74
v_dot2c_f32_bf16 v19, v26, v75
v_dot2c_f32_bf16 v20, v26, v76
v_dot2c_f32_bf16 v21, v26, v77
v_dot2c_f32_bf16 v22, v26, v78
v_dot2c_f32_bf16 v23, v26, v79
v_dot2c_f32_bf16 v16, v27, v80
v_dot2c_f32_bf16 v17, v27, v81
v_dot2c_f32_bf16 v18, v27, v82
v_dot2c_f32_bf16 v19, v27, v83
v_dot2c_f32_bf16 v20, v27, v84
v_dot2c_f32_bf16 v21, v27, v85
v_dot2c_f32_bf16 v22, v27, v86
v_dot2c_f32_bf16 v23, v27, v87
v_dot2c_f32_bf16 v16, v28, v88
v_dot2c_f32_bf16 v17, v28, v89
v_dot2c_f32_bf16 v18, v28, v90
v_dot2c_f32_bf16 v19, v28, v91
v_dot2c_f32_bf16 v20, v28, v92
v_dot2c_f32_bf16 v21, v28, v93
v_dot2c_f32_bf16 v22, v28, v94
v_dot2c_f32_bf16 v23, v28, v95
v_dot2c_f32_bf16 v16, v29, v96
v_dot2c_f32_bf16 v17, v29, v97
v_dot2c_f32_bf16 v18, v29, v98
v_dot2c_f32_bf16 v19, v29, v99
v_dot2c_f32_bf16 v20, v29, v100
v_dot2c_f32_bf16 v21, v29, v101
v_dot2c_f32_bf16 v22, v29, v102
v_dot2c_f32_bf16 v23, v29, v103
v_dot2c_f32_bf16 v16, v30, v104
v_dot2c_f32_bf16 v17, v30, v105
v_dot2c_f32_bf16 v18, v30, v106
v_dot2c_f32_bf16 v19, v30, v107
v_dot2c_f32_bf16 v20, v30, v108
v_dot2c_f32_bf16 v21, v30, v109
v_dot2c_f32_bf16 v22, v30, v110
v_dot2c_f32_bf16 v23, v30, v111
v_dot2c_f32_bf16 v16, v31, v112
v_dot2c_f32_bf16 v17, v31, v113
v_dot2c_f32_bf16 v18, v31, v114
v_dot2c_f32_bf16 v19, v31, v115
v_dot2c_f32_bf16 v20, v31, v116
v_dot2c_f32_bf16 v21, v31, v117
v_dot2c_f32_bf16 v22, v31, v118
v_dot2c_f32_bf16 v23, v31, v119
v_dot2c_f32_bf16 v16, v32, v120
v_dot2c_f32_bf16 v17, v32, v121
v_dot2c_f32_bf16 v18, v32, v122
v_dot2c_f32_bf16 v19, v32, v123
v_dot2c_f32_bf16 v20, v32, v124
v_dot2c_f32_bf16 v21, v32, v125
v_dot2c_f32_bf16 v22, v32, v126
v_dot2c_f32_bf16 v23, v32, v127
v_dot2c_f32_bf16 v16, v33, v128
v_dot2c_f32_bf16 v17, v33, v129
v_dot2c_f32_bf16 v18, v33, v130
v_dot2c_f32_bf16 v19, v33, v131
v_dot2c_f32_bf16 v20, v33, v132
v_dot2c_f32_bf16 v21, v33, v133
v_dot2c_f32_bf16 v22, v33, v134
v_dot2c_f32_bf16 v23, v33, v135
v_dot2c_f32_bf16 v16, v34, v136
v_dot2c_f32_bf16 v17, v34, v137
v_dot2c_f32_bf16 v18, v34, v138
v_dot2c_f32_bf16 v19, v34, v139
v_dot2c_f32_bf16 v20, v34, v140
v_dot2c_f32_bf16 v21, v34, v141
v_dot2c_f32_bf16 v22, v34, v142
v_dot2c_f32_bf16 v23, v34, v143
v_dot2c_f32_bf16 v16, v35, v144
v_dot2c_f32_bf16 v17, v35, v145
v_dot2c_f32_bf16 v18, v35, v146
v_dot2c_f32_bf16 v19, v35, v147
v_dot2c_f32_bf16 v20, v35, v148
v_dot2c_f32_bf16 v21, v35, v149
v_dot2c_f32_bf16 v22, v35, v150
v_dot2c_f32_bf16 v23, v35, v151
v_dot2c_f32_bf16 v16, v36, v152
v_dot2c_f32_bf16 v17, v36, v153
v_dot2c_f32_bf16 v18, v36, v154
v_dot2c_f32_bf16 v19, v36, v155
v_dot2c_f32_bf16 v20, v36, v156
v_dot2c_f32_bf16 v21, v36, v157
v_dot2c_f32_bf16 v22, v36, v158
v_dot2c_f32_bf16 v23, v36, v159
v_dot2c_f32_bf16 v16, v37, v160
v_dot2c_f32_bf16 v17, v37, v161
v_dot2c_f32_bf16 v18, v37, v162
v_dot2c_f32_bf16 v19, v37, v163
v_dot2c_f32_bf16 v20, v37, v164
v_dot2c_f32_bf16 v21, v37, v165
v_dot2c_f32_bf16 v22, v37, v166
v_dot2c_f32_bf16 v23, v37, v167
v_dot2c_f32_bf16 v16, v38, v168
v_dot2c_f32_bf16 v17, v38, v169
v_dot2c_f32_bf16 v18, v38, v170
v_dot2c_f32_bf16 v19, v38, v171
v_dot2c_f32_bf16 v20, v38, v172
v_dot2c_f32_bf16 v21, v38, v173
v_dot2c_f32_bf16 v22, v38, v174
v_dot2c_f32_bf16 v23, v38, v175
v_dot2c_f32_bf16 v16, v39, v176
v_dot2c_f32_bf16 v17, v39, v177
v_dot2c_f32_bf16 v18, v39, v178
v_dot2c_f32_bf16 v19, v39, v179
v_dot2c_f32_bf16 v20, v39, v180
v_dot2c_f32_bf16 v21, v39, v181
v_dot2c_f32_bf16 v22, v39, v182
v_dot2c_f32_bf16 v23, v39, v183
v_permlane32_swap_b32 v16, v20
v_permlane32_swap_b32 v17, v21
v_permlane32_swap_b32 v18, v22
v_permlane32_swap_b32 v19, v23
v_pk_add_f32 v[16:17], v[16:17], v[20:21]
v_pk_add_f32 v[18:19], v[18:19], v[22:23]
s_nop 1
v_permlane16_swap_b32 v16, v18
v_permlane16_swap_b32 v17, v19
v_pk_add_f32 v[16:17], v[16:17], v[18:19]
s_nop 1
v_add_f32_dpp v10, v16, v16 row_ror:8 row_mask:0xf bank_mask:0x3
s_nop 1
v_add_f32_dpp v10, v17, v17 row_ror:8 row_mask:0xf bank_mask:0xc
s_nop 1
v_add_f32_dpp v10, v10, v10 quad_perm:[2,3,0,1] row_mask:0xf bank_mask:0xf
s_nop 1
v_add_f32_dpp v10, v10, v10 row_shl:4 row_mask:0xf bank_mask:0x5
s_mov_b32 exec_lo, 0x03030303
s_mov_b32 exec_hi, 0x03030303
v_max_u32 v10, 1, v10
ds_write_b32 v12, v10 offset:256
s_mov_b64 exec, -1
s_lshl_b32 s70, s64, 12
s_lshl_b32 s71, s58, 11
s_add_u32 s70, s70, s71
s_add_u32 s70, s70, 1048576
v_mov_b32 v16, 0
v_mov_b32 v17, 0
v_mov_b32 v18, 0
v_mov_b32 v19, 0
v_mov_b32 v20, 0
v_mov_b32 v21, 0
v_mov_b32 v22, 0
v_mov_b32 v23, 0
v_lshlrev_b32 v6, 4, v0
poll_68:
ds_read2_b64 v[8:11], v13 offset0:32 offset1:40
pchk_69:
s_waitcnt lgkmcnt(0)
v_min3_u32 v12, v8, v9, v10
v_min_u32 v12, v12, v11
v_cmp_eq_u32 vcc, 0, v12
s_cbranch_vccz pdone_70
s_sub_u32 s32, s32, 1
s_cmp_gt_i32 s32, 0
s_cbranch_scc1 poll_68
pdone_70:
v_mul_f32 v12, 0xbfb8aa3b, v8
v_mul_f32 v13, 0xbfb8aa3b, v9
v_exp_f32 v12, v12
v_exp_f32 v13, v13
v_pk_mul_f32 v[8:9], v[8:9], v[10:11]
v_add_f32 v12, 1.0, v12
v_add_f32 v13, 1.0, v13
v_rcp_f32 v12, v12
v_rcp_f32 v13, v13
s_nop 0
v_pk_mul_f32 v[8:9], v[8:9], v[12:13]
v_cvt_pk_bf16_f32 v8, v8, v9
s_nop 0
v_readlane_b32 s72, v8, 0
v_readlane_b32 s73, v8, 1
v_readlane_b32 s74, v8, 2
v_readlane_b32 s75, v8, 3
v_readlane_b32 s76, v8, 4
v_readlane_b32 s77, v8, 5
v_readlane_b32 s78, v8, 6
v_readlane_b32 s79, v8, 7
v_dot2c_f32_bf16 v16, s72, v184
v_dot2c_f32_bf16 v17, s72, v185
v_dot2c_f32_bf16 v18, s72, v186
v_dot2c_f32_bf16 v19, s72, v187
v_dot2c_f32_bf16 v20, s72, v188
v_dot2c_f32_bf16 v21, s72, v189
v_dot2c_f32_bf16 v22, s72, v190
v_dot2c_f32_bf16 v23, s72, v191
v_dot2c_f32_bf16 v16, s73, v192
v_dot2c_f32_bf16 v17, s73, v193
v_dot2c_f32_bf16 v18, s73, v194
v_dot2c_f32_bf16 v19, s73, v195
v_dot2c_f32_bf16 v20, s73, v196
v_dot2c_f32_bf16 v21, s73, v197
v_dot2c_f32_bf16 v22, s73, v198
v_dot2c_f32_bf16 v23, s73, v199
v_dot2c_f32_bf16 v16, s74, v200
v_dot2c_f32_bf16 v17, s74, v201
v_dot2c_f32_bf16 v18, s74, v202
v_dot2c_f32_bf16 v19, s74, v203
v_dot2c_f32_bf16 v20, s74, v204
v_dot2c_f32_bf16 v21, s74, v205
v_dot2c_f32_bf16 v22, s74, v206
v_dot2c_f32_bf16 v23, s74, v207
v_dot2c_f32_bf16 v16, s75, v208
v_dot2c_f32_bf16 v17, s75, v209
v_dot2c_f32_bf16 v18, s75, v210
v_dot2c_f32_bf16 v19, s75, v211
v_dot2c_f32_bf16 v20, s75, v212
v_dot2c_f32_bf16 v21, s75, v213
v_dot2c_f32_bf16 v22, s75, v214
v_dot2c_f32_bf16 v23, s75, v215
v_dot2c_f32_bf16 v16, s76, v216
v_dot2c_f32_bf16 v17, s76, v217
v_dot2c_f32_bf16 v18, s76, v218
v_dot2c_f32_bf16 v19, s76, v219
v_dot2c_f32_bf16 v20, s76, v220
v_dot2c_f32_bf16 v21, s76, v221
v_dot2c_f32_bf16 v22, s76, v222
v_dot2c_f32_bf16 v23, s76, v223
v_dot2c_f32_bf16 v16, s77, v224
v_dot2c_f32_bf16 v17, s77, v225
v_dot2c_f32_bf16 v18, s77, v226
v_dot2c_f32_bf16 v19, s77, v227
v_dot2c_f32_bf16 v20, s77, v228
v_dot2c_f32_bf16 v21, s77, v229
v_dot2c_f32_bf16 v22, s77, v230
v_dot2c_f32_bf16 v23, s77, v231
v_dot2c_f32_bf16 v16, s78, v232
v_dot2c_f32_bf16 v17, s78, v233
v_dot2c_f32_bf16 v18, s78, v234
v_dot2c_f32_bf16 v19, s78, v235
v_dot2c_f32_bf16 v20, s78, v236
v_dot2c_f32_bf16 v21, s78, v237
v_dot2c_f32_bf16 v22, s78, v238
v_dot2c_f32_bf16 v23, s78, v239
v_dot2c_f32_bf16 v16, s79, v240
v_dot2c_f32_bf16 v17, s79, v241
v_dot2c_f32_bf16 v18, s79, v242
v_dot2c_f32_bf16 v19, s79, v243
v_dot2c_f32_bf16 v20, s79, v244
v_dot2c_f32_bf16 v21, s79, v245
v_dot2c_f32_bf16 v22, s79, v246
v_dot2c_f32_bf16 v23, s79, v247
v_max_u32 v16, 1, v16
v_max_u32 v17, 1, v17
v_max_u32 v18, 1, v18
v_max_u32 v19, 1, v19
v_max_u32 v20, 1, v20
v_max_u32 v21, 1, v21
v_max_u32 v22, 1, v22
v_max_u32 v23, 1, v23
buffer_store_dwordx4 v[16:19], v6, s[24:27], s70 offen offset:0 sc1
buffer_store_dwordx4 v[20:23], v6, s[24:27], s70 offen offset:1024 sc1
fnd_64:
s_cmp_eq_u32 s58, 0
s_cbranch_scc0 fnr_71
v_min_u32 v6, 55, v0
v_lshlrev_b32 v6, 12, v6
s_lshr_b32 s70, s65, 7
s_and_b32 s71, s65, 1
s_lshl1_add_u32 s70, s70, s71
s_lshl_b32 s70, s70, 10
s_bfe_u32 s71, s65, 0x60001
s_lshl4_add_u32 s70, s71, s70
s_add_u32 s72, s70, 1048576
s_add_u32 s73, s70, 1277952
s_add_u32 s74, s70, 1507328
s_add_u32 s75, s70, 1736704
s_lshl_b32 s70, s68, 12
s_lshl4_add_u32 s70, s65, s70
s_add_u32 s76, s70, 2097152
v_mov_b32 v12, s67
v_mul_f32 v12, 0xbfb8aa3b, v12
v_exp_f32 v12, v12
v_cmp_gt_u32 vcc, 56, v0
v_add_f32 v12, 1.0, v12
v_rcp_f32 v12, v12
s_lshl_b32 s70, s33, 11
s_lshl3_add_u32 s70, s65, s70
s_lshl_b32 s71, s65, 7
s_add_u32 s71, s71, 393216
v_cndmask_b32 v12, 0, v12, vcc
s_waitcnt vmcnt(0)
poll_73:
buffer_load_dwordx4 v[40:43], off, s[24:27], s76 sc1
buffer_load_dwordx4 v[24:27], v6, s[24:27], s72 offen sc1
buffer_load_dwordx4 v[28:31], v6, s[24:27], s73 offen sc1
buffer_load_dwordx4 v[32:35], v6, s[24:27], s74 offen sc1
buffer_load_dwordx4 v[36:39], v6, s[24:27], s75 offen sc1
pchk_74:
s_waitcnt vmcnt(3)
v_min3_u32 v10, v24, v25, v26
s_waitcnt vmcnt(2)
v_min3_u32 v10, v10, v27, v28
v_min3_u32 v10, v10, v29, v30
s_waitcnt vmcnt(1)
v_min3_u32 v10, v10, v31, v32
v_min3_u32 v10, v10, v33, v34
s_waitcnt vmcnt(0)
v_min3_u32 v10, v10, v35, v36
v_min3_u32 v10, v10, v37, v38
v_min3_u32 v10, v10, v39, v40
v_min3_u32 v10, v10, v41, v42
v_min_u32 v10, v10, v43
v_cmp_eq_u32 vcc, 0, v10
s_cbranch_vccz pdone_75
s_sub_u32 s32, s32, 1
s_cmp_gt_i32 s32, 0
s_cbranch_scc1 poll_73
pdone_75:
v_pk_add_f32 v[24:25], v[24:25], v[32:33]
v_pk_add_f32 v[26:27], v[26:27], v[34:35]
v_pk_add_f32 v[28:29], v[28:29], v[36:37]
v_pk_add_f32 v[30:31], v[30:31], v[38:39]
v_pk_add_f32 v[24:25], v[24:25], v[28:29]
v_pk_add_f32 v[26:27], v[26:27], v[30:31]
v_pk_mul_f32 v[24:25], v[24:25], v[12:13] op_sel:[0,0] op_sel_hi:[1,0]
v_pk_mul_f32 v[26:27], v[26:27], v[12:13] op_sel:[0,0] op_sel_hi:[1,0]
s_nop 0
v_add_f32_dpp v24, v24, v24 row_ror:1 row_mask:0xf bank_mask:0xf
v_add_f32_dpp v25, v25, v25 row_ror:1 row_mask:0xf bank_mask:0xf
v_add_f32_dpp v26, v26, v26 row_ror:1 row_mask:0xf bank_mask:0xf
v_add_f32_dpp v27, v27, v27 row_ror:1 row_mask:0xf bank_mask:0xf
v_add_f32_dpp v24, v24, v24 row_ror:2 row_mask:0xf bank_mask:0xf
v_add_f32_dpp v25, v25, v25 row_ror:2 row_mask:0xf bank_mask:0xf
v_add_f32_dpp v26, v26, v26 row_ror:2 row_mask:0xf bank_mask:0xf
v_add_f32_dpp v27, v27, v27 row_ror:2 row_mask:0xf bank_mask:0xf
v_add_f32_dpp v24, v24, v24 row_ror:4 row_mask:0xf bank_mask:0xf
v_add_f32_dpp v25, v25, v25 row_ror:4 row_mask:0xf bank_mask:0xf
v_add_f32_dpp v26, v26, v26 row_ror:4 row_mask:0xf bank_mask:0xf
v_add_f32_dpp v27, v27, v27 row_ror:4 row_mask:0xf bank_mask:0xf
v_add_f32_dpp v24, v24, v24 row_ror:8 row_mask:0xf bank_mask:0xf
v_add_f32_dpp v25, v25, v25 row_ror:8 row_mask:0xf bank_mask:0xf
v_add_f32_dpp v26, v26, v26 row_ror:8 row_mask:0xf bank_mask:0xf
v_add_f32_dpp v27, v27, v27 row_ror:8 row_mask:0xf bank_mask:0xf
v_mov_b32 v28, v24
v_mov_b32 v29, v25
v_mov_b32 v30, v26
v_mov_b32 v31, v27
v_permlane16_swap_b32 v28, v24
v_permlane16_swap_b32 v29, v25
v_permlane16_swap_b32 v30, v26
v_permlane16_swap_b32 v31, v27
v_add_f32 v24, v24, v28
v_add_f32 v25, v25, v29
v_add_f32 v26, v26, v30
v_add_f32 v27, v27, v31
v_mov_b32 v28, v24
v_mov_b32 v29, v25
v_mov_b32 v30, v26
v_mov_b32 v31, v27
v_permlane32_swap_b32 v28, v24
v_permlane32_swap_b32 v29, v25
v_permlane32_swap_b32 v30, v26
v_permlane32_swap_b32 v31, v27
v_add_f32 v24, v24, v28
v_add_f32 v25, v25, v29
v_add_f32 v26, v26, v30
v_add_f32 v27, v27, v31
v_pk_add_f32 v[24:25], v[24:25], v[40:41]
v_pk_add_f32 v[26:27], v[26:27], v[42:43]
v_cvt_pk_bf16_f32 v8, v24, v25
v_cvt_pk_bf16_f32 v9, v26, v27
s_mov_b64 exec, 1
s_cmp_eq_u32 s63, 0
s_cbranch_scc1 fl0_72
buffer_store_dwordx2 v[8:9], off, s[28:31], s70
s_mov_b64 exec, -1
s_branch L_end
fl0_72:
v_max_u32 v8, 1, v8
v_max_u32 v9, 1, v9
buffer_store_dwordx2 v[8:9], off, s[24:27], s71 sc1
s_mov_b64 exec, -1
s_waitcnt vmcnt(0)
fnr_71:
s_cmp_eq_u32 s63, 0
s_cbranch_scc0 L_end
v_add_u32 v5, s34, 4
s_mov_b64 exec, 1
ds_write_b32 v3, v5
s_mov_b64 exec, -1
v_and_b32 v6, 48, v0
v_lshlrev_b32 v6, 3, v6
s_lshl_b32 s70, s59, 11
s_add_u32 s70, s70, 393216
s_add_u32 s35, s34, 4
lw_76:
ds_read_b32 v5, v2 offset:24
s_waitcnt lgkmcnt(0)
v_cmp_gt_i32 vcc, s35, v5
s_cbranch_vccz lwd_77
s_sleep 2
s_sub_u32 s32, s32, 1
s_cmp_gt_i32 s32, 0
s_cbranch_scc1 lw_76
lwd_77:
poll_78:
buffer_load_dwordx2 v[8:9], v6, s[24:27], s70 offen offset:0 sc1
buffer_load_dwordx2 v[10:11], v6, s[24:27], s70 offen offset:512 sc1
buffer_load_dwordx2 v[12:13], v6, s[24:27], s70 offen offset:1024 sc1
buffer_load_dwordx2 v[14:15], v6, s[24:27], s70 offen offset:1536 sc1
pchk_79:
s_waitcnt vmcnt(2)
v_min3_u32 v7, v8, v9, v10
s_waitcnt vmcnt(1)
v_min3_u32 v7, v7, v11, v12
s_waitcnt vmcnt(0)
v_min3_u32 v7, v7, v13, v14
v_min_u32 v7, v7, v15
v_cmp_eq_u32 vcc, 0, v7
s_cbranch_vccz pdone_80
s_sub_u32 s32, s32, 1
s_cmp_gt_i32 s32, 0
s_cbranch_scc1 poll_78
pdone_80:
s_mov_b32 s63, 1
s_mov_b32 s34, 32
s_add_u32 s24, s24, 2359296
s_addc_u32 s25, s25, 0
s_mov_b32 s26, 2359296
s_mov_b32 s70, 131072
s_branch ftop_38
fst_41:
s_lshl4_add_u32 s70, s59, s60
s_lshl1_add_u32 s70, s70, s58
s_lshl_b32 s70, s70, 13
v_lshrrev_b32 v7, 4, v0
v_and_b32 v8, 15, v0
v_lshlrev_b32 v8, 4, v8
v_lshl_add_u32 v8, v7, 11, v8
buffer_load_dwordx4 v[24:27], v8, s[8:11], s70 offen offset:0
buffer_load_dwordx4 v[28:31], v8, s[8:11], s70 offen offset:256
buffer_load_dwordx4 v[32:35], v8, s[8:11], s70 offen offset:512
buffer_load_dwordx4 v[36:39], v8, s[8:11], s70 offen offset:768
buffer_load_dwordx4 v[40:43], v8, s[8:11], s70 offen offset:1024
buffer_load_dwordx4 v[44:47], v8, s[8:11], s70 offen offset:1280
buffer_load_dwordx4 v[48:51], v8, s[8:11], s70 offen offset:1536
buffer_load_dwordx4 v[52:55], v8, s[8:11], s70 offen offset:1792
v_lshlrev_b32 v9, 4, v1
v_mov_b32 v10, 0
v_mov_b32 v11, 0
s_waitcnt vmcnt(7)
v_dot2c_f32_bf16 v10, s69, v24
v_dot2c_f32_bf16 v11, v24, v24
v_dot2c_f32_bf16 v10, s69, v25
v_dot2c_f32_bf16 v11, v25, v25
v_dot2c_f32_bf16 v10, s69, v26
v_dot2c_f32_bf16 v11, v26, v26
v_dot2c_f32_bf16 v10, s69, v27
v_dot2c_f32_bf16 v11, v27, v27
s_waitcnt vmcnt(6)
v_dot2c_f32_bf16 v10, s69, v28
v_dot2c_f32_bf16 v11, v28, v28
v_dot2c_f32_bf16 v10, s69, v29
v_dot2c_f32_bf16 v11, v29, v29
v_dot2c_f32_bf16 v10, s69, v30
v_dot2c_f32_bf16 v11, v30, v30
v_dot2c_f32_bf16 v10, s69, v31
v_dot2c_f32_bf16 v11, v31, v31
s_waitcnt vmcnt(5)
v_dot2c_f32_bf16 v10, s69, v32
v_dot2c_f32_bf16 v11, v32, v32
v_dot2c_f32_bf16 v10, s69, v33
v_dot2c_f32_bf16 v11, v33, v33
v_dot2c_f32_bf16 v10, s69, v34
v_dot2c_f32_bf16 v11, v34, v34
v_dot2c_f32_bf16 v10, s69, v35
v_dot2c_f32_bf16 v11, v35, v35
s_waitcnt vmcnt(4)
v_dot2c_f32_bf16 v10, s69, v36
v_dot2c_f32_bf16 v11, v36, v36
v_dot2c_f32_bf16 v10, s69, v37
v_dot2c_f32_bf16 v11, v37, v37
v_dot2c_f32_bf16 v10, s69, v38
v_dot2c_f32_bf16 v11, v38, v38
v_dot2c_f32_bf16 v10, s69, v39
v_dot2c_f32_bf16 v11, v39, v39
s_waitcnt vmcnt(3)
v_dot2c_f32_bf16 v10, s69, v40
v_dot2c_f32_bf16 v11, v40, v40
v_dot2c_f32_bf16 v10, s69, v41
v_dot2c_f32_bf16 v11, v41, v41
v_dot2c_f32_bf16 v10, s69, v42
v_dot2c_f32_bf16 v11, v42, v42
v_dot2c_f32_bf16 v10, s69, v43
v_dot2c_f32_bf16 v11, v43, v43
s_waitcnt vmcnt(2)
v_dot2c_f32_bf16 v10, s69, v44
v_dot2c_f32_bf16 v11, v44, v44
v_dot2c_f32_bf16 v10, s69, v45
v_dot2c_f32_bf16 v11, v45, v45
v_dot2c_f32_bf16 v10, s69, v46
v_dot2c_f32_bf16 v11, v46, v46
v_dot2c_f32_bf16 v10, s69, v47
v_dot2c_f32_bf16 v11, v47, v47
s_waitcnt vmcnt(1)
v_dot2c_f32_bf16 v10, s69, v48
v_dot2c_f32_bf16 v11, v48, v48
v_dot2c_f32_bf16 v10, s69, v49
v_dot2c_f32_bf16 v11, v49, v49
v_dot2c_f32_bf16 v10, s69, v50
v_dot2c_f32_bf16 v11, v50, v50
v_dot2c_f32_bf16 v10, s69, v51
v_dot2c_f32_bf16 v11, v51, v51
s_waitcnt vmcnt(0)
v_dot2c_f32_bf16 v10, s69, v52
v_dot2c_f32_bf16 v11, v52, v52
v_dot2c_f32_bf16 v10, s69, v53
v_dot2c_f32_bf16 v11, v53, v53
v_dot2c_f32_bf16 v10, s69, v54
v_dot2c_f32_bf16 v11, v54, v54
v_dot2c_f32_bf16 v10, s69, v55
v_dot2c_f32_bf16 v11, v55, v55
s_nop 1
v_add_f32_dpp v10, v10, v10 row_ror:1 row_mask:0xf bank_mask:0xf
v_add_f32_dpp v11, v11, v11 row_ror:1 row_mask:0xf bank_mask:0xf
s_nop 0
v_add_f32_dpp v10, v10, v10 row_ror:2 row_mask:0xf bank_mask:0xf
v_add_f32_dpp v11, v11, v11 row_ror:2 row_mask:0xf bank_mask:0xf
s_nop 0
v_add_f32_dpp v10, v10, v10 row_ror:4 row_mask:0xf bank_mask:0xf
v_add_f32_dpp v11, v11, v11 row_ror:4 row_mask:0xf bank_mask:0xf
s_nop 0
v_add_f32_dpp v10, v10, v10 row_ror:8 row_mask:0xf bank_mask:0xf
v_add_f32_dpp v11, v11, v11 row_ror:8 row_mask:0xf bank_mask:0xf
v_mul_f32 v5, 0xba800000, v10
v_mul_f32 v11, 0x3a800000, v11
v_fma_f32 v11, -v5, v5, v11
v_max_f32 v11, 0, v11
v_add_f32 v11, 0x3727c5ac, v11
v_rsq_f32 v10, v11
s_nop 0
v_mul_f32 v11, v5, v10
v_max_u32 v11, 1, v11
s_lshl_b32 s70, s60, 7
s_add_u32 s70, s70, s76
s_lshl_b32 s73, s58, 5
s_add_u32 s70, s70, s73
v_lshlrev_b32 v7, 3, v7
s_add_u32 s35, s34, 5
lw_81:
ds_read_b32 v5, v2 offset:16
s_waitcnt lgkmcnt(0)
v_cmp_gt_i32 vcc, s35, v5
s_cbranch_vccz lwd_82
s_sleep 4
s_sub_u32 s32, s32, 1
s_cmp_gt_i32 s32, 0
s_cbranch_scc1 lw_81
lwd_82:
poll_83:
buffer_load_dword v12, v9, s[4:7], 0 offen sc1
pchk_84:
s_waitcnt vmcnt(0)
v_cmp_gt_u32 vcc, 64, v12
s_cbranch_vccz pdone_85
s_sub_u32 s32, s32, 1
s_cmp_gt_i32 s32, 0
s_cbranch_scc1 poll_83
pdone_85:
s_mov_b32 exec_lo, 0x10001
s_mov_b32 exec_hi, 0x10001
buffer_store_dwordx2 v[10:11], v7, s[24:27], s70 offen sc1
s_mov_b64 exec, -1
s_branch fsb_42
L_m:
s_setprio 2
v_mov_b32 v6, 0
v_mov_b32 v7, 0
v_lshlrev_b32 v8, 3, v0
ds_write_b64 v8, v[6:7]
s_waitcnt lgkmcnt(0)
s_barrier
s_lshr_b32 s64, s58, 1
s_and_b32 s65, s58, 1
v_and_b32 v1, 3, v0
v_lshlrev_b32 v1, 2, v1
v_and_b32 v2, 4, v1
s_lshl2_add_u32 s35, s58, 0
v_mov_b32 v3, s35
s_mov_b32 s4, s44
s_mov_b32 s5, s45
s_mov_b32 s6, 0x800
s_mov_b32 s7, 0x00020000
v_lshrrev_b32 v6, 4, v0
v_lshlrev_b32 v6, 3, v6
s_lshl_b32 s66, s62, 7
buffer_load_dwordx2 v[232:233], v6, s[4:7], s66 offen offset:0
buffer_load_dwordx2 v[234:235], v6, s[4:7], s66 offen offset:32
buffer_load_dwordx2 v[236:237], v6, s[4:7], s66 offen offset:64
buffer_load_dwordx2 v[238:239], v6, s[4:7], s66 offen offset:96
v_and_b32 v6, 31, v0
v_lshrrev_b32 v7, 5, v0
v_lshlrev_b32 v7, 3, v7
v_sub_u32 v6, v6, v7
v_mov_b32 v7, 0xf149f2ca
v_cmp_le_i32 vcc, 0, v6
s_nop 1
v_cndmask_b32 v216, 0, v7, vcc
v_cmp_le_i32 vcc, 1, v6
s_nop 1
v_cndmask_b32 v217, 0, v7, vcc
v_cmp_le_i32 vcc, 2, v6
s_nop 1
v_cndmask_b32 v218, 0, v7, vcc
v_cmp_le_i32 vcc, 3, v6
s_nop 1
v_cndmask_b32 v219, 0, v7, vcc
v_cmp_le_i32 vcc, 16, v6
s_nop 1
v_cndmask_b32 v220, 0, v7, vcc
v_cmp_le_i32 vcc, 17, v6
s_nop 1
v_cndmask_b32 v221, 0, v7, vcc
v_cmp_le_i32 vcc, 18, v6
s_nop 1
v_cndmask_b32 v222, 0, v7, vcc
v_cmp_le_i32 vcc, 19, v6
s_nop 1
v_cndmask_b32 v223, 0, v7, vcc
v_cmp_le_i32 vcc, 4, v6
s_nop 1
v_cndmask_b32 v224, 0, v7, vcc
v_cmp_le_i32 vcc, 5, v6
s_nop 1
v_cndmask_b32 v225, 0, v7, vcc
v_cmp_le_i32 vcc, 6, v6
s_nop 1
v_cndmask_b32 v226, 0, v7, vcc
v_cmp_le_i32 vcc, 7, v6
s_nop 1
v_cndmask_b32 v227, 0, v7, vcc
v_cmp_le_i32 vcc, 20, v6
s_nop 1
v_cndmask_b32 v228, 0, v7, vcc
v_cmp_le_i32 vcc, 21, v6
s_nop 1
v_cndmask_b32 v229, 0, v7, vcc
v_cmp_le_i32 vcc, 22, v6
s_nop 1
v_cndmask_b32 v230, 0, v7, vcc
v_cmp_le_i32 vcc, 23, v6
s_nop 1
v_cndmask_b32 v231, 0, v7, vcc
v_lshrrev_b32 v6, 2, v0
v_xor_b32 v6, v6, v0
v_and_b32 v6, 4, v6
v_mov_b32 v7, 0x3f803f80
v_cmp_eq_u32 vcc, 0, v6
s_nop 1
v_cndmask_b32 v212, 0, v7, vcc
v_cndmask_b32 v213, 0, v7, vcc
v_cndmask_b32 v214, 0, v7, vcc
v_cndmask_b32 v215, 0, v7, vcc
L_mtop:
v_lshrrev_b32 v10, 4, v0
s_cmp_eq_u32 s63, 0
s_cbranch_scc0 mq_86
v_bfe_u32 v11, v0, 1, 3
v_xor_b32 v11, v11, v10
v_lshlrev_b32 v11, 4, v11
v_and_b32 v12, 15, v0
v_lshl_add_u32 v6, v12, 7, v11
v_xor_b32 v7, 64, v6
s_branch mq_87
mq_86:
v_lshlrev_b32 v6, 4, v0
v_add_u32 v7, 1024, v6
mq_87:
s_lshl_b32 s66, s65, 13
s_add_u32 s66, s66, 86016
v_add_u32 v6, s66, v6
v_add_u32 v7, s66, v7
v_bfe_u32 v11, v0, 2, 2
v_lshl_add_u32 v11, v10, 3, v11
v_bfe_u32 v12, v0, 3, 2
s_lshl_b32 s66, s64, 1
v_xor_b32 v12, s66, v12
v_lshlrev_b32 v12, 5, v12
v_lshl_add_u32 v11, v11, 7, v12
v_and_b32 v12, 3, v0
v_lshl_add_u32 v11, v12, 3, v11
v_add_u32 v8, 102400, v11
v_xor_b32 v9, 32, v8
v_mov_b32 v11, 0xf149f2ca
v_xor_b32 v216, v11, v216
v_xor_b32 v217, v11, v217
v_xor_b32 v218, v11, v218
v_xor_b32 v219, v11, v219
v_xor_b32 v220, v11, v220
v_xor_b32 v221, v11, v221
v_xor_b32 v222, v11, v222
v_xor_b32 v223, v11, v223
v_xor_b32 v224, v11, v224
v_xor_b32 v225, v11, v225
v_xor_b32 v226, v11, v226
v_xor_b32 v227, v11, v227
v_xor_b32 v228, v11, v228
v_xor_b32 v229, v11, v229
v_xor_b32 v230, v11, v230
v_xor_b32 v231, v11, v231
v_mov_b32 v16, 0
v_mov_b32 v17, 0
v_mov_b32 v18, 0
v_mov_b32 v19, 0
v_mov_b32 v20, 0
v_mov_b32 v21, 0
v_mov_b32 v22, 0
v_mov_b32 v23, 0
v_mov_b32 v24, 0
v_mov_b32 v25, 0
v_mov_b32 v26, 0
v_mov_b32 v27, 0
v_mov_b32 v28, 0
v_mov_b32 v29, 0
v_mov_b32 v30, 0
v_mov_b32 v31, 0
v_mov_b32 v32, 0
v_mov_b32 v33, 0
v_mov_b32 v34, 0
v_mov_b32 v35, 0
v_mov_b32 v36, 0
v_mov_b32 v37, 0
v_mov_b32 v38, 0
v_mov_b32 v39, 0
v_mov_b32 v40, 0
v_mov_b32 v41, 0
v_mov_b32 v42, 0
v_mov_b32 v43, 0
v_mov_b32 v44, 0
v_mov_b32 v45, 0
v_mov_b32 v46, 0
v_mov_b32 v47, 0
v_mov_b32 v48, 0
v_mov_b32 v49, 0
v_mov_b32 v50, 0
v_mov_b32 v51, 0
v_mov_b32 v52, 0
v_mov_b32 v53, 0
v_mov_b32 v54, 0
v_mov_b32 v55, 0
v_mov_b32 v56, 0
v_mov_b32 v57, 0
v_mov_b32 v58, 0
v_mov_b32 v59, 0
v_mov_b32 v60, 0
v_mov_b32 v61, 0
v_mov_b32 v62, 0
v_mov_b32 v63, 0
v_mov_b32 v64, 0
v_mov_b32 v65, 0
v_mov_b32 v66, 0
v_mov_b32 v67, 0
v_mov_b32 v68, 0
v_mov_b32 v69, 0
v_mov_b32 v70, 0
v_mov_b32 v71, 0
v_mov_b32 v72, 0
v_mov_b32 v73, 0
v_mov_b32 v74, 0
v_mov_b32 v75, 0
v_mov_b32 v76, 0
v_mov_b32 v77, 0
v_mov_b32 v78, 0
v_mov_b32 v79, 0
v_mov_b32 v80, 0
v_mov_b32 v81, 0
v_mov_b32 v82, 0
v_mov_b32 v83, 0
v_mov_b32 v84, 0
v_mov_b32 v85, 0
v_mov_b32 v86, 0
v_mov_b32 v87, 0
v_mov_b32 v88, 0
v_mov_b32 v89, 0
v_mov_b32 v90, 0
v_mov_b32 v91, 0
v_mov_b32 v92, 0
v_mov_b32 v93, 0
v_mov_b32 v94, 0
v_mov_b32 v95, 0
v_mov_b32 v96, 0
v_mov_b32 v97, 0
v_mov_b32 v98, 0
v_mov_b32 v99, 0
v_mov_b32 v100, 0
v_mov_b32 v101, 0
v_mov_b32 v102, 0
v_mov_b32 v103, 0
v_mov_b32 v104, 0
v_mov_b32 v105, 0
v_mov_b32 v106, 0
v_mov_b32 v107, 0
v_mov_b32 v108, 0
v_mov_b32 v109, 0
v_mov_b32 v110, 0
v_mov_b32 v111, 0
v_mov_b32 v192, 0
v_mov_b32 v193, 0
v_mov_b32 v194, 0
v_mov_b32 v195, 0
v_mov_b32 v196, 0
v_mov_b32 v197, 0
v_mov_b32 v198, 0
v_mov_b32 v199, 0
v_mov_b32 v200, 0
v_mov_b32 v201, 0
v_mov_b32 v202, 0
v_mov_b32 v203, 0
v_mov_b32 v204, 0
v_mov_b32 v205, 0
v_mov_b32 v206, 0
v_mov_b32 v207, 0
v_mov_b32 v208, 0
v_mov_b32 v209, 0
v_mov_b32 v210, 0
v_mov_b32 v211, 0
v_add_u32 v4, s34, 1
s_mov_b32 s66, 16
s_mov_b32 s67, -40960
s_mov_b32 s68, -40960
s_mov_b32 s69, 81920
s_add_u32 s35, s34, 1
lw_88:
ds_read_b32 v5, v2 offset:16
s_waitcnt lgkmcnt(0)
v_cmp_gt_i32 vcc, s35, v5
s_cbranch_vccz lwd_89
s_sub_u32 s32, s32, 1
s_cmp_gt_i32 s32, 0
s_cbranch_scc1 lw_88
lwd_89:
ds_read_b64_tr_b16 v[144:145], v8 offset:8192
ds_read_b64_tr_b16 v[146:147], v8 offset:8704
ds_read_b64_tr_b16 v[148:149], v8 offset:12288
ds_read_b64_tr_b16 v[150:151], v8 offset:12800
ds_read_b128 v[112:115], v6 offset:0
ds_read_b128 v[116:119], v7 offset:0
ds_read_b64_tr_b16 v[152:153], v9 offset:8192
ds_read_b64_tr_b16 v[154:155], v9 offset:8704
ds_read_b64_tr_b16 v[156:157], v9 offset:12288
ds_read_b64_tr_b16 v[158:159], v9 offset:12800
ds_read_b128 v[120:123], v6 offset:2048
ds_read_b128 v[124:127], v7 offset:2048
ds_read_b128 v[128:131], v6 offset:4096
ds_read_b128 v[132:135], v7 offset:4096
ds_read_b128 v[136:139], v6 offset:6144
ds_read_b128 v[140:143], v7 offset:6144
.p2align 6
mqkv_90:
s_waitcnt lgkmcnt(7)
v_mfma_f32_16x16x32_bf16 v[16:19], v[144:147], v[112:115], v[16:19]
ds_read_b64_tr_b16 v[160:161], v8 offset:16384
s_waitcnt lgkmcnt(7)
v_mfma_f32_16x16x32_bf16 v[16:19], v[148:151], v[116:119], v[16:19]
ds_read_b64_tr_b16 v[162:163], v8 offset:16896
v_mfma_f32_16x16x32_bf16 v[20:23], v[152:155], v[112:115], v[20:23]
ds_read_b64_tr_b16 v[164:165], v8 offset:20480
v_mfma_f32_16x16x32_bf16 v[20:23], v[156:159], v[116:119], v[20:23]
ds_read_b64_tr_b16 v[166:167], v8 offset:20992
s_waitcnt lgkmcnt(9)
v_mfma_f32_16x16x32_bf16 v[24:27], v[144:147], v[120:123], v[24:27]
ds_read_b64_tr_b16 v[168:169], v9 offset:16384
s_waitcnt lgkmcnt(9)
v_mfma_f32_16x16x32_bf16 v[24:27], v[148:151], v[124:127], v[24:27]
ds_read_b64_tr_b16 v[170:171], v9 offset:16896
v_mfma_f32_16x16x32_bf16 v[28:31], v[152:155], v[120:123], v[28:31]
ds_read_b64_tr_b16 v[172:173], v9 offset:20480
v_mfma_f32_16x16x32_bf16 v[28:31], v[156:159], v[124:127], v[28:31]
ds_read_b64_tr_b16 v[174:175], v9 offset:20992
s_waitcnt lgkmcnt(11)
v_mfma_f32_16x16x32_bf16 v[32:35], v[144:147], v[128:131], v[32:35]
ds_read_b64_tr_b16 v[176:177], v8 offset:0
s_waitcnt lgkmcnt(11)
v_mfma_f32_16x16x32_bf16 v[32:35], v[148:151], v[132:135], v[32:35]
ds_read_b64_tr_b16 v[178:179], v8 offset:512
v_mfma_f32_16x16x32_bf16 v[36:39], v[152:155], v[128:131], v[36:39]
ds_read_b64_tr_b16 v[180:181], v8 offset:4096
v_mfma_f32_16x16x32_bf16 v[36:39], v[156:159], v[132:135], v[36:39]
ds_read_b64_tr_b16 v[182:183], v8 offset:4608
s_waitcnt lgkmcnt(13)
v_mfma_f32_16x16x32_bf16 v[40:43], v[144:147], v[136:139], v[40:43]
ds_read_b64_tr_b16 v[184:185], v9 offset:0
s_waitcnt lgkmcnt(13)
v_mfma_f32_16x16x32_bf16 v[40:43], v[148:151], v[140:143], v[40:43]
ds_read_b64_tr_b16 v[186:187], v9 offset:512
v_mfma_f32_16x16x32_bf16 v[44:47], v[152:155], v[136:139], v[44:47]
ds_read_b64_tr_b16 v[188:189], v9 offset:4096
v_mfma_f32_16x16x32_bf16 v[44:47], v[156:159], v[140:143], v[44:47]
ds_read_b64_tr_b16 v[190:191], v9 offset:4608
s_waitcnt lgkmcnt(14)
v_mfma_f32_16x16x32_bf16 v[48:51], v[112:115], v[160:163], v[48:51]
s_mov_b64 exec, 1
ds_write_b32 v3, v4
s_mov_b64 exec, -1
s_waitcnt lgkmcnt(13)
v_mfma_f32_16x16x32_bf16 v[48:51], v[116:119], v[164:167], v[48:51]
v_add_u32 v8, s67, v8
v_add_u32 v9, s67, v9
s_waitcnt lgkmcnt(11)
v_mfma_f32_16x16x32_bf16 v[52:55], v[112:115], v[168:171], v[52:55]
v_add_u32 v6, s67, v6
v_add_u32 v7, s67, v7
s_waitcnt lgkmcnt(9)
v_mfma_f32_16x16x32_bf16 v[52:55], v[116:119], v[172:175], v[52:55]
s_mov_b32 s70, s67
s_mov_b32 s67, s68
s_mov_b32 s68, s69
s_mov_b32 s69, s70
v_mfma_f32_16x16x32_bf16 v[56:59], v[120:123], v[160:163], v[56:59]
ds_read_b32 v5, v2 offset:16
v_mfma_f32_16x16x32_bf16 v[56:59], v[124:127], v[164:167], v[56:59]
v_mfma_f32_16x16x32_bf16 v[60:63], v[120:123], v[168:171], v[60:63]
v_mfma_f32_16x16x32_bf16 v[60:63], v[124:127], v[172:175], v[60:63]
v_mfma_f32_16x16x32_bf16 v[64:67], v[128:131], v[160:163], v[64:67]
s_waitcnt lgkmcnt(0)
v_cmp_ge_u32 vcc, v4, v5
s_cbranch_vccnz mspin_91
mback_92:
v_add_u32 v4, 1, v4
v_mfma_f32_16x16x32_bf16 v[64:67], v[132:135], v[164:167], v[64:67]
ds_read_b64_tr_b16 v[144:145], v8 offset:8192
v_mfma_f32_16x16x32_bf16 v[68:71], v[128:131], v[168:171], v[68:71]
ds_read_b64_tr_b16 v[146:147], v8 offset:8704
v_mfma_f32_16x16x32_bf16 v[68:71], v[132:135], v[172:175], v[68:71]
ds_read_b64_tr_b16 v[148:149], v8 offset:12288
v_mfma_f32_16x16x32_bf16 v[72:75], v[136:139], v[160:163], v[72:75]
ds_read_b64_tr_b16 v[150:151], v8 offset:12800
v_mfma_f32_16x16x32_bf16 v[72:75], v[140:143], v[164:167], v[72:75]
ds_read_b64_tr_b16 v[152:153], v9 offset:8192
v_mfma_f32_16x16x32_bf16 v[76:79], v[136:139], v[168:171], v[76:79]
ds_read_b64_tr_b16 v[154:155], v9 offset:8704
v_mfma_f32_16x16x32_bf16 v[76:79], v[140:143], v[172:175], v[76:79]
ds_read_b64_tr_b16 v[156:157], v9 offset:12288
v_mfma_f32_16x16x32_bf16 v[80:83], v[176:179], v[112:115], v[80:83]
ds_read_b64_tr_b16 v[158:159], v9 offset:12800
v_mfma_f32_16x16x32_bf16 v[80:83], v[180:183], v[116:119], v[80:83]
v_mfma_f32_16x16x32_bf16 v[84:87], v[184:187], v[112:115], v[84:87]
v_mfma_f32_16x16x32_bf16 v[84:87], v[188:191], v[116:119], v[84:87]
ds_read_b128 v[112:115], v6 offset:0
ds_read_b128 v[116:119], v7 offset:0
v_mfma_f32_16x16x32_bf16 v[88:91], v[176:179], v[120:123], v[88:91]
v_mfma_f32_16x16x32_bf16 v[88:91], v[180:183], v[124:127], v[88:91]
v_mfma_f32_16x16x32_bf16 v[92:95], v[184:187], v[120:123], v[92:95]
v_mfma_f32_16x16x32_bf16 v[92:95], v[188:191], v[124:127], v[92:95]
ds_read_b128 v[120:123], v6 offset:2048
ds_read_b128 v[124:127], v7 offset:2048
v_mfma_f32_16x16x32_bf16 v[96:99], v[176:179], v[128:131], v[96:99]
v_mfma_f32_16x16x32_bf16 v[96:99], v[180:183], v[132:135], v[96:99]
v_mfma_f32_16x16x32_bf16 v[100:103], v[184:187], v[128:131], v[100:103]
v_mfma_f32_16x16x32_bf16 v[100:103], v[188:191], v[132:135], v[100:103]
ds_read_b128 v[128:131], v6 offset:4096
ds_read_b128 v[132:135], v7 offset:4096
v_mfma_f32_16x16x32_bf16 v[104:107], v[176:179], v[136:139], v[104:107]
v_mfma_f32_16x16x32_bf16 v[104:107], v[180:183], v[140:143], v[104:107]
s_sub_u32 s66, s66, 1
s_cmp_eq_u32 s66, 0
v_mfma_f32_16x16x32_bf16 v[108:111], v[184:187], v[136:139], v[108:111]
v_mfma_f32_16x16x32_bf16 v[108:111], v[188:191], v[140:143], v[108:111]
ds_read_b128 v[136:139], v6 offset:6144
ds_read_b128 v[140:143], v7 offset:6144
s_cbranch_scc0 mqkv_90
v_and_b32 v10, 15, v0
v_lshrrev_b32 v11, 4, v0
s_lshl_b32 s66, s65, 8
s_add_u32 s66, s66, 1280
s_mul_i32 s67, s64, 384
v_lshl_add_u32 v6, v10, 2, s66
v_lshl_add_u32 v7, v11, 4, s66
v_lshl_add_u32 v8, v10, 2, s67
v_lshl_add_u32 v9, v11, 4, s67
v_and_b32 v12, 1, v11
v_lshrrev_b32 v11, 1, v11
v_lshlrev_b32 v11, 9, v11
v_lshl_add_u32 v11, v12, 10, v11
s_lshl_b32 s66, s64, 12
s_lshl_b32 s67, s65, 13
s_add_u32 s66, s66, 131072
s_add_u32 s68, s66, 24576
s_sub_u32 s68, s68, s67
s_add_u32 s67, s66, s67
v_lshl_add_u32 v14, v10, 4, v11
v_and_b32 v12, 3, v0
v_lshl_add_u32 v11, v12, 4, v11
v_bfe_u32 v12, v0, 3, 1
v_lshl_add_u32 v11, v12, 6, v11
v_bfe_u32 v12, v0, 2, 1
v_lshl_add_u32 v12, v12, 8, v11
v_add_u32 v13, s68, v12
v_add_u32 v12, s67, v12
v_add_u32 v15, s68, v14
v_add_u32 v14, s67, v14
s_lshl_b32 s66, s59, 4
s_add_u32 s66, s66, s60
s_lshl_b32 s72, s66, 7
s_lshl_b32 s66, s66, 15
s_lshl_b32 s67, s63, 23
s_add_u32 s66, s66, s67
s_add_u32 s71, s66, 917504
s_add_u32 s35, s34, 2
lw_93:
ds_read_b32 v5, v2 offset:24
s_waitcnt lgkmcnt(0)
v_cmp_gt_i32 vcc, s35, v5
s_cbranch_vccz lwd_94
s_sub_u32 s32, s32, 1
s_cmp_gt_i32 s32, 0
s_cbranch_scc1 lw_93
lwd_94:
v_mov_b32 v10, 0
ds_read_b32 v10, v10 offset:32
ds_read2_b32 v[144:145], v6 offset0:0 offset1:128
ds_read2_b32 v[146:147], v6 offset0:16 offset1:144
ds_read2_b32 v[148:149], v6 offset0:32 offset1:160
ds_read2_b32 v[150:151], v6 offset0:48 offset1:176
ds_read_b128 v[152:155], v9 offset:2432
ds_read_b128 v[156:159], v9 offset:2496
ds_read_b32 v168, v8 offset:2560
ds_read_b32 v169, v8 offset:2624
ds_read_b128 v[112:115], v7 offset:0
ds_read_b128 v[128:131], v7 offset:512
ds_read_b128 v[116:119], v7 offset:64
ds_read_b128 v[132:135], v7 offset:576
s_waitcnt lgkmcnt(12)
v_readfirstlane_b32 s33, v10
s_sub_u32 s33, s33, 1
s_lshr_b32 s66, s33, 7
s_cmp_eq_u32 s66, s59
s_cbranch_scc1 patch_95
pback_96:
s_waitcnt lgkmcnt(11)
v_pk_mul_f32 v[16:17], v[16:17], v[144:145] op_sel:[0,0] op_sel_hi:[1,0]
v_pk_mul_f32 v[18:19], v[18:19], v[144:145] op_sel:[0,0] op_sel_hi:[1,0]
v_pk_mul_f32 v[20:21], v[20:21], v[144:145] op_sel:[0,0] op_sel_hi:[1,0]
v_pk_mul_f32 v[22:23], v[22:23], v[144:145] op_sel:[0,0] op_sel_hi:[1,0]
s_waitcnt lgkmcnt(7)
v_pk_fma_f32 v[16:17], v[152:153], v[144:145], v[16:17] op_sel:[0,1,0] op_sel_hi:[1,1,1]
v_pk_fma_f32 v[18:19], v[154:155], v[144:145], v[18:19] op_sel:[0,1,0] op_sel_hi:[1,1,1]
s_waitcnt lgkmcnt(6)
v_pk_fma_f32 v[20:21], v[156:157], v[144:145], v[20:21] op_sel:[0,1,0] op_sel_hi:[1,1,1]
v_pk_fma_f32 v[22:23], v[158:159], v[144:145], v[22:23] op_sel:[0,1,0] op_sel_hi:[1,1,1]
v_cvt_pk_bf16_f32 v16, v16, v17
v_cvt_pk_bf16_f32 v17, v18, v19
v_cvt_pk_bf16_f32 v18, v20, v21
v_cvt_pk_bf16_f32 v19, v22, v23
buffer_store_dwordx4 v[16:19], v12, s[20:23], s71 offen offset:0 sc1
ds_write_b128 v12, v[16:19] offset:0
ds_read_b128 v[120:123], v7 offset:128
ds_read_b128 v[136:139], v7 offset:640
ds_read_b128 v[124:127], v7 offset:192
ds_read_b128 v[140:143], v7 offset:704
ds_read_b128 v[160:163], v9 offset:2304
ds_read_b128 v[164:167], v9 offset:2368
v_pk_mul_f32 v[24:25], v[24:25], v[146:147] op_sel:[0,0] op_sel_hi:[1,0]
v_pk_mul_f32 v[26:27], v[26:27], v[146:147] op_sel:[0,0] op_sel_hi:[1,0]
v_pk_mul_f32 v[28:29], v[28:29], v[146:147] op_sel:[0,0] op_sel_hi:[1,0]
v_pk_mul_f32 v[30:31], v[30:31], v[146:147] op_sel:[0,0] op_sel_hi:[1,0]
v_pk_fma_f32 v[24:25], v[152:153], v[146:147], v[24:25] op_sel:[0,1,0] op_sel_hi:[1,1,1]
v_pk_fma_f32 v[26:27], v[154:155], v[146:147], v[26:27] op_sel:[0,1,0] op_sel_hi:[1,1,1]
v_pk_fma_f32 v[28:29], v[156:157], v[146:147], v[28:29] op_sel:[0,1,0] op_sel_hi:[1,1,1]
v_pk_fma_f32 v[30:31], v[158:159], v[146:147], v[30:31] op_sel:[0,1,0] op_sel_hi:[1,1,1]
v_cvt_pk_bf16_f32 v24, v24, v25
v_cvt_pk_bf16_f32 v25, v26, v27
v_cvt_pk_bf16_f32 v26, v28, v29
v_cvt_pk_bf16_f32 v27, v30, v31
buffer_store_dwordx4 v[24:27], v12, s[20:23], s71 offen offset:128 sc1
ds_write_b128 v12, v[24:27] offset:128
v_pk_mul_f32 v[32:33], v[32:33], v[148:149] op_sel:[0,0] op_sel_hi:[1,0]
v_pk_mul_f32 v[34:35], v[34:35], v[148:149] op_sel:[0,0] op_sel_hi:[1,0]
v_pk_mul_f32 v[36:37], v[36:37], v[148:149] op_sel:[0,0] op_sel_hi:[1,0]
v_pk_mul_f32 v[38:39], v[38:39], v[148:149] op_sel:[0,0] op_sel_hi:[1,0]
v_pk_fma_f32 v[32:33], v[152:153], v[148:149], v[32:33] op_sel:[0,1,0] op_sel_hi:[1,1,1]
v_pk_fma_f32 v[34:35], v[154:155], v[148:149], v[34:35] op_sel:[0,1,0] op_sel_hi:[1,1,1]
v_pk_fma_f32 v[36:37], v[156:157], v[148:149], v[36:37] op_sel:[0,1,0] op_sel_hi:[1,1,1]
v_pk_fma_f32 v[38:39], v[158:159], v[148:149], v[38:39] op_sel:[0,1,0] op_sel_hi:[1,1,1]
v_cvt_pk_bf16_f32 v32, v32, v33
v_cvt_pk_bf16_f32 v33, v34, v35
v_cvt_pk_bf16_f32 v34, v36, v37
v_cvt_pk_bf16_f32 v35, v38, v39
buffer_store_dwordx4 v[32:35], v13, s[20:23], s71 offen offset:0 sc1
ds_write_b128 v13, v[32:35] offset:0
v_pk_mul_f32 v[40:41], v[40:41], v[150:151] op_sel:[0,0] op_sel_hi:[1,0]
v_pk_mul_f32 v[42:43], v[42:43], v[150:151] op_sel:[0,0] op_sel_hi:[1,0]
v_pk_mul_f32 v[44:45], v[44:45], v[150:151] op_sel:[0,0] op_sel_hi:[1,0]
v_pk_mul_f32 v[46:47], v[46:47], v[150:151] op_sel:[0,0] op_sel_hi:[1,0]
v_pk_fma_f32 v[40:41], v[152:153], v[150:151], v[40:41] op_sel:[0,1,0] op_sel_hi:[1,1,1]
v_pk_fma_f32 v[42:43], v[154:155], v[150:151], v[42:43] op_sel:[0,1,0] op_sel_hi:[1,1,1]
v_pk_fma_f32 v[44:45], v[156:157], v[150:151], v[44:45] op_sel:[0,1,0] op_sel_hi:[1,1,1]
v_pk_fma_f32 v[46:47], v[158:159], v[150:151], v[46:47] op_sel:[0,1,0] op_sel_hi:[1,1,1]
v_cvt_pk_bf16_f32 v40, v40, v41
v_cvt_pk_bf16_f32 v41, v42, v43
v_cvt_pk_bf16_f32 v42, v44, v45
v_cvt_pk_bf16_f32 v43, v46, v47
buffer_store_dwordx4 v[40:43], v13, s[20:23], s71 offen offset:128 sc1
ds_write_b128 v13, v[40:43] offset:128
s_waitcnt lgkmcnt(13)
v_pk_mul_f32 v[48:49], v[48:49], v[112:113]
v_pk_mul_f32 v[50:51], v[50:51], v[114:115]
s_waitcnt lgkmcnt(12)
v_pk_fma_f32 v[48:49], v[128:129], v[168:169], v[48:49] op_sel:[0,0,0] op_sel_hi:[1,0,1]
v_pk_fma_f32 v[50:51], v[130:131], v[168:169], v[50:51] op_sel:[0,0,0] op_sel_hi:[1,0,1]
s_waitcnt lgkmcnt(11)
v_pk_mul_f32 v[56:57], v[56:57], v[116:117]
v_pk_mul_f32 v[58:59], v[58:59], v[118:119]
s_waitcnt lgkmcnt(10)
v_pk_fma_f32 v[56:57], v[132:133], v[168:169], v[56:57] op_sel:[0,0,0] op_sel_hi:[1,0,1]
v_pk_fma_f32 v[58:59], v[134:135], v[168:169], v[58:59] op_sel:[0,0,0] op_sel_hi:[1,0,1]
v_cvt_pk_bf16_f32 v48, v48, v49
v_cvt_pk_bf16_f32 v49, v50, v51
v_cvt_pk_bf16_f32 v50, v56, v57
v_cvt_pk_bf16_f32 v51, v58, v59
buffer_store_dwordx4 v[48:51], v14, s[20:23], s71 offen offset:2048 sc1
ds_write_b128 v14, v[48:51] offset:2048
v_pk_mul_f32 v[52:53], v[52:53], v[112:113]
v_pk_mul_f32 v[54:55], v[54:55], v[114:115]
v_pk_fma_f32 v[52:53], v[128:129], v[168:169], v[52:53] op_sel:[0,1,0] op_sel_hi:[1,1,1]
v_pk_fma_f32 v[54:55], v[130:131], v[168:169], v[54:55] op_sel:[0,1,0] op_sel_hi:[1,1,1]
v_pk_mul_f32 v[60:61], v[60:61], v[116:117]
v_pk_mul_f32 v[62:63], v[62:63], v[118:119]
v_pk_fma_f32 v[60:61], v[132:133], v[168:169], v[60:61] op_sel:[0,1,0] op_sel_hi:[1,1,1]
v_pk_fma_f32 v[62:63], v[134:135], v[168:169], v[62:63] op_sel:[0,1,0] op_sel_hi:[1,1,1]
v_cvt_pk_bf16_f32 v52, v52, v53
v_cvt_pk_bf16_f32 v53, v54, v55
v_cvt_pk_bf16_f32 v54, v60, v61
v_cvt_pk_bf16_f32 v55, v62, v63
buffer_store_dwordx4 v[52:55], v14, s[20:23], s71 offen offset:2304 sc1
ds_write_b128 v14, v[52:55] offset:2304
s_waitcnt lgkmcnt(10)
v_pk_mul_f32 v[64:65], v[64:65], v[120:121]
v_pk_mul_f32 v[66:67], v[66:67], v[122:123]
s_waitcnt lgkmcnt(9)
v_pk_fma_f32 v[64:65], v[136:137], v[168:169], v[64:65] op_sel:[0,0,0] op_sel_hi:[1,0,1]
v_pk_fma_f32 v[66:67], v[138:139], v[168:169], v[66:67] op_sel:[0,0,0] op_sel_hi:[1,0,1]
s_waitcnt lgkmcnt(8)
v_pk_mul_f32 v[72:73], v[72:73], v[124:125]
v_pk_mul_f32 v[74:75], v[74:75], v[126:127]
s_waitcnt lgkmcnt(7)
v_pk_fma_f32 v[72:73], v[140:141], v[168:169], v[72:73] op_sel:[0,0,0] op_sel_hi:[1,0,1]
v_pk_fma_f32 v[74:75], v[142:143], v[168:169], v[74:75] op_sel:[0,0,0] op_sel_hi:[1,0,1]
v_cvt_pk_bf16_f32 v64, v64, v65
v_cvt_pk_bf16_f32 v65, v66, v67
v_cvt_pk_bf16_f32 v66, v72, v73
v_cvt_pk_bf16_f32 v67, v74, v75
buffer_store_dwordx4 v[64:67], v15, s[20:23], s71 offen offset:2048 sc1
ds_write_b128 v15, v[64:67] offset:2048
v_pk_mul_f32 v[68:69], v[68:69], v[120:121]
v_pk_mul_f32 v[70:71], v[70:71], v[122:123]
v_pk_fma_f32 v[68:69], v[136:137], v[168:169], v[68:69] op_sel:[0,1,0] op_sel_hi:[1,1,1]
v_pk_fma_f32 v[70:71], v[138:139], v[168:169], v[70:71] op_sel:[0,1,0] op_sel_hi:[1,1,1]
v_pk_mul_f32 v[76:77], v[76:77], v[124:125]
v_pk_mul_f32 v[78:79], v[78:79], v[126:127]
v_pk_fma_f32 v[76:77], v[140:141], v[168:169], v[76:77] op_sel:[0,1,0] op_sel_hi:[1,1,1]
v_pk_fma_f32 v[78:79], v[142:143], v[168:169], v[78:79] op_sel:[0,1,0] op_sel_hi:[1,1,1]
v_cvt_pk_bf16_f32 v68, v68, v69
v_cvt_pk_bf16_f32 v69, v70, v71
v_cvt_pk_bf16_f32 v70, v76, v77
v_cvt_pk_bf16_f32 v71, v78, v79
buffer_store_dwordx4 v[68:71], v15, s[20:23], s71 offen offset:2304 sc1
ds_write_b128 v15, v[68:71] offset:2304
v_add_u32 v5, s34, 17
s_mov_b64 exec, 1
ds_write_b32 v3, v5
s_mov_b64 exec, -1
s_mov_b32 s66, 0x3e8293ee
v_mul_f32 v144, s66, v144
v_mul_f32 v145, s66, v145
v_mul_f32 v146, s66, v146
v_mul_f32 v147, s66, v147
v_mul_f32 v148, s66, v148
v_mul_f32 v149, s66, v149
v_mul_f32 v150, s66, v150
v_mul_f32 v151, s66, v151
v_pk_mul_f32 v[96:97], v[96:97], v[148:149] op_sel:[0,0] op_sel_hi:[1,0]
v_pk_mul_f32 v[98:99], v[98:99], v[148:149] op_sel:[0,0] op_sel_hi:[1,0]
v_pk_mul_f32 v[100:101], v[100:101], v[148:149] op_sel:[0,0] op_sel_hi:[1,0]
v_pk_mul_f32 v[102:103], v[102:103], v[148:149] op_sel:[0,0] op_sel_hi:[1,0]
s_waitcnt lgkmcnt(9)
v_pk_fma_f32 v[96:97], v[160:161], v[148:149], v[96:97] op_sel:[0,1,0] op_sel_hi:[1,1,1]
v_pk_fma_f32 v[98:99], v[162:163], v[148:149], v[98:99] op_sel:[0,1,0] op_sel_hi:[1,1,1]
s_waitcnt lgkmcnt(8)
v_pk_fma_f32 v[100:101], v[164:165], v[148:149], v[100:101] op_sel:[0,1,0] op_sel_hi:[1,1,1]
v_pk_fma_f32 v[102:103], v[166:167], v[148:149], v[102:103] op_sel:[0,1,0] op_sel_hi:[1,1,1]
v_cvt_pk_bf16_f32 v96, v96, v97
v_cvt_pk_bf16_f32 v97, v98, v99
v_cvt_pk_bf16_f32 v98, v100, v101
v_cvt_pk_bf16_f32 v99, v102, v103
v_pk_mul_f32 v[104:105], v[104:105], v[150:151] op_sel:[0,0] op_sel_hi:[1,0]
v_pk_mul_f32 v[106:107], v[106:107], v[150:151] op_sel:[0,0] op_sel_hi:[1,0]
v_pk_mul_f32 v[108:109], v[108:109], v[150:151] op_sel:[0,0] op_sel_hi:[1,0]
v_pk_mul_f32 v[110:111], v[110:111], v[150:151] op_sel:[0,0] op_sel_hi:[1,0]
v_pk_fma_f32 v[104:105], v[160:161], v[150:151], v[104:105] op_sel:[0,1,0] op_sel_hi:[1,1,1]
v_pk_fma_f32 v[106:107], v[162:163], v[150:151], v[106:107] op_sel:[0,1,0] op_sel_hi:[1,1,1]
v_pk_fma_f32 v[108:109], v[164:165], v[150:151], v[108:109] op_sel:[0,1,0] op_sel_hi:[1,1,1]
v_pk_fma_f32 v[110:111], v[166:167], v[150:151], v[110:111] op_sel:[0,1,0] op_sel_hi:[1,1,1]
v_cvt_pk_bf16_f32 v104, v104, v105
v_cvt_pk_bf16_f32 v105, v106, v107
v_cvt_pk_bf16_f32 v106, v108, v109
v_cvt_pk_bf16_f32 v107, v110, v111
v_pk_mul_f32 v[80:81], v[80:81], v[144:145] op_sel:[0,0] op_sel_hi:[1,0]
v_pk_mul_f32 v[82:83], v[82:83], v[144:145] op_sel:[0,0] op_sel_hi:[1,0]
v_pk_mul_f32 v[84:85], v[84:85], v[144:145] op_sel:[0,0] op_sel_hi:[1,0]
v_pk_mul_f32 v[86:87], v[86:87], v[144:145] op_sel:[0,0] op_sel_hi:[1,0]
v_pk_fma_f32 v[80:81], v[160:161], v[144:145], v[80:81] op_sel:[0,1,0] op_sel_hi:[1,1,1]
v_pk_fma_f32 v[82:83], v[162:163], v[144:145], v[82:83] op_sel:[0,1,0] op_sel_hi:[1,1,1]
v_pk_fma_f32 v[84:85], v[164:165], v[144:145], v[84:85] op_sel:[0,1,0] op_sel_hi:[1,1,1]
v_pk_fma_f32 v[86:87], v[166:167], v[144:145], v[86:87] op_sel:[0,1,0] op_sel_hi:[1,1,1]
v_cvt_pk_bf16_f32 v80, v80, v81
v_cvt_pk_bf16_f32 v81, v82, v83
v_cvt_pk_bf16_f32 v82, v84, v85
v_cvt_pk_bf16_f32 v83, v86, v87
v_pk_mul_f32 v[88:89], v[88:89], v[146:147] op_sel:[0,0] op_sel_hi:[1,0]
v_pk_mul_f32 v[90:91], v[90:91], v[146:147] op_sel:[0,0] op_sel_hi:[1,0]
v_pk_mul_f32 v[92:93], v[92:93], v[146:147] op_sel:[0,0] op_sel_hi:[1,0]
v_pk_mul_f32 v[94:95], v[94:95], v[146:147] op_sel:[0,0] op_sel_hi:[1,0]
v_pk_fma_f32 v[88:89], v[160:161], v[146:147], v[88:89] op_sel:[0,1,0] op_sel_hi:[1,1,1]
v_pk_fma_f32 v[90:91], v[162:163], v[146:147], v[90:91] op_sel:[0,1,0] op_sel_hi:[1,1,1]
v_pk_fma_f32 v[92:93], v[164:165], v[146:147], v[92:93] op_sel:[0,1,0] op_sel_hi:[1,1,1]
v_pk_fma_f32 v[94:95], v[166:167], v[146:147], v[94:95] op_sel:[0,1,0] op_sel_hi:[1,1,1]
v_cvt_pk_bf16_f32 v88, v88, v89
v_cvt_pk_bf16_f32 v89, v90, v91
v_cvt_pk_bf16_f32 v90, v92, v93
v_cvt_pk_bf16_f32 v91, v94, v95
v_permlane16_swap_b32 v96, v104
v_permlane16_swap_b32 v97, v105
v_permlane16_swap_b32 v98, v106
v_permlane16_swap_b32 v99, v107
v_permlane16_swap_b32 v80, v88
v_permlane16_swap_b32 v81, v89
v_permlane16_swap_b32 v82, v90
v_permlane16_swap_b32 v83, v91
s_lshl_b32 s69, s64, 12
v_lshl_add_u32 v6, v0, 4, s69
v_add_u32 v7, 131072, v6
s_lshl_b32 s69, s65, 13
s_add_u32 s66, s69, 131072
s_sub_u32 s69, 147456, s69
v_add_u32 v8, s69, v6
ds_read_b128 v[152:155], v8 offset:8192
ds_read_b128 v[156:159], v8 offset:9216
s_mov_b32 s67, 122880
s_min_u32 s69, s59, 1
s_lshl2_add_u32 s68, s69, s65
s_cmp_ge_u32 s59, 2
s_cselect_b32 s69, s65, 0
s_add_u32 s68, s68, s69
ds_read_b128 v[160:163], v8 offset:10240
ds_read_b128 v[164:167], v8 offset:11264
s_waitcnt lgkmcnt(3)
v_mfma_f32_32x32x16_bf16 v[112:127], v[152:155], v[96:99], v[216:231]
s_waitcnt lgkmcnt(2)
v_mfma_f32_32x32x16_bf16 v[112:127], v[156:159], v[104:107], v[112:127]
s_add_u32 s35, s34, 17
lw_97:
ds_read_b32 v5, v1 offset:0
s_waitcnt lgkmcnt(0)
v_cmp_gt_i32 vcc, s35, v5
s_cbranch_vccz lwd_98
s_sub_u32 s32, s32, 1
s_cmp_gt_i32 s32, 0
s_cbranch_scc1 lw_97
lwd_98:
ds_read_b128 v[152:155], v8 offset:0
ds_read_b128 v[156:159], v8 offset:1024
.p2align 3
s_nop 4
v_exp_f32 v112, v112
v_exp_f32 v113, v113
v_exp_f32 v114, v114
v_exp_f32 v115, v115
v_exp_f32 v116, v116
v_exp_f32 v117, v117
s_waitcnt lgkmcnt(1)
v_mfma_f32_32x32x16_bf16 v[128:143], v[152:155], v[96:99], 0
v_exp_f32 v118, v118
v_exp_f32 v119, v119
v_cvt_pk_bf16_f32 v144, v112, v113
v_cvt_pk_bf16_f32 v145, v114, v115
s_waitcnt lgkmcnt(0)
v_mfma_f32_32x32x16_bf16 v[128:143], v[156:159], v[104:107], v[128:143]
ds_read_b128 v[152:155], v7 offset:8192
ds_read_b128 v[156:159], v7 offset:9216
v_cvt_pk_bf16_f32 v146, v116, v117
v_cvt_pk_bf16_f32 v147, v118, v119
v_exp_f32 v120, v120
v_exp_f32 v121, v121
v_mfma_f32_32x32x16_bf16 v[16:31], v[160:163], v[144:147], 0
ds_read_b128 v[160:163], v8 offset:2048
v_exp_f32 v122, v122
v_exp_f32 v123, v123
v_exp_f32 v124, v124
v_mfma_f32_16x16x32_bf16 v[32:35], v[212:215], v[144:147], 0
s_cmp_eq_u32 s65, 1
v_exp_f32 v125, v125
v_exp_f32 v126, v126
v_exp_f32 v127, v127
v_cvt_pk_bf16_f32 v148, v120, v121
v_cvt_pk_bf16_f32 v149, v122, v123
v_cvt_pk_bf16_f32 v150, v124, v125
v_cvt_pk_bf16_f32 v151, v126, v127
s_cbranch_scc1 at_99
v_exp_f32 v128, v128
v_exp_f32 v129, v129
v_mfma_f32_32x32x16_bf16 v[16:31], v[164:167], v[148:151], v[16:31]
ds_read_b128 v[164:167], v8 offset:3072
v_exp_f32 v130, v130
v_exp_f32 v131, v131
v_exp_f32 v132, v132
v_mfma_f32_16x16x32_bf16 v[32:35], v[212:215], v[148:151], v[32:35]
v_exp_f32 v133, v133
s_waitcnt lgkmcnt(3)
v_mfma_f32_32x32x16_bf16 v[112:127], v[152:155], v[96:99], 0
v_exp_f32 v134, v134
v_exp_f32 v135, v135
v_cvt_pk_bf16_f32 v144, v128, v129
v_cvt_pk_bf16_f32 v145, v130, v131
s_waitcnt lgkmcnt(2)
v_mfma_f32_32x32x16_bf16 v[112:127], v[156:159], v[104:107], v[112:127]
ds_read_b128 v[152:155], v7 offset:0
ds_read_b128 v[156:159], v7 offset:1024
v_cvt_pk_bf16_f32 v146, v132, v133
v_cvt_pk_bf16_f32 v147, v134, v135
v_exp_f32 v136, v136
v_exp_f32 v137, v137
s_waitcnt lgkmcnt(3)
v_mfma_f32_32x32x16_bf16 v[16:31], v[160:163], v[144:147], v[16:31]
ds_read_b128 v[160:163], v7 offset:10240
v_exp_f32 v138, v138
v_exp_f32 v139, v139
v_exp_f32 v140, v140
v_mfma_f32_16x16x32_bf16 v[32:35], v[212:215], v[144:147], v[32:35]
v_exp_f32 v141, v141
v_exp_f32 v142, v142
v_exp_f32 v143, v143
v_cvt_pk_bf16_f32 v148, v136, v137
v_cvt_pk_bf16_f32 v149, v138, v139
v_cvt_pk_bf16_f32 v150, v140, v141
v_cvt_pk_bf16_f32 v151, v142, v143
v_exp_f32 v112, v112
v_exp_f32 v113, v113
s_waitcnt lgkmcnt(3)
v_mfma_f32_32x32x16_bf16 v[16:31], v[164:167], v[148:151], v[16:31]
ds_read_b128 v[164:167], v7 offset:11264
v_exp_f32 v114, v114
v_exp_f32 v115, v115
v_exp_f32 v116, v116
v_mfma_f32_16x16x32_bf16 v[32:35], v[212:215], v[148:151], v[32:35]
v_exp_f32 v117, v117
s_waitcnt lgkmcnt(3)
v_mfma_f32_32x32x16_bf16 v[128:143], v[152:155], v[96:99], 0
v_exp_f32 v118, v118
v_exp_f32 v119, v119
v_cvt_pk_bf16_f32 v144, v112, v113
v_cvt_pk_bf16_f32 v145, v114, v115
s_waitcnt lgkmcnt(2)
v_mfma_f32_32x32x16_bf16 v[128:143], v[156:159], v[104:107], v[128:143]
v_cvt_pk_bf16_f32 v146, v116, v117
v_cvt_pk_bf16_f32 v147, v118, v119
v_exp_f32 v120, v120
v_exp_f32 v121, v121
s_waitcnt lgkmcnt(1)
v_mfma_f32_32x32x16_bf16 v[16:31], v[160:163], v[144:147], v[16:31]
ds_read_b128 v[160:163], v7 offset:2048
v_exp_f32 v122, v122
v_exp_f32 v123, v123
v_exp_f32 v124, v124
v_mfma_f32_16x16x32_bf16 v[32:35], v[212:215], v[144:147], v[32:35]
v_mov_b32 v8, v7
v_exp_f32 v125, v125
v_exp_f32 v126, v126
v_exp_f32 v127, v127
v_cvt_pk_bf16_f32 v148, v120, v121
v_cvt_pk_bf16_f32 v149, v122, v123
v_cvt_pk_bf16_f32 v150, v124, v125
v_cvt_pk_bf16_f32 v151, v126, v127
.p2align 3
at_99:
v_exp_f32 v128, v128
v_exp_f32 v129, v129
s_waitcnt lgkmcnt(1)
v_mfma_f32_32x32x16_bf16 v[16:31], v[164:167], v[148:151], v[16:31]
ds_read_b128 v[164:167], v8 offset:3072
v_exp_f32 v130, v130
v_exp_f32 v131, v131
v_exp_f32 v132, v132
v_mfma_f32_16x16x32_bf16 v[32:35], v[212:215], v[148:151], v[32:35]
v_exp_f32 v133, v133
v_mfma_f32_32x32x16_bf16 v[112:127], v[152:155], v[80:83], v[216:231]
v_exp_f32 v134, v134
v_exp_f32 v135, v135
v_cvt_pk_bf16_f32 v144, v128, v129
v_cvt_pk_bf16_f32 v145, v130, v131
v_mfma_f32_32x32x16_bf16 v[112:127], v[156:159], v[88:91], v[112:127]
s_sub_u32 s66, s66, 8192
s_cmp_eq_u32 s66, s67
s_cbranch_scc1 cross_106
cback_107:
v_add_u32 v8, s66, v6
ds_read_b128 v[152:155], v8 offset:0
ds_read_b128 v[156:159], v8 offset:1024
v_cvt_pk_bf16_f32 v146, v132, v133
v_cvt_pk_bf16_f32 v147, v134, v135
v_exp_f32 v136, v136
v_exp_f32 v137, v137
s_waitcnt lgkmcnt(3)
v_mfma_f32_32x32x16_bf16 v[16:31], v[160:163], v[144:147], v[16:31]
v_exp_f32 v138, v138
v_exp_f32 v139, v139
v_exp_f32 v140, v140
v_mfma_f32_16x16x32_bf16 v[32:35], v[212:215], v[144:147], v[32:35]
s_cmp_eq_u32 s68, 0
v_exp_f32 v141, v141
v_exp_f32 v142, v142
v_exp_f32 v143, v143
v_cvt_pk_bf16_f32 v148, v136, v137
v_cvt_pk_bf16_f32 v149, v138, v139
v_cvt_pk_bf16_f32 v150, v140, v141
v_cvt_pk_bf16_f32 v151, v142, v143
s_cbranch_scc1 at_103
.p2align 3
at_100:
v_exp_f32 v112, v112
v_exp_f32 v113, v113
s_waitcnt lgkmcnt(2)
v_mfma_f32_32x32x16_bf16 v[16:31], v[164:167], v[148:151], v[16:31]
v_exp_f32 v114, v114
v_exp_f32 v115, v115
v_exp_f32 v116, v116
v_mfma_f32_16x16x32_bf16 v[32:35], v[212:215], v[148:151], v[32:35]
v_exp_f32 v117, v117
s_waitcnt lgkmcnt(1)
v_mfma_f32_32x32x16_bf16 v[128:143], v[152:155], v[96:99], 0
v_exp_f32 v118, v118
v_exp_f32 v119, v119
v_cvt_pk_bf16_f32 v144, v112, v113
v_cvt_pk_bf16_f32 v145, v114, v115
s_waitcnt lgkmcnt(0)
v_mfma_f32_32x32x16_bf16 v[128:143], v[156:159], v[104:107], v[128:143]
v_cvt_pk_bf16_f32 v146, v116, v117
v_cvt_pk_bf16_f32 v147, v118, v119
v_exp_f32 v120, v120
v_exp_f32 v121, v121
v_mfma_f32_32x32x16_bf16 v[192:207], v[160:163], v[144:147], v[192:207]
ds_read_b128 v[160:163], v8 offset:2048
v_exp_f32 v122, v122
v_exp_f32 v123, v123
v_exp_f32 v124, v124
v_mfma_f32_16x16x32_bf16 v[208:211], v[212:215], v[144:147], v[208:211]
v_exp_f32 v125, v125
v_exp_f32 v126, v126
v_exp_f32 v127, v127
v_cvt_pk_bf16_f32 v148, v120, v121
v_cvt_pk_bf16_f32 v149, v122, v123
v_cvt_pk_bf16_f32 v150, v124, v125
v_cvt_pk_bf16_f32 v151, v126, v127
v_exp_f32 v128, v128
v_exp_f32 v129, v129
v_mfma_f32_32x32x16_bf16 v[192:207], v[164:167], v[148:151], v[192:207]
ds_read_b128 v[164:167], v8 offset:3072
v_exp_f32 v130, v130
v_exp_f32 v131, v131
v_exp_f32 v132, v132
v_mfma_f32_16x16x32_bf16 v[208:211], v[212:215], v[148:151], v[208:211]
v_exp_f32 v133, v133
v_mfma_f32_32x32x16_bf16 v[112:127], v[152:155], v[80:83], 0
v_exp_f32 v134, v134
v_exp_f32 v135, v135
v_cvt_pk_bf16_f32 v144, v128, v129
v_cvt_pk_bf16_f32 v145, v130, v131
v_mfma_f32_32x32x16_bf16 v[112:127], v[156:159], v[88:91], v[112:127]
s_sub_u32 s66, s66, 8192
s_cmp_eq_u32 s66, s67
s_cbranch_scc1 cross_108
cback_109:
v_add_u32 v8, s66, v6
ds_read_b128 v[152:155], v8 offset:0
ds_read_b128 v[156:159], v8 offset:1024
v_cvt_pk_bf16_f32 v146, v132, v133
v_cvt_pk_bf16_f32 v147, v134, v135
v_exp_f32 v136, v136
v_exp_f32 v137, v137
s_waitcnt lgkmcnt(3)
v_mfma_f32_32x32x16_bf16 v[16:31], v[160:163], v[144:147], v[16:31]
v_exp_f32 v138, v138
v_exp_f32 v139, v139
v_exp_f32 v140, v140
v_mfma_f32_16x16x32_bf16 v[32:35], v[212:215], v[144:147], v[32:35]
s_sub_u32 s68, s68, 1
s_cmp_eq_u32 s68, 0
v_exp_f32 v141, v141
v_exp_f32 v142, v142
v_exp_f32 v143, v143
v_cvt_pk_bf16_f32 v148, v136, v137
v_cvt_pk_bf16_f32 v149, v138, v139
v_cvt_pk_bf16_f32 v150, v140, v141
v_cvt_pk_bf16_f32 v151, v142, v143
s_cbranch_scc0 at_100
s_cmp_lt_u32 s59, 2
s_cbranch_scc1 at_103
.p2align 3
v_exp_f32 v112, v112
v_exp_f32 v113, v113
s_waitcnt lgkmcnt(2)
v_mfma_f32_32x32x16_bf16 v[16:31], v[164:167], v[148:151], v[16:31]
v_exp_f32 v114, v114
v_exp_f32 v115, v115
v_exp_f32 v116, v116
v_mfma_f32_16x16x32_bf16 v[32:35], v[212:215], v[148:151], v[32:35]
v_exp_f32 v117, v117
s_waitcnt lgkmcnt(1)
v_mfma_f32_32x32x16_bf16 v[128:143], v[152:155], v[96:99], v[216:231]
v_exp_f32 v118, v118
v_exp_f32 v119, v119
v_cvt_pk_bf16_f32 v144, v112, v113
v_cvt_pk_bf16_f32 v145, v114, v115
s_waitcnt lgkmcnt(0)
v_mfma_f32_32x32x16_bf16 v[128:143], v[156:159], v[104:107], v[128:143]
v_cvt_pk_bf16_f32 v146, v116, v117
v_cvt_pk_bf16_f32 v147, v118, v119
v_exp_f32 v120, v120
v_exp_f32 v121, v121
v_mfma_f32_32x32x16_bf16 v[192:207], v[160:163], v[144:147], v[192:207]
ds_read_b128 v[160:163], v8 offset:2048
v_exp_f32 v122, v122
v_exp_f32 v123, v123
v_exp_f32 v124, v124
v_mfma_f32_16x16x32_bf16 v[208:211], v[212:215], v[144:147], v[208:211]
v_exp_f32 v125, v125
v_exp_f32 v126, v126
v_exp_f32 v127, v127
v_cvt_pk_bf16_f32 v148, v120, v121
v_cvt_pk_bf16_f32 v149, v122, v123
v_cvt_pk_bf16_f32 v150, v124, v125
v_cvt_pk_bf16_f32 v151, v126, v127
v_exp_f32 v128, v128
v_exp_f32 v129, v129
v_mfma_f32_32x32x16_bf16 v[192:207], v[164:167], v[148:151], v[192:207]
ds_read_b128 v[164:167], v8 offset:3072
v_exp_f32 v130, v130
v_exp_f32 v131, v131
v_exp_f32 v132, v132
v_mfma_f32_16x16x32_bf16 v[208:211], v[212:215], v[148:151], v[208:211]
v_exp_f32 v133, v133
v_mfma_f32_32x32x16_bf16 v[112:127], v[152:155], v[80:83], 0
v_exp_f32 v134, v134
v_exp_f32 v135, v135
v_cvt_pk_bf16_f32 v144, v128, v129
v_cvt_pk_bf16_f32 v145, v130, v131
v_mfma_f32_32x32x16_bf16 v[112:127], v[156:159], v[88:91], v[112:127]
v_subrev_u32 v8, 8192, v8
ds_read_b128 v[152:155], v8 offset:0
ds_read_b128 v[156:159], v8 offset:1024
v_cvt_pk_bf16_f32 v146, v132, v133
v_cvt_pk_bf16_f32 v147, v134, v135
v_exp_f32 v136, v136
v_exp_f32 v137, v137
s_waitcnt lgkmcnt(3)
v_mfma_f32_32x32x16_bf16 v[16:31], v[160:163], v[144:147], v[16:31]
v_exp_f32 v138, v138
v_exp_f32 v139, v139
v_exp_f32 v140, v140
v_mfma_f32_16x16x32_bf16 v[32:35], v[212:215], v[144:147], v[32:35]
s_cmp_eq_u32 s65, 1
v_exp_f32 v141, v141
v_exp_f32 v142, v142
v_exp_f32 v143, v143
v_cvt_pk_bf16_f32 v148, v136, v137
v_cvt_pk_bf16_f32 v149, v138, v139
v_cvt_pk_bf16_f32 v150, v140, v141
v_cvt_pk_bf16_f32 v151, v142, v143
s_cbranch_scc1 at_102
.p2align 3
v_exp_f32 v112, v112
v_exp_f32 v113, v113
s_waitcnt lgkmcnt(2)
v_mfma_f32_32x32x16_bf16 v[16:31], v[164:167], v[148:151], v[16:31]
v_exp_f32 v114, v114
v_exp_f32 v115, v115
v_exp_f32 v116, v116
v_mfma_f32_16x16x32_bf16 v[32:35], v[212:215], v[148:151], v[32:35]
v_exp_f32 v117, v117
s_waitcnt lgkmcnt(1)
v_mfma_f32_32x32x16_bf16 v[128:143], v[152:155], v[80:83], 0
v_exp_f32 v118, v118
v_exp_f32 v119, v119
v_cvt_pk_bf16_f32 v144, v112, v113
v_cvt_pk_bf16_f32 v145, v114, v115
s_waitcnt lgkmcnt(0)
v_mfma_f32_32x32x16_bf16 v[128:143], v[156:159], v[88:91], v[128:143]
v_subrev_u32 v8, 8192, v8
ds_read_b128 v[152:155], v8 offset:0
ds_read_b128 v[156:159], v8 offset:1024
v_cvt_pk_bf16_f32 v146, v116, v117
v_cvt_pk_bf16_f32 v147, v118, v119
v_exp_f32 v120, v120
v_exp_f32 v121, v121
v_mfma_f32_32x32x16_bf16 v[192:207], v[160:163], v[144:147], v[192:207]
ds_read_b128 v[160:163], v8 offset:10240
v_exp_f32 v122, v122
v_exp_f32 v123, v123
v_exp_f32 v124, v124
v_mfma_f32_16x16x32_bf16 v[208:211], v[212:215], v[144:147], v[208:211]
v_exp_f32 v125, v125
v_exp_f32 v126, v126
v_exp_f32 v127, v127
v_cvt_pk_bf16_f32 v148, v120, v121
v_cvt_pk_bf16_f32 v149, v122, v123
v_cvt_pk_bf16_f32 v150, v124, v125
v_cvt_pk_bf16_f32 v151, v126, v127
v_exp_f32 v128, v128
v_exp_f32 v129, v129
v_mfma_f32_32x32x16_bf16 v[192:207], v[164:167], v[148:151], v[192:207]
ds_read_b128 v[164:167], v8 offset:11264
v_exp_f32 v130, v130
v_exp_f32 v131, v131
v_exp_f32 v132, v132
v_mfma_f32_16x16x32_bf16 v[208:211], v[212:215], v[148:151], v[208:211]
v_exp_f32 v133, v133
s_waitcnt lgkmcnt(3)
v_mfma_f32_32x32x16_bf16 v[112:127], v[152:155], v[80:83], 0
v_exp_f32 v134, v134
v_exp_f32 v135, v135
v_cvt_pk_bf16_f32 v144, v128, v129
v_cvt_pk_bf16_f32 v145, v130, v131
s_waitcnt lgkmcnt(2)
v_mfma_f32_32x32x16_bf16 v[112:127], v[156:159], v[88:91], v[112:127]
v_subrev_u32 v8, 8192, v8
ds_read_b128 v[152:155], v8 offset:0
ds_read_b128 v[156:159], v8 offset:1024
v_cvt_pk_bf16_f32 v146, v132, v133
v_cvt_pk_bf16_f32 v147, v134, v135
v_exp_f32 v136, v136
v_exp_f32 v137, v137
s_waitcnt lgkmcnt(3)
v_mfma_f32_32x32x16_bf16 v[192:207], v[160:163], v[144:147], v[192:207]
ds_read_b128 v[160:163], v8 offset:10240
v_exp_f32 v138, v138
v_exp_f32 v139, v139
v_exp_f32 v140, v140
v_mfma_f32_16x16x32_bf16 v[208:211], v[212:215], v[144:147], v[208:211]
v_exp_f32 v141, v141
v_exp_f32 v142, v142
v_exp_f32 v143, v143
v_cvt_pk_bf16_f32 v148, v136, v137
v_cvt_pk_bf16_f32 v149, v138, v139
v_cvt_pk_bf16_f32 v150, v140, v141
v_cvt_pk_bf16_f32 v151, v142, v143
v_exp_f32 v112, v112
v_exp_f32 v113, v113
s_waitcnt lgkmcnt(3)
v_mfma_f32_32x32x16_bf16 v[192:207], v[164:167], v[148:151], v[192:207]
ds_read_b128 v[164:167], v8 offset:11264
v_exp_f32 v114, v114
v_exp_f32 v115, v115
v_exp_f32 v116, v116
v_mfma_f32_16x16x32_bf16 v[208:211], v[212:215], v[148:151], v[208:211]
v_exp_f32 v117, v117
s_waitcnt lgkmcnt(3)
v_mfma_f32_32x32x16_bf16 v[128:143], v[152:155], v[80:83], v[216:231]
v_exp_f32 v118, v118
v_exp_f32 v119, v119
v_cvt_pk_bf16_f32 v144, v112, v113
v_cvt_pk_bf16_f32 v145, v114, v115
s_waitcnt lgkmcnt(2)
v_mfma_f32_32x32x16_bf16 v[128:143], v[156:159], v[88:91], v[128:143]
v_cvt_pk_bf16_f32 v146, v116, v117
v_cvt_pk_bf16_f32 v147, v118, v119
v_exp_f32 v120, v120
v_exp_f32 v121, v121
s_waitcnt lgkmcnt(1)
v_mfma_f32_32x32x16_bf16 v[192:207], v[160:163], v[144:147], v[192:207]
ds_read_b128 v[160:163], v8 offset:2048
v_exp_f32 v122, v122
v_exp_f32 v123, v123
v_exp_f32 v124, v124
v_mfma_f32_16x16x32_bf16 v[208:211], v[212:215], v[144:147], v[208:211]
v_exp_f32 v125, v125
v_exp_f32 v126, v126
v_exp_f32 v127, v127
v_cvt_pk_bf16_f32 v148, v120, v121
v_cvt_pk_bf16_f32 v149, v122, v123
v_cvt_pk_bf16_f32 v150, v124, v125
v_cvt_pk_bf16_f32 v151, v126, v127
s_branch at_104
.p2align 3
at_103:
v_add_u32 v5, s34, 20
s_mov_b64 exec, 1
ds_write_b32 v3, v5
s_mov_b64 exec, -1
v_exp_f32 v112, v112
v_exp_f32 v113, v113
s_waitcnt lgkmcnt(3)
v_mfma_f32_32x32x16_bf16 v[16:31], v[164:167], v[148:151], v[16:31]
v_exp_f32 v114, v114
v_exp_f32 v115, v115
v_exp_f32 v116, v116
v_mfma_f32_16x16x32_bf16 v[32:35], v[212:215], v[148:151], v[32:35]
v_exp_f32 v117, v117
v_exp_f32 v118, v118
v_exp_f32 v119, v119
v_cvt_pk_bf16_f32 v144, v112, v113
v_cvt_pk_bf16_f32 v145, v114, v115
v_cvt_pk_bf16_f32 v146, v116, v117
v_cvt_pk_bf16_f32 v147, v118, v119
v_exp_f32 v120, v120
v_exp_f32 v121, v121
v_mfma_f32_32x32x16_bf16 v[192:207], v[160:163], v[144:147], v[192:207]
v_exp_f32 v122, v122
v_exp_f32 v123, v123
v_exp_f32 v124, v124
v_mfma_f32_16x16x32_bf16 v[208:211], v[212:215], v[144:147], v[208:211]
v_exp_f32 v125, v125
v_exp_f32 v126, v126
v_exp_f32 v127, v127
v_cvt_pk_bf16_f32 v148, v120, v121
v_cvt_pk_bf16_f32 v149, v122, v123
v_cvt_pk_bf16_f32 v150, v124, v125
v_cvt_pk_bf16_f32 v151, v126, v127
s_branch at_105
.p2align 3
at_102:
v_exp_f32 v112, v112
v_exp_f32 v113, v113
s_waitcnt lgkmcnt(2)
v_mfma_f32_32x32x16_bf16 v[16:31], v[164:167], v[148:151], v[16:31]
v_exp_f32 v114, v114
v_exp_f32 v115, v115
v_exp_f32 v116, v116
v_mfma_f32_16x16x32_bf16 v[32:35], v[212:215], v[148:151], v[32:35]
v_exp_f32 v117, v117
s_waitcnt lgkmcnt(1)
v_mfma_f32_32x32x16_bf16 v[128:143], v[152:155], v[80:83], v[216:231]
v_exp_f32 v118, v118
v_exp_f32 v119, v119
v_cvt_pk_bf16_f32 v144, v112, v113
v_cvt_pk_bf16_f32 v145, v114, v115
s_waitcnt lgkmcnt(0)
v_mfma_f32_32x32x16_bf16 v[128:143], v[156:159], v[88:91], v[128:143]
v_cvt_pk_bf16_f32 v146, v116, v117
v_cvt_pk_bf16_f32 v147, v118, v119
v_exp_f32 v120, v120
v_exp_f32 v121, v121
v_mfma_f32_32x32x16_bf16 v[192:207], v[160:163], v[144:147], v[192:207]
ds_read_b128 v[160:163], v8 offset:2048
v_exp_f32 v122, v122
v_exp_f32 v123, v123
v_exp_f32 v124, v124
v_mfma_f32_16x16x32_bf16 v[208:211], v[212:215], v[144:147], v[208:211]
v_exp_f32 v125, v125
v_exp_f32 v126, v126
v_exp_f32 v127, v127
v_cvt_pk_bf16_f32 v148, v120, v121
v_cvt_pk_bf16_f32 v149, v122, v123
v_cvt_pk_bf16_f32 v150, v124, v125
v_cvt_pk_bf16_f32 v151, v126, v127
.p2align 3
at_104:
v_exp_f32 v128, v128
v_exp_f32 v129, v129
s_waitcnt lgkmcnt(1)
v_mfma_f32_32x32x16_bf16 v[192:207], v[164:167], v[148:151], v[192:207]
ds_read_b128 v[164:167], v8 offset:3072
v_exp_f32 v130, v130
v_exp_f32 v131, v131
v_exp_f32 v132, v132
v_mfma_f32_16x16x32_bf16 v[208:211], v[212:215], v[148:151], v[208:211]
v_exp_f32 v133, v133
v_exp_f32 v134, v134
v_exp_f32 v135, v135
v_cvt_pk_bf16_f32 v144, v128, v129
v_cvt_pk_bf16_f32 v145, v130, v131
v_add_u32 v5, s34, 20
s_mov_b64 exec, 1
ds_write_b32 v3, v5
s_mov_b64 exec, -1
v_cvt_pk_bf16_f32 v146, v132, v133
v_cvt_pk_bf16_f32 v147, v134, v135
v_exp_f32 v136, v136
v_exp_f32 v137, v137
s_waitcnt lgkmcnt(2)
v_mfma_f32_32x32x16_bf16 v[192:207], v[160:163], v[144:147], v[192:207]
v_exp_f32 v138, v138
v_exp_f32 v139, v139
v_exp_f32 v140, v140
v_mfma_f32_16x16x32_bf16 v[208:211], v[212:215], v[144:147], v[208:211]
v_exp_f32 v141, v141
v_exp_f32 v142, v142
v_exp_f32 v143, v143
v_cvt_pk_bf16_f32 v148, v136, v137
v_cvt_pk_bf16_f32 v149, v138, v139
v_cvt_pk_bf16_f32 v150, v140, v141
v_cvt_pk_bf16_f32 v151, v142, v143
at_105:
s_lshl_b32 s66, s59, 18
s_lshl_b32 s67, s63, 22
v_mfma_f32_16x16x32_bf16 v[208:211], v[212:215], v[148:151], v[208:211]
s_add_u32 s66, s66, s67
s_lshl1_add_u32 s67, s60, s64
s_waitcnt lgkmcnt(1)
v_mfma_f32_32x32x16_bf16 v[192:207], v[164:167], v[148:151], v[192:207]
s_lshl_b32 s67, s67, 11
s_add_u32 s66, s66, s67
s_lshl_b32 s68, s65, 16
s_add_u32 s67, s66, 18022400
s_sub_u32 s67, s67, s68
s_add_u32 s66, s66, s68
s_add_u32 s66, s66, 17825792
v_lshlrev_b32 v9, 4, v0
v_subrev_u32 v10, 0x2f800000, v32
v_subrev_u32 v11, 0x2f800000, v208
v_max_u32 v10, v10, v11
v_cmp_lt_u32 vcc, 0x20000000, v10
s_cbranch_vccnz slow_110
sback_111:
s_nop 1
v_rcp_f32 v12, v32
s_nop 1
v_pk_mul_f32 v[16:17], v[16:17], v[12:13] op_sel:[0,0] op_sel_hi:[1,0]
v_pk_mul_f32 v[18:19], v[18:19], v[12:13] op_sel:[0,0] op_sel_hi:[1,0]
v_pk_mul_f32 v[20:21], v[20:21], v[12:13] op_sel:[0,0] op_sel_hi:[1,0]
v_pk_mul_f32 v[22:23], v[22:23], v[12:13] op_sel:[0,0] op_sel_hi:[1,0]
v_pk_mul_f32 v[24:25], v[24:25], v[12:13] op_sel:[0,0] op_sel_hi:[1,0]
v_pk_mul_f32 v[26:27], v[26:27], v[12:13] op_sel:[0,0] op_sel_hi:[1,0]
v_pk_mul_f32 v[28:29], v[28:29], v[12:13] op_sel:[0,0] op_sel_hi:[1,0]
v_pk_mul_f32 v[30:31], v[30:31], v[12:13] op_sel:[0,0] op_sel_hi:[1,0]
v_cvt_pk_bf16_f32 v16, v16, v17
v_cvt_pk_bf16_f32 v17, v18, v19
v_cvt_pk_bf16_f32 v18, v20, v21
v_cvt_pk_bf16_f32 v19, v22, v23
v_cvt_pk_bf16_f32 v20, v24, v25
v_cvt_pk_bf16_f32 v21, v26, v27
v_cvt_pk_bf16_f32 v22, v28, v29
v_cvt_pk_bf16_f32 v23, v30, v31
buffer_store_dwordx4 v[16:19], v9, s[20:23], s67 offen offset:0 sc1
buffer_store_dwordx4 v[20:23], v9, s[20:23], s67 offen offset:1024 sc1
v_rcp_f32 v12, v208
s_nop 0
v_pk_mul_f32 v[192:193], v[192:193], v[12:13] op_sel:[0,0] op_sel_hi:[1,0]
v_pk_mul_f32 v[194:195], v[194:195], v[12:13] op_sel:[0,0] op_sel_hi:[1,0]
v_pk_mul_f32 v[196:197], v[196:197], v[12:13] op_sel:[0,0] op_sel_hi:[1,0]
v_pk_mul_f32 v[198:199], v[198:199], v[12:13] op_sel:[0,0] op_sel_hi:[1,0]
v_pk_mul_f32 v[200:201], v[200:201], v[12:13] op_sel:[0,0] op_sel_hi:[1,0]
v_pk_mul_f32 v[202:203], v[202:203], v[12:13] op_sel:[0,0] op_sel_hi:[1,0]
v_pk_mul_f32 v[204:205], v[204:205], v[12:13] op_sel:[0,0] op_sel_hi:[1,0]
v_pk_mul_f32 v[206:207], v[206:207], v[12:13] op_sel:[0,0] op_sel_hi:[1,0]
v_cvt_pk_bf16_f32 v192, v192, v193
v_cvt_pk_bf16_f32 v193, v194, v195
v_cvt_pk_bf16_f32 v194, v196, v197
v_cvt_pk_bf16_f32 v195, v198, v199
v_cvt_pk_bf16_f32 v196, v200, v201
v_cvt_pk_bf16_f32 v197, v202, v203
v_cvt_pk_bf16_f32 v198, v204, v205
v_cvt_pk_bf16_f32 v199, v206, v207
buffer_store_dwordx4 v[192:195], v9, s[20:23], s66 offen offset:0 sc1
buffer_store_dwordx4 v[196:199], v9, s[20:23], s66 offen offset:1024 sc1
v_bfe_u32 v48, v0, 2, 3
v_lshrrev_b32 v49, 5, v0
v_lshl_add_u32 v48, v49, 4, v48
v_lshlrev_b32 v48, 7, v48
v_bfe_u32 v49, v0, 3, 2
v_lshl_add_u32 v48, v49, 5, v48
v_and_b32 v49, 3, v0
v_lshl_add_u32 v48, v49, 3, v48
v_add_u32 v8, 32768, v48
v_xor_b32 v9, 32, v8
v_xor_b32 v10, 64, v8
v_xor_b32 v11, 96, v8
v_add_u32 v12, 0x10000, v8
v_add_u32 v13, 0x10000, v9
v_add_u32 v14, 0x10000, v10
v_add_u32 v15, 0x10000, v11
v_and_b32 v48, 15, v0
v_lshrrev_b32 v49, 4, v0
s_lshl2_add_u32 s66, s61, s58
s_lshl_b32 s67, s66, 16
s_lshl_b32 s68, s63, 22
s_add_u32 s67, s67, s68
s_add_u32 s67, s67, 17825792
v_lshl_add_u32 v6, v48, 4, s67
v_lshl_add_u32 v6, v49, 9, v6
s_add_u32 s70, s72, 327680
s_mov_b64 exec, 1
s_waitcnt vmcnt(0)
buffer_store_dword v212, v3, s[24:27], s70 offen sc1
s_mov_b64 exec, -1
v_add_u32 v5, s34, 21
s_mov_b64 exec, 1
ds_write_b32 v3, v5
s_mov_b64 exec, -1
s_cmp_eq_u32 s63, 0
s_cbranch_scc0 mo_112
v_permlane16_swap_b32 v240, v242
v_permlane16_swap_b32 v241, v243
v_permlane16_swap_b32 v244, v246
v_permlane16_swap_b32 v245, v247
v_permlane16_swap_b32 v248, v250
v_permlane16_swap_b32 v249, v251
v_permlane16_swap_b32 v252, v254
v_permlane16_swap_b32 v253, v255
mo_113:
v_lshlrev_b32 v16, 16, v240
v_and_b32 v17, 0xffff0000, v240
v_lshlrev_b32 v18, 16, v241
v_and_b32 v19, 0xffff0000, v241
v_lshlrev_b32 v20, 16, v242
v_and_b32 v21, 0xffff0000, v242
v_lshlrev_b32 v22, 16, v243
v_and_b32 v23, 0xffff0000, v243
v_lshlrev_b32 v24, 16, v244
v_and_b32 v25, 0xffff0000, v244
v_lshlrev_b32 v26, 16, v245
v_and_b32 v27, 0xffff0000, v245
v_lshlrev_b32 v28, 16, v246
v_and_b32 v29, 0xffff0000, v246
v_lshlrev_b32 v30, 16, v247
v_and_b32 v31, 0xffff0000, v247
v_lshlrev_b32 v32, 16, v248
v_and_b32 v33, 0xffff0000, v248
v_lshlrev_b32 v34, 16, v249
v_and_b32 v35, 0xffff0000, v249
v_lshlrev_b32 v36, 16, v250
v_and_b32 v37, 0xffff0000, v250
v_lshlrev_b32 v38, 16, v251
v_and_b32 v39, 0xffff0000, v251
v_lshlrev_b32 v40, 16, v252
v_and_b32 v41, 0xffff0000, v252
v_lshlrev_b32 v42, 16, v253
v_and_b32 v43, 0xffff0000, v253
v_lshlrev_b32 v44, 16, v254
v_and_b32 v45, 0xffff0000, v254
v_lshlrev_b32 v46, 16, v255
v_and_b32 v47, 0xffff0000, v255
s_add_u32 s66, s61, s62
s_and_b32 s66, s66, 15
s_lshl_b32 s66, s66, 12
s_add_u32 s35, s34, 18
lw_114:
ds_read_b32 v5, v2 offset:16
s_waitcnt lgkmcnt(0)
v_cmp_gt_i32 vcc, s35, v5
s_cbranch_vccz lwd_115
s_sub_u32 s32, s32, 1
s_cmp_gt_i32 s32, 0
s_cbranch_scc1 lw_114
lwd_115:
buffer_load_dwordx4 v[80:83], v6, s[20:23], s66 offen offset:0 sc1
buffer_load_dwordx4 v[88:91], v6, s[20:23], s66 offen offset:2048 sc1
buffer_load_dwordx4 v[84:87], v6, s[20:23], s66 offen offset:256 sc1
buffer_load_dwordx4 v[92:95], v6, s[20:23], s66 offen offset:2304 sc1
s_add_u32 s66, s66, 4096
s_and_b32 s66, s66, 0xffff
ds_read_b64_tr_b16 v[48:49], v8 offset:0
ds_read_b64_tr_b16 v[50:51], v8 offset:1024
ds_read_b64_tr_b16 v[52:53], v8 offset:4096
ds_read_b64_tr_b16 v[54:55], v8 offset:5120
buffer_load_dwordx4 v[96:99], v6, s[20:23], s66 offen offset:0 sc1
buffer_load_dwordx4 v[104:107], v6, s[20:23], s66 offen offset:2048 sc1
buffer_load_dwordx4 v[100:103], v6, s[20:23], s66 offen offset:256 sc1
buffer_load_dwordx4 v[108:111], v6, s[20:23], s66 offen offset:2304 sc1
s_add_u32 s66, s66, 4096
s_and_b32 s66, s66, 0xffff
ds_read_b64_tr_b16 v[56:57], v9 offset:0
ds_read_b64_tr_b16 v[58:59], v9 offset:1024
ds_read_b64_tr_b16 v[60:61], v9 offset:4096
ds_read_b64_tr_b16 v[62:63], v9 offset:5120
buffer_load_dwordx4 v[112:115], v6, s[20:23], s66 offen offset:0 sc1
buffer_load_dwordx4 v[120:123], v6, s[20:23], s66 offen offset:2048 sc1
buffer_load_dwordx4 v[116:119], v6, s[20:23], s66 offen offset:256 sc1
buffer_load_dwordx4 v[124:127], v6, s[20:23], s66 offen offset:2304 sc1
s_add_u32 s66, s66, 4096
s_and_b32 s66, s66, 0xffff
ds_read_b64_tr_b16 v[64:65], v10 offset:0
ds_read_b64_tr_b16 v[66:67], v10 offset:1024
ds_read_b64_tr_b16 v[68:69], v10 offset:4096
ds_read_b64_tr_b16 v[70:71], v10 offset:5120
buffer_load_dwordx4 v[128:131], v6, s[20:23], s66 offen offset:0 sc1
buffer_load_dwordx4 v[136:139], v6, s[20:23], s66 offen offset:2048 sc1
buffer_load_dwordx4 v[132:135], v6, s[20:23], s66 offen offset:256 sc1
buffer_load_dwordx4 v[140:143], v6, s[20:23], s66 offen offset:2304 sc1
s_add_u32 s66, s66, 4096
s_and_b32 s66, s66, 0xffff
buffer_load_dwordx4 v[144:147], v6, s[20:23], s66 offen offset:0 sc1
buffer_load_dwordx4 v[152:155], v6, s[20:23], s66 offen offset:2048 sc1
buffer_load_dwordx4 v[148:151], v6, s[20:23], s66 offen offset:256 sc1
buffer_load_dwordx4 v[156:159], v6, s[20:23], s66 offen offset:2304 sc1
s_add_u32 s66, s66, 4096
s_and_b32 s66, s66, 0xffff
buffer_load_dwordx4 v[160:163], v6, s[20:23], s66 offen offset:0 sc1
buffer_load_dwordx4 v[168:171], v6, s[20:23], s66 offen offset:2048 sc1
buffer_load_dwordx4 v[164:167], v6, s[20:23], s66 offen offset:256 sc1
buffer_load_dwordx4 v[172:175], v6, s[20:23], s66 offen offset:2304 sc1
s_add_u32 s66, s66, 4096
s_and_b32 s66, s66, 0xffff
buffer_load_dwordx4 v[176:179], v6, s[20:23], s66 offen offset:0 sc1
buffer_load_dwordx4 v[184:187], v6, s[20:23], s66 offen offset:2048 sc1
buffer_load_dwordx4 v[180:183], v6, s[20:23], s66 offen offset:256 sc1
buffer_load_dwordx4 v[188:191], v6, s[20:23], s66 offen offset:2304 sc1
s_add_u32 s66, s66, 4096
s_and_b32 s66, s66, 0xffff
buffer_load_dwordx4 v[192:195], v6, s[20:23], s66 offen offset:0 sc1
buffer_load_dwordx4 v[200:203], v6, s[20:23], s66 offen offset:2048 sc1
buffer_load_dwordx4 v[196:199], v6, s[20:23], s66 offen offset:256 sc1
buffer_load_dwordx4 v[204:207], v6, s[20:23], s66 offen offset:2304 sc1
s_add_u32 s66, s66, 4096
s_and_b32 s66, s66, 0xffff
.p2align 3
s_waitcnt vmcnt(31) lgkmcnt(10)
v_mfma_f32_16x16x32_bf16 v[16:19], v[48:51], v[80:83], v[16:19]
ds_read_b64_tr_b16 v[72:73], v11 offset:0
s_waitcnt vmcnt(30) lgkmcnt(9)
v_mfma_f32_16x16x32_bf16 v[16:19], v[52:55], v[88:91], v[16:19]
ds_read_b64_tr_b16 v[74:75], v11 offset:1024
s_waitcnt vmcnt(29)
v_mfma_f32_16x16x32_bf16 v[32:35], v[48:51], v[84:87], v[32:35]
ds_read_b64_tr_b16 v[76:77], v11 offset:4096
s_waitcnt vmcnt(28)
v_mfma_f32_16x16x32_bf16 v[32:35], v[52:55], v[92:95], v[32:35]
ds_read_b64_tr_b16 v[78:79], v11 offset:5120
s_waitcnt lgkmcnt(10)
v_mfma_f32_16x16x32_bf16 v[20:23], v[56:59], v[80:83], v[20:23]
ds_read_b64_tr_b16 v[48:49], v8 offset:8192
s_waitcnt lgkmcnt(9)
v_mfma_f32_16x16x32_bf16 v[20:23], v[60:63], v[88:91], v[20:23]
ds_read_b64_tr_b16 v[50:51], v8 offset:9216
v_mfma_f32_16x16x32_bf16 v[36:39], v[56:59], v[84:87], v[36:39]
ds_read_b64_tr_b16 v[52:53], v8 offset:12288
v_mfma_f32_16x16x32_bf16 v[36:39], v[60:63], v[92:95], v[36:39]
ds_read_b64_tr_b16 v[54:55], v8 offset:13312
s_waitcnt lgkmcnt(10)
v_mfma_f32_16x16x32_bf16 v[24:27], v[64:67], v[80:83], v[24:27]
ds_read_b64_tr_b16 v[56:57], v9 offset:8192
s_waitcnt lgkmcnt(9)
v_mfma_f32_16x16x32_bf16 v[24:27], v[68:71], v[88:91], v[24:27]
ds_read_b64_tr_b16 v[58:59], v9 offset:9216
v_mfma_f32_16x16x32_bf16 v[40:43], v[64:67], v[84:87], v[40:43]
ds_read_b64_tr_b16 v[60:61], v9 offset:12288
v_mfma_f32_16x16x32_bf16 v[40:43], v[68:71], v[92:95], v[40:43]
ds_read_b64_tr_b16 v[62:63], v9 offset:13312
s_waitcnt lgkmcnt(10)
v_mfma_f32_16x16x32_bf16 v[28:31], v[72:75], v[80:83], v[28:31]
ds_read_b64_tr_b16 v[64:65], v10 offset:8192
s_waitcnt lgkmcnt(9)
v_mfma_f32_16x16x32_bf16 v[28:31], v[76:79], v[88:91], v[28:31]
ds_read_b64_tr_b16 v[66:67], v10 offset:9216
v_mfma_f32_16x16x32_bf16 v[44:47], v[72:75], v[84:87], v[44:47]
ds_read_b64_tr_b16 v[68:69], v10 offset:12288
v_mfma_f32_16x16x32_bf16 v[44:47], v[76:79], v[92:95], v[44:47]
ds_read_b64_tr_b16 v[70:71], v10 offset:13312
s_waitcnt vmcnt(27) lgkmcnt(10)
v_mfma_f32_16x16x32_bf16 v[16:19], v[48:51], v[96:99], v[16:19]
ds_read_b64_tr_b16 v[72:73], v11 offset:8192
buffer_load_dwordx4 v[80:83], v6, s[20:23], s66 offen offset:0 sc1
s_waitcnt vmcnt(27) lgkmcnt(9)
v_mfma_f32_16x16x32_bf16 v[16:19], v[52:55], v[104:107], v[16:19]
ds_read_b64_tr_b16 v[74:75], v11 offset:9216
buffer_load_dwordx4 v[88:91], v6, s[20:23], s66 offen offset:2048 sc1
s_waitcnt vmcnt(27)
v_mfma_f32_16x16x32_bf16 v[32:35], v[48:51], v[100:103], v[32:35]
ds_read_b64_tr_b16 v[76:77], v11 offset:12288
buffer_load_dwordx4 v[84:87], v6, s[20:23], s66 offen offset:256 sc1
s_waitcnt vmcnt(27)
v_mfma_f32_16x16x32_bf16 v[32:35], v[52:55], v[108:111], v[32:35]
ds_read_b64_tr_b16 v[78:79], v11 offset:13312
buffer_load_dwordx4 v[92:95], v6, s[20:23], s66 offen offset:2304 sc1
s_waitcnt lgkmcnt(10)
v_mfma_f32_16x16x32_bf16 v[20:23], v[56:59], v[96:99], v[20:23]
ds_read_b64_tr_b16 v[48:49], v8 offset:16384
s_add_u32 s66, s66, 4096
s_and_b32 s66, s66, 0xffff
s_waitcnt lgkmcnt(9)
v_mfma_f32_16x16x32_bf16 v[20:23], v[60:63], v[104:107], v[20:23]
ds_read_b64_tr_b16 v[50:51], v8 offset:17408
v_mfma_f32_16x16x32_bf16 v[36:39], v[56:59], v[100:103], v[36:39]
ds_read_b64_tr_b16 v[52:53], v8 offset:20480
v_mfma_f32_16x16x32_bf16 v[36:39], v[60:63], v[108:111], v[36:39]
ds_read_b64_tr_b16 v[54:55], v8 offset:21504
s_waitcnt lgkmcnt(10)
v_mfma_f32_16x16x32_bf16 v[24:27], v[64:67], v[96:99], v[24:27]
ds_read_b64_tr_b16 v[56:57], v9 offset:16384
s_waitcnt lgkmcnt(9)
v_mfma_f32_16x16x32_bf16 v[24:27], v[68:71], v[104:107], v[24:27]
ds_read_b64_tr_b16 v[58:59], v9 offset:17408
v_mfma_f32_16x16x32_bf16 v[40:43], v[64:67], v[100:103], v[40:43]
ds_read_b64_tr_b16 v[60:61], v9 offset:20480
v_mfma_f32_16x16x32_bf16 v[40:43], v[68:71], v[108:111], v[40:43]
ds_read_b64_tr_b16 v[62:63], v9 offset:21504
s_waitcnt lgkmcnt(10)
v_mfma_f32_16x16x32_bf16 v[28:31], v[72:75], v[96:99], v[28:31]
ds_read_b64_tr_b16 v[64:65], v10 offset:16384
s_waitcnt lgkmcnt(9)
v_mfma_f32_16x16x32_bf16 v[28:31], v[76:79], v[104:107], v[28:31]
ds_read_b64_tr_b16 v[66:67], v10 offset:17408
v_mfma_f32_16x16x32_bf16 v[44:47], v[72:75], v[100:103], v[44:47]
ds_read_b64_tr_b16 v[68:69], v10 offset:20480
v_mfma_f32_16x16x32_bf16 v[44:47], v[76:79], v[108:111], v[44:47]
ds_read_b64_tr_b16 v[70:71], v10 offset:21504
s_waitcnt vmcnt(27) lgkmcnt(10)
v_mfma_f32_16x16x32_bf16 v[16:19], v[48:51], v[112:115], v[16:19]
ds_read_b64_tr_b16 v[72:73], v11 offset:16384
buffer_load_dwordx4 v[96:99], v6, s[20:23], s66 offen offset:0 sc1
s_waitcnt vmcnt(27) lgkmcnt(9)
v_mfma_f32_16x16x32_bf16 v[16:19], v[52:55], v[120:123], v[16:19]
ds_read_b64_tr_b16 v[74:75], v11 offset:17408
buffer_load_dwordx4 v[104:107], v6, s[20:23], s66 offen offset:2048 sc1
s_waitcnt vmcnt(27)
v_mfma_f32_16x16x32_bf16 v[32:35], v[48:51], v[116:119], v[32:35]
ds_read_b64_tr_b16 v[76:77], v11 offset:20480
buffer_load_dwordx4 v[100:103], v6, s[20:23], s66 offen offset:256 sc1
s_waitcnt vmcnt(27)
v_mfma_f32_16x16x32_bf16 v[32:35], v[52:55], v[124:127], v[32:35]
ds_read_b64_tr_b16 v[78:79], v11 offset:21504
buffer_load_dwordx4 v[108:111], v6, s[20:23], s66 offen offset:2304 sc1
s_waitcnt lgkmcnt(10)
v_mfma_f32_16x16x32_bf16 v[20:23], v[56:59], v[112:115], v[20:23]
ds_read_b64_tr_b16 v[48:49], v8 offset:24576
s_add_u32 s66, s66, 4096
s_and_b32 s66, s66, 0xffff
s_waitcnt lgkmcnt(9)
v_mfma_f32_16x16x32_bf16 v[20:23], v[60:63], v[120:123], v[20:23]
ds_read_b64_tr_b16 v[50:51], v8 offset:25600
v_mfma_f32_16x16x32_bf16 v[36:39], v[56:59], v[116:119], v[36:39]
ds_read_b64_tr_b16 v[52:53], v8 offset:28672
v_mfma_f32_16x16x32_bf16 v[36:39], v[60:63], v[124:127], v[36:39]
ds_read_b64_tr_b16 v[54:55], v8 offset:29696
s_waitcnt lgkmcnt(10)
v_mfma_f32_16x16x32_bf16 v[24:27], v[64:67], v[112:115], v[24:27]
ds_read_b64_tr_b16 v[56:57], v9 offset:24576
s_waitcnt lgkmcnt(9)
v_mfma_f32_16x16x32_bf16 v[24:27], v[68:71], v[120:123], v[24:27]
ds_read_b64_tr_b16 v[58:59], v9 offset:25600
v_mfma_f32_16x16x32_bf16 v[40:43], v[64:67], v[116:119], v[40:43]
ds_read_b64_tr_b16 v[60:61], v9 offset:28672
v_mfma_f32_16x16x32_bf16 v[40:43], v[68:71], v[124:127], v[40:43]
ds_read_b64_tr_b16 v[62:63], v9 offset:29696
s_waitcnt lgkmcnt(10)
v_mfma_f32_16x16x32_bf16 v[28:31], v[72:75], v[112:115], v[28:31]
ds_read_b64_tr_b16 v[64:65], v10 offset:24576
s_waitcnt lgkmcnt(9)
v_mfma_f32_16x16x32_bf16 v[28:31], v[76:79], v[120:123], v[28:31]
ds_read_b64_tr_b16 v[66:67], v10 offset:25600
v_mfma_f32_16x16x32_bf16 v[44:47], v[72:75], v[116:119], v[44:47]
ds_read_b64_tr_b16 v[68:69], v10 offset:28672
v_mfma_f32_16x16x32_bf16 v[44:47], v[76:79], v[124:127], v[44:47]
ds_read_b64_tr_b16 v[70:71], v10 offset:29696
s_waitcnt vmcnt(27) lgkmcnt(10)
v_mfma_f32_16x16x32_bf16 v[16:19], v[48:51], v[128:131], v[16:19]
ds_read_b64_tr_b16 v[72:73], v11 offset:24576
buffer_load_dwordx4 v[112:115], v6, s[20:23], s66 offen offset:0 sc1
s_waitcnt vmcnt(27) lgkmcnt(9)
v_mfma_f32_16x16x32_bf16 v[16:19], v[52:55], v[136:139], v[16:19]
ds_read_b64_tr_b16 v[74:75], v11 offset:25600
buffer_load_dwordx4 v[120:123], v6, s[20:23], s66 offen offset:2048 sc1
s_waitcnt vmcnt(27)
v_mfma_f32_16x16x32_bf16 v[32:35], v[48:51], v[132:135], v[32:35]
ds_read_b64_tr_b16 v[76:77], v11 offset:28672
buffer_load_dwordx4 v[116:119], v6, s[20:23], s66 offen offset:256 sc1
s_waitcnt vmcnt(27)
v_mfma_f32_16x16x32_bf16 v[32:35], v[52:55], v[140:143], v[32:35]
ds_read_b64_tr_b16 v[78:79], v11 offset:29696
buffer_load_dwordx4 v[124:127], v6, s[20:23], s66 offen offset:2304 sc1
s_waitcnt lgkmcnt(10)
v_mfma_f32_16x16x32_bf16 v[20:23], v[56:59], v[128:131], v[20:23]
ds_read_b64_tr_b16 v[48:49], v8 offset:32768
s_add_u32 s66, s66, 4096
s_and_b32 s66, s66, 0xffff
s_waitcnt lgkmcnt(9)
v_mfma_f32_16x16x32_bf16 v[20:23], v[60:63], v[136:139], v[20:23]
ds_read_b64_tr_b16 v[50:51], v8 offset:33792
v_mfma_f32_16x16x32_bf16 v[36:39], v[56:59], v[132:135], v[36:39]
ds_read_b64_tr_b16 v[52:53], v8 offset:36864
v_mfma_f32_16x16x32_bf16 v[36:39], v[60:63], v[140:143], v[36:39]
ds_read_b64_tr_b16 v[54:55], v8 offset:37888
s_waitcnt lgkmcnt(10)
v_mfma_f32_16x16x32_bf16 v[24:27], v[64:67], v[128:131], v[24:27]
ds_read_b64_tr_b16 v[56:57], v9 offset:32768
s_waitcnt lgkmcnt(9)
v_mfma_f32_16x16x32_bf16 v[24:27], v[68:71], v[136:139], v[24:27]
ds_read_b64_tr_b16 v[58:59], v9 offset:33792
v_mfma_f32_16x16x32_bf16 v[40:43], v[64:67], v[132:135], v[40:43]
ds_read_b64_tr_b16 v[60:61], v9 offset:36864
v_mfma_f32_16x16x32_bf16 v[40:43], v[68:71], v[140:143], v[40:43]
ds_read_b64_tr_b16 v[62:63], v9 offset:37888
s_waitcnt lgkmcnt(10)
v_mfma_f32_16x16x32_bf16 v[28:31], v[72:75], v[128:131], v[28:31]
ds_read_b64_tr_b16 v[64:65], v10 offset:32768
s_waitcnt lgkmcnt(9)
v_mfma_f32_16x16x32_bf16 v[28:31], v[76:79], v[136:139], v[28:31]
ds_read_b64_tr_b16 v[66:67], v10 offset:33792
v_mfma_f32_16x16x32_bf16 v[44:47], v[72:75], v[132:135], v[44:47]
ds_read_b64_tr_b16 v[68:69], v10 offset:36864
v_mfma_f32_16x16x32_bf16 v[44:47], v[76:79], v[140:143], v[44:47]
ds_read_b64_tr_b16 v[70:71], v10 offset:37888
s_waitcnt vmcnt(27) lgkmcnt(10)
v_mfma_f32_16x16x32_bf16 v[16:19], v[48:51], v[144:147], v[16:19]
ds_read_b64_tr_b16 v[72:73], v11 offset:32768
buffer_load_dwordx4 v[128:131], v6, s[20:23], s66 offen offset:0 sc1
s_waitcnt vmcnt(27) lgkmcnt(9)
v_mfma_f32_16x16x32_bf16 v[16:19], v[52:55], v[152:155], v[16:19]
ds_read_b64_tr_b16 v[74:75], v11 offset:33792
buffer_load_dwordx4 v[136:139], v6, s[20:23], s66 offen offset:2048 sc1
s_waitcnt vmcnt(27)
v_mfma_f32_16x16x32_bf16 v[32:35], v[48:51], v[148:151], v[32:35]
ds_read_b64_tr_b16 v[76:77], v11 offset:36864
buffer_load_dwordx4 v[132:135], v6, s[20:23], s66 offen offset:256 sc1
s_waitcnt vmcnt(27)
v_mfma_f32_16x16x32_bf16 v[32:35], v[52:55], v[156:159], v[32:35]
ds_read_b64_tr_b16 v[78:79], v11 offset:37888
buffer_load_dwordx4 v[140:143], v6, s[20:23], s66 offen offset:2304 sc1
s_waitcnt lgkmcnt(10)
v_mfma_f32_16x16x32_bf16 v[20:23], v[56:59], v[144:147], v[20:23]
ds_read_b64_tr_b16 v[48:49], v8 offset:40960
s_add_u32 s66, s66, 4096
s_and_b32 s66, s66, 0xffff
s_waitcnt lgkmcnt(9)
v_mfma_f32_16x16x32_bf16 v[20:23], v[60:63], v[152:155], v[20:23]
ds_read_b64_tr_b16 v[50:51], v8 offset:41984
v_mfma_f32_16x16x32_bf16 v[36:39], v[56:59], v[148:151], v[36:39]
ds_read_b64_tr_b16 v[52:53], v8 offset:45056
v_mfma_f32_16x16x32_bf16 v[36:39], v[60:63], v[156:159], v[36:39]
ds_read_b64_tr_b16 v[54:55], v8 offset:46080
s_waitcnt lgkmcnt(10)
v_mfma_f32_16x16x32_bf16 v[24:27], v[64:67], v[144:147], v[24:27]
ds_read_b64_tr_b16 v[56:57], v9 offset:40960
s_waitcnt lgkmcnt(9)
v_mfma_f32_16x16x32_bf16 v[24:27], v[68:71], v[152:155], v[24:27]
ds_read_b64_tr_b16 v[58:59], v9 offset:41984
v_mfma_f32_16x16x32_bf16 v[40:43], v[64:67], v[148:151], v[40:43]
ds_read_b64_tr_b16 v[60:61], v9 offset:45056
v_mfma_f32_16x16x32_bf16 v[40:43], v[68:71], v[156:159], v[40:43]
ds_read_b64_tr_b16 v[62:63], v9 offset:46080
s_waitcnt lgkmcnt(10)
v_mfma_f32_16x16x32_bf16 v[28:31], v[72:75], v[144:147], v[28:31]
ds_read_b64_tr_b16 v[64:65], v10 offset:40960
s_waitcnt lgkmcnt(9)
v_mfma_f32_16x16x32_bf16 v[28:31], v[76:79], v[152:155], v[28:31]
ds_read_b64_tr_b16 v[66:67], v10 offset:41984
v_mfma_f32_16x16x32_bf16 v[44:47], v[72:75], v[148:151], v[44:47]
ds_read_b64_tr_b16 v[68:69], v10 offset:45056
v_mfma_f32_16x16x32_bf16 v[44:47], v[76:79], v[156:159], v[44:47]
ds_read_b64_tr_b16 v[70:71], v10 offset:46080
s_waitcnt vmcnt(27) lgkmcnt(10)
v_mfma_f32_16x16x32_bf16 v[16:19], v[48:51], v[160:163], v[16:19]
ds_read_b64_tr_b16 v[72:73], v11 offset:40960
buffer_load_dwordx4 v[144:147], v6, s[20:23], s66 offen offset:0 sc1
s_waitcnt vmcnt(27) lgkmcnt(9)
v_mfma_f32_16x16x32_bf16 v[16:19], v[52:55], v[168:171], v[16:19]
ds_read_b64_tr_b16 v[74:75], v11 offset:41984
buffer_load_dwordx4 v[152:155], v6, s[20:23], s66 offen offset:2048 sc1
s_waitcnt vmcnt(27)
v_mfma_f32_16x16x32_bf16 v[32:35], v[48:51], v[164:167], v[32:35]
ds_read_b64_tr_b16 v[76:77], v11 offset:45056
buffer_load_dwordx4 v[148:151], v6, s[20:23], s66 offen offset:256 sc1
s_waitcnt vmcnt(27)
v_mfma_f32_16x16x32_bf16 v[32:35], v[52:55], v[172:175], v[32:35]
ds_read_b64_tr_b16 v[78:79], v11 offset:46080
buffer_load_dwordx4 v[156:159], v6, s[20:23], s66 offen offset:2304 sc1
s_waitcnt lgkmcnt(10)
v_mfma_f32_16x16x32_bf16 v[20:23], v[56:59], v[160:163], v[20:23]
ds_read_b64_tr_b16 v[48:49], v8 offset:49152
s_add_u32 s66, s66, 4096
s_and_b32 s66, s66, 0xffff
s_waitcnt lgkmcnt(9)
v_mfma_f32_16x16x32_bf16 v[20:23], v[60:63], v[168:171], v[20:23]
ds_read_b64_tr_b16 v[50:51], v8 offset:50176
v_mfma_f32_16x16x32_bf16 v[36:39], v[56:59], v[164:167], v[36:39]
ds_read_b64_tr_b16 v[52:53], v8 offset:53248
v_mfma_f32_16x16x32_bf16 v[36:39], v[60:63], v[172:175], v[36:39]
ds_read_b64_tr_b16 v[54:55], v8 offset:54272
s_waitcnt lgkmcnt(10)
v_mfma_f32_16x16x32_bf16 v[24:27], v[64:67], v[160:163], v[24:27]
ds_read_b64_tr_b16 v[56:57], v9 offset:49152
s_waitcnt lgkmcnt(9)
v_mfma_f32_16x16x32_bf16 v[24:27], v[68:71], v[168:171], v[24:27]
ds_read_b64_tr_b16 v[58:59], v9 offset:50176
v_mfma_f32_16x16x32_bf16 v[40:43], v[64:67], v[164:167], v[40:43]
ds_read_b64_tr_b16 v[60:61], v9 offset:53248
v_mfma_f32_16x16x32_bf16 v[40:43], v[68:71], v[172:175], v[40:43]
ds_read_b64_tr_b16 v[62:63], v9 offset:54272
s_waitcnt lgkmcnt(10)
v_mfma_f32_16x16x32_bf16 v[28:31], v[72:75], v[160:163], v[28:31]
ds_read_b64_tr_b16 v[64:65], v10 offset:49152
s_waitcnt lgkmcnt(9)
v_mfma_f32_16x16x32_bf16 v[28:31], v[76:79], v[168:171], v[28:31]
ds_read_b64_tr_b16 v[66:67], v10 offset:50176
v_mfma_f32_16x16x32_bf16 v[44:47], v[72:75], v[164:167], v[44:47]
ds_read_b64_tr_b16 v[68:69], v10 offset:53248
v_mfma_f32_16x16x32_bf16 v[44:47], v[76:79], v[172:175], v[44:47]
ds_read_b64_tr_b16 v[70:71], v10 offset:54272
s_waitcnt vmcnt(27) lgkmcnt(10)
v_mfma_f32_16x16x32_bf16 v[16:19], v[48:51], v[176:179], v[16:19]
ds_read_b64_tr_b16 v[72:73], v11 offset:49152
buffer_load_dwordx4 v[160:163], v6, s[20:23], s66 offen offset:0 sc1
s_waitcnt vmcnt(27) lgkmcnt(9)
v_mfma_f32_16x16x32_bf16 v[16:19], v[52:55], v[184:187], v[16:19]
ds_read_b64_tr_b16 v[74:75], v11 offset:50176
buffer_load_dwordx4 v[168:171], v6, s[20:23], s66 offen offset:2048 sc1
s_waitcnt vmcnt(27)
v_mfma_f32_16x16x32_bf16 v[32:35], v[48:51], v[180:183], v[32:35]
ds_read_b64_tr_b16 v[76:77], v11 offset:53248
buffer_load_dwordx4 v[164:167], v6, s[20:23], s66 offen offset:256 sc1
s_waitcnt vmcnt(27)
v_mfma_f32_16x16x32_bf16 v[32:35], v[52:55], v[188:191], v[32:35]
ds_read_b64_tr_b16 v[78:79], v11 offset:54272
buffer_load_dwordx4 v[172:175], v6, s[20:23], s66 offen offset:2304 sc1
s_waitcnt lgkmcnt(10)
v_mfma_f32_16x16x32_bf16 v[20:23], v[56:59], v[176:179], v[20:23]
ds_read_b64_tr_b16 v[48:49], v8 offset:57344
s_add_u32 s66, s66, 4096
s_and_b32 s66, s66, 0xffff
s_waitcnt lgkmcnt(9)
v_mfma_f32_16x16x32_bf16 v[20:23], v[60:63], v[184:187], v[20:23]
ds_read_b64_tr_b16 v[50:51], v8 offset:58368
v_mfma_f32_16x16x32_bf16 v[36:39], v[56:59], v[180:183], v[36:39]
ds_read_b64_tr_b16 v[52:53], v8 offset:61440
v_mfma_f32_16x16x32_bf16 v[36:39], v[60:63], v[188:191], v[36:39]
ds_read_b64_tr_b16 v[54:55], v8 offset:62464
s_waitcnt lgkmcnt(10)
v_mfma_f32_16x16x32_bf16 v[24:27], v[64:67], v[176:179], v[24:27]
ds_read_b64_tr_b16 v[56:57], v9 offset:57344
s_waitcnt lgkmcnt(9)
v_mfma_f32_16x16x32_bf16 v[24:27], v[68:71], v[184:187], v[24:27]
ds_read_b64_tr_b16 v[58:59], v9 offset:58368
v_mfma_f32_16x16x32_bf16 v[40:43], v[64:67], v[180:183], v[40:43]
ds_read_b64_tr_b16 v[60:61], v9 offset:61440
v_mfma_f32_16x16x32_bf16 v[40:43], v[68:71], v[188:191], v[40:43]
ds_read_b64_tr_b16 v[62:63], v9 offset:62464
s_waitcnt lgkmcnt(10)
v_mfma_f32_16x16x32_bf16 v[28:31], v[72:75], v[176:179], v[28:31]
ds_read_b64_tr_b16 v[64:65], v10 offset:57344
s_waitcnt lgkmcnt(9)
v_mfma_f32_16x16x32_bf16 v[28:31], v[76:79], v[184:187], v[28:31]
ds_read_b64_tr_b16 v[66:67], v10 offset:58368
v_mfma_f32_16x16x32_bf16 v[44:47], v[72:75], v[180:183], v[44:47]
ds_read_b64_tr_b16 v[68:69], v10 offset:61440
v_mfma_f32_16x16x32_bf16 v[44:47], v[76:79], v[188:191], v[44:47]
ds_read_b64_tr_b16 v[70:71], v10 offset:62464
s_waitcnt vmcnt(27) lgkmcnt(10)
v_mfma_f32_16x16x32_bf16 v[16:19], v[48:51], v[192:195], v[16:19]
ds_read_b64_tr_b16 v[72:73], v11 offset:57344
buffer_load_dwordx4 v[176:179], v6, s[20:23], s66 offen offset:0 sc1
s_waitcnt vmcnt(27) lgkmcnt(9)
v_mfma_f32_16x16x32_bf16 v[16:19], v[52:55], v[200:203], v[16:19]
ds_read_b64_tr_b16 v[74:75], v11 offset:58368
buffer_load_dwordx4 v[184:187], v6, s[20:23], s66 offen offset:2048 sc1
s_waitcnt vmcnt(27)
v_mfma_f32_16x16x32_bf16 v[32:35], v[48:51], v[196:199], v[32:35]
ds_read_b64_tr_b16 v[76:77], v11 offset:61440
buffer_load_dwordx4 v[180:183], v6, s[20:23], s66 offen offset:256 sc1
s_waitcnt vmcnt(27)
v_mfma_f32_16x16x32_bf16 v[32:35], v[52:55], v[204:207], v[32:35]
ds_read_b64_tr_b16 v[78:79], v11 offset:62464
buffer_load_dwordx4 v[188:191], v6, s[20:23], s66 offen offset:2304 sc1
s_waitcnt lgkmcnt(10)
v_mfma_f32_16x16x32_bf16 v[20:23], v[56:59], v[192:195], v[20:23]
ds_read_b64_tr_b16 v[48:49], v12 offset:0
s_add_u32 s66, s66, 4096
s_and_b32 s66, s66, 0xffff
s_waitcnt lgkmcnt(9)
v_mfma_f32_16x16x32_bf16 v[20:23], v[60:63], v[200:203], v[20:23]
ds_read_b64_tr_b16 v[50:51], v12 offset:1024
v_mfma_f32_16x16x32_bf16 v[36:39], v[56:59], v[196:199], v[36:39]
ds_read_b64_tr_b16 v[52:53], v12 offset:4096
v_mfma_f32_16x16x32_bf16 v[36:39], v[60:63], v[204:207], v[36:39]
ds_read_b64_tr_b16 v[54:55], v12 offset:5120
s_waitcnt lgkmcnt(10)
v_mfma_f32_16x16x32_bf16 v[24:27], v[64:67], v[192:195], v[24:27]
ds_read_b64_tr_b16 v[56:57], v13 offset:0
s_waitcnt lgkmcnt(9)
v_mfma_f32_16x16x32_bf16 v[24:27], v[68:71], v[200:203], v[24:27]
ds_read_b64_tr_b16 v[58:59], v13 offset:1024
v_mfma_f32_16x16x32_bf16 v[40:43], v[64:67], v[196:199], v[40:43]
ds_read_b64_tr_b16 v[60:61], v13 offset:4096
v_mfma_f32_16x16x32_bf16 v[40:43], v[68:71], v[204:207], v[40:43]
ds_read_b64_tr_b16 v[62:63], v13 offset:5120
s_waitcnt lgkmcnt(10)
v_mfma_f32_16x16x32_bf16 v[28:31], v[72:75], v[192:195], v[28:31]
ds_read_b64_tr_b16 v[64:65], v14 offset:0
s_waitcnt lgkmcnt(9)
v_mfma_f32_16x16x32_bf16 v[28:31], v[76:79], v[200:203], v[28:31]
ds_read_b64_tr_b16 v[66:67], v14 offset:1024
v_mfma_f32_16x16x32_bf16 v[44:47], v[72:75], v[196:199], v[44:47]
ds_read_b64_tr_b16 v[68:69], v14 offset:4096
v_mfma_f32_16x16x32_bf16 v[44:47], v[76:79], v[204:207], v[44:47]
ds_read_b64_tr_b16 v[70:71], v14 offset:5120
s_waitcnt vmcnt(27) lgkmcnt(10)
v_mfma_f32_16x16x32_bf16 v[16:19], v[48:51], v[80:83], v[16:19]
ds_read_b64_tr_b16 v[72:73], v15 offset:0
buffer_load_dwordx4 v[192:195], v6, s[20:23], s66 offen offset:0 sc1
s_waitcnt vmcnt(27) lgkmcnt(9)
v_mfma_f32_16x16x32_bf16 v[16:19], v[52:55], v[88:91], v[16:19]
ds_read_b64_tr_b16 v[74:75], v15 offset:1024
buffer_load_dwordx4 v[200:203], v6, s[20:23], s66 offen offset:2048 sc1
s_waitcnt vmcnt(27)
v_mfma_f32_16x16x32_bf16 v[32:35], v[48:51], v[84:87], v[32:35]
ds_read_b64_tr_b16 v[76:77], v15 offset:4096
buffer_load_dwordx4 v[196:199], v6, s[20:23], s66 offen offset:256 sc1
s_waitcnt vmcnt(27)
v_mfma_f32_16x16x32_bf16 v[32:35], v[52:55], v[92:95], v[32:35]
ds_read_b64_tr_b16 v[78:79], v15 offset:5120
buffer_load_dwordx4 v[204:207], v6, s[20:23], s66 offen offset:2304 sc1
s_waitcnt lgkmcnt(10)
v_mfma_f32_16x16x32_bf16 v[20:23], v[56:59], v[80:83], v[20:23]
ds_read_b64_tr_b16 v[48:49], v12 offset:8192
s_add_u32 s66, s66, 4096
s_and_b32 s66, s66, 0xffff
s_waitcnt lgkmcnt(9)
v_mfma_f32_16x16x32_bf16 v[20:23], v[60:63], v[88:91], v[20:23]
ds_read_b64_tr_b16 v[50:51], v12 offset:9216
v_mfma_f32_16x16x32_bf16 v[36:39], v[56:59], v[84:87], v[36:39]
ds_read_b64_tr_b16 v[52:53], v12 offset:12288
v_mfma_f32_16x16x32_bf16 v[36:39], v[60:63], v[92:95], v[36:39]
ds_read_b64_tr_b16 v[54:55], v12 offset:13312
s_waitcnt lgkmcnt(10)
v_mfma_f32_16x16x32_bf16 v[24:27], v[64:67], v[80:83], v[24:27]
ds_read_b64_tr_b16 v[56:57], v13 offset:8192
s_waitcnt lgkmcnt(9)
v_mfma_f32_16x16x32_bf16 v[24:27], v[68:71], v[88:91], v[24:27]
ds_read_b64_tr_b16 v[58:59], v13 offset:9216
v_mfma_f32_16x16x32_bf16 v[40:43], v[64:67], v[84:87], v[40:43]
ds_read_b64_tr_b16 v[60:61], v13 offset:12288
v_mfma_f32_16x16x32_bf16 v[40:43], v[68:71], v[92:95], v[40:43]
ds_read_b64_tr_b16 v[62:63], v13 offset:13312
s_waitcnt lgkmcnt(10)
v_mfma_f32_16x16x32_bf16 v[28:31], v[72:75], v[80:83], v[28:31]
ds_read_b64_tr_b16 v[64:65], v14 offset:8192
s_waitcnt lgkmcnt(9)
v_mfma_f32_16x16x32_bf16 v[28:31], v[76:79], v[88:91], v[28:31]
ds_read_b64_tr_b16 v[66:67], v14 offset:9216
v_mfma_f32_16x16x32_bf16 v[44:47], v[72:75], v[84:87], v[44:47]
ds_read_b64_tr_b16 v[68:69], v14 offset:12288
v_mfma_f32_16x16x32_bf16 v[44:47], v[76:79], v[92:95], v[44:47]
ds_read_b64_tr_b16 v[70:71], v14 offset:13312
s_waitcnt vmcnt(27) lgkmcnt(10)
v_mfma_f32_16x16x32_bf16 v[16:19], v[48:51], v[96:99], v[16:19]
ds_read_b64_tr_b16 v[72:73], v15 offset:8192
s_waitcnt vmcnt(26) lgkmcnt(9)
v_mfma_f32_16x16x32_bf16 v[16:19], v[52:55], v[104:107], v[16:19]
ds_read_b64_tr_b16 v[74:75], v15 offset:9216
s_waitcnt vmcnt(25)
v_mfma_f32_16x16x32_bf16 v[32:35], v[48:51], v[100:103], v[32:35]
ds_read_b64_tr_b16 v[76:77], v15 offset:12288
s_waitcnt vmcnt(24)
v_mfma_f32_16x16x32_bf16 v[32:35], v[52:55], v[108:111], v[32:35]
ds_read_b64_tr_b16 v[78:79], v15 offset:13312
s_waitcnt lgkmcnt(10)
v_mfma_f32_16x16x32_bf16 v[20:23], v[56:59], v[96:99], v[20:23]
ds_read_b64_tr_b16 v[48:49], v12 offset:16384
s_waitcnt lgkmcnt(9)
v_mfma_f32_16x16x32_bf16 v[20:23], v[60:63], v[104:107], v[20:23]
ds_read_b64_tr_b16 v[50:51], v12 offset:17408
v_mfma_f32_16x16x32_bf16 v[36:39], v[56:59], v[100:103], v[36:39]
ds_read_b64_tr_b16 v[52:53], v12 offset:20480
v_mfma_f32_16x16x32_bf16 v[36:39], v[60:63], v[108:111], v[36:39]
ds_read_b64_tr_b16 v[54:55], v12 offset:21504
s_waitcnt lgkmcnt(10)
v_mfma_f32_16x16x32_bf16 v[24:27], v[64:67], v[96:99], v[24:27]
ds_read_b64_tr_b16 v[56:57], v13 offset:16384
s_waitcnt lgkmcnt(9)
v_mfma_f32_16x16x32_bf16 v[24:27], v[68:71], v[104:107], v[24:27]
ds_read_b64_tr_b16 v[58:59], v13 offset:17408
v_mfma_f32_16x16x32_bf16 v[40:43], v[64:67], v[100:103], v[40:43]
ds_read_b64_tr_b16 v[60:61], v13 offset:20480
v_mfma_f32_16x16x32_bf16 v[40:43], v[68:71], v[108:111], v[40:43]
ds_read_b64_tr_b16 v[62:63], v13 offset:21504
s_waitcnt lgkmcnt(10)
v_mfma_f32_16x16x32_bf16 v[28:31], v[72:75], v[96:99], v[28:31]
ds_read_b64_tr_b16 v[64:65], v14 offset:16384
s_waitcnt lgkmcnt(9)
v_mfma_f32_16x16x32_bf16 v[28:31], v[76:79], v[104:107], v[28:31]
ds_read_b64_tr_b16 v[66:67], v14 offset:17408
v_mfma_f32_16x16x32_bf16 v[44:47], v[72:75], v[100:103], v[44:47]
ds_read_b64_tr_b16 v[68:69], v14 offset:20480
v_mfma_f32_16x16x32_bf16 v[44:47], v[76:79], v[108:111], v[44:47]
ds_read_b64_tr_b16 v[70:71], v14 offset:21504
s_waitcnt vmcnt(23) lgkmcnt(10)
v_mfma_f32_16x16x32_bf16 v[16:19], v[48:51], v[112:115], v[16:19]
ds_read_b64_tr_b16 v[72:73], v15 offset:16384
s_waitcnt vmcnt(22) lgkmcnt(9)
v_mfma_f32_16x16x32_bf16 v[16:19], v[52:55], v[120:123], v[16:19]
ds_read_b64_tr_b16 v[74:75], v15 offset:17408
s_waitcnt vmcnt(21)
v_mfma_f32_16x16x32_bf16 v[32:35], v[48:51], v[116:119], v[32:35]
ds_read_b64_tr_b16 v[76:77], v15 offset:20480
s_waitcnt vmcnt(20)
v_mfma_f32_16x16x32_bf16 v[32:35], v[52:55], v[124:127], v[32:35]
ds_read_b64_tr_b16 v[78:79], v15 offset:21504
s_waitcnt lgkmcnt(10)
v_mfma_f32_16x16x32_bf16 v[20:23], v[56:59], v[112:115], v[20:23]
ds_read_b64_tr_b16 v[48:49], v12 offset:24576
s_waitcnt lgkmcnt(9)
v_mfma_f32_16x16x32_bf16 v[20:23], v[60:63], v[120:123], v[20:23]
ds_read_b64_tr_b16 v[50:51], v12 offset:25600
v_mfma_f32_16x16x32_bf16 v[36:39], v[56:59], v[116:119], v[36:39]
ds_read_b64_tr_b16 v[52:53], v12 offset:28672
v_mfma_f32_16x16x32_bf16 v[36:39], v[60:63], v[124:127], v[36:39]
ds_read_b64_tr_b16 v[54:55], v12 offset:29696
s_waitcnt lgkmcnt(10)
v_mfma_f32_16x16x32_bf16 v[24:27], v[64:67], v[112:115], v[24:27]
ds_read_b64_tr_b16 v[56:57], v13 offset:24576
s_waitcnt lgkmcnt(9)
v_mfma_f32_16x16x32_bf16 v[24:27], v[68:71], v[120:123], v[24:27]
ds_read_b64_tr_b16 v[58:59], v13 offset:25600
v_mfma_f32_16x16x32_bf16 v[40:43], v[64:67], v[116:119], v[40:43]
ds_read_b64_tr_b16 v[60:61], v13 offset:28672
v_mfma_f32_16x16x32_bf16 v[40:43], v[68:71], v[124:127], v[40:43]
ds_read_b64_tr_b16 v[62:63], v13 offset:29696
s_waitcnt lgkmcnt(10)
v_mfma_f32_16x16x32_bf16 v[28:31], v[72:75], v[112:115], v[28:31]
ds_read_b64_tr_b16 v[64:65], v14 offset:24576
s_waitcnt lgkmcnt(9)
v_mfma_f32_16x16x32_bf16 v[28:31], v[76:79], v[120:123], v[28:31]
ds_read_b64_tr_b16 v[66:67], v14 offset:25600
v_mfma_f32_16x16x32_bf16 v[44:47], v[72:75], v[116:119], v[44:47]
ds_read_b64_tr_b16 v[68:69], v14 offset:28672
v_mfma_f32_16x16x32_bf16 v[44:47], v[76:79], v[124:127], v[44:47]
ds_read_b64_tr_b16 v[70:71], v14 offset:29696
s_waitcnt vmcnt(19) lgkmcnt(10)
v_mfma_f32_16x16x32_bf16 v[16:19], v[48:51], v[128:131], v[16:19]
ds_read_b64_tr_b16 v[72:73], v15 offset:24576
s_waitcnt vmcnt(18) lgkmcnt(9)
v_mfma_f32_16x16x32_bf16 v[16:19], v[52:55], v[136:139], v[16:19]
ds_read_b64_tr_b16 v[74:75], v15 offset:25600
s_waitcnt vmcnt(17)
v_mfma_f32_16x16x32_bf16 v[32:35], v[48:51], v[132:135], v[32:35]
ds_read_b64_tr_b16 v[76:77], v15 offset:28672
s_waitcnt vmcnt(16)
v_mfma_f32_16x16x32_bf16 v[32:35], v[52:55], v[140:143], v[32:35]
ds_read_b64_tr_b16 v[78:79], v15 offset:29696
s_waitcnt lgkmcnt(10)
v_mfma_f32_16x16x32_bf16 v[20:23], v[56:59], v[128:131], v[20:23]
ds_read_b64_tr_b16 v[48:49], v12 offset:32768
s_waitcnt lgkmcnt(9)
v_mfma_f32_16x16x32_bf16 v[20:23], v[60:63], v[136:139], v[20:23]
ds_read_b64_tr_b16 v[50:51], v12 offset:33792
v_mfma_f32_16x16x32_bf16 v[36:39], v[56:59], v[132:135], v[36:39]
ds_read_b64_tr_b16 v[52:53], v12 offset:36864
v_mfma_f32_16x16x32_bf16 v[36:39], v[60:63], v[140:143], v[36:39]
ds_read_b64_tr_b16 v[54:55], v12 offset:37888
s_waitcnt lgkmcnt(10)
v_mfma_f32_16x16x32_bf16 v[24:27], v[64:67], v[128:131], v[24:27]
ds_read_b64_tr_b16 v[56:57], v13 offset:32768
s_waitcnt lgkmcnt(9)
v_mfma_f32_16x16x32_bf16 v[24:27], v[68:71], v[136:139], v[24:27]
ds_read_b64_tr_b16 v[58:59], v13 offset:33792
v_mfma_f32_16x16x32_bf16 v[40:43], v[64:67], v[132:135], v[40:43]
ds_read_b64_tr_b16 v[60:61], v13 offset:36864
v_mfma_f32_16x16x32_bf16 v[40:43], v[68:71], v[140:143], v[40:43]
ds_read_b64_tr_b16 v[62:63], v13 offset:37888
s_waitcnt lgkmcnt(10)
v_mfma_f32_16x16x32_bf16 v[28:31], v[72:75], v[128:131], v[28:31]
ds_read_b64_tr_b16 v[64:65], v14 offset:32768
s_waitcnt lgkmcnt(9)
v_mfma_f32_16x16x32_bf16 v[28:31], v[76:79], v[136:139], v[28:31]
ds_read_b64_tr_b16 v[66:67], v14 offset:33792
v_mfma_f32_16x16x32_bf16 v[44:47], v[72:75], v[132:135], v[44:47]
ds_read_b64_tr_b16 v[68:69], v14 offset:36864
v_mfma_f32_16x16x32_bf16 v[44:47], v[76:79], v[140:143], v[44:47]
ds_read_b64_tr_b16 v[70:71], v14 offset:37888
s_waitcnt vmcnt(15) lgkmcnt(10)
v_mfma_f32_16x16x32_bf16 v[16:19], v[48:51], v[144:147], v[16:19]
ds_read_b64_tr_b16 v[72:73], v15 offset:32768
s_waitcnt vmcnt(14) lgkmcnt(9)
v_mfma_f32_16x16x32_bf16 v[16:19], v[52:55], v[152:155], v[16:19]
ds_read_b64_tr_b16 v[74:75], v15 offset:33792
s_waitcnt vmcnt(13)
v_mfma_f32_16x16x32_bf16 v[32:35], v[48:51], v[148:151], v[32:35]
ds_read_b64_tr_b16 v[76:77], v15 offset:36864
s_waitcnt vmcnt(12)
v_mfma_f32_16x16x32_bf16 v[32:35], v[52:55], v[156:159], v[32:35]
ds_read_b64_tr_b16 v[78:79], v15 offset:37888
s_waitcnt lgkmcnt(10)
v_mfma_f32_16x16x32_bf16 v[20:23], v[56:59], v[144:147], v[20:23]
ds_read_b64_tr_b16 v[48:49], v12 offset:40960
s_waitcnt lgkmcnt(9)
v_mfma_f32_16x16x32_bf16 v[20:23], v[60:63], v[152:155], v[20:23]
ds_read_b64_tr_b16 v[50:51], v12 offset:41984
v_mfma_f32_16x16x32_bf16 v[36:39], v[56:59], v[148:151], v[36:39]
ds_read_b64_tr_b16 v[52:53], v12 offset:45056
v_mfma_f32_16x16x32_bf16 v[36:39], v[60:63], v[156:159], v[36:39]
ds_read_b64_tr_b16 v[54:55], v12 offset:46080
s_waitcnt lgkmcnt(10)
v_mfma_f32_16x16x32_bf16 v[24:27], v[64:67], v[144:147], v[24:27]
ds_read_b64_tr_b16 v[56:57], v13 offset:40960
s_waitcnt lgkmcnt(9)
v_mfma_f32_16x16x32_bf16 v[24:27], v[68:71], v[152:155], v[24:27]
ds_read_b64_tr_b16 v[58:59], v13 offset:41984
v_mfma_f32_16x16x32_bf16 v[40:43], v[64:67], v[148:151], v[40:43]
ds_read_b64_tr_b16 v[60:61], v13 offset:45056
v_mfma_f32_16x16x32_bf16 v[40:43], v[68:71], v[156:159], v[40:43]
ds_read_b64_tr_b16 v[62:63], v13 offset:46080
s_waitcnt lgkmcnt(10)
v_mfma_f32_16x16x32_bf16 v[28:31], v[72:75], v[144:147], v[28:31]
ds_read_b64_tr_b16 v[64:65], v14 offset:40960
s_waitcnt lgkmcnt(9)
v_mfma_f32_16x16x32_bf16 v[28:31], v[76:79], v[152:155], v[28:31]
ds_read_b64_tr_b16 v[66:67], v14 offset:41984
v_mfma_f32_16x16x32_bf16 v[44:47], v[72:75], v[148:151], v[44:47]
ds_read_b64_tr_b16 v[68:69], v14 offset:45056
v_mfma_f32_16x16x32_bf16 v[44:47], v[76:79], v[156:159], v[44:47]
ds_read_b64_tr_b16 v[70:71], v14 offset:46080
s_waitcnt vmcnt(11) lgkmcnt(10)
v_mfma_f32_16x16x32_bf16 v[16:19], v[48:51], v[160:163], v[16:19]
ds_read_b64_tr_b16 v[72:73], v15 offset:40960
s_waitcnt vmcnt(10) lgkmcnt(9)
v_mfma_f32_16x16x32_bf16 v[16:19], v[52:55], v[168:171], v[16:19]
ds_read_b64_tr_b16 v[74:75], v15 offset:41984
s_waitcnt vmcnt(9)
v_mfma_f32_16x16x32_bf16 v[32:35], v[48:51], v[164:167], v[32:35]
ds_read_b64_tr_b16 v[76:77], v15 offset:45056
s_waitcnt vmcnt(8)
v_mfma_f32_16x16x32_bf16 v[32:35], v[52:55], v[172:175], v[32:35]
ds_read_b64_tr_b16 v[78:79], v15 offset:46080
s_waitcnt lgkmcnt(10)
v_mfma_f32_16x16x32_bf16 v[20:23], v[56:59], v[160:163], v[20:23]
ds_read_b64_tr_b16 v[48:49], v12 offset:49152
s_waitcnt lgkmcnt(9)
v_mfma_f32_16x16x32_bf16 v[20:23], v[60:63], v[168:171], v[20:23]
ds_read_b64_tr_b16 v[50:51], v12 offset:50176
v_mfma_f32_16x16x32_bf16 v[36:39], v[56:59], v[164:167], v[36:39]
ds_read_b64_tr_b16 v[52:53], v12 offset:53248
v_mfma_f32_16x16x32_bf16 v[36:39], v[60:63], v[172:175], v[36:39]
ds_read_b64_tr_b16 v[54:55], v12 offset:54272
s_waitcnt lgkmcnt(10)
v_mfma_f32_16x16x32_bf16 v[24:27], v[64:67], v[160:163], v[24:27]
ds_read_b64_tr_b16 v[56:57], v13 offset:49152
s_waitcnt lgkmcnt(9)
v_mfma_f32_16x16x32_bf16 v[24:27], v[68:71], v[168:171], v[24:27]
ds_read_b64_tr_b16 v[58:59], v13 offset:50176
v_mfma_f32_16x16x32_bf16 v[40:43], v[64:67], v[164:167], v[40:43]
ds_read_b64_tr_b16 v[60:61], v13 offset:53248
v_mfma_f32_16x16x32_bf16 v[40:43], v[68:71], v[172:175], v[40:43]
ds_read_b64_tr_b16 v[62:63], v13 offset:54272
s_waitcnt lgkmcnt(10)
v_mfma_f32_16x16x32_bf16 v[28:31], v[72:75], v[160:163], v[28:31]
ds_read_b64_tr_b16 v[64:65], v14 offset:49152
s_waitcnt lgkmcnt(9)
v_mfma_f32_16x16x32_bf16 v[28:31], v[76:79], v[168:171], v[28:31]
ds_read_b64_tr_b16 v[66:67], v14 offset:50176
v_mfma_f32_16x16x32_bf16 v[44:47], v[72:75], v[164:167], v[44:47]
ds_read_b64_tr_b16 v[68:69], v14 offset:53248
v_mfma_f32_16x16x32_bf16 v[44:47], v[76:79], v[172:175], v[44:47]
ds_read_b64_tr_b16 v[70:71], v14 offset:54272
s_waitcnt vmcnt(7) lgkmcnt(10)
v_mfma_f32_16x16x32_bf16 v[16:19], v[48:51], v[176:179], v[16:19]
ds_read_b64_tr_b16 v[72:73], v15 offset:49152
s_waitcnt vmcnt(6) lgkmcnt(9)
v_mfma_f32_16x16x32_bf16 v[16:19], v[52:55], v[184:187], v[16:19]
ds_read_b64_tr_b16 v[74:75], v15 offset:50176
s_waitcnt vmcnt(5)
v_mfma_f32_16x16x32_bf16 v[32:35], v[48:51], v[180:183], v[32:35]
ds_read_b64_tr_b16 v[76:77], v15 offset:53248
s_waitcnt vmcnt(4)
v_mfma_f32_16x16x32_bf16 v[32:35], v[52:55], v[188:191], v[32:35]
ds_read_b64_tr_b16 v[78:79], v15 offset:54272
s_waitcnt lgkmcnt(10)
v_mfma_f32_16x16x32_bf16 v[20:23], v[56:59], v[176:179], v[20:23]
ds_read_b64_tr_b16 v[48:49], v12 offset:57344
s_waitcnt lgkmcnt(9)
v_mfma_f32_16x16x32_bf16 v[20:23], v[60:63], v[184:187], v[20:23]
ds_read_b64_tr_b16 v[50:51], v12 offset:58368
v_mfma_f32_16x16x32_bf16 v[36:39], v[56:59], v[180:183], v[36:39]
ds_read_b64_tr_b16 v[52:53], v12 offset:61440
v_mfma_f32_16x16x32_bf16 v[36:39], v[60:63], v[188:191], v[36:39]
ds_read_b64_tr_b16 v[54:55], v12 offset:62464
s_waitcnt lgkmcnt(10)
v_mfma_f32_16x16x32_bf16 v[24:27], v[64:67], v[176:179], v[24:27]
ds_read_b64_tr_b16 v[56:57], v13 offset:57344
s_waitcnt lgkmcnt(9)
v_mfma_f32_16x16x32_bf16 v[24:27], v[68:71], v[184:187], v[24:27]
ds_read_b64_tr_b16 v[58:59], v13 offset:58368
v_mfma_f32_16x16x32_bf16 v[40:43], v[64:67], v[180:183], v[40:43]
ds_read_b64_tr_b16 v[60:61], v13 offset:61440
v_mfma_f32_16x16x32_bf16 v[40:43], v[68:71], v[188:191], v[40:43]
ds_read_b64_tr_b16 v[62:63], v13 offset:62464
s_waitcnt lgkmcnt(10)
v_mfma_f32_16x16x32_bf16 v[28:31], v[72:75], v[176:179], v[28:31]
ds_read_b64_tr_b16 v[64:65], v14 offset:57344
s_waitcnt lgkmcnt(9)
v_mfma_f32_16x16x32_bf16 v[28:31], v[76:79], v[184:187], v[28:31]
ds_read_b64_tr_b16 v[66:67], v14 offset:58368
v_mfma_f32_16x16x32_bf16 v[44:47], v[72:75], v[180:183], v[44:47]
ds_read_b64_tr_b16 v[68:69], v14 offset:61440
v_mfma_f32_16x16x32_bf16 v[44:47], v[76:79], v[188:191], v[44:47]
ds_read_b64_tr_b16 v[70:71], v14 offset:62464
s_waitcnt vmcnt(3) lgkmcnt(10)
v_mfma_f32_16x16x32_bf16 v[16:19], v[48:51], v[192:195], v[16:19]
ds_read_b64_tr_b16 v[72:73], v15 offset:57344
s_waitcnt vmcnt(2) lgkmcnt(9)
v_mfma_f32_16x16x32_bf16 v[16:19], v[52:55], v[200:203], v[16:19]
ds_read_b64_tr_b16 v[74:75], v15 offset:58368
s_waitcnt vmcnt(1)
v_mfma_f32_16x16x32_bf16 v[32:35], v[48:51], v[196:199], v[32:35]
ds_read_b64_tr_b16 v[76:77], v15 offset:61440
s_waitcnt vmcnt(0)
v_mfma_f32_16x16x32_bf16 v[32:35], v[52:55], v[204:207], v[32:35]
ds_read_b64_tr_b16 v[78:79], v15 offset:62464
s_waitcnt lgkmcnt(10)
v_mfma_f32_16x16x32_bf16 v[20:23], v[56:59], v[192:195], v[20:23]
v_add_u32 v5, s34, 22
s_mov_b64 exec, 1
ds_write_b32 v3, v5
s_mov_b64 exec, -1
s_waitcnt lgkmcnt(9)
v_mfma_f32_16x16x32_bf16 v[20:23], v[60:63], v[200:203], v[20:23]
v_mfma_f32_16x16x32_bf16 v[36:39], v[56:59], v[196:199], v[36:39]
v_mfma_f32_16x16x32_bf16 v[36:39], v[60:63], v[204:207], v[36:39]
s_waitcnt lgkmcnt(7)
v_mfma_f32_16x16x32_bf16 v[24:27], v[64:67], v[192:195], v[24:27]
s_waitcnt lgkmcnt(5)
v_mfma_f32_16x16x32_bf16 v[24:27], v[68:71], v[200:203], v[24:27]
v_mfma_f32_16x16x32_bf16 v[40:43], v[64:67], v[196:199], v[40:43]
v_mfma_f32_16x16x32_bf16 v[40:43], v[68:71], v[204:207], v[40:43]
s_waitcnt lgkmcnt(3)
v_mfma_f32_16x16x32_bf16 v[28:31], v[72:75], v[192:195], v[28:31]
s_waitcnt lgkmcnt(1)
v_mfma_f32_16x16x32_bf16 v[28:31], v[76:79], v[200:203], v[28:31]
v_mfma_f32_16x16x32_bf16 v[44:47], v[72:75], v[196:199], v[44:47]
v_mfma_f32_16x16x32_bf16 v[44:47], v[76:79], v[204:207], v[44:47]
s_lshl2_add_u32 s73, s61, s58
s_lshl4_add_u32 s66, s61, s62
s_lshl2_add_u32 s68, s66, s58
s_lshl_b32 s68, s68, 12
s_add_u32 s68, s68, 26214400
s_lshl_b32 s66, s66, 7
s_add_u32 s66, s66, 360448
s_lshl_b32 s74, s73, 13
s_add_u32 s74, s74, 524288
s_lshl_b32 s67, s62, 9
s_add_u32 s67, s67, s74
v_lshlrev_b32 v6, 4, v0
s_mov_b32 s69, 0x3f803f80
v_mov_b32 v8, 0
v_mov_b32 v9, 0
v_mov_b32 v10, 0
v_mov_b32 v11, 0
v_mov_b32 v12, 0
v_mov_b32 v13, 0
v_mov_b32 v14, 0
v_dot2c_f32_bf16 v11, s69, v232
v_dot2c_f32_bf16 v11, s69, v233
v_dot2c_f32_bf16 v11, s69, v234
v_dot2c_f32_bf16 v11, s69, v235
v_dot2c_f32_bf16 v11, s69, v236
v_dot2c_f32_bf16 v11, s69, v237
v_dot2c_f32_bf16 v11, s69, v238
v_dot2c_f32_bf16 v11, s69, v239
s_cmp_eq_u32 s63, 0
v_cvt_pk_bf16_f32 v240, v16, v17
v_cvt_pk_bf16_f32 v241, v18, v19
v_cvt_pk_bf16_f32 v242, v20, v21
v_cvt_pk_bf16_f32 v243, v22, v23
v_cvt_pk_bf16_f32 v244, v24, v25
v_cvt_pk_bf16_f32 v245, v26, v27
v_cvt_pk_bf16_f32 v246, v28, v29
v_cvt_pk_bf16_f32 v247, v30, v31
v_cvt_pk_bf16_f32 v248, v32, v33
v_cvt_pk_bf16_f32 v249, v34, v35
v_cvt_pk_bf16_f32 v250, v36, v37
v_cvt_pk_bf16_f32 v251, v38, v39
v_cvt_pk_bf16_f32 v252, v40, v41
v_cvt_pk_bf16_f32 v253, v42, v43
v_cvt_pk_bf16_f32 v254, v44, v45
v_cvt_pk_bf16_f32 v255, v46, v47
s_cselect_b64 exec, -1, 0
buffer_store_dwordx4 v[240:243], v6, s[20:23], s68 offen offset:0 sc1
buffer_store_dwordx4 v[244:247], v6, s[20:23], s68 offen offset:1024 sc1
buffer_store_dwordx4 v[248:251], v6, s[20:23], s68 offen offset:2048 sc1
buffer_store_dwordx4 v[252:255], v6, s[20:23], s68 offen offset:3072 sc1
s_mov_b64 exec, -1
v_dot2c_f32_bf16 v8, s69, v240
v_dot2c_f32_bf16 v9, v240, v240
v_dot2c_f32_bf16 v10, v232, v240
v_dot2c_f32_bf16 v12, s69, v248
v_dot2c_f32_bf16 v13, v248, v248
v_dot2c_f32_bf16 v14, v232, v248
v_dot2c_f32_bf16 v8, s69, v241
v_dot2c_f32_bf16 v9, v241, v241
v_dot2c_f32_bf16 v10, v233, v241
v_dot2c_f32_bf16 v12, s69, v249
v_dot2c_f32_bf16 v13, v249, v249
v_dot2c_f32_bf16 v14, v233, v249
v_dot2c_f32_bf16 v8, s69, v242
v_dot2c_f32_bf16 v9, v242, v242
v_dot2c_f32_bf16 v10, v234, v242
v_dot2c_f32_bf16 v12, s69, v250
v_dot2c_f32_bf16 v13, v250, v250
v_dot2c_f32_bf16 v14, v234, v250
v_dot2c_f32_bf16 v8, s69, v243
v_dot2c_f32_bf16 v9, v243, v243
v_dot2c_f32_bf16 v10, v235, v243
v_dot2c_f32_bf16 v12, s69, v251
v_dot2c_f32_bf16 v13, v251, v251
v_dot2c_f32_bf16 v14, v235, v251
v_dot2c_f32_bf16 v8, s69, v244
v_dot2c_f32_bf16 v9, v244, v244
v_dot2c_f32_bf16 v10, v236, v244
v_dot2c_f32_bf16 v12, s69, v252
v_dot2c_f32_bf16 v13, v252, v252
v_dot2c_f32_bf16 v14, v236, v252
v_dot2c_f32_bf16 v8, s69, v245
v_dot2c_f32_bf16 v9, v245, v245
v_dot2c_f32_bf16 v10, v237, v245
v_dot2c_f32_bf16 v12, s69, v253
v_dot2c_f32_bf16 v13, v253, v253
v_dot2c_f32_bf16 v14, v237, v253
v_dot2c_f32_bf16 v8, s69, v246
v_dot2c_f32_bf16 v9, v246, v246
v_dot2c_f32_bf16 v10, v238, v246
v_dot2c_f32_bf16 v12, s69, v254
v_dot2c_f32_bf16 v13, v254, v254
v_dot2c_f32_bf16 v14, v238, v254
v_dot2c_f32_bf16 v8, s69, v247
v_dot2c_f32_bf16 v9, v247, v247
v_dot2c_f32_bf16 v10, v239, v247
v_dot2c_f32_bf16 v12, s69, v255
v_dot2c_f32_bf16 v13, v255, v255
v_dot2c_f32_bf16 v14, v239, v255
v_mov_b32 v15, v11
v_lshrrev_b32 v7, 5, v0
v_mul_u32_u24 v7, 3584, v7
v_permlane16_swap_b32 v8, v12
v_permlane16_swap_b32 v9, v13
v_permlane16_swap_b32 v10, v14
v_permlane16_swap_b32 v11, v15
v_pk_add_f32 v[8:9], v[8:9], v[12:13]
v_pk_add_f32 v[10:11], v[10:11], v[14:15]
v_mov_b32 v12, v8
v_mov_b32 v13, v9
v_mov_b32 v14, v10
v_mov_b32 v15, v11
v_permlane32_swap_b32 v12, v8
v_permlane32_swap_b32 v13, v9
v_permlane32_swap_b32 v14, v10
v_permlane32_swap_b32 v15, v11
v_pk_add_f32 v[8:9], v[8:9], v[12:13]
v_pk_add_f32 v[10:11], v[10:11], v[14:15]
v_add_u32 v7, v6, v7
v_max_u32 v8, 1, v8
v_max_u32 v9, 1, v9
v_max_u32 v10, 1, v10
v_max_u32 v11, 1, v11
s_mov_b32 exec_hi, 0
buffer_store_dwordx4 v[8:11], v6, s[24:27], s67 offen sc1
s_mov_b32 exec_hi, -1
v_lshlrev_b32 v16, 16, v240
v_and_b32 v17, 0xffff0000, v240
v_lshlrev_b32 v18, 16, v241
v_and_b32 v19, 0xffff0000, v241
v_lshlrev_b32 v20, 16, v242
v_and_b32 v21, 0xffff0000, v242
v_lshlrev_b32 v22, 16, v243
v_and_b32 v23, 0xffff0000, v243
v_lshlrev_b32 v24, 16, v244
v_and_b32 v25, 0xffff0000, v244
v_lshlrev_b32 v26, 16, v245
v_and_b32 v27, 0xffff0000, v245
v_lshlrev_b32 v28, 16, v246
v_and_b32 v29, 0xffff0000, v246
v_lshlrev_b32 v30, 16, v247
v_and_b32 v31, 0xffff0000, v247
v_lshlrev_b32 v32, 16, v248
v_and_b32 v33, 0xffff0000, v248
v_lshlrev_b32 v34, 16, v249
v_and_b32 v35, 0xffff0000, v249
v_lshlrev_b32 v36, 16, v250
v_and_b32 v37, 0xffff0000, v250
v_lshlrev_b32 v38, 16, v251
v_and_b32 v39, 0xffff0000, v251
v_lshlrev_b32 v40, 16, v252
v_and_b32 v41, 0xffff0000, v252
v_lshlrev_b32 v42, 16, v253
v_and_b32 v43, 0xffff0000, v253
v_lshlrev_b32 v44, 16, v254
v_and_b32 v45, 0xffff0000, v254
v_lshlrev_b32 v46, 16, v255
v_and_b32 v47, 0xffff0000, v255
v_and_b32 v14, 15, v0
v_lshlrev_b32 v14, 11, v14
v_bfe_u32 v15, v0, 4, 1
v_lshl_add_u32 v14, v15, 5, v14
v_lshrrev_b32 v15, 5, v0
v_lshl_add_u32 v14, v15, 4, v14
s_lshl2_add_u32 s70, s61, s58
s_lshl_b32 s70, s70, 16
s_lshl_b32 s71, s62, 7
s_add_u32 s70, s70, s71
s_add_u32 s71, s70, 0x8000
s_lshl_b32 s67, s62, 6
s_add_u32 s67, s67, s73
s_lshl_b32 s67, s67, 7
s_add_u32 s67, s67, 425984
s_lshl4_add_u32 s68, s73, s62
s_lshl_b32 s69, s68, 8
s_add_u32 s69, s69, 2097152
s_lshl_b32 s68, s68, 7
s_add_u32 s68, s68, 1966080
s_lshl_b32 s75, s73, 5
s_add_u32 s75, s75, 1
v_and_b32 v15, 48, v0
v_add_u32 v13, s75, v0
s_mov_b64 exec, 1
s_waitcnt vmcnt(1)
buffer_store_dword v212, v3, s[24:27], s66 offen sc1
s_mov_b64 exec, -1
v_add_u32 v5, s34, 23
s_mov_b64 exec, 1
ds_write_b32 v3, v5
s_mov_b64 exec, -1
s_waitcnt vmcnt(1)
poll_116:
buffer_load_dwordx4 v[80:83], v7, s[24:27], s74 offen offset:0 sc1
buffer_load_dwordx4 v[84:87], v7, s[24:27], s74 offen offset:512 sc1
buffer_load_dwordx4 v[88:91], v7, s[24:27], s74 offen offset:1024 sc1
buffer_load_dwordx4 v[92:95], v7, s[24:27], s74 offen offset:1536 sc1
buffer_load_dwordx4 v[96:99], v7, s[24:27], s74 offen offset:2048 sc1
buffer_load_dwordx4 v[100:103], v7, s[24:27], s74 offen offset:2560 sc1
buffer_load_dwordx4 v[104:107], v7, s[24:27], s74 offen offset:3072 sc1
buffer_load_dwordx4 v[108:111], v7, s[24:27], s74 offen offset:3584 sc1
pchk_117:
s_waitcnt vmcnt(7)
v_min3_u32 v8, v80, v81, v82
s_waitcnt vmcnt(6)
v_min3_u32 v8, v8, v83, v84
v_min3_u32 v8, v8, v85, v86
s_waitcnt vmcnt(5)
v_min3_u32 v8, v8, v87, v88
v_min3_u32 v8, v8, v89, v90
s_waitcnt vmcnt(4)
v_min3_u32 v8, v8, v91, v92
v_min3_u32 v8, v8, v93, v94
s_waitcnt vmcnt(3)
v_min3_u32 v8, v8, v95, v96
v_min3_u32 v8, v8, v97, v98
s_waitcnt vmcnt(2)
v_min3_u32 v8, v8, v99, v100
v_min3_u32 v8, v8, v101, v102
s_waitcnt vmcnt(1)
v_min3_u32 v8, v8, v103, v104
v_min3_u32 v8, v8, v105, v106
s_waitcnt vmcnt(0)
v_min3_u32 v8, v8, v107, v108
v_min3_u32 v8, v8, v109, v110
v_min_u32 v8, v8, v111
v_cmp_eq_u32 vcc, 0, v8
s_cbranch_vccz pdone_118
s_sub_u32 s32, s32, 1
s_cmp_gt_i32 s32, 0
s_cbranch_scc1 poll_116
pdone_118:
v_pk_add_f32 v[80:81], v[80:81], v[96:97]
v_pk_add_f32 v[82:83], v[82:83], v[98:99]
v_pk_add_f32 v[84:85], v[84:85], v[100:101]
v_pk_add_f32 v[86:87], v[86:87], v[102:103]
v_pk_add_f32 v[88:89], v[88:89], v[104:105]
v_pk_add_f32 v[90:91], v[90:91], v[106:107]
v_pk_add_f32 v[92:93], v[92:93], v[108:109]
v_pk_add_f32 v[94:95], v[94:95], v[110:111]
v_pk_add_f32 v[80:81], v[80:81], v[88:89]
v_pk_add_f32 v[82:83], v[82:83], v[90:91]
v_pk_add_f32 v[84:85], v[84:85], v[92:93]
v_pk_add_f32 v[86:87], v[86:87], v[94:95]
v_pk_add_f32 v[80:81], v[80:81], v[84:85]
v_pk_add_f32 v[82:83], v[82:83], v[86:87]
v_mov_b32 v8, v80
v_mov_b32 v9, v81
v_mov_b32 v10, v82
v_mov_b32 v11, v83
v_permlane32_swap_b32 v8, v80
v_permlane32_swap_b32 v9, v81
v_permlane32_swap_b32 v10, v82
v_permlane32_swap_b32 v11, v83
v_pk_add_f32 v[8:9], v[8:9], v[80:81]
v_pk_add_f32 v[10:11], v[10:11], v[82:83]
v_mul_f32 v8, 0xba800000, v8
v_mul_f32 v9, 0x3a800000, v9
v_fma_f32 v9, -v8, v8, v9
v_max_f32 v9, 0, v9
v_add_f32 v12, 0x3727c5ac, v9
v_rsq_f32 v80, v12
v_fma_f32 v10, v8, v11, v10
v_mul_f32 v12, v80, v10
v_max_u32 v12, 1, v12
v_mov_b32 v10, v12
s_nop 1
v_max_f32_dpp v10, v10, v10 row_ror:1 row_mask:0xf bank_mask:0xf
s_nop 1
v_max_f32_dpp v10, v10, v10 row_ror:2 row_mask:0xf bank_mask:0xf
s_nop 1
v_max_f32_dpp v10, v10, v10 row_ror:4 row_mask:0xf bank_mask:0xf
s_nop 1
v_max_f32_dpp v10, v10, v10 row_ror:8 row_mask:0xf bank_mask:0xf
v_mov_b32 v11, v10
s_nop 1
v_permlane16_swap_b32 v11, v10
v_max_f32 v10, v10, v11
v_cmp_eq_f32 vcc, v10, v12
s_ff1_i32_b64 s66, vcc
s_and_b32 s66, s66, 31
s_lshl_b64 s[76:77], 1, s66
s_cmp_lt_u32 s62, 8
s_cselect_b64 exec, s[76:77], 0
buffer_store_dwordx2 v[12:13], off, s[24:27], s67 sc1
s_mov_b64 exec, -1
v_add_u32 v5, s34, 24
s_mov_b64 exec, 1
ds_write_b32 v3, v5
s_mov_b64 exec, -1
v_mul_f32 v81, v8, v80
v_add_f32 v10, 1.0, v80
v_mov_b32 v82, v80
v_mov_b32 v83, v81
s_and_b32 s67, s66, 15
s_lshl_b32 s67, 0x10001, s67
s_bitcmp0_b32 s66, 4
v_permlane16_swap_b32 v80, v82
v_permlane16_swap_b32 v81, v83
s_cselect_b32 s76, s67, 0
s_cselect_b32 s78, 0, s67
s_cselect_b32 s77, s67, 0
s_cselect_b32 s79, 0, s67
s_add_u32 s75, s75, s66
v_lshlrev_b32 v11, 1, v15
v_pk_fma_f32 v[48:49], v[16:17], v[80:81], v[80:81] op_sel:[0,0,1] op_sel_hi:[1,0,1]
v_pk_fma_f32 v[50:51], v[18:19], v[80:81], v[80:81] op_sel:[0,0,1] op_sel_hi:[1,0,1]
v_pk_fma_f32 v[52:53], v[20:21], v[80:81], v[80:81] op_sel:[0,0,1] op_sel_hi:[1,0,1]
v_pk_fma_f32 v[54:55], v[22:23], v[80:81], v[80:81] op_sel:[0,0,1] op_sel_hi:[1,0,1]
v_pk_fma_f32 v[56:57], v[24:25], v[80:81], v[80:81] op_sel:[0,0,1] op_sel_hi:[1,0,1]
v_pk_fma_f32 v[58:59], v[26:27], v[80:81], v[80:81] op_sel:[0,0,1] op_sel_hi:[1,0,1]
v_pk_fma_f32 v[60:61], v[28:29], v[80:81], v[80:81] op_sel:[0,0,1] op_sel_hi:[1,0,1]
v_pk_fma_f32 v[62:63], v[30:31], v[80:81], v[80:81] op_sel:[0,0,1] op_sel_hi:[1,0,1]
v_pk_fma_f32 v[64:65], v[32:33], v[82:83], v[82:83] op_sel:[0,0,1] op_sel_hi:[1,0,1]
v_pk_fma_f32 v[66:67], v[34:35], v[82:83], v[82:83] op_sel:[0,0,1] op_sel_hi:[1,0,1]
v_pk_fma_f32 v[68:69], v[36:37], v[82:83], v[82:83] op_sel:[0,0,1] op_sel_hi:[1,0,1]
v_pk_fma_f32 v[70:71], v[38:39], v[82:83], v[82:83] op_sel:[0,0,1] op_sel_hi:[1,0,1]
v_pk_fma_f32 v[72:73], v[40:41], v[82:83], v[82:83] op_sel:[0,0,1] op_sel_hi:[1,0,1]
v_pk_fma_f32 v[74:75], v[42:43], v[82:83], v[82:83] op_sel:[0,0,1] op_sel_hi:[1,0,1]
v_pk_fma_f32 v[76:77], v[44:45], v[82:83], v[82:83] op_sel:[0,0,1] op_sel_hi:[1,0,1]
v_pk_fma_f32 v[78:79], v[46:47], v[82:83], v[82:83] op_sel:[0,0,1] op_sel_hi:[1,0,1]
v_cvt_pk_bf16_f32 v84, v48, v49
v_cvt_pk_bf16_f32 v85, v50, v51
v_cvt_pk_bf16_f32 v86, v52, v53
v_cvt_pk_bf16_f32 v87, v54, v55
v_cvt_pk_bf16_f32 v88, v56, v57
v_cvt_pk_bf16_f32 v89, v58, v59
v_cvt_pk_bf16_f32 v90, v60, v61
v_cvt_pk_bf16_f32 v91, v62, v63
v_cvt_pk_bf16_f32 v92, v64, v65
v_cvt_pk_bf16_f32 v93, v66, v67
v_cvt_pk_bf16_f32 v94, v68, v69
v_cvt_pk_bf16_f32 v95, v70, v71
v_cvt_pk_bf16_f32 v96, v72, v73
v_cvt_pk_bf16_f32 v97, v74, v75
v_cvt_pk_bf16_f32 v98, v76, v77
v_cvt_pk_bf16_f32 v99, v78, v79
v_max_u32 v84, 1, v84
v_max_u32 v85, 1, v85
v_max_u32 v86, 1, v86
v_max_u32 v87, 1, v87
v_max_u32 v88, 1, v88
v_max_u32 v89, 1, v89
v_max_u32 v90, 1, v90
v_max_u32 v91, 1, v91
v_max_u32 v92, 1, v92
v_max_u32 v93, 1, v93
v_max_u32 v94, 1, v94
v_max_u32 v95, 1, v95
v_max_u32 v96, 1, v96
v_max_u32 v97, 1, v97
v_max_u32 v98, 1, v98
v_max_u32 v99, 1, v99
s_mov_b64 exec, s[76:77]
buffer_store_dwordx4 v[84:87], v11, s[24:27], s68 offen offset:0 sc1
buffer_store_dwordx4 v[88:91], v11, s[24:27], s68 offen offset:16 sc1
s_mov_b64 exec, s[78:79]
buffer_store_dwordx4 v[92:95], v11, s[24:27], s68 offen offset:0 sc1
buffer_store_dwordx4 v[96:99], v11, s[24:27], s68 offen offset:16 sc1
s_mov_b64 exec, -1
v_pk_add_f32 v[16:17], v[16:17], v[48:49]
v_pk_add_f32 v[18:19], v[18:19], v[50:51]
v_pk_add_f32 v[20:21], v[20:21], v[52:53]
v_pk_add_f32 v[22:23], v[22:23], v[54:55]
v_pk_add_f32 v[24:25], v[24:25], v[56:57]
v_pk_add_f32 v[26:27], v[26:27], v[58:59]
v_pk_add_f32 v[28:29], v[28:29], v[60:61]
v_pk_add_f32 v[30:31], v[30:31], v[62:63]
v_pk_add_f32 v[32:33], v[32:33], v[64:65]
v_pk_add_f32 v[34:35], v[34:35], v[66:67]
v_pk_add_f32 v[36:37], v[36:37], v[68:69]
v_pk_add_f32 v[38:39], v[38:39], v[70:71]
v_pk_add_f32 v[40:41], v[40:41], v[72:73]
v_pk_add_f32 v[42:43], v[42:43], v[74:75]
v_pk_add_f32 v[44:45], v[44:45], v[76:77]
v_pk_add_f32 v[46:47], v[46:47], v[78:79]
v_cvt_pk_bf16_f32 v240, v16, v17
v_cvt_pk_bf16_f32 v241, v18, v19
v_cvt_pk_bf16_f32 v242, v20, v21
v_cvt_pk_bf16_f32 v243, v22, v23
v_cvt_pk_bf16_f32 v244, v24, v25
v_cvt_pk_bf16_f32 v245, v26, v27
v_cvt_pk_bf16_f32 v246, v28, v29
v_cvt_pk_bf16_f32 v247, v30, v31
v_cvt_pk_bf16_f32 v248, v32, v33
v_cvt_pk_bf16_f32 v249, v34, v35
v_cvt_pk_bf16_f32 v250, v36, v37
v_cvt_pk_bf16_f32 v251, v38, v39
v_cvt_pk_bf16_f32 v252, v40, v41
v_cvt_pk_bf16_f32 v253, v42, v43
v_cvt_pk_bf16_f32 v254, v44, v45
v_cvt_pk_bf16_f32 v255, v46, v47
v_max_u32 v16, 1, v16
v_max_u32 v17, 1, v17
v_max_u32 v18, 1, v18
v_max_u32 v19, 1, v19
v_max_u32 v20, 1, v20
v_max_u32 v21, 1, v21
v_max_u32 v22, 1, v22
v_max_u32 v23, 1, v23
v_max_u32 v24, 1, v24
v_max_u32 v25, 1, v25
v_max_u32 v26, 1, v26
v_max_u32 v27, 1, v27
v_max_u32 v28, 1, v28
v_max_u32 v29, 1, v29
v_max_u32 v30, 1, v30
v_max_u32 v31, 1, v31
v_max_u32 v32, 1, v32
v_max_u32 v33, 1, v33
v_max_u32 v34, 1, v34
v_max_u32 v35, 1, v35
v_max_u32 v36, 1, v36
v_max_u32 v37, 1, v37
v_max_u32 v38, 1, v38
v_max_u32 v39, 1, v39
v_max_u32 v40, 1, v40
v_max_u32 v41, 1, v41
v_max_u32 v42, 1, v42
v_max_u32 v43, 1, v43
v_max_u32 v44, 1, v44
v_max_u32 v45, 1, v45
v_max_u32 v46, 1, v46
v_max_u32 v47, 1, v47
s_mov_b64 exec, s[76:77]
buffer_store_dwordx4 v[16:19], v15, s[24:27], s69 offen offset:0 sc1
buffer_store_dwordx4 v[20:23], v15, s[24:27], s69 offen offset:64 sc1
buffer_store_dwordx4 v[24:27], v15, s[24:27], s69 offen offset:128 sc1
buffer_store_dwordx4 v[28:31], v15, s[24:27], s69 offen offset:192 sc1
s_mov_b64 exec, s[78:79]
buffer_store_dwordx4 v[32:35], v15, s[24:27], s69 offen offset:0 sc1
buffer_store_dwordx4 v[36:39], v15, s[24:27], s69 offen offset:64 sc1
buffer_store_dwordx4 v[40:43], v15, s[24:27], s69 offen offset:128 sc1
buffer_store_dwordx4 v[44:47], v15, s[24:27], s69 offen offset:192 sc1
s_mov_b64 exec, -1
s_cmp_eq_u32 s63, 0
s_cbranch_scc0 mout_119
v_mul_f32 v11, v10, v10
v_mov_b32 v12, 0x3727c5ac
v_fma_f32 v11, v11, v9, v12
v_rsq_f32 v11, v11
v_lshrrev_b32 v12, 3, v0
v_lshlrev_b32 v12, 6, v12
v_lshl_add_u32 v12, v0, 3, v12
v_mul_f32 v10, v10, v11
v_mul_f32 v11, v8, v10
s_lshl_b32 s66, s73, 9
s_add_u32 s66, s66, 2621440
v_max_u32 v11, 1, v11
s_cmp_eq_u32 s62, 8
s_cselect_b32 exec_lo, -1, 0
s_mov_b32 exec_hi, 0
buffer_store_dwordx2 v[10:11], v12, s[24:27], s66 offen sc1
s_mov_b64 exec, -1
s_mov_b32 s63, 1
s_mov_b32 s34, 32
s_add_u32 s24, s24, 2359296
s_addc_u32 s25, s25, 0
s_mov_b32 s26, 2359296
s_branch L_mtop
mout_119:
v_permlane16_swap_b32 v240, v242
v_permlane16_swap_b32 v241, v243
v_permlane16_swap_b32 v244, v246
v_permlane16_swap_b32 v245, v247
v_permlane16_swap_b32 v248, v250
v_permlane16_swap_b32 v249, v251
v_permlane16_swap_b32 v252, v254
v_permlane16_swap_b32 v253, v255
s_not_b64 exec, s[76:77]
buffer_store_dwordx4 v[240:243], v14, s[28:31], s70 offen offset:0
buffer_store_dwordx4 v[244:247], v14, s[28:31], s70 offen offset:64
s_not_b64 exec, s[78:79]
buffer_store_dwordx4 v[248:251], v14, s[28:31], s71 offen offset:0
buffer_store_dwordx4 v[252:255], v14, s[28:31], s71 offen offset:64
s_mov_b64 exec, -1
v_mov_b32 v11, 0
s_add_u32 s35, s34, 3
lw_120:
ds_read_b32 v5, v2 offset:24
s_waitcnt lgkmcnt(0)
v_cmp_gt_i32 vcc, s35, v5
s_cbranch_vccz lwd_121
s_sleep 2
s_sub_u32 s32, s32, 1
s_cmp_gt_i32 s32, 0
s_cbranch_scc1 lw_120
lwd_121:
ds_read_b32 v11, v11 offset:32
s_waitcnt lgkmcnt(0)
v_cmp_eq_u32 vcc, s75, v11
s_cbranch_vccnz L_end
s_mov_b64 exec, s[76:77]
buffer_store_dwordx4 v[240:243], v14, s[28:31], s70 offen offset:0
buffer_store_dwordx4 v[244:247], v14, s[28:31], s70 offen offset:64
s_mov_b64 exec, s[78:79]
buffer_store_dwordx4 v[248:251], v14, s[28:31], s71 offen offset:0
buffer_store_dwordx4 v[252:255], v14, s[28:31], s71 offen offset:64
s_mov_b64 exec, -1
s_branch L_end
mspin_91:
s_cmp_eq_u32 s66, 1
s_cbranch_scc1 mback_92
msp_122:
ds_read_b32 v5, v2 offset:16
s_waitcnt lgkmcnt(0)
v_cmp_ge_u32 vcc, v4, v5
s_cbranch_vccz mback_92
s_sub_u32 s32, s32, 1
s_cmp_gt_i32 s32, 0
s_cbranch_scc1 msp_122
s_branch mback_92
patch_95:
s_bfe_u32 s66, s33, 0x20005
s_lshr_b32 s67, s66, 1
s_xor_b32 s66, s66, s67
s_and_b32 s66, s66, 1
s_cmp_eq_u32 s66, s65
s_cbranch_scc0 pback_96
s_lshl_b32 s67, s67, 5
s_and_b32 s66, s33, 31
s_add_u32 s66, s66, s67
v_and_b32 v10, 15, v0
v_sub_u32 v10, s66, v10
v_lshrrev_b32 v11, 4, v0
v_lshlrev_b32 v11, 2, v11
v_sub_u32 v11, s66, v11
v_cmp_eq_u32 vcc, 0, v10
s_mov_b64 exec, vcc
ds_read_b128 v[16:19], v9 offset:3456
ds_read_b128 v[20:23], v9 offset:3520
ds_read_b128 v[80:83], v9 offset:3328
ds_read_b128 v[84:87], v9 offset:3392
s_mov_b64 exec, -1
v_cmp_eq_u32 vcc, 0, v11
s_mov_b64 exec, vcc
ds_read_b32 v48, v8 offset:3584
ds_read_b32 v52, v8 offset:3648
s_mov_b64 exec, -1
v_cmp_eq_u32 vcc, 1, v11
s_mov_b64 exec, vcc
ds_read_b32 v49, v8 offset:3584
ds_read_b32 v53, v8 offset:3648
s_mov_b64 exec, -1
v_cmp_eq_u32 vcc, 2, v11
s_mov_b64 exec, vcc
ds_read_b32 v50, v8 offset:3584
ds_read_b32 v54, v8 offset:3648
s_mov_b64 exec, -1
v_cmp_eq_u32 vcc, 3, v11
s_mov_b64 exec, vcc
ds_read_b32 v51, v8 offset:3584
ds_read_b32 v55, v8 offset:3648
s_mov_b64 exec, -1
s_waitcnt lgkmcnt(0)
v_cmp_eq_u32 vcc, 16, v10
s_mov_b64 exec, vcc
ds_read_b128 v[24:27], v9 offset:3456
ds_read_b128 v[28:31], v9 offset:3520
ds_read_b128 v[88:91], v9 offset:3328
ds_read_b128 v[92:95], v9 offset:3392
s_mov_b64 exec, -1
v_cmp_eq_u32 vcc, 16, v11
s_mov_b64 exec, vcc
ds_read_b32 v56, v8 offset:3584
ds_read_b32 v60, v8 offset:3648
s_mov_b64 exec, -1
v_cmp_eq_u32 vcc, 17, v11
s_mov_b64 exec, vcc
ds_read_b32 v57, v8 offset:3584
ds_read_b32 v61, v8 offset:3648
s_mov_b64 exec, -1
v_cmp_eq_u32 vcc, 18, v11
s_mov_b64 exec, vcc
ds_read_b32 v58, v8 offset:3584
ds_read_b32 v62, v8 offset:3648
s_mov_b64 exec, -1
v_cmp_eq_u32 vcc, 19, v11
s_mov_b64 exec, vcc
ds_read_b32 v59, v8 offset:3584
ds_read_b32 v63, v8 offset:3648
s_mov_b64 exec, -1
s_waitcnt lgkmcnt(0)
v_cmp_eq_u32 vcc, 32, v10
s_mov_b64 exec, vcc
ds_read_b128 v[32:35], v9 offset:3456
ds_read_b128 v[36:39], v9 offset:3520
ds_read_b128 v[96:99], v9 offset:3328
ds_read_b128 v[100:103], v9 offset:3392
s_mov_b64 exec, -1
v_cmp_eq_u32 vcc, 32, v11
s_mov_b64 exec, vcc
ds_read_b32 v64, v8 offset:3584
ds_read_b32 v68, v8 offset:3648
s_mov_b64 exec, -1
v_cmp_eq_u32 vcc, 33, v11
s_mov_b64 exec, vcc
ds_read_b32 v65, v8 offset:3584
ds_read_b32 v69, v8 offset:3648
s_mov_b64 exec, -1
v_cmp_eq_u32 vcc, 34, v11
s_mov_b64 exec, vcc
ds_read_b32 v66, v8 offset:3584
ds_read_b32 v70, v8 offset:3648
s_mov_b64 exec, -1
v_cmp_eq_u32 vcc, 35, v11
s_mov_b64 exec, vcc
ds_read_b32 v67, v8 offset:3584
ds_read_b32 v71, v8 offset:3648
s_mov_b64 exec, -1
s_waitcnt lgkmcnt(0)
v_cmp_eq_u32 vcc, 48, v10
s_mov_b64 exec, vcc
ds_read_b128 v[40:43], v9 offset:3456
ds_read_b128 v[44:47], v9 offset:3520
ds_read_b128 v[104:107], v9 offset:3328
ds_read_b128 v[108:111], v9 offset:3392
s_mov_b64 exec, -1
v_cmp_eq_u32 vcc, 48, v11
s_mov_b64 exec, vcc
ds_read_b32 v72, v8 offset:3584
ds_read_b32 v76, v8 offset:3648
s_mov_b64 exec, -1
v_cmp_eq_u32 vcc, 49, v11
s_mov_b64 exec, vcc
ds_read_b32 v73, v8 offset:3584
ds_read_b32 v77, v8 offset:3648
s_mov_b64 exec, -1
v_cmp_eq_u32 vcc, 50, v11
s_mov_b64 exec, vcc
ds_read_b32 v74, v8 offset:3584
ds_read_b32 v78, v8 offset:3648
s_mov_b64 exec, -1
v_cmp_eq_u32 vcc, 51, v11
s_mov_b64 exec, vcc
ds_read_b32 v75, v8 offset:3584
ds_read_b32 v79, v8 offset:3648
s_mov_b64 exec, -1
s_waitcnt lgkmcnt(0)
s_branch pback_96
cross_106:
s_cmp_eq_u32 s67, 122880
s_cbranch_scc0 cr2_123
v_add_u32 v5, s34, 18
s_mov_b64 exec, 1
ds_write_b32 v3, v5
s_mov_b64 exec, -1
s_add_u32 s70, s72, 294912
s_mov_b64 exec, 1
s_waitcnt vmcnt(0)
buffer_store_dword v5, v3, s[24:27], s70 offen sc1
s_mov_b64 exec, -1
v_mov_b32 v9, 0xf149f2ca
v_xor_b32 v216, v9, v216
v_xor_b32 v217, v9, v217
v_xor_b32 v218, v9, v218
v_xor_b32 v219, v9, v219
v_xor_b32 v220, v9, v220
v_xor_b32 v221, v9, v221
v_xor_b32 v222, v9, v222
v_xor_b32 v223, v9, v223
v_xor_b32 v224, v9, v224
v_xor_b32 v225, v9, v225
v_xor_b32 v226, v9, v226
v_xor_b32 v227, v9, v227
v_xor_b32 v228, v9, v228
v_xor_b32 v229, v9, v229
v_xor_b32 v230, v9, v230
v_xor_b32 v231, v9, v231
s_mov_b32 s67, 90112
s_cmp_eq_u32 s63, 0
s_cbranch_scc0 cr3_124
v_and_b32 v9, 15, v0
v_lshlrev_b32 v9, 11, v9
v_bfe_u32 v10, v0, 4, 1
v_lshl_add_u32 v9, v10, 5, v9
v_lshrrev_b32 v10, 5, v0
v_lshl_add_u32 v9, v10, 4, v9
s_lshl2_add_u32 s70, s61, s58
s_lshl_b32 s70, s70, 16
s_lshl_b32 s71, s62, 7
s_add_u32 s70, s70, s71
s_add_u32 s71, s70, 0x8000
buffer_load_dwordx4 v[240:243], v9, s[8:11], s70 offen offset:0
buffer_load_dwordx4 v[244:247], v9, s[8:11], s70 offen offset:64
buffer_load_dwordx4 v[248:251], v9, s[8:11], s71 offen offset:0
buffer_load_dwordx4 v[252:255], v9, s[8:11], s71 offen offset:64
cr3_124:
s_cmp_eq_u32 s59, 0
s_cbranch_scc1 cback_107
v_mov_b32 v9, 0
s_add_u32 s35, s34, 17
lw_125:
ds_read_b32 v5, v9 offset:16
s_waitcnt lgkmcnt(0)
v_cmp_gt_i32 vcc, s35, v5
s_cbranch_vccz lwd_126
s_sub_u32 s32, s32, 1
s_cmp_gt_i32 s32, 0
s_cbranch_scc1 lw_125
lwd_126:
s_branch cback_107
cr2_123:
v_add_u32 v5, s34, 19
s_mov_b64 exec, 1
ds_write_b32 v3, v5
s_mov_b64 exec, -1
s_mov_b32 s66, 28672
s_cmp_lt_u32 s59, 2
s_cbranch_scc1 cback_107
s_add_u32 s35, s34, 17
lw_127:
ds_read_b32 v5, v2 offset:16
s_waitcnt lgkmcnt(0)
v_cmp_gt_i32 vcc, s35, v5
s_cbranch_vccz lwd_128
s_sub_u32 s32, s32, 1
s_cmp_gt_i32 s32, 0
s_cbranch_scc1 lw_127
lwd_128:
s_branch cback_107
cross_108:
s_cmp_eq_u32 s67, 122880
s_cbranch_scc0 cr2_129
v_add_u32 v5, s34, 18
s_mov_b64 exec, 1
ds_write_b32 v3, v5
s_mov_b64 exec, -1
s_add_u32 s70, s72, 294912
s_mov_b64 exec, 1
s_waitcnt vmcnt(0)
buffer_store_dword v5, v3, s[24:27], s70 offen sc1
s_mov_b64 exec, -1
v_mov_b32 v9, 0xf149f2ca
v_xor_b32 v216, v9, v216
v_xor_b32 v217, v9, v217
v_xor_b32 v218, v9, v218
v_xor_b32 v219, v9, v219
v_xor_b32 v220, v9, v220
v_xor_b32 v221, v9, v221
v_xor_b32 v222, v9, v222
v_xor_b32 v223, v9, v223
v_xor_b32 v224, v9, v224
v_xor_b32 v225, v9, v225
v_xor_b32 v226, v9, v226
v_xor_b32 v227, v9, v227
v_xor_b32 v228, v9, v228
v_xor_b32 v229, v9, v229
v_xor_b32 v230, v9, v230
v_xor_b32 v231, v9, v231
s_mov_b32 s67, 90112
s_cmp_eq_u32 s63, 0
s_cbranch_scc0 cr3_130
v_and_b32 v9, 15, v0
v_lshlrev_b32 v9, 11, v9
v_bfe_u32 v10, v0, 4, 1
v_lshl_add_u32 v9, v10, 5, v9
v_lshrrev_b32 v10, 5, v0
v_lshl_add_u32 v9, v10, 4, v9
s_lshl2_add_u32 s70, s61, s58
s_lshl_b32 s70, s70, 16
s_lshl_b32 s71, s62, 7
s_add_u32 s70, s70, s71
s_add_u32 s71, s70, 0x8000
buffer_load_dwordx4 v[240:243], v9, s[8:11], s70 offen offset:0
buffer_load_dwordx4 v[244:247], v9, s[8:11], s70 offen offset:64
buffer_load_dwordx4 v[248:251], v9, s[8:11], s71 offen offset:0
buffer_load_dwordx4 v[252:255], v9, s[8:11], s71 offen offset:64
cr3_130:
s_cmp_eq_u32 s59, 0
s_cbranch_scc1 cback_109
v_mov_b32 v9, 0
s_add_u32 s35, s34, 17
lw_131:
ds_read_b32 v5, v9 offset:16
s_waitcnt lgkmcnt(0)
v_cmp_gt_i32 vcc, s35, v5
s_cbranch_vccz lwd_132
s_sub_u32 s32, s32, 1
s_cmp_gt_i32 s32, 0
s_cbranch_scc1 lw_131
lwd_132:
s_branch cback_109
cr2_129:
v_add_u32 v5, s34, 19
s_mov_b64 exec, 1
ds_write_b32 v3, v5
s_mov_b64 exec, -1
s_mov_b32 s66, 28672
s_cmp_lt_u32 s59, 2
s_cbranch_scc1 cback_109
s_add_u32 s35, s34, 17
lw_133:
ds_read_b32 v5, v2 offset:16
s_waitcnt lgkmcnt(0)
v_cmp_gt_i32 vcc, s35, v5
s_cbranch_vccz lwd_134
s_sub_u32 s32, s32, 1
s_cmp_gt_i32 s32, 0
s_cbranch_scc1 lw_133
lwd_134:
s_branch cback_109
slow_110:
s_add_u32 s70, s72, 294912
poll_135:
buffer_load_dword v10, v1, s[24:27], s70 offen sc1
pchk_136:
s_waitcnt vmcnt(0)
v_cmp_eq_u32 vcc, 0, v10
s_cbranch_vccz pdone_137
s_sub_u32 s32, s32, 1
s_cmp_gt_i32 s32, 0
s_cbranch_scc1 poll_135
pdone_137:
s_lshl_b32 s73, s60, 15
s_lshl_b32 s74, s63, 23
s_add_u32 s73, s73, s74
s_add_u32 s73, s73, 1048576
v_mov_b32 v10, 0xf149f2ca
v_mov_b32 v11, 0
v_mov_b32 v192, 0
v_mov_b32 v193, 0
v_mov_b32 v194, 0
v_mov_b32 v195, 0
v_mov_b32 v196, 0
v_mov_b32 v197, 0
v_mov_b32 v198, 0
v_mov_b32 v199, 0
v_mov_b32 v200, 0
v_mov_b32 v201, 0
v_mov_b32 v202, 0
v_mov_b32 v203, 0
v_mov_b32 v204, 0
v_mov_b32 v205, 0
v_mov_b32 v206, 0
v_mov_b32 v207, 0
v_mov_b32 v208, 0
v_mov_b32 v209, 0
v_mov_b32 v210, 0
v_mov_b32 v211, 0
s_lshl2_add_u32 s74, s59, s65
s_mov_b32 s75, 0
sl_138:
s_lshr_b32 s76, s74, 2
s_lshl_b32 s76, s76, 19
s_and_b32 s77, s74, 3
s_lshl_b32 s77, s77, 13
s_add_u32 s76, s76, s77
s_add_u32 s76, s76, s73
buffer_load_dwordx4 v[152:155], v6, s[20:23], s76 offen offset:0 sc1
buffer_load_dwordx4 v[156:159], v6, s[20:23], s76 offen offset:1024 sc1
s_cmp_eq_u32 s75, 0
s_cselect_b32 s76, 0xf149f2ca, 0
s_and_b32 s77, s75, 7
s_cselect_b32 s77, 0, -1
v_xor_b32 v112, s76, v216
v_and_b32 v112, s77, v112
v_xor_b32 v113, s76, v217
v_and_b32 v113, s77, v113
v_xor_b32 v114, s76, v218
v_and_b32 v114, s77, v114
v_xor_b32 v115, s76, v219
v_and_b32 v115, s77, v115
v_xor_b32 v116, s76, v220
v_and_b32 v116, s77, v116
v_xor_b32 v117, s76, v221
v_and_b32 v117, s77, v117
v_xor_b32 v118, s76, v222
v_and_b32 v118, s77, v118
v_xor_b32 v119, s76, v223
v_and_b32 v119, s77, v119
v_xor_b32 v120, s76, v224
v_and_b32 v120, s77, v120
v_xor_b32 v121, s76, v225
v_and_b32 v121, s77, v121
v_xor_b32 v122, s76, v226
v_and_b32 v122, s77, v122
v_xor_b32 v123, s76, v227
v_and_b32 v123, s77, v123
v_xor_b32 v124, s76, v228
v_and_b32 v124, s77, v124
v_xor_b32 v125, s76, v229
v_and_b32 v125, s77, v125
v_xor_b32 v126, s76, v230
v_and_b32 v126, s77, v126
v_xor_b32 v127, s76, v231
v_and_b32 v127, s77, v127
s_waitcnt vmcnt(1)
s_nop 0
v_mfma_f32_32x32x16_bf16 v[112:127], v[152:155], v[80:83], v[112:127]
s_waitcnt vmcnt(0)
v_mfma_f32_32x32x16_bf16 v[112:127], v[156:159], v[88:91], v[112:127]
s_nop 11
v_max3_f32 v10, v10, v112, v113
v_max3_f32 v10, v10, v114, v115
v_max3_f32 v10, v10, v116, v117
v_max3_f32 v10, v10, v118, v119
v_max3_f32 v10, v10, v120, v121
v_max3_f32 v10, v10, v122, v123
v_max3_f32 v10, v10, v124, v125
v_max3_f32 v10, v10, v126, v127
s_add_u32 s75, s75, 1
s_sub_u32 s74, s74, 1
s_cselect_b32 s75, 9, s75
s_cmp_lt_u32 s75, 9
s_cbranch_scc1 sl_138
v_mov_b32 v11, v10
s_nop 1
v_permlane32_swap_b32 v11, v10
v_max_f32 v10, v10, v11
s_lshl2_add_u32 s74, s59, s65
s_mov_b32 s75, 0
sl_139:
s_lshr_b32 s76, s74, 2
s_lshl_b32 s76, s76, 19
s_and_b32 s77, s74, 3
s_lshl_b32 s77, s77, 13
s_add_u32 s76, s76, s77
s_add_u32 s76, s76, s73
buffer_load_dwordx4 v[152:155], v6, s[20:23], s76 offen offset:0 sc1
buffer_load_dwordx4 v[156:159], v6, s[20:23], s76 offen offset:1024 sc1
buffer_load_dwordx4 v[160:163], v6, s[20:23], s76 offen offset:2048 sc1
buffer_load_dwordx4 v[164:167], v6, s[20:23], s76 offen offset:3072 sc1
s_cmp_eq_u32 s75, 0
s_cselect_b32 s76, 0xf149f2ca, 0
s_and_b32 s77, s75, 7
s_cselect_b32 s77, 0, -1
v_xor_b32 v112, s76, v216
v_and_b32 v112, s77, v112
v_sub_f32 v112, v112, v10
v_xor_b32 v113, s76, v217
v_and_b32 v113, s77, v113
v_sub_f32 v113, v113, v10
v_xor_b32 v114, s76, v218
v_and_b32 v114, s77, v114
v_sub_f32 v114, v114, v10
v_xor_b32 v115, s76, v219
v_and_b32 v115, s77, v115
v_sub_f32 v115, v115, v10
v_xor_b32 v116, s76, v220
v_and_b32 v116, s77, v116
v_sub_f32 v116, v116, v10
v_xor_b32 v117, s76, v221
v_and_b32 v117, s77, v117
v_sub_f32 v117, v117, v10
v_xor_b32 v118, s76, v222
v_and_b32 v118, s77, v118
v_sub_f32 v118, v118, v10
v_xor_b32 v119, s76, v223
v_and_b32 v119, s77, v119
v_sub_f32 v119, v119, v10
v_xor_b32 v120, s76, v224
v_and_b32 v120, s77, v120
v_sub_f32 v120, v120, v10
v_xor_b32 v121, s76, v225
v_and_b32 v121, s77, v121
v_sub_f32 v121, v121, v10
v_xor_b32 v122, s76, v226
v_and_b32 v122, s77, v122
v_sub_f32 v122, v122, v10
v_xor_b32 v123, s76, v227
v_and_b32 v123, s77, v123
v_sub_f32 v123, v123, v10
v_xor_b32 v124, s76, v228
v_and_b32 v124, s77, v124
v_sub_f32 v124, v124, v10
v_xor_b32 v125, s76, v229
v_and_b32 v125, s77, v125
v_sub_f32 v125, v125, v10
v_xor_b32 v126, s76, v230
v_and_b32 v126, s77, v126
v_sub_f32 v126, v126, v10
v_xor_b32 v127, s76, v231
v_and_b32 v127, s77, v127
v_sub_f32 v127, v127, v10
s_waitcnt vmcnt(3)
s_nop 0
v_mfma_f32_32x32x16_bf16 v[112:127], v[152:155], v[80:83], v[112:127]
s_waitcnt vmcnt(2)
v_mfma_f32_32x32x16_bf16 v[112:127], v[156:159], v[88:91], v[112:127]
s_nop 11
v_exp_f32 v112, v112
v_exp_f32 v113, v113
v_exp_f32 v114, v114
v_exp_f32 v115, v115
v_exp_f32 v116, v116
v_exp_f32 v117, v117
v_exp_f32 v118, v118
v_exp_f32 v119, v119
v_exp_f32 v120, v120
v_exp_f32 v121, v121
v_exp_f32 v122, v122
v_exp_f32 v123, v123
v_exp_f32 v124, v124
v_exp_f32 v125, v125
v_exp_f32 v126, v126
v_exp_f32 v127, v127
v_cvt_pk_bf16_f32 v144, v112, v113
v_cvt_pk_bf16_f32 v145, v114, v115
v_cvt_pk_bf16_f32 v146, v116, v117
v_cvt_pk_bf16_f32 v147, v118, v119
v_cvt_pk_bf16_f32 v148, v120, v121
v_cvt_pk_bf16_f32 v149, v122, v123
v_cvt_pk_bf16_f32 v150, v124, v125
v_cvt_pk_bf16_f32 v151, v126, v127
s_waitcnt vmcnt(1)
v_mfma_f32_32x32x16_bf16 v[192:207], v[160:163], v[144:147], v[192:207]
v_mfma_f32_16x16x32_bf16 v[208:211], v[212:215], v[144:147], v[208:211]
s_waitcnt vmcnt(0)
v_mfma_f32_32x32x16_bf16 v[192:207], v[164:167], v[148:151], v[192:207]
v_mfma_f32_16x16x32_bf16 v[208:211], v[212:215], v[148:151], v[208:211]
s_add_u32 s75, s75, 1
s_sub_u32 s74, s74, 1
s_cselect_b32 s75, 9, s75
s_cmp_lt_u32 s75, 9
s_cbranch_scc1 sl_139
v_mov_b32 v10, 0xf149f2ca
v_mov_b32 v11, 0
v_mov_b32 v16, 0
v_mov_b32 v17, 0
v_mov_b32 v18, 0
v_mov_b32 v19, 0
v_mov_b32 v20, 0
v_mov_b32 v21, 0
v_mov_b32 v22, 0
v_mov_b32 v23, 0
v_mov_b32 v24, 0
v_mov_b32 v25, 0
v_mov_b32 v26, 0
v_mov_b32 v27, 0
v_mov_b32 v28, 0
v_mov_b32 v29, 0
v_mov_b32 v30, 0
v_mov_b32 v31, 0
v_mov_b32 v32, 0
v_mov_b32 v33, 0
v_mov_b32 v34, 0
v_mov_b32 v35, 0
s_sub_u32 s74, 3, s65
s_lshl2_add_u32 s74, s59, s74
s_mov_b32 s75, 0
sl_140:
s_lshr_b32 s76, s74, 2
s_lshl_b32 s76, s76, 19
s_and_b32 s77, s74, 3
s_lshl_b32 s77, s77, 13
s_add_u32 s76, s76, s77
s_add_u32 s76, s76, s73
buffer_load_dwordx4 v[152:155], v6, s[20:23], s76 offen offset:0 sc1
buffer_load_dwordx4 v[156:159], v6, s[20:23], s76 offen offset:1024 sc1
s_cmp_eq_u32 s75, 0
s_cselect_b32 s76, 0xf149f2ca, 0
s_and_b32 s77, s75, 7
s_cselect_b32 s77, 0, -1
v_xor_b32 v112, s76, v216
v_and_b32 v112, s77, v112
v_xor_b32 v113, s76, v217
v_and_b32 v113, s77, v113
v_xor_b32 v114, s76, v218
v_and_b32 v114, s77, v114
v_xor_b32 v115, s76, v219
v_and_b32 v115, s77, v115
v_xor_b32 v116, s76, v220
v_and_b32 v116, s77, v116
v_xor_b32 v117, s76, v221
v_and_b32 v117, s77, v117
v_xor_b32 v118, s76, v222
v_and_b32 v118, s77, v118
v_xor_b32 v119, s76, v223
v_and_b32 v119, s77, v119
v_xor_b32 v120, s76, v224
v_and_b32 v120, s77, v120
v_xor_b32 v121, s76, v225
v_and_b32 v121, s77, v121
v_xor_b32 v122, s76, v226
v_and_b32 v122, s77, v122
v_xor_b32 v123, s76, v227
v_and_b32 v123, s77, v123
v_xor_b32 v124, s76, v228
v_and_b32 v124, s77, v124
v_xor_b32 v125, s76, v229
v_and_b32 v125, s77, v125
v_xor_b32 v126, s76, v230
v_and_b32 v126, s77, v126
v_xor_b32 v127, s76, v231
v_and_b32 v127, s77, v127
s_waitcnt vmcnt(1)
s_nop 0
v_mfma_f32_32x32x16_bf16 v[112:127], v[152:155], v[96:99], v[112:127]
s_waitcnt vmcnt(0)
v_mfma_f32_32x32x16_bf16 v[112:127], v[156:159], v[104:107], v[112:127]
s_nop 11
v_max3_f32 v10, v10, v112, v113
v_max3_f32 v10, v10, v114, v115
v_max3_f32 v10, v10, v116, v117
v_max3_f32 v10, v10, v118, v119
v_max3_f32 v10, v10, v120, v121
v_max3_f32 v10, v10, v122, v123
v_max3_f32 v10, v10, v124, v125
v_max3_f32 v10, v10, v126, v127
s_add_u32 s75, s75, 1
s_sub_u32 s74, s74, 1
s_cselect_b32 s75, 9, s75
s_cmp_lt_u32 s75, 9
s_cbranch_scc1 sl_140
v_mov_b32 v11, v10
s_nop 1
v_permlane32_swap_b32 v11, v10
v_max_f32 v10, v10, v11
s_sub_u32 s74, 3, s65
s_lshl2_add_u32 s74, s59, s74
s_mov_b32 s75, 0
sl_141:
s_lshr_b32 s76, s74, 2
s_lshl_b32 s76, s76, 19
s_and_b32 s77, s74, 3
s_lshl_b32 s77, s77, 13
s_add_u32 s76, s76, s77
s_add_u32 s76, s76, s73
buffer_load_dwordx4 v[152:155], v6, s[20:23], s76 offen offset:0 sc1
buffer_load_dwordx4 v[156:159], v6, s[20:23], s76 offen offset:1024 sc1
buffer_load_dwordx4 v[160:163], v6, s[20:23], s76 offen offset:2048 sc1
buffer_load_dwordx4 v[164:167], v6, s[20:23], s76 offen offset:3072 sc1
s_cmp_eq_u32 s75, 0
s_cselect_b32 s76, 0xf149f2ca, 0
s_and_b32 s77, s75, 7
s_cselect_b32 s77, 0, -1
v_xor_b32 v112, s76, v216
v_and_b32 v112, s77, v112
v_sub_f32 v112, v112, v10
v_xor_b32 v113, s76, v217
v_and_b32 v113, s77, v113
v_sub_f32 v113, v113, v10
v_xor_b32 v114, s76, v218
v_and_b32 v114, s77, v114
v_sub_f32 v114, v114, v10
v_xor_b32 v115, s76, v219
v_and_b32 v115, s77, v115
v_sub_f32 v115, v115, v10
v_xor_b32 v116, s76, v220
v_and_b32 v116, s77, v116
v_sub_f32 v116, v116, v10
v_xor_b32 v117, s76, v221
v_and_b32 v117, s77, v117
v_sub_f32 v117, v117, v10
v_xor_b32 v118, s76, v222
v_and_b32 v118, s77, v118
v_sub_f32 v118, v118, v10
v_xor_b32 v119, s76, v223
v_and_b32 v119, s77, v119
v_sub_f32 v119, v119, v10
v_xor_b32 v120, s76, v224
v_and_b32 v120, s77, v120
v_sub_f32 v120, v120, v10
v_xor_b32 v121, s76, v225
v_and_b32 v121, s77, v121
v_sub_f32 v121, v121, v10
v_xor_b32 v122, s76, v226
v_and_b32 v122, s77, v122
v_sub_f32 v122, v122, v10
v_xor_b32 v123, s76, v227
v_and_b32 v123, s77, v123
v_sub_f32 v123, v123, v10
v_xor_b32 v124, s76, v228
v_and_b32 v124, s77, v124
v_sub_f32 v124, v124, v10
v_xor_b32 v125, s76, v229
v_and_b32 v125, s77, v125
v_sub_f32 v125, v125, v10
v_xor_b32 v126, s76, v230
v_and_b32 v126, s77, v126
v_sub_f32 v126, v126, v10
v_xor_b32 v127, s76, v231
v_and_b32 v127, s77, v127
v_sub_f32 v127, v127, v10
s_waitcnt vmcnt(3)
s_nop 0
v_mfma_f32_32x32x16_bf16 v[112:127], v[152:155], v[96:99], v[112:127]
s_waitcnt vmcnt(2)
v_mfma_f32_32x32x16_bf16 v[112:127], v[156:159], v[104:107], v[112:127]
s_nop 11
v_exp_f32 v112, v112
v_exp_f32 v113, v113
v_exp_f32 v114, v114
v_exp_f32 v115, v115
v_exp_f32 v116, v116
v_exp_f32 v117, v117
v_exp_f32 v118, v118
v_exp_f32 v119, v119
v_exp_f32 v120, v120
v_exp_f32 v121, v121
v_exp_f32 v122, v122
v_exp_f32 v123, v123
v_exp_f32 v124, v124
v_exp_f32 v125, v125
v_exp_f32 v126, v126
v_exp_f32 v127, v127
v_cvt_pk_bf16_f32 v144, v112, v113
v_cvt_pk_bf16_f32 v145, v114, v115
v_cvt_pk_bf16_f32 v146, v116, v117
v_cvt_pk_bf16_f32 v147, v118, v119
v_cvt_pk_bf16_f32 v148, v120, v121
v_cvt_pk_bf16_f32 v149, v122, v123
v_cvt_pk_bf16_f32 v150, v124, v125
v_cvt_pk_bf16_f32 v151, v126, v127
s_waitcnt vmcnt(1)
v_mfma_f32_32x32x16_bf16 v[16:31], v[160:163], v[144:147], v[16:31]
v_mfma_f32_16x16x32_bf16 v[32:35], v[212:215], v[144:147], v[32:35]
s_waitcnt vmcnt(0)
v_mfma_f32_32x32x16_bf16 v[16:31], v[164:167], v[148:151], v[16:31]
v_mfma_f32_16x16x32_bf16 v[32:35], v[212:215], v[148:151], v[32:35]
s_add_u32 s75, s75, 1
s_sub_u32 s74, s74, 1
s_cselect_b32 s75, 9, s75
s_cmp_lt_u32 s75, 9
s_cbranch_scc1 sl_141
s_branch sback_111
mo_112:
s_lshr_b32 s67, s33, 5
s_cmp_eq_u32 s67, s66
s_cbranch_scc0 mo_113
s_and_b32 s67, s33, 31
v_sub_u32 v48, s67, v48
v_lshlrev_b32 v49, 7, v49
s_lshl_b32 s67, s62, 11
s_add_u32 s67, s67, 30801920
poll_142:
buffer_load_dwordx2 v[56:57], v49, s[20:23], s67 offen offset:0 sc1
buffer_load_dwordx2 v[58:59], v49, s[20:23], s67 offen offset:512 sc1
buffer_load_dwordx2 v[60:61], v49, s[20:23], s67 offen offset:1024 sc1
buffer_load_dwordx2 v[62:63], v49, s[20:23], s67 offen offset:1536 sc1
pchk_143:
s_waitcnt vmcnt(2)
v_min3_u32 v50, v56, v57, v58
s_waitcnt vmcnt(1)
v_min3_u32 v50, v50, v59, v60
s_waitcnt vmcnt(0)
v_min3_u32 v50, v50, v61, v62
v_min_u32 v50, v50, v63
v_cmp_eq_u32 vcc, 0, v50
s_cbranch_vccz pdone_144
s_sub_u32 s32, s32, 1
s_cmp_gt_i32 s32, 0
s_cbranch_scc1 poll_142
pdone_144:
v_cmp_eq_u32 vcc, 0, v48
s_nop 1
v_cndmask_b32 v240, v240, v56, vcc
v_cndmask_b32 v241, v241, v57, vcc
v_cndmask_b32 v242, v242, v58, vcc
v_cndmask_b32 v243, v243, v59, vcc
v_cndmask_b32 v244, v244, v60, vcc
v_cndmask_b32 v245, v245, v61, vcc
v_cndmask_b32 v246, v246, v62, vcc
v_cndmask_b32 v247, v247, v63, vcc
v_cmp_eq_u32 vcc, 16, v48
s_nop 1
v_cndmask_b32 v248, v248, v56, vcc
v_cndmask_b32 v249, v249, v57, vcc
v_cndmask_b32 v250, v250, v58, vcc
v_cndmask_b32 v251, v251, v59, vcc
v_cndmask_b32 v252, v252, v60, vcc
v_cndmask_b32 v253, v253, v61, vcc
v_cndmask_b32 v254, v254, v62, vcc
v_cndmask_b32 v255, v255, v63, vcc
s_branch mo_113
L_end:
L_fin:
s_endpgm
.section .rodata,"a"
.p2align 6
.amdhsa_kernel interleave_layers__sliding_block__moe_arch_mod__prompt_kernel
  .amdhsa_next_free_vgpr 256
  .amdhsa_next_free_sgpr 102
  .amdhsa_accum_offset 256
  .amdhsa_group_segment_fixed_size 0
  .amdhsa_kernarg_size 88
  .amdhsa_user_sgpr_count 2
  .amdhsa_user_sgpr_kernarg_segment_ptr 1
  .amdhsa_system_sgpr_workgroup_id_x 1
  .amdhsa_float_denorm_mode_32 3
.end_amdhsa_kernel
```

```asm
; @launch grid=(256,1,1) block=(512,1,1) lds=163840
.amdgcn_target "amdgcn-amd-amdhsa--gfx950"
.text
.globl interleave_layers__sliding_block__moe_arch_mod__prompt_kernel
.p2align 8
.type interleave_layers__sliding_block__moe_arch_mod__prompt_kernel,@function
interleave_layers__sliding_block__moe_arch_mod__prompt_kernel:
s_cmp_ge_u32 s2, 256
s_cbranch_scc1 L_fin
s_load_dwordx16 s[36:51], s[0:1], 0
s_load_dwordx4 s[52:55], s[0:1], 64
s_load_dwordx2 s[56:57], s[0:1], 80
v_lshrrev_b32 v1, 6, v0
v_and_b32 v0, 63, v0
s_and_b32 s64, s2, 7
v_readfirstlane_b32 s3, v1
s_lshr_b32 s65, s2, 3
s_and_b32 s66, s65, 7
s_and_b32 s67, s64, 1
s_lshl3_add_u32 s59, s67, s66
s_lshr_b32 s66, s65, 3
s_lshr_b32 s67, s64, 1
s_lshl2_add_u32 s60, s67, s66
s_and_b32 s66, s65, 1
s_lshl1_add_u32 s61, s64, s66
s_lshr_b32 s62, s65, 1
s_mov_b32 s63, 0
s_mov_b32 s34, 0
s_mov_b32 s32, 200000
s_mov_b32 s33, -1
s_cmp_ge_u32 s3, 4
s_cselect_b32 s66, 3, 1
s_and_b32 s58, s3, s66
s_waitcnt lgkmcnt(0)
s_mov_b32 s8, s36
s_mov_b32 s9, s37
s_mov_b32 s10, 0x400000
s_mov_b32 s11, 0x00020000
s_mov_b32 s12, s38
s_mov_b32 s13, s39
s_mov_b32 s14, 0x600000
s_mov_b32 s15, 0x00020000
s_mov_b32 s16, s40
s_mov_b32 s17, s41
s_mov_b32 s18, 0x200000
s_mov_b32 s19, 0x00020000
s_mov_b32 s20, s56
s_mov_b32 s21, s57
s_mov_b32 s22, 0x2300000
s_mov_b32 s23, 0x00020000
s_add_u32 s24, s56, 30408704
s_addc_u32 s25, s57, 0
s_mov_b32 s26, 4718592
s_mov_b32 s27, 0x00020000
s_mov_b32 s28, s52
s_mov_b32 s29, s53
s_mov_b32 s30, 0x400000
s_mov_b32 s31, 0x00020000
s_cmp_ge_u32 s3, 4
s_cbranch_scc1 L_m
s_cmp_ge_u32 s3, 2
s_cbranch_scc1 L_f
s_setprio 1
v_and_b32 v22, 7, v0
v_lshrrev_b32 v23, 4, v0
v_lshrrev_b32 v6, 3, v0
v_xor_b32 v7, v22, v23
v_lshlrev_b32 v7, 4, v7
v_lshl_add_u32 v8, v6, 11, v7
v_xor_b32 v7, 64, v8
v_add_u32 v9, 15360, v7
v_add_u32 v10, 30720, v8
v_add_u32 v11, 46080, v7
s_lshl_b32 s70, s59, 18
s_lshl_b32 s71, s58, 16
s_add_u32 s68, s70, s71
s_sub_u32 s69, s70, s71
s_add_u32 s69, s69, 196608
s_mov_b32 s67, 128
s_lshl_b32 s75, s58, 13
s_mov_b32 s65, 86016
s_lshr_b32 s70, s59, 3
s_lshl1_add_u32 s70, s59, s70
s_lshr_b32 s71, s60, 2
s_lshl2_add_u32 s71, s60, s71
s_add_u32 s70, s70, s71
s_and_b32 s64, s70, 15
s_mul_i32 s70, s64, s67
s_add_u32 m0, s65, s75
s_add_u32 s71, s70, s68
buffer_load_dwordx4 v8, s[8:11], s71 offen offset:0 sc1 lds
buffer_load_dwordx4 v9, s[8:11], s71 offen offset:1024 sc1 lds
buffer_load_dwordx4 v10, s[8:11], s71 offen offset:2048 sc1 lds
buffer_load_dwordx4 v11, s[8:11], s71 offen offset:3072 sc1 lds
s_add_u32 m0, m0, 4096
s_add_u32 s71, s70, s69
buffer_load_dwordx4 v8, s[8:11], s71 offen offset:0 sc1 lds
buffer_load_dwordx4 v9, s[8:11], s71 offen offset:1024 sc1 lds
buffer_load_dwordx4 v10, s[8:11], s71 offen offset:2048 sc1 lds
buffer_load_dwordx4 v11, s[8:11], s71 offen offset:3072 sc1 lds
v_and_b32 v7, 2, v6
v_xor_b32 v7, v7, v22
v_mul_u32_u24 v6, 6144, v6
v_lshl_add_u32 v12, v7, 4, v6
v_xor_b32 v6, 64, v12
v_add_u32 v13, 48128, v6
v_add_u32 v14, 96256, v12
v_add_u32 v15, 144384, v6
s_mul_i32 s76, s58, 12288
s_add_u32 s76, s76, 16384
s_lshl_b32 s70, s60, 7
s_cmp_eq_u32 s58, 0
s_mov_b32 s71, 198656
s_cselect_b32 s72, 0, s71
s_mov_b32 s71, 4096
s_cselect_b32 s73, 196608, s71
s_mov_b32 s71, 200704
s_cselect_b32 s74, 2048, s71
s_add_u32 s72, s72, s70
s_add_u32 s73, s73, s70
s_add_u32 s74, s74, s70
s_mul_i32 s70, s64, 393216
s_add_u32 m0, s65, s76
s_add_u32 s71, s70, s72
buffer_load_dwordx4 v12, s[12:15], s71 offen offset:0 lds
buffer_load_dwordx4 v13, s[12:15], s71 offen offset:1024 lds
buffer_load_dwordx4 v14, s[12:15], s71 offen offset:2048 lds
buffer_load_dwordx4 v15, s[12:15], s71 offen offset:3072 lds
s_add_u32 m0, m0, 4096
s_add_u32 s71, s70, s73
buffer_load_dwordx4 v12, s[12:15], s71 offen offset:0 lds
buffer_load_dwordx4 v13, s[12:15], s71 offen offset:1024 lds
buffer_load_dwordx4 v14, s[12:15], s71 offen offset:2048 lds
buffer_load_dwordx4 v15, s[12:15], s71 offen offset:3072 lds
s_add_u32 m0, m0, 4096
s_add_u32 s71, s70, s74
buffer_load_dwordx4 v12, s[12:15], s71 offen offset:0 lds
buffer_load_dwordx4 v13, s[12:15], s71 offen offset:1024 lds
buffer_load_dwordx4 v14, s[12:15], s71 offen offset:2048 lds
buffer_load_dwordx4 v15, s[12:15], s71 offen offset:3072 lds
s_add_u32 s64, s64, 1
s_and_b32 s64, s64, 15
s_sub_u32 s65, s65, 40960
s_cselect_b32 s65, 86016, s65
v_and_b32 v1, 3, v0
v_lshlrev_b32 v1, 2, v1
v_and_b32 v2, 4, v1
s_lshl2_add_u32 s35, s58, 16
v_mov_b32 v3, s35
v_lshlrev_b32 v20, 4, v0
v_lshrrev_b32 v6, 2, v0
v_lshl_add_u32 v21, v6, 7, v1
v_lshrrev_b32 v6, 3, v0
v_lshlrev_b32 v23, 1, v23
v_xor_b32 v23, v23, v22
v_lshlrev_b32 v23, 4, v23
v_lshl_add_u32 v23, v6, 11, v23
s_lshl_b32 s70, s62, 7
s_lshl_b32 s71, s58, 16
s_add_u32 s70, s70, s71
v_add_u32 v16, s70, v23
v_add_u32 v17, 15360, v16
v_add_u32 v18, 30720, v16
v_add_u32 v19, 46080, v16
s_add_u32 s77, s61, s62
s_lshl_b32 s77, s77, 17
s_lshl_b32 s78, s58, 12
s_mov_b32 s66, -2
s_cmp_eq_u32 s58, 0
s_cselect_b32 s4, s46, s48
s_cselect_b32 s5, s47, s49
s_cmp_lt_u32 s2, 224
s_cselect_b32 s6, 7340032, 0
s_mov_b32 s7, 0x00020000
s_bfe_u32 s70, s2, 0x20003
s_mul_i32 s70, s70, 1835008
s_and_b32 s71, s2, 7
s_mul_i32 s71, s71, 896
s_add_u32 s70, s70, s71
s_lshr_b32 s71, s2, 5
s_lshl_b32 s71, s71, 7
s_add_u32 s70, s70, s71
v_lshrrev_b32 v24, 2, v0
v_and_b32 v25, 3, v0
v_lshl_add_u32 v24, v24, 3, v25
v_mul_u32_u24 v24, 7168, v24
v_add_u32 v24, s70, v24
s_barrier
.p2align 4
lq_1:
s_add_u32 s35, s66, 1
lw_4:
ds_read_b32 v5, v1 offset:0
s_waitcnt lgkmcnt(0)
v_cmp_gt_i32 vcc, s35, v5
s_cbranch_vccz lwd_5
s_sub_u32 s32, s32, 1
s_cmp_gt_i32 s32, 0
s_cbranch_scc1 lw_4
lwd_5:
s_cmp_eq_u32 s66, 0
s_cbranch_scc1 lcs_2
lcb_3:
s_mul_i32 s70, s64, s67
s_add_u32 m0, s65, s75
s_add_u32 s71, s70, s68
buffer_load_dwordx4 v8, s[8:11], s71 offen offset:0 sc1 lds
buffer_load_dwordx4 v9, s[8:11], s71 offen offset:1024 sc1 lds
buffer_load_dwordx4 v10, s[8:11], s71 offen offset:2048 sc1 lds
buffer_load_dwordx4 v11, s[8:11], s71 offen offset:3072 sc1 lds
s_add_u32 m0, m0, 4096
s_add_u32 s71, s70, s69
buffer_load_dwordx4 v8, s[8:11], s71 offen offset:0 sc1 lds
buffer_load_dwordx4 v9, s[8:11], s71 offen offset:1024 sc1 lds
buffer_load_dwordx4 v10, s[8:11], s71 offen offset:2048 sc1 lds
buffer_load_dwordx4 v11, s[8:11], s71 offen offset:3072 sc1 lds
s_mul_i32 s70, s64, 393216
s_add_u32 m0, s65, s76
s_add_u32 s71, s70, s72
buffer_load_dwordx4 v12, s[12:15], s71 offen offset:0 lds
buffer_load_dwordx4 v13, s[12:15], s71 offen offset:1024 lds
buffer_load_dwordx4 v14, s[12:15], s71 offen offset:2048 lds
buffer_load_dwordx4 v15, s[12:15], s71 offen offset:3072 lds
v_add_u32 v5, s66, 3
s_mov_b64 exec, 1
s_waitcnt vmcnt(12)
ds_write_b32 v3, v5
s_mov_b64 exec, -1
s_mul_i32 s70, s64, 393216
s_add_u32 m0, m0, 4096
s_add_u32 s71, s70, s73
buffer_load_dwordx4 v12, s[12:15], s71 offen offset:0 lds
buffer_load_dwordx4 v13, s[12:15], s71 offen offset:1024 lds
buffer_load_dwordx4 v14, s[12:15], s71 offen offset:2048 lds
buffer_load_dwordx4 v15, s[12:15], s71 offen offset:3072 lds
s_mul_i32 s70, s64, 393216
s_add_u32 m0, m0, 4096
s_add_u32 s71, s70, s74
buffer_load_dwordx4 v12, s[12:15], s71 offen offset:0 lds
buffer_load_dwordx4 v13, s[12:15], s71 offen offset:1024 lds
buffer_load_dwordx4 v14, s[12:15], s71 offen offset:2048 lds
buffer_load_dwordx4 v15, s[12:15], s71 offen offset:3072 lds
s_add_u32 s64, s64, 1
s_and_b32 s64, s64, 15
s_sub_u32 s65, s65, 40960
s_cselect_b32 s65, 86016, s65
s_add_u32 s66, s66, 1
s_and_b32 s70, s66, 31
s_cmp_eq_u32 s70, 13
s_cbranch_scc0 lq_1
s_waitcnt vmcnt(0)
v_add_u32 v5, s34, 16
s_mov_b64 exec, 1
ds_write_b32 v3, v5
s_mov_b64 exec, -1
s_add_u32 s35, s34, 14
lw_6:
ds_read_b32 v5, v1 offset:0
s_waitcnt lgkmcnt(0)
v_cmp_gt_i32 vcc, s35, v5
s_cbranch_vccz lwd_7
s_sleep 1
s_sub_u32 s32, s32, 1
s_cmp_gt_i32 s32, 0
s_cbranch_scc1 lw_6
lwd_7:
s_add_u32 s70, s77, 262144
s_add_u32 m0, s78, 49152
s_and_b32 s70, s70, 0x1fffff
buffer_load_dwordx4 v16, s[16:19], s70 offen offset:0 lds
buffer_load_dwordx4 v17, s[16:19], s70 offen offset:1024 lds
buffer_load_dwordx4 v18, s[16:19], s70 offen offset:2048 lds
buffer_load_dwordx4 v19, s[16:19], s70 offen offset:3072 lds
s_add_u32 s70, s77, 393216
s_add_u32 m0, s78, 57344
s_and_b32 s70, s70, 0x1fffff
buffer_load_dwordx4 v16, s[16:19], s70 offen offset:0 lds
buffer_load_dwordx4 v17, s[16:19], s70 offen offset:1024 lds
buffer_load_dwordx4 v18, s[16:19], s70 offen offset:2048 lds
buffer_load_dwordx4 v19, s[16:19], s70 offen offset:3072 lds
s_add_u32 s70, s77, 524288
s_add_u32 m0, s78, 65536
s_and_b32 s70, s70, 0x1fffff
buffer_load_dwordx4 v16, s[16:19], s70 offen offset:0 lds
buffer_load_dwordx4 v17, s[16:19], s70 offen offset:1024 lds
buffer_load_dwordx4 v18, s[16:19], s70 offen offset:2048 lds
buffer_load_dwordx4 v19, s[16:19], s70 offen offset:3072 lds
s_add_u32 s70, s77, 655360
s_add_u32 m0, s78, 73728
s_and_b32 s70, s70, 0x1fffff
buffer_load_dwordx4 v16, s[16:19], s70 offen offset:0 lds
buffer_load_dwordx4 v17, s[16:19], s70 offen offset:1024 lds
buffer_load_dwordx4 v18, s[16:19], s70 offen offset:2048 lds
buffer_load_dwordx4 v19, s[16:19], s70 offen offset:3072 lds
s_sub_u32 s70, s59, s58
s_lshl4_add_u32 s70, s70, s60
s_sub_u32 s70, s70, 16
s_lshl_b32 s66, s70, 7
s_add_u32 s66, s66, 491520
s_lshl_b32 s70, s70, 15
s_lshl_b32 s71, s63, 23
s_add_u32 s70, s70, s71
s_add_u32 s64, s70, 1077248
s_mul_i32 s65, s58, -94208
s_add_u32 s35, s34, 16
lw_8:
ds_read_b32 v5, v1 offset:0
s_waitcnt lgkmcnt(0)
v_cmp_gt_i32 vcc, s35, v5
s_cbranch_vccz lwd_9
s_sleep 1
s_sub_u32 s32, s32, 1
s_cmp_gt_i32 s32, 0
s_cbranch_scc1 lw_8
lwd_9:
s_add_u32 s70, s77, 131072
s_add_u32 m0, s78, 40960
s_and_b32 s70, s70, 0x1fffff
buffer_load_dwordx4 v16, s[16:19], s70 offen offset:0 lds
buffer_load_dwordx4 v17, s[16:19], s70 offen offset:1024 lds
buffer_load_dwordx4 v18, s[16:19], s70 offen offset:2048 lds
buffer_load_dwordx4 v19, s[16:19], s70 offen offset:3072 lds
s_add_u32 s70, s77, 786432
s_add_u32 m0, s78, 81920
s_and_b32 s70, s70, 0x1fffff
buffer_load_dwordx4 v16, s[16:19], s70 offen offset:0 lds
buffer_load_dwordx4 v17, s[16:19], s70 offen offset:1024 lds
buffer_load_dwordx4 v18, s[16:19], s70 offen offset:2048 lds
buffer_load_dwordx4 v19, s[16:19], s70 offen offset:3072 lds
s_add_u32 s70, s77, 917504
s_add_u32 m0, s78, 90112
s_and_b32 s70, s70, 0x1fffff
buffer_load_dwordx4 v16, s[16:19], s70 offen offset:0 lds
buffer_load_dwordx4 v17, s[16:19], s70 offen offset:1024 lds
buffer_load_dwordx4 v18, s[16:19], s70 offen offset:2048 lds
buffer_load_dwordx4 v19, s[16:19], s70 offen offset:3072 lds
s_add_u32 s35, s34, 17
lw_11:
ds_read_b32 v5, v1 offset:0
s_waitcnt lgkmcnt(0)
v_cmp_gt_i32 vcc, s35, v5
s_cbranch_vccz lwd_12
s_sleep 1
s_sub_u32 s32, s32, 1
s_cmp_gt_i32 s32, 0
s_cbranch_scc1 lw_11
lwd_12:
s_cmp_gt_u32 s59, s58
s_cbranch_scc0 nokv_10
poll_13:
buffer_load_dword v6, v1, s[24:27], s66 offen sc1
pchk_14:
s_waitcnt vmcnt(0)
v_cmp_eq_u32 vcc, 0, v6
s_cbranch_vccz pdone_15
s_sub_u32 s32, s32, 1
s_cmp_gt_i32 s32, 0
s_cbranch_scc1 poll_13
pdone_15:
s_add_u32 m0, s65, 126976
s_nop 0
buffer_load_dwordx4 v20, s[20:23], s64 offen offset:0 sc1 lds
buffer_load_dwordx4 v20, s[20:23], s64 offen offset:1024 sc1 lds
buffer_load_dwordx4 v20, s[20:23], s64 offen offset:2048 sc1 lds
buffer_load_dwordx4 v20, s[20:23], s64 offen offset:3072 sc1 lds
s_add_u32 m0, s65, 122880
s_sub_u32 s64, s64, 4096
buffer_load_dwordx4 v20, s[20:23], s64 offen offset:0 sc1 lds
buffer_load_dwordx4 v20, s[20:23], s64 offen offset:1024 sc1 lds
buffer_load_dwordx4 v20, s[20:23], s64 offen offset:2048 sc1 lds
buffer_load_dwordx4 v20, s[20:23], s64 offen offset:3072 sc1 lds
s_add_u32 m0, s65, 118784
s_sub_u32 s64, s64, 4096
buffer_load_dwordx4 v20, s[20:23], s64 offen offset:0 sc1 lds
buffer_load_dwordx4 v20, s[20:23], s64 offen offset:1024 sc1 lds
buffer_load_dwordx4 v20, s[20:23], s64 offen offset:2048 sc1 lds
buffer_load_dwordx4 v20, s[20:23], s64 offen offset:3072 sc1 lds
s_add_u32 m0, s65, 114688
s_sub_u32 s64, s64, 4096
buffer_load_dwordx4 v20, s[20:23], s64 offen offset:0 sc1 lds
buffer_load_dwordx4 v20, s[20:23], s64 offen offset:1024 sc1 lds
buffer_load_dwordx4 v20, s[20:23], s64 offen offset:2048 sc1 lds
buffer_load_dwordx4 v20, s[20:23], s64 offen offset:3072 sc1 lds
s_add_u32 m0, s65, 110592
s_sub_u32 s64, s64, 4096
buffer_load_dwordx4 v20, s[20:23], s64 offen offset:0 sc1 lds
buffer_load_dwordx4 v20, s[20:23], s64 offen offset:1024 sc1 lds
buffer_load_dwordx4 v20, s[20:23], s64 offen offset:2048 sc1 lds
buffer_load_dwordx4 v20, s[20:23], s64 offen offset:3072 sc1 lds
s_add_u32 m0, s65, 106496
s_sub_u32 s64, s64, 4096
buffer_load_dwordx4 v20, s[20:23], s64 offen offset:0 sc1 lds
buffer_load_dwordx4 v20, s[20:23], s64 offen offset:1024 sc1 lds
buffer_load_dwordx4 v20, s[20:23], s64 offen offset:2048 sc1 lds
buffer_load_dwordx4 v20, s[20:23], s64 offen offset:3072 sc1 lds
s_add_u32 m0, s65, 102400
s_sub_u32 s64, s64, 4096
buffer_load_dwordx4 v20, s[20:23], s64 offen offset:0 sc1 lds
buffer_load_dwordx4 v20, s[20:23], s64 offen offset:1024 sc1 lds
buffer_load_dwordx4 v20, s[20:23], s64 offen offset:2048 sc1 lds
buffer_load_dwordx4 v20, s[20:23], s64 offen offset:3072 sc1 lds
s_add_u32 m0, s65, 98304
s_sub_u32 s64, s64, 4096
buffer_load_dwordx4 v20, s[20:23], s64 offen offset:0 sc1 lds
buffer_load_dwordx4 v20, s[20:23], s64 offen offset:1024 sc1 lds
buffer_load_dwordx4 v20, s[20:23], s64 offen offset:2048 sc1 lds
buffer_load_dwordx4 v20, s[20:23], s64 offen offset:3072 sc1 lds
nokv_10:
s_waitcnt vmcnt(0)
v_add_u32 v5, s34, 17
s_mov_b64 exec, 1
ds_write_b32 v3, v5
s_mov_b64 exec, -1
s_add_u32 s35, s34, 18
lw_16:
ds_read_b32 v5, v1 offset:0
s_waitcnt lgkmcnt(0)
v_cmp_gt_i32 vcc, s35, v5
s_cbranch_vccz lwd_17
s_sleep 1
s_sub_u32 s32, s32, 1
s_cmp_gt_i32 s32, 0
s_cbranch_scc1 lw_16
lwd_17:
s_add_u32 s70, s77, 1572864
s_add_u32 m0, s78, 131072
s_and_b32 s70, s70, 0x1fffff
buffer_load_dwordx4 v16, s[16:19], s70 offen offset:0 lds
buffer_load_dwordx4 v17, s[16:19], s70 offen offset:1024 lds
buffer_load_dwordx4 v18, s[16:19], s70 offen offset:2048 lds
buffer_load_dwordx4 v19, s[16:19], s70 offen offset:3072 lds
s_add_u32 s70, s77, 1703936
s_add_u32 m0, s78, 139264
s_and_b32 s70, s70, 0x1fffff
buffer_load_dwordx4 v16, s[16:19], s70 offen offset:0 lds
buffer_load_dwordx4 v17, s[16:19], s70 offen offset:1024 lds
buffer_load_dwordx4 v18, s[16:19], s70 offen offset:2048 lds
buffer_load_dwordx4 v19, s[16:19], s70 offen offset:3072 lds
s_add_u32 s70, s77, 1835008
s_add_u32 m0, s78, 147456
s_and_b32 s70, s70, 0x1fffff
buffer_load_dwordx4 v16, s[16:19], s70 offen offset:0 lds
buffer_load_dwordx4 v17, s[16:19], s70 offen offset:1024 lds
buffer_load_dwordx4 v18, s[16:19], s70 offen offset:2048 lds
buffer_load_dwordx4 v19, s[16:19], s70 offen offset:3072 lds
s_add_u32 s70, s77, 1966080
s_add_u32 m0, s78, 155648
s_and_b32 s70, s70, 0x1fffff
buffer_load_dwordx4 v16, s[16:19], s70 offen offset:0 lds
buffer_load_dwordx4 v17, s[16:19], s70 offen offset:1024 lds
buffer_load_dwordx4 v18, s[16:19], s70 offen offset:2048 lds
buffer_load_dwordx4 v19, s[16:19], s70 offen offset:3072 lds
s_add_u32 s35, s34, 19
lw_18:
ds_read_b32 v5, v1 offset:0
s_waitcnt lgkmcnt(0)
v_cmp_gt_i32 vcc, s35, v5
s_cbranch_vccz lwd_19
s_sleep 2
s_sub_u32 s32, s32, 1
s_cmp_gt_i32 s32, 0
s_cbranch_scc1 lw_18
lwd_19:
s_add_u32 s70, s77, 1048576
s_add_u32 m0, s78, 98304
s_and_b32 s70, s70, 0x1fffff
buffer_load_dwordx4 v16, s[16:19], s70 offen offset:0 lds
buffer_load_dwordx4 v17, s[16:19], s70 offen offset:1024 lds
buffer_load_dwordx4 v18, s[16:19], s70 offen offset:2048 lds
buffer_load_dwordx4 v19, s[16:19], s70 offen offset:3072 lds
s_add_u32 s70, s77, 1179648
s_add_u32 m0, s78, 106496
s_and_b32 s70, s70, 0x1fffff
buffer_load_dwordx4 v16, s[16:19], s70 offen offset:0 lds
buffer_load_dwordx4 v17, s[16:19], s70 offen offset:1024 lds
buffer_load_dwordx4 v18, s[16:19], s70 offen offset:2048 lds
buffer_load_dwordx4 v19, s[16:19], s70 offen offset:3072 lds
s_add_u32 s70, s77, 1310720
s_add_u32 m0, s78, 114688
s_and_b32 s70, s70, 0x1fffff
buffer_load_dwordx4 v16, s[16:19], s70 offen offset:0 lds
buffer_load_dwordx4 v17, s[16:19], s70 offen offset:1024 lds
buffer_load_dwordx4 v18, s[16:19], s70 offen offset:2048 lds
buffer_load_dwordx4 v19, s[16:19], s70 offen offset:3072 lds
s_add_u32 s70, s77, 1441792
s_add_u32 m0, s78, 122880
s_and_b32 s70, s70, 0x1fffff
buffer_load_dwordx4 v16, s[16:19], s70 offen offset:0 lds
buffer_load_dwordx4 v17, s[16:19], s70 offen offset:1024 lds
buffer_load_dwordx4 v18, s[16:19], s70 offen offset:2048 lds
buffer_load_dwordx4 v19, s[16:19], s70 offen offset:3072 lds
s_add_u32 s35, s34, 20
lw_20:
ds_read_b32 v5, v1 offset:0
s_waitcnt lgkmcnt(0)
v_cmp_gt_i32 vcc, s35, v5
s_cbranch_vccz lwd_21
s_sleep 2
s_sub_u32 s32, s32, 1
s_cmp_gt_i32 s32, 0
s_cbranch_scc1 lw_20
lwd_21:
s_add_u32 s70, s77, 0
s_add_u32 m0, s78, 32768
s_and_b32 s70, s70, 0x1fffff
buffer_load_dwordx4 v16, s[16:19], s70 offen offset:0 lds
buffer_load_dwordx4 v17, s[16:19], s70 offen offset:1024 lds
buffer_load_dwordx4 v18, s[16:19], s70 offen offset:2048 lds
buffer_load_dwordx4 v19, s[16:19], s70 offen offset:3072 lds
s_lshl_b32 s66, s61, 11
s_add_u32 s66, s66, 327680
s_cmp_eq_u32 s58, 0
s_cbranch_scc0 nofo_22
s_add_u32 s35, s34, 21
lw_23:
ds_read_b32 v5, v1 offset:0
s_waitcnt lgkmcnt(0)
v_cmp_gt_i32 vcc, s35, v5
s_cbranch_vccz lwd_24
s_sleep 1
s_sub_u32 s32, s32, 1
s_cmp_gt_i32 s32, 0
s_cbranch_scc1 lw_23
lwd_24:
poll_25:
buffer_load_dword v6, v21, s[24:27], s66 offen sc1
pchk_26:
s_waitcnt vmcnt(0)
v_cmp_eq_u32 vcc, 0, v6
s_cbranch_vccz pdone_27
s_sub_u32 s32, s32, 1
s_cmp_gt_i32 s32, 0
s_cbranch_scc1 poll_25
pdone_27:
nofo_22:
s_waitcnt vmcnt(0)
v_add_u32 v5, s34, 18
s_mov_b64 exec, 1
ds_write_b32 v3, v5
s_mov_b64 exec, -1
s_cmp_eq_u32 s63, 0
s_cbranch_scc0 L_end
v_bfe_u32 v6, v0, 3, 2
v_and_b32 v7, 2, v6
v_xor_b32 v7, v7, v22
v_lshrrev_b32 v23, 5, v0
v_lshl_add_u32 v6, v23, 4, v6
v_mul_u32_u24 v6, 6144, v6
v_lshl_add_u32 v12, v7, 4, v6
v_xor_b32 v6, 64, v12
v_add_u32 v13, 23552, v6
v_add_u32 v14, 47104, v12
v_add_u32 v15, 70656, v6
v_mov_b32 v8, v20
v_mov_b32 v9, v20
v_mov_b32 v10, v20
v_mov_b32 v11, v20
s_mov_b32 s8, s56
s_mov_b32 s9, s57
s_mov_b32 s10, 0x2300000
s_mov_b32 s11, 0x00020000
s_mov_b32 s6, 0
s_lshl_b32 s70, s59, 18
s_add_u32 s70, s70, 26214400
s_add_u32 s68, s70, s78
s_sub_u32 s69, s70, s78
s_add_u32 s69, s69, 12288
s_mov_b32 s67, 16384
s_lshl_b32 s66, s59, 11
s_add_u32 s66, s66, 360448
s_and_b32 s64, s61, 14
s_mov_b32 s65, 86016
s_add_u32 s35, s34, 22
lw_28:
ds_read_b32 v5, v1 offset:0
s_waitcnt lgkmcnt(0)
v_cmp_gt_i32 vcc, s35, v5
s_cbranch_vccz lwd_29
s_sleep 2
s_sub_u32 s32, s32, 1
s_cmp_gt_i32 s32, 0
s_cbranch_scc1 lw_28
lwd_29:
s_mul_i32 s70, s64, 393216
s_add_u32 m0, s65, s76
s_add_u32 s71, s70, s72
buffer_load_dwordx4 v12, s[12:15], s71 offen offset:0 lds
buffer_load_dwordx4 v13, s[12:15], s71 offen offset:1024 lds
buffer_load_dwordx4 v14, s[12:15], s71 offen offset:2048 lds
buffer_load_dwordx4 v15, s[12:15], s71 offen offset:3072 lds
s_add_u32 m0, m0, 4096
s_add_u32 s71, s70, s73
buffer_load_dwordx4 v12, s[12:15], s71 offen offset:0 lds
buffer_load_dwordx4 v13, s[12:15], s71 offen offset:1024 lds
buffer_load_dwordx4 v14, s[12:15], s71 offen offset:2048 lds
buffer_load_dwordx4 v15, s[12:15], s71 offen offset:3072 lds
s_add_u32 m0, m0, 4096
s_add_u32 s71, s70, s74
buffer_load_dwordx4 v12, s[12:15], s71 offen offset:0 lds
buffer_load_dwordx4 v13, s[12:15], s71 offen offset:1024 lds
buffer_load_dwordx4 v14, s[12:15], s71 offen offset:2048 lds
buffer_load_dwordx4 v15, s[12:15], s71 offen offset:3072 lds
s_add_u32 s64, s64, 1
s_and_b32 s64, s64, 15
s_sub_u32 s65, s65, 40960
s_cselect_b32 s65, 86016, s65
s_mul_i32 s70, s64, 393216
s_add_u32 m0, s65, s76
s_add_u32 s71, s70, s72
buffer_load_dwordx4 v12, s[12:15], s71 offen offset:0 lds
buffer_load_dwordx4 v13, s[12:15], s71 offen offset:1024 lds
buffer_load_dwordx4 v14, s[12:15], s71 offen offset:2048 lds
buffer_load_dwordx4 v15, s[12:15], s71 offen offset:3072 lds
s_add_u32 m0, m0, 4096
s_add_u32 s71, s70, s73
buffer_load_dwordx4 v12, s[12:15], s71 offen offset:0 lds
buffer_load_dwordx4 v13, s[12:15], s71 offen offset:1024 lds
buffer_load_dwordx4 v14, s[12:15], s71 offen offset:2048 lds
buffer_load_dwordx4 v15, s[12:15], s71 offen offset:3072 lds
s_add_u32 m0, m0, 4096
s_add_u32 s71, s70, s74
buffer_load_dwordx4 v12, s[12:15], s71 offen offset:0 lds
buffer_load_dwordx4 v13, s[12:15], s71 offen offset:1024 lds
buffer_load_dwordx4 v14, s[12:15], s71 offen offset:2048 lds
buffer_load_dwordx4 v15, s[12:15], s71 offen offset:3072 lds
s_add_u32 s64, s64, 1
s_and_b32 s64, s64, 15
s_sub_u32 s65, s65, 40960
s_cselect_b32 s65, 86016, s65
s_mul_i32 s70, s64, 393216
s_add_u32 m0, s65, s76
s_add_u32 s71, s70, s72
buffer_load_dwordx4 v12, s[12:15], s71 offen offset:0 lds
buffer_load_dwordx4 v13, s[12:15], s71 offen offset:1024 lds
buffer_load_dwordx4 v14, s[12:15], s71 offen offset:2048 lds
buffer_load_dwordx4 v15, s[12:15], s71 offen offset:3072 lds
s_add_u32 m0, m0, 4096
s_add_u32 s71, s70, s73
buffer_load_dwordx4 v12, s[12:15], s71 offen offset:0 lds
buffer_load_dwordx4 v13, s[12:15], s71 offen offset:1024 lds
buffer_load_dwordx4 v14, s[12:15], s71 offen offset:2048 lds
buffer_load_dwordx4 v15, s[12:15], s71 offen offset:3072 lds
s_add_u32 m0, m0, 4096
s_add_u32 s71, s70, s74
buffer_load_dwordx4 v12, s[12:15], s71 offen offset:0 lds
buffer_load_dwordx4 v13, s[12:15], s71 offen offset:1024 lds
buffer_load_dwordx4 v14, s[12:15], s71 offen offset:2048 lds
buffer_load_dwordx4 v15, s[12:15], s71 offen offset:3072 lds
s_add_u32 s64, s64, 1
s_and_b32 s64, s64, 15
s_sub_u32 s65, s65, 40960
s_cselect_b32 s65, 86016, s65
s_mov_b32 s64, s59
s_mov_b32 s65, 114688
s_mul_i32 s70, s64, 393216
s_add_u32 m0, s65, s76
s_add_u32 s71, s70, s72
buffer_load_dwordx4 v12, s[12:15], s71 offen offset:0 lds
buffer_load_dwordx4 v13, s[12:15], s71 offen offset:1024 lds
buffer_load_dwordx4 v14, s[12:15], s71 offen offset:2048 lds
buffer_load_dwordx4 v15, s[12:15], s71 offen offset:3072 lds
s_add_u32 m0, m0, 4096
s_add_u32 s71, s70, s73
buffer_load_dwordx4 v12, s[12:15], s71 offen offset:0 lds
buffer_load_dwordx4 v13, s[12:15], s71 offen offset:1024 lds
buffer_load_dwordx4 v14, s[12:15], s71 offen offset:2048 lds
buffer_load_dwordx4 v15, s[12:15], s71 offen offset:3072 lds
s_add_u32 m0, m0, 4096
s_add_u32 s71, s70, s74
buffer_load_dwordx4 v12, s[12:15], s71 offen offset:0 lds
buffer_load_dwordx4 v13, s[12:15], s71 offen offset:1024 lds
buffer_load_dwordx4 v14, s[12:15], s71 offen offset:2048 lds
buffer_load_dwordx4 v15, s[12:15], s71 offen offset:3072 lds
s_and_b32 s64, s61, 14
s_mov_b32 s65, 86016
s_add_u32 s35, s34, 23
lw_30:
ds_read_b32 v5, v1 offset:0
s_waitcnt lgkmcnt(0)
v_cmp_gt_i32 vcc, s35, v5
s_cbranch_vccz lwd_31
s_sleep 1
s_sub_u32 s32, s32, 1
s_cmp_gt_i32 s32, 0
s_cbranch_scc1 lw_30
lwd_31:
poll_32:
buffer_load_dword v6, v21, s[24:27], s66 offen sc1
pchk_33:
s_waitcnt vmcnt(0)
v_cmp_eq_u32 vcc, 0, v6
s_cbranch_vccz pdone_34
s_sub_u32 s32, s32, 1
s_cmp_gt_i32 s32, 0
s_cbranch_scc1 poll_32
pdone_34:
s_mul_i32 s70, s64, s67
s_add_u32 m0, s65, s75
s_add_u32 s71, s70, s68
buffer_load_dwordx4 v8, s[8:11], s71 offen offset:0 sc1 lds
buffer_load_dwordx4 v9, s[8:11], s71 offen offset:1024 sc1 lds
buffer_load_dwordx4 v10, s[8:11], s71 offen offset:2048 sc1 lds
buffer_load_dwordx4 v11, s[8:11], s71 offen offset:3072 sc1 lds
s_add_u32 m0, m0, 4096
s_add_u32 s71, s70, s69
buffer_load_dwordx4 v8, s[8:11], s71 offen offset:0 sc1 lds
buffer_load_dwordx4 v9, s[8:11], s71 offen offset:1024 sc1 lds
buffer_load_dwordx4 v10, s[8:11], s71 offen offset:2048 sc1 lds
buffer_load_dwordx4 v11, s[8:11], s71 offen offset:3072 sc1 lds
s_add_u32 s64, s64, 1
s_and_b32 s64, s64, 15
s_sub_u32 s65, s65, 40960
s_cselect_b32 s65, 86016, s65
s_mul_i32 s70, s64, s67
s_add_u32 m0, s65, s75
s_add_u32 s71, s70, s68
buffer_load_dwordx4 v8, s[8:11], s71 offen offset:0 sc1 lds
buffer_load_dwordx4 v9, s[8:11], s71 offen offset:1024 sc1 lds
buffer_load_dwordx4 v10, s[8:11], s71 offen offset:2048 sc1 lds
buffer_load_dwordx4 v11, s[8:11], s71 offen offset:3072 sc1 lds
s_add_u32 m0, m0, 4096
s_add_u32 s71, s70, s69
buffer_load_dwordx4 v8, s[8:11], s71 offen offset:0 sc1 lds
buffer_load_dwordx4 v9, s[8:11], s71 offen offset:1024 sc1 lds
buffer_load_dwordx4 v10, s[8:11], s71 offen offset:2048 sc1 lds
buffer_load_dwordx4 v11, s[8:11], s71 offen offset:3072 sc1 lds
s_add_u32 s64, s64, 1
s_and_b32 s64, s64, 15
s_sub_u32 s65, s65, 40960
s_cselect_b32 s65, 86016, s65
s_mul_i32 s70, s64, s67
s_add_u32 m0, s65, s75
s_add_u32 s71, s70, s68
buffer_load_dwordx4 v8, s[8:11], s71 offen offset:0 sc1 lds
buffer_load_dwordx4 v9, s[8:11], s71 offen offset:1024 sc1 lds
buffer_load_dwordx4 v10, s[8:11], s71 offen offset:2048 sc1 lds
buffer_load_dwordx4 v11, s[8:11], s71 offen offset:3072 sc1 lds
s_add_u32 m0, m0, 4096
s_add_u32 s71, s70, s69
buffer_load_dwordx4 v8, s[8:11], s71 offen offset:0 sc1 lds
buffer_load_dwordx4 v9, s[8:11], s71 offen offset:1024 sc1 lds
buffer_load_dwordx4 v10, s[8:11], s71 offen offset:2048 sc1 lds
buffer_load_dwordx4 v11, s[8:11], s71 offen offset:3072 sc1 lds
s_add_u32 s64, s64, 1
s_and_b32 s64, s64, 15
s_sub_u32 s65, s65, 40960
s_cselect_b32 s65, 86016, s65
s_mov_b32 s63, 1
s_mov_b32 s34, 32
s_add_u32 s24, s24, 2359296
s_addc_u32 s25, s25, 0
s_mov_b32 s26, 2359296
s_waitcnt vmcnt(16)
v_add_u32 v5, s34, 1
s_mov_b64 exec, 1
ds_write_b32 v3, v5
s_mov_b64 exec, -1
s_waitcnt vmcnt(8)
v_add_u32 v5, s34, 2
s_mov_b64 exec, 1
ds_write_b32 v3, v5
s_mov_b64 exec, -1
s_mov_b32 s66, 32
s_branch lq_1
lcs_2:
s_add_u32 s35, s34, 1
lw_35:
ds_read_b32 v5, v2 offset:24
s_waitcnt lgkmcnt(0)
v_cmp_gt_i32 vcc, s35, v5
s_cbranch_vccz lwd_36
s_sub_u32 s32, s32, 1
s_cmp_gt_i32 s32, 0
s_cbranch_scc1 lw_35
lwd_36:
s_branch lcb_3
L_f:
s_cmp_eq_u32 s58, 0
s_cbranch_scc0 fz_37
v_lshlrev_b32 v14, 4, v0
v_mov_b32 v56, 0
v_mov_b32 v57, 0
v_mov_b32 v58, 0
v_mov_b32 v59, 0
s_mul_i32 s70, s2, 1280
buffer_store_dwordx4 v[56:59], v14, s[24:27], s70 offen offset:0 sc1
buffer_store_dwordx4 v[56:59], v14, s[24:27], s70 offen offset:256 sc1
fz_37:
v_and_b32 v1, 3, v0
v_lshlrev_b32 v1, 2, v1
v_and_b32 v2, 4, v1
s_lshl2_add_u32 s35, s58, 24
v_mov_b32 v3, s35
s_mov_b32 s4, s54
s_mov_b32 s5, s55
s_mov_b32 s6, 0x100
s_mov_b32 s7, 0x00020000
s_and_b32 s70, s2, 7
s_lshr_b32 s71, s2, 3
s_mul_i32 s64, s70, 28
s_add_u32 s64, s64, s71
s_lshl_b32 s65, s70, 5
s_add_u32 s65, s65, s71
s_mov_b32 s69, 0x3f803f80
s_barrier
s_cmp_eq_u32 s58, 0
s_cselect_b32 s16, s46, s48
s_cselect_b32 s17, s47, s49
s_mov_b32 s18, 7340032
s_mov_b32 s12, s50
s_mov_b32 s13, s51
s_mov_b32 s14, 0x700000
s_mov_b32 s15, 0x00020000
s_min_u32 s70, s64, 223
s_lshl_b32 s70, s70, 15
s_lshl_b32 s71, s58, 10
s_add_u32 s66, s70, s71
s_add_u32 s78, s50, s66
s_addc_u32 s79, s51, 0
s_lshr_b32 s70, s2, 3
s_min_u32 s70, s70, 27
s_and_b32 s71, s70, 3
s_mul_i32 s71, s71, 1835008
s_lshr_b32 s70, s70, 2
s_lshl_b32 s70, s70, 7
s_add_u32 s71, s71, s70
s_and_b32 s70, s2, 7
s_mul_i32 s70, s70, 896
s_add_u32 s77, s71, s70
s_add_u32 s36, s16, s77
s_addc_u32 s37, s17, 0
s_lshl_b32 s71, s64, 5
v_lshrrev_b32 v6, 2, v0
v_bfe_u32 v7, v0, 1, 1
v_lshl_add_u32 v6, v6, 3, v7
v_mul_u32_u24 v6, 57344, v6
v_and_b32 v7, 1, v0
v_lshl_add_u32 v6, v7, 4, v6
v_add_u32 v4, s71, v6
s_and_b32 s73, s2, 3
s_lshl_b32 s73, s73, 6
v_mov_b32 v14, 1
s_sub_u32 exec_lo, 1, s58
s_mov_b32 exec_hi, 0
s_waitcnt vmcnt(0)
buffer_atomic_add v14, off, s[4:7], s73 sc1
s_mov_b64 exec, -1
v_mov_b32 v8, s69
v_mov_b32 v9, s69
v_mov_b32 v10, s69
v_mov_b32 v11, s69
v_mov_b32 v12, s69
v_mov_b32 v13, s69
v_mov_b32 v14, s69
v_mov_b32 v15, s69
s_mov_b32 s70, 102400
ftop_38:
v_lshrrev_b32 v6, 4, v0
v_bfe_u32 v7, v0, 2, 2
v_lshl_add_u32 v6, v6, 3, v7
v_bfe_u32 v7, v0, 3, 2
s_lshl_b32 s71, s58, 1
v_xor_b32 v7, s71, v7
v_lshl_add_u32 v7, v7, 5, s70
v_lshl_add_u32 v6, v6, 7, v7
v_lshl_add_u32 v6, v1, 1, v6
v_xor_b32 v7, 32, v6
v_mov_b32 v16, 0
v_mov_b32 v17, 0
v_mov_b32 v18, 0
v_mov_b32 v19, 0
v_mov_b32 v20, 0
v_mov_b32 v21, 0
v_mov_b32 v22, 0
v_mov_b32 v23, 0
s_add_u32 s35, s34, 1
lw_39:
ds_read_b32 v5, v2 offset:16
s_waitcnt lgkmcnt(0)
v_cmp_gt_i32 vcc, s35, v5
s_cbranch_vccz lwd_40
s_sleep 1
s_sub_u32 s32, s32, 1
s_cmp_gt_i32 s32, 0
s_cbranch_scc1 lw_39
lwd_40:
ds_read_b64_tr_b16 v[24:25], v6 offset:0
ds_read_b64_tr_b16 v[26:27], v6 offset:512
ds_read_b64_tr_b16 v[28:29], v6 offset:4096
ds_read_b64_tr_b16 v[30:31], v6 offset:4608
ds_read_b64_tr_b16 v[32:33], v7 offset:0
ds_read_b64_tr_b16 v[34:35], v7 offset:512
ds_read_b64_tr_b16 v[36:37], v7 offset:4096
ds_read_b64_tr_b16 v[38:39], v7 offset:4608
ds_read_b64_tr_b16 v[40:41], v6 offset:8192
ds_read_b64_tr_b16 v[42:43], v6 offset:8704
ds_read_b64_tr_b16 v[44:45], v6 offset:12288
ds_read_b64_tr_b16 v[46:47], v6 offset:12800
ds_read_b64_tr_b16 v[48:49], v7 offset:8192
ds_read_b64_tr_b16 v[50:51], v7 offset:8704
ds_read_b64_tr_b16 v[52:53], v7 offset:12288
ds_read_b64_tr_b16 v[54:55], v7 offset:12800
v_dot2c_f32_bf16 v22, s69, v8
v_dot2c_f32_bf16 v23, v8, v8
v_dot2c_f32_bf16 v22, s69, v9
v_dot2c_f32_bf16 v23, v9, v9
v_dot2c_f32_bf16 v22, s69, v10
v_dot2c_f32_bf16 v23, v10, v10
v_dot2c_f32_bf16 v22, s69, v11
v_dot2c_f32_bf16 v23, v11, v11
v_dot2c_f32_bf16 v22, s69, v12
v_dot2c_f32_bf16 v23, v12, v12
v_dot2c_f32_bf16 v22, s69, v13
v_dot2c_f32_bf16 v23, v13, v13
v_dot2c_f32_bf16 v22, s69, v14
v_dot2c_f32_bf16 v23, v14, v14
v_dot2c_f32_bf16 v22, s69, v15
v_dot2c_f32_bf16 v23, v15, v15
s_waitcnt lgkmcnt(14)
v_dot2c_f32_bf16 v16, v8, v24
s_waitcnt lgkmcnt(11)
v_dot2c_f32_bf16 v17, v8, v32
v_dot2c_f32_bf16 v16, v9, v25
v_dot2c_f32_bf16 v17, v9, v33
v_dot2c_f32_bf16 v16, v10, v26
s_waitcnt lgkmcnt(10)
v_dot2c_f32_bf16 v17, v10, v34
v_dot2c_f32_bf16 v16, v11, v27
v_dot2c_f32_bf16 v17, v11, v35
v_dot2c_f32_bf16 v16, v12, v28
s_waitcnt lgkmcnt(9)
v_dot2c_f32_bf16 v17, v12, v36
v_dot2c_f32_bf16 v16, v13, v29
v_dot2c_f32_bf16 v17, v13, v37
v_dot2c_f32_bf16 v16, v14, v30
s_waitcnt lgkmcnt(8)
v_dot2c_f32_bf16 v17, v14, v38
v_dot2c_f32_bf16 v16, v15, v31
v_dot2c_f32_bf16 v17, v15, v39
ds_read_b64_tr_b16 v[24:25], v6 offset:16384
ds_read_b64_tr_b16 v[26:27], v6 offset:16896
ds_read_b64_tr_b16 v[28:29], v6 offset:20480
ds_read_b64_tr_b16 v[30:31], v6 offset:20992
ds_read_b64_tr_b16 v[32:33], v7 offset:16384
ds_read_b64_tr_b16 v[34:35], v7 offset:16896
ds_read_b64_tr_b16 v[36:37], v7 offset:20480
ds_read_b64_tr_b16 v[38:39], v7 offset:20992
v_add_u32 v5, s34, 1
s_mov_b64 exec, 1
ds_write_b32 v3, v5
s_mov_b64 exec, -1
s_waitcnt lgkmcnt(14)
v_dot2c_f32_bf16 v18, v8, v40
s_waitcnt lgkmcnt(12)
v_dot2c_f32_bf16 v19, v8, v48
v_dot2c_f32_bf16 v18, v9, v41
v_dot2c_f32_bf16 v19, v9, v49
v_dot2c_f32_bf16 v18, v10, v42
s_waitcnt lgkmcnt(11)
v_dot2c_f32_bf16 v19, v10, v50
v_dot2c_f32_bf16 v18, v11, v43
v_dot2c_f32_bf16 v19, v11, v51
v_dot2c_f32_bf16 v18, v12, v44
s_waitcnt lgkmcnt(10)
v_dot2c_f32_bf16 v19, v12, v52
v_dot2c_f32_bf16 v18, v13, v45
v_dot2c_f32_bf16 v19, v13, v53
v_dot2c_f32_bf16 v18, v14, v46
s_waitcnt lgkmcnt(9)
v_dot2c_f32_bf16 v19, v14, v54
v_dot2c_f32_bf16 v18, v15, v47
v_dot2c_f32_bf16 v19, v15, v55
s_waitcnt lgkmcnt(8)
v_dot2c_f32_bf16 v20, v8, v24
s_waitcnt lgkmcnt(4)
v_dot2c_f32_bf16 v21, v8, v32
v_dot2c_f32_bf16 v20, v9, v25
v_dot2c_f32_bf16 v21, v9, v33
v_dot2c_f32_bf16 v20, v10, v26
s_waitcnt lgkmcnt(3)
v_dot2c_f32_bf16 v21, v10, v34
v_dot2c_f32_bf16 v20, v11, v27
v_dot2c_f32_bf16 v21, v11, v35
v_dot2c_f32_bf16 v20, v12, v28
s_waitcnt lgkmcnt(2)
v_dot2c_f32_bf16 v21, v12, v36
v_dot2c_f32_bf16 v20, v13, v29
v_dot2c_f32_bf16 v21, v13, v37
v_dot2c_f32_bf16 v20, v14, v30
s_waitcnt lgkmcnt(1)
v_dot2c_f32_bf16 v21, v14, v38
v_dot2c_f32_bf16 v20, v15, v31
v_dot2c_f32_bf16 v21, v15, v39
s_lshl_b32 s72, s60, 14
s_lshl_b32 s70, s58, 9
s_add_u32 s72, s72, s70
s_lshl_b32 s70, s59, 10
s_add_u32 s71, s72, s70
v_lshlrev_b32 v6, 3, v0
v_permlane32_swap_b32 v16, v20
v_permlane32_swap_b32 v17, v21
v_permlane32_swap_b32 v18, v22
v_permlane32_swap_b32 v19, v23
v_pk_add_f32 v[16:17], v[16:17], v[20:21]
v_pk_add_f32 v[18:19], v[18:19], v[22:23]
s_nop 1
v_permlane16_swap_b32 v16, v18
v_permlane16_swap_b32 v17, v19
v_pk_add_f32 v[16:17], v[16:17], v[18:19]
s_lshl_b32 s76, s59, 11
s_add_u32 s76, s76, 262144
v_max_u32 v16, 1, v16
v_max_u32 v17, 1, v17
s_cmp_eq_u32 s63, 0
s_cbranch_scc1 fst_41
fsb_42:
buffer_store_dwordx2 v[16:17], v6, s[24:27], s71 offen sc1
s_add_u32 s73, s72, 4096
s_add_u32 s74, s72, 8192
s_add_u32 s75, s72, 12288
v_lshrrev_b32 v7, 2, v0
v_lshlrev_b32 v7, 7, v7
v_lshl_add_u32 v7, v1, 2, v7
v_lshrrev_b32 v8, 5, v0
v_lshrrev_b32 v9, 4, v0
v_xor_b32 v10, v8, v9
v_and_b32 v10, 1, v10
v_lshl_add_u32 v8, v10, 1, v8
v_and_b32 v10, 15, v0
v_lshlrev_b32 v8, 7, v8
v_lshl_add_u32 v8, v10, 3, v8
v_add_u32 v8, 1280, v8
s_mul_i32 s70, s58, 384
s_lshl_b32 s71, s63, 10
s_add_u32 s70, s70, s71
s_add_u32 s70, s70, 2304
v_lshl_add_u32 v9, v9, 7, s70
v_lshl_add_u32 v9, v10, 2, v9
s_cmp_eq_u32 s63, 0
s_cbranch_scc1 fg_43
fg_44:
poll_45:
buffer_load_dwordx4 v[12:15], v7, s[24:27], s76 offen sc1
pchk_46:
s_waitcnt vmcnt(0)
v_min3_u32 v10, v12, v13, v14
v_min_u32 v10, v10, v15
v_cmp_eq_u32 vcc, 0, v10
s_cbranch_vccz pdone_47
s_sub_u32 s32, s32, 1
s_cmp_gt_i32 s32, 0
s_cbranch_scc1 poll_45
pdone_47:
s_lshr_b32 s70, s33, 7
s_sub_u32 s70, s70, s59
s_mul_i32 s70, s70, s63
s_cmp_eq_u32 s70, 0
s_cbranch_scc0 fng_48
poll_49:
buffer_load_dwordx2 v[24:25], v6, s[24:27], s72 offen offset:0 sc1
buffer_load_dwordx2 v[26:27], v6, s[24:27], s72 offen offset:1024 sc1
buffer_load_dwordx2 v[28:29], v6, s[24:27], s72 offen offset:2048 sc1
buffer_load_dwordx2 v[30:31], v6, s[24:27], s72 offen offset:3072 sc1
buffer_load_dwordx2 v[32:33], v6, s[24:27], s73 offen offset:0 sc1
buffer_load_dwordx2 v[34:35], v6, s[24:27], s73 offen offset:1024 sc1
buffer_load_dwordx2 v[36:37], v6, s[24:27], s73 offen offset:2048 sc1
buffer_load_dwordx2 v[38:39], v6, s[24:27], s73 offen offset:3072 sc1
buffer_load_dwordx2 v[40:41], v6, s[24:27], s74 offen offset:0 sc1
buffer_load_dwordx2 v[42:43], v6, s[24:27], s74 offen offset:1024 sc1
buffer_load_dwordx2 v[44:45], v6, s[24:27], s74 offen offset:2048 sc1
buffer_load_dwordx2 v[46:47], v6, s[24:27], s74 offen offset:3072 sc1
buffer_load_dwordx2 v[48:49], v6, s[24:27], s75 offen offset:0 sc1
buffer_load_dwordx2 v[50:51], v6, s[24:27], s75 offen offset:1024 sc1
buffer_load_dwordx2 v[52:53], v6, s[24:27], s75 offen offset:2048 sc1
buffer_load_dwordx2 v[54:55], v6, s[24:27], s75 offen offset:3072 sc1
pchk_50:
s_waitcnt vmcnt(14)
v_min3_u32 v10, v24, v25, v26
s_waitcnt vmcnt(13)
v_min3_u32 v10, v10, v27, v28
s_waitcnt vmcnt(12)
v_min3_u32 v10, v10, v29, v30
s_waitcnt vmcnt(11)
v_min3_u32 v10, v10, v31, v32
s_waitcnt vmcnt(10)
v_min3_u32 v10, v10, v33, v34
s_waitcnt vmcnt(9)
v_min3_u32 v10, v10, v35, v36
s_waitcnt vmcnt(8)
v_min3_u32 v10, v10, v37, v38
s_waitcnt vmcnt(7)
v_min3_u32 v10, v10, v39, v40
s_waitcnt vmcnt(6)
v_min3_u32 v10, v10, v41, v42
s_waitcnt vmcnt(5)
v_min3_u32 v10, v10, v43, v44
s_waitcnt vmcnt(4)
v_min3_u32 v10, v10, v45, v46
s_waitcnt vmcnt(3)
v_min3_u32 v10, v10, v47, v48
s_waitcnt vmcnt(2)
v_min3_u32 v10, v10, v49, v50
s_waitcnt vmcnt(1)
v_min3_u32 v10, v10, v51, v52
s_waitcnt vmcnt(0)
v_min3_u32 v10, v10, v53, v54
v_min_u32 v10, v10, v55
v_cmp_eq_u32 vcc, 0, v10
s_cbranch_vccz pdone_51
s_sub_u32 s32, s32, 1
s_cmp_gt_i32 s32, 0
s_cbranch_scc1 poll_49
pdone_51:
v_pk_add_f32 v[24:25], v[24:25], v[40:41]
v_pk_add_f32 v[26:27], v[26:27], v[42:43]
v_pk_add_f32 v[28:29], v[28:29], v[44:45]
v_pk_add_f32 v[30:31], v[30:31], v[46:47]
v_pk_add_f32 v[32:33], v[32:33], v[48:49]
v_pk_add_f32 v[34:35], v[34:35], v[50:51]
v_pk_add_f32 v[36:37], v[36:37], v[52:53]
v_pk_add_f32 v[38:39], v[38:39], v[54:55]
v_pk_add_f32 v[24:25], v[24:25], v[32:33]
v_pk_add_f32 v[26:27], v[26:27], v[34:35]
v_pk_add_f32 v[28:29], v[28:29], v[36:37]
v_pk_add_f32 v[30:31], v[30:31], v[38:39]
v_pk_add_f32 v[24:25], v[24:25], v[28:29]
v_pk_add_f32 v[26:27], v[26:27], v[30:31]
v_pk_add_f32 v[24:25], v[24:25], v[26:27]
s_mov_b32 exec_hi, 0xffff
ds_write2_b32 v9, v24, v25 offset1:16
s_mov_b32 exec_hi, -1
v_mul_f32 v5, 0xba800000, v24
v_mul_f32 v25, 0x3a800000, v25
v_fma_f32 v25, -v5, v5, v25
v_max_f32 v25, 0, v25
v_add_f32 v25, 0x3727c5ac, v25
v_rsq_f32 v24, v25
s_nop 0
v_mul_f32 v25, v5, v24
s_lshl_b32 s70, s59, 7
s_sub_u32 s70, s33, s70
v_lshlrev_b32 v10, 1, v0
v_sub_u32 v10, s70, v10
v_readlane_b32 s70, v24, 48
v_readlane_b32 s71, v25, 48
v_cmp_eq_u32 vcc, 0, v10
s_mov_b64 exec, vcc
v_mov_b32 v12, s70
v_mov_b32 v13, s71
s_mov_b64 exec, -1
v_cmp_eq_u32 vcc, 1, v10
s_mov_b64 exec, vcc
v_mov_b32 v14, s70
v_mov_b32 v15, s71
s_mov_b64 exec, -1
fng_48:
ds_write2_b32 v8, v12, v14 offset1:1
ds_write2_b32 v8, v13, v15 offset0:128 offset1:129
v_add_u32 v5, s34, 2
s_mov_b64 exec, 1
ds_write_b32 v3, v5
s_mov_b64 exec, -1
s_setprio 0
s_lshl_b32 s70, s63, 8
s_add_u32 s70, s70, s2
s_cmp_lt_u32 s70, 224
s_cbranch_scc1 fnw_52
fnw_53:
s_and_b32 s70, s2, 7
s_lshl_b32 s70, s70, 13
s_add_u32 s70, s70, 425984
v_lshlrev_b32 v6, 7, v0
v_and_b32 v7, 62, v0
v_lshlrev_b32 v7, 5, v7
s_mov_b32 s72, 1966080
v_mov_b32 v16, 0
v_mov_b32 v17, 0
v_mov_b32 v18, 0
v_mov_b32 v19, 0
v_mov_b32 v20, 0
v_mov_b32 v21, 0
v_mov_b32 v22, 0
v_mov_b32 v23, 0
v_and_b32 v12, 1, v0
v_lshrrev_b32 v13, 3, v0
v_lshl_add_u32 v12, v12, 3, v13
s_lshl1_add_u32 s71, s63, s58
s_lshl_b32 s71, s71, 6
v_lshl_add_u32 v12, v12, 2, s71
v_and_b32 v13, 7, v0
s_lshl_b32 s71, s63, 7
v_lshl_add_u32 v13, v13, 3, s71
s_add_u32 s35, s34, 22
lw_54:
ds_read_b32 v5, v1 offset:0
s_waitcnt lgkmcnt(0)
v_cmp_gt_i32 vcc, s35, v5
s_cbranch_vccz lwd_55
s_sleep 4
s_sub_u32 s32, s32, 1
s_cmp_gt_i32 s32, 0
s_cbranch_scc1 lw_54
lwd_55:
s_setprio 3
s_add_u32 s35, s34, 24
lw_56:
ds_read_b32 v5, v1 offset:0
s_waitcnt lgkmcnt(0)
v_cmp_gt_i32 vcc, s35, v5
s_cbranch_vccz lwd_57
s_sleep 2
s_sub_u32 s32, s32, 1
s_cmp_gt_i32 s32, 0
s_cbranch_scc1 lw_56
lwd_57:
poll_58:
buffer_load_dwordx2 v[8:9], v6, s[24:27], s70 offen sc1
pchk_59:
s_waitcnt vmcnt(0)
v_min_u32 v10, v8, v9
v_cmp_eq_u32 vcc, 0, v10
s_cbranch_vccz pdone_60
s_sub_u32 s32, s32, 1
s_cmp_gt_i32 s32, 0
s_cbranch_scc1 poll_58
pdone_60:
v_mov_b32 v10, v8
s_nop 1
v_max_f32_dpp v10, v10, v10 row_ror:1 row_mask:0xf bank_mask:0xf
s_nop 1
v_max_f32_dpp v10, v10, v10 row_ror:2 row_mask:0xf bank_mask:0xf
s_nop 1
v_max_f32_dpp v10, v10, v10 row_ror:4 row_mask:0xf bank_mask:0xf
s_nop 1
v_max_f32_dpp v10, v10, v10 row_ror:8 row_mask:0xf bank_mask:0xf
v_mov_b32 v11, v10
s_nop 1
v_permlane16_swap_b32 v11, v10
v_max_f32 v10, v10, v11
v_mov_b32 v11, v10
s_nop 1
v_permlane32_swap_b32 v11, v10
v_max_f32 v10, v10, v11
v_cmp_eq_f32 vcc, v10, v8
s_ff1_i32_b64 s68, vcc
s_and_b32 s68, s68, 63
s_lshl_b32 s71, s68, 11
v_add_u32 v7, s71, v7
buffer_load_dwordx4 v[24:27], v7, s[24:27], s72 offen offset:0 sc1
buffer_load_dwordx4 v[28:31], v7, s[24:27], s72 offen offset:16 sc1
buffer_load_dwordx4 v[32:35], v7, s[24:27], s72 offen offset:32 sc1
buffer_load_dwordx4 v[36:39], v7, s[24:27], s72 offen offset:48 sc1
v_readlane_b32 s33, v9, s68
v_readlane_b32 s67, v8, s68
s_nop 0
v_mov_b32 v11, s33
ds_write_b32 v16, v11 offset:32
v_add_u32 v5, s34, 3
s_mov_b64 exec, 1
ds_write_b32 v3, v5
s_mov_b64 exec, -1
s_sub_u32 s33, s33, 1
s_and_b32 s33, s33, 2047
s_cmp_lt_u32 s2, 224
s_cbranch_scc0 fnd_61
s_branch pchk_63
poll_62:
buffer_load_dwordx4 v[24:27], v7, s[24:27], s72 offen offset:0 sc1
buffer_load_dwordx4 v[28:31], v7, s[24:27], s72 offen offset:16 sc1
buffer_load_dwordx4 v[32:35], v7, s[24:27], s72 offen offset:32 sc1
buffer_load_dwordx4 v[36:39], v7, s[24:27], s72 offen offset:48 sc1
pchk_63:
s_waitcnt vmcnt(3)
v_min3_u32 v10, v24, v25, v26
s_waitcnt vmcnt(2)
v_min3_u32 v10, v10, v27, v28
v_min3_u32 v10, v10, v29, v30
s_waitcnt vmcnt(1)
v_min3_u32 v10, v10, v31, v32
v_min3_u32 v10, v10, v33, v34
s_waitcnt vmcnt(0)
v_min3_u32 v10, v10, v35, v36
v_min3_u32 v10, v10, v37, v38
v_min_u32 v10, v10, v39
v_cmp_eq_u32 vcc, 0, v10
s_cbranch_vccz pdone_64
s_sub_u32 s32, s32, 1
s_cmp_gt_i32 s32, 0
s_cbranch_scc1 poll_62
pdone_64:
v_dot2c_f32_bf16 v16, v24, v56
v_dot2c_f32_bf16 v17, v24, v57
v_dot2c_f32_bf16 v18, v24, v58
v_dot2c_f32_bf16 v19, v24, v59
v_dot2c_f32_bf16 v20, v24, v60
v_dot2c_f32_bf16 v21, v24, v61
v_dot2c_f32_bf16 v22, v24, v62
v_dot2c_f32_bf16 v23, v24, v63
v_dot2c_f32_bf16 v16, v25, v64
v_dot2c_f32_bf16 v17, v25, v65
v_dot2c_f32_bf16 v18, v25, v66
v_dot2c_f32_bf16 v19, v25, v67
v_dot2c_f32_bf16 v20, v25, v68
v_dot2c_f32_bf16 v21, v25, v69
v_dot2c_f32_bf16 v22, v25, v70
v_dot2c_f32_bf16 v23, v25, v71
v_dot2c_f32_bf16 v16, v26, v72
v_dot2c_f32_bf16 v17, v26, v73
v_dot2c_f32_bf16 v18, v26, v74
v_dot2c_f32_bf16 v19, v26, v75
v_dot2c_f32_bf16 v20, v26, v76
v_dot2c_f32_bf16 v21, v26, v77
v_dot2c_f32_bf16 v22, v26, v78
v_dot2c_f32_bf16 v23, v26, v79
v_dot2c_f32_bf16 v16, v27, v80
v_dot2c_f32_bf16 v17, v27, v81
v_dot2c_f32_bf16 v18, v27, v82
v_dot2c_f32_bf16 v19, v27, v83
v_dot2c_f32_bf16 v20, v27, v84
v_dot2c_f32_bf16 v21, v27, v85
v_dot2c_f32_bf16 v22, v27, v86
v_dot2c_f32_bf16 v23, v27, v87
v_dot2c_f32_bf16 v16, v28, v88
v_dot2c_f32_bf16 v17, v28, v89
v_dot2c_f32_bf16 v18, v28, v90
v_dot2c_f32_bf16 v19, v28, v91
v_dot2c_f32_bf16 v20, v28, v92
v_dot2c_f32_bf16 v21, v28, v93
v_dot2c_f32_bf16 v22, v28, v94
v_dot2c_f32_bf16 v23, v28, v95
v_dot2c_f32_bf16 v16, v29, v96
v_dot2c_f32_bf16 v17, v29, v97
v_dot2c_f32_bf16 v18, v29, v98
v_dot2c_f32_bf16 v19, v29, v99
v_dot2c_f32_bf16 v20, v29, v100
v_dot2c_f32_bf16 v21, v29, v101
v_dot2c_f32_bf16 v22, v29, v102
v_dot2c_f32_bf16 v23, v29, v103
v_dot2c_f32_bf16 v16, v30, v104
v_dot2c_f32_bf16 v17, v30, v105
v_dot2c_f32_bf16 v18, v30, v106
v_dot2c_f32_bf16 v19, v30, v107
v_dot2c_f32_bf16 v20, v30, v108
v_dot2c_f32_bf16 v21, v30, v109
v_dot2c_f32_bf16 v22, v30, v110
v_dot2c_f32_bf16 v23, v30, v111
v_dot2c_f32_bf16 v16, v31, v112
v_dot2c_f32_bf16 v17, v31, v113
v_dot2c_f32_bf16 v18, v31, v114
v_dot2c_f32_bf16 v19, v31, v115
v_dot2c_f32_bf16 v20, v31, v116
v_dot2c_f32_bf16 v21, v31, v117
v_dot2c_f32_bf16 v22, v31, v118
v_dot2c_f32_bf16 v23, v31, v119
v_dot2c_f32_bf16 v16, v32, v120
v_dot2c_f32_bf16 v17, v32, v121
v_dot2c_f32_bf16 v18, v32, v122
v_dot2c_f32_bf16 v19, v32, v123
v_dot2c_f32_bf16 v20, v32, v124
v_dot2c_f32_bf16 v21, v32, v125
v_dot2c_f32_bf16 v22, v32, v126
v_dot2c_f32_bf16 v23, v32, v127
v_dot2c_f32_bf16 v16, v33, v128
v_dot2c_f32_bf16 v17, v33, v129
v_dot2c_f32_bf16 v18, v33, v130
v_dot2c_f32_bf16 v19, v33, v131
v_dot2c_f32_bf16 v20, v33, v132
v_dot2c_f32_bf16 v21, v33, v133
v_dot2c_f32_bf16 v22, v33, v134
v_dot2c_f32_bf16 v23, v33, v135
v_dot2c_f32_bf16 v16, v34, v136
v_dot2c_f32_bf16 v17, v34, v137
v_dot2c_f32_bf16 v18, v34, v138
v_dot2c_f32_bf16 v19, v34, v139
v_dot2c_f32_bf16 v20, v34, v140
v_dot2c_f32_bf16 v21, v34, v141
v_dot2c_f32_bf16 v22, v34, v142
v_dot2c_f32_bf16 v23, v34, v143
v_dot2c_f32_bf16 v16, v35, v144
v_dot2c_f32_bf16 v17, v35, v145
v_dot2c_f32_bf16 v18, v35, v146
v_dot2c_f32_bf16 v19, v35, v147
v_dot2c_f32_bf16 v20, v35, v148
v_dot2c_f32_bf16 v21, v35, v149
v_dot2c_f32_bf16 v22, v35, v150
v_dot2c_f32_bf16 v23, v35, v151
v_dot2c_f32_bf16 v16, v36, v152
v_dot2c_f32_bf16 v17, v36, v153
v_dot2c_f32_bf16 v18, v36, v154
v_dot2c_f32_bf16 v19, v36, v155
v_dot2c_f32_bf16 v20, v36, v156
v_dot2c_f32_bf16 v21, v36, v157
v_dot2c_f32_bf16 v22, v36, v158
v_dot2c_f32_bf16 v23, v36, v159
v_dot2c_f32_bf16 v16, v37, v160
v_dot2c_f32_bf16 v17, v37, v161
v_dot2c_f32_bf16 v18, v37, v162
v_dot2c_f32_bf16 v19, v37, v163
v_dot2c_f32_bf16 v20, v37, v164
v_dot2c_f32_bf16 v21, v37, v165
v_dot2c_f32_bf16 v22, v37, v166
v_dot2c_f32_bf16 v23, v37, v167
v_dot2c_f32_bf16 v16, v38, v168
v_dot2c_f32_bf16 v17, v38, v169
v_dot2c_f32_bf16 v18, v38, v170
v_dot2c_f32_bf16 v19, v38, v171
v_dot2c_f32_bf16 v20, v38, v172
v_dot2c_f32_bf16 v21, v38, v173
v_dot2c_f32_bf16 v22, v38, v174
v_dot2c_f32_bf16 v23, v38, v175
v_dot2c_f32_bf16 v16, v39, v176
v_dot2c_f32_bf16 v17, v39, v177
v_dot2c_f32_bf16 v18, v39, v178
v_dot2c_f32_bf16 v19, v39, v179
v_dot2c_f32_bf16 v20, v39, v180
v_dot2c_f32_bf16 v21, v39, v181
v_dot2c_f32_bf16 v22, v39, v182
v_dot2c_f32_bf16 v23, v39, v183
v_permlane32_swap_b32 v16, v20
v_permlane32_swap_b32 v17, v21
v_permlane32_swap_b32 v18, v22
v_permlane32_swap_b32 v19, v23
v_pk_add_f32 v[16:17], v[16:17], v[20:21]
v_pk_add_f32 v[18:19], v[18:19], v[22:23]
s_nop 1
v_permlane16_swap_b32 v16, v18
v_permlane16_swap_b32 v17, v19
v_pk_add_f32 v[16:17], v[16:17], v[18:19]
s_nop 1
v_add_f32_dpp v10, v16, v16 row_ror:8 row_mask:0xf bank_mask:0x3
s_nop 1
v_add_f32_dpp v10, v17, v17 row_ror:8 row_mask:0xf bank_mask:0xc
s_nop 1
v_add_f32_dpp v10, v10, v10 quad_perm:[2,3,0,1] row_mask:0xf bank_mask:0xf
s_nop 1
v_add_f32_dpp v10, v10, v10 row_shl:4 row_mask:0xf bank_mask:0x5
s_mov_b32 exec_lo, 0x03030303
s_mov_b32 exec_hi, 0x03030303
v_max_u32 v10, 1, v10
ds_write_b32 v12, v10 offset:256
s_mov_b64 exec, -1
s_lshl_b32 s70, s64, 12
s_lshl_b32 s71, s58, 11
s_add_u32 s70, s70, s71
s_add_u32 s70, s70, 1048576
v_mov_b32 v16, 0
v_mov_b32 v17, 0
v_mov_b32 v18, 0
v_mov_b32 v19, 0
v_mov_b32 v20, 0
v_mov_b32 v21, 0
v_mov_b32 v22, 0
v_mov_b32 v23, 0
v_lshlrev_b32 v6, 4, v0
poll_65:
ds_read2_b64 v[8:11], v13 offset0:32 offset1:40
pchk_66:
s_waitcnt lgkmcnt(0)
v_min3_u32 v12, v8, v9, v10
v_min_u32 v12, v12, v11
v_cmp_eq_u32 vcc, 0, v12
s_cbranch_vccz pdone_67
s_sub_u32 s32, s32, 1
s_cmp_gt_i32 s32, 0
s_cbranch_scc1 poll_65
pdone_67:
v_mul_f32 v12, 0xbfb8aa3b, v8
v_mul_f32 v13, 0xbfb8aa3b, v9
v_exp_f32 v12, v12
v_exp_f32 v13, v13
v_pk_mul_f32 v[8:9], v[8:9], v[10:11]
v_add_f32 v12, 1.0, v12
v_add_f32 v13, 1.0, v13
v_rcp_f32 v12, v12
v_rcp_f32 v13, v13
s_nop 0
v_pk_mul_f32 v[8:9], v[8:9], v[12:13]
v_cvt_pk_bf16_f32 v8, v8, v9
s_nop 0
v_readlane_b32 s72, v8, 0
v_readlane_b32 s73, v8, 1
v_readlane_b32 s74, v8, 2
v_readlane_b32 s75, v8, 3
v_readlane_b32 s76, v8, 4
v_readlane_b32 s77, v8, 5
v_readlane_b32 s78, v8, 6
v_readlane_b32 s79, v8, 7
v_dot2c_f32_bf16 v16, s72, v184
v_dot2c_f32_bf16 v17, s72, v185
v_dot2c_f32_bf16 v18, s72, v186
v_dot2c_f32_bf16 v19, s72, v187
v_dot2c_f32_bf16 v20, s72, v188
v_dot2c_f32_bf16 v21, s72, v189
v_dot2c_f32_bf16 v22, s72, v190
v_dot2c_f32_bf16 v23, s72, v191
v_dot2c_f32_bf16 v16, s73, v192
v_dot2c_f32_bf16 v17, s73, v193
v_dot2c_f32_bf16 v18, s73, v194
v_dot2c_f32_bf16 v19, s73, v195
v_dot2c_f32_bf16 v20, s73, v196
v_dot2c_f32_bf16 v21, s73, v197
v_dot2c_f32_bf16 v22, s73, v198
v_dot2c_f32_bf16 v23, s73, v199
v_dot2c_f32_bf16 v16, s74, v200
v_dot2c_f32_bf16 v17, s74, v201
v_dot2c_f32_bf16 v18, s74, v202
v_dot2c_f32_bf16 v19, s74, v203
v_dot2c_f32_bf16 v20, s74, v204
v_dot2c_f32_bf16 v21, s74, v205
v_dot2c_f32_bf16 v22, s74, v206
v_dot2c_f32_bf16 v23, s74, v207
v_dot2c_f32_bf16 v16, s75, v208
v_dot2c_f32_bf16 v17, s75, v209
v_dot2c_f32_bf16 v18, s75, v210
v_dot2c_f32_bf16 v19, s75, v211
v_dot2c_f32_bf16 v20, s75, v212
v_dot2c_f32_bf16 v21, s75, v213
v_dot2c_f32_bf16 v22, s75, v214
v_dot2c_f32_bf16 v23, s75, v215
v_dot2c_f32_bf16 v16, s76, v216
v_dot2c_f32_bf16 v17, s76, v217
v_dot2c_f32_bf16 v18, s76, v218
v_dot2c_f32_bf16 v19, s76, v219
v_dot2c_f32_bf16 v20, s76, v220
v_dot2c_f32_bf16 v21, s76, v221
v_dot2c_f32_bf16 v22, s76, v222
v_dot2c_f32_bf16 v23, s76, v223
v_dot2c_f32_bf16 v16, s77, v224
v_dot2c_f32_bf16 v17, s77, v225
v_dot2c_f32_bf16 v18, s77, v226
v_dot2c_f32_bf16 v19, s77, v227
v_dot2c_f32_bf16 v20, s77, v228
v_dot2c_f32_bf16 v21, s77, v229
v_dot2c_f32_bf16 v22, s77, v230
v_dot2c_f32_bf16 v23, s77, v231
v_dot2c_f32_bf16 v16, s78, v232
v_dot2c_f32_bf16 v17, s78, v233
v_dot2c_f32_bf16 v18, s78, v234
v_dot2c_f32_bf16 v19, s78, v235
v_dot2c_f32_bf16 v20, s78, v236
v_dot2c_f32_bf16 v21, s78, v237
v_dot2c_f32_bf16 v22, s78, v238
v_dot2c_f32_bf16 v23, s78, v239
v_dot2c_f32_bf16 v16, s79, v240
v_dot2c_f32_bf16 v17, s79, v241
v_dot2c_f32_bf16 v18, s79, v242
v_dot2c_f32_bf16 v19, s79, v243
v_dot2c_f32_bf16 v20, s79, v244
v_dot2c_f32_bf16 v21, s79, v245
v_dot2c_f32_bf16 v22, s79, v246
v_dot2c_f32_bf16 v23, s79, v247
v_max_u32 v16, 1, v16
v_max_u32 v17, 1, v17
v_max_u32 v18, 1, v18
v_max_u32 v19, 1, v19
v_max_u32 v20, 1, v20
v_max_u32 v21, 1, v21
v_max_u32 v22, 1, v22
v_max_u32 v23, 1, v23
buffer_store_dwordx4 v[16:19], v6, s[24:27], s70 offen offset:0 sc1
buffer_store_dwordx4 v[20:23], v6, s[24:27], s70 offen offset:1024 sc1
fnd_61:
s_cmp_eq_u32 s58, 0
s_cbranch_scc0 fnr_68
v_min_u32 v6, 55, v0
v_lshlrev_b32 v6, 12, v6
s_lshr_b32 s70, s65, 7
s_and_b32 s71, s65, 1
s_lshl1_add_u32 s70, s70, s71
s_lshl_b32 s70, s70, 10
s_bfe_u32 s71, s65, 0x60001
s_lshl4_add_u32 s70, s71, s70
s_add_u32 s72, s70, 1048576
s_add_u32 s73, s70, 1277952
s_add_u32 s74, s70, 1507328
s_add_u32 s75, s70, 1736704
s_lshl_b32 s70, s68, 12
s_lshl4_add_u32 s70, s65, s70
s_add_u32 s76, s70, 2097152
v_mov_b32 v12, s67
v_mul_f32 v12, 0xbfb8aa3b, v12
v_exp_f32 v12, v12
v_cmp_gt_u32 vcc, 56, v0
v_add_f32 v12, 1.0, v12
v_rcp_f32 v12, v12
s_lshl_b32 s70, s33, 11
s_lshl3_add_u32 s70, s65, s70
s_lshl_b32 s71, s65, 7
s_add_u32 s71, s71, 393216
v_cndmask_b32 v12, 0, v12, vcc
s_waitcnt vmcnt(0)
poll_70:
buffer_load_dwordx4 v[40:43], off, s[24:27], s76 sc1
buffer_load_dwordx4 v[24:27], v6, s[24:27], s72 offen sc1
buffer_load_dwordx4 v[28:31], v6, s[24:27], s73 offen sc1
buffer_load_dwordx4 v[32:35], v6, s[24:27], s74 offen sc1
buffer_load_dwordx4 v[36:39], v6, s[24:27], s75 offen sc1
pchk_71:
s_waitcnt vmcnt(3)
v_min3_u32 v10, v24, v25, v26
s_waitcnt vmcnt(2)
v_min3_u32 v10, v10, v27, v28
v_min3_u32 v10, v10, v29, v30
s_waitcnt vmcnt(1)
v_min3_u32 v10, v10, v31, v32
v_min3_u32 v10, v10, v33, v34
s_waitcnt vmcnt(0)
v_min3_u32 v10, v10, v35, v36
v_min3_u32 v10, v10, v37, v38
v_min3_u32 v10, v10, v39, v40
v_min3_u32 v10, v10, v41, v42
v_min_u32 v10, v10, v43
v_cmp_eq_u32 vcc, 0, v10
s_cbranch_vccz pdone_72
s_sub_u32 s32, s32, 1
s_cmp_gt_i32 s32, 0
s_cbranch_scc1 poll_70
pdone_72:
v_pk_add_f32 v[24:25], v[24:25], v[32:33]
v_pk_add_f32 v[26:27], v[26:27], v[34:35]
v_pk_add_f32 v[28:29], v[28:29], v[36:37]
v_pk_add_f32 v[30:31], v[30:31], v[38:39]
v_pk_add_f32 v[24:25], v[24:25], v[28:29]
v_pk_add_f32 v[26:27], v[26:27], v[30:31]
v_pk_mul_f32 v[24:25], v[24:25], v[12:13] op_sel:[0,0] op_sel_hi:[1,0]
v_pk_mul_f32 v[26:27], v[26:27], v[12:13] op_sel:[0,0] op_sel_hi:[1,0]
s_nop 0
v_add_f32_dpp v24, v24, v24 row_ror:1 row_mask:0xf bank_mask:0xf
v_add_f32_dpp v25, v25, v25 row_ror:1 row_mask:0xf bank_mask:0xf
v_add_f32_dpp v26, v26, v26 row_ror:1 row_mask:0xf bank_mask:0xf
v_add_f32_dpp v27, v27, v27 row_ror:1 row_mask:0xf bank_mask:0xf
v_add_f32_dpp v24, v24, v24 row_ror:2 row_mask:0xf bank_mask:0xf
v_add_f32_dpp v25, v25, v25 row_ror:2 row_mask:0xf bank_mask:0xf
v_add_f32_dpp v26, v26, v26 row_ror:2 row_mask:0xf bank_mask:0xf
v_add_f32_dpp v27, v27, v27 row_ror:2 row_mask:0xf bank_mask:0xf
v_add_f32_dpp v24, v24, v24 row_ror:4 row_mask:0xf bank_mask:0xf
v_add_f32_dpp v25, v25, v25 row_ror:4 row_mask:0xf bank_mask:0xf
v_add_f32_dpp v26, v26, v26 row_ror:4 row_mask:0xf bank_mask:0xf
v_add_f32_dpp v27, v27, v27 row_ror:4 row_mask:0xf bank_mask:0xf
v_add_f32_dpp v24, v24, v24 row_ror:8 row_mask:0xf bank_mask:0xf
v_add_f32_dpp v25, v25, v25 row_ror:8 row_mask:0xf bank_mask:0xf
v_add_f32_dpp v26, v26, v26 row_ror:8 row_mask:0xf bank_mask:0xf
v_add_f32_dpp v27, v27, v27 row_ror:8 row_mask:0xf bank_mask:0xf
v_mov_b32 v28, v24
v_mov_b32 v29, v25
v_mov_b32 v30, v26
v_mov_b32 v31, v27
v_permlane16_swap_b32 v28, v24
v_permlane16_swap_b32 v29, v25
v_permlane16_swap_b32 v30, v26
v_permlane16_swap_b32 v31, v27
v_add_f32 v24, v24, v28
v_add_f32 v25, v25, v29
v_add_f32 v26, v26, v30
v_add_f32 v27, v27, v31
v_mov_b32 v28, v24
v_mov_b32 v29, v25
v_mov_b32 v30, v26
v_mov_b32 v31, v27
v_permlane32_swap_b32 v28, v24
v_permlane32_swap_b32 v29, v25
v_permlane32_swap_b32 v30, v26
v_permlane32_swap_b32 v31, v27
v_add_f32 v24, v24, v28
v_add_f32 v25, v25, v29
v_add_f32 v26, v26, v30
v_add_f32 v27, v27, v31
v_pk_add_f32 v[24:25], v[24:25], v[40:41]
v_pk_add_f32 v[26:27], v[26:27], v[42:43]
v_cvt_pk_bf16_f32 v8, v24, v25
v_cvt_pk_bf16_f32 v9, v26, v27
s_mov_b64 exec, 1
s_cmp_eq_u32 s63, 0
s_cbranch_scc1 fl0_69
buffer_store_dwordx2 v[8:9], off, s[28:31], s70
s_mov_b64 exec, -1
s_branch L_end
fl0_69:
v_max_u32 v8, 1, v8
v_max_u32 v9, 1, v9
buffer_store_dwordx2 v[8:9], off, s[24:27], s71 sc1
s_mov_b64 exec, -1
s_waitcnt vmcnt(0)
fnr_68:
s_cmp_eq_u32 s63, 0
s_cbranch_scc0 L_end
v_add_u32 v5, s34, 4
s_mov_b64 exec, 1
ds_write_b32 v3, v5
s_mov_b64 exec, -1
v_and_b32 v6, 48, v0
v_lshlrev_b32 v6, 3, v6
s_lshl_b32 s70, s59, 11
s_add_u32 s70, s70, 393216
s_add_u32 s35, s34, 4
lw_73:
ds_read_b32 v5, v2 offset:24
s_waitcnt lgkmcnt(0)
v_cmp_gt_i32 vcc, s35, v5
s_cbranch_vccz lwd_74
s_sleep 2
s_sub_u32 s32, s32, 1
s_cmp_gt_i32 s32, 0
s_cbranch_scc1 lw_73
lwd_74:
poll_75:
buffer_load_dwordx2 v[8:9], v6, s[24:27], s70 offen offset:0 sc1
buffer_load_dwordx2 v[10:11], v6, s[24:27], s70 offen offset:512 sc1
buffer_load_dwordx2 v[12:13], v6, s[24:27], s70 offen offset:1024 sc1
buffer_load_dwordx2 v[14:15], v6, s[24:27], s70 offen offset:1536 sc1
pchk_76:
s_waitcnt vmcnt(2)
v_min3_u32 v7, v8, v9, v10
s_waitcnt vmcnt(1)
v_min3_u32 v7, v7, v11, v12
s_waitcnt vmcnt(0)
v_min3_u32 v7, v7, v13, v14
v_min_u32 v7, v7, v15
v_cmp_eq_u32 vcc, 0, v7
s_cbranch_vccz pdone_77
s_sub_u32 s32, s32, 1
s_cmp_gt_i32 s32, 0
s_cbranch_scc1 poll_75
pdone_77:
s_mov_b32 s63, 1
s_mov_b32 s34, 32
s_add_u32 s24, s24, 2359296
s_addc_u32 s25, s25, 0
s_mov_b32 s26, 2359296
s_mov_b32 s70, 131072
s_branch ftop_38
fst_41:
s_lshl4_add_u32 s70, s59, s60
s_lshl1_add_u32 s70, s70, s58
s_lshl_b32 s70, s70, 13
v_lshrrev_b32 v7, 4, v0
v_and_b32 v8, 15, v0
v_lshlrev_b32 v8, 4, v8
v_lshl_add_u32 v8, v7, 11, v8
buffer_load_dwordx4 v[24:27], v8, s[8:11], s70 offen offset:0
buffer_load_dwordx4 v[28:31], v8, s[8:11], s70 offen offset:256
buffer_load_dwordx4 v[32:35], v8, s[8:11], s70 offen offset:512
buffer_load_dwordx4 v[36:39], v8, s[8:11], s70 offen offset:768
buffer_load_dwordx4 v[40:43], v8, s[8:11], s70 offen offset:1024
buffer_load_dwordx4 v[44:47], v8, s[8:11], s70 offen offset:1280
buffer_load_dwordx4 v[48:51], v8, s[8:11], s70 offen offset:1536
buffer_load_dwordx4 v[52:55], v8, s[8:11], s70 offen offset:1792
s_cmp_eq_u32 s58, 1
s_cbranch_scc0 fz_78
v_lshlrev_b32 v14, 4, v0
v_mov_b32 v56, 0
v_mov_b32 v57, 0
v_mov_b32 v58, 0
v_mov_b32 v59, 0
s_mul_i32 s70, s2, 17408
s_add_u32 s70, s70, 327680
buffer_store_dwordx4 v[56:59], v14, s[24:27], s70 offen offset:0 sc1
buffer_store_dwordx4 v[56:59], v14, s[24:27], s70 offen offset:1024 sc1
buffer_store_dwordx4 v[56:59], v14, s[24:27], s70 offen offset:2048 sc1
buffer_store_dwordx4 v[56:59], v14, s[24:27], s70 offen offset:3072 sc1
s_add_u32 s70, s70, 4096
buffer_store_dwordx4 v[56:59], v14, s[24:27], s70 offen offset:0 sc1
buffer_store_dwordx4 v[56:59], v14, s[24:27], s70 offen offset:1024 sc1
buffer_store_dwordx4 v[56:59], v14, s[24:27], s70 offen offset:2048 sc1
buffer_store_dwordx4 v[56:59], v14, s[24:27], s70 offen offset:3072 sc1
s_add_u32 s70, s70, 4096
buffer_store_dwordx4 v[56:59], v14, s[24:27], s70 offen offset:0 sc1
buffer_store_dwordx4 v[56:59], v14, s[24:27], s70 offen offset:1024 sc1
buffer_store_dwordx4 v[56:59], v14, s[24:27], s70 offen offset:2048 sc1
buffer_store_dwordx4 v[56:59], v14, s[24:27], s70 offen offset:3072 sc1
s_add_u32 s70, s70, 4096
buffer_store_dwordx4 v[56:59], v14, s[24:27], s70 offen offset:0 sc1
buffer_store_dwordx4 v[56:59], v14, s[24:27], s70 offen offset:1024 sc1
buffer_store_dwordx4 v[56:59], v14, s[24:27], s70 offen offset:2048 sc1
buffer_store_dwordx4 v[56:59], v14, s[24:27], s70 offen offset:3072 sc1
s_add_u32 s70, s70, 4096
buffer_store_dwordx4 v[56:59], v14, s[24:27], s70 offen offset:0 sc1
fz_78:
v_lshlrev_b32 v9, 4, v1
v_mov_b32 v10, 0
v_mov_b32 v11, 0
s_waitcnt vmcnt(7)
v_dot2c_f32_bf16 v10, s69, v24
v_dot2c_f32_bf16 v11, v24, v24
v_dot2c_f32_bf16 v10, s69, v25
v_dot2c_f32_bf16 v11, v25, v25
v_dot2c_f32_bf16 v10, s69, v26
v_dot2c_f32_bf16 v11, v26, v26
v_dot2c_f32_bf16 v10, s69, v27
v_dot2c_f32_bf16 v11, v27, v27
s_waitcnt vmcnt(6)
v_dot2c_f32_bf16 v10, s69, v28
v_dot2c_f32_bf16 v11, v28, v28
v_dot2c_f32_bf16 v10, s69, v29
v_dot2c_f32_bf16 v11, v29, v29
v_dot2c_f32_bf16 v10, s69, v30
v_dot2c_f32_bf16 v11, v30, v30
v_dot2c_f32_bf16 v10, s69, v31
v_dot2c_f32_bf16 v11, v31, v31
s_waitcnt vmcnt(5)
v_dot2c_f32_bf16 v10, s69, v32
v_dot2c_f32_bf16 v11, v32, v32
v_dot2c_f32_bf16 v10, s69, v33
v_dot2c_f32_bf16 v11, v33, v33
v_dot2c_f32_bf16 v10, s69, v34
v_dot2c_f32_bf16 v11, v34, v34
v_dot2c_f32_bf16 v10, s69, v35
v_dot2c_f32_bf16 v11, v35, v35
s_waitcnt vmcnt(4)
v_dot2c_f32_bf16 v10, s69, v36
v_dot2c_f32_bf16 v11, v36, v36
v_dot2c_f32_bf16 v10, s69, v37
v_dot2c_f32_bf16 v11, v37, v37
v_dot2c_f32_bf16 v10, s69, v38
v_dot2c_f32_bf16 v11, v38, v38
v_dot2c_f32_bf16 v10, s69, v39
v_dot2c_f32_bf16 v11, v39, v39
s_waitcnt vmcnt(3)
v_dot2c_f32_bf16 v10, s69, v40
v_dot2c_f32_bf16 v11, v40, v40
v_dot2c_f32_bf16 v10, s69, v41
v_dot2c_f32_bf16 v11, v41, v41
v_dot2c_f32_bf16 v10, s69, v42
v_dot2c_f32_bf16 v11, v42, v42
v_dot2c_f32_bf16 v10, s69, v43
v_dot2c_f32_bf16 v11, v43, v43
s_waitcnt vmcnt(2)
v_dot2c_f32_bf16 v10, s69, v44
v_dot2c_f32_bf16 v11, v44, v44
v_dot2c_f32_bf16 v10, s69, v45
v_dot2c_f32_bf16 v11, v45, v45
v_dot2c_f32_bf16 v10, s69, v46
v_dot2c_f32_bf16 v11, v46, v46
v_dot2c_f32_bf16 v10, s69, v47
v_dot2c_f32_bf16 v11, v47, v47
s_waitcnt vmcnt(1)
v_dot2c_f32_bf16 v10, s69, v48
v_dot2c_f32_bf16 v11, v48, v48
v_dot2c_f32_bf16 v10, s69, v49
v_dot2c_f32_bf16 v11, v49, v49
v_dot2c_f32_bf16 v10, s69, v50
v_dot2c_f32_bf16 v11, v50, v50
v_dot2c_f32_bf16 v10, s69, v51
v_dot2c_f32_bf16 v11, v51, v51
s_waitcnt vmcnt(0)
v_dot2c_f32_bf16 v10, s69, v52
v_dot2c_f32_bf16 v11, v52, v52
v_dot2c_f32_bf16 v10, s69, v53
v_dot2c_f32_bf16 v11, v53, v53
v_dot2c_f32_bf16 v10, s69, v54
v_dot2c_f32_bf16 v11, v54, v54
v_dot2c_f32_bf16 v10, s69, v55
v_dot2c_f32_bf16 v11, v55, v55
s_nop 1
v_add_f32_dpp v10, v10, v10 row_ror:1 row_mask:0xf bank_mask:0xf
v_add_f32_dpp v11, v11, v11 row_ror:1 row_mask:0xf bank_mask:0xf
s_nop 0
v_add_f32_dpp v10, v10, v10 row_ror:2 row_mask:0xf bank_mask:0xf
v_add_f32_dpp v11, v11, v11 row_ror:2 row_mask:0xf bank_mask:0xf
s_nop 0
v_add_f32_dpp v10, v10, v10 row_ror:4 row_mask:0xf bank_mask:0xf
v_add_f32_dpp v11, v11, v11 row_ror:4 row_mask:0xf bank_mask:0xf
s_nop 0
v_add_f32_dpp v10, v10, v10 row_ror:8 row_mask:0xf bank_mask:0xf
v_add_f32_dpp v11, v11, v11 row_ror:8 row_mask:0xf bank_mask:0xf
v_mul_f32 v5, 0xba800000, v10
v_mul_f32 v11, 0x3a800000, v11
v_fma_f32 v11, -v5, v5, v11
v_max_f32 v11, 0, v11
v_add_f32 v11, 0x3727c5ac, v11
v_rsq_f32 v10, v11
s_nop 0
v_mul_f32 v11, v5, v10
v_max_u32 v11, 1, v11
s_lshl_b32 s70, s60, 7
s_add_u32 s70, s70, s76
s_lshl_b32 s73, s58, 5
s_add_u32 s70, s70, s73
v_lshlrev_b32 v7, 3, v7
s_add_u32 s35, s34, 5
lw_79:
ds_read_b32 v5, v2 offset:16
s_waitcnt lgkmcnt(0)
v_cmp_gt_i32 vcc, s35, v5
s_cbranch_vccz lwd_80
s_sleep 4
s_sub_u32 s32, s32, 1
s_cmp_gt_i32 s32, 0
s_cbranch_scc1 lw_79
lwd_80:
poll_81:
buffer_load_dword v12, v9, s[4:7], 0 offen sc1
pchk_82:
s_waitcnt vmcnt(0)
v_cmp_gt_u32 vcc, 64, v12
s_cbranch_vccz pdone_83
s_sleep 16
s_sub_u32 s32, s32, 1
s_cmp_gt_i32 s32, 0
s_cbranch_scc1 poll_81
pdone_83:
s_and_b32 s73, s2, 7
s_lshl_b32 s73, s73, 7
s_add_u32 s73, s73, 294912
v_mov_b32 v14, 1
s_mov_b32 exec_lo, s58
s_mov_b32 exec_hi, 0
s_waitcnt vmcnt(0)
buffer_atomic_add v14, off, s[24:27], s73 sc1
s_mov_b64 exec, -1
s_mov_b32 exec_lo, 0x10001
s_mov_b32 exec_hi, 0x10001
buffer_store_dwordx2 v[10:11], v7, s[24:27], s70 offen sc1
s_mov_b64 exec, -1
s_branch fsb_42
fg_43:
s_lshl1_add_u32 s35, s2, s58
s_lshl_b32 s35, s35, 12
s_add_u32 s44, s40, s35
s_addc_u32 s45, s41, 0
s_mov_b32 s35, 4
ft_84:
s_load_dwordx2 s[42:43], s[44:45], 60
s_load_dwordx2 s[42:43], s[44:45], 188
s_load_dwordx2 s[42:43], s[44:45], 316
s_load_dwordx2 s[42:43], s[44:45], 444
s_load_dwordx2 s[42:43], s[44:45], 572
s_load_dwordx2 s[42:43], s[44:45], 700
s_load_dwordx2 s[42:43], s[44:45], 828
s_load_dwordx2 s[42:43], s[44:45], 956
s_add_u32 s44, s44, 1024
s_addc_u32 s45, s45, 0
s_sub_u32 s35, s35, 1
s_cmp_eq_u32 s35, 0
s_cbranch_scc0 ft_84
v_and_b32 v10, 7, v0
v_lshlrev_b32 v10, 7, v10
s_mov_b32 s70, 294912
s_add_u32 s35, s34, 10
lw_85:
ds_read_b32 v5, v2 offset:16
s_waitcnt lgkmcnt(0)
v_cmp_gt_i32 vcc, s35, v5
s_cbranch_vccz lwd_86
s_sleep 4
s_sub_u32 s32, s32, 1
s_cmp_gt_i32 s32, 0
s_cbranch_scc1 lw_85
lwd_86:
poll_87:
buffer_load_dword v12, v10, s[24:27], s70 offen sc1
pchk_88:
s_waitcnt vmcnt(0)
v_cmp_gt_u32 vcc, 32, v12
s_cbranch_vccz pdone_89
s_sleep 16
s_sub_u32 s32, s32, 1
s_cmp_gt_i32 s32, 0
s_cbranch_scc1 poll_87
pdone_89:
s_branch fg_44
fnw_52:
v_lshlrev_b32 v7, 4, v0
s_mov_b32 s72, 0x05040100
s_mov_b32 s73, 0x07060302
s_add_u32 s35, s34, 16
lw_90:
ds_read_b32 v5, v2 offset:16
s_waitcnt lgkmcnt(0)
v_cmp_gt_i32 vcc, s35, v5
s_cbranch_vccz lwd_91
s_sleep 4
s_sub_u32 s32, s32, 1
s_cmp_gt_i32 s32, 0
s_cbranch_scc1 lw_90
lwd_91:
v_lshrrev_b32 v8, 2, v0
v_and_b32 v9, 3, v0
v_lshl_add_u32 v8, v8, 3, v9
v_mul_u32_u24 v8, 7168, v8
s_add_u32 s70, s77, 0
buffer_load_dword v10, v8, s[16:19], s70 offen
v_lshrrev_b32 v8, 2, v0
v_and_b32 v9, 3, v0
v_lshl_add_u32 v8, v8, 3, v9
v_mul_u32_u24 v8, 7168, v8
s_add_u32 s70, s77, 917504
buffer_load_dword v10, v8, s[16:19], s70 offen
s_add_u32 s35, s34, 17
lw_92:
ds_read_b32 v5, v2 offset:16
s_waitcnt lgkmcnt(0)
v_cmp_gt_i32 vcc, s35, v5
s_cbranch_vccz lwd_93
s_sleep 4
s_sub_u32 s32, s32, 1
s_cmp_gt_i32 s32, 0
s_cbranch_scc1 lw_92
lwd_93:
s_mov_b32 s70, 0
buffer_load_dwordx4 v[64:67], v4, s[16:19], s70 offen
s_add_u32 s70, s70, 7168
buffer_load_dwordx4 v[68:71], v4, s[16:19], s70 offen
s_add_u32 s70, s70, 7168
buffer_load_dwordx4 v[72:75], v4, s[16:19], s70 offen
s_add_u32 s70, s70, 7168
buffer_load_dwordx4 v[76:79], v4, s[16:19], s70 offen
s_add_u32 s70, s70, 93184
buffer_load_dwordx4 v[80:83], v4, s[16:19], s70 offen
s_add_u32 s70, s70, 7168
buffer_load_dwordx4 v[84:87], v4, s[16:19], s70 offen
s_add_u32 s70, s70, 7168
buffer_load_dwordx4 v[88:91], v4, s[16:19], s70 offen
s_add_u32 s70, s70, 7168
buffer_load_dwordx4 v[92:95], v4, s[16:19], s70 offen
s_mov_b32 s70, 229376
buffer_load_dwordx4 v[96:99], v4, s[16:19], s70 offen
s_add_u32 s70, s70, 7168
buffer_load_dwordx4 v[100:103], v4, s[16:19], s70 offen
s_add_u32 s70, s70, 7168
buffer_load_dwordx4 v[104:107], v4, s[16:19], s70 offen
s_add_u32 s70, s70, 7168
buffer_load_dwordx4 v[108:111], v4, s[16:19], s70 offen
s_add_u32 s70, s70, 93184
buffer_load_dwordx4 v[112:115], v4, s[16:19], s70 offen
s_add_u32 s70, s70, 7168
buffer_load_dwordx4 v[116:119], v4, s[16:19], s70 offen
s_add_u32 s70, s70, 7168
buffer_load_dwordx4 v[120:123], v4, s[16:19], s70 offen
s_add_u32 s70, s70, 7168
buffer_load_dwordx4 v[124:127], v4, s[16:19], s70 offen
s_waitcnt vmcnt(14)
v_perm_b32 v56, v68, v64, s72
v_perm_b32 v57, v68, v64, s73
v_perm_b32 v58, v69, v65, s72
v_perm_b32 v59, v69, v65, s73
v_perm_b32 v60, v70, v66, s72
v_perm_b32 v61, v70, v66, s73
v_perm_b32 v62, v71, v67, s72
v_perm_b32 v63, v71, v67, s73
s_waitcnt vmcnt(12)
v_perm_b32 v64, v76, v72, s72
v_perm_b32 v65, v76, v72, s73
v_perm_b32 v66, v77, v73, s72
v_perm_b32 v67, v77, v73, s73
v_perm_b32 v68, v78, v74, s72
v_perm_b32 v69, v78, v74, s73
v_perm_b32 v70, v79, v75, s72
v_perm_b32 v71, v79, v75, s73
s_waitcnt vmcnt(10)
v_perm_b32 v72, v84, v80, s72
v_perm_b32 v73, v84, v80, s73
v_perm_b32 v74, v85, v81, s72
v_perm_b32 v75, v85, v81, s73
v_perm_b32 v76, v86, v82, s72
v_perm_b32 v77, v86, v82, s73
v_perm_b32 v78, v87, v83, s72
v_perm_b32 v79, v87, v83, s73
s_waitcnt vmcnt(8)
v_perm_b32 v80, v92, v88, s72
v_perm_b32 v81, v92, v88, s73
v_perm_b32 v82, v93, v89, s72
v_perm_b32 v83, v93, v89, s73
v_perm_b32 v84, v94, v90, s72
v_perm_b32 v85, v94, v90, s73
v_perm_b32 v86, v95, v91, s72
v_perm_b32 v87, v95, v91, s73
s_waitcnt vmcnt(6)
v_perm_b32 v88, v100, v96, s72
v_perm_b32 v89, v100, v96, s73
v_perm_b32 v90, v101, v97, s72
v_perm_b32 v91, v101, v97, s73
v_perm_b32 v92, v102, v98, s72
v_perm_b32 v93, v102, v98, s73
v_perm_b32 v94, v103, v99, s72
v_perm_b32 v95, v103, v99, s73
s_waitcnt vmcnt(4)
v_perm_b32 v96, v108, v104, s72
v_perm_b32 v97, v108, v104, s73
v_perm_b32 v98, v109, v105, s72
v_perm_b32 v99, v109, v105, s73
v_perm_b32 v100, v110, v106, s72
v_perm_b32 v101, v110, v106, s73
v_perm_b32 v102, v111, v107, s72
v_perm_b32 v103, v111, v107, s73
s_waitcnt vmcnt(2)
v_perm_b32 v104, v116, v112, s72
v_perm_b32 v105, v116, v112, s73
v_perm_b32 v106, v117, v113, s72
v_perm_b32 v107, v117, v113, s73
v_perm_b32 v108, v118, v114, s72
v_perm_b32 v109, v118, v114, s73
v_perm_b32 v110, v119, v115, s72
v_perm_b32 v111, v119, v115, s73
s_waitcnt vmcnt(0)
v_perm_b32 v112, v124, v120, s72
v_perm_b32 v113, v124, v120, s73
v_perm_b32 v114, v125, v121, s72
v_perm_b32 v115, v125, v121, s73
v_perm_b32 v116, v126, v122, s72
v_perm_b32 v117, v126, v122, s73
v_perm_b32 v118, v127, v123, s72
v_perm_b32 v119, v127, v123, s73
s_add_u32 s35, s34, 22
lw_94:
ds_read_b32 v5, v1 offset:0
s_waitcnt lgkmcnt(0)
v_cmp_gt_i32 vcc, s35, v5
s_cbranch_vccz lwd_95
s_sleep 4
s_sub_u32 s32, s32, 1
s_cmp_gt_i32 s32, 0
s_cbranch_scc1 lw_94
lwd_95:
s_mov_b32 s70, 28672
buffer_load_dwordx4 v[128:131], v4, s[16:19], s70 offen
s_add_u32 s70, s70, 7168
buffer_load_dwordx4 v[132:135], v4, s[16:19], s70 offen
s_add_u32 s70, s70, 7168
buffer_load_dwordx4 v[136:139], v4, s[16:19], s70 offen
s_add_u32 s70, s70, 7168
buffer_load_dwordx4 v[140:143], v4, s[16:19], s70 offen
s_add_u32 s70, s70, 93184
buffer_load_dwordx4 v[144:147], v4, s[16:19], s70 offen
s_add_u32 s70, s70, 7168
buffer_load_dwordx4 v[148:151], v4, s[16:19], s70 offen
s_add_u32 s70, s70, 7168
buffer_load_dwordx4 v[152:155], v4, s[16:19], s70 offen
s_add_u32 s70, s70, 7168
buffer_load_dwordx4 v[156:159], v4, s[16:19], s70 offen
s_mov_b32 s70, 258048
buffer_load_dwordx4 v[160:163], v4, s[16:19], s70 offen
s_add_u32 s70, s70, 7168
buffer_load_dwordx4 v[164:167], v4, s[16:19], s70 offen
s_add_u32 s70, s70, 7168
buffer_load_dwordx4 v[168:171], v4, s[16:19], s70 offen
s_add_u32 s70, s70, 7168
buffer_load_dwordx4 v[172:175], v4, s[16:19], s70 offen
s_add_u32 s70, s70, 93184
buffer_load_dwordx4 v[176:179], v4, s[16:19], s70 offen
s_add_u32 s70, s70, 7168
buffer_load_dwordx4 v[180:183], v4, s[16:19], s70 offen
s_add_u32 s70, s70, 7168
buffer_load_dwordx4 v[184:187], v4, s[16:19], s70 offen
s_add_u32 s70, s70, 7168
buffer_load_dwordx4 v[188:191], v4, s[16:19], s70 offen
buffer_load_dwordx4 v[192:195], v7, s[12:15], s66 offen offset:0
buffer_load_dwordx4 v[196:199], v7, s[12:15], s66 offen offset:2048
s_add_u32 s66, s66, 4096
buffer_load_dwordx4 v[200:203], v7, s[12:15], s66 offen offset:0
buffer_load_dwordx4 v[204:207], v7, s[12:15], s66 offen offset:2048
s_add_u32 s66, s66, 4096
buffer_load_dwordx4 v[208:211], v7, s[12:15], s66 offen offset:0
buffer_load_dwordx4 v[212:215], v7, s[12:15], s66 offen offset:2048
s_add_u32 s66, s66, 4096
buffer_load_dwordx4 v[216:219], v7, s[12:15], s66 offen offset:0
buffer_load_dwordx4 v[220:223], v7, s[12:15], s66 offen offset:2048
s_add_u32 s66, s66, 4096
buffer_load_dwordx4 v[224:227], v7, s[12:15], s66 offen offset:0
buffer_load_dwordx4 v[228:231], v7, s[12:15], s66 offen offset:2048
s_add_u32 s66, s66, 4096
buffer_load_dwordx4 v[232:235], v7, s[12:15], s66 offen offset:0
buffer_load_dwordx4 v[236:239], v7, s[12:15], s66 offen offset:2048
s_add_u32 s66, s66, 4096
buffer_load_dwordx4 v[240:243], v7, s[12:15], s66 offen offset:0
buffer_load_dwordx4 v[244:247], v7, s[12:15], s66 offen offset:2048
s_add_u32 s66, s66, 4096
buffer_load_dwordx4 v[248:251], v7, s[12:15], s66 offen offset:0
buffer_load_dwordx4 v[252:255], v7, s[12:15], s66 offen offset:2048
s_add_u32 s66, s66, 4096
s_waitcnt vmcnt(30)
v_perm_b32 v120, v132, v128, s72
v_perm_b32 v121, v132, v128, s73
v_perm_b32 v122, v133, v129, s72
v_perm_b32 v123, v133, v129, s73
v_perm_b32 v124, v134, v130, s72
v_perm_b32 v125, v134, v130, s73
v_perm_b32 v126, v135, v131, s72
v_perm_b32 v127, v135, v131, s73
s_waitcnt vmcnt(28)
v_perm_b32 v128, v140, v136, s72
v_perm_b32 v129, v140, v136, s73
v_perm_b32 v130, v141, v137, s72
v_perm_b32 v131, v141, v137, s73
v_perm_b32 v132, v142, v138, s72
v_perm_b32 v133, v142, v138, s73
v_perm_b32 v134, v143, v139, s72
v_perm_b32 v135, v143, v139, s73
s_waitcnt vmcnt(26)
v_perm_b32 v136, v148, v144, s72
v_perm_b32 v137, v148, v144, s73
v_perm_b32 v138, v149, v145, s72
v_perm_b32 v139, v149, v145, s73
v_perm_b32 v140, v150, v146, s72
v_perm_b32 v141, v150, v146, s73
v_perm_b32 v142, v151, v147, s72
v_perm_b32 v143, v151, v147, s73
s_waitcnt vmcnt(24)
v_perm_b32 v144, v156, v152, s72
v_perm_b32 v145, v156, v152, s73
v_perm_b32 v146, v157, v153, s72
v_perm_b32 v147, v157, v153, s73
v_perm_b32 v148, v158, v154, s72
v_perm_b32 v149, v158, v154, s73
v_perm_b32 v150, v159, v155, s72
v_perm_b32 v151, v159, v155, s73
s_waitcnt vmcnt(22)
v_perm_b32 v152, v164, v160, s72
v_perm_b32 v153, v164, v160, s73
v_perm_b32 v154, v165, v161, s72
v_perm_b32 v155, v165, v161, s73
v_perm_b32 v156, v166, v162, s72
v_perm_b32 v157, v166, v162, s73
v_perm_b32 v158, v167, v163, s72
v_perm_b32 v159, v167, v163, s73
s_waitcnt vmcnt(20)
v_perm_b32 v160, v172, v168, s72
v_perm_b32 v161, v172, v168, s73
v_perm_b32 v162, v173, v169, s72
v_perm_b32 v163, v173, v169, s73
v_perm_b32 v164, v174, v170, s72
v_perm_b32 v165, v174, v170, s73
v_perm_b32 v166, v175, v171, s72
v_perm_b32 v167, v175, v171, s73
s_waitcnt vmcnt(18)
v_perm_b32 v168, v180, v176, s72
v_perm_b32 v169, v180, v176, s73
v_perm_b32 v170, v181, v177, s72
v_perm_b32 v171, v181, v177, s73
v_perm_b32 v172, v182, v178, s72
v_perm_b32 v173, v182, v178, s73
v_perm_b32 v174, v183, v179, s72
v_perm_b32 v175, v183, v179, s73
s_waitcnt vmcnt(16)
v_perm_b32 v176, v188, v184, s72
v_perm_b32 v177, v188, v184, s73
v_perm_b32 v178, v189, v185, s72
v_perm_b32 v179, v189, v185, s73
v_perm_b32 v180, v190, v186, s72
v_perm_b32 v181, v190, v186, s73
v_perm_b32 v182, v191, v187, s72
v_perm_b32 v183, v191, v187, s73
s_waitcnt vmcnt(14)
v_perm_b32 v184, v196, v192, s72
v_perm_b32 v185, v196, v192, s73
v_perm_b32 v186, v197, v193, s72
v_perm_b32 v187, v197, v193, s73
v_perm_b32 v188, v198, v194, s72
v_perm_b32 v189, v198, v194, s73
v_perm_b32 v190, v199, v195, s72
v_perm_b32 v191, v199, v195, s73
s_waitcnt vmcnt(12)
v_perm_b32 v192, v204, v200, s72
v_perm_b32 v193, v204, v200, s73
v_perm_b32 v194, v205, v201, s72
v_perm_b32 v195, v205, v201, s73
v_perm_b32 v196, v206, v202, s72
v_perm_b32 v197, v206, v202, s73
v_perm_b32 v198, v207, v203, s72
v_perm_b32 v199, v207, v203, s73
s_waitcnt vmcnt(10)
v_perm_b32 v200, v212, v208, s72
v_perm_b32 v201, v212, v208, s73
v_perm_b32 v202, v213, v209, s72
v_perm_b32 v203, v213, v209, s73
v_perm_b32 v204, v214, v210, s72
v_perm_b32 v205, v214, v210, s73
v_perm_b32 v206, v215, v211, s72
v_perm_b32 v207, v215, v211, s73
s_waitcnt vmcnt(8)
v_perm_b32 v208, v220, v216, s72
v_perm_b32 v209, v220, v216, s73
v_perm_b32 v210, v221, v217, s72
v_perm_b32 v211, v221, v217, s73
v_perm_b32 v212, v222, v218, s72
v_perm_b32 v213, v222, v218, s73
v_perm_b32 v214, v223, v219, s72
v_perm_b32 v215, v223, v219, s73
s_waitcnt vmcnt(6)
v_perm_b32 v216, v228, v224, s72
v_perm_b32 v217, v228, v224, s73
v_perm_b32 v218, v229, v225, s72
v_perm_b32 v219, v229, v225, s73
v_perm_b32 v220, v230, v226, s72
v_perm_b32 v221, v230, v226, s73
v_perm_b32 v222, v231, v227, s72
v_perm_b32 v223, v231, v227, s73
s_waitcnt vmcnt(4)
v_perm_b32 v224, v236, v232, s72
v_perm_b32 v225, v236, v232, s73
v_perm_b32 v226, v237, v233, s72
v_perm_b32 v227, v237, v233, s73
v_perm_b32 v228, v238, v234, s72
v_perm_b32 v229, v238, v234, s73
v_perm_b32 v230, v239, v235, s72
v_perm_b32 v231, v239, v235, s73
s_waitcnt vmcnt(2)
v_perm_b32 v232, v244, v240, s72
v_perm_b32 v233, v244, v240, s73
v_perm_b32 v234, v245, v241, s72
v_perm_b32 v235, v245, v241, s73
v_perm_b32 v236, v246, v242, s72
v_perm_b32 v237, v246, v242, s73
v_perm_b32 v238, v247, v243, s72
v_perm_b32 v239, v247, v243, s73
s_waitcnt vmcnt(0)
v_perm_b32 v240, v252, v248, s72
v_perm_b32 v241, v252, v248, s73
v_perm_b32 v242, v253, v249, s72
v_perm_b32 v243, v253, v249, s73
v_perm_b32 v244, v254, v250, s72
v_perm_b32 v245, v254, v250, s73
v_perm_b32 v246, v255, v251, s72
v_perm_b32 v247, v255, v251, s73
s_branch fnw_53
L_m:
s_setprio 2
v_mov_b32 v6, 0
v_mov_b32 v7, 0
v_lshlrev_b32 v8, 3, v0
ds_write_b64 v8, v[6:7]
s_waitcnt lgkmcnt(0)
s_barrier
s_lshr_b32 s64, s58, 1
s_and_b32 s65, s58, 1
v_and_b32 v1, 3, v0
v_lshlrev_b32 v1, 2, v1
v_and_b32 v2, 4, v1
s_lshl2_add_u32 s35, s58, 0
v_mov_b32 v3, s35
s_mov_b32 s4, s44
s_mov_b32 s5, s45
s_mov_b32 s6, 0x800
s_mov_b32 s7, 0x00020000
v_lshrrev_b32 v6, 4, v0
v_lshlrev_b32 v6, 3, v6
s_lshl_b32 s66, s62, 7
buffer_load_dwordx2 v[232:233], v6, s[4:7], s66 offen offset:0
buffer_load_dwordx2 v[234:235], v6, s[4:7], s66 offen offset:32
buffer_load_dwordx2 v[236:237], v6, s[4:7], s66 offen offset:64
buffer_load_dwordx2 v[238:239], v6, s[4:7], s66 offen offset:96
v_and_b32 v6, 31, v0
v_lshrrev_b32 v7, 5, v0
v_lshlrev_b32 v7, 3, v7
v_sub_u32 v6, v6, v7
v_mov_b32 v7, 0xf149f2ca
v_cmp_le_i32 vcc, 0, v6
s_nop 1
v_cndmask_b32 v216, 0, v7, vcc
v_cmp_le_i32 vcc, 1, v6
s_nop 1
v_cndmask_b32 v217, 0, v7, vcc
v_cmp_le_i32 vcc, 2, v6
s_nop 1
v_cndmask_b32 v218, 0, v7, vcc
v_cmp_le_i32 vcc, 3, v6
s_nop 1
v_cndmask_b32 v219, 0, v7, vcc
v_cmp_le_i32 vcc, 16, v6
s_nop 1
v_cndmask_b32 v220, 0, v7, vcc
v_cmp_le_i32 vcc, 17, v6
s_nop 1
v_cndmask_b32 v221, 0, v7, vcc
v_cmp_le_i32 vcc, 18, v6
s_nop 1
v_cndmask_b32 v222, 0, v7, vcc
v_cmp_le_i32 vcc, 19, v6
s_nop 1
v_cndmask_b32 v223, 0, v7, vcc
v_cmp_le_i32 vcc, 4, v6
s_nop 1
v_cndmask_b32 v224, 0, v7, vcc
v_cmp_le_i32 vcc, 5, v6
s_nop 1
v_cndmask_b32 v225, 0, v7, vcc
v_cmp_le_i32 vcc, 6, v6
s_nop 1
v_cndmask_b32 v226, 0, v7, vcc
v_cmp_le_i32 vcc, 7, v6
s_nop 1
v_cndmask_b32 v227, 0, v7, vcc
v_cmp_le_i32 vcc, 20, v6
s_nop 1
v_cndmask_b32 v228, 0, v7, vcc
v_cmp_le_i32 vcc, 21, v6
s_nop 1
v_cndmask_b32 v229, 0, v7, vcc
v_cmp_le_i32 vcc, 22, v6
s_nop 1
v_cndmask_b32 v230, 0, v7, vcc
v_cmp_le_i32 vcc, 23, v6
s_nop 1
v_cndmask_b32 v231, 0, v7, vcc
v_lshrrev_b32 v6, 2, v0
v_xor_b32 v6, v6, v0
v_and_b32 v6, 4, v6
v_mov_b32 v7, 0x3f803f80
v_cmp_eq_u32 vcc, 0, v6
s_nop 1
v_cndmask_b32 v212, 0, v7, vcc
v_cndmask_b32 v213, 0, v7, vcc
v_cndmask_b32 v214, 0, v7, vcc
v_cndmask_b32 v215, 0, v7, vcc
L_mtop:
v_lshrrev_b32 v10, 4, v0
s_cmp_eq_u32 s63, 0
s_cbranch_scc0 mq_96
v_bfe_u32 v11, v0, 1, 3
v_xor_b32 v11, v11, v10
v_lshlrev_b32 v11, 4, v11
v_and_b32 v12, 15, v0
v_lshl_add_u32 v6, v12, 7, v11
v_xor_b32 v7, 64, v6
s_branch mq_97
mq_96:
v_lshlrev_b32 v6, 4, v0
v_add_u32 v7, 1024, v6
mq_97:
s_lshl_b32 s66, s65, 13
s_add_u32 s66, s66, 86016
v_add_u32 v6, s66, v6
v_add_u32 v7, s66, v7
v_bfe_u32 v11, v0, 2, 2
v_lshl_add_u32 v11, v10, 3, v11
v_bfe_u32 v12, v0, 3, 2
s_lshl_b32 s66, s64, 1
v_xor_b32 v12, s66, v12
v_lshlrev_b32 v12, 5, v12
v_lshl_add_u32 v11, v11, 7, v12
v_and_b32 v12, 3, v0
v_lshl_add_u32 v11, v12, 3, v11
v_add_u32 v8, 102400, v11
v_xor_b32 v9, 32, v8
v_mov_b32 v11, 0xf149f2ca
v_xor_b32 v216, v11, v216
v_xor_b32 v217, v11, v217
v_xor_b32 v218, v11, v218
v_xor_b32 v219, v11, v219
v_xor_b32 v220, v11, v220
v_xor_b32 v221, v11, v221
v_xor_b32 v222, v11, v222
v_xor_b32 v223, v11, v223
v_xor_b32 v224, v11, v224
v_xor_b32 v225, v11, v225
v_xor_b32 v226, v11, v226
v_xor_b32 v227, v11, v227
v_xor_b32 v228, v11, v228
v_xor_b32 v229, v11, v229
v_xor_b32 v230, v11, v230
v_xor_b32 v231, v11, v231
v_mov_b32 v16, 0
v_mov_b32 v17, 0
v_mov_b32 v18, 0
v_mov_b32 v19, 0
v_mov_b32 v20, 0
v_mov_b32 v21, 0
v_mov_b32 v22, 0
v_mov_b32 v23, 0
v_mov_b32 v24, 0
v_mov_b32 v25, 0
v_mov_b32 v26, 0
v_mov_b32 v27, 0
v_mov_b32 v28, 0
v_mov_b32 v29, 0
v_mov_b32 v30, 0
v_mov_b32 v31, 0
v_mov_b32 v32, 0
v_mov_b32 v33, 0
v_mov_b32 v34, 0
v_mov_b32 v35, 0
v_mov_b32 v36, 0
v_mov_b32 v37, 0
v_mov_b32 v38, 0
v_mov_b32 v39, 0
v_mov_b32 v40, 0
v_mov_b32 v41, 0
v_mov_b32 v42, 0
v_mov_b32 v43, 0
v_mov_b32 v44, 0
v_mov_b32 v45, 0
v_mov_b32 v46, 0
v_mov_b32 v47, 0
v_mov_b32 v48, 0
v_mov_b32 v49, 0
v_mov_b32 v50, 0
v_mov_b32 v51, 0
v_mov_b32 v52, 0
v_mov_b32 v53, 0
v_mov_b32 v54, 0
v_mov_b32 v55, 0
v_mov_b32 v56, 0
v_mov_b32 v57, 0
v_mov_b32 v58, 0
v_mov_b32 v59, 0
v_mov_b32 v60, 0
v_mov_b32 v61, 0
v_mov_b32 v62, 0
v_mov_b32 v63, 0
v_mov_b32 v64, 0
v_mov_b32 v65, 0
v_mov_b32 v66, 0
v_mov_b32 v67, 0
v_mov_b32 v68, 0
v_mov_b32 v69, 0
v_mov_b32 v70, 0
v_mov_b32 v71, 0
v_mov_b32 v72, 0
v_mov_b32 v73, 0
v_mov_b32 v74, 0
v_mov_b32 v75, 0
v_mov_b32 v76, 0
v_mov_b32 v77, 0
v_mov_b32 v78, 0
v_mov_b32 v79, 0
v_mov_b32 v80, 0
v_mov_b32 v81, 0
v_mov_b32 v82, 0
v_mov_b32 v83, 0
v_mov_b32 v84, 0
v_mov_b32 v85, 0
v_mov_b32 v86, 0
v_mov_b32 v87, 0
v_mov_b32 v88, 0
v_mov_b32 v89, 0
v_mov_b32 v90, 0
v_mov_b32 v91, 0
v_mov_b32 v92, 0
v_mov_b32 v93, 0
v_mov_b32 v94, 0
v_mov_b32 v95, 0
v_mov_b32 v96, 0
v_mov_b32 v97, 0
v_mov_b32 v98, 0
v_mov_b32 v99, 0
v_mov_b32 v100, 0
v_mov_b32 v101, 0
v_mov_b32 v102, 0
v_mov_b32 v103, 0
v_mov_b32 v104, 0
v_mov_b32 v105, 0
v_mov_b32 v106, 0
v_mov_b32 v107, 0
v_mov_b32 v108, 0
v_mov_b32 v109, 0
v_mov_b32 v110, 0
v_mov_b32 v111, 0
v_mov_b32 v192, 0
v_mov_b32 v193, 0
v_mov_b32 v194, 0
v_mov_b32 v195, 0
v_mov_b32 v196, 0
v_mov_b32 v197, 0
v_mov_b32 v198, 0
v_mov_b32 v199, 0
v_mov_b32 v200, 0
v_mov_b32 v201, 0
v_mov_b32 v202, 0
v_mov_b32 v203, 0
v_mov_b32 v204, 0
v_mov_b32 v205, 0
v_mov_b32 v206, 0
v_mov_b32 v207, 0
v_mov_b32 v208, 0
v_mov_b32 v209, 0
v_mov_b32 v210, 0
v_mov_b32 v211, 0
v_add_u32 v4, s34, 1
s_mov_b32 s66, 16
s_mov_b32 s67, -40960
s_mov_b32 s68, -40960
s_mov_b32 s69, 81920
s_add_u32 s35, s34, 1
lw_98:
ds_read_b32 v5, v2 offset:16
s_waitcnt lgkmcnt(0)
v_cmp_gt_i32 vcc, s35, v5
s_cbranch_vccz lwd_99
s_sub_u32 s32, s32, 1
s_cmp_gt_i32 s32, 0
s_cbranch_scc1 lw_98
lwd_99:
ds_read_b64_tr_b16 v[144:145], v8 offset:8192
ds_read_b64_tr_b16 v[146:147], v8 offset:8704
ds_read_b64_tr_b16 v[148:149], v8 offset:12288
ds_read_b64_tr_b16 v[150:151], v8 offset:12800
ds_read_b128 v[112:115], v6 offset:0
ds_read_b128 v[116:119], v7 offset:0
ds_read_b64_tr_b16 v[152:153], v9 offset:8192
ds_read_b64_tr_b16 v[154:155], v9 offset:8704
ds_read_b64_tr_b16 v[156:157], v9 offset:12288
ds_read_b64_tr_b16 v[158:159], v9 offset:12800
ds_read_b128 v[120:123], v6 offset:2048
ds_read_b128 v[124:127], v7 offset:2048
ds_read_b128 v[128:131], v6 offset:4096
ds_read_b128 v[132:135], v7 offset:4096
ds_read_b128 v[136:139], v6 offset:6144
ds_read_b128 v[140:143], v7 offset:6144
.p2align 6
mqkv_100:
s_waitcnt lgkmcnt(7)
v_mfma_f32_16x16x32_bf16 v[16:19], v[144:147], v[112:115], v[16:19]
ds_read_b64_tr_b16 v[160:161], v8 offset:16384
s_waitcnt lgkmcnt(7)
v_mfma_f32_16x16x32_bf16 v[16:19], v[148:151], v[116:119], v[16:19]
ds_read_b64_tr_b16 v[162:163], v8 offset:16896
v_mfma_f32_16x16x32_bf16 v[20:23], v[152:155], v[112:115], v[20:23]
ds_read_b64_tr_b16 v[164:165], v8 offset:20480
v_mfma_f32_16x16x32_bf16 v[20:23], v[156:159], v[116:119], v[20:23]
ds_read_b64_tr_b16 v[166:167], v8 offset:20992
s_waitcnt lgkmcnt(9)
v_mfma_f32_16x16x32_bf16 v[24:27], v[144:147], v[120:123], v[24:27]
ds_read_b64_tr_b16 v[168:169], v9 offset:16384
s_waitcnt lgkmcnt(9)
v_mfma_f32_16x16x32_bf16 v[24:27], v[148:151], v[124:127], v[24:27]
ds_read_b64_tr_b16 v[170:171], v9 offset:16896
v_mfma_f32_16x16x32_bf16 v[28:31], v[152:155], v[120:123], v[28:31]
ds_read_b64_tr_b16 v[172:173], v9 offset:20480
v_mfma_f32_16x16x32_bf16 v[28:31], v[156:159], v[124:127], v[28:31]
ds_read_b64_tr_b16 v[174:175], v9 offset:20992
s_waitcnt lgkmcnt(11)
v_mfma_f32_16x16x32_bf16 v[32:35], v[144:147], v[128:131], v[32:35]
ds_read_b64_tr_b16 v[176:177], v8 offset:0
s_waitcnt lgkmcnt(11)
v_mfma_f32_16x16x32_bf16 v[32:35], v[148:151], v[132:135], v[32:35]
ds_read_b64_tr_b16 v[178:179], v8 offset:512
v_mfma_f32_16x16x32_bf16 v[36:39], v[152:155], v[128:131], v[36:39]
ds_read_b64_tr_b16 v[180:181], v8 offset:4096
v_mfma_f32_16x16x32_bf16 v[36:39], v[156:159], v[132:135], v[36:39]
ds_read_b64_tr_b16 v[182:183], v8 offset:4608
s_waitcnt lgkmcnt(13)
v_mfma_f32_16x16x32_bf16 v[40:43], v[144:147], v[136:139], v[40:43]
ds_read_b64_tr_b16 v[184:185], v9 offset:0
s_waitcnt lgkmcnt(13)
v_mfma_f32_16x16x32_bf16 v[40:43], v[148:151], v[140:143], v[40:43]
ds_read_b64_tr_b16 v[186:187], v9 offset:512
v_mfma_f32_16x16x32_bf16 v[44:47], v[152:155], v[136:139], v[44:47]
ds_read_b64_tr_b16 v[188:189], v9 offset:4096
v_mfma_f32_16x16x32_bf16 v[44:47], v[156:159], v[140:143], v[44:47]
ds_read_b64_tr_b16 v[190:191], v9 offset:4608
s_waitcnt lgkmcnt(14)
v_mfma_f32_16x16x32_bf16 v[48:51], v[112:115], v[160:163], v[48:51]
s_mov_b64 exec, 1
ds_write_b32 v3, v4
s_mov_b64 exec, -1
s_waitcnt lgkmcnt(13)
v_mfma_f32_16x16x32_bf16 v[48:51], v[116:119], v[164:167], v[48:51]
v_add_u32 v8, s67, v8
v_add_u32 v9, s67, v9
s_waitcnt lgkmcnt(11)
v_mfma_f32_16x16x32_bf16 v[52:55], v[112:115], v[168:171], v[52:55]
v_add_u32 v6, s67, v6
v_add_u32 v7, s67, v7
s_waitcnt lgkmcnt(9)
v_mfma_f32_16x16x32_bf16 v[52:55], v[116:119], v[172:175], v[52:55]
s_mov_b32 s70, s67
s_mov_b32 s67, s68
s_mov_b32 s68, s69
s_mov_b32 s69, s70
v_mfma_f32_16x16x32_bf16 v[56:59], v[120:123], v[160:163], v[56:59]
ds_read_b32 v5, v2 offset:16
v_mfma_f32_16x16x32_bf16 v[56:59], v[124:127], v[164:167], v[56:59]
v_mfma_f32_16x16x32_bf16 v[60:63], v[120:123], v[168:171], v[60:63]
v_mfma_f32_16x16x32_bf16 v[60:63], v[124:127], v[172:175], v[60:63]
v_mfma_f32_16x16x32_bf16 v[64:67], v[128:131], v[160:163], v[64:67]
s_waitcnt lgkmcnt(0)
v_cmp_ge_u32 vcc, v4, v5
s_cbranch_vccnz mspin_101
mback_102:
v_add_u32 v4, 1, v4
v_mfma_f32_16x16x32_bf16 v[64:67], v[132:135], v[164:167], v[64:67]
ds_read_b64_tr_b16 v[144:145], v8 offset:8192
v_mfma_f32_16x16x32_bf16 v[68:71], v[128:131], v[168:171], v[68:71]
ds_read_b64_tr_b16 v[146:147], v8 offset:8704
v_mfma_f32_16x16x32_bf16 v[68:71], v[132:135], v[172:175], v[68:71]
ds_read_b64_tr_b16 v[148:149], v8 offset:12288
v_mfma_f32_16x16x32_bf16 v[72:75], v[136:139], v[160:163], v[72:75]
ds_read_b64_tr_b16 v[150:151], v8 offset:12800
v_mfma_f32_16x16x32_bf16 v[72:75], v[140:143], v[164:167], v[72:75]
ds_read_b64_tr_b16 v[152:153], v9 offset:8192
v_mfma_f32_16x16x32_bf16 v[76:79], v[136:139], v[168:171], v[76:79]
ds_read_b64_tr_b16 v[154:155], v9 offset:8704
v_mfma_f32_16x16x32_bf16 v[76:79], v[140:143], v[172:175], v[76:79]
ds_read_b64_tr_b16 v[156:157], v9 offset:12288
v_mfma_f32_16x16x32_bf16 v[80:83], v[176:179], v[112:115], v[80:83]
ds_read_b64_tr_b16 v[158:159], v9 offset:12800
v_mfma_f32_16x16x32_bf16 v[80:83], v[180:183], v[116:119], v[80:83]
v_mfma_f32_16x16x32_bf16 v[84:87], v[184:187], v[112:115], v[84:87]
v_mfma_f32_16x16x32_bf16 v[84:87], v[188:191], v[116:119], v[84:87]
ds_read_b128 v[112:115], v6 offset:0
ds_read_b128 v[116:119], v7 offset:0
v_mfma_f32_16x16x32_bf16 v[88:91], v[176:179], v[120:123], v[88:91]
v_mfma_f32_16x16x32_bf16 v[88:91], v[180:183], v[124:127], v[88:91]
v_mfma_f32_16x16x32_bf16 v[92:95], v[184:187], v[120:123], v[92:95]
v_mfma_f32_16x16x32_bf16 v[92:95], v[188:191], v[124:127], v[92:95]
ds_read_b128 v[120:123], v6 offset:2048
ds_read_b128 v[124:127], v7 offset:2048
v_mfma_f32_16x16x32_bf16 v[96:99], v[176:179], v[128:131], v[96:99]
v_mfma_f32_16x16x32_bf16 v[96:99], v[180:183], v[132:135], v[96:99]
v_mfma_f32_16x16x32_bf16 v[100:103], v[184:187], v[128:131], v[100:103]
v_mfma_f32_16x16x32_bf16 v[100:103], v[188:191], v[132:135], v[100:103]
ds_read_b128 v[128:131], v6 offset:4096
ds_read_b128 v[132:135], v7 offset:4096
v_mfma_f32_16x16x32_bf16 v[104:107], v[176:179], v[136:139], v[104:107]
v_mfma_f32_16x16x32_bf16 v[104:107], v[180:183], v[140:143], v[104:107]
s_sub_u32 s66, s66, 1
s_cmp_eq_u32 s66, 0
v_mfma_f32_16x16x32_bf16 v[108:111], v[184:187], v[136:139], v[108:111]
v_mfma_f32_16x16x32_bf16 v[108:111], v[188:191], v[140:143], v[108:111]
ds_read_b128 v[136:139], v6 offset:6144
ds_read_b128 v[140:143], v7 offset:6144
s_cbranch_scc0 mqkv_100
v_and_b32 v10, 15, v0
v_lshrrev_b32 v11, 4, v0
s_lshl_b32 s66, s65, 8
s_add_u32 s66, s66, 1280
s_mul_i32 s67, s64, 384
v_lshl_add_u32 v6, v10, 2, s66
v_lshl_add_u32 v7, v11, 4, s66
v_lshl_add_u32 v8, v10, 2, s67
v_lshl_add_u32 v9, v11, 4, s67
v_and_b32 v12, 1, v11
v_lshrrev_b32 v11, 1, v11
v_lshlrev_b32 v11, 9, v11
v_lshl_add_u32 v11, v12, 10, v11
s_lshl_b32 s66, s64, 12
s_lshl_b32 s67, s65, 13
s_add_u32 s66, s66, 131072
s_add_u32 s68, s66, 24576
s_sub_u32 s68, s68, s67
s_add_u32 s67, s66, s67
v_lshl_add_u32 v14, v10, 4, v11
v_and_b32 v12, 3, v0
v_lshl_add_u32 v11, v12, 4, v11
v_bfe_u32 v12, v0, 3, 1
v_lshl_add_u32 v11, v12, 6, v11
v_bfe_u32 v12, v0, 2, 1
v_lshl_add_u32 v12, v12, 8, v11
v_add_u32 v13, s68, v12
v_add_u32 v12, s67, v12
v_add_u32 v15, s68, v14
v_add_u32 v14, s67, v14
s_lshl_b32 s66, s59, 4
s_add_u32 s66, s66, s60
s_lshl_b32 s72, s66, 7
s_lshl_b32 s66, s66, 15
s_lshl_b32 s67, s63, 23
s_add_u32 s66, s66, s67
s_add_u32 s71, s66, 917504
s_add_u32 s35, s34, 2
lw_103:
ds_read_b32 v5, v2 offset:24
s_waitcnt lgkmcnt(0)
v_cmp_gt_i32 vcc, s35, v5
s_cbranch_vccz lwd_104
s_sub_u32 s32, s32, 1
s_cmp_gt_i32 s32, 0
s_cbranch_scc1 lw_103
lwd_104:
v_mov_b32 v10, 0
ds_read_b32 v10, v10 offset:32
ds_read2_b32 v[144:145], v6 offset0:0 offset1:128
ds_read2_b32 v[146:147], v6 offset0:16 offset1:144
ds_read2_b32 v[148:149], v6 offset0:32 offset1:160
ds_read2_b32 v[150:151], v6 offset0:48 offset1:176
ds_read_b128 v[152:155], v9 offset:2432
ds_read_b128 v[156:159], v9 offset:2496
ds_read_b32 v168, v8 offset:2560
ds_read_b32 v169, v8 offset:2624
ds_read_b128 v[112:115], v7 offset:0
ds_read_b128 v[128:131], v7 offset:512
ds_read_b128 v[116:119], v7 offset:64
ds_read_b128 v[132:135], v7 offset:576
s_waitcnt lgkmcnt(12)
v_readfirstlane_b32 s33, v10
s_sub_u32 s33, s33, 1
s_lshr_b32 s66, s33, 7
s_cmp_eq_u32 s66, s59
s_cbranch_scc1 patch_105
pback_106:
s_waitcnt lgkmcnt(11)
v_pk_mul_f32 v[16:17], v[16:17], v[144:145] op_sel:[0,0] op_sel_hi:[1,0]
v_pk_mul_f32 v[18:19], v[18:19], v[144:145] op_sel:[0,0] op_sel_hi:[1,0]
v_pk_mul_f32 v[20:21], v[20:21], v[144:145] op_sel:[0,0] op_sel_hi:[1,0]
v_pk_mul_f32 v[22:23], v[22:23], v[144:145] op_sel:[0,0] op_sel_hi:[1,0]
s_waitcnt lgkmcnt(7)
v_pk_fma_f32 v[16:17], v[152:153], v[144:145], v[16:17] op_sel:[0,1,0] op_sel_hi:[1,1,1]
v_pk_fma_f32 v[18:19], v[154:155], v[144:145], v[18:19] op_sel:[0,1,0] op_sel_hi:[1,1,1]
s_waitcnt lgkmcnt(6)
v_pk_fma_f32 v[20:21], v[156:157], v[144:145], v[20:21] op_sel:[0,1,0] op_sel_hi:[1,1,1]
v_pk_fma_f32 v[22:23], v[158:159], v[144:145], v[22:23] op_sel:[0,1,0] op_sel_hi:[1,1,1]
v_cvt_pk_bf16_f32 v16, v16, v17
v_cvt_pk_bf16_f32 v17, v18, v19
v_cvt_pk_bf16_f32 v18, v20, v21
v_cvt_pk_bf16_f32 v19, v22, v23
buffer_store_dwordx4 v[16:19], v12, s[20:23], s71 offen offset:0 sc1
ds_write_b128 v12, v[16:19] offset:0
ds_read_b128 v[120:123], v7 offset:128
ds_read_b128 v[136:139], v7 offset:640
ds_read_b128 v[124:127], v7 offset:192
ds_read_b128 v[140:143], v7 offset:704
ds_read_b128 v[160:163], v9 offset:2304
ds_read_b128 v[164:167], v9 offset:2368
v_pk_mul_f32 v[24:25], v[24:25], v[146:147] op_sel:[0,0] op_sel_hi:[1,0]
v_pk_mul_f32 v[26:27], v[26:27], v[146:147] op_sel:[0,0] op_sel_hi:[1,0]
v_pk_mul_f32 v[28:29], v[28:29], v[146:147] op_sel:[0,0] op_sel_hi:[1,0]
v_pk_mul_f32 v[30:31], v[30:31], v[146:147] op_sel:[0,0] op_sel_hi:[1,0]
v_pk_fma_f32 v[24:25], v[152:153], v[146:147], v[24:25] op_sel:[0,1,0] op_sel_hi:[1,1,1]
v_pk_fma_f32 v[26:27], v[154:155], v[146:147], v[26:27] op_sel:[0,1,0] op_sel_hi:[1,1,1]
v_pk_fma_f32 v[28:29], v[156:157], v[146:147], v[28:29] op_sel:[0,1,0] op_sel_hi:[1,1,1]
v_pk_fma_f32 v[30:31], v[158:159], v[146:147], v[30:31] op_sel:[0,1,0] op_sel_hi:[1,1,1]
v_cvt_pk_bf16_f32 v24, v24, v25
v_cvt_pk_bf16_f32 v25, v26, v27
v_cvt_pk_bf16_f32 v26, v28, v29
v_cvt_pk_bf16_f32 v27, v30, v31
buffer_store_dwordx4 v[24:27], v12, s[20:23], s71 offen offset:128 sc1
ds_write_b128 v12, v[24:27] offset:128
v_pk_mul_f32 v[32:33], v[32:33], v[148:149] op_sel:[0,0] op_sel_hi:[1,0]
v_pk_mul_f32 v[34:35], v[34:35], v[148:149] op_sel:[0,0] op_sel_hi:[1,0]
v_pk_mul_f32 v[36:37], v[36:37], v[148:149] op_sel:[0,0] op_sel_hi:[1,0]
v_pk_mul_f32 v[38:39], v[38:39], v[148:149] op_sel:[0,0] op_sel_hi:[1,0]
v_pk_fma_f32 v[32:33], v[152:153], v[148:149], v[32:33] op_sel:[0,1,0] op_sel_hi:[1,1,1]
v_pk_fma_f32 v[34:35], v[154:155], v[148:149], v[34:35] op_sel:[0,1,0] op_sel_hi:[1,1,1]
v_pk_fma_f32 v[36:37], v[156:157], v[148:149], v[36:37] op_sel:[0,1,0] op_sel_hi:[1,1,1]
v_pk_fma_f32 v[38:39], v[158:159], v[148:149], v[38:39] op_sel:[0,1,0] op_sel_hi:[1,1,1]
v_cvt_pk_bf16_f32 v32, v32, v33
v_cvt_pk_bf16_f32 v33, v34, v35
v_cvt_pk_bf16_f32 v34, v36, v37
v_cvt_pk_bf16_f32 v35, v38, v39
buffer_store_dwordx4 v[32:35], v13, s[20:23], s71 offen offset:0 sc1
ds_write_b128 v13, v[32:35] offset:0
v_pk_mul_f32 v[40:41], v[40:41], v[150:151] op_sel:[0,0] op_sel_hi:[1,0]
v_pk_mul_f32 v[42:43], v[42:43], v[150:151] op_sel:[0,0] op_sel_hi:[1,0]
v_pk_mul_f32 v[44:45], v[44:45], v[150:151] op_sel:[0,0] op_sel_hi:[1,0]
v_pk_mul_f32 v[46:47], v[46:47], v[150:151] op_sel:[0,0] op_sel_hi:[1,0]
v_pk_fma_f32 v[40:41], v[152:153], v[150:151], v[40:41] op_sel:[0,1,0] op_sel_hi:[1,1,1]
v_pk_fma_f32 v[42:43], v[154:155], v[150:151], v[42:43] op_sel:[0,1,0] op_sel_hi:[1,1,1]
v_pk_fma_f32 v[44:45], v[156:157], v[150:151], v[44:45] op_sel:[0,1,0] op_sel_hi:[1,1,1]
v_pk_fma_f32 v[46:47], v[158:159], v[150:151], v[46:47] op_sel:[0,1,0] op_sel_hi:[1,1,1]
v_cvt_pk_bf16_f32 v40, v40, v41
v_cvt_pk_bf16_f32 v41, v42, v43
v_cvt_pk_bf16_f32 v42, v44, v45
v_cvt_pk_bf16_f32 v43, v46, v47
buffer_store_dwordx4 v[40:43], v13, s[20:23], s71 offen offset:128 sc1
ds_write_b128 v13, v[40:43] offset:128
s_waitcnt lgkmcnt(13)
v_pk_mul_f32 v[48:49], v[48:49], v[112:113]
v_pk_mul_f32 v[50:51], v[50:51], v[114:115]
s_waitcnt lgkmcnt(12)
v_pk_fma_f32 v[48:49], v[128:129], v[168:169], v[48:49] op_sel:[0,0,0] op_sel_hi:[1,0,1]
v_pk_fma_f32 v[50:51], v[130:131], v[168:169], v[50:51] op_sel:[0,0,0] op_sel_hi:[1,0,1]
s_waitcnt lgkmcnt(11)
v_pk_mul_f32 v[56:57], v[56:57], v[116:117]
v_pk_mul_f32 v[58:59], v[58:59], v[118:119]
s_waitcnt lgkmcnt(10)
v_pk_fma_f32 v[56:57], v[132:133], v[168:169], v[56:57] op_sel:[0,0,0] op_sel_hi:[1,0,1]
v_pk_fma_f32 v[58:59], v[134:135], v[168:169], v[58:59] op_sel:[0,0,0] op_sel_hi:[1,0,1]
v_cvt_pk_bf16_f32 v48, v48, v49
v_cvt_pk_bf16_f32 v49, v50, v51
v_cvt_pk_bf16_f32 v50, v56, v57
v_cvt_pk_bf16_f32 v51, v58, v59
buffer_store_dwordx4 v[48:51], v14, s[20:23], s71 offen offset:2048 sc1
ds_write_b128 v14, v[48:51] offset:2048
v_pk_mul_f32 v[52:53], v[52:53], v[112:113]
v_pk_mul_f32 v[54:55], v[54:55], v[114:115]
v_pk_fma_f32 v[52:53], v[128:129], v[168:169], v[52:53] op_sel:[0,1,0] op_sel_hi:[1,1,1]
v_pk_fma_f32 v[54:55], v[130:131], v[168:169], v[54:55] op_sel:[0,1,0] op_sel_hi:[1,1,1]
v_pk_mul_f32 v[60:61], v[60:61], v[116:117]
v_pk_mul_f32 v[62:63], v[62:63], v[118:119]
v_pk_fma_f32 v[60:61], v[132:133], v[168:169], v[60:61] op_sel:[0,1,0] op_sel_hi:[1,1,1]
v_pk_fma_f32 v[62:63], v[134:135], v[168:169], v[62:63] op_sel:[0,1,0] op_sel_hi:[1,1,1]
v_cvt_pk_bf16_f32 v52, v52, v53
v_cvt_pk_bf16_f32 v53, v54, v55
v_cvt_pk_bf16_f32 v54, v60, v61
v_cvt_pk_bf16_f32 v55, v62, v63
buffer_store_dwordx4 v[52:55], v14, s[20:23], s71 offen offset:2304 sc1
ds_write_b128 v14, v[52:55] offset:2304
s_waitcnt lgkmcnt(10)
v_pk_mul_f32 v[64:65], v[64:65], v[120:121]
v_pk_mul_f32 v[66:67], v[66:67], v[122:123]
s_waitcnt lgkmcnt(9)
v_pk_fma_f32 v[64:65], v[136:137], v[168:169], v[64:65] op_sel:[0,0,0] op_sel_hi:[1,0,1]
v_pk_fma_f32 v[66:67], v[138:139], v[168:169], v[66:67] op_sel:[0,0,0] op_sel_hi:[1,0,1]
s_waitcnt lgkmcnt(8)
v_pk_mul_f32 v[72:73], v[72:73], v[124:125]
v_pk_mul_f32 v[74:75], v[74:75], v[126:127]
s_waitcnt lgkmcnt(7)
v_pk_fma_f32 v[72:73], v[140:141], v[168:169], v[72:73] op_sel:[0,0,0] op_sel_hi:[1,0,1]
v_pk_fma_f32 v[74:75], v[142:143], v[168:169], v[74:75] op_sel:[0,0,0] op_sel_hi:[1,0,1]
v_cvt_pk_bf16_f32 v64, v64, v65
v_cvt_pk_bf16_f32 v65, v66, v67
v_cvt_pk_bf16_f32 v66, v72, v73
v_cvt_pk_bf16_f32 v67, v74, v75
buffer_store_dwordx4 v[64:67], v15, s[20:23], s71 offen offset:2048 sc1
ds_write_b128 v15, v[64:67] offset:2048
v_pk_mul_f32 v[68:69], v[68:69], v[120:121]
v_pk_mul_f32 v[70:71], v[70:71], v[122:123]
v_pk_fma_f32 v[68:69], v[136:137], v[168:169], v[68:69] op_sel:[0,1,0] op_sel_hi:[1,1,1]
v_pk_fma_f32 v[70:71], v[138:139], v[168:169], v[70:71] op_sel:[0,1,0] op_sel_hi:[1,1,1]
v_pk_mul_f32 v[76:77], v[76:77], v[124:125]
v_pk_mul_f32 v[78:79], v[78:79], v[126:127]
v_pk_fma_f32 v[76:77], v[140:141], v[168:169], v[76:77] op_sel:[0,1,0] op_sel_hi:[1,1,1]
v_pk_fma_f32 v[78:79], v[142:143], v[168:169], v[78:79] op_sel:[0,1,0] op_sel_hi:[1,1,1]
v_cvt_pk_bf16_f32 v68, v68, v69
v_cvt_pk_bf16_f32 v69, v70, v71
v_cvt_pk_bf16_f32 v70, v76, v77
v_cvt_pk_bf16_f32 v71, v78, v79
buffer_store_dwordx4 v[68:71], v15, s[20:23], s71 offen offset:2304 sc1
ds_write_b128 v15, v[68:71] offset:2304
v_add_u32 v5, s34, 17
s_mov_b64 exec, 1
ds_write_b32 v3, v5
s_mov_b64 exec, -1
s_mov_b32 s66, 0x3e8293ee
v_mul_f32 v144, s66, v144
v_mul_f32 v145, s66, v145
v_mul_f32 v146, s66, v146
v_mul_f32 v147, s66, v147
v_mul_f32 v148, s66, v148
v_mul_f32 v149, s66, v149
v_mul_f32 v150, s66, v150
v_mul_f32 v151, s66, v151
v_pk_mul_f32 v[96:97], v[96:97], v[148:149] op_sel:[0,0] op_sel_hi:[1,0]
v_pk_mul_f32 v[98:99], v[98:99], v[148:149] op_sel:[0,0] op_sel_hi:[1,0]
v_pk_mul_f32 v[100:101], v[100:101], v[148:149] op_sel:[0,0] op_sel_hi:[1,0]
v_pk_mul_f32 v[102:103], v[102:103], v[148:149] op_sel:[0,0] op_sel_hi:[1,0]
s_waitcnt lgkmcnt(9)
v_pk_fma_f32 v[96:97], v[160:161], v[148:149], v[96:97] op_sel:[0,1,0] op_sel_hi:[1,1,1]
v_pk_fma_f32 v[98:99], v[162:163], v[148:149], v[98:99] op_sel:[0,1,0] op_sel_hi:[1,1,1]
s_waitcnt lgkmcnt(8)
v_pk_fma_f32 v[100:101], v[164:165], v[148:149], v[100:101] op_sel:[0,1,0] op_sel_hi:[1,1,1]
v_pk_fma_f32 v[102:103], v[166:167], v[148:149], v[102:103] op_sel:[0,1,0] op_sel_hi:[1,1,1]
v_cvt_pk_bf16_f32 v96, v96, v97
v_cvt_pk_bf16_f32 v97, v98, v99
v_cvt_pk_bf16_f32 v98, v100, v101
v_cvt_pk_bf16_f32 v99, v102, v103
v_pk_mul_f32 v[104:105], v[104:105], v[150:151] op_sel:[0,0] op_sel_hi:[1,0]
v_pk_mul_f32 v[106:107], v[106:107], v[150:151] op_sel:[0,0] op_sel_hi:[1,0]
v_pk_mul_f32 v[108:109], v[108:109], v[150:151] op_sel:[0,0] op_sel_hi:[1,0]
v_pk_mul_f32 v[110:111], v[110:111], v[150:151] op_sel:[0,0] op_sel_hi:[1,0]
v_pk_fma_f32 v[104:105], v[160:161], v[150:151], v[104:105] op_sel:[0,1,0] op_sel_hi:[1,1,1]
v_pk_fma_f32 v[106:107], v[162:163], v[150:151], v[106:107] op_sel:[0,1,0] op_sel_hi:[1,1,1]
v_pk_fma_f32 v[108:109], v[164:165], v[150:151], v[108:109] op_sel:[0,1,0] op_sel_hi:[1,1,1]
v_pk_fma_f32 v[110:111], v[166:167], v[150:151], v[110:111] op_sel:[0,1,0] op_sel_hi:[1,1,1]
v_cvt_pk_bf16_f32 v104, v104, v105
v_cvt_pk_bf16_f32 v105, v106, v107
v_cvt_pk_bf16_f32 v106, v108, v109
v_cvt_pk_bf16_f32 v107, v110, v111
v_pk_mul_f32 v[80:81], v[80:81], v[144:145] op_sel:[0,0] op_sel_hi:[1,0]
v_pk_mul_f32 v[82:83], v[82:83], v[144:145] op_sel:[0,0] op_sel_hi:[1,0]
v_pk_mul_f32 v[84:85], v[84:85], v[144:145] op_sel:[0,0] op_sel_hi:[1,0]
v_pk_mul_f32 v[86:87], v[86:87], v[144:145] op_sel:[0,0] op_sel_hi:[1,0]
v_pk_fma_f32 v[80:81], v[160:161], v[144:145], v[80:81] op_sel:[0,1,0] op_sel_hi:[1,1,1]
v_pk_fma_f32 v[82:83], v[162:163], v[144:145], v[82:83] op_sel:[0,1,0] op_sel_hi:[1,1,1]
v_pk_fma_f32 v[84:85], v[164:165], v[144:145], v[84:85] op_sel:[0,1,0] op_sel_hi:[1,1,1]
v_pk_fma_f32 v[86:87], v[166:167], v[144:145], v[86:87] op_sel:[0,1,0] op_sel_hi:[1,1,1]
v_cvt_pk_bf16_f32 v80, v80, v81
v_cvt_pk_bf16_f32 v81, v82, v83
v_cvt_pk_bf16_f32 v82, v84, v85
v_cvt_pk_bf16_f32 v83, v86, v87
v_pk_mul_f32 v[88:89], v[88:89], v[146:147] op_sel:[0,0] op_sel_hi:[1,0]
v_pk_mul_f32 v[90:91], v[90:91], v[146:147] op_sel:[0,0] op_sel_hi:[1,0]
v_pk_mul_f32 v[92:93], v[92:93], v[146:147] op_sel:[0,0] op_sel_hi:[1,0]
v_pk_mul_f32 v[94:95], v[94:95], v[146:147] op_sel:[0,0] op_sel_hi:[1,0]
v_pk_fma_f32 v[88:89], v[160:161], v[146:147], v[88:89] op_sel:[0,1,0] op_sel_hi:[1,1,1]
v_pk_fma_f32 v[90:91], v[162:163], v[146:147], v[90:91] op_sel:[0,1,0] op_sel_hi:[1,1,1]
v_pk_fma_f32 v[92:93], v[164:165], v[146:147], v[92:93] op_sel:[0,1,0] op_sel_hi:[1,1,1]
v_pk_fma_f32 v[94:95], v[166:167], v[146:147], v[94:95] op_sel:[0,1,0] op_sel_hi:[1,1,1]
v_cvt_pk_bf16_f32 v88, v88, v89
v_cvt_pk_bf16_f32 v89, v90, v91
v_cvt_pk_bf16_f32 v90, v92, v93
v_cvt_pk_bf16_f32 v91, v94, v95
v_permlane16_swap_b32 v96, v104
v_permlane16_swap_b32 v97, v105
v_permlane16_swap_b32 v98, v106
v_permlane16_swap_b32 v99, v107
v_permlane16_swap_b32 v80, v88
v_permlane16_swap_b32 v81, v89
v_permlane16_swap_b32 v82, v90
v_permlane16_swap_b32 v83, v91
s_lshl_b32 s69, s64, 12
v_lshl_add_u32 v6, v0, 4, s69
v_add_u32 v7, 131072, v6
s_lshl_b32 s69, s65, 13
s_add_u32 s66, s69, 131072
s_sub_u32 s69, 147456, s69
v_add_u32 v8, s69, v6
ds_read_b128 v[152:155], v8 offset:8192
ds_read_b128 v[156:159], v8 offset:9216
s_mov_b32 s67, 122880
s_min_u32 s69, s59, 1
s_lshl2_add_u32 s68, s69, s65
s_cmp_ge_u32 s59, 2
s_cselect_b32 s69, s65, 0
s_add_u32 s68, s68, s69
ds_read_b128 v[160:163], v8 offset:10240
ds_read_b128 v[164:167], v8 offset:11264
s_waitcnt lgkmcnt(3)
v_mfma_f32_32x32x16_bf16 v[112:127], v[152:155], v[96:99], v[216:231]
s_waitcnt lgkmcnt(2)
v_mfma_f32_32x32x16_bf16 v[112:127], v[156:159], v[104:107], v[112:127]
s_add_u32 s35, s34, 17
lw_107:
ds_read_b32 v5, v1 offset:0
s_waitcnt lgkmcnt(0)
v_cmp_gt_i32 vcc, s35, v5
s_cbranch_vccz lwd_108
s_sub_u32 s32, s32, 1
s_cmp_gt_i32 s32, 0
s_cbranch_scc1 lw_107
lwd_108:
ds_read_b128 v[152:155], v8 offset:0
ds_read_b128 v[156:159], v8 offset:1024
.p2align 3
s_nop 4
v_exp_f32 v112, v112
v_exp_f32 v113, v113
v_exp_f32 v114, v114
v_exp_f32 v115, v115
v_exp_f32 v116, v116
v_exp_f32 v117, v117
s_waitcnt lgkmcnt(1)
v_mfma_f32_32x32x16_bf16 v[128:143], v[152:155], v[96:99], 0
v_exp_f32 v118, v118
v_exp_f32 v119, v119
v_cvt_pk_bf16_f32 v144, v112, v113
v_cvt_pk_bf16_f32 v145, v114, v115
s_waitcnt lgkmcnt(0)
v_mfma_f32_32x32x16_bf16 v[128:143], v[156:159], v[104:107], v[128:143]
ds_read_b128 v[152:155], v7 offset:8192
ds_read_b128 v[156:159], v7 offset:9216
v_cvt_pk_bf16_f32 v146, v116, v117
v_cvt_pk_bf16_f32 v147, v118, v119
v_exp_f32 v120, v120
v_exp_f32 v121, v121
v_mfma_f32_32x32x16_bf16 v[16:31], v[160:163], v[144:147], 0
ds_read_b128 v[160:163], v8 offset:2048
v_exp_f32 v122, v122
v_exp_f32 v123, v123
v_exp_f32 v124, v124
v_mfma_f32_16x16x32_bf16 v[32:35], v[212:215], v[144:147], 0
s_cmp_eq_u32 s65, 1
v_exp_f32 v125, v125
v_exp_f32 v126, v126
v_exp_f32 v127, v127
v_cvt_pk_bf16_f32 v148, v120, v121
v_cvt_pk_bf16_f32 v149, v122, v123
v_cvt_pk_bf16_f32 v150, v124, v125
v_cvt_pk_bf16_f32 v151, v126, v127
s_cbranch_scc1 at_109
v_exp_f32 v128, v128
v_exp_f32 v129, v129
v_mfma_f32_32x32x16_bf16 v[16:31], v[164:167], v[148:151], v[16:31]
ds_read_b128 v[164:167], v8 offset:3072
v_exp_f32 v130, v130
v_exp_f32 v131, v131
v_exp_f32 v132, v132
v_mfma_f32_16x16x32_bf16 v[32:35], v[212:215], v[148:151], v[32:35]
v_exp_f32 v133, v133
s_waitcnt lgkmcnt(3)
v_mfma_f32_32x32x16_bf16 v[112:127], v[152:155], v[96:99], 0
v_exp_f32 v134, v134
v_exp_f32 v135, v135
v_cvt_pk_bf16_f32 v144, v128, v129
v_cvt_pk_bf16_f32 v145, v130, v131
s_waitcnt lgkmcnt(2)
v_mfma_f32_32x32x16_bf16 v[112:127], v[156:159], v[104:107], v[112:127]
ds_read_b128 v[152:155], v7 offset:0
ds_read_b128 v[156:159], v7 offset:1024
v_cvt_pk_bf16_f32 v146, v132, v133
v_cvt_pk_bf16_f32 v147, v134, v135
v_exp_f32 v136, v136
v_exp_f32 v137, v137
s_waitcnt lgkmcnt(3)
v_mfma_f32_32x32x16_bf16 v[16:31], v[160:163], v[144:147], v[16:31]
ds_read_b128 v[160:163], v7 offset:10240
v_exp_f32 v138, v138
v_exp_f32 v139, v139
v_exp_f32 v140, v140
v_mfma_f32_16x16x32_bf16 v[32:35], v[212:215], v[144:147], v[32:35]
v_exp_f32 v141, v141
v_exp_f32 v142, v142
v_exp_f32 v143, v143
v_cvt_pk_bf16_f32 v148, v136, v137
v_cvt_pk_bf16_f32 v149, v138, v139
v_cvt_pk_bf16_f32 v150, v140, v141
v_cvt_pk_bf16_f32 v151, v142, v143
v_exp_f32 v112, v112
v_exp_f32 v113, v113
s_waitcnt lgkmcnt(3)
v_mfma_f32_32x32x16_bf16 v[16:31], v[164:167], v[148:151], v[16:31]
ds_read_b128 v[164:167], v7 offset:11264
v_exp_f32 v114, v114
v_exp_f32 v115, v115
v_exp_f32 v116, v116
v_mfma_f32_16x16x32_bf16 v[32:35], v[212:215], v[148:151], v[32:35]
v_exp_f32 v117, v117
s_waitcnt lgkmcnt(3)
v_mfma_f32_32x32x16_bf16 v[128:143], v[152:155], v[96:99], 0
v_exp_f32 v118, v118
v_exp_f32 v119, v119
v_cvt_pk_bf16_f32 v144, v112, v113
v_cvt_pk_bf16_f32 v145, v114, v115
s_waitcnt lgkmcnt(2)
v_mfma_f32_32x32x16_bf16 v[128:143], v[156:159], v[104:107], v[128:143]
v_cvt_pk_bf16_f32 v146, v116, v117
v_cvt_pk_bf16_f32 v147, v118, v119
v_exp_f32 v120, v120
v_exp_f32 v121, v121
s_waitcnt lgkmcnt(1)
v_mfma_f32_32x32x16_bf16 v[16:31], v[160:163], v[144:147], v[16:31]
ds_read_b128 v[160:163], v7 offset:2048
v_exp_f32 v122, v122
v_exp_f32 v123, v123
v_exp_f32 v124, v124
v_mfma_f32_16x16x32_bf16 v[32:35], v[212:215], v[144:147], v[32:35]
v_mov_b32 v8, v7
v_exp_f32 v125, v125
v_exp_f32 v126, v126
v_exp_f32 v127, v127
v_cvt_pk_bf16_f32 v148, v120, v121
v_cvt_pk_bf16_f32 v149, v122, v123
v_cvt_pk_bf16_f32 v150, v124, v125
v_cvt_pk_bf16_f32 v151, v126, v127
.p2align 3
at_109:
v_exp_f32 v128, v128
v_exp_f32 v129, v129
s_waitcnt lgkmcnt(1)
v_mfma_f32_32x32x16_bf16 v[16:31], v[164:167], v[148:151], v[16:31]
ds_read_b128 v[164:167], v8 offset:3072
v_exp_f32 v130, v130
v_exp_f32 v131, v131
v_exp_f32 v132, v132
v_mfma_f32_16x16x32_bf16 v[32:35], v[212:215], v[148:151], v[32:35]
v_exp_f32 v133, v133
v_mfma_f32_32x32x16_bf16 v[112:127], v[152:155], v[80:83], v[216:231]
v_exp_f32 v134, v134
v_exp_f32 v135, v135
v_cvt_pk_bf16_f32 v144, v128, v129
v_cvt_pk_bf16_f32 v145, v130, v131
v_mfma_f32_32x32x16_bf16 v[112:127], v[156:159], v[88:91], v[112:127]
s_sub_u32 s66, s66, 8192
s_cmp_eq_u32 s66, s67
s_cbranch_scc1 cross_116
cback_117:
v_add_u32 v8, s66, v6
ds_read_b128 v[152:155], v8 offset:0
ds_read_b128 v[156:159], v8 offset:1024
v_cvt_pk_bf16_f32 v146, v132, v133
v_cvt_pk_bf16_f32 v147, v134, v135
v_exp_f32 v136, v136
v_exp_f32 v137, v137
s_waitcnt lgkmcnt(3)
v_mfma_f32_32x32x16_bf16 v[16:31], v[160:163], v[144:147], v[16:31]
v_exp_f32 v138, v138
v_exp_f32 v139, v139
v_exp_f32 v140, v140
v_mfma_f32_16x16x32_bf16 v[32:35], v[212:215], v[144:147], v[32:35]
s_cmp_eq_u32 s68, 0
v_exp_f32 v141, v141
v_exp_f32 v142, v142
v_exp_f32 v143, v143
v_cvt_pk_bf16_f32 v148, v136, v137
v_cvt_pk_bf16_f32 v149, v138, v139
v_cvt_pk_bf16_f32 v150, v140, v141
v_cvt_pk_bf16_f32 v151, v142, v143
s_cbranch_scc1 at_113
.p2align 3
at_110:
v_exp_f32 v112, v112
v_exp_f32 v113, v113
s_waitcnt lgkmcnt(2)
v_mfma_f32_32x32x16_bf16 v[16:31], v[164:167], v[148:151], v[16:31]
v_exp_f32 v114, v114
v_exp_f32 v115, v115
v_exp_f32 v116, v116
v_mfma_f32_16x16x32_bf16 v[32:35], v[212:215], v[148:151], v[32:35]
v_exp_f32 v117, v117
s_waitcnt lgkmcnt(1)
v_mfma_f32_32x32x16_bf16 v[128:143], v[152:155], v[96:99], 0
v_exp_f32 v118, v118
v_exp_f32 v119, v119
v_cvt_pk_bf16_f32 v144, v112, v113
v_cvt_pk_bf16_f32 v145, v114, v115
s_waitcnt lgkmcnt(0)
v_mfma_f32_32x32x16_bf16 v[128:143], v[156:159], v[104:107], v[128:143]
v_cvt_pk_bf16_f32 v146, v116, v117
v_cvt_pk_bf16_f32 v147, v118, v119
v_exp_f32 v120, v120
v_exp_f32 v121, v121
v_mfma_f32_32x32x16_bf16 v[192:207], v[160:163], v[144:147], v[192:207]
ds_read_b128 v[160:163], v8 offset:2048
v_exp_f32 v122, v122
v_exp_f32 v123, v123
v_exp_f32 v124, v124
v_mfma_f32_16x16x32_bf16 v[208:211], v[212:215], v[144:147], v[208:211]
v_exp_f32 v125, v125
v_exp_f32 v126, v126
v_exp_f32 v127, v127
v_cvt_pk_bf16_f32 v148, v120, v121
v_cvt_pk_bf16_f32 v149, v122, v123
v_cvt_pk_bf16_f32 v150, v124, v125
v_cvt_pk_bf16_f32 v151, v126, v127
v_exp_f32 v128, v128
v_exp_f32 v129, v129
v_mfma_f32_32x32x16_bf16 v[192:207], v[164:167], v[148:151], v[192:207]
ds_read_b128 v[164:167], v8 offset:3072
v_exp_f32 v130, v130
v_exp_f32 v131, v131
v_exp_f32 v132, v132
v_mfma_f32_16x16x32_bf16 v[208:211], v[212:215], v[148:151], v[208:211]
v_exp_f32 v133, v133
v_mfma_f32_32x32x16_bf16 v[112:127], v[152:155], v[80:83], 0
v_exp_f32 v134, v134
v_exp_f32 v135, v135
v_cvt_pk_bf16_f32 v144, v128, v129
v_cvt_pk_bf16_f32 v145, v130, v131
v_mfma_f32_32x32x16_bf16 v[112:127], v[156:159], v[88:91], v[112:127]
s_sub_u32 s66, s66, 8192
s_cmp_eq_u32 s66, s67
s_cbranch_scc1 cross_118
cback_119:
v_add_u32 v8, s66, v6
ds_read_b128 v[152:155], v8 offset:0
ds_read_b128 v[156:159], v8 offset:1024
v_cvt_pk_bf16_f32 v146, v132, v133
v_cvt_pk_bf16_f32 v147, v134, v135
v_exp_f32 v136, v136
v_exp_f32 v137, v137
s_waitcnt lgkmcnt(3)
v_mfma_f32_32x32x16_bf16 v[16:31], v[160:163], v[144:147], v[16:31]
v_exp_f32 v138, v138
v_exp_f32 v139, v139
v_exp_f32 v140, v140
v_mfma_f32_16x16x32_bf16 v[32:35], v[212:215], v[144:147], v[32:35]
s_sub_u32 s68, s68, 1
s_cmp_eq_u32 s68, 0
v_exp_f32 v141, v141
v_exp_f32 v142, v142
v_exp_f32 v143, v143
v_cvt_pk_bf16_f32 v148, v136, v137
v_cvt_pk_bf16_f32 v149, v138, v139
v_cvt_pk_bf16_f32 v150, v140, v141
v_cvt_pk_bf16_f32 v151, v142, v143
s_cbranch_scc0 at_110
s_cmp_lt_u32 s59, 2
s_cbranch_scc1 at_113
.p2align 3
v_exp_f32 v112, v112
v_exp_f32 v113, v113
s_waitcnt lgkmcnt(2)
v_mfma_f32_32x32x16_bf16 v[16:31], v[164:167], v[148:151], v[16:31]
v_exp_f32 v114, v114
v_exp_f32 v115, v115
v_exp_f32 v116, v116
v_mfma_f32_16x16x32_bf16 v[32:35], v[212:215], v[148:151], v[32:35]
v_exp_f32 v117, v117
s_waitcnt lgkmcnt(1)
v_mfma_f32_32x32x16_bf16 v[128:143], v[152:155], v[96:99], v[216:231]
v_exp_f32 v118, v118
v_exp_f32 v119, v119
v_cvt_pk_bf16_f32 v144, v112, v113
v_cvt_pk_bf16_f32 v145, v114, v115
s_waitcnt lgkmcnt(0)
v_mfma_f32_32x32x16_bf16 v[128:143], v[156:159], v[104:107], v[128:143]
v_cvt_pk_bf16_f32 v146, v116, v117
v_cvt_pk_bf16_f32 v147, v118, v119
v_exp_f32 v120, v120
v_exp_f32 v121, v121
v_mfma_f32_32x32x16_bf16 v[192:207], v[160:163], v[144:147], v[192:207]
ds_read_b128 v[160:163], v8 offset:2048
v_exp_f32 v122, v122
v_exp_f32 v123, v123
v_exp_f32 v124, v124
v_mfma_f32_16x16x32_bf16 v[208:211], v[212:215], v[144:147], v[208:211]
v_exp_f32 v125, v125
v_exp_f32 v126, v126
v_exp_f32 v127, v127
v_cvt_pk_bf16_f32 v148, v120, v121
v_cvt_pk_bf16_f32 v149, v122, v123
v_cvt_pk_bf16_f32 v150, v124, v125
v_cvt_pk_bf16_f32 v151, v126, v127
v_exp_f32 v128, v128
v_exp_f32 v129, v129
v_mfma_f32_32x32x16_bf16 v[192:207], v[164:167], v[148:151], v[192:207]
ds_read_b128 v[164:167], v8 offset:3072
v_exp_f32 v130, v130
v_exp_f32 v131, v131
v_exp_f32 v132, v132
v_mfma_f32_16x16x32_bf16 v[208:211], v[212:215], v[148:151], v[208:211]
v_exp_f32 v133, v133
v_mfma_f32_32x32x16_bf16 v[112:127], v[152:155], v[80:83], 0
v_exp_f32 v134, v134
v_exp_f32 v135, v135
v_cvt_pk_bf16_f32 v144, v128, v129
v_cvt_pk_bf16_f32 v145, v130, v131
v_mfma_f32_32x32x16_bf16 v[112:127], v[156:159], v[88:91], v[112:127]
v_subrev_u32 v8, 8192, v8
ds_read_b128 v[152:155], v8 offset:0
ds_read_b128 v[156:159], v8 offset:1024
v_cvt_pk_bf16_f32 v146, v132, v133
v_cvt_pk_bf16_f32 v147, v134, v135
v_exp_f32 v136, v136
v_exp_f32 v137, v137
s_waitcnt lgkmcnt(3)
v_mfma_f32_32x32x16_bf16 v[16:31], v[160:163], v[144:147], v[16:31]
v_exp_f32 v138, v138
v_exp_f32 v139, v139
v_exp_f32 v140, v140
v_mfma_f32_16x16x32_bf16 v[32:35], v[212:215], v[144:147], v[32:35]
s_cmp_eq_u32 s65, 1
v_exp_f32 v141, v141
v_exp_f32 v142, v142
v_exp_f32 v143, v143
v_cvt_pk_bf16_f32 v148, v136, v137
v_cvt_pk_bf16_f32 v149, v138, v139
v_cvt_pk_bf16_f32 v150, v140, v141
v_cvt_pk_bf16_f32 v151, v142, v143
s_cbranch_scc1 at_112
.p2align 3
v_exp_f32 v112, v112
v_exp_f32 v113, v113
s_waitcnt lgkmcnt(2)
v_mfma_f32_32x32x16_bf16 v[16:31], v[164:167], v[148:151], v[16:31]
v_exp_f32 v114, v114
v_exp_f32 v115, v115
v_exp_f32 v116, v116
v_mfma_f32_16x16x32_bf16 v[32:35], v[212:215], v[148:151], v[32:35]
v_exp_f32 v117, v117
s_waitcnt lgkmcnt(1)
v_mfma_f32_32x32x16_bf16 v[128:143], v[152:155], v[80:83], 0
v_exp_f32 v118, v118
v_exp_f32 v119, v119
v_cvt_pk_bf16_f32 v144, v112, v113
v_cvt_pk_bf16_f32 v145, v114, v115
s_waitcnt lgkmcnt(0)
v_mfma_f32_32x32x16_bf16 v[128:143], v[156:159], v[88:91], v[128:143]
v_subrev_u32 v8, 8192, v8
ds_read_b128 v[152:155], v8 offset:0
ds_read_b128 v[156:159], v8 offset:1024
v_cvt_pk_bf16_f32 v146, v116, v117
v_cvt_pk_bf16_f32 v147, v118, v119
v_exp_f32 v120, v120
v_exp_f32 v121, v121
v_mfma_f32_32x32x16_bf16 v[192:207], v[160:163], v[144:147], v[192:207]
ds_read_b128 v[160:163], v8 offset:10240
v_exp_f32 v122, v122
v_exp_f32 v123, v123
v_exp_f32 v124, v124
v_mfma_f32_16x16x32_bf16 v[208:211], v[212:215], v[144:147], v[208:211]
v_exp_f32 v125, v125
v_exp_f32 v126, v126
v_exp_f32 v127, v127
v_cvt_pk_bf16_f32 v148, v120, v121
v_cvt_pk_bf16_f32 v149, v122, v123
v_cvt_pk_bf16_f32 v150, v124, v125
v_cvt_pk_bf16_f32 v151, v126, v127
v_exp_f32 v128, v128
v_exp_f32 v129, v129
v_mfma_f32_32x32x16_bf16 v[192:207], v[164:167], v[148:151], v[192:207]
ds_read_b128 v[164:167], v8 offset:11264
v_exp_f32 v130, v130
v_exp_f32 v131, v131
v_exp_f32 v132, v132
v_mfma_f32_16x16x32_bf16 v[208:211], v[212:215], v[148:151], v[208:211]
v_exp_f32 v133, v133
s_waitcnt lgkmcnt(3)
v_mfma_f32_32x32x16_bf16 v[112:127], v[152:155], v[80:83], 0
v_exp_f32 v134, v134
v_exp_f32 v135, v135
v_cvt_pk_bf16_f32 v144, v128, v129
v_cvt_pk_bf16_f32 v145, v130, v131
s_waitcnt lgkmcnt(2)
v_mfma_f32_32x32x16_bf16 v[112:127], v[156:159], v[88:91], v[112:127]
v_subrev_u32 v8, 8192, v8
ds_read_b128 v[152:155], v8 offset:0
ds_read_b128 v[156:159], v8 offset:1024
v_cvt_pk_bf16_f32 v146, v132, v133
v_cvt_pk_bf16_f32 v147, v134, v135
v_exp_f32 v136, v136
v_exp_f32 v137, v137
s_waitcnt lgkmcnt(3)
v_mfma_f32_32x32x16_bf16 v[192:207], v[160:163], v[144:147], v[192:207]
ds_read_b128 v[160:163], v8 offset:10240
v_exp_f32 v138, v138
v_exp_f32 v139, v139
v_exp_f32 v140, v140
v_mfma_f32_16x16x32_bf16 v[208:211], v[212:215], v[144:147], v[208:211]
v_exp_f32 v141, v141
v_exp_f32 v142, v142
v_exp_f32 v143, v143
v_cvt_pk_bf16_f32 v148, v136, v137
v_cvt_pk_bf16_f32 v149, v138, v139
v_cvt_pk_bf16_f32 v150, v140, v141
v_cvt_pk_bf16_f32 v151, v142, v143
v_exp_f32 v112, v112
v_exp_f32 v113, v113
s_waitcnt lgkmcnt(3)
v_mfma_f32_32x32x16_bf16 v[192:207], v[164:167], v[148:151], v[192:207]
ds_read_b128 v[164:167], v8 offset:11264
v_exp_f32 v114, v114
v_exp_f32 v115, v115
v_exp_f32 v116, v116
v_mfma_f32_16x16x32_bf16 v[208:211], v[212:215], v[148:151], v[208:211]
v_exp_f32 v117, v117
s_waitcnt lgkmcnt(3)
v_mfma_f32_32x32x16_bf16 v[128:143], v[152:155], v[80:83], v[216:231]
v_exp_f32 v118, v118
v_exp_f32 v119, v119
v_cvt_pk_bf16_f32 v144, v112, v113
v_cvt_pk_bf16_f32 v145, v114, v115
s_waitcnt lgkmcnt(2)
v_mfma_f32_32x32x16_bf16 v[128:143], v[156:159], v[88:91], v[128:143]
v_cvt_pk_bf16_f32 v146, v116, v117
v_cvt_pk_bf16_f32 v147, v118, v119
v_exp_f32 v120, v120
v_exp_f32 v121, v121
s_waitcnt lgkmcnt(1)
v_mfma_f32_32x32x16_bf16 v[192:207], v[160:163], v[144:147], v[192:207]
ds_read_b128 v[160:163], v8 offset:2048
v_exp_f32 v122, v122
v_exp_f32 v123, v123
v_exp_f32 v124, v124
v_mfma_f32_16x16x32_bf16 v[208:211], v[212:215], v[144:147], v[208:211]
v_exp_f32 v125, v125
v_exp_f32 v126, v126
v_exp_f32 v127, v127
v_cvt_pk_bf16_f32 v148, v120, v121
v_cvt_pk_bf16_f32 v149, v122, v123
v_cvt_pk_bf16_f32 v150, v124, v125
v_cvt_pk_bf16_f32 v151, v126, v127
s_branch at_114
.p2align 3
at_113:
v_add_u32 v5, s34, 20
s_mov_b64 exec, 1
ds_write_b32 v3, v5
s_mov_b64 exec, -1
v_exp_f32 v112, v112
v_exp_f32 v113, v113
s_waitcnt lgkmcnt(3)
v_mfma_f32_32x32x16_bf16 v[16:31], v[164:167], v[148:151], v[16:31]
v_exp_f32 v114, v114
v_exp_f32 v115, v115
v_exp_f32 v116, v116
v_mfma_f32_16x16x32_bf16 v[32:35], v[212:215], v[148:151], v[32:35]
v_exp_f32 v117, v117
v_exp_f32 v118, v118
v_exp_f32 v119, v119
v_cvt_pk_bf16_f32 v144, v112, v113
v_cvt_pk_bf16_f32 v145, v114, v115
v_cvt_pk_bf16_f32 v146, v116, v117
v_cvt_pk_bf16_f32 v147, v118, v119
v_exp_f32 v120, v120
v_exp_f32 v121, v121
v_mfma_f32_32x32x16_bf16 v[192:207], v[160:163], v[144:147], v[192:207]
v_exp_f32 v122, v122
v_exp_f32 v123, v123
v_exp_f32 v124, v124
v_mfma_f32_16x16x32_bf16 v[208:211], v[212:215], v[144:147], v[208:211]
v_exp_f32 v125, v125
v_exp_f32 v126, v126
v_exp_f32 v127, v127
v_cvt_pk_bf16_f32 v148, v120, v121
v_cvt_pk_bf16_f32 v149, v122, v123
v_cvt_pk_bf16_f32 v150, v124, v125
v_cvt_pk_bf16_f32 v151, v126, v127
s_branch at_115
.p2align 3
at_112:
v_exp_f32 v112, v112
v_exp_f32 v113, v113
s_waitcnt lgkmcnt(2)
v_mfma_f32_32x32x16_bf16 v[16:31], v[164:167], v[148:151], v[16:31]
v_exp_f32 v114, v114
v_exp_f32 v115, v115
v_exp_f32 v116, v116
v_mfma_f32_16x16x32_bf16 v[32:35], v[212:215], v[148:151], v[32:35]
v_exp_f32 v117, v117
s_waitcnt lgkmcnt(1)
v_mfma_f32_32x32x16_bf16 v[128:143], v[152:155], v[80:83], v[216:231]
v_exp_f32 v118, v118
v_exp_f32 v119, v119
v_cvt_pk_bf16_f32 v144, v112, v113
v_cvt_pk_bf16_f32 v145, v114, v115
s_waitcnt lgkmcnt(0)
v_mfma_f32_32x32x16_bf16 v[128:143], v[156:159], v[88:91], v[128:143]
v_cvt_pk_bf16_f32 v146, v116, v117
v_cvt_pk_bf16_f32 v147, v118, v119
v_exp_f32 v120, v120
v_exp_f32 v121, v121
v_mfma_f32_32x32x16_bf16 v[192:207], v[160:163], v[144:147], v[192:207]
ds_read_b128 v[160:163], v8 offset:2048
v_exp_f32 v122, v122
v_exp_f32 v123, v123
v_exp_f32 v124, v124
v_mfma_f32_16x16x32_bf16 v[208:211], v[212:215], v[144:147], v[208:211]
v_exp_f32 v125, v125
v_exp_f32 v126, v126
v_exp_f32 v127, v127
v_cvt_pk_bf16_f32 v148, v120, v121
v_cvt_pk_bf16_f32 v149, v122, v123
v_cvt_pk_bf16_f32 v150, v124, v125
v_cvt_pk_bf16_f32 v151, v126, v127
.p2align 3
at_114:
v_exp_f32 v128, v128
v_exp_f32 v129, v129
s_waitcnt lgkmcnt(1)
v_mfma_f32_32x32x16_bf16 v[192:207], v[164:167], v[148:151], v[192:207]
ds_read_b128 v[164:167], v8 offset:3072
v_exp_f32 v130, v130
v_exp_f32 v131, v131
v_exp_f32 v132, v132
v_mfma_f32_16x16x32_bf16 v[208:211], v[212:215], v[148:151], v[208:211]
v_exp_f32 v133, v133
v_exp_f32 v134, v134
v_exp_f32 v135, v135
v_cvt_pk_bf16_f32 v144, v128, v129
v_cvt_pk_bf16_f32 v145, v130, v131
v_add_u32 v5, s34, 20
s_mov_b64 exec, 1
ds_write_b32 v3, v5
s_mov_b64 exec, -1
v_cvt_pk_bf16_f32 v146, v132, v133
v_cvt_pk_bf16_f32 v147, v134, v135
v_exp_f32 v136, v136
v_exp_f32 v137, v137
s_waitcnt lgkmcnt(2)
v_mfma_f32_32x32x16_bf16 v[192:207], v[160:163], v[144:147], v[192:207]
v_exp_f32 v138, v138
v_exp_f32 v139, v139
v_exp_f32 v140, v140
v_mfma_f32_16x16x32_bf16 v[208:211], v[212:215], v[144:147], v[208:211]
v_exp_f32 v141, v141
v_exp_f32 v142, v142
v_exp_f32 v143, v143
v_cvt_pk_bf16_f32 v148, v136, v137
v_cvt_pk_bf16_f32 v149, v138, v139
v_cvt_pk_bf16_f32 v150, v140, v141
v_cvt_pk_bf16_f32 v151, v142, v143
at_115:
s_lshl_b32 s66, s59, 18
s_lshl_b32 s67, s63, 22
v_mfma_f32_16x16x32_bf16 v[208:211], v[212:215], v[148:151], v[208:211]
s_add_u32 s66, s66, s67
s_lshl1_add_u32 s67, s60, s64
s_waitcnt lgkmcnt(1)
v_mfma_f32_32x32x16_bf16 v[192:207], v[164:167], v[148:151], v[192:207]
s_lshl_b32 s67, s67, 11
s_add_u32 s66, s66, s67
s_lshl_b32 s68, s65, 16
s_add_u32 s67, s66, 18022400
s_sub_u32 s67, s67, s68
s_add_u32 s66, s66, s68
s_add_u32 s66, s66, 17825792
v_lshlrev_b32 v9, 4, v0
v_subrev_u32 v10, 0x2f800000, v32
v_subrev_u32 v11, 0x2f800000, v208
v_max_u32 v10, v10, v11
v_cmp_lt_u32 vcc, 0x20000000, v10
s_cbranch_vccnz slow_120
sback_121:
s_nop 1
v_rcp_f32 v12, v32
s_nop 1
v_pk_mul_f32 v[16:17], v[16:17], v[12:13] op_sel:[0,0] op_sel_hi:[1,0]
v_pk_mul_f32 v[18:19], v[18:19], v[12:13] op_sel:[0,0] op_sel_hi:[1,0]
v_pk_mul_f32 v[20:21], v[20:21], v[12:13] op_sel:[0,0] op_sel_hi:[1,0]
v_pk_mul_f32 v[22:23], v[22:23], v[12:13] op_sel:[0,0] op_sel_hi:[1,0]
v_pk_mul_f32 v[24:25], v[24:25], v[12:13] op_sel:[0,0] op_sel_hi:[1,0]
v_pk_mul_f32 v[26:27], v[26:27], v[12:13] op_sel:[0,0] op_sel_hi:[1,0]
v_pk_mul_f32 v[28:29], v[28:29], v[12:13] op_sel:[0,0] op_sel_hi:[1,0]
v_pk_mul_f32 v[30:31], v[30:31], v[12:13] op_sel:[0,0] op_sel_hi:[1,0]
v_cvt_pk_bf16_f32 v16, v16, v17
v_cvt_pk_bf16_f32 v17, v18, v19
v_cvt_pk_bf16_f32 v18, v20, v21
v_cvt_pk_bf16_f32 v19, v22, v23
v_cvt_pk_bf16_f32 v20, v24, v25
v_cvt_pk_bf16_f32 v21, v26, v27
v_cvt_pk_bf16_f32 v22, v28, v29
v_cvt_pk_bf16_f32 v23, v30, v31
buffer_store_dwordx4 v[16:19], v9, s[20:23], s67 offen offset:0 sc1
buffer_store_dwordx4 v[20:23], v9, s[20:23], s67 offen offset:1024 sc1
v_rcp_f32 v12, v208
s_nop 0
v_pk_mul_f32 v[192:193], v[192:193], v[12:13] op_sel:[0,0] op_sel_hi:[1,0]
v_pk_mul_f32 v[194:195], v[194:195], v[12:13] op_sel:[0,0] op_sel_hi:[1,0]
v_pk_mul_f32 v[196:197], v[196:197], v[12:13] op_sel:[0,0] op_sel_hi:[1,0]
v_pk_mul_f32 v[198:199], v[198:199], v[12:13] op_sel:[0,0] op_sel_hi:[1,0]
v_pk_mul_f32 v[200:201], v[200:201], v[12:13] op_sel:[0,0] op_sel_hi:[1,0]
v_pk_mul_f32 v[202:203], v[202:203], v[12:13] op_sel:[0,0] op_sel_hi:[1,0]
v_pk_mul_f32 v[204:205], v[204:205], v[12:13] op_sel:[0,0] op_sel_hi:[1,0]
v_pk_mul_f32 v[206:207], v[206:207], v[12:13] op_sel:[0,0] op_sel_hi:[1,0]
v_cvt_pk_bf16_f32 v192, v192, v193
v_cvt_pk_bf16_f32 v193, v194, v195
v_cvt_pk_bf16_f32 v194, v196, v197
v_cvt_pk_bf16_f32 v195, v198, v199
v_cvt_pk_bf16_f32 v196, v200, v201
v_cvt_pk_bf16_f32 v197, v202, v203
v_cvt_pk_bf16_f32 v198, v204, v205
v_cvt_pk_bf16_f32 v199, v206, v207
buffer_store_dwordx4 v[192:195], v9, s[20:23], s66 offen offset:0 sc1
buffer_store_dwordx4 v[196:199], v9, s[20:23], s66 offen offset:1024 sc1
v_bfe_u32 v48, v0, 2, 3
v_lshrrev_b32 v49, 5, v0
v_lshl_add_u32 v48, v49, 4, v48
v_lshlrev_b32 v48, 7, v48
v_bfe_u32 v49, v0, 3, 2
v_lshl_add_u32 v48, v49, 5, v48
v_and_b32 v49, 3, v0
v_lshl_add_u32 v48, v49, 3, v48
v_add_u32 v8, 32768, v48
v_xor_b32 v9, 32, v8
v_xor_b32 v10, 64, v8
v_xor_b32 v11, 96, v8
v_add_u32 v12, 0x10000, v8
v_add_u32 v13, 0x10000, v9
v_add_u32 v14, 0x10000, v10
v_add_u32 v15, 0x10000, v11
v_and_b32 v48, 15, v0
v_lshrrev_b32 v49, 4, v0
s_lshl2_add_u32 s66, s61, s58
s_lshl_b32 s67, s66, 16
s_lshl_b32 s68, s63, 22
s_add_u32 s67, s67, s68
s_add_u32 s67, s67, 17825792
v_lshl_add_u32 v6, v48, 4, s67
v_lshl_add_u32 v6, v49, 9, v6
s_add_u32 s70, s72, 327680
s_mov_b64 exec, 1
s_waitcnt vmcnt(0)
buffer_store_dword v212, v3, s[24:27], s70 offen sc1
s_mov_b64 exec, -1
v_add_u32 v5, s34, 21
s_mov_b64 exec, 1
ds_write_b32 v3, v5
s_mov_b64 exec, -1
s_cmp_eq_u32 s63, 0
s_cbranch_scc0 mo_122
v_permlane16_swap_b32 v240, v242
v_permlane16_swap_b32 v241, v243
v_permlane16_swap_b32 v244, v246
v_permlane16_swap_b32 v245, v247
v_permlane16_swap_b32 v248, v250
v_permlane16_swap_b32 v249, v251
v_permlane16_swap_b32 v252, v254
v_permlane16_swap_b32 v253, v255
mo_123:
v_lshlrev_b32 v16, 16, v240
v_and_b32 v17, 0xffff0000, v240
v_lshlrev_b32 v18, 16, v241
v_and_b32 v19, 0xffff0000, v241
v_lshlrev_b32 v20, 16, v242
v_and_b32 v21, 0xffff0000, v242
v_lshlrev_b32 v22, 16, v243
v_and_b32 v23, 0xffff0000, v243
v_lshlrev_b32 v24, 16, v244
v_and_b32 v25, 0xffff0000, v244
v_lshlrev_b32 v26, 16, v245
v_and_b32 v27, 0xffff0000, v245
v_lshlrev_b32 v28, 16, v246
v_and_b32 v29, 0xffff0000, v246
v_lshlrev_b32 v30, 16, v247
v_and_b32 v31, 0xffff0000, v247
v_lshlrev_b32 v32, 16, v248
v_and_b32 v33, 0xffff0000, v248
v_lshlrev_b32 v34, 16, v249
v_and_b32 v35, 0xffff0000, v249
v_lshlrev_b32 v36, 16, v250
v_and_b32 v37, 0xffff0000, v250
v_lshlrev_b32 v38, 16, v251
v_and_b32 v39, 0xffff0000, v251
v_lshlrev_b32 v40, 16, v252
v_and_b32 v41, 0xffff0000, v252
v_lshlrev_b32 v42, 16, v253
v_and_b32 v43, 0xffff0000, v253
v_lshlrev_b32 v44, 16, v254
v_and_b32 v45, 0xffff0000, v254
v_lshlrev_b32 v46, 16, v255
v_and_b32 v47, 0xffff0000, v255
s_add_u32 s66, s61, s62
s_and_b32 s66, s66, 15
s_lshl_b32 s66, s66, 12
s_add_u32 s35, s34, 18
lw_124:
ds_read_b32 v5, v2 offset:16
s_waitcnt lgkmcnt(0)
v_cmp_gt_i32 vcc, s35, v5
s_cbranch_vccz lwd_125
s_sub_u32 s32, s32, 1
s_cmp_gt_i32 s32, 0
s_cbranch_scc1 lw_124
lwd_125:
buffer_load_dwordx4 v[80:83], v6, s[20:23], s66 offen offset:0 sc1
buffer_load_dwordx4 v[88:91], v6, s[20:23], s66 offen offset:2048 sc1
buffer_load_dwordx4 v[84:87], v6, s[20:23], s66 offen offset:256 sc1
buffer_load_dwordx4 v[92:95], v6, s[20:23], s66 offen offset:2304 sc1
s_add_u32 s66, s66, 4096
s_and_b32 s66, s66, 0xffff
ds_read_b64_tr_b16 v[48:49], v8 offset:0
ds_read_b64_tr_b16 v[50:51], v8 offset:1024
ds_read_b64_tr_b16 v[52:53], v8 offset:4096
ds_read_b64_tr_b16 v[54:55], v8 offset:5120
buffer_load_dwordx4 v[96:99], v6, s[20:23], s66 offen offset:0 sc1
buffer_load_dwordx4 v[104:107], v6, s[20:23], s66 offen offset:2048 sc1
buffer_load_dwordx4 v[100:103], v6, s[20:23], s66 offen offset:256 sc1
buffer_load_dwordx4 v[108:111], v6, s[20:23], s66 offen offset:2304 sc1
s_add_u32 s66, s66, 4096
s_and_b32 s66, s66, 0xffff
ds_read_b64_tr_b16 v[56:57], v9 offset:0
ds_read_b64_tr_b16 v[58:59], v9 offset:1024
ds_read_b64_tr_b16 v[60:61], v9 offset:4096
ds_read_b64_tr_b16 v[62:63], v9 offset:5120
buffer_load_dwordx4 v[112:115], v6, s[20:23], s66 offen offset:0 sc1
buffer_load_dwordx4 v[120:123], v6, s[20:23], s66 offen offset:2048 sc1
buffer_load_dwordx4 v[116:119], v6, s[20:23], s66 offen offset:256 sc1
buffer_load_dwordx4 v[124:127], v6, s[20:23], s66 offen offset:2304 sc1
s_add_u32 s66, s66, 4096
s_and_b32 s66, s66, 0xffff
ds_read_b64_tr_b16 v[64:65], v10 offset:0
ds_read_b64_tr_b16 v[66:67], v10 offset:1024
ds_read_b64_tr_b16 v[68:69], v10 offset:4096
ds_read_b64_tr_b16 v[70:71], v10 offset:5120
buffer_load_dwordx4 v[128:131], v6, s[20:23], s66 offen offset:0 sc1
buffer_load_dwordx4 v[136:139], v6, s[20:23], s66 offen offset:2048 sc1
buffer_load_dwordx4 v[132:135], v6, s[20:23], s66 offen offset:256 sc1
buffer_load_dwordx4 v[140:143], v6, s[20:23], s66 offen offset:2304 sc1
s_add_u32 s66, s66, 4096
s_and_b32 s66, s66, 0xffff
buffer_load_dwordx4 v[144:147], v6, s[20:23], s66 offen offset:0 sc1
buffer_load_dwordx4 v[152:155], v6, s[20:23], s66 offen offset:2048 sc1
buffer_load_dwordx4 v[148:151], v6, s[20:23], s66 offen offset:256 sc1
buffer_load_dwordx4 v[156:159], v6, s[20:23], s66 offen offset:2304 sc1
s_add_u32 s66, s66, 4096
s_and_b32 s66, s66, 0xffff
buffer_load_dwordx4 v[160:163], v6, s[20:23], s66 offen offset:0 sc1
buffer_load_dwordx4 v[168:171], v6, s[20:23], s66 offen offset:2048 sc1
buffer_load_dwordx4 v[164:167], v6, s[20:23], s66 offen offset:256 sc1
buffer_load_dwordx4 v[172:175], v6, s[20:23], s66 offen offset:2304 sc1
s_add_u32 s66, s66, 4096
s_and_b32 s66, s66, 0xffff
buffer_load_dwordx4 v[176:179], v6, s[20:23], s66 offen offset:0 sc1
buffer_load_dwordx4 v[184:187], v6, s[20:23], s66 offen offset:2048 sc1
buffer_load_dwordx4 v[180:183], v6, s[20:23], s66 offen offset:256 sc1
buffer_load_dwordx4 v[188:191], v6, s[20:23], s66 offen offset:2304 sc1
s_add_u32 s66, s66, 4096
s_and_b32 s66, s66, 0xffff
buffer_load_dwordx4 v[192:195], v6, s[20:23], s66 offen offset:0 sc1
buffer_load_dwordx4 v[200:203], v6, s[20:23], s66 offen offset:2048 sc1
buffer_load_dwordx4 v[196:199], v6, s[20:23], s66 offen offset:256 sc1
buffer_load_dwordx4 v[204:207], v6, s[20:23], s66 offen offset:2304 sc1
s_add_u32 s66, s66, 4096
s_and_b32 s66, s66, 0xffff
.p2align 3
s_waitcnt vmcnt(31) lgkmcnt(10)
v_mfma_f32_16x16x32_bf16 v[16:19], v[48:51], v[80:83], v[16:19]
ds_read_b64_tr_b16 v[72:73], v11 offset:0
s_waitcnt vmcnt(30) lgkmcnt(9)
v_mfma_f32_16x16x32_bf16 v[16:19], v[52:55], v[88:91], v[16:19]
ds_read_b64_tr_b16 v[74:75], v11 offset:1024
s_waitcnt vmcnt(29)
v_mfma_f32_16x16x32_bf16 v[32:35], v[48:51], v[84:87], v[32:35]
ds_read_b64_tr_b16 v[76:77], v11 offset:4096
s_waitcnt vmcnt(28)
v_mfma_f32_16x16x32_bf16 v[32:35], v[52:55], v[92:95], v[32:35]
ds_read_b64_tr_b16 v[78:79], v11 offset:5120
s_waitcnt lgkmcnt(10)
v_mfma_f32_16x16x32_bf16 v[20:23], v[56:59], v[80:83], v[20:23]
ds_read_b64_tr_b16 v[48:49], v8 offset:8192
s_waitcnt lgkmcnt(9)
v_mfma_f32_16x16x32_bf16 v[20:23], v[60:63], v[88:91], v[20:23]
ds_read_b64_tr_b16 v[50:51], v8 offset:9216
v_mfma_f32_16x16x32_bf16 v[36:39], v[56:59], v[84:87], v[36:39]
ds_read_b64_tr_b16 v[52:53], v8 offset:12288
v_mfma_f32_16x16x32_bf16 v[36:39], v[60:63], v[92:95], v[36:39]
ds_read_b64_tr_b16 v[54:55], v8 offset:13312
s_waitcnt lgkmcnt(10)
v_mfma_f32_16x16x32_bf16 v[24:27], v[64:67], v[80:83], v[24:27]
ds_read_b64_tr_b16 v[56:57], v9 offset:8192
s_waitcnt lgkmcnt(9)
v_mfma_f32_16x16x32_bf16 v[24:27], v[68:71], v[88:91], v[24:27]
ds_read_b64_tr_b16 v[58:59], v9 offset:9216
v_mfma_f32_16x16x32_bf16 v[40:43], v[64:67], v[84:87], v[40:43]
ds_read_b64_tr_b16 v[60:61], v9 offset:12288
v_mfma_f32_16x16x32_bf16 v[40:43], v[68:71], v[92:95], v[40:43]
ds_read_b64_tr_b16 v[62:63], v9 offset:13312
s_waitcnt lgkmcnt(10)
v_mfma_f32_16x16x32_bf16 v[28:31], v[72:75], v[80:83], v[28:31]
ds_read_b64_tr_b16 v[64:65], v10 offset:8192
s_waitcnt lgkmcnt(9)
v_mfma_f32_16x16x32_bf16 v[28:31], v[76:79], v[88:91], v[28:31]
ds_read_b64_tr_b16 v[66:67], v10 offset:9216
v_mfma_f32_16x16x32_bf16 v[44:47], v[72:75], v[84:87], v[44:47]
ds_read_b64_tr_b16 v[68:69], v10 offset:12288
v_mfma_f32_16x16x32_bf16 v[44:47], v[76:79], v[92:95], v[44:47]
ds_read_b64_tr_b16 v[70:71], v10 offset:13312
s_waitcnt vmcnt(27) lgkmcnt(10)
v_mfma_f32_16x16x32_bf16 v[16:19], v[48:51], v[96:99], v[16:19]
ds_read_b64_tr_b16 v[72:73], v11 offset:8192
buffer_load_dwordx4 v[80:83], v6, s[20:23], s66 offen offset:0 sc1
s_waitcnt vmcnt(27) lgkmcnt(9)
v_mfma_f32_16x16x32_bf16 v[16:19], v[52:55], v[104:107], v[16:19]
ds_read_b64_tr_b16 v[74:75], v11 offset:9216
buffer_load_dwordx4 v[88:91], v6, s[20:23], s66 offen offset:2048 sc1
s_waitcnt vmcnt(27)
v_mfma_f32_16x16x32_bf16 v[32:35], v[48:51], v[100:103], v[32:35]
ds_read_b64_tr_b16 v[76:77], v11 offset:12288
buffer_load_dwordx4 v[84:87], v6, s[20:23], s66 offen offset:256 sc1
s_waitcnt vmcnt(27)
v_mfma_f32_16x16x32_bf16 v[32:35], v[52:55], v[108:111], v[32:35]
ds_read_b64_tr_b16 v[78:79], v11 offset:13312
buffer_load_dwordx4 v[92:95], v6, s[20:23], s66 offen offset:2304 sc1
s_waitcnt lgkmcnt(10)
v_mfma_f32_16x16x32_bf16 v[20:23], v[56:59], v[96:99], v[20:23]
ds_read_b64_tr_b16 v[48:49], v8 offset:16384
s_add_u32 s66, s66, 4096
s_and_b32 s66, s66, 0xffff
s_waitcnt lgkmcnt(9)
v_mfma_f32_16x16x32_bf16 v[20:23], v[60:63], v[104:107], v[20:23]
ds_read_b64_tr_b16 v[50:51], v8 offset:17408
v_mfma_f32_16x16x32_bf16 v[36:39], v[56:59], v[100:103], v[36:39]
ds_read_b64_tr_b16 v[52:53], v8 offset:20480
v_mfma_f32_16x16x32_bf16 v[36:39], v[60:63], v[108:111], v[36:39]
ds_read_b64_tr_b16 v[54:55], v8 offset:21504
s_waitcnt lgkmcnt(10)
v_mfma_f32_16x16x32_bf16 v[24:27], v[64:67], v[96:99], v[24:27]
ds_read_b64_tr_b16 v[56:57], v9 offset:16384
s_waitcnt lgkmcnt(9)
v_mfma_f32_16x16x32_bf16 v[24:27], v[68:71], v[104:107], v[24:27]
ds_read_b64_tr_b16 v[58:59], v9 offset:17408
v_mfma_f32_16x16x32_bf16 v[40:43], v[64:67], v[100:103], v[40:43]
ds_read_b64_tr_b16 v[60:61], v9 offset:20480
v_mfma_f32_16x16x32_bf16 v[40:43], v[68:71], v[108:111], v[40:43]
ds_read_b64_tr_b16 v[62:63], v9 offset:21504
s_waitcnt lgkmcnt(10)
v_mfma_f32_16x16x32_bf16 v[28:31], v[72:75], v[96:99], v[28:31]
ds_read_b64_tr_b16 v[64:65], v10 offset:16384
s_waitcnt lgkmcnt(9)
v_mfma_f32_16x16x32_bf16 v[28:31], v[76:79], v[104:107], v[28:31]
ds_read_b64_tr_b16 v[66:67], v10 offset:17408
v_mfma_f32_16x16x32_bf16 v[44:47], v[72:75], v[100:103], v[44:47]
ds_read_b64_tr_b16 v[68:69], v10 offset:20480
v_mfma_f32_16x16x32_bf16 v[44:47], v[76:79], v[108:111], v[44:47]
ds_read_b64_tr_b16 v[70:71], v10 offset:21504
s_waitcnt vmcnt(27) lgkmcnt(10)
v_mfma_f32_16x16x32_bf16 v[16:19], v[48:51], v[112:115], v[16:19]
ds_read_b64_tr_b16 v[72:73], v11 offset:16384
buffer_load_dwordx4 v[96:99], v6, s[20:23], s66 offen offset:0 sc1
s_waitcnt vmcnt(27) lgkmcnt(9)
v_mfma_f32_16x16x32_bf16 v[16:19], v[52:55], v[120:123], v[16:19]
ds_read_b64_tr_b16 v[74:75], v11 offset:17408
buffer_load_dwordx4 v[104:107], v6, s[20:23], s66 offen offset:2048 sc1
s_waitcnt vmcnt(27)
v_mfma_f32_16x16x32_bf16 v[32:35], v[48:51], v[116:119], v[32:35]
ds_read_b64_tr_b16 v[76:77], v11 offset:20480
buffer_load_dwordx4 v[100:103], v6, s[20:23], s66 offen offset:256 sc1
s_waitcnt vmcnt(27)
v_mfma_f32_16x16x32_bf16 v[32:35], v[52:55], v[124:127], v[32:35]
ds_read_b64_tr_b16 v[78:79], v11 offset:21504
buffer_load_dwordx4 v[108:111], v6, s[20:23], s66 offen offset:2304 sc1
s_waitcnt lgkmcnt(10)
v_mfma_f32_16x16x32_bf16 v[20:23], v[56:59], v[112:115], v[20:23]
ds_read_b64_tr_b16 v[48:49], v8 offset:24576
s_add_u32 s66, s66, 4096
s_and_b32 s66, s66, 0xffff
s_waitcnt lgkmcnt(9)
v_mfma_f32_16x16x32_bf16 v[20:23], v[60:63], v[120:123], v[20:23]
ds_read_b64_tr_b16 v[50:51], v8 offset:25600
v_mfma_f32_16x16x32_bf16 v[36:39], v[56:59], v[116:119], v[36:39]
ds_read_b64_tr_b16 v[52:53], v8 offset:28672
v_mfma_f32_16x16x32_bf16 v[36:39], v[60:63], v[124:127], v[36:39]
ds_read_b64_tr_b16 v[54:55], v8 offset:29696
s_waitcnt lgkmcnt(10)
v_mfma_f32_16x16x32_bf16 v[24:27], v[64:67], v[112:115], v[24:27]
ds_read_b64_tr_b16 v[56:57], v9 offset:24576
s_waitcnt lgkmcnt(9)
v_mfma_f32_16x16x32_bf16 v[24:27], v[68:71], v[120:123], v[24:27]
ds_read_b64_tr_b16 v[58:59], v9 offset:25600
v_mfma_f32_16x16x32_bf16 v[40:43], v[64:67], v[116:119], v[40:43]
ds_read_b64_tr_b16 v[60:61], v9 offset:28672
v_mfma_f32_16x16x32_bf16 v[40:43], v[68:71], v[124:127], v[40:43]
ds_read_b64_tr_b16 v[62:63], v9 offset:29696
s_waitcnt lgkmcnt(10)
v_mfma_f32_16x16x32_bf16 v[28:31], v[72:75], v[112:115], v[28:31]
ds_read_b64_tr_b16 v[64:65], v10 offset:24576
s_waitcnt lgkmcnt(9)
v_mfma_f32_16x16x32_bf16 v[28:31], v[76:79], v[120:123], v[28:31]
ds_read_b64_tr_b16 v[66:67], v10 offset:25600
v_mfma_f32_16x16x32_bf16 v[44:47], v[72:75], v[116:119], v[44:47]
ds_read_b64_tr_b16 v[68:69], v10 offset:28672
v_mfma_f32_16x16x32_bf16 v[44:47], v[76:79], v[124:127], v[44:47]
ds_read_b64_tr_b16 v[70:71], v10 offset:29696
s_waitcnt vmcnt(27) lgkmcnt(10)
v_mfma_f32_16x16x32_bf16 v[16:19], v[48:51], v[128:131], v[16:19]
ds_read_b64_tr_b16 v[72:73], v11 offset:24576
buffer_load_dwordx4 v[112:115], v6, s[20:23], s66 offen offset:0 sc1
s_waitcnt vmcnt(27) lgkmcnt(9)
v_mfma_f32_16x16x32_bf16 v[16:19], v[52:55], v[136:139], v[16:19]
ds_read_b64_tr_b16 v[74:75], v11 offset:25600
buffer_load_dwordx4 v[120:123], v6, s[20:23], s66 offen offset:2048 sc1
s_waitcnt vmcnt(27)
v_mfma_f32_16x16x32_bf16 v[32:35], v[48:51], v[132:135], v[32:35]
ds_read_b64_tr_b16 v[76:77], v11 offset:28672
buffer_load_dwordx4 v[116:119], v6, s[20:23], s66 offen offset:256 sc1
s_waitcnt vmcnt(27)
v_mfma_f32_16x16x32_bf16 v[32:35], v[52:55], v[140:143], v[32:35]
ds_read_b64_tr_b16 v[78:79], v11 offset:29696
buffer_load_dwordx4 v[124:127], v6, s[20:23], s66 offen offset:2304 sc1
s_waitcnt lgkmcnt(10)
v_mfma_f32_16x16x32_bf16 v[20:23], v[56:59], v[128:131], v[20:23]
ds_read_b64_tr_b16 v[48:49], v8 offset:32768
s_add_u32 s66, s66, 4096
s_and_b32 s66, s66, 0xffff
s_waitcnt lgkmcnt(9)
v_mfma_f32_16x16x32_bf16 v[20:23], v[60:63], v[136:139], v[20:23]
ds_read_b64_tr_b16 v[50:51], v8 offset:33792
v_mfma_f32_16x16x32_bf16 v[36:39], v[56:59], v[132:135], v[36:39]
ds_read_b64_tr_b16 v[52:53], v8 offset:36864
v_mfma_f32_16x16x32_bf16 v[36:39], v[60:63], v[140:143], v[36:39]
ds_read_b64_tr_b16 v[54:55], v8 offset:37888
s_waitcnt lgkmcnt(10)
v_mfma_f32_16x16x32_bf16 v[24:27], v[64:67], v[128:131], v[24:27]
ds_read_b64_tr_b16 v[56:57], v9 offset:32768
s_waitcnt lgkmcnt(9)
v_mfma_f32_16x16x32_bf16 v[24:27], v[68:71], v[136:139], v[24:27]
ds_read_b64_tr_b16 v[58:59], v9 offset:33792
v_mfma_f32_16x16x32_bf16 v[40:43], v[64:67], v[132:135], v[40:43]
ds_read_b64_tr_b16 v[60:61], v9 offset:36864
v_mfma_f32_16x16x32_bf16 v[40:43], v[68:71], v[140:143], v[40:43]
ds_read_b64_tr_b16 v[62:63], v9 offset:37888
s_waitcnt lgkmcnt(10)
v_mfma_f32_16x16x32_bf16 v[28:31], v[72:75], v[128:131], v[28:31]
ds_read_b64_tr_b16 v[64:65], v10 offset:32768
s_waitcnt lgkmcnt(9)
v_mfma_f32_16x16x32_bf16 v[28:31], v[76:79], v[136:139], v[28:31]
ds_read_b64_tr_b16 v[66:67], v10 offset:33792
v_mfma_f32_16x16x32_bf16 v[44:47], v[72:75], v[132:135], v[44:47]
ds_read_b64_tr_b16 v[68:69], v10 offset:36864
v_mfma_f32_16x16x32_bf16 v[44:47], v[76:79], v[140:143], v[44:47]
ds_read_b64_tr_b16 v[70:71], v10 offset:37888
s_waitcnt vmcnt(27) lgkmcnt(10)
v_mfma_f32_16x16x32_bf16 v[16:19], v[48:51], v[144:147], v[16:19]
ds_read_b64_tr_b16 v[72:73], v11 offset:32768
buffer_load_dwordx4 v[128:131], v6, s[20:23], s66 offen offset:0 sc1
s_waitcnt vmcnt(27) lgkmcnt(9)
v_mfma_f32_16x16x32_bf16 v[16:19], v[52:55], v[152:155], v[16:19]
ds_read_b64_tr_b16 v[74:75], v11 offset:33792
buffer_load_dwordx4 v[136:139], v6, s[20:23], s66 offen offset:2048 sc1
s_waitcnt vmcnt(27)
v_mfma_f32_16x16x32_bf16 v[32:35], v[48:51], v[148:151], v[32:35]
ds_read_b64_tr_b16 v[76:77], v11 offset:36864
buffer_load_dwordx4 v[132:135], v6, s[20:23], s66 offen offset:256 sc1
s_waitcnt vmcnt(27)
v_mfma_f32_16x16x32_bf16 v[32:35], v[52:55], v[156:159], v[32:35]
ds_read_b64_tr_b16 v[78:79], v11 offset:37888
buffer_load_dwordx4 v[140:143], v6, s[20:23], s66 offen offset:2304 sc1
s_waitcnt lgkmcnt(10)
v_mfma_f32_16x16x32_bf16 v[20:23], v[56:59], v[144:147], v[20:23]
ds_read_b64_tr_b16 v[48:49], v8 offset:40960
s_add_u32 s66, s66, 4096
s_and_b32 s66, s66, 0xffff
s_waitcnt lgkmcnt(9)
v_mfma_f32_16x16x32_bf16 v[20:23], v[60:63], v[152:155], v[20:23]
ds_read_b64_tr_b16 v[50:51], v8 offset:41984
v_mfma_f32_16x16x32_bf16 v[36:39], v[56:59], v[148:151], v[36:39]
ds_read_b64_tr_b16 v[52:53], v8 offset:45056
v_mfma_f32_16x16x32_bf16 v[36:39], v[60:63], v[156:159], v[36:39]
ds_read_b64_tr_b16 v[54:55], v8 offset:46080
s_waitcnt lgkmcnt(10)
v_mfma_f32_16x16x32_bf16 v[24:27], v[64:67], v[144:147], v[24:27]
ds_read_b64_tr_b16 v[56:57], v9 offset:40960
s_waitcnt lgkmcnt(9)
v_mfma_f32_16x16x32_bf16 v[24:27], v[68:71], v[152:155], v[24:27]
ds_read_b64_tr_b16 v[58:59], v9 offset:41984
v_mfma_f32_16x16x32_bf16 v[40:43], v[64:67], v[148:151], v[40:43]
ds_read_b64_tr_b16 v[60:61], v9 offset:45056
v_mfma_f32_16x16x32_bf16 v[40:43], v[68:71], v[156:159], v[40:43]
ds_read_b64_tr_b16 v[62:63], v9 offset:46080
s_waitcnt lgkmcnt(10)
v_mfma_f32_16x16x32_bf16 v[28:31], v[72:75], v[144:147], v[28:31]
ds_read_b64_tr_b16 v[64:65], v10 offset:40960
s_waitcnt lgkmcnt(9)
v_mfma_f32_16x16x32_bf16 v[28:31], v[76:79], v[152:155], v[28:31]
ds_read_b64_tr_b16 v[66:67], v10 offset:41984
v_mfma_f32_16x16x32_bf16 v[44:47], v[72:75], v[148:151], v[44:47]
ds_read_b64_tr_b16 v[68:69], v10 offset:45056
v_mfma_f32_16x16x32_bf16 v[44:47], v[76:79], v[156:159], v[44:47]
ds_read_b64_tr_b16 v[70:71], v10 offset:46080
s_waitcnt vmcnt(27) lgkmcnt(10)
v_mfma_f32_16x16x32_bf16 v[16:19], v[48:51], v[160:163], v[16:19]
ds_read_b64_tr_b16 v[72:73], v11 offset:40960
buffer_load_dwordx4 v[144:147], v6, s[20:23], s66 offen offset:0 sc1
s_waitcnt vmcnt(27) lgkmcnt(9)
v_mfma_f32_16x16x32_bf16 v[16:19], v[52:55], v[168:171], v[16:19]
ds_read_b64_tr_b16 v[74:75], v11 offset:41984
buffer_load_dwordx4 v[152:155], v6, s[20:23], s66 offen offset:2048 sc1
s_waitcnt vmcnt(27)
v_mfma_f32_16x16x32_bf16 v[32:35], v[48:51], v[164:167], v[32:35]
ds_read_b64_tr_b16 v[76:77], v11 offset:45056
buffer_load_dwordx4 v[148:151], v6, s[20:23], s66 offen offset:256 sc1
s_waitcnt vmcnt(27)
v_mfma_f32_16x16x32_bf16 v[32:35], v[52:55], v[172:175], v[32:35]
ds_read_b64_tr_b16 v[78:79], v11 offset:46080
buffer_load_dwordx4 v[156:159], v6, s[20:23], s66 offen offset:2304 sc1
s_waitcnt lgkmcnt(10)
v_mfma_f32_16x16x32_bf16 v[20:23], v[56:59], v[160:163], v[20:23]
ds_read_b64_tr_b16 v[48:49], v8 offset:49152
s_add_u32 s66, s66, 4096
s_and_b32 s66, s66, 0xffff
s_waitcnt lgkmcnt(9)
v_mfma_f32_16x16x32_bf16 v[20:23], v[60:63], v[168:171], v[20:23]
ds_read_b64_tr_b16 v[50:51], v8 offset:50176
v_mfma_f32_16x16x32_bf16 v[36:39], v[56:59], v[164:167], v[36:39]
ds_read_b64_tr_b16 v[52:53], v8 offset:53248
v_mfma_f32_16x16x32_bf16 v[36:39], v[60:63], v[172:175], v[36:39]
ds_read_b64_tr_b16 v[54:55], v8 offset:54272
s_waitcnt lgkmcnt(10)
v_mfma_f32_16x16x32_bf16 v[24:27], v[64:67], v[160:163], v[24:27]
ds_read_b64_tr_b16 v[56:57], v9 offset:49152
s_waitcnt lgkmcnt(9)
v_mfma_f32_16x16x32_bf16 v[24:27], v[68:71], v[168:171], v[24:27]
ds_read_b64_tr_b16 v[58:59], v9 offset:50176
v_mfma_f32_16x16x32_bf16 v[40:43], v[64:67], v[164:167], v[40:43]
ds_read_b64_tr_b16 v[60:61], v9 offset:53248
v_mfma_f32_16x16x32_bf16 v[40:43], v[68:71], v[172:175], v[40:43]
ds_read_b64_tr_b16 v[62:63], v9 offset:54272
s_waitcnt lgkmcnt(10)
v_mfma_f32_16x16x32_bf16 v[28:31], v[72:75], v[160:163], v[28:31]
ds_read_b64_tr_b16 v[64:65], v10 offset:49152
s_waitcnt lgkmcnt(9)
v_mfma_f32_16x16x32_bf16 v[28:31], v[76:79], v[168:171], v[28:31]
ds_read_b64_tr_b16 v[66:67], v10 offset:50176
v_mfma_f32_16x16x32_bf16 v[44:47], v[72:75], v[164:167], v[44:47]
ds_read_b64_tr_b16 v[68:69], v10 offset:53248
v_mfma_f32_16x16x32_bf16 v[44:47], v[76:79], v[172:175], v[44:47]
ds_read_b64_tr_b16 v[70:71], v10 offset:54272
s_waitcnt vmcnt(27) lgkmcnt(10)
v_mfma_f32_16x16x32_bf16 v[16:19], v[48:51], v[176:179], v[16:19]
ds_read_b64_tr_b16 v[72:73], v11 offset:49152
buffer_load_dwordx4 v[160:163], v6, s[20:23], s66 offen offset:0 sc1
s_waitcnt vmcnt(27) lgkmcnt(9)
v_mfma_f32_16x16x32_bf16 v[16:19], v[52:55], v[184:187], v[16:19]
ds_read_b64_tr_b16 v[74:75], v11 offset:50176
buffer_load_dwordx4 v[168:171], v6, s[20:23], s66 offen offset:2048 sc1
s_waitcnt vmcnt(27)
v_mfma_f32_16x16x32_bf16 v[32:35], v[48:51], v[180:183], v[32:35]
ds_read_b64_tr_b16 v[76:77], v11 offset:53248
buffer_load_dwordx4 v[164:167], v6, s[20:23], s66 offen offset:256 sc1
s_waitcnt vmcnt(27)
v_mfma_f32_16x16x32_bf16 v[32:35], v[52:55], v[188:191], v[32:35]
ds_read_b64_tr_b16 v[78:79], v11 offset:54272
buffer_load_dwordx4 v[172:175], v6, s[20:23], s66 offen offset:2304 sc1
s_waitcnt lgkmcnt(10)
v_mfma_f32_16x16x32_bf16 v[20:23], v[56:59], v[176:179], v[20:23]
ds_read_b64_tr_b16 v[48:49], v8 offset:57344
s_add_u32 s66, s66, 4096
s_and_b32 s66, s66, 0xffff
s_waitcnt lgkmcnt(9)
v_mfma_f32_16x16x32_bf16 v[20:23], v[60:63], v[184:187], v[20:23]
ds_read_b64_tr_b16 v[50:51], v8 offset:58368
v_mfma_f32_16x16x32_bf16 v[36:39], v[56:59], v[180:183], v[36:39]
ds_read_b64_tr_b16 v[52:53], v8 offset:61440
v_mfma_f32_16x16x32_bf16 v[36:39], v[60:63], v[188:191], v[36:39]
ds_read_b64_tr_b16 v[54:55], v8 offset:62464
s_waitcnt lgkmcnt(10)
v_mfma_f32_16x16x32_bf16 v[24:27], v[64:67], v[176:179], v[24:27]
ds_read_b64_tr_b16 v[56:57], v9 offset:57344
s_waitcnt lgkmcnt(9)
v_mfma_f32_16x16x32_bf16 v[24:27], v[68:71], v[184:187], v[24:27]
ds_read_b64_tr_b16 v[58:59], v9 offset:58368
v_mfma_f32_16x16x32_bf16 v[40:43], v[64:67], v[180:183], v[40:43]
ds_read_b64_tr_b16 v[60:61], v9 offset:61440
v_mfma_f32_16x16x32_bf16 v[40:43], v[68:71], v[188:191], v[40:43]
ds_read_b64_tr_b16 v[62:63], v9 offset:62464
s_waitcnt lgkmcnt(10)
v_mfma_f32_16x16x32_bf16 v[28:31], v[72:75], v[176:179], v[28:31]
ds_read_b64_tr_b16 v[64:65], v10 offset:57344
s_waitcnt lgkmcnt(9)
v_mfma_f32_16x16x32_bf16 v[28:31], v[76:79], v[184:187], v[28:31]
ds_read_b64_tr_b16 v[66:67], v10 offset:58368
v_mfma_f32_16x16x32_bf16 v[44:47], v[72:75], v[180:183], v[44:47]
ds_read_b64_tr_b16 v[68:69], v10 offset:61440
v_mfma_f32_16x16x32_bf16 v[44:47], v[76:79], v[188:191], v[44:47]
ds_read_b64_tr_b16 v[70:71], v10 offset:62464
s_waitcnt vmcnt(27) lgkmcnt(10)
v_mfma_f32_16x16x32_bf16 v[16:19], v[48:51], v[192:195], v[16:19]
ds_read_b64_tr_b16 v[72:73], v11 offset:57344
buffer_load_dwordx4 v[176:179], v6, s[20:23], s66 offen offset:0 sc1
s_waitcnt vmcnt(27) lgkmcnt(9)
v_mfma_f32_16x16x32_bf16 v[16:19], v[52:55], v[200:203], v[16:19]
ds_read_b64_tr_b16 v[74:75], v11 offset:58368
buffer_load_dwordx4 v[184:187], v6, s[20:23], s66 offen offset:2048 sc1
s_waitcnt vmcnt(27)
v_mfma_f32_16x16x32_bf16 v[32:35], v[48:51], v[196:199], v[32:35]
ds_read_b64_tr_b16 v[76:77], v11 offset:61440
buffer_load_dwordx4 v[180:183], v6, s[20:23], s66 offen offset:256 sc1
s_waitcnt vmcnt(27)
v_mfma_f32_16x16x32_bf16 v[32:35], v[52:55], v[204:207], v[32:35]
ds_read_b64_tr_b16 v[78:79], v11 offset:62464
buffer_load_dwordx4 v[188:191], v6, s[20:23], s66 offen offset:2304 sc1
s_waitcnt lgkmcnt(10)
v_mfma_f32_16x16x32_bf16 v[20:23], v[56:59], v[192:195], v[20:23]
ds_read_b64_tr_b16 v[48:49], v12 offset:0
s_add_u32 s66, s66, 4096
s_and_b32 s66, s66, 0xffff
s_waitcnt lgkmcnt(9)
v_mfma_f32_16x16x32_bf16 v[20:23], v[60:63], v[200:203], v[20:23]
ds_read_b64_tr_b16 v[50:51], v12 offset:1024
v_mfma_f32_16x16x32_bf16 v[36:39], v[56:59], v[196:199], v[36:39]
ds_read_b64_tr_b16 v[52:53], v12 offset:4096
v_mfma_f32_16x16x32_bf16 v[36:39], v[60:63], v[204:207], v[36:39]
ds_read_b64_tr_b16 v[54:55], v12 offset:5120
s_waitcnt lgkmcnt(10)
v_mfma_f32_16x16x32_bf16 v[24:27], v[64:67], v[192:195], v[24:27]
ds_read_b64_tr_b16 v[56:57], v13 offset:0
s_waitcnt lgkmcnt(9)
v_mfma_f32_16x16x32_bf16 v[24:27], v[68:71], v[200:203], v[24:27]
ds_read_b64_tr_b16 v[58:59], v13 offset:1024
v_mfma_f32_16x16x32_bf16 v[40:43], v[64:67], v[196:199], v[40:43]
ds_read_b64_tr_b16 v[60:61], v13 offset:4096
v_mfma_f32_16x16x32_bf16 v[40:43], v[68:71], v[204:207], v[40:43]
ds_read_b64_tr_b16 v[62:63], v13 offset:5120
s_waitcnt lgkmcnt(10)
v_mfma_f32_16x16x32_bf16 v[28:31], v[72:75], v[192:195], v[28:31]
ds_read_b64_tr_b16 v[64:65], v14 offset:0
s_waitcnt lgkmcnt(9)
v_mfma_f32_16x16x32_bf16 v[28:31], v[76:79], v[200:203], v[28:31]
ds_read_b64_tr_b16 v[66:67], v14 offset:1024
v_mfma_f32_16x16x32_bf16 v[44:47], v[72:75], v[196:199], v[44:47]
ds_read_b64_tr_b16 v[68:69], v14 offset:4096
v_mfma_f32_16x16x32_bf16 v[44:47], v[76:79], v[204:207], v[44:47]
ds_read_b64_tr_b16 v[70:71], v14 offset:5120
s_waitcnt vmcnt(27) lgkmcnt(10)
v_mfma_f32_16x16x32_bf16 v[16:19], v[48:51], v[80:83], v[16:19]
ds_read_b64_tr_b16 v[72:73], v15 offset:0
buffer_load_dwordx4 v[192:195], v6, s[20:23], s66 offen offset:0 sc1
s_waitcnt vmcnt(27) lgkmcnt(9)
v_mfma_f32_16x16x32_bf16 v[16:19], v[52:55], v[88:91], v[16:19]
ds_read_b64_tr_b16 v[74:75], v15 offset:1024
buffer_load_dwordx4 v[200:203], v6, s[20:23], s66 offen offset:2048 sc1
s_waitcnt vmcnt(27)
v_mfma_f32_16x16x32_bf16 v[32:35], v[48:51], v[84:87], v[32:35]
ds_read_b64_tr_b16 v[76:77], v15 offset:4096
buffer_load_dwordx4 v[196:199], v6, s[20:23], s66 offen offset:256 sc1
s_waitcnt vmcnt(27)
v_mfma_f32_16x16x32_bf16 v[32:35], v[52:55], v[92:95], v[32:35]
ds_read_b64_tr_b16 v[78:79], v15 offset:5120
buffer_load_dwordx4 v[204:207], v6, s[20:23], s66 offen offset:2304 sc1
s_waitcnt lgkmcnt(10)
v_mfma_f32_16x16x32_bf16 v[20:23], v[56:59], v[80:83], v[20:23]
ds_read_b64_tr_b16 v[48:49], v12 offset:8192
s_add_u32 s66, s66, 4096
s_and_b32 s66, s66, 0xffff
s_waitcnt lgkmcnt(9)
v_mfma_f32_16x16x32_bf16 v[20:23], v[60:63], v[88:91], v[20:23]
ds_read_b64_tr_b16 v[50:51], v12 offset:9216
v_mfma_f32_16x16x32_bf16 v[36:39], v[56:59], v[84:87], v[36:39]
ds_read_b64_tr_b16 v[52:53], v12 offset:12288
v_mfma_f32_16x16x32_bf16 v[36:39], v[60:63], v[92:95], v[36:39]
ds_read_b64_tr_b16 v[54:55], v12 offset:13312
s_waitcnt lgkmcnt(10)
v_mfma_f32_16x16x32_bf16 v[24:27], v[64:67], v[80:83], v[24:27]
ds_read_b64_tr_b16 v[56:57], v13 offset:8192
s_waitcnt lgkmcnt(9)
v_mfma_f32_16x16x32_bf16 v[24:27], v[68:71], v[88:91], v[24:27]
ds_read_b64_tr_b16 v[58:59], v13 offset:9216
v_mfma_f32_16x16x32_bf16 v[40:43], v[64:67], v[84:87], v[40:43]
ds_read_b64_tr_b16 v[60:61], v13 offset:12288
v_mfma_f32_16x16x32_bf16 v[40:43], v[68:71], v[92:95], v[40:43]
ds_read_b64_tr_b16 v[62:63], v13 offset:13312
s_waitcnt lgkmcnt(10)
v_mfma_f32_16x16x32_bf16 v[28:31], v[72:75], v[80:83], v[28:31]
ds_read_b64_tr_b16 v[64:65], v14 offset:8192
s_waitcnt lgkmcnt(9)
v_mfma_f32_16x16x32_bf16 v[28:31], v[76:79], v[88:91], v[28:31]
ds_read_b64_tr_b16 v[66:67], v14 offset:9216
v_mfma_f32_16x16x32_bf16 v[44:47], v[72:75], v[84:87], v[44:47]
ds_read_b64_tr_b16 v[68:69], v14 offset:12288
v_mfma_f32_16x16x32_bf16 v[44:47], v[76:79], v[92:95], v[44:47]
ds_read_b64_tr_b16 v[70:71], v14 offset:13312
s_waitcnt vmcnt(27) lgkmcnt(10)
v_mfma_f32_16x16x32_bf16 v[16:19], v[48:51], v[96:99], v[16:19]
ds_read_b64_tr_b16 v[72:73], v15 offset:8192
s_waitcnt vmcnt(26) lgkmcnt(9)
v_mfma_f32_16x16x32_bf16 v[16:19], v[52:55], v[104:107], v[16:19]
ds_read_b64_tr_b16 v[74:75], v15 offset:9216
s_waitcnt vmcnt(25)
v_mfma_f32_16x16x32_bf16 v[32:35], v[48:51], v[100:103], v[32:35]
ds_read_b64_tr_b16 v[76:77], v15 offset:12288
s_waitcnt vmcnt(24)
v_mfma_f32_16x16x32_bf16 v[32:35], v[52:55], v[108:111], v[32:35]
ds_read_b64_tr_b16 v[78:79], v15 offset:13312
s_waitcnt lgkmcnt(10)
v_mfma_f32_16x16x32_bf16 v[20:23], v[56:59], v[96:99], v[20:23]
ds_read_b64_tr_b16 v[48:49], v12 offset:16384
s_waitcnt lgkmcnt(9)
v_mfma_f32_16x16x32_bf16 v[20:23], v[60:63], v[104:107], v[20:23]
ds_read_b64_tr_b16 v[50:51], v12 offset:17408
v_mfma_f32_16x16x32_bf16 v[36:39], v[56:59], v[100:103], v[36:39]
ds_read_b64_tr_b16 v[52:53], v12 offset:20480
v_mfma_f32_16x16x32_bf16 v[36:39], v[60:63], v[108:111], v[36:39]
ds_read_b64_tr_b16 v[54:55], v12 offset:21504
s_waitcnt lgkmcnt(10)
v_mfma_f32_16x16x32_bf16 v[24:27], v[64:67], v[96:99], v[24:27]
ds_read_b64_tr_b16 v[56:57], v13 offset:16384
s_waitcnt lgkmcnt(9)
v_mfma_f32_16x16x32_bf16 v[24:27], v[68:71], v[104:107], v[24:27]
ds_read_b64_tr_b16 v[58:59], v13 offset:17408
v_mfma_f32_16x16x32_bf16 v[40:43], v[64:67], v[100:103], v[40:43]
ds_read_b64_tr_b16 v[60:61], v13 offset:20480
v_mfma_f32_16x16x32_bf16 v[40:43], v[68:71], v[108:111], v[40:43]
ds_read_b64_tr_b16 v[62:63], v13 offset:21504
s_waitcnt lgkmcnt(10)
v_mfma_f32_16x16x32_bf16 v[28:31], v[72:75], v[96:99], v[28:31]
ds_read_b64_tr_b16 v[64:65], v14 offset:16384
s_waitcnt lgkmcnt(9)
v_mfma_f32_16x16x32_bf16 v[28:31], v[76:79], v[104:107], v[28:31]
ds_read_b64_tr_b16 v[66:67], v14 offset:17408
v_mfma_f32_16x16x32_bf16 v[44:47], v[72:75], v[100:103], v[44:47]
ds_read_b64_tr_b16 v[68:69], v14 offset:20480
v_mfma_f32_16x16x32_bf16 v[44:47], v[76:79], v[108:111], v[44:47]
ds_read_b64_tr_b16 v[70:71], v14 offset:21504
s_waitcnt vmcnt(23) lgkmcnt(10)
v_mfma_f32_16x16x32_bf16 v[16:19], v[48:51], v[112:115], v[16:19]
ds_read_b64_tr_b16 v[72:73], v15 offset:16384
s_waitcnt vmcnt(22) lgkmcnt(9)
v_mfma_f32_16x16x32_bf16 v[16:19], v[52:55], v[120:123], v[16:19]
ds_read_b64_tr_b16 v[74:75], v15 offset:17408
s_waitcnt vmcnt(21)
v_mfma_f32_16x16x32_bf16 v[32:35], v[48:51], v[116:119], v[32:35]
ds_read_b64_tr_b16 v[76:77], v15 offset:20480
s_waitcnt vmcnt(20)
v_mfma_f32_16x16x32_bf16 v[32:35], v[52:55], v[124:127], v[32:35]
ds_read_b64_tr_b16 v[78:79], v15 offset:21504
s_waitcnt lgkmcnt(10)
v_mfma_f32_16x16x32_bf16 v[20:23], v[56:59], v[112:115], v[20:23]
ds_read_b64_tr_b16 v[48:49], v12 offset:24576
s_waitcnt lgkmcnt(9)
v_mfma_f32_16x16x32_bf16 v[20:23], v[60:63], v[120:123], v[20:23]
ds_read_b64_tr_b16 v[50:51], v12 offset:25600
v_mfma_f32_16x16x32_bf16 v[36:39], v[56:59], v[116:119], v[36:39]
ds_read_b64_tr_b16 v[52:53], v12 offset:28672
v_mfma_f32_16x16x32_bf16 v[36:39], v[60:63], v[124:127], v[36:39]
ds_read_b64_tr_b16 v[54:55], v12 offset:29696
s_waitcnt lgkmcnt(10)
v_mfma_f32_16x16x32_bf16 v[24:27], v[64:67], v[112:115], v[24:27]
ds_read_b64_tr_b16 v[56:57], v13 offset:24576
s_waitcnt lgkmcnt(9)
v_mfma_f32_16x16x32_bf16 v[24:27], v[68:71], v[120:123], v[24:27]
ds_read_b64_tr_b16 v[58:59], v13 offset:25600
v_mfma_f32_16x16x32_bf16 v[40:43], v[64:67], v[116:119], v[40:43]
ds_read_b64_tr_b16 v[60:61], v13 offset:28672
v_mfma_f32_16x16x32_bf16 v[40:43], v[68:71], v[124:127], v[40:43]
ds_read_b64_tr_b16 v[62:63], v13 offset:29696
s_waitcnt lgkmcnt(10)
v_mfma_f32_16x16x32_bf16 v[28:31], v[72:75], v[112:115], v[28:31]
ds_read_b64_tr_b16 v[64:65], v14 offset:24576
s_waitcnt lgkmcnt(9)
v_mfma_f32_16x16x32_bf16 v[28:31], v[76:79], v[120:123], v[28:31]
ds_read_b64_tr_b16 v[66:67], v14 offset:25600
v_mfma_f32_16x16x32_bf16 v[44:47], v[72:75], v[116:119], v[44:47]
ds_read_b64_tr_b16 v[68:69], v14 offset:28672
v_mfma_f32_16x16x32_bf16 v[44:47], v[76:79], v[124:127], v[44:47]
ds_read_b64_tr_b16 v[70:71], v14 offset:29696
s_waitcnt vmcnt(19) lgkmcnt(10)
v_mfma_f32_16x16x32_bf16 v[16:19], v[48:51], v[128:131], v[16:19]
ds_read_b64_tr_b16 v[72:73], v15 offset:24576
s_waitcnt vmcnt(18) lgkmcnt(9)
v_mfma_f32_16x16x32_bf16 v[16:19], v[52:55], v[136:139], v[16:19]
ds_read_b64_tr_b16 v[74:75], v15 offset:25600
s_waitcnt vmcnt(17)
v_mfma_f32_16x16x32_bf16 v[32:35], v[48:51], v[132:135], v[32:35]
ds_read_b64_tr_b16 v[76:77], v15 offset:28672
s_waitcnt vmcnt(16)
v_mfma_f32_16x16x32_bf16 v[32:35], v[52:55], v[140:143], v[32:35]
ds_read_b64_tr_b16 v[78:79], v15 offset:29696
s_waitcnt lgkmcnt(10)
v_mfma_f32_16x16x32_bf16 v[20:23], v[56:59], v[128:131], v[20:23]
ds_read_b64_tr_b16 v[48:49], v12 offset:32768
s_waitcnt lgkmcnt(9)
v_mfma_f32_16x16x32_bf16 v[20:23], v[60:63], v[136:139], v[20:23]
ds_read_b64_tr_b16 v[50:51], v12 offset:33792
v_mfma_f32_16x16x32_bf16 v[36:39], v[56:59], v[132:135], v[36:39]
ds_read_b64_tr_b16 v[52:53], v12 offset:36864
v_mfma_f32_16x16x32_bf16 v[36:39], v[60:63], v[140:143], v[36:39]
ds_read_b64_tr_b16 v[54:55], v12 offset:37888
s_waitcnt lgkmcnt(10)
v_mfma_f32_16x16x32_bf16 v[24:27], v[64:67], v[128:131], v[24:27]
ds_read_b64_tr_b16 v[56:57], v13 offset:32768
s_waitcnt lgkmcnt(9)
v_mfma_f32_16x16x32_bf16 v[24:27], v[68:71], v[136:139], v[24:27]
ds_read_b64_tr_b16 v[58:59], v13 offset:33792
v_mfma_f32_16x16x32_bf16 v[40:43], v[64:67], v[132:135], v[40:43]
ds_read_b64_tr_b16 v[60:61], v13 offset:36864
v_mfma_f32_16x16x32_bf16 v[40:43], v[68:71], v[140:143], v[40:43]
ds_read_b64_tr_b16 v[62:63], v13 offset:37888
s_waitcnt lgkmcnt(10)
v_mfma_f32_16x16x32_bf16 v[28:31], v[72:75], v[128:131], v[28:31]
ds_read_b64_tr_b16 v[64:65], v14 offset:32768
s_waitcnt lgkmcnt(9)
v_mfma_f32_16x16x32_bf16 v[28:31], v[76:79], v[136:139], v[28:31]
ds_read_b64_tr_b16 v[66:67], v14 offset:33792
v_mfma_f32_16x16x32_bf16 v[44:47], v[72:75], v[132:135], v[44:47]
ds_read_b64_tr_b16 v[68:69], v14 offset:36864
v_mfma_f32_16x16x32_bf16 v[44:47], v[76:79], v[140:143], v[44:47]
ds_read_b64_tr_b16 v[70:71], v14 offset:37888
s_waitcnt vmcnt(15) lgkmcnt(10)
v_mfma_f32_16x16x32_bf16 v[16:19], v[48:51], v[144:147], v[16:19]
ds_read_b64_tr_b16 v[72:73], v15 offset:32768
s_waitcnt vmcnt(14) lgkmcnt(9)
v_mfma_f32_16x16x32_bf16 v[16:19], v[52:55], v[152:155], v[16:19]
ds_read_b64_tr_b16 v[74:75], v15 offset:33792
s_waitcnt vmcnt(13)
v_mfma_f32_16x16x32_bf16 v[32:35], v[48:51], v[148:151], v[32:35]
ds_read_b64_tr_b16 v[76:77], v15 offset:36864
s_waitcnt vmcnt(12)
v_mfma_f32_16x16x32_bf16 v[32:35], v[52:55], v[156:159], v[32:35]
ds_read_b64_tr_b16 v[78:79], v15 offset:37888
s_waitcnt lgkmcnt(10)
v_mfma_f32_16x16x32_bf16 v[20:23], v[56:59], v[144:147], v[20:23]
ds_read_b64_tr_b16 v[48:49], v12 offset:40960
s_waitcnt lgkmcnt(9)
v_mfma_f32_16x16x32_bf16 v[20:23], v[60:63], v[152:155], v[20:23]
ds_read_b64_tr_b16 v[50:51], v12 offset:41984
v_mfma_f32_16x16x32_bf16 v[36:39], v[56:59], v[148:151], v[36:39]
ds_read_b64_tr_b16 v[52:53], v12 offset:45056
v_mfma_f32_16x16x32_bf16 v[36:39], v[60:63], v[156:159], v[36:39]
ds_read_b64_tr_b16 v[54:55], v12 offset:46080
s_waitcnt lgkmcnt(10)
v_mfma_f32_16x16x32_bf16 v[24:27], v[64:67], v[144:147], v[24:27]
ds_read_b64_tr_b16 v[56:57], v13 offset:40960
s_waitcnt lgkmcnt(9)
v_mfma_f32_16x16x32_bf16 v[24:27], v[68:71], v[152:155], v[24:27]
ds_read_b64_tr_b16 v[58:59], v13 offset:41984
v_mfma_f32_16x16x32_bf16 v[40:43], v[64:67], v[148:151], v[40:43]
ds_read_b64_tr_b16 v[60:61], v13 offset:45056
v_mfma_f32_16x16x32_bf16 v[40:43], v[68:71], v[156:159], v[40:43]
ds_read_b64_tr_b16 v[62:63], v13 offset:46080
s_waitcnt lgkmcnt(10)
v_mfma_f32_16x16x32_bf16 v[28:31], v[72:75], v[144:147], v[28:31]
ds_read_b64_tr_b16 v[64:65], v14 offset:40960
s_waitcnt lgkmcnt(9)
v_mfma_f32_16x16x32_bf16 v[28:31], v[76:79], v[152:155], v[28:31]
ds_read_b64_tr_b16 v[66:67], v14 offset:41984
v_mfma_f32_16x16x32_bf16 v[44:47], v[72:75], v[148:151], v[44:47]
ds_read_b64_tr_b16 v[68:69], v14 offset:45056
v_mfma_f32_16x16x32_bf16 v[44:47], v[76:79], v[156:159], v[44:47]
ds_read_b64_tr_b16 v[70:71], v14 offset:46080
s_waitcnt vmcnt(11) lgkmcnt(10)
v_mfma_f32_16x16x32_bf16 v[16:19], v[48:51], v[160:163], v[16:19]
ds_read_b64_tr_b16 v[72:73], v15 offset:40960
s_waitcnt vmcnt(10) lgkmcnt(9)
v_mfma_f32_16x16x32_bf16 v[16:19], v[52:55], v[168:171], v[16:19]
ds_read_b64_tr_b16 v[74:75], v15 offset:41984
s_waitcnt vmcnt(9)
v_mfma_f32_16x16x32_bf16 v[32:35], v[48:51], v[164:167], v[32:35]
ds_read_b64_tr_b16 v[76:77], v15 offset:45056
s_waitcnt vmcnt(8)
v_mfma_f32_16x16x32_bf16 v[32:35], v[52:55], v[172:175], v[32:35]
ds_read_b64_tr_b16 v[78:79], v15 offset:46080
s_waitcnt lgkmcnt(10)
v_mfma_f32_16x16x32_bf16 v[20:23], v[56:59], v[160:163], v[20:23]
ds_read_b64_tr_b16 v[48:49], v12 offset:49152
s_waitcnt lgkmcnt(9)
v_mfma_f32_16x16x32_bf16 v[20:23], v[60:63], v[168:171], v[20:23]
ds_read_b64_tr_b16 v[50:51], v12 offset:50176
v_mfma_f32_16x16x32_bf16 v[36:39], v[56:59], v[164:167], v[36:39]
ds_read_b64_tr_b16 v[52:53], v12 offset:53248
v_mfma_f32_16x16x32_bf16 v[36:39], v[60:63], v[172:175], v[36:39]
ds_read_b64_tr_b16 v[54:55], v12 offset:54272
s_waitcnt lgkmcnt(10)
v_mfma_f32_16x16x32_bf16 v[24:27], v[64:67], v[160:163], v[24:27]
ds_read_b64_tr_b16 v[56:57], v13 offset:49152
s_waitcnt lgkmcnt(9)
v_mfma_f32_16x16x32_bf16 v[24:27], v[68:71], v[168:171], v[24:27]
ds_read_b64_tr_b16 v[58:59], v13 offset:50176
v_mfma_f32_16x16x32_bf16 v[40:43], v[64:67], v[164:167], v[40:43]
ds_read_b64_tr_b16 v[60:61], v13 offset:53248
v_mfma_f32_16x16x32_bf16 v[40:43], v[68:71], v[172:175], v[40:43]
ds_read_b64_tr_b16 v[62:63], v13 offset:54272
s_waitcnt lgkmcnt(10)
v_mfma_f32_16x16x32_bf16 v[28:31], v[72:75], v[160:163], v[28:31]
ds_read_b64_tr_b16 v[64:65], v14 offset:49152
s_waitcnt lgkmcnt(9)
v_mfma_f32_16x16x32_bf16 v[28:31], v[76:79], v[168:171], v[28:31]
ds_read_b64_tr_b16 v[66:67], v14 offset:50176
v_mfma_f32_16x16x32_bf16 v[44:47], v[72:75], v[164:167], v[44:47]
ds_read_b64_tr_b16 v[68:69], v14 offset:53248
v_mfma_f32_16x16x32_bf16 v[44:47], v[76:79], v[172:175], v[44:47]
ds_read_b64_tr_b16 v[70:71], v14 offset:54272
s_waitcnt vmcnt(7) lgkmcnt(10)
v_mfma_f32_16x16x32_bf16 v[16:19], v[48:51], v[176:179], v[16:19]
ds_read_b64_tr_b16 v[72:73], v15 offset:49152
s_waitcnt vmcnt(6) lgkmcnt(9)
v_mfma_f32_16x16x32_bf16 v[16:19], v[52:55], v[184:187], v[16:19]
ds_read_b64_tr_b16 v[74:75], v15 offset:50176
s_waitcnt vmcnt(5)
v_mfma_f32_16x16x32_bf16 v[32:35], v[48:51], v[180:183], v[32:35]
ds_read_b64_tr_b16 v[76:77], v15 offset:53248
s_waitcnt vmcnt(4)
v_mfma_f32_16x16x32_bf16 v[32:35], v[52:55], v[188:191], v[32:35]
ds_read_b64_tr_b16 v[78:79], v15 offset:54272
s_waitcnt lgkmcnt(10)
v_mfma_f32_16x16x32_bf16 v[20:23], v[56:59], v[176:179], v[20:23]
ds_read_b64_tr_b16 v[48:49], v12 offset:57344
s_waitcnt lgkmcnt(9)
v_mfma_f32_16x16x32_bf16 v[20:23], v[60:63], v[184:187], v[20:23]
ds_read_b64_tr_b16 v[50:51], v12 offset:58368
v_mfma_f32_16x16x32_bf16 v[36:39], v[56:59], v[180:183], v[36:39]
ds_read_b64_tr_b16 v[52:53], v12 offset:61440
v_mfma_f32_16x16x32_bf16 v[36:39], v[60:63], v[188:191], v[36:39]
ds_read_b64_tr_b16 v[54:55], v12 offset:62464
s_waitcnt lgkmcnt(10)
v_mfma_f32_16x16x32_bf16 v[24:27], v[64:67], v[176:179], v[24:27]
ds_read_b64_tr_b16 v[56:57], v13 offset:57344
s_waitcnt lgkmcnt(9)
v_mfma_f32_16x16x32_bf16 v[24:27], v[68:71], v[184:187], v[24:27]
ds_read_b64_tr_b16 v[58:59], v13 offset:58368
v_mfma_f32_16x16x32_bf16 v[40:43], v[64:67], v[180:183], v[40:43]
ds_read_b64_tr_b16 v[60:61], v13 offset:61440
v_mfma_f32_16x16x32_bf16 v[40:43], v[68:71], v[188:191], v[40:43]
ds_read_b64_tr_b16 v[62:63], v13 offset:62464
s_waitcnt lgkmcnt(10)
v_mfma_f32_16x16x32_bf16 v[28:31], v[72:75], v[176:179], v[28:31]
ds_read_b64_tr_b16 v[64:65], v14 offset:57344
s_waitcnt lgkmcnt(9)
v_mfma_f32_16x16x32_bf16 v[28:31], v[76:79], v[184:187], v[28:31]
ds_read_b64_tr_b16 v[66:67], v14 offset:58368
v_mfma_f32_16x16x32_bf16 v[44:47], v[72:75], v[180:183], v[44:47]
ds_read_b64_tr_b16 v[68:69], v14 offset:61440
v_mfma_f32_16x16x32_bf16 v[44:47], v[76:79], v[188:191], v[44:47]
ds_read_b64_tr_b16 v[70:71], v14 offset:62464
s_waitcnt vmcnt(3) lgkmcnt(10)
v_mfma_f32_16x16x32_bf16 v[16:19], v[48:51], v[192:195], v[16:19]
ds_read_b64_tr_b16 v[72:73], v15 offset:57344
s_waitcnt vmcnt(2) lgkmcnt(9)
v_mfma_f32_16x16x32_bf16 v[16:19], v[52:55], v[200:203], v[16:19]
ds_read_b64_tr_b16 v[74:75], v15 offset:58368
s_waitcnt vmcnt(1)
v_mfma_f32_16x16x32_bf16 v[32:35], v[48:51], v[196:199], v[32:35]
ds_read_b64_tr_b16 v[76:77], v15 offset:61440
s_waitcnt vmcnt(0)
v_mfma_f32_16x16x32_bf16 v[32:35], v[52:55], v[204:207], v[32:35]
ds_read_b64_tr_b16 v[78:79], v15 offset:62464
s_waitcnt lgkmcnt(10)
v_mfma_f32_16x16x32_bf16 v[20:23], v[56:59], v[192:195], v[20:23]
v_add_u32 v5, s34, 22
s_mov_b64 exec, 1
ds_write_b32 v3, v5
s_mov_b64 exec, -1
s_waitcnt lgkmcnt(9)
v_mfma_f32_16x16x32_bf16 v[20:23], v[60:63], v[200:203], v[20:23]
v_mfma_f32_16x16x32_bf16 v[36:39], v[56:59], v[196:199], v[36:39]
v_mfma_f32_16x16x32_bf16 v[36:39], v[60:63], v[204:207], v[36:39]
s_waitcnt lgkmcnt(7)
v_mfma_f32_16x16x32_bf16 v[24:27], v[64:67], v[192:195], v[24:27]
s_waitcnt lgkmcnt(5)
v_mfma_f32_16x16x32_bf16 v[24:27], v[68:71], v[200:203], v[24:27]
v_mfma_f32_16x16x32_bf16 v[40:43], v[64:67], v[196:199], v[40:43]
v_mfma_f32_16x16x32_bf16 v[40:43], v[68:71], v[204:207], v[40:43]
s_waitcnt lgkmcnt(3)
v_mfma_f32_16x16x32_bf16 v[28:31], v[72:75], v[192:195], v[28:31]
s_waitcnt lgkmcnt(1)
v_mfma_f32_16x16x32_bf16 v[28:31], v[76:79], v[200:203], v[28:31]
v_mfma_f32_16x16x32_bf16 v[44:47], v[72:75], v[196:199], v[44:47]
v_mfma_f32_16x16x32_bf16 v[44:47], v[76:79], v[204:207], v[44:47]
s_lshl2_add_u32 s73, s61, s58
s_lshl4_add_u32 s66, s61, s62
s_lshl2_add_u32 s68, s66, s58
s_lshl_b32 s68, s68, 12
s_add_u32 s68, s68, 26214400
s_lshl_b32 s66, s66, 7
s_add_u32 s66, s66, 360448
s_lshl_b32 s74, s73, 13
s_add_u32 s74, s74, 524288
s_lshl_b32 s67, s62, 9
s_add_u32 s67, s67, s74
v_lshlrev_b32 v6, 4, v0
s_mov_b32 s69, 0x3f803f80
v_mov_b32 v8, 0
v_mov_b32 v9, 0
v_mov_b32 v10, 0
v_mov_b32 v11, 0
v_mov_b32 v12, 0
v_mov_b32 v13, 0
v_mov_b32 v14, 0
v_dot2c_f32_bf16 v11, s69, v232
v_dot2c_f32_bf16 v11, s69, v233
v_dot2c_f32_bf16 v11, s69, v234
v_dot2c_f32_bf16 v11, s69, v235
v_dot2c_f32_bf16 v11, s69, v236
v_dot2c_f32_bf16 v11, s69, v237
v_dot2c_f32_bf16 v11, s69, v238
v_dot2c_f32_bf16 v11, s69, v239
s_cmp_eq_u32 s63, 0
v_cvt_pk_bf16_f32 v240, v16, v17
v_cvt_pk_bf16_f32 v241, v18, v19
v_cvt_pk_bf16_f32 v242, v20, v21
v_cvt_pk_bf16_f32 v243, v22, v23
v_cvt_pk_bf16_f32 v244, v24, v25
v_cvt_pk_bf16_f32 v245, v26, v27
v_cvt_pk_bf16_f32 v246, v28, v29
v_cvt_pk_bf16_f32 v247, v30, v31
v_cvt_pk_bf16_f32 v248, v32, v33
v_cvt_pk_bf16_f32 v249, v34, v35
v_cvt_pk_bf16_f32 v250, v36, v37
v_cvt_pk_bf16_f32 v251, v38, v39
v_cvt_pk_bf16_f32 v252, v40, v41
v_cvt_pk_bf16_f32 v253, v42, v43
v_cvt_pk_bf16_f32 v254, v44, v45
v_cvt_pk_bf16_f32 v255, v46, v47
s_cselect_b64 exec, -1, 0
buffer_store_dwordx4 v[240:243], v6, s[20:23], s68 offen offset:0 sc1
buffer_store_dwordx4 v[244:247], v6, s[20:23], s68 offen offset:1024 sc1
buffer_store_dwordx4 v[248:251], v6, s[20:23], s68 offen offset:2048 sc1
buffer_store_dwordx4 v[252:255], v6, s[20:23], s68 offen offset:3072 sc1
s_mov_b64 exec, -1
v_dot2c_f32_bf16 v8, s69, v240
v_dot2c_f32_bf16 v9, v240, v240
v_dot2c_f32_bf16 v10, v232, v240
v_dot2c_f32_bf16 v12, s69, v248
v_dot2c_f32_bf16 v13, v248, v248
v_dot2c_f32_bf16 v14, v232, v248
v_dot2c_f32_bf16 v8, s69, v241
v_dot2c_f32_bf16 v9, v241, v241
v_dot2c_f32_bf16 v10, v233, v241
v_dot2c_f32_bf16 v12, s69, v249
v_dot2c_f32_bf16 v13, v249, v249
v_dot2c_f32_bf16 v14, v233, v249
v_dot2c_f32_bf16 v8, s69, v242
v_dot2c_f32_bf16 v9, v242, v242
v_dot2c_f32_bf16 v10, v234, v242
v_dot2c_f32_bf16 v12, s69, v250
v_dot2c_f32_bf16 v13, v250, v250
v_dot2c_f32_bf16 v14, v234, v250
v_dot2c_f32_bf16 v8, s69, v243
v_dot2c_f32_bf16 v9, v243, v243
v_dot2c_f32_bf16 v10, v235, v243
v_dot2c_f32_bf16 v12, s69, v251
v_dot2c_f32_bf16 v13, v251, v251
v_dot2c_f32_bf16 v14, v235, v251
v_dot2c_f32_bf16 v8, s69, v244
v_dot2c_f32_bf16 v9, v244, v244
v_dot2c_f32_bf16 v10, v236, v244
v_dot2c_f32_bf16 v12, s69, v252
v_dot2c_f32_bf16 v13, v252, v252
v_dot2c_f32_bf16 v14, v236, v252
v_dot2c_f32_bf16 v8, s69, v245
v_dot2c_f32_bf16 v9, v245, v245
v_dot2c_f32_bf16 v10, v237, v245
v_dot2c_f32_bf16 v12, s69, v253
v_dot2c_f32_bf16 v13, v253, v253
v_dot2c_f32_bf16 v14, v237, v253
v_dot2c_f32_bf16 v8, s69, v246
v_dot2c_f32_bf16 v9, v246, v246
v_dot2c_f32_bf16 v10, v238, v246
v_dot2c_f32_bf16 v12, s69, v254
v_dot2c_f32_bf16 v13, v254, v254
v_dot2c_f32_bf16 v14, v238, v254
v_dot2c_f32_bf16 v8, s69, v247
v_dot2c_f32_bf16 v9, v247, v247
v_dot2c_f32_bf16 v10, v239, v247
v_dot2c_f32_bf16 v12, s69, v255
v_dot2c_f32_bf16 v13, v255, v255
v_dot2c_f32_bf16 v14, v239, v255
v_mov_b32 v15, v11
v_lshrrev_b32 v7, 5, v0
v_mul_u32_u24 v7, 3584, v7
v_permlane16_swap_b32 v8, v12
v_permlane16_swap_b32 v9, v13
v_permlane16_swap_b32 v10, v14
v_permlane16_swap_b32 v11, v15
v_pk_add_f32 v[8:9], v[8:9], v[12:13]
v_pk_add_f32 v[10:11], v[10:11], v[14:15]
v_mov_b32 v12, v8
v_mov_b32 v13, v9
v_mov_b32 v14, v10
v_mov_b32 v15, v11
v_permlane32_swap_b32 v12, v8
v_permlane32_swap_b32 v13, v9
v_permlane32_swap_b32 v14, v10
v_permlane32_swap_b32 v15, v11
v_pk_add_f32 v[8:9], v[8:9], v[12:13]
v_pk_add_f32 v[10:11], v[10:11], v[14:15]
v_add_u32 v7, v6, v7
v_max_u32 v8, 1, v8
v_max_u32 v9, 1, v9
v_max_u32 v10, 1, v10
v_max_u32 v11, 1, v11
s_mov_b32 exec_hi, 0
buffer_store_dwordx4 v[8:11], v6, s[24:27], s67 offen sc1
s_mov_b32 exec_hi, -1
v_lshlrev_b32 v16, 16, v240
v_and_b32 v17, 0xffff0000, v240
v_lshlrev_b32 v18, 16, v241
v_and_b32 v19, 0xffff0000, v241
v_lshlrev_b32 v20, 16, v242
v_and_b32 v21, 0xffff0000, v242
v_lshlrev_b32 v22, 16, v243
v_and_b32 v23, 0xffff0000, v243
v_lshlrev_b32 v24, 16, v244
v_and_b32 v25, 0xffff0000, v244
v_lshlrev_b32 v26, 16, v245
v_and_b32 v27, 0xffff0000, v245
v_lshlrev_b32 v28, 16, v246
v_and_b32 v29, 0xffff0000, v246
v_lshlrev_b32 v30, 16, v247
v_and_b32 v31, 0xffff0000, v247
v_lshlrev_b32 v32, 16, v248
v_and_b32 v33, 0xffff0000, v248
v_lshlrev_b32 v34, 16, v249
v_and_b32 v35, 0xffff0000, v249
v_lshlrev_b32 v36, 16, v250
v_and_b32 v37, 0xffff0000, v250
v_lshlrev_b32 v38, 16, v251
v_and_b32 v39, 0xffff0000, v251
v_lshlrev_b32 v40, 16, v252
v_and_b32 v41, 0xffff0000, v252
v_lshlrev_b32 v42, 16, v253
v_and_b32 v43, 0xffff0000, v253
v_lshlrev_b32 v44, 16, v254
v_and_b32 v45, 0xffff0000, v254
v_lshlrev_b32 v46, 16, v255
v_and_b32 v47, 0xffff0000, v255
v_and_b32 v14, 15, v0
v_lshlrev_b32 v14, 11, v14
v_bfe_u32 v15, v0, 4, 1
v_lshl_add_u32 v14, v15, 5, v14
v_lshrrev_b32 v15, 5, v0
v_lshl_add_u32 v14, v15, 4, v14
s_lshl2_add_u32 s70, s61, s58
s_lshl_b32 s70, s70, 16
s_lshl_b32 s71, s62, 7
s_add_u32 s70, s70, s71
s_add_u32 s71, s70, 0x8000
s_lshl_b32 s67, s62, 6
s_add_u32 s67, s67, s73
s_lshl_b32 s67, s67, 7
s_add_u32 s67, s67, 425984
s_lshl4_add_u32 s68, s73, s62
s_lshl_b32 s69, s68, 8
s_add_u32 s69, s69, 2097152
s_lshl_b32 s68, s68, 7
s_add_u32 s68, s68, 1966080
s_lshl_b32 s75, s73, 5
s_add_u32 s75, s75, 1
v_and_b32 v15, 48, v0
v_add_u32 v13, s75, v0
s_mov_b64 exec, 1
s_waitcnt vmcnt(1)
buffer_store_dword v212, v3, s[24:27], s66 offen sc1
s_mov_b64 exec, -1
v_add_u32 v5, s34, 23
s_mov_b64 exec, 1
ds_write_b32 v3, v5
s_mov_b64 exec, -1
s_waitcnt vmcnt(1)
poll_126:
buffer_load_dwordx4 v[80:83], v7, s[24:27], s74 offen offset:0 sc1
buffer_load_dwordx4 v[84:87], v7, s[24:27], s74 offen offset:512 sc1
buffer_load_dwordx4 v[88:91], v7, s[24:27], s74 offen offset:1024 sc1
buffer_load_dwordx4 v[92:95], v7, s[24:27], s74 offen offset:1536 sc1
buffer_load_dwordx4 v[96:99], v7, s[24:27], s74 offen offset:2048 sc1
buffer_load_dwordx4 v[100:103], v7, s[24:27], s74 offen offset:2560 sc1
buffer_load_dwordx4 v[104:107], v7, s[24:27], s74 offen offset:3072 sc1
buffer_load_dwordx4 v[108:111], v7, s[24:27], s74 offen offset:3584 sc1
pchk_127:
s_waitcnt vmcnt(7)
v_min3_u32 v8, v80, v81, v82
s_waitcnt vmcnt(6)
v_min3_u32 v8, v8, v83, v84
v_min3_u32 v8, v8, v85, v86
s_waitcnt vmcnt(5)
v_min3_u32 v8, v8, v87, v88
v_min3_u32 v8, v8, v89, v90
s_waitcnt vmcnt(4)
v_min3_u32 v8, v8, v91, v92
v_min3_u32 v8, v8, v93, v94
s_waitcnt vmcnt(3)
v_min3_u32 v8, v8, v95, v96
v_min3_u32 v8, v8, v97, v98
s_waitcnt vmcnt(2)
v_min3_u32 v8, v8, v99, v100
v_min3_u32 v8, v8, v101, v102
s_waitcnt vmcnt(1)
v_min3_u32 v8, v8, v103, v104
v_min3_u32 v8, v8, v105, v106
s_waitcnt vmcnt(0)
v_min3_u32 v8, v8, v107, v108
v_min3_u32 v8, v8, v109, v110
v_min_u32 v8, v8, v111
v_cmp_eq_u32 vcc, 0, v8
s_cbranch_vccz pdone_128
s_sub_u32 s32, s32, 1
s_cmp_gt_i32 s32, 0
s_cbranch_scc1 poll_126
pdone_128:
v_pk_add_f32 v[80:81], v[80:81], v[96:97]
v_pk_add_f32 v[82:83], v[82:83], v[98:99]
v_pk_add_f32 v[84:85], v[84:85], v[100:101]
v_pk_add_f32 v[86:87], v[86:87], v[102:103]
v_pk_add_f32 v[88:89], v[88:89], v[104:105]
v_pk_add_f32 v[90:91], v[90:91], v[106:107]
v_pk_add_f32 v[92:93], v[92:93], v[108:109]
v_pk_add_f32 v[94:95], v[94:95], v[110:111]
v_pk_add_f32 v[80:81], v[80:81], v[88:89]
v_pk_add_f32 v[82:83], v[82:83], v[90:91]
v_pk_add_f32 v[84:85], v[84:85], v[92:93]
v_pk_add_f32 v[86:87], v[86:87], v[94:95]
v_pk_add_f32 v[80:81], v[80:81], v[84:85]
v_pk_add_f32 v[82:83], v[82:83], v[86:87]
v_mov_b32 v8, v80
v_mov_b32 v9, v81
v_mov_b32 v10, v82
v_mov_b32 v11, v83
v_permlane32_swap_b32 v8, v80
v_permlane32_swap_b32 v9, v81
v_permlane32_swap_b32 v10, v82
v_permlane32_swap_b32 v11, v83
v_pk_add_f32 v[8:9], v[8:9], v[80:81]
v_pk_add_f32 v[10:11], v[10:11], v[82:83]
v_mul_f32 v8, 0xba800000, v8
v_mul_f32 v9, 0x3a800000, v9
v_fma_f32 v9, -v8, v8, v9
v_max_f32 v9, 0, v9
v_add_f32 v12, 0x3727c5ac, v9
v_rsq_f32 v80, v12
v_fma_f32 v10, v8, v11, v10
v_mul_f32 v12, v80, v10
v_max_u32 v12, 1, v12
v_mov_b32 v10, v12
s_nop 1
v_max_f32_dpp v10, v10, v10 row_ror:1 row_mask:0xf bank_mask:0xf
s_nop 1
v_max_f32_dpp v10, v10, v10 row_ror:2 row_mask:0xf bank_mask:0xf
s_nop 1
v_max_f32_dpp v10, v10, v10 row_ror:4 row_mask:0xf bank_mask:0xf
s_nop 1
v_max_f32_dpp v10, v10, v10 row_ror:8 row_mask:0xf bank_mask:0xf
v_mov_b32 v11, v10
s_nop 1
v_permlane16_swap_b32 v11, v10
v_max_f32 v10, v10, v11
v_cmp_eq_f32 vcc, v10, v12
s_ff1_i32_b64 s66, vcc
s_and_b32 s66, s66, 31
s_lshl_b64 s[76:77], 1, s66
s_cmp_lt_u32 s62, 8
s_cselect_b64 exec, s[76:77], 0
buffer_store_dwordx2 v[12:13], off, s[24:27], s67 sc1
s_mov_b64 exec, -1
v_add_u32 v5, s34, 24
s_mov_b64 exec, 1
ds_write_b32 v3, v5
s_mov_b64 exec, -1
v_mul_f32 v81, v8, v80
v_add_f32 v10, 1.0, v80
v_mov_b32 v82, v80
v_mov_b32 v83, v81
s_and_b32 s67, s66, 15
s_lshl_b32 s67, 0x10001, s67
s_bitcmp0_b32 s66, 4
v_permlane16_swap_b32 v80, v82
v_permlane16_swap_b32 v81, v83
s_cselect_b32 s76, s67, 0
s_cselect_b32 s78, 0, s67
s_cselect_b32 s77, s67, 0
s_cselect_b32 s79, 0, s67
s_add_u32 s75, s75, s66
v_lshlrev_b32 v11, 1, v15
v_pk_fma_f32 v[48:49], v[16:17], v[80:81], v[80:81] op_sel:[0,0,1] op_sel_hi:[1,0,1]
v_pk_fma_f32 v[50:51], v[18:19], v[80:81], v[80:81] op_sel:[0,0,1] op_sel_hi:[1,0,1]
v_pk_fma_f32 v[52:53], v[20:21], v[80:81], v[80:81] op_sel:[0,0,1] op_sel_hi:[1,0,1]
v_pk_fma_f32 v[54:55], v[22:23], v[80:81], v[80:81] op_sel:[0,0,1] op_sel_hi:[1,0,1]
v_pk_fma_f32 v[56:57], v[24:25], v[80:81], v[80:81] op_sel:[0,0,1] op_sel_hi:[1,0,1]
v_pk_fma_f32 v[58:59], v[26:27], v[80:81], v[80:81] op_sel:[0,0,1] op_sel_hi:[1,0,1]
v_pk_fma_f32 v[60:61], v[28:29], v[80:81], v[80:81] op_sel:[0,0,1] op_sel_hi:[1,0,1]
v_pk_fma_f32 v[62:63], v[30:31], v[80:81], v[80:81] op_sel:[0,0,1] op_sel_hi:[1,0,1]
v_pk_fma_f32 v[64:65], v[32:33], v[82:83], v[82:83] op_sel:[0,0,1] op_sel_hi:[1,0,1]
v_pk_fma_f32 v[66:67], v[34:35], v[82:83], v[82:83] op_sel:[0,0,1] op_sel_hi:[1,0,1]
v_pk_fma_f32 v[68:69], v[36:37], v[82:83], v[82:83] op_sel:[0,0,1] op_sel_hi:[1,0,1]
v_pk_fma_f32 v[70:71], v[38:39], v[82:83], v[82:83] op_sel:[0,0,1] op_sel_hi:[1,0,1]
v_pk_fma_f32 v[72:73], v[40:41], v[82:83], v[82:83] op_sel:[0,0,1] op_sel_hi:[1,0,1]
v_pk_fma_f32 v[74:75], v[42:43], v[82:83], v[82:83] op_sel:[0,0,1] op_sel_hi:[1,0,1]
v_pk_fma_f32 v[76:77], v[44:45], v[82:83], v[82:83] op_sel:[0,0,1] op_sel_hi:[1,0,1]
v_pk_fma_f32 v[78:79], v[46:47], v[82:83], v[82:83] op_sel:[0,0,1] op_sel_hi:[1,0,1]
v_cvt_pk_bf16_f32 v84, v48, v49
v_cvt_pk_bf16_f32 v85, v50, v51
v_cvt_pk_bf16_f32 v86, v52, v53
v_cvt_pk_bf16_f32 v87, v54, v55
v_cvt_pk_bf16_f32 v88, v56, v57
v_cvt_pk_bf16_f32 v89, v58, v59
v_cvt_pk_bf16_f32 v90, v60, v61
v_cvt_pk_bf16_f32 v91, v62, v63
v_cvt_pk_bf16_f32 v92, v64, v65
v_cvt_pk_bf16_f32 v93, v66, v67
v_cvt_pk_bf16_f32 v94, v68, v69
v_cvt_pk_bf16_f32 v95, v70, v71
v_cvt_pk_bf16_f32 v96, v72, v73
v_cvt_pk_bf16_f32 v97, v74, v75
v_cvt_pk_bf16_f32 v98, v76, v77
v_cvt_pk_bf16_f32 v99, v78, v79
v_max_u32 v84, 1, v84
v_max_u32 v85, 1, v85
v_max_u32 v86, 1, v86
v_max_u32 v87, 1, v87
v_max_u32 v88, 1, v88
v_max_u32 v89, 1, v89
v_max_u32 v90, 1, v90
v_max_u32 v91, 1, v91
v_max_u32 v92, 1, v92
v_max_u32 v93, 1, v93
v_max_u32 v94, 1, v94
v_max_u32 v95, 1, v95
v_max_u32 v96, 1, v96
v_max_u32 v97, 1, v97
v_max_u32 v98, 1, v98
v_max_u32 v99, 1, v99
s_mov_b64 exec, s[76:77]
buffer_store_dwordx4 v[84:87], v11, s[24:27], s68 offen offset:0 sc1
buffer_store_dwordx4 v[88:91], v11, s[24:27], s68 offen offset:16 sc1
s_mov_b64 exec, s[78:79]
buffer_store_dwordx4 v[92:95], v11, s[24:27], s68 offen offset:0 sc1
buffer_store_dwordx4 v[96:99], v11, s[24:27], s68 offen offset:16 sc1
s_mov_b64 exec, -1
v_pk_add_f32 v[16:17], v[16:17], v[48:49]
v_pk_add_f32 v[18:19], v[18:19], v[50:51]
v_pk_add_f32 v[20:21], v[20:21], v[52:53]
v_pk_add_f32 v[22:23], v[22:23], v[54:55]
v_pk_add_f32 v[24:25], v[24:25], v[56:57]
v_pk_add_f32 v[26:27], v[26:27], v[58:59]
v_pk_add_f32 v[28:29], v[28:29], v[60:61]
v_pk_add_f32 v[30:31], v[30:31], v[62:63]
v_pk_add_f32 v[32:33], v[32:33], v[64:65]
v_pk_add_f32 v[34:35], v[34:35], v[66:67]
v_pk_add_f32 v[36:37], v[36:37], v[68:69]
v_pk_add_f32 v[38:39], v[38:39], v[70:71]
v_pk_add_f32 v[40:41], v[40:41], v[72:73]
v_pk_add_f32 v[42:43], v[42:43], v[74:75]
v_pk_add_f32 v[44:45], v[44:45], v[76:77]
v_pk_add_f32 v[46:47], v[46:47], v[78:79]
v_cvt_pk_bf16_f32 v240, v16, v17
v_cvt_pk_bf16_f32 v241, v18, v19
v_cvt_pk_bf16_f32 v242, v20, v21
v_cvt_pk_bf16_f32 v243, v22, v23
v_cvt_pk_bf16_f32 v244, v24, v25
v_cvt_pk_bf16_f32 v245, v26, v27
v_cvt_pk_bf16_f32 v246, v28, v29
v_cvt_pk_bf16_f32 v247, v30, v31
v_cvt_pk_bf16_f32 v248, v32, v33
v_cvt_pk_bf16_f32 v249, v34, v35
v_cvt_pk_bf16_f32 v250, v36, v37
v_cvt_pk_bf16_f32 v251, v38, v39
v_cvt_pk_bf16_f32 v252, v40, v41
v_cvt_pk_bf16_f32 v253, v42, v43
v_cvt_pk_bf16_f32 v254, v44, v45
v_cvt_pk_bf16_f32 v255, v46, v47
v_max_u32 v16, 1, v16
v_max_u32 v17, 1, v17
v_max_u32 v18, 1, v18
v_max_u32 v19, 1, v19
v_max_u32 v20, 1, v20
v_max_u32 v21, 1, v21
v_max_u32 v22, 1, v22
v_max_u32 v23, 1, v23
v_max_u32 v24, 1, v24
v_max_u32 v25, 1, v25
v_max_u32 v26, 1, v26
v_max_u32 v27, 1, v27
v_max_u32 v28, 1, v28
v_max_u32 v29, 1, v29
v_max_u32 v30, 1, v30
v_max_u32 v31, 1, v31
v_max_u32 v32, 1, v32
v_max_u32 v33, 1, v33
v_max_u32 v34, 1, v34
v_max_u32 v35, 1, v35
v_max_u32 v36, 1, v36
v_max_u32 v37, 1, v37
v_max_u32 v38, 1, v38
v_max_u32 v39, 1, v39
v_max_u32 v40, 1, v40
v_max_u32 v41, 1, v41
v_max_u32 v42, 1, v42
v_max_u32 v43, 1, v43
v_max_u32 v44, 1, v44
v_max_u32 v45, 1, v45
v_max_u32 v46, 1, v46
v_max_u32 v47, 1, v47
s_mov_b64 exec, s[76:77]
buffer_store_dwordx4 v[16:19], v15, s[24:27], s69 offen offset:0 sc1
buffer_store_dwordx4 v[20:23], v15, s[24:27], s69 offen offset:64 sc1
buffer_store_dwordx4 v[24:27], v15, s[24:27], s69 offen offset:128 sc1
buffer_store_dwordx4 v[28:31], v15, s[24:27], s69 offen offset:192 sc1
s_mov_b64 exec, s[78:79]
buffer_store_dwordx4 v[32:35], v15, s[24:27], s69 offen offset:0 sc1
buffer_store_dwordx4 v[36:39], v15, s[24:27], s69 offen offset:64 sc1
buffer_store_dwordx4 v[40:43], v15, s[24:27], s69 offen offset:128 sc1
buffer_store_dwordx4 v[44:47], v15, s[24:27], s69 offen offset:192 sc1
s_mov_b64 exec, -1
s_cmp_eq_u32 s63, 0
s_cbranch_scc0 mout_129
v_mul_f32 v11, v10, v10
v_mov_b32 v12, 0x3727c5ac
v_fma_f32 v11, v11, v9, v12
v_rsq_f32 v11, v11
v_lshrrev_b32 v12, 3, v0
v_lshlrev_b32 v12, 6, v12
v_lshl_add_u32 v12, v0, 3, v12
v_mul_f32 v10, v10, v11
v_mul_f32 v11, v8, v10
s_lshl_b32 s66, s73, 9
s_add_u32 s66, s66, 2621440
v_max_u32 v11, 1, v11
s_cmp_eq_u32 s62, 8
s_cselect_b32 exec_lo, -1, 0
s_mov_b32 exec_hi, 0
buffer_store_dwordx2 v[10:11], v12, s[24:27], s66 offen sc1
s_mov_b64 exec, -1
s_mov_b32 s63, 1
s_mov_b32 s34, 32
s_add_u32 s24, s24, 2359296
s_addc_u32 s25, s25, 0
s_mov_b32 s26, 2359296
s_branch L_mtop
mout_129:
v_permlane16_swap_b32 v240, v242
v_permlane16_swap_b32 v241, v243
v_permlane16_swap_b32 v244, v246
v_permlane16_swap_b32 v245, v247
v_permlane16_swap_b32 v248, v250
v_permlane16_swap_b32 v249, v251
v_permlane16_swap_b32 v252, v254
v_permlane16_swap_b32 v253, v255
s_not_b64 exec, s[76:77]
buffer_store_dwordx4 v[240:243], v14, s[28:31], s70 offen offset:0
buffer_store_dwordx4 v[244:247], v14, s[28:31], s70 offen offset:64
s_not_b64 exec, s[78:79]
buffer_store_dwordx4 v[248:251], v14, s[28:31], s71 offen offset:0
buffer_store_dwordx4 v[252:255], v14, s[28:31], s71 offen offset:64
s_mov_b64 exec, -1
v_mov_b32 v11, 0
s_add_u32 s35, s34, 3
lw_130:
ds_read_b32 v5, v2 offset:24
s_waitcnt lgkmcnt(0)
v_cmp_gt_i32 vcc, s35, v5
s_cbranch_vccz lwd_131
s_sleep 2
s_sub_u32 s32, s32, 1
s_cmp_gt_i32 s32, 0
s_cbranch_scc1 lw_130
lwd_131:
ds_read_b32 v11, v11 offset:32
s_waitcnt lgkmcnt(0)
v_cmp_eq_u32 vcc, s75, v11
s_cbranch_vccnz L_end
s_mov_b64 exec, s[76:77]
buffer_store_dwordx4 v[240:243], v14, s[28:31], s70 offen offset:0
buffer_store_dwordx4 v[244:247], v14, s[28:31], s70 offen offset:64
s_mov_b64 exec, s[78:79]
buffer_store_dwordx4 v[248:251], v14, s[28:31], s71 offen offset:0
buffer_store_dwordx4 v[252:255], v14, s[28:31], s71 offen offset:64
s_mov_b64 exec, -1
s_branch L_end
mspin_101:
s_cmp_eq_u32 s66, 1
s_cbranch_scc1 mback_102
msp_132:
ds_read_b32 v5, v2 offset:16
s_waitcnt lgkmcnt(0)
v_cmp_ge_u32 vcc, v4, v5
s_cbranch_vccz mback_102
s_sub_u32 s32, s32, 1
s_cmp_gt_i32 s32, 0
s_cbranch_scc1 msp_132
s_branch mback_102
patch_105:
s_bfe_u32 s66, s33, 0x20005
s_lshr_b32 s67, s66, 1
s_xor_b32 s66, s66, s67
s_and_b32 s66, s66, 1
s_cmp_eq_u32 s66, s65
s_cbranch_scc0 pback_106
s_lshl_b32 s67, s67, 5
s_and_b32 s66, s33, 31
s_add_u32 s66, s66, s67
v_and_b32 v10, 15, v0
v_sub_u32 v10, s66, v10
v_lshrrev_b32 v11, 4, v0
v_lshlrev_b32 v11, 2, v11
v_sub_u32 v11, s66, v11
v_cmp_eq_u32 vcc, 0, v10
s_mov_b64 exec, vcc
ds_read_b128 v[16:19], v9 offset:3456
ds_read_b128 v[20:23], v9 offset:3520
ds_read_b128 v[80:83], v9 offset:3328
ds_read_b128 v[84:87], v9 offset:3392
s_mov_b64 exec, -1
v_cmp_eq_u32 vcc, 0, v11
s_mov_b64 exec, vcc
ds_read_b32 v48, v8 offset:3584
ds_read_b32 v52, v8 offset:3648
s_mov_b64 exec, -1
v_cmp_eq_u32 vcc, 1, v11
s_mov_b64 exec, vcc
ds_read_b32 v49, v8 offset:3584
ds_read_b32 v53, v8 offset:3648
s_mov_b64 exec, -1
v_cmp_eq_u32 vcc, 2, v11
s_mov_b64 exec, vcc
ds_read_b32 v50, v8 offset:3584
ds_read_b32 v54, v8 offset:3648
s_mov_b64 exec, -1
v_cmp_eq_u32 vcc, 3, v11
s_mov_b64 exec, vcc
ds_read_b32 v51, v8 offset:3584
ds_read_b32 v55, v8 offset:3648
s_mov_b64 exec, -1
s_waitcnt lgkmcnt(0)
v_cmp_eq_u32 vcc, 16, v10
s_mov_b64 exec, vcc
ds_read_b128 v[24:27], v9 offset:3456
ds_read_b128 v[28:31], v9 offset:3520
ds_read_b128 v[88:91], v9 offset:3328
ds_read_b128 v[92:95], v9 offset:3392
s_mov_b64 exec, -1
v_cmp_eq_u32 vcc, 16, v11
s_mov_b64 exec, vcc
ds_read_b32 v56, v8 offset:3584
ds_read_b32 v60, v8 offset:3648
s_mov_b64 exec, -1
v_cmp_eq_u32 vcc, 17, v11
s_mov_b64 exec, vcc
ds_read_b32 v57, v8 offset:3584
ds_read_b32 v61, v8 offset:3648
s_mov_b64 exec, -1
v_cmp_eq_u32 vcc, 18, v11
s_mov_b64 exec, vcc
ds_read_b32 v58, v8 offset:3584
ds_read_b32 v62, v8 offset:3648
s_mov_b64 exec, -1
v_cmp_eq_u32 vcc, 19, v11
s_mov_b64 exec, vcc
ds_read_b32 v59, v8 offset:3584
ds_read_b32 v63, v8 offset:3648
s_mov_b64 exec, -1
s_waitcnt lgkmcnt(0)
v_cmp_eq_u32 vcc, 32, v10
s_mov_b64 exec, vcc
ds_read_b128 v[32:35], v9 offset:3456
ds_read_b128 v[36:39], v9 offset:3520
ds_read_b128 v[96:99], v9 offset:3328
ds_read_b128 v[100:103], v9 offset:3392
s_mov_b64 exec, -1
v_cmp_eq_u32 vcc, 32, v11
s_mov_b64 exec, vcc
ds_read_b32 v64, v8 offset:3584
ds_read_b32 v68, v8 offset:3648
s_mov_b64 exec, -1
v_cmp_eq_u32 vcc, 33, v11
s_mov_b64 exec, vcc
ds_read_b32 v65, v8 offset:3584
ds_read_b32 v69, v8 offset:3648
s_mov_b64 exec, -1
v_cmp_eq_u32 vcc, 34, v11
s_mov_b64 exec, vcc
ds_read_b32 v66, v8 offset:3584
ds_read_b32 v70, v8 offset:3648
s_mov_b64 exec, -1
v_cmp_eq_u32 vcc, 35, v11
s_mov_b64 exec, vcc
ds_read_b32 v67, v8 offset:3584
ds_read_b32 v71, v8 offset:3648
s_mov_b64 exec, -1
s_waitcnt lgkmcnt(0)
v_cmp_eq_u32 vcc, 48, v10
s_mov_b64 exec, vcc
ds_read_b128 v[40:43], v9 offset:3456
ds_read_b128 v[44:47], v9 offset:3520
ds_read_b128 v[104:107], v9 offset:3328
ds_read_b128 v[108:111], v9 offset:3392
s_mov_b64 exec, -1
v_cmp_eq_u32 vcc, 48, v11
s_mov_b64 exec, vcc
ds_read_b32 v72, v8 offset:3584
ds_read_b32 v76, v8 offset:3648
s_mov_b64 exec, -1
v_cmp_eq_u32 vcc, 49, v11
s_mov_b64 exec, vcc
ds_read_b32 v73, v8 offset:3584
ds_read_b32 v77, v8 offset:3648
s_mov_b64 exec, -1
v_cmp_eq_u32 vcc, 50, v11
s_mov_b64 exec, vcc
ds_read_b32 v74, v8 offset:3584
ds_read_b32 v78, v8 offset:3648
s_mov_b64 exec, -1
v_cmp_eq_u32 vcc, 51, v11
s_mov_b64 exec, vcc
ds_read_b32 v75, v8 offset:3584
ds_read_b32 v79, v8 offset:3648
s_mov_b64 exec, -1
s_waitcnt lgkmcnt(0)
s_branch pback_106
cross_116:
s_cmp_eq_u32 s67, 122880
s_cbranch_scc0 cr2_133
v_add_u32 v5, s34, 18
s_mov_b64 exec, 1
ds_write_b32 v3, v5
s_mov_b64 exec, -1
s_add_u32 s70, s72, 491520
s_mov_b64 exec, 1
s_waitcnt vmcnt(0)
buffer_store_dword v5, v3, s[24:27], s70 offen sc1
s_mov_b64 exec, -1
v_mov_b32 v9, 0xf149f2ca
v_xor_b32 v216, v9, v216
v_xor_b32 v217, v9, v217
v_xor_b32 v218, v9, v218
v_xor_b32 v219, v9, v219
v_xor_b32 v220, v9, v220
v_xor_b32 v221, v9, v221
v_xor_b32 v222, v9, v222
v_xor_b32 v223, v9, v223
v_xor_b32 v224, v9, v224
v_xor_b32 v225, v9, v225
v_xor_b32 v226, v9, v226
v_xor_b32 v227, v9, v227
v_xor_b32 v228, v9, v228
v_xor_b32 v229, v9, v229
v_xor_b32 v230, v9, v230
v_xor_b32 v231, v9, v231
s_mov_b32 s67, 90112
s_cmp_eq_u32 s63, 0
s_cbranch_scc0 cr3_134
v_and_b32 v9, 15, v0
v_lshlrev_b32 v9, 11, v9
v_bfe_u32 v10, v0, 4, 1
v_lshl_add_u32 v9, v10, 5, v9
v_lshrrev_b32 v10, 5, v0
v_lshl_add_u32 v9, v10, 4, v9
s_lshl2_add_u32 s70, s61, s58
s_lshl_b32 s70, s70, 16
s_lshl_b32 s71, s62, 7
s_add_u32 s70, s70, s71
s_add_u32 s71, s70, 0x8000
buffer_load_dwordx4 v[240:243], v9, s[8:11], s70 offen offset:0
buffer_load_dwordx4 v[244:247], v9, s[8:11], s70 offen offset:64
buffer_load_dwordx4 v[248:251], v9, s[8:11], s71 offen offset:0
buffer_load_dwordx4 v[252:255], v9, s[8:11], s71 offen offset:64
cr3_134:
s_cmp_eq_u32 s59, 0
s_cbranch_scc1 cback_117
v_mov_b32 v9, 0
s_add_u32 s35, s34, 17
lw_135:
ds_read_b32 v5, v9 offset:16
s_waitcnt lgkmcnt(0)
v_cmp_gt_i32 vcc, s35, v5
s_cbranch_vccz lwd_136
s_sub_u32 s32, s32, 1
s_cmp_gt_i32 s32, 0
s_cbranch_scc1 lw_135
lwd_136:
s_branch cback_117
cr2_133:
v_add_u32 v5, s34, 19
s_mov_b64 exec, 1
ds_write_b32 v3, v5
s_mov_b64 exec, -1
s_mov_b32 s66, 28672
s_cmp_lt_u32 s59, 2
s_cbranch_scc1 cback_117
s_add_u32 s35, s34, 17
lw_137:
ds_read_b32 v5, v2 offset:16
s_waitcnt lgkmcnt(0)
v_cmp_gt_i32 vcc, s35, v5
s_cbranch_vccz lwd_138
s_sub_u32 s32, s32, 1
s_cmp_gt_i32 s32, 0
s_cbranch_scc1 lw_137
lwd_138:
s_branch cback_117
cross_118:
s_cmp_eq_u32 s67, 122880
s_cbranch_scc0 cr2_139
v_add_u32 v5, s34, 18
s_mov_b64 exec, 1
ds_write_b32 v3, v5
s_mov_b64 exec, -1
s_add_u32 s70, s72, 491520
s_mov_b64 exec, 1
s_waitcnt vmcnt(0)
buffer_store_dword v5, v3, s[24:27], s70 offen sc1
s_mov_b64 exec, -1
v_mov_b32 v9, 0xf149f2ca
v_xor_b32 v216, v9, v216
v_xor_b32 v217, v9, v217
v_xor_b32 v218, v9, v218
v_xor_b32 v219, v9, v219
v_xor_b32 v220, v9, v220
v_xor_b32 v221, v9, v221
v_xor_b32 v222, v9, v222
v_xor_b32 v223, v9, v223
v_xor_b32 v224, v9, v224
v_xor_b32 v225, v9, v225
v_xor_b32 v226, v9, v226
v_xor_b32 v227, v9, v227
v_xor_b32 v228, v9, v228
v_xor_b32 v229, v9, v229
v_xor_b32 v230, v9, v230
v_xor_b32 v231, v9, v231
s_mov_b32 s67, 90112
s_cmp_eq_u32 s63, 0
s_cbranch_scc0 cr3_140
v_and_b32 v9, 15, v0
v_lshlrev_b32 v9, 11, v9
v_bfe_u32 v10, v0, 4, 1
v_lshl_add_u32 v9, v10, 5, v9
v_lshrrev_b32 v10, 5, v0
v_lshl_add_u32 v9, v10, 4, v9
s_lshl2_add_u32 s70, s61, s58
s_lshl_b32 s70, s70, 16
s_lshl_b32 s71, s62, 7
s_add_u32 s70, s70, s71
s_add_u32 s71, s70, 0x8000
buffer_load_dwordx4 v[240:243], v9, s[8:11], s70 offen offset:0
buffer_load_dwordx4 v[244:247], v9, s[8:11], s70 offen offset:64
buffer_load_dwordx4 v[248:251], v9, s[8:11], s71 offen offset:0
buffer_load_dwordx4 v[252:255], v9, s[8:11], s71 offen offset:64
cr3_140:
s_cmp_eq_u32 s59, 0
s_cbranch_scc1 cback_119
v_mov_b32 v9, 0
s_add_u32 s35, s34, 17
lw_141:
ds_read_b32 v5, v9 offset:16
s_waitcnt lgkmcnt(0)
v_cmp_gt_i32 vcc, s35, v5
s_cbranch_vccz lwd_142
s_sub_u32 s32, s32, 1
s_cmp_gt_i32 s32, 0
s_cbranch_scc1 lw_141
lwd_142:
s_branch cback_119
cr2_139:
v_add_u32 v5, s34, 19
s_mov_b64 exec, 1
ds_write_b32 v3, v5
s_mov_b64 exec, -1
s_mov_b32 s66, 28672
s_cmp_lt_u32 s59, 2
s_cbranch_scc1 cback_119
s_add_u32 s35, s34, 17
lw_143:
ds_read_b32 v5, v2 offset:16
s_waitcnt lgkmcnt(0)
v_cmp_gt_i32 vcc, s35, v5
s_cbranch_vccz lwd_144
s_sub_u32 s32, s32, 1
s_cmp_gt_i32 s32, 0
s_cbranch_scc1 lw_143
lwd_144:
s_branch cback_119
slow_120:
s_add_u32 s70, s72, 491520
poll_145:
buffer_load_dword v10, v1, s[24:27], s70 offen sc1
pchk_146:
s_waitcnt vmcnt(0)
v_cmp_eq_u32 vcc, 0, v10
s_cbranch_vccz pdone_147
s_sub_u32 s32, s32, 1
s_cmp_gt_i32 s32, 0
s_cbranch_scc1 poll_145
pdone_147:
s_lshl_b32 s73, s60, 15
s_lshl_b32 s74, s63, 23
s_add_u32 s73, s73, s74
s_add_u32 s73, s73, 1048576
v_mov_b32 v10, 0xf149f2ca
v_mov_b32 v11, 0
v_mov_b32 v192, 0
v_mov_b32 v193, 0
v_mov_b32 v194, 0
v_mov_b32 v195, 0
v_mov_b32 v196, 0
v_mov_b32 v197, 0
v_mov_b32 v198, 0
v_mov_b32 v199, 0
v_mov_b32 v200, 0
v_mov_b32 v201, 0
v_mov_b32 v202, 0
v_mov_b32 v203, 0
v_mov_b32 v204, 0
v_mov_b32 v205, 0
v_mov_b32 v206, 0
v_mov_b32 v207, 0
v_mov_b32 v208, 0
v_mov_b32 v209, 0
v_mov_b32 v210, 0
v_mov_b32 v211, 0
s_lshl2_add_u32 s74, s59, s65
s_mov_b32 s75, 0
sl_148:
s_lshr_b32 s76, s74, 2
s_lshl_b32 s76, s76, 19
s_and_b32 s77, s74, 3
s_lshl_b32 s77, s77, 13
s_add_u32 s76, s76, s77
s_add_u32 s76, s76, s73
buffer_load_dwordx4 v[152:155], v6, s[20:23], s76 offen offset:0 sc1
buffer_load_dwordx4 v[156:159], v6, s[20:23], s76 offen offset:1024 sc1
s_cmp_eq_u32 s75, 0
s_cselect_b32 s76, 0xf149f2ca, 0
s_and_b32 s77, s75, 7
s_cselect_b32 s77, 0, -1
v_xor_b32 v112, s76, v216
v_and_b32 v112, s77, v112
v_xor_b32 v113, s76, v217
v_and_b32 v113, s77, v113
v_xor_b32 v114, s76, v218
v_and_b32 v114, s77, v114
v_xor_b32 v115, s76, v219
v_and_b32 v115, s77, v115
v_xor_b32 v116, s76, v220
v_and_b32 v116, s77, v116
v_xor_b32 v117, s76, v221
v_and_b32 v117, s77, v117
v_xor_b32 v118, s76, v222
v_and_b32 v118, s77, v118
v_xor_b32 v119, s76, v223
v_and_b32 v119, s77, v119
v_xor_b32 v120, s76, v224
v_and_b32 v120, s77, v120
v_xor_b32 v121, s76, v225
v_and_b32 v121, s77, v121
v_xor_b32 v122, s76, v226
v_and_b32 v122, s77, v122
v_xor_b32 v123, s76, v227
v_and_b32 v123, s77, v123
v_xor_b32 v124, s76, v228
v_and_b32 v124, s77, v124
v_xor_b32 v125, s76, v229
v_and_b32 v125, s77, v125
v_xor_b32 v126, s76, v230
v_and_b32 v126, s77, v126
v_xor_b32 v127, s76, v231
v_and_b32 v127, s77, v127
s_waitcnt vmcnt(1)
s_nop 0
v_mfma_f32_32x32x16_bf16 v[112:127], v[152:155], v[80:83], v[112:127]
s_waitcnt vmcnt(0)
v_mfma_f32_32x32x16_bf16 v[112:127], v[156:159], v[88:91], v[112:127]
s_nop 11
v_max3_f32 v10, v10, v112, v113
v_max3_f32 v10, v10, v114, v115
v_max3_f32 v10, v10, v116, v117
v_max3_f32 v10, v10, v118, v119
v_max3_f32 v10, v10, v120, v121
v_max3_f32 v10, v10, v122, v123
v_max3_f32 v10, v10, v124, v125
v_max3_f32 v10, v10, v126, v127
s_add_u32 s75, s75, 1
s_sub_u32 s74, s74, 1
s_cselect_b32 s75, 9, s75
s_cmp_lt_u32 s75, 9
s_cbranch_scc1 sl_148
v_mov_b32 v11, v10
s_nop 1
v_permlane32_swap_b32 v11, v10
v_max_f32 v10, v10, v11
s_lshl2_add_u32 s74, s59, s65
s_mov_b32 s75, 0
sl_149:
s_lshr_b32 s76, s74, 2
s_lshl_b32 s76, s76, 19
s_and_b32 s77, s74, 3
s_lshl_b32 s77, s77, 13
s_add_u32 s76, s76, s77
s_add_u32 s76, s76, s73
buffer_load_dwordx4 v[152:155], v6, s[20:23], s76 offen offset:0 sc1
buffer_load_dwordx4 v[156:159], v6, s[20:23], s76 offen offset:1024 sc1
buffer_load_dwordx4 v[160:163], v6, s[20:23], s76 offen offset:2048 sc1
buffer_load_dwordx4 v[164:167], v6, s[20:23], s76 offen offset:3072 sc1
s_cmp_eq_u32 s75, 0
s_cselect_b32 s76, 0xf149f2ca, 0
s_and_b32 s77, s75, 7
s_cselect_b32 s77, 0, -1
v_xor_b32 v112, s76, v216
v_and_b32 v112, s77, v112
v_sub_f32 v112, v112, v10
v_xor_b32 v113, s76, v217
v_and_b32 v113, s77, v113
v_sub_f32 v113, v113, v10
v_xor_b32 v114, s76, v218
v_and_b32 v114, s77, v114
v_sub_f32 v114, v114, v10
v_xor_b32 v115, s76, v219
v_and_b32 v115, s77, v115
v_sub_f32 v115, v115, v10
v_xor_b32 v116, s76, v220
v_and_b32 v116, s77, v116
v_sub_f32 v116, v116, v10
v_xor_b32 v117, s76, v221
v_and_b32 v117, s77, v117
v_sub_f32 v117, v117, v10
v_xor_b32 v118, s76, v222
v_and_b32 v118, s77, v118
v_sub_f32 v118, v118, v10
v_xor_b32 v119, s76, v223
v_and_b32 v119, s77, v119
v_sub_f32 v119, v119, v10
v_xor_b32 v120, s76, v224
v_and_b32 v120, s77, v120
v_sub_f32 v120, v120, v10
v_xor_b32 v121, s76, v225
v_and_b32 v121, s77, v121
v_sub_f32 v121, v121, v10
v_xor_b32 v122, s76, v226
v_and_b32 v122, s77, v122
v_sub_f32 v122, v122, v10
v_xor_b32 v123, s76, v227
v_and_b32 v123, s77, v123
v_sub_f32 v123, v123, v10
v_xor_b32 v124, s76, v228
v_and_b32 v124, s77, v124
v_sub_f32 v124, v124, v10
v_xor_b32 v125, s76, v229
v_and_b32 v125, s77, v125
v_sub_f32 v125, v125, v10
v_xor_b32 v126, s76, v230
v_and_b32 v126, s77, v126
v_sub_f32 v126, v126, v10
v_xor_b32 v127, s76, v231
v_and_b32 v127, s77, v127
v_sub_f32 v127, v127, v10
s_waitcnt vmcnt(3)
s_nop 0
v_mfma_f32_32x32x16_bf16 v[112:127], v[152:155], v[80:83], v[112:127]
s_waitcnt vmcnt(2)
v_mfma_f32_32x32x16_bf16 v[112:127], v[156:159], v[88:91], v[112:127]
s_nop 11
v_exp_f32 v112, v112
v_exp_f32 v113, v113
v_exp_f32 v114, v114
v_exp_f32 v115, v115
v_exp_f32 v116, v116
v_exp_f32 v117, v117
v_exp_f32 v118, v118
v_exp_f32 v119, v119
v_exp_f32 v120, v120
v_exp_f32 v121, v121
v_exp_f32 v122, v122
v_exp_f32 v123, v123
v_exp_f32 v124, v124
v_exp_f32 v125, v125
v_exp_f32 v126, v126
v_exp_f32 v127, v127
v_cvt_pk_bf16_f32 v144, v112, v113
v_cvt_pk_bf16_f32 v145, v114, v115
v_cvt_pk_bf16_f32 v146, v116, v117
v_cvt_pk_bf16_f32 v147, v118, v119
v_cvt_pk_bf16_f32 v148, v120, v121
v_cvt_pk_bf16_f32 v149, v122, v123
v_cvt_pk_bf16_f32 v150, v124, v125
v_cvt_pk_bf16_f32 v151, v126, v127
s_waitcnt vmcnt(1)
v_mfma_f32_32x32x16_bf16 v[192:207], v[160:163], v[144:147], v[192:207]
v_mfma_f32_16x16x32_bf16 v[208:211], v[212:215], v[144:147], v[208:211]
s_waitcnt vmcnt(0)
v_mfma_f32_32x32x16_bf16 v[192:207], v[164:167], v[148:151], v[192:207]
v_mfma_f32_16x16x32_bf16 v[208:211], v[212:215], v[148:151], v[208:211]
s_add_u32 s75, s75, 1
s_sub_u32 s74, s74, 1
s_cselect_b32 s75, 9, s75
s_cmp_lt_u32 s75, 9
s_cbranch_scc1 sl_149
v_mov_b32 v10, 0xf149f2ca
v_mov_b32 v11, 0
v_mov_b32 v16, 0
v_mov_b32 v17, 0
v_mov_b32 v18, 0
v_mov_b32 v19, 0
v_mov_b32 v20, 0
v_mov_b32 v21, 0
v_mov_b32 v22, 0
v_mov_b32 v23, 0
v_mov_b32 v24, 0
v_mov_b32 v25, 0
v_mov_b32 v26, 0
v_mov_b32 v27, 0
v_mov_b32 v28, 0
v_mov_b32 v29, 0
v_mov_b32 v30, 0
v_mov_b32 v31, 0
v_mov_b32 v32, 0
v_mov_b32 v33, 0
v_mov_b32 v34, 0
v_mov_b32 v35, 0
s_sub_u32 s74, 3, s65
s_lshl2_add_u32 s74, s59, s74
s_mov_b32 s75, 0
sl_150:
s_lshr_b32 s76, s74, 2
s_lshl_b32 s76, s76, 19
s_and_b32 s77, s74, 3
s_lshl_b32 s77, s77, 13
s_add_u32 s76, s76, s77
s_add_u32 s76, s76, s73
buffer_load_dwordx4 v[152:155], v6, s[20:23], s76 offen offset:0 sc1
buffer_load_dwordx4 v[156:159], v6, s[20:23], s76 offen offset:1024 sc1
s_cmp_eq_u32 s75, 0
s_cselect_b32 s76, 0xf149f2ca, 0
s_and_b32 s77, s75, 7
s_cselect_b32 s77, 0, -1
v_xor_b32 v112, s76, v216
v_and_b32 v112, s77, v112
v_xor_b32 v113, s76, v217
v_and_b32 v113, s77, v113
v_xor_b32 v114, s76, v218
v_and_b32 v114, s77, v114
v_xor_b32 v115, s76, v219
v_and_b32 v115, s77, v115
v_xor_b32 v116, s76, v220
v_and_b32 v116, s77, v116
v_xor_b32 v117, s76, v221
v_and_b32 v117, s77, v117
v_xor_b32 v118, s76, v222
v_and_b32 v118, s77, v118
v_xor_b32 v119, s76, v223
v_and_b32 v119, s77, v119
v_xor_b32 v120, s76, v224
v_and_b32 v120, s77, v120
v_xor_b32 v121, s76, v225
v_and_b32 v121, s77, v121
v_xor_b32 v122, s76, v226
v_and_b32 v122, s77, v122
v_xor_b32 v123, s76, v227
v_and_b32 v123, s77, v123
v_xor_b32 v124, s76, v228
v_and_b32 v124, s77, v124
v_xor_b32 v125, s76, v229
v_and_b32 v125, s77, v125
v_xor_b32 v126, s76, v230
v_and_b32 v126, s77, v126
v_xor_b32 v127, s76, v231
v_and_b32 v127, s77, v127
s_waitcnt vmcnt(1)
s_nop 0
v_mfma_f32_32x32x16_bf16 v[112:127], v[152:155], v[96:99], v[112:127]
s_waitcnt vmcnt(0)
v_mfma_f32_32x32x16_bf16 v[112:127], v[156:159], v[104:107], v[112:127]
s_nop 11
v_max3_f32 v10, v10, v112, v113
v_max3_f32 v10, v10, v114, v115
v_max3_f32 v10, v10, v116, v117
v_max3_f32 v10, v10, v118, v119
v_max3_f32 v10, v10, v120, v121
v_max3_f32 v10, v10, v122, v123
v_max3_f32 v10, v10, v124, v125
v_max3_f32 v10, v10, v126, v127
s_add_u32 s75, s75, 1
s_sub_u32 s74, s74, 1
s_cselect_b32 s75, 9, s75
s_cmp_lt_u32 s75, 9
s_cbranch_scc1 sl_150
v_mov_b32 v11, v10
s_nop 1
v_permlane32_swap_b32 v11, v10
v_max_f32 v10, v10, v11
s_sub_u32 s74, 3, s65
s_lshl2_add_u32 s74, s59, s74
s_mov_b32 s75, 0
sl_151:
s_lshr_b32 s76, s74, 2
s_lshl_b32 s76, s76, 19
s_and_b32 s77, s74, 3
s_lshl_b32 s77, s77, 13
s_add_u32 s76, s76, s77
s_add_u32 s76, s76, s73
buffer_load_dwordx4 v[152:155], v6, s[20:23], s76 offen offset:0 sc1
buffer_load_dwordx4 v[156:159], v6, s[20:23], s76 offen offset:1024 sc1
buffer_load_dwordx4 v[160:163], v6, s[20:23], s76 offen offset:2048 sc1
buffer_load_dwordx4 v[164:167], v6, s[20:23], s76 offen offset:3072 sc1
s_cmp_eq_u32 s75, 0
s_cselect_b32 s76, 0xf149f2ca, 0
s_and_b32 s77, s75, 7
s_cselect_b32 s77, 0, -1
v_xor_b32 v112, s76, v216
v_and_b32 v112, s77, v112
v_sub_f32 v112, v112, v10
v_xor_b32 v113, s76, v217
v_and_b32 v113, s77, v113
v_sub_f32 v113, v113, v10
v_xor_b32 v114, s76, v218
v_and_b32 v114, s77, v114
v_sub_f32 v114, v114, v10
v_xor_b32 v115, s76, v219
v_and_b32 v115, s77, v115
v_sub_f32 v115, v115, v10
v_xor_b32 v116, s76, v220
v_and_b32 v116, s77, v116
v_sub_f32 v116, v116, v10
v_xor_b32 v117, s76, v221
v_and_b32 v117, s77, v117
v_sub_f32 v117, v117, v10
v_xor_b32 v118, s76, v222
v_and_b32 v118, s77, v118
v_sub_f32 v118, v118, v10
v_xor_b32 v119, s76, v223
v_and_b32 v119, s77, v119
v_sub_f32 v119, v119, v10
v_xor_b32 v120, s76, v224
v_and_b32 v120, s77, v120
v_sub_f32 v120, v120, v10
v_xor_b32 v121, s76, v225
v_and_b32 v121, s77, v121
v_sub_f32 v121, v121, v10
v_xor_b32 v122, s76, v226
v_and_b32 v122, s77, v122
v_sub_f32 v122, v122, v10
v_xor_b32 v123, s76, v227
v_and_b32 v123, s77, v123
v_sub_f32 v123, v123, v10
v_xor_b32 v124, s76, v228
v_and_b32 v124, s77, v124
v_sub_f32 v124, v124, v10
v_xor_b32 v125, s76, v229
v_and_b32 v125, s77, v125
v_sub_f32 v125, v125, v10
v_xor_b32 v126, s76, v230
v_and_b32 v126, s77, v126
v_sub_f32 v126, v126, v10
v_xor_b32 v127, s76, v231
v_and_b32 v127, s77, v127
v_sub_f32 v127, v127, v10
s_waitcnt vmcnt(3)
s_nop 0
v_mfma_f32_32x32x16_bf16 v[112:127], v[152:155], v[96:99], v[112:127]
s_waitcnt vmcnt(2)
v_mfma_f32_32x32x16_bf16 v[112:127], v[156:159], v[104:107], v[112:127]
s_nop 11
v_exp_f32 v112, v112
v_exp_f32 v113, v113
v_exp_f32 v114, v114
v_exp_f32 v115, v115
v_exp_f32 v116, v116
v_exp_f32 v117, v117
v_exp_f32 v118, v118
v_exp_f32 v119, v119
v_exp_f32 v120, v120
v_exp_f32 v121, v121
v_exp_f32 v122, v122
v_exp_f32 v123, v123
v_exp_f32 v124, v124
v_exp_f32 v125, v125
v_exp_f32 v126, v126
v_exp_f32 v127, v127
v_cvt_pk_bf16_f32 v144, v112, v113
v_cvt_pk_bf16_f32 v145, v114, v115
v_cvt_pk_bf16_f32 v146, v116, v117
v_cvt_pk_bf16_f32 v147, v118, v119
v_cvt_pk_bf16_f32 v148, v120, v121
v_cvt_pk_bf16_f32 v149, v122, v123
v_cvt_pk_bf16_f32 v150, v124, v125
v_cvt_pk_bf16_f32 v151, v126, v127
s_waitcnt vmcnt(1)
v_mfma_f32_32x32x16_bf16 v[16:31], v[160:163], v[144:147], v[16:31]
v_mfma_f32_16x16x32_bf16 v[32:35], v[212:215], v[144:147], v[32:35]
s_waitcnt vmcnt(0)
v_mfma_f32_32x32x16_bf16 v[16:31], v[164:167], v[148:151], v[16:31]
v_mfma_f32_16x16x32_bf16 v[32:35], v[212:215], v[148:151], v[32:35]
s_add_u32 s75, s75, 1
s_sub_u32 s74, s74, 1
s_cselect_b32 s75, 9, s75
s_cmp_lt_u32 s75, 9
s_cbranch_scc1 sl_151
s_branch sback_121
mo_122:
s_lshr_b32 s67, s33, 5
s_cmp_eq_u32 s67, s66
s_cbranch_scc0 mo_123
s_and_b32 s67, s33, 31
v_sub_u32 v48, s67, v48
v_lshlrev_b32 v49, 7, v49
s_lshl_b32 s67, s62, 11
s_add_u32 s67, s67, 30801920
poll_152:
buffer_load_dwordx2 v[56:57], v49, s[20:23], s67 offen offset:0 sc1
buffer_load_dwordx2 v[58:59], v49, s[20:23], s67 offen offset:512 sc1
buffer_load_dwordx2 v[60:61], v49, s[20:23], s67 offen offset:1024 sc1
buffer_load_dwordx2 v[62:63], v49, s[20:23], s67 offen offset:1536 sc1
pchk_153:
s_waitcnt vmcnt(2)
v_min3_u32 v50, v56, v57, v58
s_waitcnt vmcnt(1)
v_min3_u32 v50, v50, v59, v60
s_waitcnt vmcnt(0)
v_min3_u32 v50, v50, v61, v62
v_min_u32 v50, v50, v63
v_cmp_eq_u32 vcc, 0, v50
s_cbranch_vccz pdone_154
s_sub_u32 s32, s32, 1
s_cmp_gt_i32 s32, 0
s_cbranch_scc1 poll_152
pdone_154:
v_cmp_eq_u32 vcc, 0, v48
s_nop 1
v_cndmask_b32 v240, v240, v56, vcc
v_cndmask_b32 v241, v241, v57, vcc
v_cndmask_b32 v242, v242, v58, vcc
v_cndmask_b32 v243, v243, v59, vcc
v_cndmask_b32 v244, v244, v60, vcc
v_cndmask_b32 v245, v245, v61, vcc
v_cndmask_b32 v246, v246, v62, vcc
v_cndmask_b32 v247, v247, v63, vcc
v_cmp_eq_u32 vcc, 16, v48
s_nop 1
v_cndmask_b32 v248, v248, v56, vcc
v_cndmask_b32 v249, v249, v57, vcc
v_cndmask_b32 v250, v250, v58, vcc
v_cndmask_b32 v251, v251, v59, vcc
v_cndmask_b32 v252, v252, v60, vcc
v_cndmask_b32 v253, v253, v61, vcc
v_cndmask_b32 v254, v254, v62, vcc
v_cndmask_b32 v255, v255, v63, vcc
s_branch mo_123
L_end:
L_fin:
s_endpgm
.section .rodata,"a"
.p2align 6
.amdhsa_kernel interleave_layers__sliding_block__moe_arch_mod__prompt_kernel
  .amdhsa_next_free_vgpr 256
  .amdhsa_next_free_sgpr 102
  .amdhsa_accum_offset 256
  .amdhsa_group_segment_fixed_size 0
  .amdhsa_kernarg_size 88
  .amdhsa_user_sgpr_count 2
  .amdhsa_user_sgpr_kernarg_segment_ptr 1
  .amdhsa_system_sgpr_workgroup_id_x 1
  .amdhsa_float_denorm_mode_32 3
.end_amdhsa_kernel
```

```asm
; @launch grid=(256,1,1) block=(512,1,1) lds=163840
.amdgcn_target "amdgcn-amd-amdhsa--gfx950"
.text
.globl interleave_layers__sliding_block__moe_arch_mod__prompt_kernel
.p2align 8
.type interleave_layers__sliding_block__moe_arch_mod__prompt_kernel,@function
interleave_layers__sliding_block__moe_arch_mod__prompt_kernel:
s_cmp_ge_u32 s2, 256
s_cbranch_scc1 L_fin
s_load_dwordx16 s[36:51], s[0:1], 0
s_load_dwordx4 s[52:55], s[0:1], 64
s_load_dwordx2 s[56:57], s[0:1], 80
v_lshrrev_b32 v1, 6, v0
v_and_b32 v0, 63, v0
s_and_b32 s64, s2, 7
v_readfirstlane_b32 s3, v1
s_lshr_b32 s65, s2, 3
s_and_b32 s66, s65, 7
s_and_b32 s67, s64, 1
s_lshl3_add_u32 s59, s67, s66
s_lshr_b32 s66, s65, 3
s_lshr_b32 s67, s64, 1
s_lshl2_add_u32 s60, s67, s66
s_and_b32 s66, s65, 1
s_lshl1_add_u32 s61, s64, s66
s_lshr_b32 s62, s65, 1
s_mov_b32 s63, 0
s_mov_b32 s34, 0
s_mov_b32 s32, 200000
s_mov_b32 s33, -1
s_cmp_ge_u32 s3, 4
s_cselect_b32 s66, 3, 1
s_and_b32 s58, s3, s66
s_waitcnt lgkmcnt(0)
s_mov_b32 s8, s36
s_mov_b32 s9, s37
s_mov_b32 s10, 0x400000
s_mov_b32 s11, 0x00020000
s_mov_b32 s12, s38
s_mov_b32 s13, s39
s_mov_b32 s14, 0x600000
s_mov_b32 s15, 0x00020000
s_mov_b32 s16, s40
s_mov_b32 s17, s41
s_mov_b32 s18, 0x200000
s_mov_b32 s19, 0x00020000
s_mov_b32 s20, s56
s_mov_b32 s21, s57
s_mov_b32 s22, 0x2500000
s_mov_b32 s23, 0x00020000
s_add_u32 s24, s56, 30408704
s_addc_u32 s25, s57, 0
s_mov_b32 s26, 5898240
s_mov_b32 s27, 0x00020000
s_mov_b32 s28, s52
s_mov_b32 s29, s53
s_mov_b32 s30, 0x400000
s_mov_b32 s31, 0x00020000
s_cmp_ge_u32 s3, 4
s_cbranch_scc1 L_m
s_cmp_ge_u32 s3, 2
s_cbranch_scc1 L_f
s_setprio 1
v_and_b32 v22, 7, v0
v_lshrrev_b32 v23, 4, v0
v_lshrrev_b32 v6, 3, v0
v_xor_b32 v7, v22, v23
v_lshlrev_b32 v7, 4, v7
v_lshl_add_u32 v8, v6, 11, v7
v_xor_b32 v7, 64, v8
v_add_u32 v9, 15360, v7
v_add_u32 v10, 30720, v8
v_add_u32 v11, 46080, v7
s_lshl_b32 s70, s59, 18
s_lshl_b32 s71, s58, 16
s_add_u32 s68, s70, s71
s_sub_u32 s69, s70, s71
s_add_u32 s69, s69, 196608
s_mov_b32 s67, 128
s_lshl_b32 s75, s58, 13
s_mov_b32 s65, 86016
s_lshr_b32 s70, s59, 3
s_lshl1_add_u32 s70, s59, s70
s_lshr_b32 s71, s60, 2
s_lshl2_add_u32 s71, s60, s71
s_add_u32 s70, s70, s71
s_and_b32 s64, s70, 15
s_mul_i32 s70, s64, s67
s_add_u32 m0, s65, s75
s_add_u32 s71, s70, s68
buffer_load_dwordx4 v8, s[8:11], s71 offen offset:0 lds
buffer_load_dwordx4 v9, s[8:11], s71 offen offset:1024 lds
buffer_load_dwordx4 v10, s[8:11], s71 offen offset:2048 lds
buffer_load_dwordx4 v11, s[8:11], s71 offen offset:3072 lds
s_add_u32 m0, m0, 4096
s_add_u32 s71, s70, s69
buffer_load_dwordx4 v8, s[8:11], s71 offen offset:0 lds
buffer_load_dwordx4 v9, s[8:11], s71 offen offset:1024 lds
buffer_load_dwordx4 v10, s[8:11], s71 offen offset:2048 lds
buffer_load_dwordx4 v11, s[8:11], s71 offen offset:3072 lds
v_and_b32 v7, 2, v6
v_xor_b32 v7, v7, v22
v_mul_u32_u24 v6, 6144, v6
v_lshl_add_u32 v12, v7, 4, v6
v_xor_b32 v6, 64, v12
v_add_u32 v13, 48128, v6
v_add_u32 v14, 96256, v12
v_add_u32 v15, 144384, v6
s_mul_i32 s76, s58, 12288
s_add_u32 s76, s76, 16384
s_lshl_b32 s70, s60, 7
s_cmp_eq_u32 s58, 0
s_mov_b32 s71, 198656
s_cselect_b32 s72, 0, s71
s_mov_b32 s71, 4096
s_cselect_b32 s73, 196608, s71
s_mov_b32 s71, 200704
s_cselect_b32 s74, 2048, s71
s_add_u32 s72, s72, s70
s_add_u32 s73, s73, s70
s_add_u32 s74, s74, s70
s_mul_i32 s70, s64, 393216
s_add_u32 m0, s65, s76
s_add_u32 s71, s70, s72
buffer_load_dwordx4 v12, s[12:15], s71 offen offset:0 lds
buffer_load_dwordx4 v13, s[12:15], s71 offen offset:1024 lds
buffer_load_dwordx4 v14, s[12:15], s71 offen offset:2048 lds
buffer_load_dwordx4 v15, s[12:15], s71 offen offset:3072 lds
s_add_u32 m0, m0, 4096
s_add_u32 s71, s70, s73
buffer_load_dwordx4 v12, s[12:15], s71 offen offset:0 lds
buffer_load_dwordx4 v13, s[12:15], s71 offen offset:1024 lds
buffer_load_dwordx4 v14, s[12:15], s71 offen offset:2048 lds
buffer_load_dwordx4 v15, s[12:15], s71 offen offset:3072 lds
s_add_u32 m0, m0, 4096
s_add_u32 s71, s70, s74
buffer_load_dwordx4 v12, s[12:15], s71 offen offset:0 lds
buffer_load_dwordx4 v13, s[12:15], s71 offen offset:1024 lds
buffer_load_dwordx4 v14, s[12:15], s71 offen offset:2048 lds
buffer_load_dwordx4 v15, s[12:15], s71 offen offset:3072 lds
s_add_u32 s64, s64, 1
s_and_b32 s64, s64, 15
s_sub_u32 s65, s65, 40960
s_cselect_b32 s65, 86016, s65
v_and_b32 v1, 3, v0
v_lshlrev_b32 v1, 2, v1
v_and_b32 v2, 4, v1
s_lshl2_add_u32 s35, s58, 16
v_mov_b32 v3, s35
v_lshlrev_b32 v20, 4, v0
v_lshrrev_b32 v6, 2, v0
v_lshl_add_u32 v21, v6, 7, v1
v_lshrrev_b32 v6, 3, v0
v_lshlrev_b32 v23, 1, v23
v_xor_b32 v23, v23, v22
v_lshlrev_b32 v23, 4, v23
v_lshl_add_u32 v23, v6, 11, v23
s_lshl_b32 s70, s62, 7
s_lshl_b32 s71, s58, 16
s_add_u32 s70, s70, s71
v_add_u32 v16, s70, v23
v_add_u32 v17, 15360, v16
v_add_u32 v18, 30720, v16
v_add_u32 v19, 46080, v16
s_add_u32 s77, s61, s62
s_lshl_b32 s77, s77, 17
s_lshl_b32 s78, s58, 12
s_mov_b32 s66, -2
s_barrier
.p2align 4
lq_1:
s_add_u32 s35, s66, 1
lw_4:
ds_read_b32 v5, v1 offset:0
s_waitcnt lgkmcnt(0)
v_cmp_gt_i32 vcc, s35, v5
s_cbranch_vccz lwd_5
s_sub_u32 s32, s32, 1
s_cmp_gt_i32 s32, 0
s_cbranch_scc1 lw_4
lwd_5:
s_cmp_eq_u32 s66, 0
s_cbranch_scc1 lcs_2
lcb_3:
s_mul_i32 s70, s64, s67
s_add_u32 m0, s65, s75
s_add_u32 s71, s70, s68
buffer_load_dwordx4 v8, s[8:11], s71 offen offset:0 sc1 lds
buffer_load_dwordx4 v9, s[8:11], s71 offen offset:1024 sc1 lds
buffer_load_dwordx4 v10, s[8:11], s71 offen offset:2048 sc1 lds
buffer_load_dwordx4 v11, s[8:11], s71 offen offset:3072 sc1 lds
s_add_u32 m0, m0, 4096
s_add_u32 s71, s70, s69
buffer_load_dwordx4 v8, s[8:11], s71 offen offset:0 sc1 lds
buffer_load_dwordx4 v9, s[8:11], s71 offen offset:1024 sc1 lds
buffer_load_dwordx4 v10, s[8:11], s71 offen offset:2048 sc1 lds
buffer_load_dwordx4 v11, s[8:11], s71 offen offset:3072 sc1 lds
s_mul_i32 s70, s64, 393216
s_add_u32 m0, s65, s76
s_add_u32 s71, s70, s72
buffer_load_dwordx4 v12, s[12:15], s71 offen offset:0 lds
buffer_load_dwordx4 v13, s[12:15], s71 offen offset:1024 lds
buffer_load_dwordx4 v14, s[12:15], s71 offen offset:2048 lds
buffer_load_dwordx4 v15, s[12:15], s71 offen offset:3072 lds
v_add_u32 v5, s66, 3
s_mov_b64 exec, 1
s_waitcnt vmcnt(12)
ds_write_b32 v3, v5
s_mov_b64 exec, -1
s_mul_i32 s70, s64, 393216
s_add_u32 m0, m0, 4096
s_add_u32 s71, s70, s73
buffer_load_dwordx4 v12, s[12:15], s71 offen offset:0 lds
buffer_load_dwordx4 v13, s[12:15], s71 offen offset:1024 lds
buffer_load_dwordx4 v14, s[12:15], s71 offen offset:2048 lds
buffer_load_dwordx4 v15, s[12:15], s71 offen offset:3072 lds
s_mul_i32 s70, s64, 393216
s_add_u32 m0, m0, 4096
s_add_u32 s71, s70, s74
buffer_load_dwordx4 v12, s[12:15], s71 offen offset:0 lds
buffer_load_dwordx4 v13, s[12:15], s71 offen offset:1024 lds
buffer_load_dwordx4 v14, s[12:15], s71 offen offset:2048 lds
buffer_load_dwordx4 v15, s[12:15], s71 offen offset:3072 lds
s_add_u32 s64, s64, 1
s_and_b32 s64, s64, 15
s_sub_u32 s65, s65, 40960
s_cselect_b32 s65, 86016, s65
s_add_u32 s66, s66, 1
s_and_b32 s70, s66, 31
s_cmp_eq_u32 s70, 13
s_cbranch_scc0 lq_1
s_waitcnt vmcnt(0)
v_add_u32 v5, s34, 16
s_mov_b64 exec, 1
ds_write_b32 v3, v5
s_mov_b64 exec, -1
s_add_u32 s35, s34, 14
lw_6:
ds_read_b32 v5, v1 offset:0
s_waitcnt lgkmcnt(0)
v_cmp_gt_i32 vcc, s35, v5
s_cbranch_vccz lwd_7
s_sleep 1
s_sub_u32 s32, s32, 1
s_cmp_gt_i32 s32, 0
s_cbranch_scc1 lw_6
lwd_7:
s_add_u32 s70, s77, 262144
s_add_u32 m0, s78, 49152
s_and_b32 s70, s70, 0x1fffff
buffer_load_dwordx4 v16, s[16:19], s70 offen offset:0 lds
buffer_load_dwordx4 v17, s[16:19], s70 offen offset:1024 lds
buffer_load_dwordx4 v18, s[16:19], s70 offen offset:2048 lds
buffer_load_dwordx4 v19, s[16:19], s70 offen offset:3072 lds
s_add_u32 s70, s77, 393216
s_add_u32 m0, s78, 57344
s_and_b32 s70, s70, 0x1fffff
buffer_load_dwordx4 v16, s[16:19], s70 offen offset:0 lds
buffer_load_dwordx4 v17, s[16:19], s70 offen offset:1024 lds
buffer_load_dwordx4 v18, s[16:19], s70 offen offset:2048 lds
buffer_load_dwordx4 v19, s[16:19], s70 offen offset:3072 lds
s_add_u32 s70, s77, 524288
s_add_u32 m0, s78, 65536
s_and_b32 s70, s70, 0x1fffff
buffer_load_dwordx4 v16, s[16:19], s70 offen offset:0 lds
buffer_load_dwordx4 v17, s[16:19], s70 offen offset:1024 lds
buffer_load_dwordx4 v18, s[16:19], s70 offen offset:2048 lds
buffer_load_dwordx4 v19, s[16:19], s70 offen offset:3072 lds
s_add_u32 s70, s77, 655360
s_add_u32 m0, s78, 73728
s_and_b32 s70, s70, 0x1fffff
buffer_load_dwordx4 v16, s[16:19], s70 offen offset:0 lds
buffer_load_dwordx4 v17, s[16:19], s70 offen offset:1024 lds
buffer_load_dwordx4 v18, s[16:19], s70 offen offset:2048 lds
buffer_load_dwordx4 v19, s[16:19], s70 offen offset:3072 lds
s_sub_u32 s70, s59, s58
s_lshl4_add_u32 s70, s70, s60
s_sub_u32 s70, s70, 16
s_lshl_b32 s66, s70, 7
s_add_u32 s66, s66, 360448
s_lshl_b32 s70, s70, 15
s_lshl_b32 s71, s63, 23
s_add_u32 s70, s70, s71
s_add_u32 s64, s70, 1077248
s_mul_i32 s65, s58, -94208
s_add_u32 s35, s34, 16
lw_8:
ds_read_b32 v5, v1 offset:0
s_waitcnt lgkmcnt(0)
v_cmp_gt_i32 vcc, s35, v5
s_cbranch_vccz lwd_9
s_sleep 1
s_sub_u32 s32, s32, 1
s_cmp_gt_i32 s32, 0
s_cbranch_scc1 lw_8
lwd_9:
s_add_u32 s70, s77, 131072
s_add_u32 m0, s78, 40960
s_and_b32 s70, s70, 0x1fffff
buffer_load_dwordx4 v16, s[16:19], s70 offen offset:0 lds
buffer_load_dwordx4 v17, s[16:19], s70 offen offset:1024 lds
buffer_load_dwordx4 v18, s[16:19], s70 offen offset:2048 lds
buffer_load_dwordx4 v19, s[16:19], s70 offen offset:3072 lds
s_add_u32 s70, s77, 786432
s_add_u32 m0, s78, 81920
s_and_b32 s70, s70, 0x1fffff
buffer_load_dwordx4 v16, s[16:19], s70 offen offset:0 lds
buffer_load_dwordx4 v17, s[16:19], s70 offen offset:1024 lds
buffer_load_dwordx4 v18, s[16:19], s70 offen offset:2048 lds
buffer_load_dwordx4 v19, s[16:19], s70 offen offset:3072 lds
s_add_u32 s70, s77, 917504
s_add_u32 m0, s78, 90112
s_and_b32 s70, s70, 0x1fffff
buffer_load_dwordx4 v16, s[16:19], s70 offen offset:0 lds
buffer_load_dwordx4 v17, s[16:19], s70 offen offset:1024 lds
buffer_load_dwordx4 v18, s[16:19], s70 offen offset:2048 lds
buffer_load_dwordx4 v19, s[16:19], s70 offen offset:3072 lds
s_add_u32 s35, s34, 17
lw_11:
ds_read_b32 v5, v1 offset:0
s_waitcnt lgkmcnt(0)
v_cmp_gt_i32 vcc, s35, v5
s_cbranch_vccz lwd_12
s_sleep 1
s_sub_u32 s32, s32, 1
s_cmp_gt_i32 s32, 0
s_cbranch_scc1 lw_11
lwd_12:
s_cmp_gt_u32 s59, s58
s_cbranch_scc0 nokv_10
poll_13:
buffer_load_dword v6, v1, s[24:27], s66 offen sc1
pchk_14:
s_waitcnt vmcnt(0)
v_cmp_eq_u32 vcc, 0, v6
s_cbranch_vccz pdone_15
s_sub_u32 s32, s32, 1
s_cmp_gt_i32 s32, 0
s_cbranch_scc1 poll_13
pdone_15:
s_add_u32 m0, s65, 126976
s_nop 0
buffer_load_dwordx4 v20, s[20:23], s64 offen offset:0 sc1 lds
buffer_load_dwordx4 v20, s[20:23], s64 offen offset:1024 sc1 lds
buffer_load_dwordx4 v20, s[20:23], s64 offen offset:2048 sc1 lds
buffer_load_dwordx4 v20, s[20:23], s64 offen offset:3072 sc1 lds
s_add_u32 m0, s65, 122880
s_sub_u32 s64, s64, 4096
buffer_load_dwordx4 v20, s[20:23], s64 offen offset:0 sc1 lds
buffer_load_dwordx4 v20, s[20:23], s64 offen offset:1024 sc1 lds
buffer_load_dwordx4 v20, s[20:23], s64 offen offset:2048 sc1 lds
buffer_load_dwordx4 v20, s[20:23], s64 offen offset:3072 sc1 lds
s_add_u32 m0, s65, 118784
s_sub_u32 s64, s64, 4096
buffer_load_dwordx4 v20, s[20:23], s64 offen offset:0 sc1 lds
buffer_load_dwordx4 v20, s[20:23], s64 offen offset:1024 sc1 lds
buffer_load_dwordx4 v20, s[20:23], s64 offen offset:2048 sc1 lds
buffer_load_dwordx4 v20, s[20:23], s64 offen offset:3072 sc1 lds
s_add_u32 m0, s65, 114688
s_sub_u32 s64, s64, 4096
buffer_load_dwordx4 v20, s[20:23], s64 offen offset:0 sc1 lds
buffer_load_dwordx4 v20, s[20:23], s64 offen offset:1024 sc1 lds
buffer_load_dwordx4 v20, s[20:23], s64 offen offset:2048 sc1 lds
buffer_load_dwordx4 v20, s[20:23], s64 offen offset:3072 sc1 lds
s_add_u32 m0, s65, 110592
s_sub_u32 s64, s64, 4096
buffer_load_dwordx4 v20, s[20:23], s64 offen offset:0 sc1 lds
buffer_load_dwordx4 v20, s[20:23], s64 offen offset:1024 sc1 lds
buffer_load_dwordx4 v20, s[20:23], s64 offen offset:2048 sc1 lds
buffer_load_dwordx4 v20, s[20:23], s64 offen offset:3072 sc1 lds
s_add_u32 m0, s65, 106496
s_sub_u32 s64, s64, 4096
buffer_load_dwordx4 v20, s[20:23], s64 offen offset:0 sc1 lds
buffer_load_dwordx4 v20, s[20:23], s64 offen offset:1024 sc1 lds
buffer_load_dwordx4 v20, s[20:23], s64 offen offset:2048 sc1 lds
buffer_load_dwordx4 v20, s[20:23], s64 offen offset:3072 sc1 lds
s_add_u32 m0, s65, 102400
s_sub_u32 s64, s64, 4096
buffer_load_dwordx4 v20, s[20:23], s64 offen offset:0 sc1 lds
buffer_load_dwordx4 v20, s[20:23], s64 offen offset:1024 sc1 lds
buffer_load_dwordx4 v20, s[20:23], s64 offen offset:2048 sc1 lds
buffer_load_dwordx4 v20, s[20:23], s64 offen offset:3072 sc1 lds
s_add_u32 m0, s65, 98304
s_sub_u32 s64, s64, 4096
buffer_load_dwordx4 v20, s[20:23], s64 offen offset:0 sc1 lds
buffer_load_dwordx4 v20, s[20:23], s64 offen offset:1024 sc1 lds
buffer_load_dwordx4 v20, s[20:23], s64 offen offset:2048 sc1 lds
buffer_load_dwordx4 v20, s[20:23], s64 offen offset:3072 sc1 lds
nokv_10:
s_waitcnt vmcnt(0)
v_add_u32 v5, s34, 17
s_mov_b64 exec, 1
ds_write_b32 v3, v5
s_mov_b64 exec, -1
s_add_u32 s35, s34, 18
lw_16:
ds_read_b32 v5, v1 offset:0
s_waitcnt lgkmcnt(0)
v_cmp_gt_i32 vcc, s35, v5
s_cbranch_vccz lwd_17
s_sleep 1
s_sub_u32 s32, s32, 1
s_cmp_gt_i32 s32, 0
s_cbranch_scc1 lw_16
lwd_17:
s_add_u32 s70, s77, 1572864
s_add_u32 m0, s78, 131072
s_and_b32 s70, s70, 0x1fffff
buffer_load_dwordx4 v16, s[16:19], s70 offen offset:0 lds
buffer_load_dwordx4 v17, s[16:19], s70 offen offset:1024 lds
buffer_load_dwordx4 v18, s[16:19], s70 offen offset:2048 lds
buffer_load_dwordx4 v19, s[16:19], s70 offen offset:3072 lds
s_add_u32 s70, s77, 1703936
s_add_u32 m0, s78, 139264
s_and_b32 s70, s70, 0x1fffff
buffer_load_dwordx4 v16, s[16:19], s70 offen offset:0 lds
buffer_load_dwordx4 v17, s[16:19], s70 offen offset:1024 lds
buffer_load_dwordx4 v18, s[16:19], s70 offen offset:2048 lds
buffer_load_dwordx4 v19, s[16:19], s70 offen offset:3072 lds
s_add_u32 s70, s77, 1835008
s_add_u32 m0, s78, 147456
s_and_b32 s70, s70, 0x1fffff
buffer_load_dwordx4 v16, s[16:19], s70 offen offset:0 lds
buffer_load_dwordx4 v17, s[16:19], s70 offen offset:1024 lds
buffer_load_dwordx4 v18, s[16:19], s70 offen offset:2048 lds
buffer_load_dwordx4 v19, s[16:19], s70 offen offset:3072 lds
s_add_u32 s70, s77, 1966080
s_add_u32 m0, s78, 155648
s_and_b32 s70, s70, 0x1fffff
buffer_load_dwordx4 v16, s[16:19], s70 offen offset:0 lds
buffer_load_dwordx4 v17, s[16:19], s70 offen offset:1024 lds
buffer_load_dwordx4 v18, s[16:19], s70 offen offset:2048 lds
buffer_load_dwordx4 v19, s[16:19], s70 offen offset:3072 lds
s_add_u32 s35, s34, 19
lw_18:
ds_read_b32 v5, v1 offset:0
s_waitcnt lgkmcnt(0)
v_cmp_gt_i32 vcc, s35, v5
s_cbranch_vccz lwd_19
s_sleep 2
s_sub_u32 s32, s32, 1
s_cmp_gt_i32 s32, 0
s_cbranch_scc1 lw_18
lwd_19:
s_add_u32 s70, s77, 1048576
s_add_u32 m0, s78, 98304
s_and_b32 s70, s70, 0x1fffff
buffer_load_dwordx4 v16, s[16:19], s70 offen offset:0 lds
buffer_load_dwordx4 v17, s[16:19], s70 offen offset:1024 lds
buffer_load_dwordx4 v18, s[16:19], s70 offen offset:2048 lds
buffer_load_dwordx4 v19, s[16:19], s70 offen offset:3072 lds
s_add_u32 s70, s77, 1179648
s_add_u32 m0, s78, 106496
s_and_b32 s70, s70, 0x1fffff
buffer_load_dwordx4 v16, s[16:19], s70 offen offset:0 lds
buffer_load_dwordx4 v17, s[16:19], s70 offen offset:1024 lds
buffer_load_dwordx4 v18, s[16:19], s70 offen offset:2048 lds
buffer_load_dwordx4 v19, s[16:19], s70 offen offset:3072 lds
s_add_u32 s70, s77, 1310720
s_add_u32 m0, s78, 114688
s_and_b32 s70, s70, 0x1fffff
buffer_load_dwordx4 v16, s[16:19], s70 offen offset:0 lds
buffer_load_dwordx4 v17, s[16:19], s70 offen offset:1024 lds
buffer_load_dwordx4 v18, s[16:19], s70 offen offset:2048 lds
buffer_load_dwordx4 v19, s[16:19], s70 offen offset:3072 lds
s_add_u32 s70, s77, 1441792
s_add_u32 m0, s78, 122880
s_and_b32 s70, s70, 0x1fffff
buffer_load_dwordx4 v16, s[16:19], s70 offen offset:0 lds
buffer_load_dwordx4 v17, s[16:19], s70 offen offset:1024 lds
buffer_load_dwordx4 v18, s[16:19], s70 offen offset:2048 lds
buffer_load_dwordx4 v19, s[16:19], s70 offen offset:3072 lds
s_add_u32 s35, s34, 20
lw_20:
ds_read_b32 v5, v1 offset:0
s_waitcnt lgkmcnt(0)
v_cmp_gt_i32 vcc, s35, v5
s_cbranch_vccz lwd_21
s_sleep 2
s_sub_u32 s32, s32, 1
s_cmp_gt_i32 s32, 0
s_cbranch_scc1 lw_20
lwd_21:
s_add_u32 s70, s77, 0
s_add_u32 m0, s78, 32768
s_and_b32 s70, s70, 0x1fffff
buffer_load_dwordx4 v16, s[16:19], s70 offen offset:0 lds
buffer_load_dwordx4 v17, s[16:19], s70 offen offset:1024 lds
buffer_load_dwordx4 v18, s[16:19], s70 offen offset:2048 lds
buffer_load_dwordx4 v19, s[16:19], s70 offen offset:3072 lds
s_lshl_b32 s66, s61, 11
s_add_u32 s66, s66, 327680
s_cmp_eq_u32 s58, 0
s_cbranch_scc0 nofo_22
s_add_u32 s35, s34, 21
lw_23:
ds_read_b32 v5, v1 offset:0
s_waitcnt lgkmcnt(0)
v_cmp_gt_i32 vcc, s35, v5
s_cbranch_vccz lwd_24
s_sleep 1
s_sub_u32 s32, s32, 1
s_cmp_gt_i32 s32, 0
s_cbranch_scc1 lw_23
lwd_24:
poll_25:
buffer_load_dword v6, v21, s[24:27], s66 offen sc1
pchk_26:
s_waitcnt vmcnt(0)
v_cmp_eq_u32 vcc, 0, v6
s_cbranch_vccz pdone_27
s_sub_u32 s32, s32, 1
s_cmp_gt_i32 s32, 0
s_cbranch_scc1 poll_25
pdone_27:
nofo_22:
s_waitcnt vmcnt(0)
v_add_u32 v5, s34, 18
s_mov_b64 exec, 1
ds_write_b32 v3, v5
s_mov_b64 exec, -1
s_cmp_eq_u32 s63, 0
s_cbranch_scc0 L_end
v_bfe_u32 v6, v0, 3, 2
v_and_b32 v7, 2, v6
v_xor_b32 v7, v7, v22
v_lshrrev_b32 v23, 5, v0
v_lshl_add_u32 v6, v23, 4, v6
v_mul_u32_u24 v6, 6144, v6
v_lshl_add_u32 v12, v7, 4, v6
v_xor_b32 v6, 64, v12
v_add_u32 v13, 23552, v6
v_add_u32 v14, 47104, v12
v_add_u32 v15, 70656, v6
v_mov_b32 v8, v20
v_mov_b32 v9, v20
v_mov_b32 v10, v20
v_mov_b32 v11, v20
s_mov_b32 s8, s56
s_mov_b32 s9, s57
s_mov_b32 s10, 0x2500000
s_mov_b32 s11, 0x00020000
s_lshl_b32 s70, s59, 18
s_add_u32 s70, s70, 26214400
s_add_u32 s68, s70, s78
s_sub_u32 s69, s70, s78
s_add_u32 s69, s69, 12288
s_mov_b32 s67, 16384
s_lshl_b32 s66, s59, 11
s_add_u32 s66, s66, 2883584
s_and_b32 s64, s61, 14
s_mov_b32 s65, 86016
s_add_u32 s35, s34, 22
lw_28:
ds_read_b32 v5, v1 offset:0
s_waitcnt lgkmcnt(0)
v_cmp_gt_i32 vcc, s35, v5
s_cbranch_vccz lwd_29
s_sleep 2
s_sub_u32 s32, s32, 1
s_cmp_gt_i32 s32, 0
s_cbranch_scc1 lw_28
lwd_29:
s_mul_i32 s70, s64, 393216
s_add_u32 m0, s65, s76
s_add_u32 s71, s70, s72
buffer_load_dwordx4 v12, s[12:15], s71 offen offset:0 lds
buffer_load_dwordx4 v13, s[12:15], s71 offen offset:1024 lds
buffer_load_dwordx4 v14, s[12:15], s71 offen offset:2048 lds
buffer_load_dwordx4 v15, s[12:15], s71 offen offset:3072 lds
s_add_u32 m0, m0, 4096
s_add_u32 s71, s70, s73
buffer_load_dwordx4 v12, s[12:15], s71 offen offset:0 lds
buffer_load_dwordx4 v13, s[12:15], s71 offen offset:1024 lds
buffer_load_dwordx4 v14, s[12:15], s71 offen offset:2048 lds
buffer_load_dwordx4 v15, s[12:15], s71 offen offset:3072 lds
s_add_u32 m0, m0, 4096
s_add_u32 s71, s70, s74
buffer_load_dwordx4 v12, s[12:15], s71 offen offset:0 lds
buffer_load_dwordx4 v13, s[12:15], s71 offen offset:1024 lds
buffer_load_dwordx4 v14, s[12:15], s71 offen offset:2048 lds
buffer_load_dwordx4 v15, s[12:15], s71 offen offset:3072 lds
s_add_u32 s64, s64, 1
s_and_b32 s64, s64, 15
s_sub_u32 s65, s65, 40960
s_cselect_b32 s65, 86016, s65
s_mul_i32 s70, s64, 393216
s_add_u32 m0, s65, s76
s_add_u32 s71, s70, s72
buffer_load_dwordx4 v12, s[12:15], s71 offen offset:0 lds
buffer_load_dwordx4 v13, s[12:15], s71 offen offset:1024 lds
buffer_load_dwordx4 v14, s[12:15], s71 offen offset:2048 lds
buffer_load_dwordx4 v15, s[12:15], s71 offen offset:3072 lds
s_add_u32 m0, m0, 4096
s_add_u32 s71, s70, s73
buffer_load_dwordx4 v12, s[12:15], s71 offen offset:0 lds
buffer_load_dwordx4 v13, s[12:15], s71 offen offset:1024 lds
buffer_load_dwordx4 v14, s[12:15], s71 offen offset:2048 lds
buffer_load_dwordx4 v15, s[12:15], s71 offen offset:3072 lds
s_add_u32 m0, m0, 4096
s_add_u32 s71, s70, s74
buffer_load_dwordx4 v12, s[12:15], s71 offen offset:0 lds
buffer_load_dwordx4 v13, s[12:15], s71 offen offset:1024 lds
buffer_load_dwordx4 v14, s[12:15], s71 offen offset:2048 lds
buffer_load_dwordx4 v15, s[12:15], s71 offen offset:3072 lds
s_add_u32 s64, s64, 1
s_and_b32 s64, s64, 15
s_sub_u32 s65, s65, 40960
s_cselect_b32 s65, 86016, s65
s_mul_i32 s70, s64, 393216
s_add_u32 m0, s65, s76
s_add_u32 s71, s70, s72
buffer_load_dwordx4 v12, s[12:15], s71 offen offset:0 lds
buffer_load_dwordx4 v13, s[12:15], s71 offen offset:1024 lds
buffer_load_dwordx4 v14, s[12:15], s71 offen offset:2048 lds
buffer_load_dwordx4 v15, s[12:15], s71 offen offset:3072 lds
s_add_u32 m0, m0, 4096
s_add_u32 s71, s70, s73
buffer_load_dwordx4 v12, s[12:15], s71 offen offset:0 lds
buffer_load_dwordx4 v13, s[12:15], s71 offen offset:1024 lds
buffer_load_dwordx4 v14, s[12:15], s71 offen offset:2048 lds
buffer_load_dwordx4 v15, s[12:15], s71 offen offset:3072 lds
s_add_u32 m0, m0, 4096
s_add_u32 s71, s70, s74
buffer_load_dwordx4 v12, s[12:15], s71 offen offset:0 lds
buffer_load_dwordx4 v13, s[12:15], s71 offen offset:1024 lds
buffer_load_dwordx4 v14, s[12:15], s71 offen offset:2048 lds
buffer_load_dwordx4 v15, s[12:15], s71 offen offset:3072 lds
s_add_u32 s64, s64, 1
s_and_b32 s64, s64, 15
s_sub_u32 s65, s65, 40960
s_cselect_b32 s65, 86016, s65
s_mov_b32 s64, s59
s_mov_b32 s65, 114688
s_mul_i32 s70, s64, 393216
s_add_u32 m0, s65, s76
s_add_u32 s71, s70, s72
buffer_load_dwordx4 v12, s[12:15], s71 offen offset:0 lds
buffer_load_dwordx4 v13, s[12:15], s71 offen offset:1024 lds
buffer_load_dwordx4 v14, s[12:15], s71 offen offset:2048 lds
buffer_load_dwordx4 v15, s[12:15], s71 offen offset:3072 lds
s_add_u32 m0, m0, 4096
s_add_u32 s71, s70, s73
buffer_load_dwordx4 v12, s[12:15], s71 offen offset:0 lds
buffer_load_dwordx4 v13, s[12:15], s71 offen offset:1024 lds
buffer_load_dwordx4 v14, s[12:15], s71 offen offset:2048 lds
buffer_load_dwordx4 v15, s[12:15], s71 offen offset:3072 lds
s_add_u32 m0, m0, 4096
s_add_u32 s71, s70, s74
buffer_load_dwordx4 v12, s[12:15], s71 offen offset:0 lds
buffer_load_dwordx4 v13, s[12:15], s71 offen offset:1024 lds
buffer_load_dwordx4 v14, s[12:15], s71 offen offset:2048 lds
buffer_load_dwordx4 v15, s[12:15], s71 offen offset:3072 lds
s_and_b32 s64, s61, 14
s_mov_b32 s65, 86016
s_add_u32 s35, s34, 23
lw_30:
ds_read_b32 v5, v1 offset:0
s_waitcnt lgkmcnt(0)
v_cmp_gt_i32 vcc, s35, v5
s_cbranch_vccz lwd_31
s_sleep 1
s_sub_u32 s32, s32, 1
s_cmp_gt_i32 s32, 0
s_cbranch_scc1 lw_30
lwd_31:
poll_32:
buffer_load_dword v6, v21, s[24:27], s66 offen sc1
pchk_33:
s_waitcnt vmcnt(0)
v_cmp_eq_u32 vcc, 0, v6
s_cbranch_vccz pdone_34
s_sub_u32 s32, s32, 1
s_cmp_gt_i32 s32, 0
s_cbranch_scc1 poll_32
pdone_34:
s_mul_i32 s70, s64, s67
s_add_u32 m0, s65, s75
s_add_u32 s71, s70, s68
buffer_load_dwordx4 v8, s[8:11], s71 offen offset:0 sc1 lds
buffer_load_dwordx4 v9, s[8:11], s71 offen offset:1024 sc1 lds
buffer_load_dwordx4 v10, s[8:11], s71 offen offset:2048 sc1 lds
buffer_load_dwordx4 v11, s[8:11], s71 offen offset:3072 sc1 lds
s_add_u32 m0, m0, 4096
s_add_u32 s71, s70, s69
buffer_load_dwordx4 v8, s[8:11], s71 offen offset:0 sc1 lds
buffer_load_dwordx4 v9, s[8:11], s71 offen offset:1024 sc1 lds
buffer_load_dwordx4 v10, s[8:11], s71 offen offset:2048 sc1 lds
buffer_load_dwordx4 v11, s[8:11], s71 offen offset:3072 sc1 lds
s_add_u32 s64, s64, 1
s_and_b32 s64, s64, 15
s_sub_u32 s65, s65, 40960
s_cselect_b32 s65, 86016, s65
s_mul_i32 s70, s64, s67
s_add_u32 m0, s65, s75
s_add_u32 s71, s70, s68
buffer_load_dwordx4 v8, s[8:11], s71 offen offset:0 sc1 lds
buffer_load_dwordx4 v9, s[8:11], s71 offen offset:1024 sc1 lds
buffer_load_dwordx4 v10, s[8:11], s71 offen offset:2048 sc1 lds
buffer_load_dwordx4 v11, s[8:11], s71 offen offset:3072 sc1 lds
s_add_u32 m0, m0, 4096
s_add_u32 s71, s70, s69
buffer_load_dwordx4 v8, s[8:11], s71 offen offset:0 sc1 lds
buffer_load_dwordx4 v9, s[8:11], s71 offen offset:1024 sc1 lds
buffer_load_dwordx4 v10, s[8:11], s71 offen offset:2048 sc1 lds
buffer_load_dwordx4 v11, s[8:11], s71 offen offset:3072 sc1 lds
s_add_u32 s64, s64, 1
s_and_b32 s64, s64, 15
s_sub_u32 s65, s65, 40960
s_cselect_b32 s65, 86016, s65
s_mul_i32 s70, s64, s67
s_add_u32 m0, s65, s75
s_add_u32 s71, s70, s68
buffer_load_dwordx4 v8, s[8:11], s71 offen offset:0 sc1 lds
buffer_load_dwordx4 v9, s[8:11], s71 offen offset:1024 sc1 lds
buffer_load_dwordx4 v10, s[8:11], s71 offen offset:2048 sc1 lds
buffer_load_dwordx4 v11, s[8:11], s71 offen offset:3072 sc1 lds
s_add_u32 m0, m0, 4096
s_add_u32 s71, s70, s69
buffer_load_dwordx4 v8, s[8:11], s71 offen offset:0 sc1 lds
buffer_load_dwordx4 v9, s[8:11], s71 offen offset:1024 sc1 lds
buffer_load_dwordx4 v10, s[8:11], s71 offen offset:2048 sc1 lds
buffer_load_dwordx4 v11, s[8:11], s71 offen offset:3072 sc1 lds
s_add_u32 s64, s64, 1
s_and_b32 s64, s64, 15
s_sub_u32 s65, s65, 40960
s_cselect_b32 s65, 86016, s65
s_mov_b32 s63, 1
s_mov_b32 s34, 32
s_add_u32 s24, s24, 2949120
s_addc_u32 s25, s25, 0
s_mov_b32 s26, 2949120
s_waitcnt vmcnt(16)
v_add_u32 v5, s34, 1
s_mov_b64 exec, 1
ds_write_b32 v3, v5
s_mov_b64 exec, -1
s_waitcnt vmcnt(8)
v_add_u32 v5, s34, 2
s_mov_b64 exec, 1
ds_write_b32 v3, v5
s_mov_b64 exec, -1
s_mov_b32 s66, 32
s_branch lq_1
lcs_2:
s_add_u32 s35, s34, 1
lw_35:
ds_read_b32 v5, v2 offset:24
s_waitcnt lgkmcnt(0)
v_cmp_gt_i32 vcc, s35, v5
s_cbranch_vccz lwd_36
s_sub_u32 s32, s32, 1
s_cmp_gt_i32 s32, 0
s_cbranch_scc1 lw_35
lwd_36:
s_branch lcb_3
L_f:
s_cmp_eq_u32 s58, 0
s_cbranch_scc0 fz_37
v_lshlrev_b32 v14, 4, v0
v_mov_b32 v56, 0
v_mov_b32 v57, 0
v_mov_b32 v58, 0
v_mov_b32 v59, 0
s_mul_i32 s70, s2, 1280
buffer_store_dwordx4 v[56:59], v14, s[24:27], s70 offen offset:0 sc1
buffer_store_dwordx4 v[56:59], v14, s[24:27], s70 offen offset:256 sc1
fz_37:
v_and_b32 v1, 3, v0
v_lshlrev_b32 v1, 2, v1
v_and_b32 v2, 4, v1
s_lshl2_add_u32 s35, s58, 24
v_mov_b32 v3, s35
s_mov_b32 s4, s54
s_mov_b32 s5, s55
s_mov_b32 s6, 0x100
s_mov_b32 s7, 0x00020000
s_and_b32 s70, s2, 7
s_lshr_b32 s71, s2, 3
s_mul_i32 s64, s70, 28
s_add_u32 s64, s64, s71
s_lshl_b32 s65, s70, 5
s_add_u32 s65, s65, s71
s_mov_b32 s69, 0x3f803f80
s_barrier
s_cmp_eq_u32 s58, 0
s_cselect_b32 s16, s46, s48
s_cselect_b32 s17, s47, s49
s_mov_b32 s12, s50
s_mov_b32 s13, s51
s_mov_b32 s14, 0x0
s_mov_b32 s15, 0x00020000
s_cmp_lt_u32 s2, 224
s_cselect_b32 s18, 7340032, 0
s_mov_b32 s14, s18
s_mov_b32 s70, s64
s_lshr_b32 s71, s70, 1
s_lshl_b32 s66, s71, 16
s_and_b32 s71, s70, 1
s_lshl3_add_u32 s71, s71, s58
s_lshl_b32 s71, s71, 10
s_add_u32 s66, s66, s71
s_and_b32 s71, s70, 31
s_mul_i32 s71, s71, 229376
s_lshr_b32 s70, s70, 5
s_lshl_b32 s70, s70, 10
s_add_u32 s77, s71, s70
v_lshlrev_b32 v4, 4, v0
s_and_b32 s73, s2, 3
s_lshl_b32 s73, s73, 6
v_mov_b32 v14, 1
s_sub_u32 exec_lo, 1, s58
s_mov_b32 exec_hi, 0
s_waitcnt vmcnt(0)
buffer_atomic_add v14, off, s[4:7], s73 sc1
s_mov_b64 exec, -1
v_mov_b32 v8, s69
v_mov_b32 v9, s69
v_mov_b32 v10, s69
v_mov_b32 v11, s69
v_mov_b32 v12, s69
v_mov_b32 v13, s69
v_mov_b32 v14, s69
v_mov_b32 v15, s69
s_mov_b32 s70, 102400
ftop_38:
v_lshrrev_b32 v6, 4, v0
v_bfe_u32 v7, v0, 2, 2
v_lshl_add_u32 v6, v6, 3, v7
v_bfe_u32 v7, v0, 3, 2
s_lshl_b32 s71, s58, 1
v_xor_b32 v7, s71, v7
v_lshl_add_u32 v7, v7, 5, s70
v_lshl_add_u32 v6, v6, 7, v7
v_lshl_add_u32 v6, v1, 1, v6
v_xor_b32 v7, 32, v6
v_mov_b32 v16, 0
v_mov_b32 v17, 0
v_mov_b32 v18, 0
v_mov_b32 v19, 0
v_mov_b32 v20, 0
v_mov_b32 v21, 0
v_mov_b32 v22, 0
v_mov_b32 v23, 0
s_add_u32 s35, s34, 1
lw_39:
ds_read_b32 v5, v2 offset:16
s_waitcnt lgkmcnt(0)
v_cmp_gt_i32 vcc, s35, v5
s_cbranch_vccz lwd_40
s_sleep 1
s_sub_u32 s32, s32, 1
s_cmp_gt_i32 s32, 0
s_cbranch_scc1 lw_39
lwd_40:
ds_read_b64_tr_b16 v[24:25], v6 offset:0
ds_read_b64_tr_b16 v[26:27], v6 offset:512
ds_read_b64_tr_b16 v[28:29], v6 offset:4096
ds_read_b64_tr_b16 v[30:31], v6 offset:4608
ds_read_b64_tr_b16 v[32:33], v7 offset:0
ds_read_b64_tr_b16 v[34:35], v7 offset:512
ds_read_b64_tr_b16 v[36:37], v7 offset:4096
ds_read_b64_tr_b16 v[38:39], v7 offset:4608
ds_read_b64_tr_b16 v[40:41], v6 offset:8192
ds_read_b64_tr_b16 v[42:43], v6 offset:8704
ds_read_b64_tr_b16 v[44:45], v6 offset:12288
ds_read_b64_tr_b16 v[46:47], v6 offset:12800
ds_read_b64_tr_b16 v[48:49], v7 offset:8192
ds_read_b64_tr_b16 v[50:51], v7 offset:8704
ds_read_b64_tr_b16 v[52:53], v7 offset:12288
ds_read_b64_tr_b16 v[54:55], v7 offset:12800
v_dot2c_f32_bf16 v22, s69, v8
v_dot2c_f32_bf16 v23, v8, v8
v_dot2c_f32_bf16 v22, s69, v9
v_dot2c_f32_bf16 v23, v9, v9
v_dot2c_f32_bf16 v22, s69, v10
v_dot2c_f32_bf16 v23, v10, v10
v_dot2c_f32_bf16 v22, s69, v11
v_dot2c_f32_bf16 v23, v11, v11
v_dot2c_f32_bf16 v22, s69, v12
v_dot2c_f32_bf16 v23, v12, v12
v_dot2c_f32_bf16 v22, s69, v13
v_dot2c_f32_bf16 v23, v13, v13
v_dot2c_f32_bf16 v22, s69, v14
v_dot2c_f32_bf16 v23, v14, v14
v_dot2c_f32_bf16 v22, s69, v15
v_dot2c_f32_bf16 v23, v15, v15
s_waitcnt lgkmcnt(14)
v_dot2c_f32_bf16 v16, v8, v24
s_waitcnt lgkmcnt(11)
v_dot2c_f32_bf16 v17, v8, v32
v_dot2c_f32_bf16 v16, v9, v25
v_dot2c_f32_bf16 v17, v9, v33
v_dot2c_f32_bf16 v16, v10, v26
s_waitcnt lgkmcnt(10)
v_dot2c_f32_bf16 v17, v10, v34
v_dot2c_f32_bf16 v16, v11, v27
v_dot2c_f32_bf16 v17, v11, v35
v_dot2c_f32_bf16 v16, v12, v28
s_waitcnt lgkmcnt(9)
v_dot2c_f32_bf16 v17, v12, v36
v_dot2c_f32_bf16 v16, v13, v29
v_dot2c_f32_bf16 v17, v13, v37
v_dot2c_f32_bf16 v16, v14, v30
s_waitcnt lgkmcnt(8)
v_dot2c_f32_bf16 v17, v14, v38
v_dot2c_f32_bf16 v16, v15, v31
v_dot2c_f32_bf16 v17, v15, v39
ds_read_b64_tr_b16 v[24:25], v6 offset:16384
ds_read_b64_tr_b16 v[26:27], v6 offset:16896
ds_read_b64_tr_b16 v[28:29], v6 offset:20480
ds_read_b64_tr_b16 v[30:31], v6 offset:20992
ds_read_b64_tr_b16 v[32:33], v7 offset:16384
ds_read_b64_tr_b16 v[34:35], v7 offset:16896
ds_read_b64_tr_b16 v[36:37], v7 offset:20480
ds_read_b64_tr_b16 v[38:39], v7 offset:20992
v_add_u32 v5, s34, 1
s_mov_b64 exec, 1
ds_write_b32 v3, v5
s_mov_b64 exec, -1
s_waitcnt lgkmcnt(14)
v_dot2c_f32_bf16 v18, v8, v40
s_waitcnt lgkmcnt(12)
v_dot2c_f32_bf16 v19, v8, v48
v_dot2c_f32_bf16 v18, v9, v41
v_dot2c_f32_bf16 v19, v9, v49
v_dot2c_f32_bf16 v18, v10, v42
s_waitcnt lgkmcnt(11)
v_dot2c_f32_bf16 v19, v10, v50
v_dot2c_f32_bf16 v18, v11, v43
v_dot2c_f32_bf16 v19, v11, v51
v_dot2c_f32_bf16 v18, v12, v44
s_waitcnt lgkmcnt(10)
v_dot2c_f32_bf16 v19, v12, v52
v_dot2c_f32_bf16 v18, v13, v45
v_dot2c_f32_bf16 v19, v13, v53
v_dot2c_f32_bf16 v18, v14, v46
s_waitcnt lgkmcnt(9)
v_dot2c_f32_bf16 v19, v14, v54
v_dot2c_f32_bf16 v18, v15, v47
v_dot2c_f32_bf16 v19, v15, v55
s_waitcnt lgkmcnt(8)
v_dot2c_f32_bf16 v20, v8, v24
s_waitcnt lgkmcnt(4)
v_dot2c_f32_bf16 v21, v8, v32
v_dot2c_f32_bf16 v20, v9, v25
v_dot2c_f32_bf16 v21, v9, v33
v_dot2c_f32_bf16 v20, v10, v26
s_waitcnt lgkmcnt(3)
v_dot2c_f32_bf16 v21, v10, v34
v_dot2c_f32_bf16 v20, v11, v27
v_dot2c_f32_bf16 v21, v11, v35
v_dot2c_f32_bf16 v20, v12, v28
s_waitcnt lgkmcnt(2)
v_dot2c_f32_bf16 v21, v12, v36
v_dot2c_f32_bf16 v20, v13, v29
v_dot2c_f32_bf16 v21, v13, v37
v_dot2c_f32_bf16 v20, v14, v30
s_waitcnt lgkmcnt(1)
v_dot2c_f32_bf16 v21, v14, v38
v_dot2c_f32_bf16 v20, v15, v31
v_dot2c_f32_bf16 v21, v15, v39
s_lshl_b32 s72, s60, 14
s_lshl_b32 s70, s58, 9
s_add_u32 s72, s72, s70
s_lshl_b32 s70, s59, 10
s_add_u32 s71, s72, s70
v_lshlrev_b32 v6, 3, v0
v_permlane32_swap_b32 v16, v20
v_permlane32_swap_b32 v17, v21
v_permlane32_swap_b32 v18, v22
v_permlane32_swap_b32 v19, v23
v_pk_add_f32 v[16:17], v[16:17], v[20:21]
v_pk_add_f32 v[18:19], v[18:19], v[22:23]
s_nop 1
v_permlane16_swap_b32 v16, v18
v_permlane16_swap_b32 v17, v19
v_pk_add_f32 v[16:17], v[16:17], v[18:19]
s_lshl_b32 s76, s59, 11
s_add_u32 s76, s76, 262144
v_max_u32 v16, 1, v16
v_max_u32 v17, 1, v17
s_cmp_eq_u32 s63, 0
s_cbranch_scc1 fst_41
fsb_42:
buffer_store_dwordx2 v[16:17], v6, s[24:27], s71 offen sc1
s_add_u32 s73, s72, 4096
s_add_u32 s74, s72, 8192
s_add_u32 s75, s72, 12288
v_lshrrev_b32 v7, 2, v0
v_lshlrev_b32 v7, 7, v7
v_lshl_add_u32 v7, v1, 2, v7
v_lshrrev_b32 v8, 5, v0
v_lshrrev_b32 v9, 4, v0
v_xor_b32 v10, v8, v9
v_and_b32 v10, 1, v10
v_lshl_add_u32 v8, v10, 1, v8
v_and_b32 v10, 15, v0
v_lshlrev_b32 v8, 7, v8
v_lshl_add_u32 v8, v10, 3, v8
v_add_u32 v8, 1280, v8
s_mul_i32 s70, s58, 384
s_lshl_b32 s71, s63, 10
s_add_u32 s70, s70, s71
s_add_u32 s70, s70, 2304
v_lshl_add_u32 v9, v9, 7, s70
v_lshl_add_u32 v9, v10, 2, v9
s_cmp_eq_u32 s63, 0
s_cbranch_scc1 fg_43
fg_44:
poll_45:
buffer_load_dwordx4 v[12:15], v7, s[24:27], s76 offen sc1
pchk_46:
s_waitcnt vmcnt(0)
v_min3_u32 v10, v12, v13, v14
v_min_u32 v10, v10, v15
v_cmp_eq_u32 vcc, 0, v10
s_cbranch_vccz pdone_47
s_sub_u32 s32, s32, 1
s_cmp_gt_i32 s32, 0
s_cbranch_scc1 poll_45
pdone_47:
s_lshr_b32 s70, s33, 7
s_sub_u32 s70, s70, s59
s_mul_i32 s70, s70, s63
s_cmp_eq_u32 s70, 0
s_cbranch_scc0 fng_48
poll_49:
buffer_load_dwordx2 v[24:25], v6, s[24:27], s72 offen offset:0 sc1
buffer_load_dwordx2 v[26:27], v6, s[24:27], s72 offen offset:1024 sc1
buffer_load_dwordx2 v[28:29], v6, s[24:27], s72 offen offset:2048 sc1
buffer_load_dwordx2 v[30:31], v6, s[24:27], s72 offen offset:3072 sc1
buffer_load_dwordx2 v[32:33], v6, s[24:27], s73 offen offset:0 sc1
buffer_load_dwordx2 v[34:35], v6, s[24:27], s73 offen offset:1024 sc1
buffer_load_dwordx2 v[36:37], v6, s[24:27], s73 offen offset:2048 sc1
buffer_load_dwordx2 v[38:39], v6, s[24:27], s73 offen offset:3072 sc1
buffer_load_dwordx2 v[40:41], v6, s[24:27], s74 offen offset:0 sc1
buffer_load_dwordx2 v[42:43], v6, s[24:27], s74 offen offset:1024 sc1
buffer_load_dwordx2 v[44:45], v6, s[24:27], s74 offen offset:2048 sc1
buffer_load_dwordx2 v[46:47], v6, s[24:27], s74 offen offset:3072 sc1
buffer_load_dwordx2 v[48:49], v6, s[24:27], s75 offen offset:0 sc1
buffer_load_dwordx2 v[50:51], v6, s[24:27], s75 offen offset:1024 sc1
buffer_load_dwordx2 v[52:53], v6, s[24:27], s75 offen offset:2048 sc1
buffer_load_dwordx2 v[54:55], v6, s[24:27], s75 offen offset:3072 sc1
pchk_50:
s_waitcnt vmcnt(14)
v_min3_u32 v10, v24, v25, v26
s_waitcnt vmcnt(13)
v_min3_u32 v10, v10, v27, v28
s_waitcnt vmcnt(12)
v_min3_u32 v10, v10, v29, v30
s_waitcnt vmcnt(11)
v_min3_u32 v10, v10, v31, v32
s_waitcnt vmcnt(10)
v_min3_u32 v10, v10, v33, v34
s_waitcnt vmcnt(9)
v_min3_u32 v10, v10, v35, v36
s_waitcnt vmcnt(8)
v_min3_u32 v10, v10, v37, v38
s_waitcnt vmcnt(7)
v_min3_u32 v10, v10, v39, v40
s_waitcnt vmcnt(6)
v_min3_u32 v10, v10, v41, v42
s_waitcnt vmcnt(5)
v_min3_u32 v10, v10, v43, v44
s_waitcnt vmcnt(4)
v_min3_u32 v10, v10, v45, v46
s_waitcnt vmcnt(3)
v_min3_u32 v10, v10, v47, v48
s_waitcnt vmcnt(2)
v_min3_u32 v10, v10, v49, v50
s_waitcnt vmcnt(1)
v_min3_u32 v10, v10, v51, v52
s_waitcnt vmcnt(0)
v_min3_u32 v10, v10, v53, v54
v_min_u32 v10, v10, v55
v_cmp_eq_u32 vcc, 0, v10
s_cbranch_vccz pdone_51
s_sub_u32 s32, s32, 1
s_cmp_gt_i32 s32, 0
s_cbranch_scc1 poll_49
pdone_51:
v_pk_add_f32 v[24:25], v[24:25], v[40:41]
v_pk_add_f32 v[26:27], v[26:27], v[42:43]
v_pk_add_f32 v[28:29], v[28:29], v[44:45]
v_pk_add_f32 v[30:31], v[30:31], v[46:47]
v_pk_add_f32 v[32:33], v[32:33], v[48:49]
v_pk_add_f32 v[34:35], v[34:35], v[50:51]
v_pk_add_f32 v[36:37], v[36:37], v[52:53]
v_pk_add_f32 v[38:39], v[38:39], v[54:55]
v_pk_add_f32 v[24:25], v[24:25], v[32:33]
v_pk_add_f32 v[26:27], v[26:27], v[34:35]
v_pk_add_f32 v[28:29], v[28:29], v[36:37]
v_pk_add_f32 v[30:31], v[30:31], v[38:39]
v_pk_add_f32 v[24:25], v[24:25], v[28:29]
v_pk_add_f32 v[26:27], v[26:27], v[30:31]
v_pk_add_f32 v[24:25], v[24:25], v[26:27]
s_mov_b32 exec_hi, 0xffff
ds_write2_b32 v9, v24, v25 offset1:16
s_mov_b32 exec_hi, -1
v_mul_f32 v5, 0xba800000, v24
v_mul_f32 v25, 0x3a800000, v25
v_fma_f32 v25, -v5, v5, v25
v_max_f32 v25, 0, v25
v_add_f32 v25, 0x3727c5ac, v25
v_rsq_f32 v24, v25
s_nop 0
v_mul_f32 v25, v5, v24
s_lshl_b32 s70, s59, 7
s_sub_u32 s70, s33, s70
v_lshlrev_b32 v10, 1, v0
v_sub_u32 v10, s70, v10
v_readlane_b32 s70, v24, 48
v_readlane_b32 s71, v25, 48
v_cmp_eq_u32 vcc, 0, v10
s_mov_b64 exec, vcc
v_mov_b32 v12, s70
v_mov_b32 v13, s71
s_mov_b64 exec, -1
v_cmp_eq_u32 vcc, 1, v10
s_mov_b64 exec, vcc
v_mov_b32 v14, s70
v_mov_b32 v15, s71
s_mov_b64 exec, -1
fng_48:
ds_write2_b32 v8, v12, v14 offset1:1
ds_write2_b32 v8, v13, v15 offset0:128 offset1:129
v_add_u32 v5, s34, 2
s_mov_b64 exec, 1
ds_write_b32 v3, v5
s_mov_b64 exec, -1
s_setprio 0
s_lshl_b32 s70, s63, 8
s_add_u32 s70, s70, s2
s_cmp_lt_u32 s70, 224
s_cbranch_scc1 fnw_52
fnw_53:
s_and_b32 s70, s64, 31
s_lshl_b32 s70, s70, 7
s_add_u32 s72, s70, 2752512
v_lshrrev_b32 v6, 2, v0
v_lshlrev_b32 v6, 12, v6
v_lshl_add_u32 v7, v1, 2, v6
v_mov_b32 v16, 0
v_mov_b32 v17, 0
v_mov_b32 v18, 0
v_mov_b32 v19, 0
v_mov_b32 v20, 0
v_mov_b32 v21, 0
v_mov_b32 v22, 0
v_mov_b32 v23, 0
s_add_u32 s35, s34, 22
lw_54:
ds_read_b32 v5, v1 offset:0
s_waitcnt lgkmcnt(0)
v_cmp_gt_i32 vcc, s35, v5
s_cbranch_vccz lwd_55
s_sleep 4
s_sub_u32 s32, s32, 1
s_cmp_gt_i32 s32, 0
s_cbranch_scc1 lw_54
lwd_55:
s_setprio 3
s_add_u32 s35, s34, 24
lw_56:
ds_read_b32 v5, v1 offset:0
s_waitcnt lgkmcnt(0)
v_cmp_gt_i32 vcc, s35, v5
s_cbranch_vccz lwd_57
s_sleep 2
s_sub_u32 s32, s32, 1
s_cmp_gt_i32 s32, 0
s_cbranch_scc1 lw_56
lwd_57:
poll_58:
buffer_load_dwordx4 v[24:27], v7, s[24:27], s72 offen sc1
buffer_load_dwordx2 v[28:29], v6, s[24:27], s72 offen offset:64 sc1
pchk_59:
s_waitcnt vmcnt(1)
v_min3_u32 v10, v24, v25, v26
s_waitcnt vmcnt(0)
v_min3_u32 v10, v10, v27, v28
v_min_u32 v10, v10, v29
v_cmp_eq_u32 vcc, 0, v10
s_cbranch_vccz pdone_60
s_sub_u32 s32, s32, 1
s_cmp_gt_i32 s32, 0
s_cbranch_scc1 poll_58
pdone_60:
v_mov_b32 v10, v28
s_nop 1
v_max_f32_dpp v10, v10, v10 row_ror:4 row_mask:0xf bank_mask:0xf
s_nop 1
v_max_f32_dpp v10, v10, v10 row_ror:8 row_mask:0xf bank_mask:0xf
v_mov_b32 v11, v10
s_nop 1
v_permlane16_swap_b32 v11, v10
v_max_f32 v10, v10, v11
v_mov_b32 v11, v10
s_nop 1
v_permlane32_swap_b32 v11, v10
v_max_f32 v10, v10, v11
v_cmp_eq_f32 vcc, v10, v28
s_ff1_i32_b64 s68, vcc
s_and_b32 s68, s68, 60
v_readlane_b32 s33, v29, s68
v_readlane_b32 s67, v28, s68
v_readlane_b32 s36, v24, s68
v_readlane_b32 s37, v25, s68
v_readlane_b32 s44, v26, s68
v_readlane_b32 s45, v27, s68
s_add_u32 s68, s68, 1
v_readlane_b32 s38, v24, s68
v_readlane_b32 s39, v25, s68
v_readlane_b32 s46, v26, s68
v_readlane_b32 s47, v27, s68
s_add_u32 s68, s68, 1
v_readlane_b32 s40, v24, s68
v_readlane_b32 s41, v25, s68
v_readlane_b32 s48, v26, s68
v_readlane_b32 s49, v27, s68
s_add_u32 s68, s68, 1
v_readlane_b32 s42, v24, s68
v_readlane_b32 s43, v25, s68
v_readlane_b32 s50, v26, s68
v_readlane_b32 s51, v27, s68
s_lshr_b32 s68, s68, 2
v_mov_b32 v11, s33
ds_write_b32 v16, v11 offset:32
v_add_u32 v5, s34, 3
s_mov_b64 exec, 1
ds_write_b32 v3, v5
s_mov_b64 exec, -1
s_sub_u32 s33, s33, 1
s_and_b32 s33, s33, 2047
s_cmp_lt_u32 s2, 224
s_cbranch_scc0 fnd_61
s_lshl1_add_u32 s70, s64, s58
s_lshl_b32 s70, s70, 11
s_add_u32 s71, s70, 1835008
s_add_u32 s70, s70, 917504
v_dot2c_f32_bf16 v16, s36, v56
v_dot2c_f32_bf16 v17, s36, v57
v_dot2c_f32_bf16 v18, s36, v58
v_dot2c_f32_bf16 v19, s36, v59
v_dot2c_f32_bf16 v20, s36, v60
v_dot2c_f32_bf16 v21, s36, v61
v_dot2c_f32_bf16 v22, s36, v62
v_dot2c_f32_bf16 v23, s36, v63
v_dot2c_f32_bf16 v16, s37, v64
v_dot2c_f32_bf16 v17, s37, v65
v_dot2c_f32_bf16 v18, s37, v66
v_dot2c_f32_bf16 v19, s37, v67
v_dot2c_f32_bf16 v20, s37, v68
v_dot2c_f32_bf16 v21, s37, v69
v_dot2c_f32_bf16 v22, s37, v70
v_dot2c_f32_bf16 v23, s37, v71
v_dot2c_f32_bf16 v16, s38, v72
v_dot2c_f32_bf16 v17, s38, v73
v_dot2c_f32_bf16 v18, s38, v74
v_dot2c_f32_bf16 v19, s38, v75
v_dot2c_f32_bf16 v20, s38, v76
v_dot2c_f32_bf16 v21, s38, v77
v_dot2c_f32_bf16 v22, s38, v78
v_dot2c_f32_bf16 v23, s38, v79
v_dot2c_f32_bf16 v16, s39, v80
v_dot2c_f32_bf16 v17, s39, v81
v_dot2c_f32_bf16 v18, s39, v82
v_dot2c_f32_bf16 v19, s39, v83
v_dot2c_f32_bf16 v20, s39, v84
v_dot2c_f32_bf16 v21, s39, v85
v_dot2c_f32_bf16 v22, s39, v86
v_dot2c_f32_bf16 v23, s39, v87
v_dot2c_f32_bf16 v16, s40, v88
v_dot2c_f32_bf16 v17, s40, v89
v_dot2c_f32_bf16 v18, s40, v90
v_dot2c_f32_bf16 v19, s40, v91
v_dot2c_f32_bf16 v20, s40, v92
v_dot2c_f32_bf16 v21, s40, v93
v_dot2c_f32_bf16 v22, s40, v94
v_dot2c_f32_bf16 v23, s40, v95
v_dot2c_f32_bf16 v16, s41, v96
v_dot2c_f32_bf16 v17, s41, v97
v_dot2c_f32_bf16 v18, s41, v98
v_dot2c_f32_bf16 v19, s41, v99
v_dot2c_f32_bf16 v20, s41, v100
v_dot2c_f32_bf16 v21, s41, v101
v_dot2c_f32_bf16 v22, s41, v102
v_dot2c_f32_bf16 v23, s41, v103
v_dot2c_f32_bf16 v16, s42, v104
v_dot2c_f32_bf16 v17, s42, v105
v_dot2c_f32_bf16 v18, s42, v106
v_dot2c_f32_bf16 v19, s42, v107
v_dot2c_f32_bf16 v20, s42, v108
v_dot2c_f32_bf16 v21, s42, v109
v_dot2c_f32_bf16 v22, s42, v110
v_dot2c_f32_bf16 v23, s42, v111
v_dot2c_f32_bf16 v16, s43, v112
v_dot2c_f32_bf16 v17, s43, v113
v_dot2c_f32_bf16 v18, s43, v114
v_dot2c_f32_bf16 v19, s43, v115
v_dot2c_f32_bf16 v20, s43, v116
v_dot2c_f32_bf16 v21, s43, v117
v_dot2c_f32_bf16 v22, s43, v118
v_dot2c_f32_bf16 v23, s43, v119
v_dot2c_f32_bf16 v16, s44, v120
v_dot2c_f32_bf16 v17, s44, v121
v_dot2c_f32_bf16 v18, s44, v122
v_dot2c_f32_bf16 v19, s44, v123
v_dot2c_f32_bf16 v20, s44, v124
v_dot2c_f32_bf16 v21, s44, v125
v_dot2c_f32_bf16 v22, s44, v126
v_dot2c_f32_bf16 v23, s44, v127
v_dot2c_f32_bf16 v16, s45, v128
v_dot2c_f32_bf16 v17, s45, v129
v_dot2c_f32_bf16 v18, s45, v130
v_dot2c_f32_bf16 v19, s45, v131
v_dot2c_f32_bf16 v20, s45, v132
v_dot2c_f32_bf16 v21, s45, v133
v_dot2c_f32_bf16 v22, s45, v134
v_dot2c_f32_bf16 v23, s45, v135
v_dot2c_f32_bf16 v16, s46, v136
v_dot2c_f32_bf16 v17, s46, v137
v_dot2c_f32_bf16 v18, s46, v138
v_dot2c_f32_bf16 v19, s46, v139
v_dot2c_f32_bf16 v20, s46, v140
v_dot2c_f32_bf16 v21, s46, v141
v_dot2c_f32_bf16 v22, s46, v142
v_dot2c_f32_bf16 v23, s46, v143
v_dot2c_f32_bf16 v16, s47, v144
v_dot2c_f32_bf16 v17, s47, v145
v_dot2c_f32_bf16 v18, s47, v146
v_dot2c_f32_bf16 v19, s47, v147
v_dot2c_f32_bf16 v20, s47, v148
v_dot2c_f32_bf16 v21, s47, v149
v_dot2c_f32_bf16 v22, s47, v150
v_dot2c_f32_bf16 v23, s47, v151
v_dot2c_f32_bf16 v16, s48, v152
v_dot2c_f32_bf16 v17, s48, v153
v_dot2c_f32_bf16 v18, s48, v154
v_dot2c_f32_bf16 v19, s48, v155
v_dot2c_f32_bf16 v20, s48, v156
v_dot2c_f32_bf16 v21, s48, v157
v_dot2c_f32_bf16 v22, s48, v158
v_dot2c_f32_bf16 v23, s48, v159
v_dot2c_f32_bf16 v16, s49, v160
v_dot2c_f32_bf16 v17, s49, v161
v_dot2c_f32_bf16 v18, s49, v162
v_dot2c_f32_bf16 v19, s49, v163
v_dot2c_f32_bf16 v20, s49, v164
v_dot2c_f32_bf16 v21, s49, v165
v_dot2c_f32_bf16 v22, s49, v166
v_dot2c_f32_bf16 v23, s49, v167
v_dot2c_f32_bf16 v16, s50, v168
v_dot2c_f32_bf16 v17, s50, v169
v_dot2c_f32_bf16 v18, s50, v170
v_dot2c_f32_bf16 v19, s50, v171
v_dot2c_f32_bf16 v20, s50, v172
v_dot2c_f32_bf16 v21, s50, v173
v_dot2c_f32_bf16 v22, s50, v174
v_dot2c_f32_bf16 v23, s50, v175
v_dot2c_f32_bf16 v16, s51, v176
v_dot2c_f32_bf16 v17, s51, v177
v_dot2c_f32_bf16 v18, s51, v178
v_dot2c_f32_bf16 v19, s51, v179
v_dot2c_f32_bf16 v20, s51, v180
v_dot2c_f32_bf16 v21, s51, v181
v_dot2c_f32_bf16 v22, s51, v182
v_dot2c_f32_bf16 v23, s51, v183
v_max_u32 v16, 1, v16
v_max_u32 v17, 1, v17
v_max_u32 v18, 1, v18
v_max_u32 v19, 1, v19
v_max_u32 v20, 1, v20
v_max_u32 v21, 1, v21
v_max_u32 v22, 1, v22
v_max_u32 v23, 1, v23
buffer_store_dwordx4 v[16:19], v4, s[24:27], s71 offen offset:0 sc1
buffer_store_dwordx4 v[20:23], v4, s[24:27], s71 offen offset:1024 sc1
s_lshr_b32 s71, s64, 5
s_lshl_b32 s71, s71, 17
s_and_b32 s72, s64, 1
s_bfe_u32 s73, s64, 0x40001
s_lshl4_add_u32 s72, s72, s73
s_lshl_b32 s72, s72, 6
s_add_u32 s71, s71, s72
s_add_u32 s72, s71, 1835008
s_add_u32 s73, s71, 1900544
s_waitcnt vmcnt(0)
v_mov_b32 v16, 0
v_mov_b32 v17, 0
v_mov_b32 v18, 0
v_mov_b32 v19, 0
v_mov_b32 v20, 0
v_mov_b32 v21, 0
v_mov_b32 v22, 0
v_mov_b32 v23, 0
poll_62:
buffer_load_dwordx4 v[24:27], v7, s[24:27], s72 offen offset:0 sc1
buffer_load_dwordx4 v[28:31], v7, s[24:27], s72 offen offset:2048 sc1
buffer_load_dwordx4 v[32:35], v7, s[24:27], s73 offen offset:0 sc1
buffer_load_dwordx4 v[36:39], v7, s[24:27], s73 offen offset:2048 sc1
pchk_63:
s_waitcnt vmcnt(3)
v_min3_u32 v10, v24, v25, v26
s_waitcnt vmcnt(2)
v_min3_u32 v10, v10, v27, v28
v_min3_u32 v10, v10, v29, v30
s_waitcnt vmcnt(1)
v_min3_u32 v10, v10, v31, v32
v_min3_u32 v10, v10, v33, v34
s_waitcnt vmcnt(0)
v_min3_u32 v10, v10, v35, v36
v_min3_u32 v10, v10, v37, v38
v_min_u32 v10, v10, v39
v_cmp_eq_u32 vcc, 0, v10
s_cbranch_vccz pdone_64
s_sub_u32 s32, s32, 1
s_cmp_gt_i32 s32, 0
s_cbranch_scc1 poll_62
pdone_64:
v_pk_add_f32 v[8:9], v[24:25], v[32:33]
v_pk_add_f32 v[10:11], v[26:27], v[34:35]
v_pk_add_f32 v[12:13], v[28:29], v[36:37]
v_pk_add_f32 v[14:15], v[30:31], v[38:39]
s_nop 0
v_permlane32_swap_b32 v8, v12
v_permlane32_swap_b32 v9, v13
v_permlane32_swap_b32 v10, v14
v_permlane32_swap_b32 v11, v15
v_pk_add_f32 v[8:9], v[8:9], v[12:13]
v_pk_add_f32 v[10:11], v[10:11], v[14:15]
s_nop 1
v_permlane16_swap_b32 v8, v10
v_permlane16_swap_b32 v9, v11
v_pk_add_f32 v[8:9], v[8:9], v[10:11]
s_nop 1
v_add_f32_dpp v8, v8, v8 row_ror:4 row_mask:0xf bank_mask:0xf
v_add_f32_dpp v9, v9, v9 row_ror:4 row_mask:0xf bank_mask:0xf
s_nop 0
v_add_f32_dpp v8, v8, v8 row_ror:8 row_mask:0xf bank_mask:0xf
v_add_f32_dpp v9, v9, v9 row_ror:8 row_mask:0xf bank_mask:0xf
v_mov_b32 v10, v8
v_mov_b32 v11, v9
s_nop 0
v_permlane32_swap_b32 v8, v10
v_permlane32_swap_b32 v9, v11
v_mul_f32 v12, 0xbfb8aa3b, v8
v_mul_f32 v13, 0xbfb8aa3b, v9
v_exp_f32 v12, v12
v_exp_f32 v13, v13
v_pk_mul_f32 v[8:9], v[8:9], v[10:11]
v_add_f32 v12, 1.0, v12
v_add_f32 v13, 1.0, v13
v_rcp_f32 v12, v12
v_rcp_f32 v13, v13
s_nop 0
v_pk_mul_f32 v[8:9], v[8:9], v[12:13]
v_cvt_pk_bf16_f32 v8, v8, v9
s_nop 0
v_readlane_b32 s36, v8, 0
v_readlane_b32 s37, v8, 16
v_readlane_b32 s38, v8, 1
v_readlane_b32 s39, v8, 17
v_readlane_b32 s40, v8, 2
v_readlane_b32 s41, v8, 18
v_readlane_b32 s42, v8, 3
v_readlane_b32 s43, v8, 19
v_dot2c_f32_bf16 v16, s36, v184
v_dot2c_f32_bf16 v17, s36, v185
v_dot2c_f32_bf16 v18, s36, v186
v_dot2c_f32_bf16 v19, s36, v187
v_dot2c_f32_bf16 v20, s36, v188
v_dot2c_f32_bf16 v21, s36, v189
v_dot2c_f32_bf16 v22, s36, v190
v_dot2c_f32_bf16 v23, s36, v191
v_dot2c_f32_bf16 v16, s37, v192
v_dot2c_f32_bf16 v17, s37, v193
v_dot2c_f32_bf16 v18, s37, v194
v_dot2c_f32_bf16 v19, s37, v195
v_dot2c_f32_bf16 v20, s37, v196
v_dot2c_f32_bf16 v21, s37, v197
v_dot2c_f32_bf16 v22, s37, v198
v_dot2c_f32_bf16 v23, s37, v199
v_dot2c_f32_bf16 v16, s38, v200
v_dot2c_f32_bf16 v17, s38, v201
v_dot2c_f32_bf16 v18, s38, v202
v_dot2c_f32_bf16 v19, s38, v203
v_dot2c_f32_bf16 v20, s38, v204
v_dot2c_f32_bf16 v21, s38, v205
v_dot2c_f32_bf16 v22, s38, v206
v_dot2c_f32_bf16 v23, s38, v207
v_dot2c_f32_bf16 v16, s39, v208
v_dot2c_f32_bf16 v17, s39, v209
v_dot2c_f32_bf16 v18, s39, v210
v_dot2c_f32_bf16 v19, s39, v211
v_dot2c_f32_bf16 v20, s39, v212
v_dot2c_f32_bf16 v21, s39, v213
v_dot2c_f32_bf16 v22, s39, v214
v_dot2c_f32_bf16 v23, s39, v215
v_dot2c_f32_bf16 v16, s40, v216
v_dot2c_f32_bf16 v17, s40, v217
v_dot2c_f32_bf16 v18, s40, v218
v_dot2c_f32_bf16 v19, s40, v219
v_dot2c_f32_bf16 v20, s40, v220
v_dot2c_f32_bf16 v21, s40, v221
v_dot2c_f32_bf16 v22, s40, v222
v_dot2c_f32_bf16 v23, s40, v223
v_dot2c_f32_bf16 v16, s41, v224
v_dot2c_f32_bf16 v17, s41, v225
v_dot2c_f32_bf16 v18, s41, v226
v_dot2c_f32_bf16 v19, s41, v227
v_dot2c_f32_bf16 v20, s41, v228
v_dot2c_f32_bf16 v21, s41, v229
v_dot2c_f32_bf16 v22, s41, v230
v_dot2c_f32_bf16 v23, s41, v231
v_dot2c_f32_bf16 v16, s42, v232
v_dot2c_f32_bf16 v17, s42, v233
v_dot2c_f32_bf16 v18, s42, v234
v_dot2c_f32_bf16 v19, s42, v235
v_dot2c_f32_bf16 v20, s42, v236
v_dot2c_f32_bf16 v21, s42, v237
v_dot2c_f32_bf16 v22, s42, v238
v_dot2c_f32_bf16 v23, s42, v239
v_dot2c_f32_bf16 v16, s43, v240
v_dot2c_f32_bf16 v17, s43, v241
v_dot2c_f32_bf16 v18, s43, v242
v_dot2c_f32_bf16 v19, s43, v243
v_dot2c_f32_bf16 v20, s43, v244
v_dot2c_f32_bf16 v21, s43, v245
v_dot2c_f32_bf16 v22, s43, v246
v_dot2c_f32_bf16 v23, s43, v247
v_max_u32 v16, 1, v16
v_max_u32 v17, 1, v17
v_max_u32 v18, 1, v18
v_max_u32 v19, 1, v19
v_max_u32 v20, 1, v20
v_max_u32 v21, 1, v21
v_max_u32 v22, 1, v22
v_max_u32 v23, 1, v23
buffer_store_dwordx4 v[16:19], v4, s[24:27], s70 offen offset:0 sc1
buffer_store_dwordx4 v[20:23], v4, s[24:27], s70 offen offset:1024 sc1
fnd_61:
s_cmp_eq_u32 s58, 0
s_cbranch_scc0 fnr_65
v_min_u32 v6, 55, v0
v_lshlrev_b32 v6, 12, v6
s_lshr_b32 s70, s65, 7
s_and_b32 s71, s65, 1
s_lshl1_add_u32 s70, s70, s71
s_lshl_b32 s70, s70, 10
s_bfe_u32 s71, s65, 0x60001
s_lshl4_add_u32 s70, s71, s70
s_add_u32 s72, s70, 917504
s_add_u32 s73, s70, 1146880
s_add_u32 s74, s70, 1376256
s_add_u32 s75, s70, 1605632
s_lshl_b32 s70, s68, 12
s_lshl4_add_u32 s70, s65, s70
s_add_u32 s76, s70, 2818048
v_mov_b32 v12, s67
v_mul_f32 v12, 0xbfb8aa3b, v12
v_exp_f32 v12, v12
v_cmp_gt_u32 vcc, 56, v0
v_add_f32 v12, 1.0, v12
v_rcp_f32 v12, v12
s_lshl_b32 s70, s33, 11
s_lshl3_add_u32 s70, s65, s70
s_lshl_b32 s71, s65, 7
s_add_u32 s71, s71, 2916352
v_cndmask_b32 v12, 0, v12, vcc
s_waitcnt vmcnt(0)
poll_67:
buffer_load_dwordx4 v[40:43], off, s[24:27], s76 sc1
buffer_load_dwordx4 v[24:27], v6, s[24:27], s72 offen sc1
buffer_load_dwordx4 v[28:31], v6, s[24:27], s73 offen sc1
buffer_load_dwordx4 v[32:35], v6, s[24:27], s74 offen sc1
buffer_load_dwordx4 v[36:39], v6, s[24:27], s75 offen sc1
pchk_68:
s_waitcnt vmcnt(3)
v_min3_u32 v10, v24, v25, v26
s_waitcnt vmcnt(2)
v_min3_u32 v10, v10, v27, v28
v_min3_u32 v10, v10, v29, v30
s_waitcnt vmcnt(1)
v_min3_u32 v10, v10, v31, v32
v_min3_u32 v10, v10, v33, v34
s_waitcnt vmcnt(0)
v_min3_u32 v10, v10, v35, v36
v_min3_u32 v10, v10, v37, v38
v_min3_u32 v10, v10, v39, v40
v_min3_u32 v10, v10, v41, v42
v_min_u32 v10, v10, v43
v_cmp_eq_u32 vcc, 0, v10
s_cbranch_vccz pdone_69
s_sub_u32 s32, s32, 1
s_cmp_gt_i32 s32, 0
s_cbranch_scc1 poll_67
pdone_69:
v_pk_add_f32 v[24:25], v[24:25], v[32:33]
v_pk_add_f32 v[26:27], v[26:27], v[34:35]
v_pk_add_f32 v[28:29], v[28:29], v[36:37]
v_pk_add_f32 v[30:31], v[30:31], v[38:39]
v_pk_add_f32 v[24:25], v[24:25], v[28:29]
v_pk_add_f32 v[26:27], v[26:27], v[30:31]
v_pk_mul_f32 v[24:25], v[24:25], v[12:13] op_sel:[0,0] op_sel_hi:[1,0]
v_pk_mul_f32 v[26:27], v[26:27], v[12:13] op_sel:[0,0] op_sel_hi:[1,0]
s_nop 0
v_add_f32_dpp v24, v24, v24 row_ror:1 row_mask:0xf bank_mask:0xf
v_add_f32_dpp v25, v25, v25 row_ror:1 row_mask:0xf bank_mask:0xf
v_add_f32_dpp v26, v26, v26 row_ror:1 row_mask:0xf bank_mask:0xf
v_add_f32_dpp v27, v27, v27 row_ror:1 row_mask:0xf bank_mask:0xf
v_add_f32_dpp v24, v24, v24 row_ror:2 row_mask:0xf bank_mask:0xf
v_add_f32_dpp v25, v25, v25 row_ror:2 row_mask:0xf bank_mask:0xf
v_add_f32_dpp v26, v26, v26 row_ror:2 row_mask:0xf bank_mask:0xf
v_add_f32_dpp v27, v27, v27 row_ror:2 row_mask:0xf bank_mask:0xf
v_add_f32_dpp v24, v24, v24 row_ror:4 row_mask:0xf bank_mask:0xf
v_add_f32_dpp v25, v25, v25 row_ror:4 row_mask:0xf bank_mask:0xf
v_add_f32_dpp v26, v26, v26 row_ror:4 row_mask:0xf bank_mask:0xf
v_add_f32_dpp v27, v27, v27 row_ror:4 row_mask:0xf bank_mask:0xf
v_add_f32_dpp v24, v24, v24 row_ror:8 row_mask:0xf bank_mask:0xf
v_add_f32_dpp v25, v25, v25 row_ror:8 row_mask:0xf bank_mask:0xf
v_add_f32_dpp v26, v26, v26 row_ror:8 row_mask:0xf bank_mask:0xf
v_add_f32_dpp v27, v27, v27 row_ror:8 row_mask:0xf bank_mask:0xf
v_mov_b32 v28, v24
v_mov_b32 v29, v25
v_mov_b32 v30, v26
v_mov_b32 v31, v27
v_permlane16_swap_b32 v28, v24
v_permlane16_swap_b32 v29, v25
v_permlane16_swap_b32 v30, v26
v_permlane16_swap_b32 v31, v27
v_add_f32 v24, v24, v28
v_add_f32 v25, v25, v29
v_add_f32 v26, v26, v30
v_add_f32 v27, v27, v31
v_mov_b32 v28, v24
v_mov_b32 v29, v25
v_mov_b32 v30, v26
v_mov_b32 v31, v27
v_permlane32_swap_b32 v28, v24
v_permlane32_swap_b32 v29, v25
v_permlane32_swap_b32 v30, v26
v_permlane32_swap_b32 v31, v27
v_add_f32 v24, v24, v28
v_add_f32 v25, v25, v29
v_add_f32 v26, v26, v30
v_add_f32 v27, v27, v31
v_pk_add_f32 v[24:25], v[24:25], v[40:41]
v_pk_add_f32 v[26:27], v[26:27], v[42:43]
v_cvt_pk_bf16_f32 v8, v24, v25
v_cvt_pk_bf16_f32 v9, v26, v27
s_mov_b64 exec, 1
s_cmp_eq_u32 s63, 0
s_cbranch_scc1 fl0_66
buffer_store_dwordx2 v[8:9], off, s[28:31], s70
s_mov_b64 exec, -1
s_branch L_end
fl0_66:
v_max_u32 v8, 1, v8
v_max_u32 v9, 1, v9
buffer_store_dwordx2 v[8:9], off, s[24:27], s71 sc1
s_mov_b64 exec, -1
s_waitcnt vmcnt(0)
fnr_65:
s_cmp_eq_u32 s63, 0
s_cbranch_scc0 L_end
v_add_u32 v5, s34, 4
s_mov_b64 exec, 1
ds_write_b32 v3, v5
s_mov_b64 exec, -1
v_and_b32 v6, 48, v0
v_lshlrev_b32 v6, 3, v6
s_lshl_b32 s70, s59, 11
s_add_u32 s70, s70, 2916352
s_add_u32 s35, s34, 4
lw_70:
ds_read_b32 v5, v2 offset:24
s_waitcnt lgkmcnt(0)
v_cmp_gt_i32 vcc, s35, v5
s_cbranch_vccz lwd_71
s_sleep 2
s_sub_u32 s32, s32, 1
s_cmp_gt_i32 s32, 0
s_cbranch_scc1 lw_70
lwd_71:
poll_72:
buffer_load_dwordx2 v[8:9], v6, s[24:27], s70 offen offset:0 sc1
buffer_load_dwordx2 v[10:11], v6, s[24:27], s70 offen offset:512 sc1
buffer_load_dwordx2 v[12:13], v6, s[24:27], s70 offen offset:1024 sc1
buffer_load_dwordx2 v[14:15], v6, s[24:27], s70 offen offset:1536 sc1
pchk_73:
s_waitcnt vmcnt(2)
v_min3_u32 v7, v8, v9, v10
s_waitcnt vmcnt(1)
v_min3_u32 v7, v7, v11, v12
s_waitcnt vmcnt(0)
v_min3_u32 v7, v7, v13, v14
v_min_u32 v7, v7, v15
v_cmp_eq_u32 vcc, 0, v7
s_cbranch_vccz pdone_74
s_sub_u32 s32, s32, 1
s_cmp_gt_i32 s32, 0
s_cbranch_scc1 poll_72
pdone_74:
s_mov_b32 s63, 1
s_mov_b32 s34, 32
s_add_u32 s24, s24, 2949120
s_addc_u32 s25, s25, 0
s_mov_b32 s26, 2949120
s_mov_b32 s70, 131072
s_branch ftop_38
fst_41:
s_lshl4_add_u32 s70, s59, s60
s_lshl1_add_u32 s70, s70, s58
s_lshl_b32 s70, s70, 13
v_lshrrev_b32 v7, 4, v0
v_and_b32 v8, 15, v0
v_lshlrev_b32 v8, 4, v8
v_lshl_add_u32 v8, v7, 11, v8
buffer_load_dwordx4 v[24:27], v8, s[8:11], s70 offen offset:0
buffer_load_dwordx4 v[28:31], v8, s[8:11], s70 offen offset:256
buffer_load_dwordx4 v[32:35], v8, s[8:11], s70 offen offset:512
buffer_load_dwordx4 v[36:39], v8, s[8:11], s70 offen offset:768
buffer_load_dwordx4 v[40:43], v8, s[8:11], s70 offen offset:1024
buffer_load_dwordx4 v[44:47], v8, s[8:11], s70 offen offset:1280
buffer_load_dwordx4 v[48:51], v8, s[8:11], s70 offen offset:1536
buffer_load_dwordx4 v[52:55], v8, s[8:11], s70 offen offset:1792
s_cmp_eq_u32 s58, 1
s_cbranch_scc0 fz_75
v_lshlrev_b32 v14, 4, v0
v_mov_b32 v56, 0
v_mov_b32 v57, 0
v_mov_b32 v58, 0
v_mov_b32 v59, 0
s_mul_i32 s70, s2, 21504
s_add_u32 s70, s70, 327680
buffer_store_dwordx4 v[56:59], v14, s[24:27], s70 offen offset:0 sc1
buffer_store_dwordx4 v[56:59], v14, s[24:27], s70 offen offset:1024 sc1
buffer_store_dwordx4 v[56:59], v14, s[24:27], s70 offen offset:2048 sc1
buffer_store_dwordx4 v[56:59], v14, s[24:27], s70 offen offset:3072 sc1
s_add_u32 s70, s70, 4096
buffer_store_dwordx4 v[56:59], v14, s[24:27], s70 offen offset:0 sc1
buffer_store_dwordx4 v[56:59], v14, s[24:27], s70 offen offset:1024 sc1
buffer_store_dwordx4 v[56:59], v14, s[24:27], s70 offen offset:2048 sc1
buffer_store_dwordx4 v[56:59], v14, s[24:27], s70 offen offset:3072 sc1
s_add_u32 s70, s70, 4096
buffer_store_dwordx4 v[56:59], v14, s[24:27], s70 offen offset:0 sc1
buffer_store_dwordx4 v[56:59], v14, s[24:27], s70 offen offset:1024 sc1
buffer_store_dwordx4 v[56:59], v14, s[24:27], s70 offen offset:2048 sc1
buffer_store_dwordx4 v[56:59], v14, s[24:27], s70 offen offset:3072 sc1
s_add_u32 s70, s70, 4096
buffer_store_dwordx4 v[56:59], v14, s[24:27], s70 offen offset:0 sc1
buffer_store_dwordx4 v[56:59], v14, s[24:27], s70 offen offset:1024 sc1
buffer_store_dwordx4 v[56:59], v14, s[24:27], s70 offen offset:2048 sc1
buffer_store_dwordx4 v[56:59], v14, s[24:27], s70 offen offset:3072 sc1
s_add_u32 s70, s70, 4096
buffer_store_dwordx4 v[56:59], v14, s[24:27], s70 offen offset:0 sc1
buffer_store_dwordx4 v[56:59], v14, s[24:27], s70 offen offset:1024 sc1
buffer_store_dwordx4 v[56:59], v14, s[24:27], s70 offen offset:2048 sc1
buffer_store_dwordx4 v[56:59], v14, s[24:27], s70 offen offset:3072 sc1
s_add_u32 s70, s70, 4096
buffer_store_dwordx4 v[56:59], v14, s[24:27], s70 offen offset:0 sc1
fz_75:
v_lshlrev_b32 v9, 4, v1
v_mov_b32 v10, 0
v_mov_b32 v11, 0
s_waitcnt vmcnt(7)
v_dot2c_f32_bf16 v10, s69, v24
v_dot2c_f32_bf16 v11, v24, v24
v_dot2c_f32_bf16 v10, s69, v25
v_dot2c_f32_bf16 v11, v25, v25
v_dot2c_f32_bf16 v10, s69, v26
v_dot2c_f32_bf16 v11, v26, v26
v_dot2c_f32_bf16 v10, s69, v27
v_dot2c_f32_bf16 v11, v27, v27
s_waitcnt vmcnt(6)
v_dot2c_f32_bf16 v10, s69, v28
v_dot2c_f32_bf16 v11, v28, v28
v_dot2c_f32_bf16 v10, s69, v29
v_dot2c_f32_bf16 v11, v29, v29
v_dot2c_f32_bf16 v10, s69, v30
v_dot2c_f32_bf16 v11, v30, v30
v_dot2c_f32_bf16 v10, s69, v31
v_dot2c_f32_bf16 v11, v31, v31
s_waitcnt vmcnt(5)
v_dot2c_f32_bf16 v10, s69, v32
v_dot2c_f32_bf16 v11, v32, v32
v_dot2c_f32_bf16 v10, s69, v33
v_dot2c_f32_bf16 v11, v33, v33
v_dot2c_f32_bf16 v10, s69, v34
v_dot2c_f32_bf16 v11, v34, v34
v_dot2c_f32_bf16 v10, s69, v35
v_dot2c_f32_bf16 v11, v35, v35
s_waitcnt vmcnt(4)
v_dot2c_f32_bf16 v10, s69, v36
v_dot2c_f32_bf16 v11, v36, v36
v_dot2c_f32_bf16 v10, s69, v37
v_dot2c_f32_bf16 v11, v37, v37
v_dot2c_f32_bf16 v10, s69, v38
v_dot2c_f32_bf16 v11, v38, v38
v_dot2c_f32_bf16 v10, s69, v39
v_dot2c_f32_bf16 v11, v39, v39
s_waitcnt vmcnt(3)
v_dot2c_f32_bf16 v10, s69, v40
v_dot2c_f32_bf16 v11, v40, v40
v_dot2c_f32_bf16 v10, s69, v41
v_dot2c_f32_bf16 v11, v41, v41
v_dot2c_f32_bf16 v10, s69, v42
v_dot2c_f32_bf16 v11, v42, v42
v_dot2c_f32_bf16 v10, s69, v43
v_dot2c_f32_bf16 v11, v43, v43
s_waitcnt vmcnt(2)
v_dot2c_f32_bf16 v10, s69, v44
v_dot2c_f32_bf16 v11, v44, v44
v_dot2c_f32_bf16 v10, s69, v45
v_dot2c_f32_bf16 v11, v45, v45
v_dot2c_f32_bf16 v10, s69, v46
v_dot2c_f32_bf16 v11, v46, v46
v_dot2c_f32_bf16 v10, s69, v47
v_dot2c_f32_bf16 v11, v47, v47
s_waitcnt vmcnt(1)
v_dot2c_f32_bf16 v10, s69, v48
v_dot2c_f32_bf16 v11, v48, v48
v_dot2c_f32_bf16 v10, s69, v49
v_dot2c_f32_bf16 v11, v49, v49
v_dot2c_f32_bf16 v10, s69, v50
v_dot2c_f32_bf16 v11, v50, v50
v_dot2c_f32_bf16 v10, s69, v51
v_dot2c_f32_bf16 v11, v51, v51
s_waitcnt vmcnt(0)
v_dot2c_f32_bf16 v10, s69, v52
v_dot2c_f32_bf16 v11, v52, v52
v_dot2c_f32_bf16 v10, s69, v53
v_dot2c_f32_bf16 v11, v53, v53
v_dot2c_f32_bf16 v10, s69, v54
v_dot2c_f32_bf16 v11, v54, v54
v_dot2c_f32_bf16 v10, s69, v55
v_dot2c_f32_bf16 v11, v55, v55
s_nop 1
v_add_f32_dpp v10, v10, v10 row_ror:1 row_mask:0xf bank_mask:0xf
v_add_f32_dpp v11, v11, v11 row_ror:1 row_mask:0xf bank_mask:0xf
s_nop 0
v_add_f32_dpp v10, v10, v10 row_ror:2 row_mask:0xf bank_mask:0xf
v_add_f32_dpp v11, v11, v11 row_ror:2 row_mask:0xf bank_mask:0xf
s_nop 0
v_add_f32_dpp v10, v10, v10 row_ror:4 row_mask:0xf bank_mask:0xf
v_add_f32_dpp v11, v11, v11 row_ror:4 row_mask:0xf bank_mask:0xf
s_nop 0
v_add_f32_dpp v10, v10, v10 row_ror:8 row_mask:0xf bank_mask:0xf
v_add_f32_dpp v11, v11, v11 row_ror:8 row_mask:0xf bank_mask:0xf
v_mul_f32 v5, 0xba800000, v10
v_mul_f32 v11, 0x3a800000, v11
v_fma_f32 v11, -v5, v5, v11
v_max_f32 v11, 0, v11
v_add_f32 v11, 0x3727c5ac, v11
v_rsq_f32 v10, v11
s_nop 0
v_mul_f32 v11, v5, v10
v_max_u32 v11, 1, v11
s_lshl_b32 s70, s60, 7
s_add_u32 s70, s70, s76
s_lshl_b32 s73, s58, 5
s_add_u32 s70, s70, s73
v_lshlrev_b32 v7, 3, v7
s_add_u32 s35, s34, 5
lw_76:
ds_read_b32 v5, v2 offset:16
s_waitcnt lgkmcnt(0)
v_cmp_gt_i32 vcc, s35, v5
s_cbranch_vccz lwd_77
s_sleep 4
s_sub_u32 s32, s32, 1
s_cmp_gt_i32 s32, 0
s_cbranch_scc1 lw_76
lwd_77:
poll_78:
buffer_load_dword v12, v9, s[4:7], 0 offen sc1
pchk_79:
s_waitcnt vmcnt(0)
v_cmp_gt_u32 vcc, 64, v12
s_cbranch_vccz pdone_80
s_sleep 16
s_sub_u32 s32, s32, 1
s_cmp_gt_i32 s32, 0
s_cbranch_scc1 poll_78
pdone_80:
s_and_b32 s73, s2, 7
s_lshl_b32 s73, s73, 7
s_add_u32 s73, s73, 294912
v_mov_b32 v14, 1
s_mov_b32 exec_lo, s58
s_mov_b32 exec_hi, 0
s_waitcnt vmcnt(0)
buffer_atomic_add v14, off, s[24:27], s73 sc1
s_mov_b64 exec, -1
s_mov_b32 exec_lo, 0x10001
s_mov_b32 exec_hi, 0x10001
buffer_store_dwordx2 v[10:11], v7, s[24:27], s70 offen sc1
s_mov_b64 exec, -1
s_branch fsb_42
fg_43:
s_lshl1_add_u32 s35, s2, s58
s_lshl_b32 s35, s35, 12
s_add_u32 s44, s40, s35
s_addc_u32 s45, s41, 0
s_mov_b32 s35, 4
ft_81:
s_load_dwordx2 s[42:43], s[44:45], 60
s_load_dwordx2 s[42:43], s[44:45], 188
s_load_dwordx2 s[42:43], s[44:45], 316
s_load_dwordx2 s[42:43], s[44:45], 444
s_load_dwordx2 s[42:43], s[44:45], 572
s_load_dwordx2 s[42:43], s[44:45], 700
s_load_dwordx2 s[42:43], s[44:45], 828
s_load_dwordx2 s[42:43], s[44:45], 956
s_add_u32 s44, s44, 1024
s_addc_u32 s45, s45, 0
s_sub_u32 s35, s35, 1
s_cmp_eq_u32 s35, 0
s_cbranch_scc0 ft_81
buffer_load_dwordx4 v[64:67], v4, s[16:19], s77 offen nt
s_add_u32 s77, s77, 7168
buffer_load_dwordx4 v[68:71], v4, s[16:19], s77 offen nt
s_add_u32 s77, s77, 7168
buffer_load_dwordx4 v[72:75], v4, s[16:19], s77 offen nt
s_add_u32 s77, s77, 7168
buffer_load_dwordx4 v[76:79], v4, s[16:19], s77 offen nt
s_add_u32 s77, s77, 7168
buffer_load_dwordx4 v[80:83], v4, s[16:19], s77 offen nt
s_add_u32 s77, s77, 7168
buffer_load_dwordx4 v[84:87], v4, s[16:19], s77 offen nt
s_add_u32 s77, s77, 7168
buffer_load_dwordx4 v[88:91], v4, s[16:19], s77 offen nt
s_add_u32 s77, s77, 7168
buffer_load_dwordx4 v[92:95], v4, s[16:19], s77 offen nt
s_add_u32 s77, s77, 7168
buffer_load_dwordx4 v[96:99], v4, s[16:19], s77 offen nt
s_add_u32 s77, s77, 7168
buffer_load_dwordx4 v[100:103], v4, s[16:19], s77 offen nt
s_add_u32 s77, s77, 7168
buffer_load_dwordx4 v[104:107], v4, s[16:19], s77 offen nt
s_add_u32 s77, s77, 7168
buffer_load_dwordx4 v[108:111], v4, s[16:19], s77 offen nt
s_add_u32 s77, s77, 7168
buffer_load_dwordx4 v[112:115], v4, s[16:19], s77 offen nt
s_add_u32 s77, s77, 7168
buffer_load_dwordx4 v[116:119], v4, s[16:19], s77 offen nt
s_add_u32 s77, s77, 7168
buffer_load_dwordx4 v[120:123], v4, s[16:19], s77 offen nt
s_add_u32 s77, s77, 7168
buffer_load_dwordx4 v[124:127], v4, s[16:19], s77 offen nt
s_add_u32 s77, s77, 7168
v_and_b32 v10, 7, v0
v_lshlrev_b32 v10, 7, v10
s_mov_b32 s70, 294912
s_add_u32 s35, s34, 10
lw_82:
ds_read_b32 v5, v2 offset:16
s_waitcnt lgkmcnt(0)
v_cmp_gt_i32 vcc, s35, v5
s_cbranch_vccz lwd_83
s_sleep 4
s_sub_u32 s32, s32, 1
s_cmp_gt_i32 s32, 0
s_cbranch_scc1 lw_82
lwd_83:
poll_84:
buffer_load_dword v12, v10, s[24:27], s70 offen sc1
pchk_85:
s_waitcnt vmcnt(0)
v_cmp_gt_u32 vcc, 32, v12
s_cbranch_vccz pdone_86
s_sleep 16
s_sub_u32 s32, s32, 1
s_cmp_gt_i32 s32, 0
s_cbranch_scc1 poll_84
pdone_86:
s_branch fg_44
fnw_52:
s_mov_b32 s72, 0x05040100
s_mov_b32 s73, 0x07060302
s_add_u32 s35, s34, 17
lw_87:
ds_read_b32 v5, v2 offset:16
s_waitcnt lgkmcnt(0)
v_cmp_gt_i32 vcc, s35, v5
s_cbranch_vccz lwd_88
s_sleep 4
s_sub_u32 s32, s32, 1
s_cmp_gt_i32 s32, 0
s_cbranch_scc1 lw_87
lwd_88:
buffer_load_dwordx4 v[128:131], v4, s[16:19], s77 offen nt
s_add_u32 s77, s77, 7168
buffer_load_dwordx4 v[132:135], v4, s[16:19], s77 offen nt
s_add_u32 s77, s77, 7168
buffer_load_dwordx4 v[136:139], v4, s[16:19], s77 offen nt
s_add_u32 s77, s77, 7168
buffer_load_dwordx4 v[140:143], v4, s[16:19], s77 offen nt
s_add_u32 s77, s77, 7168
buffer_load_dwordx4 v[144:147], v4, s[16:19], s77 offen nt
s_add_u32 s77, s77, 7168
buffer_load_dwordx4 v[148:151], v4, s[16:19], s77 offen nt
s_add_u32 s77, s77, 7168
buffer_load_dwordx4 v[152:155], v4, s[16:19], s77 offen nt
s_add_u32 s77, s77, 7168
buffer_load_dwordx4 v[156:159], v4, s[16:19], s77 offen nt
s_add_u32 s77, s77, 7168
buffer_load_dwordx4 v[160:163], v4, s[16:19], s77 offen nt
s_add_u32 s77, s77, 7168
buffer_load_dwordx4 v[164:167], v4, s[16:19], s77 offen nt
s_add_u32 s77, s77, 7168
buffer_load_dwordx4 v[168:171], v4, s[16:19], s77 offen nt
s_add_u32 s77, s77, 7168
buffer_load_dwordx4 v[172:175], v4, s[16:19], s77 offen nt
s_add_u32 s77, s77, 7168
buffer_load_dwordx4 v[176:179], v4, s[16:19], s77 offen nt
s_add_u32 s77, s77, 7168
buffer_load_dwordx4 v[180:183], v4, s[16:19], s77 offen nt
s_add_u32 s77, s77, 7168
buffer_load_dwordx4 v[184:187], v4, s[16:19], s77 offen nt
s_add_u32 s77, s77, 7168
buffer_load_dwordx4 v[188:191], v4, s[16:19], s77 offen nt
s_add_u32 s77, s77, 7168
buffer_load_dwordx4 v[192:195], v4, s[12:15], s66 offen offset:0 nt
buffer_load_dwordx4 v[196:199], v4, s[12:15], s66 offen offset:2048 nt
s_add_u32 s66, s66, 4096
buffer_load_dwordx4 v[200:203], v4, s[12:15], s66 offen offset:0 nt
buffer_load_dwordx4 v[204:207], v4, s[12:15], s66 offen offset:2048 nt
s_add_u32 s66, s66, 12288
buffer_load_dwordx4 v[208:211], v4, s[12:15], s66 offen offset:0 nt
buffer_load_dwordx4 v[212:215], v4, s[12:15], s66 offen offset:2048 nt
s_add_u32 s66, s66, 4096
buffer_load_dwordx4 v[216:219], v4, s[12:15], s66 offen offset:0 nt
buffer_load_dwordx4 v[220:223], v4, s[12:15], s66 offen offset:2048 nt
s_add_u32 s66, s66, 12288
buffer_load_dwordx4 v[224:227], v4, s[12:15], s66 offen offset:0 nt
buffer_load_dwordx4 v[228:231], v4, s[12:15], s66 offen offset:2048 nt
s_add_u32 s66, s66, 4096
buffer_load_dwordx4 v[232:235], v4, s[12:15], s66 offen offset:0 nt
buffer_load_dwordx4 v[236:239], v4, s[12:15], s66 offen offset:2048 nt
s_add_u32 s66, s66, 12288
buffer_load_dwordx4 v[240:243], v4, s[12:15], s66 offen offset:0 nt
buffer_load_dwordx4 v[244:247], v4, s[12:15], s66 offen offset:2048 nt
s_add_u32 s66, s66, 4096
buffer_load_dwordx4 v[248:251], v4, s[12:15], s66 offen offset:0 nt
buffer_load_dwordx4 v[252:255], v4, s[12:15], s66 offen offset:2048 nt
s_add_u32 s66, s66, 12288
v_perm_b32 v56, v68, v64, s72
v_perm_b32 v57, v68, v64, s73
v_perm_b32 v58, v69, v65, s72
v_perm_b32 v59, v69, v65, s73
v_perm_b32 v60, v70, v66, s72
v_perm_b32 v61, v70, v66, s73
v_perm_b32 v62, v71, v67, s72
v_perm_b32 v63, v71, v67, s73
v_perm_b32 v64, v76, v72, s72
v_perm_b32 v65, v76, v72, s73
v_perm_b32 v66, v77, v73, s72
v_perm_b32 v67, v77, v73, s73
v_perm_b32 v68, v78, v74, s72
v_perm_b32 v69, v78, v74, s73
v_perm_b32 v70, v79, v75, s72
v_perm_b32 v71, v79, v75, s73
v_perm_b32 v72, v84, v80, s72
v_perm_b32 v73, v84, v80, s73
v_perm_b32 v74, v85, v81, s72
v_perm_b32 v75, v85, v81, s73
v_perm_b32 v76, v86, v82, s72
v_perm_b32 v77, v86, v82, s73
v_perm_b32 v78, v87, v83, s72
v_perm_b32 v79, v87, v83, s73
v_perm_b32 v80, v92, v88, s72
v_perm_b32 v81, v92, v88, s73
v_perm_b32 v82, v93, v89, s72
v_perm_b32 v83, v93, v89, s73
v_perm_b32 v84, v94, v90, s72
v_perm_b32 v85, v94, v90, s73
v_perm_b32 v86, v95, v91, s72
v_perm_b32 v87, v95, v91, s73
v_perm_b32 v88, v100, v96, s72
v_perm_b32 v89, v100, v96, s73
v_perm_b32 v90, v101, v97, s72
v_perm_b32 v91, v101, v97, s73
v_perm_b32 v92, v102, v98, s72
v_perm_b32 v93, v102, v98, s73
v_perm_b32 v94, v103, v99, s72
v_perm_b32 v95, v103, v99, s73
v_perm_b32 v96, v108, v104, s72
v_perm_b32 v97, v108, v104, s73
v_perm_b32 v98, v109, v105, s72
v_perm_b32 v99, v109, v105, s73
v_perm_b32 v100, v110, v106, s72
v_perm_b32 v101, v110, v106, s73
v_perm_b32 v102, v111, v107, s72
v_perm_b32 v103, v111, v107, s73
v_perm_b32 v104, v116, v112, s72
v_perm_b32 v105, v116, v112, s73
v_perm_b32 v106, v117, v113, s72
v_perm_b32 v107, v117, v113, s73
v_perm_b32 v108, v118, v114, s72
v_perm_b32 v109, v118, v114, s73
v_perm_b32 v110, v119, v115, s72
v_perm_b32 v111, v119, v115, s73
v_perm_b32 v112, v124, v120, s72
v_perm_b32 v113, v124, v120, s73
v_perm_b32 v114, v125, v121, s72
v_perm_b32 v115, v125, v121, s73
v_perm_b32 v116, v126, v122, s72
v_perm_b32 v117, v126, v122, s73
v_perm_b32 v118, v127, v123, s72
v_perm_b32 v119, v127, v123, s73
s_waitcnt vmcnt(30)
v_perm_b32 v120, v132, v128, s72
v_perm_b32 v121, v132, v128, s73
v_perm_b32 v122, v133, v129, s72
v_perm_b32 v123, v133, v129, s73
v_perm_b32 v124, v134, v130, s72
v_perm_b32 v125, v134, v130, s73
v_perm_b32 v126, v135, v131, s72
v_perm_b32 v127, v135, v131, s73
s_waitcnt vmcnt(28)
v_perm_b32 v128, v140, v136, s72
v_perm_b32 v129, v140, v136, s73
v_perm_b32 v130, v141, v137, s72
v_perm_b32 v131, v141, v137, s73
v_perm_b32 v132, v142, v138, s72
v_perm_b32 v133, v142, v138, s73
v_perm_b32 v134, v143, v139, s72
v_perm_b32 v135, v143, v139, s73
s_waitcnt vmcnt(26)
v_perm_b32 v136, v148, v144, s72
v_perm_b32 v137, v148, v144, s73
v_perm_b32 v138, v149, v145, s72
v_perm_b32 v139, v149, v145, s73
v_perm_b32 v140, v150, v146, s72
v_perm_b32 v141, v150, v146, s73
v_perm_b32 v142, v151, v147, s72
v_perm_b32 v143, v151, v147, s73
s_waitcnt vmcnt(24)
v_perm_b32 v144, v156, v152, s72
v_perm_b32 v145, v156, v152, s73
v_perm_b32 v146, v157, v153, s72
v_perm_b32 v147, v157, v153, s73
v_perm_b32 v148, v158, v154, s72
v_perm_b32 v149, v158, v154, s73
v_perm_b32 v150, v159, v155, s72
v_perm_b32 v151, v159, v155, s73
s_waitcnt vmcnt(22)
v_perm_b32 v152, v164, v160, s72
v_perm_b32 v153, v164, v160, s73
v_perm_b32 v154, v165, v161, s72
v_perm_b32 v155, v165, v161, s73
v_perm_b32 v156, v166, v162, s72
v_perm_b32 v157, v166, v162, s73
v_perm_b32 v158, v167, v163, s72
v_perm_b32 v159, v167, v163, s73
s_waitcnt vmcnt(20)
v_perm_b32 v160, v172, v168, s72
v_perm_b32 v161, v172, v168, s73
v_perm_b32 v162, v173, v169, s72
v_perm_b32 v163, v173, v169, s73
v_perm_b32 v164, v174, v170, s72
v_perm_b32 v165, v174, v170, s73
v_perm_b32 v166, v175, v171, s72
v_perm_b32 v167, v175, v171, s73
s_waitcnt vmcnt(18)
v_perm_b32 v168, v180, v176, s72
v_perm_b32 v169, v180, v176, s73
v_perm_b32 v170, v181, v177, s72
v_perm_b32 v171, v181, v177, s73
v_perm_b32 v172, v182, v178, s72
v_perm_b32 v173, v182, v178, s73
v_perm_b32 v174, v183, v179, s72
v_perm_b32 v175, v183, v179, s73
s_waitcnt vmcnt(16)
v_perm_b32 v176, v188, v184, s72
v_perm_b32 v177, v188, v184, s73
v_perm_b32 v178, v189, v185, s72
v_perm_b32 v179, v189, v185, s73
v_perm_b32 v180, v190, v186, s72
v_perm_b32 v181, v190, v186, s73
v_perm_b32 v182, v191, v187, s72
v_perm_b32 v183, v191, v187, s73
s_waitcnt vmcnt(14)
v_perm_b32 v184, v196, v192, s72
v_perm_b32 v185, v196, v192, s73
v_perm_b32 v186, v197, v193, s72
v_perm_b32 v187, v197, v193, s73
v_perm_b32 v188, v198, v194, s72
v_perm_b32 v189, v198, v194, s73
v_perm_b32 v190, v199, v195, s72
v_perm_b32 v191, v199, v195, s73
s_waitcnt vmcnt(12)
v_perm_b32 v192, v204, v200, s72
v_perm_b32 v193, v204, v200, s73
v_perm_b32 v194, v205, v201, s72
v_perm_b32 v195, v205, v201, s73
v_perm_b32 v196, v206, v202, s72
v_perm_b32 v197, v206, v202, s73
v_perm_b32 v198, v207, v203, s72
v_perm_b32 v199, v207, v203, s73
s_waitcnt vmcnt(10)
v_perm_b32 v200, v212, v208, s72
v_perm_b32 v201, v212, v208, s73
v_perm_b32 v202, v213, v209, s72
v_perm_b32 v203, v213, v209, s73
v_perm_b32 v204, v214, v210, s72
v_perm_b32 v205, v214, v210, s73
v_perm_b32 v206, v215, v211, s72
v_perm_b32 v207, v215, v211, s73
s_waitcnt vmcnt(8)
v_perm_b32 v208, v220, v216, s72
v_perm_b32 v209, v220, v216, s73
v_perm_b32 v210, v221, v217, s72
v_perm_b32 v211, v221, v217, s73
v_perm_b32 v212, v222, v218, s72
v_perm_b32 v213, v222, v218, s73
v_perm_b32 v214, v223, v219, s72
v_perm_b32 v215, v223, v219, s73
s_waitcnt vmcnt(6)
v_perm_b32 v216, v228, v224, s72
v_perm_b32 v217, v228, v224, s73
v_perm_b32 v218, v229, v225, s72
v_perm_b32 v219, v229, v225, s73
v_perm_b32 v220, v230, v226, s72
v_perm_b32 v221, v230, v226, s73
v_perm_b32 v222, v231, v227, s72
v_perm_b32 v223, v231, v227, s73
s_waitcnt vmcnt(4)
v_perm_b32 v224, v236, v232, s72
v_perm_b32 v225, v236, v232, s73
v_perm_b32 v226, v237, v233, s72
v_perm_b32 v227, v237, v233, s73
v_perm_b32 v228, v238, v234, s72
v_perm_b32 v229, v238, v234, s73
v_perm_b32 v230, v239, v235, s72
v_perm_b32 v231, v239, v235, s73
s_waitcnt vmcnt(2)
v_perm_b32 v232, v244, v240, s72
v_perm_b32 v233, v244, v240, s73
v_perm_b32 v234, v245, v241, s72
v_perm_b32 v235, v245, v241, s73
v_perm_b32 v236, v246, v242, s72
v_perm_b32 v237, v246, v242, s73
v_perm_b32 v238, v247, v243, s72
v_perm_b32 v239, v247, v243, s73
s_waitcnt vmcnt(0)
v_perm_b32 v240, v252, v248, s72
v_perm_b32 v241, v252, v248, s73
v_perm_b32 v242, v253, v249, s72
v_perm_b32 v243, v253, v249, s73
v_perm_b32 v244, v254, v250, s72
v_perm_b32 v245, v254, v250, s73
v_perm_b32 v246, v255, v251, s72
v_perm_b32 v247, v255, v251, s73
s_branch fnw_53
L_m:
s_setprio 2
v_mov_b32 v6, 0
v_mov_b32 v7, 0
v_lshlrev_b32 v8, 3, v0
ds_write_b64 v8, v[6:7]
s_waitcnt lgkmcnt(0)
s_barrier
s_lshr_b32 s64, s58, 1
s_and_b32 s65, s58, 1
v_and_b32 v1, 3, v0
v_lshlrev_b32 v1, 2, v1
v_and_b32 v2, 4, v1
s_lshl2_add_u32 s35, s58, 0
v_mov_b32 v3, s35
s_mov_b32 s4, s44
s_mov_b32 s5, s45
s_mov_b32 s6, 0x800
s_mov_b32 s7, 0x00020000
v_lshrrev_b32 v6, 4, v0
v_lshlrev_b32 v6, 3, v6
s_lshl_b32 s66, s62, 7
buffer_load_dwordx2 v[232:233], v6, s[4:7], s66 offen offset:0
buffer_load_dwordx2 v[234:235], v6, s[4:7], s66 offen offset:32
buffer_load_dwordx2 v[236:237], v6, s[4:7], s66 offen offset:64
buffer_load_dwordx2 v[238:239], v6, s[4:7], s66 offen offset:96
v_and_b32 v6, 31, v0
v_lshrrev_b32 v7, 5, v0
v_lshlrev_b32 v7, 3, v7
v_sub_u32 v6, v6, v7
v_mov_b32 v7, 0xf149f2ca
v_cmp_le_i32 vcc, 0, v6
s_nop 1
v_cndmask_b32 v216, 0, v7, vcc
v_cmp_le_i32 vcc, 1, v6
s_nop 1
v_cndmask_b32 v217, 0, v7, vcc
v_cmp_le_i32 vcc, 2, v6
s_nop 1
v_cndmask_b32 v218, 0, v7, vcc
v_cmp_le_i32 vcc, 3, v6
s_nop 1
v_cndmask_b32 v219, 0, v7, vcc
v_cmp_le_i32 vcc, 16, v6
s_nop 1
v_cndmask_b32 v220, 0, v7, vcc
v_cmp_le_i32 vcc, 17, v6
s_nop 1
v_cndmask_b32 v221, 0, v7, vcc
v_cmp_le_i32 vcc, 18, v6
s_nop 1
v_cndmask_b32 v222, 0, v7, vcc
v_cmp_le_i32 vcc, 19, v6
s_nop 1
v_cndmask_b32 v223, 0, v7, vcc
v_cmp_le_i32 vcc, 4, v6
s_nop 1
v_cndmask_b32 v224, 0, v7, vcc
v_cmp_le_i32 vcc, 5, v6
s_nop 1
v_cndmask_b32 v225, 0, v7, vcc
v_cmp_le_i32 vcc, 6, v6
s_nop 1
v_cndmask_b32 v226, 0, v7, vcc
v_cmp_le_i32 vcc, 7, v6
s_nop 1
v_cndmask_b32 v227, 0, v7, vcc
v_cmp_le_i32 vcc, 20, v6
s_nop 1
v_cndmask_b32 v228, 0, v7, vcc
v_cmp_le_i32 vcc, 21, v6
s_nop 1
v_cndmask_b32 v229, 0, v7, vcc
v_cmp_le_i32 vcc, 22, v6
s_nop 1
v_cndmask_b32 v230, 0, v7, vcc
v_cmp_le_i32 vcc, 23, v6
s_nop 1
v_cndmask_b32 v231, 0, v7, vcc
v_lshrrev_b32 v6, 2, v0
v_xor_b32 v6, v6, v0
v_and_b32 v6, 4, v6
v_mov_b32 v7, 0x3f803f80
v_cmp_eq_u32 vcc, 0, v6
s_nop 1
v_cndmask_b32 v212, 0, v7, vcc
v_cndmask_b32 v213, 0, v7, vcc
v_cndmask_b32 v214, 0, v7, vcc
v_cndmask_b32 v215, 0, v7, vcc
L_mtop:
v_lshrrev_b32 v10, 4, v0
s_cmp_eq_u32 s63, 0
s_cbranch_scc0 mq_89
v_bfe_u32 v11, v0, 1, 3
v_xor_b32 v11, v11, v10
v_lshlrev_b32 v11, 4, v11
v_and_b32 v12, 15, v0
v_lshl_add_u32 v6, v12, 7, v11
v_xor_b32 v7, 64, v6
s_branch mq_90
mq_89:
v_lshlrev_b32 v6, 4, v0
v_add_u32 v7, 1024, v6
mq_90:
s_lshl_b32 s66, s65, 13
s_add_u32 s66, s66, 86016
v_add_u32 v6, s66, v6
v_add_u32 v7, s66, v7
v_bfe_u32 v11, v0, 2, 2
v_lshl_add_u32 v11, v10, 3, v11
v_bfe_u32 v12, v0, 3, 2
s_lshl_b32 s66, s64, 1
v_xor_b32 v12, s66, v12
v_lshlrev_b32 v12, 5, v12
v_lshl_add_u32 v11, v11, 7, v12
v_and_b32 v12, 3, v0
v_lshl_add_u32 v11, v12, 3, v11
v_add_u32 v8, 102400, v11
v_xor_b32 v9, 32, v8
v_mov_b32 v11, 0xf149f2ca
v_xor_b32 v216, v11, v216
v_xor_b32 v217, v11, v217
v_xor_b32 v218, v11, v218
v_xor_b32 v219, v11, v219
v_xor_b32 v220, v11, v220
v_xor_b32 v221, v11, v221
v_xor_b32 v222, v11, v222
v_xor_b32 v223, v11, v223
v_xor_b32 v224, v11, v224
v_xor_b32 v225, v11, v225
v_xor_b32 v226, v11, v226
v_xor_b32 v227, v11, v227
v_xor_b32 v228, v11, v228
v_xor_b32 v229, v11, v229
v_xor_b32 v230, v11, v230
v_xor_b32 v231, v11, v231
v_mov_b32 v16, 0
v_mov_b32 v17, 0
v_mov_b32 v18, 0
v_mov_b32 v19, 0
v_mov_b32 v20, 0
v_mov_b32 v21, 0
v_mov_b32 v22, 0
v_mov_b32 v23, 0
v_mov_b32 v24, 0
v_mov_b32 v25, 0
v_mov_b32 v26, 0
v_mov_b32 v27, 0
v_mov_b32 v28, 0
v_mov_b32 v29, 0
v_mov_b32 v30, 0
v_mov_b32 v31, 0
v_mov_b32 v32, 0
v_mov_b32 v33, 0
v_mov_b32 v34, 0
v_mov_b32 v35, 0
v_mov_b32 v36, 0
v_mov_b32 v37, 0
v_mov_b32 v38, 0
v_mov_b32 v39, 0
v_mov_b32 v40, 0
v_mov_b32 v41, 0
v_mov_b32 v42, 0
v_mov_b32 v43, 0
v_mov_b32 v44, 0
v_mov_b32 v45, 0
v_mov_b32 v46, 0
v_mov_b32 v47, 0
v_mov_b32 v48, 0
v_mov_b32 v49, 0
v_mov_b32 v50, 0
v_mov_b32 v51, 0
v_mov_b32 v52, 0
v_mov_b32 v53, 0
v_mov_b32 v54, 0
v_mov_b32 v55, 0
v_mov_b32 v56, 0
v_mov_b32 v57, 0
v_mov_b32 v58, 0
v_mov_b32 v59, 0
v_mov_b32 v60, 0
v_mov_b32 v61, 0
v_mov_b32 v62, 0
v_mov_b32 v63, 0
v_mov_b32 v64, 0
v_mov_b32 v65, 0
v_mov_b32 v66, 0
v_mov_b32 v67, 0
v_mov_b32 v68, 0
v_mov_b32 v69, 0
v_mov_b32 v70, 0
v_mov_b32 v71, 0
v_mov_b32 v72, 0
v_mov_b32 v73, 0
v_mov_b32 v74, 0
v_mov_b32 v75, 0
v_mov_b32 v76, 0
v_mov_b32 v77, 0
v_mov_b32 v78, 0
v_mov_b32 v79, 0
v_mov_b32 v80, 0
v_mov_b32 v81, 0
v_mov_b32 v82, 0
v_mov_b32 v83, 0
v_mov_b32 v84, 0
v_mov_b32 v85, 0
v_mov_b32 v86, 0
v_mov_b32 v87, 0
v_mov_b32 v88, 0
v_mov_b32 v89, 0
v_mov_b32 v90, 0
v_mov_b32 v91, 0
v_mov_b32 v92, 0
v_mov_b32 v93, 0
v_mov_b32 v94, 0
v_mov_b32 v95, 0
v_mov_b32 v96, 0
v_mov_b32 v97, 0
v_mov_b32 v98, 0
v_mov_b32 v99, 0
v_mov_b32 v100, 0
v_mov_b32 v101, 0
v_mov_b32 v102, 0
v_mov_b32 v103, 0
v_mov_b32 v104, 0
v_mov_b32 v105, 0
v_mov_b32 v106, 0
v_mov_b32 v107, 0
v_mov_b32 v108, 0
v_mov_b32 v109, 0
v_mov_b32 v110, 0
v_mov_b32 v111, 0
v_mov_b32 v192, 0
v_mov_b32 v193, 0
v_mov_b32 v194, 0
v_mov_b32 v195, 0
v_mov_b32 v196, 0
v_mov_b32 v197, 0
v_mov_b32 v198, 0
v_mov_b32 v199, 0
v_mov_b32 v200, 0
v_mov_b32 v201, 0
v_mov_b32 v202, 0
v_mov_b32 v203, 0
v_mov_b32 v204, 0
v_mov_b32 v205, 0
v_mov_b32 v206, 0
v_mov_b32 v207, 0
v_mov_b32 v208, 0
v_mov_b32 v209, 0
v_mov_b32 v210, 0
v_mov_b32 v211, 0
v_add_u32 v4, s34, 1
s_mov_b32 s66, 16
s_mov_b32 s67, -40960
s_mov_b32 s68, -40960
s_mov_b32 s69, 81920
s_add_u32 s35, s34, 1
lw_91:
ds_read_b32 v5, v2 offset:16
s_waitcnt lgkmcnt(0)
v_cmp_gt_i32 vcc, s35, v5
s_cbranch_vccz lwd_92
s_sub_u32 s32, s32, 1
s_cmp_gt_i32 s32, 0
s_cbranch_scc1 lw_91
lwd_92:
ds_read_b64_tr_b16 v[144:145], v8 offset:8192
ds_read_b64_tr_b16 v[146:147], v8 offset:8704
ds_read_b64_tr_b16 v[148:149], v8 offset:12288
ds_read_b64_tr_b16 v[150:151], v8 offset:12800
ds_read_b128 v[112:115], v6 offset:0
ds_read_b128 v[116:119], v7 offset:0
ds_read_b64_tr_b16 v[152:153], v9 offset:8192
ds_read_b64_tr_b16 v[154:155], v9 offset:8704
ds_read_b64_tr_b16 v[156:157], v9 offset:12288
ds_read_b64_tr_b16 v[158:159], v9 offset:12800
ds_read_b128 v[120:123], v6 offset:2048
ds_read_b128 v[124:127], v7 offset:2048
ds_read_b128 v[128:131], v6 offset:4096
ds_read_b128 v[132:135], v7 offset:4096
ds_read_b128 v[136:139], v6 offset:6144
ds_read_b128 v[140:143], v7 offset:6144
.p2align 6
mqkv_93:
s_waitcnt lgkmcnt(7)
v_mfma_f32_16x16x32_bf16 v[16:19], v[144:147], v[112:115], v[16:19]
ds_read_b64_tr_b16 v[160:161], v8 offset:16384
s_waitcnt lgkmcnt(7)
v_mfma_f32_16x16x32_bf16 v[16:19], v[148:151], v[116:119], v[16:19]
ds_read_b64_tr_b16 v[162:163], v8 offset:16896
v_mfma_f32_16x16x32_bf16 v[20:23], v[152:155], v[112:115], v[20:23]
ds_read_b64_tr_b16 v[164:165], v8 offset:20480
v_mfma_f32_16x16x32_bf16 v[20:23], v[156:159], v[116:119], v[20:23]
ds_read_b64_tr_b16 v[166:167], v8 offset:20992
s_waitcnt lgkmcnt(9)
v_mfma_f32_16x16x32_bf16 v[24:27], v[144:147], v[120:123], v[24:27]
ds_read_b64_tr_b16 v[168:169], v9 offset:16384
s_waitcnt lgkmcnt(9)
v_mfma_f32_16x16x32_bf16 v[24:27], v[148:151], v[124:127], v[24:27]
ds_read_b64_tr_b16 v[170:171], v9 offset:16896
v_mfma_f32_16x16x32_bf16 v[28:31], v[152:155], v[120:123], v[28:31]
ds_read_b64_tr_b16 v[172:173], v9 offset:20480
v_mfma_f32_16x16x32_bf16 v[28:31], v[156:159], v[124:127], v[28:31]
ds_read_b64_tr_b16 v[174:175], v9 offset:20992
s_waitcnt lgkmcnt(11)
v_mfma_f32_16x16x32_bf16 v[32:35], v[144:147], v[128:131], v[32:35]
ds_read_b64_tr_b16 v[176:177], v8 offset:0
s_waitcnt lgkmcnt(11)
v_mfma_f32_16x16x32_bf16 v[32:35], v[148:151], v[132:135], v[32:35]
ds_read_b64_tr_b16 v[178:179], v8 offset:512
v_mfma_f32_16x16x32_bf16 v[36:39], v[152:155], v[128:131], v[36:39]
ds_read_b64_tr_b16 v[180:181], v8 offset:4096
v_mfma_f32_16x16x32_bf16 v[36:39], v[156:159], v[132:135], v[36:39]
ds_read_b64_tr_b16 v[182:183], v8 offset:4608
s_waitcnt lgkmcnt(13)
v_mfma_f32_16x16x32_bf16 v[40:43], v[144:147], v[136:139], v[40:43]
ds_read_b64_tr_b16 v[184:185], v9 offset:0
s_waitcnt lgkmcnt(13)
v_mfma_f32_16x16x32_bf16 v[40:43], v[148:151], v[140:143], v[40:43]
ds_read_b64_tr_b16 v[186:187], v9 offset:512
v_mfma_f32_16x16x32_bf16 v[44:47], v[152:155], v[136:139], v[44:47]
ds_read_b64_tr_b16 v[188:189], v9 offset:4096
v_mfma_f32_16x16x32_bf16 v[44:47], v[156:159], v[140:143], v[44:47]
ds_read_b64_tr_b16 v[190:191], v9 offset:4608
s_waitcnt lgkmcnt(14)
v_mfma_f32_16x16x32_bf16 v[48:51], v[112:115], v[160:163], v[48:51]
s_mov_b64 exec, 1
ds_write_b32 v3, v4
s_mov_b64 exec, -1
s_waitcnt lgkmcnt(13)
v_mfma_f32_16x16x32_bf16 v[48:51], v[116:119], v[164:167], v[48:51]
v_add_u32 v8, s67, v8
v_add_u32 v9, s67, v9
s_waitcnt lgkmcnt(11)
v_mfma_f32_16x16x32_bf16 v[52:55], v[112:115], v[168:171], v[52:55]
v_add_u32 v6, s67, v6
v_add_u32 v7, s67, v7
s_waitcnt lgkmcnt(9)
v_mfma_f32_16x16x32_bf16 v[52:55], v[116:119], v[172:175], v[52:55]
s_mov_b32 s70, s67
s_mov_b32 s67, s68
s_mov_b32 s68, s69
s_mov_b32 s69, s70
v_mfma_f32_16x16x32_bf16 v[56:59], v[120:123], v[160:163], v[56:59]
ds_read_b32 v5, v2 offset:16
v_mfma_f32_16x16x32_bf16 v[56:59], v[124:127], v[164:167], v[56:59]
v_mfma_f32_16x16x32_bf16 v[60:63], v[120:123], v[168:171], v[60:63]
v_mfma_f32_16x16x32_bf16 v[60:63], v[124:127], v[172:175], v[60:63]
v_mfma_f32_16x16x32_bf16 v[64:67], v[128:131], v[160:163], v[64:67]
s_waitcnt lgkmcnt(0)
v_cmp_ge_u32 vcc, v4, v5
s_cbranch_vccnz mspin_94
mback_95:
v_add_u32 v4, 1, v4
v_mfma_f32_16x16x32_bf16 v[64:67], v[132:135], v[164:167], v[64:67]
ds_read_b64_tr_b16 v[144:145], v8 offset:8192
v_mfma_f32_16x16x32_bf16 v[68:71], v[128:131], v[168:171], v[68:71]
ds_read_b64_tr_b16 v[146:147], v8 offset:8704
v_mfma_f32_16x16x32_bf16 v[68:71], v[132:135], v[172:175], v[68:71]
ds_read_b64_tr_b16 v[148:149], v8 offset:12288
v_mfma_f32_16x16x32_bf16 v[72:75], v[136:139], v[160:163], v[72:75]
ds_read_b64_tr_b16 v[150:151], v8 offset:12800
v_mfma_f32_16x16x32_bf16 v[72:75], v[140:143], v[164:167], v[72:75]
ds_read_b64_tr_b16 v[152:153], v9 offset:8192
v_mfma_f32_16x16x32_bf16 v[76:79], v[136:139], v[168:171], v[76:79]
ds_read_b64_tr_b16 v[154:155], v9 offset:8704
v_mfma_f32_16x16x32_bf16 v[76:79], v[140:143], v[172:175], v[76:79]
ds_read_b64_tr_b16 v[156:157], v9 offset:12288
v_mfma_f32_16x16x32_bf16 v[80:83], v[176:179], v[112:115], v[80:83]
ds_read_b64_tr_b16 v[158:159], v9 offset:12800
v_mfma_f32_16x16x32_bf16 v[80:83], v[180:183], v[116:119], v[80:83]
v_mfma_f32_16x16x32_bf16 v[84:87], v[184:187], v[112:115], v[84:87]
v_mfma_f32_16x16x32_bf16 v[84:87], v[188:191], v[116:119], v[84:87]
ds_read_b128 v[112:115], v6 offset:0
ds_read_b128 v[116:119], v7 offset:0
v_mfma_f32_16x16x32_bf16 v[88:91], v[176:179], v[120:123], v[88:91]
v_mfma_f32_16x16x32_bf16 v[88:91], v[180:183], v[124:127], v[88:91]
v_mfma_f32_16x16x32_bf16 v[92:95], v[184:187], v[120:123], v[92:95]
v_mfma_f32_16x16x32_bf16 v[92:95], v[188:191], v[124:127], v[92:95]
ds_read_b128 v[120:123], v6 offset:2048
ds_read_b128 v[124:127], v7 offset:2048
v_mfma_f32_16x16x32_bf16 v[96:99], v[176:179], v[128:131], v[96:99]
v_mfma_f32_16x16x32_bf16 v[96:99], v[180:183], v[132:135], v[96:99]
v_mfma_f32_16x16x32_bf16 v[100:103], v[184:187], v[128:131], v[100:103]
v_mfma_f32_16x16x32_bf16 v[100:103], v[188:191], v[132:135], v[100:103]
ds_read_b128 v[128:131], v6 offset:4096
ds_read_b128 v[132:135], v7 offset:4096
v_mfma_f32_16x16x32_bf16 v[104:107], v[176:179], v[136:139], v[104:107]
v_mfma_f32_16x16x32_bf16 v[104:107], v[180:183], v[140:143], v[104:107]
s_sub_u32 s66, s66, 1
s_cmp_eq_u32 s66, 0
v_mfma_f32_16x16x32_bf16 v[108:111], v[184:187], v[136:139], v[108:111]
v_mfma_f32_16x16x32_bf16 v[108:111], v[188:191], v[140:143], v[108:111]
ds_read_b128 v[136:139], v6 offset:6144
ds_read_b128 v[140:143], v7 offset:6144
s_cbranch_scc0 mqkv_93
v_and_b32 v10, 15, v0
v_lshrrev_b32 v11, 4, v0
s_lshl_b32 s66, s65, 8
s_add_u32 s66, s66, 1280
s_mul_i32 s67, s64, 384
v_lshl_add_u32 v6, v10, 2, s66
v_lshl_add_u32 v7, v11, 4, s66
v_lshl_add_u32 v8, v10, 2, s67
v_lshl_add_u32 v9, v11, 4, s67
v_and_b32 v12, 1, v11
v_lshrrev_b32 v11, 1, v11
v_lshlrev_b32 v11, 9, v11
v_lshl_add_u32 v11, v12, 10, v11
s_lshl_b32 s66, s64, 12
s_lshl_b32 s67, s65, 13
s_add_u32 s66, s66, 131072
s_add_u32 s68, s66, 24576
s_sub_u32 s68, s68, s67
s_add_u32 s67, s66, s67
v_lshl_add_u32 v14, v10, 4, v11
v_and_b32 v12, 3, v0
v_lshl_add_u32 v11, v12, 4, v11
v_bfe_u32 v12, v0, 3, 1
v_lshl_add_u32 v11, v12, 6, v11
v_bfe_u32 v12, v0, 2, 1
v_lshl_add_u32 v12, v12, 8, v11
v_add_u32 v13, s68, v12
v_add_u32 v12, s67, v12
v_add_u32 v15, s68, v14
v_add_u32 v14, s67, v14
s_lshl_b32 s66, s59, 4
s_add_u32 s66, s66, s60
s_lshl_b32 s72, s66, 7
s_lshl_b32 s66, s66, 15
s_lshl_b32 s67, s63, 23
s_add_u32 s66, s66, s67
s_add_u32 s71, s66, 917504
s_add_u32 s35, s34, 2
lw_96:
ds_read_b32 v5, v2 offset:24
s_waitcnt lgkmcnt(0)
v_cmp_gt_i32 vcc, s35, v5
s_cbranch_vccz lwd_97
s_sub_u32 s32, s32, 1
s_cmp_gt_i32 s32, 0
s_cbranch_scc1 lw_96
lwd_97:
v_mov_b32 v10, 0
ds_read_b32 v10, v10 offset:32
ds_read2_b32 v[144:145], v6 offset0:0 offset1:128
ds_read2_b32 v[146:147], v6 offset0:16 offset1:144
ds_read2_b32 v[148:149], v6 offset0:32 offset1:160
ds_read2_b32 v[150:151], v6 offset0:48 offset1:176
ds_read_b128 v[152:155], v9 offset:2432
ds_read_b128 v[156:159], v9 offset:2496
ds_read_b32 v168, v8 offset:2560
ds_read_b32 v169, v8 offset:2624
ds_read_b128 v[112:115], v7 offset:0
ds_read_b128 v[128:131], v7 offset:512
ds_read_b128 v[116:119], v7 offset:64
ds_read_b128 v[132:135], v7 offset:576
s_waitcnt lgkmcnt(12)
v_readfirstlane_b32 s33, v10
s_sub_u32 s33, s33, 1
s_lshr_b32 s66, s33, 7
s_cmp_eq_u32 s66, s59
s_cbranch_scc1 patch_98
pback_99:
s_waitcnt lgkmcnt(11)
v_pk_mul_f32 v[16:17], v[16:17], v[144:145] op_sel:[0,0] op_sel_hi:[1,0]
v_pk_mul_f32 v[18:19], v[18:19], v[144:145] op_sel:[0,0] op_sel_hi:[1,0]
v_pk_mul_f32 v[20:21], v[20:21], v[144:145] op_sel:[0,0] op_sel_hi:[1,0]
v_pk_mul_f32 v[22:23], v[22:23], v[144:145] op_sel:[0,0] op_sel_hi:[1,0]
s_waitcnt lgkmcnt(7)
v_pk_fma_f32 v[16:17], v[152:153], v[144:145], v[16:17] op_sel:[0,1,0] op_sel_hi:[1,1,1]
v_pk_fma_f32 v[18:19], v[154:155], v[144:145], v[18:19] op_sel:[0,1,0] op_sel_hi:[1,1,1]
s_waitcnt lgkmcnt(6)
v_pk_fma_f32 v[20:21], v[156:157], v[144:145], v[20:21] op_sel:[0,1,0] op_sel_hi:[1,1,1]
v_pk_fma_f32 v[22:23], v[158:159], v[144:145], v[22:23] op_sel:[0,1,0] op_sel_hi:[1,1,1]
v_cvt_pk_bf16_f32 v16, v16, v17
v_cvt_pk_bf16_f32 v17, v18, v19
v_cvt_pk_bf16_f32 v18, v20, v21
v_cvt_pk_bf16_f32 v19, v22, v23
buffer_store_dwordx4 v[16:19], v12, s[20:23], s71 offen offset:0 sc1
ds_write_b128 v12, v[16:19] offset:0
ds_read_b128 v[120:123], v7 offset:128
ds_read_b128 v[136:139], v7 offset:640
ds_read_b128 v[124:127], v7 offset:192
ds_read_b128 v[140:143], v7 offset:704
ds_read_b128 v[160:163], v9 offset:2304
ds_read_b128 v[164:167], v9 offset:2368
v_pk_mul_f32 v[24:25], v[24:25], v[146:147] op_sel:[0,0] op_sel_hi:[1,0]
v_pk_mul_f32 v[26:27], v[26:27], v[146:147] op_sel:[0,0] op_sel_hi:[1,0]
v_pk_mul_f32 v[28:29], v[28:29], v[146:147] op_sel:[0,0] op_sel_hi:[1,0]
v_pk_mul_f32 v[30:31], v[30:31], v[146:147] op_sel:[0,0] op_sel_hi:[1,0]
v_pk_fma_f32 v[24:25], v[152:153], v[146:147], v[24:25] op_sel:[0,1,0] op_sel_hi:[1,1,1]
v_pk_fma_f32 v[26:27], v[154:155], v[146:147], v[26:27] op_sel:[0,1,0] op_sel_hi:[1,1,1]
v_pk_fma_f32 v[28:29], v[156:157], v[146:147], v[28:29] op_sel:[0,1,0] op_sel_hi:[1,1,1]
v_pk_fma_f32 v[30:31], v[158:159], v[146:147], v[30:31] op_sel:[0,1,0] op_sel_hi:[1,1,1]
v_cvt_pk_bf16_f32 v24, v24, v25
v_cvt_pk_bf16_f32 v25, v26, v27
v_cvt_pk_bf16_f32 v26, v28, v29
v_cvt_pk_bf16_f32 v27, v30, v31
buffer_store_dwordx4 v[24:27], v12, s[20:23], s71 offen offset:128 sc1
ds_write_b128 v12, v[24:27] offset:128
v_pk_mul_f32 v[32:33], v[32:33], v[148:149] op_sel:[0,0] op_sel_hi:[1,0]
v_pk_mul_f32 v[34:35], v[34:35], v[148:149] op_sel:[0,0] op_sel_hi:[1,0]
v_pk_mul_f32 v[36:37], v[36:37], v[148:149] op_sel:[0,0] op_sel_hi:[1,0]
v_pk_mul_f32 v[38:39], v[38:39], v[148:149] op_sel:[0,0] op_sel_hi:[1,0]
v_pk_fma_f32 v[32:33], v[152:153], v[148:149], v[32:33] op_sel:[0,1,0] op_sel_hi:[1,1,1]
v_pk_fma_f32 v[34:35], v[154:155], v[148:149], v[34:35] op_sel:[0,1,0] op_sel_hi:[1,1,1]
v_pk_fma_f32 v[36:37], v[156:157], v[148:149], v[36:37] op_sel:[0,1,0] op_sel_hi:[1,1,1]
v_pk_fma_f32 v[38:39], v[158:159], v[148:149], v[38:39] op_sel:[0,1,0] op_sel_hi:[1,1,1]
v_cvt_pk_bf16_f32 v32, v32, v33
v_cvt_pk_bf16_f32 v33, v34, v35
v_cvt_pk_bf16_f32 v34, v36, v37
v_cvt_pk_bf16_f32 v35, v38, v39
buffer_store_dwordx4 v[32:35], v13, s[20:23], s71 offen offset:0 sc1
ds_write_b128 v13, v[32:35] offset:0
v_pk_mul_f32 v[40:41], v[40:41], v[150:151] op_sel:[0,0] op_sel_hi:[1,0]
v_pk_mul_f32 v[42:43], v[42:43], v[150:151] op_sel:[0,0] op_sel_hi:[1,0]
v_pk_mul_f32 v[44:45], v[44:45], v[150:151] op_sel:[0,0] op_sel_hi:[1,0]
v_pk_mul_f32 v[46:47], v[46:47], v[150:151] op_sel:[0,0] op_sel_hi:[1,0]
v_pk_fma_f32 v[40:41], v[152:153], v[150:151], v[40:41] op_sel:[0,1,0] op_sel_hi:[1,1,1]
v_pk_fma_f32 v[42:43], v[154:155], v[150:151], v[42:43] op_sel:[0,1,0] op_sel_hi:[1,1,1]
v_pk_fma_f32 v[44:45], v[156:157], v[150:151], v[44:45] op_sel:[0,1,0] op_sel_hi:[1,1,1]
v_pk_fma_f32 v[46:47], v[158:159], v[150:151], v[46:47] op_sel:[0,1,0] op_sel_hi:[1,1,1]
v_cvt_pk_bf16_f32 v40, v40, v41
v_cvt_pk_bf16_f32 v41, v42, v43
v_cvt_pk_bf16_f32 v42, v44, v45
v_cvt_pk_bf16_f32 v43, v46, v47
buffer_store_dwordx4 v[40:43], v13, s[20:23], s71 offen offset:128 sc1
ds_write_b128 v13, v[40:43] offset:128
s_waitcnt lgkmcnt(13)
v_pk_mul_f32 v[48:49], v[48:49], v[112:113]
v_pk_mul_f32 v[50:51], v[50:51], v[114:115]
s_waitcnt lgkmcnt(12)
v_pk_fma_f32 v[48:49], v[128:129], v[168:169], v[48:49] op_sel:[0,0,0] op_sel_hi:[1,0,1]
v_pk_fma_f32 v[50:51], v[130:131], v[168:169], v[50:51] op_sel:[0,0,0] op_sel_hi:[1,0,1]
s_waitcnt lgkmcnt(11)
v_pk_mul_f32 v[56:57], v[56:57], v[116:117]
v_pk_mul_f32 v[58:59], v[58:59], v[118:119]
s_waitcnt lgkmcnt(10)
v_pk_fma_f32 v[56:57], v[132:133], v[168:169], v[56:57] op_sel:[0,0,0] op_sel_hi:[1,0,1]
v_pk_fma_f32 v[58:59], v[134:135], v[168:169], v[58:59] op_sel:[0,0,0] op_sel_hi:[1,0,1]
v_cvt_pk_bf16_f32 v48, v48, v49
v_cvt_pk_bf16_f32 v49, v50, v51
v_cvt_pk_bf16_f32 v50, v56, v57
v_cvt_pk_bf16_f32 v51, v58, v59
buffer_store_dwordx4 v[48:51], v14, s[20:23], s71 offen offset:2048 sc1
ds_write_b128 v14, v[48:51] offset:2048
v_pk_mul_f32 v[52:53], v[52:53], v[112:113]
v_pk_mul_f32 v[54:55], v[54:55], v[114:115]
v_pk_fma_f32 v[52:53], v[128:129], v[168:169], v[52:53] op_sel:[0,1,0] op_sel_hi:[1,1,1]
v_pk_fma_f32 v[54:55], v[130:131], v[168:169], v[54:55] op_sel:[0,1,0] op_sel_hi:[1,1,1]
v_pk_mul_f32 v[60:61], v[60:61], v[116:117]
v_pk_mul_f32 v[62:63], v[62:63], v[118:119]
v_pk_fma_f32 v[60:61], v[132:133], v[168:169], v[60:61] op_sel:[0,1,0] op_sel_hi:[1,1,1]
v_pk_fma_f32 v[62:63], v[134:135], v[168:169], v[62:63] op_sel:[0,1,0] op_sel_hi:[1,1,1]
v_cvt_pk_bf16_f32 v52, v52, v53
v_cvt_pk_bf16_f32 v53, v54, v55
v_cvt_pk_bf16_f32 v54, v60, v61
v_cvt_pk_bf16_f32 v55, v62, v63
buffer_store_dwordx4 v[52:55], v14, s[20:23], s71 offen offset:2304 sc1
ds_write_b128 v14, v[52:55] offset:2304
s_waitcnt lgkmcnt(10)
v_pk_mul_f32 v[64:65], v[64:65], v[120:121]
v_pk_mul_f32 v[66:67], v[66:67], v[122:123]
s_waitcnt lgkmcnt(9)
v_pk_fma_f32 v[64:65], v[136:137], v[168:169], v[64:65] op_sel:[0,0,0] op_sel_hi:[1,0,1]
v_pk_fma_f32 v[66:67], v[138:139], v[168:169], v[66:67] op_sel:[0,0,0] op_sel_hi:[1,0,1]
s_waitcnt lgkmcnt(8)
v_pk_mul_f32 v[72:73], v[72:73], v[124:125]
v_pk_mul_f32 v[74:75], v[74:75], v[126:127]
s_waitcnt lgkmcnt(7)
v_pk_fma_f32 v[72:73], v[140:141], v[168:169], v[72:73] op_sel:[0,0,0] op_sel_hi:[1,0,1]
v_pk_fma_f32 v[74:75], v[142:143], v[168:169], v[74:75] op_sel:[0,0,0] op_sel_hi:[1,0,1]
v_cvt_pk_bf16_f32 v64, v64, v65
v_cvt_pk_bf16_f32 v65, v66, v67
v_cvt_pk_bf16_f32 v66, v72, v73
v_cvt_pk_bf16_f32 v67, v74, v75
buffer_store_dwordx4 v[64:67], v15, s[20:23], s71 offen offset:2048 sc1
ds_write_b128 v15, v[64:67] offset:2048
v_pk_mul_f32 v[68:69], v[68:69], v[120:121]
v_pk_mul_f32 v[70:71], v[70:71], v[122:123]
v_pk_fma_f32 v[68:69], v[136:137], v[168:169], v[68:69] op_sel:[0,1,0] op_sel_hi:[1,1,1]
v_pk_fma_f32 v[70:71], v[138:139], v[168:169], v[70:71] op_sel:[0,1,0] op_sel_hi:[1,1,1]
v_pk_mul_f32 v[76:77], v[76:77], v[124:125]
v_pk_mul_f32 v[78:79], v[78:79], v[126:127]
v_pk_fma_f32 v[76:77], v[140:141], v[168:169], v[76:77] op_sel:[0,1,0] op_sel_hi:[1,1,1]
v_pk_fma_f32 v[78:79], v[142:143], v[168:169], v[78:79] op_sel:[0,1,0] op_sel_hi:[1,1,1]
v_cvt_pk_bf16_f32 v68, v68, v69
v_cvt_pk_bf16_f32 v69, v70, v71
v_cvt_pk_bf16_f32 v70, v76, v77
v_cvt_pk_bf16_f32 v71, v78, v79
buffer_store_dwordx4 v[68:71], v15, s[20:23], s71 offen offset:2304 sc1
ds_write_b128 v15, v[68:71] offset:2304
v_add_u32 v5, s34, 17
s_mov_b64 exec, 1
ds_write_b32 v3, v5
s_mov_b64 exec, -1
s_mov_b32 s66, 0x3e8293ee
v_mul_f32 v144, s66, v144
v_mul_f32 v145, s66, v145
v_mul_f32 v146, s66, v146
v_mul_f32 v147, s66, v147
v_mul_f32 v148, s66, v148
v_mul_f32 v149, s66, v149
v_mul_f32 v150, s66, v150
v_mul_f32 v151, s66, v151
v_pk_mul_f32 v[96:97], v[96:97], v[148:149] op_sel:[0,0] op_sel_hi:[1,0]
v_pk_mul_f32 v[98:99], v[98:99], v[148:149] op_sel:[0,0] op_sel_hi:[1,0]
v_pk_mul_f32 v[100:101], v[100:101], v[148:149] op_sel:[0,0] op_sel_hi:[1,0]
v_pk_mul_f32 v[102:103], v[102:103], v[148:149] op_sel:[0,0] op_sel_hi:[1,0]
s_waitcnt lgkmcnt(9)
v_pk_fma_f32 v[96:97], v[160:161], v[148:149], v[96:97] op_sel:[0,1,0] op_sel_hi:[1,1,1]
v_pk_fma_f32 v[98:99], v[162:163], v[148:149], v[98:99] op_sel:[0,1,0] op_sel_hi:[1,1,1]
s_waitcnt lgkmcnt(8)
v_pk_fma_f32 v[100:101], v[164:165], v[148:149], v[100:101] op_sel:[0,1,0] op_sel_hi:[1,1,1]
v_pk_fma_f32 v[102:103], v[166:167], v[148:149], v[102:103] op_sel:[0,1,0] op_sel_hi:[1,1,1]
v_cvt_pk_bf16_f32 v96, v96, v97
v_cvt_pk_bf16_f32 v97, v98, v99
v_cvt_pk_bf16_f32 v98, v100, v101
v_cvt_pk_bf16_f32 v99, v102, v103
v_pk_mul_f32 v[104:105], v[104:105], v[150:151] op_sel:[0,0] op_sel_hi:[1,0]
v_pk_mul_f32 v[106:107], v[106:107], v[150:151] op_sel:[0,0] op_sel_hi:[1,0]
v_pk_mul_f32 v[108:109], v[108:109], v[150:151] op_sel:[0,0] op_sel_hi:[1,0]
v_pk_mul_f32 v[110:111], v[110:111], v[150:151] op_sel:[0,0] op_sel_hi:[1,0]
v_pk_fma_f32 v[104:105], v[160:161], v[150:151], v[104:105] op_sel:[0,1,0] op_sel_hi:[1,1,1]
v_pk_fma_f32 v[106:107], v[162:163], v[150:151], v[106:107] op_sel:[0,1,0] op_sel_hi:[1,1,1]
v_pk_fma_f32 v[108:109], v[164:165], v[150:151], v[108:109] op_sel:[0,1,0] op_sel_hi:[1,1,1]
v_pk_fma_f32 v[110:111], v[166:167], v[150:151], v[110:111] op_sel:[0,1,0] op_sel_hi:[1,1,1]
v_cvt_pk_bf16_f32 v104, v104, v105
v_cvt_pk_bf16_f32 v105, v106, v107
v_cvt_pk_bf16_f32 v106, v108, v109
v_cvt_pk_bf16_f32 v107, v110, v111
v_pk_mul_f32 v[80:81], v[80:81], v[144:145] op_sel:[0,0] op_sel_hi:[1,0]
v_pk_mul_f32 v[82:83], v[82:83], v[144:145] op_sel:[0,0] op_sel_hi:[1,0]
v_pk_mul_f32 v[84:85], v[84:85], v[144:145] op_sel:[0,0] op_sel_hi:[1,0]
v_pk_mul_f32 v[86:87], v[86:87], v[144:145] op_sel:[0,0] op_sel_hi:[1,0]
v_pk_fma_f32 v[80:81], v[160:161], v[144:145], v[80:81] op_sel:[0,1,0] op_sel_hi:[1,1,1]
v_pk_fma_f32 v[82:83], v[162:163], v[144:145], v[82:83] op_sel:[0,1,0] op_sel_hi:[1,1,1]
v_pk_fma_f32 v[84:85], v[164:165], v[144:145], v[84:85] op_sel:[0,1,0] op_sel_hi:[1,1,1]
v_pk_fma_f32 v[86:87], v[166:167], v[144:145], v[86:87] op_sel:[0,1,0] op_sel_hi:[1,1,1]
v_cvt_pk_bf16_f32 v80, v80, v81
v_cvt_pk_bf16_f32 v81, v82, v83
v_cvt_pk_bf16_f32 v82, v84, v85
v_cvt_pk_bf16_f32 v83, v86, v87
v_pk_mul_f32 v[88:89], v[88:89], v[146:147] op_sel:[0,0] op_sel_hi:[1,0]
v_pk_mul_f32 v[90:91], v[90:91], v[146:147] op_sel:[0,0] op_sel_hi:[1,0]
v_pk_mul_f32 v[92:93], v[92:93], v[146:147] op_sel:[0,0] op_sel_hi:[1,0]
v_pk_mul_f32 v[94:95], v[94:95], v[146:147] op_sel:[0,0] op_sel_hi:[1,0]
v_pk_fma_f32 v[88:89], v[160:161], v[146:147], v[88:89] op_sel:[0,1,0] op_sel_hi:[1,1,1]
v_pk_fma_f32 v[90:91], v[162:163], v[146:147], v[90:91] op_sel:[0,1,0] op_sel_hi:[1,1,1]
v_pk_fma_f32 v[92:93], v[164:165], v[146:147], v[92:93] op_sel:[0,1,0] op_sel_hi:[1,1,1]
v_pk_fma_f32 v[94:95], v[166:167], v[146:147], v[94:95] op_sel:[0,1,0] op_sel_hi:[1,1,1]
v_cvt_pk_bf16_f32 v88, v88, v89
v_cvt_pk_bf16_f32 v89, v90, v91
v_cvt_pk_bf16_f32 v90, v92, v93
v_cvt_pk_bf16_f32 v91, v94, v95
v_permlane16_swap_b32 v96, v104
v_permlane16_swap_b32 v97, v105
v_permlane16_swap_b32 v98, v106
v_permlane16_swap_b32 v99, v107
v_permlane16_swap_b32 v80, v88
v_permlane16_swap_b32 v81, v89
v_permlane16_swap_b32 v82, v90
v_permlane16_swap_b32 v83, v91
s_lshl_b32 s69, s64, 12
v_lshl_add_u32 v6, v0, 4, s69
v_add_u32 v7, 131072, v6
s_lshl_b32 s69, s65, 13
s_add_u32 s66, s69, 131072
s_sub_u32 s69, 147456, s69
v_add_u32 v8, s69, v6
ds_read_b128 v[152:155], v8 offset:8192
ds_read_b128 v[156:159], v8 offset:9216
s_mov_b32 s67, 122880
s_min_u32 s69, s59, 1
s_lshl2_add_u32 s68, s69, s65
s_cmp_ge_u32 s59, 2
s_cselect_b32 s69, s65, 0
s_add_u32 s68, s68, s69
ds_read_b128 v[160:163], v8 offset:10240
ds_read_b128 v[164:167], v8 offset:11264
s_waitcnt lgkmcnt(3)
v_mfma_f32_32x32x16_bf16 v[112:127], v[152:155], v[96:99], v[216:231]
s_waitcnt lgkmcnt(2)
v_mfma_f32_32x32x16_bf16 v[112:127], v[156:159], v[104:107], v[112:127]
s_add_u32 s35, s34, 17
lw_100:
ds_read_b32 v5, v1 offset:0
s_waitcnt lgkmcnt(0)
v_cmp_gt_i32 vcc, s35, v5
s_cbranch_vccz lwd_101
s_sub_u32 s32, s32, 1
s_cmp_gt_i32 s32, 0
s_cbranch_scc1 lw_100
lwd_101:
ds_read_b128 v[152:155], v8 offset:0
ds_read_b128 v[156:159], v8 offset:1024
.p2align 3
s_nop 4
v_exp_f32 v112, v112
v_exp_f32 v113, v113
v_exp_f32 v114, v114
v_exp_f32 v115, v115
v_exp_f32 v116, v116
v_exp_f32 v117, v117
s_waitcnt lgkmcnt(1)
v_mfma_f32_32x32x16_bf16 v[128:143], v[152:155], v[96:99], 0
v_exp_f32 v118, v118
v_exp_f32 v119, v119
v_cvt_pk_bf16_f32 v144, v112, v113
v_cvt_pk_bf16_f32 v145, v114, v115
s_waitcnt lgkmcnt(0)
v_mfma_f32_32x32x16_bf16 v[128:143], v[156:159], v[104:107], v[128:143]
ds_read_b128 v[152:155], v7 offset:8192
ds_read_b128 v[156:159], v7 offset:9216
v_cvt_pk_bf16_f32 v146, v116, v117
v_cvt_pk_bf16_f32 v147, v118, v119
v_exp_f32 v120, v120
v_exp_f32 v121, v121
v_mfma_f32_32x32x16_bf16 v[16:31], v[160:163], v[144:147], 0
ds_read_b128 v[160:163], v8 offset:2048
v_exp_f32 v122, v122
v_exp_f32 v123, v123
v_exp_f32 v124, v124
v_mfma_f32_16x16x32_bf16 v[32:35], v[212:215], v[144:147], 0
s_cmp_eq_u32 s65, 1
v_exp_f32 v125, v125
v_exp_f32 v126, v126
v_exp_f32 v127, v127
v_cvt_pk_bf16_f32 v148, v120, v121
v_cvt_pk_bf16_f32 v149, v122, v123
v_cvt_pk_bf16_f32 v150, v124, v125
v_cvt_pk_bf16_f32 v151, v126, v127
s_cbranch_scc1 at_102
v_exp_f32 v128, v128
v_exp_f32 v129, v129
v_mfma_f32_32x32x16_bf16 v[16:31], v[164:167], v[148:151], v[16:31]
ds_read_b128 v[164:167], v8 offset:3072
v_exp_f32 v130, v130
v_exp_f32 v131, v131
v_exp_f32 v132, v132
v_mfma_f32_16x16x32_bf16 v[32:35], v[212:215], v[148:151], v[32:35]
v_exp_f32 v133, v133
s_waitcnt lgkmcnt(3)
v_mfma_f32_32x32x16_bf16 v[112:127], v[152:155], v[96:99], 0
v_exp_f32 v134, v134
v_exp_f32 v135, v135
v_cvt_pk_bf16_f32 v144, v128, v129
v_cvt_pk_bf16_f32 v145, v130, v131
s_waitcnt lgkmcnt(2)
v_mfma_f32_32x32x16_bf16 v[112:127], v[156:159], v[104:107], v[112:127]
ds_read_b128 v[152:155], v7 offset:0
ds_read_b128 v[156:159], v7 offset:1024
v_cvt_pk_bf16_f32 v146, v132, v133
v_cvt_pk_bf16_f32 v147, v134, v135
v_exp_f32 v136, v136
v_exp_f32 v137, v137
s_waitcnt lgkmcnt(3)
v_mfma_f32_32x32x16_bf16 v[16:31], v[160:163], v[144:147], v[16:31]
ds_read_b128 v[160:163], v7 offset:10240
v_exp_f32 v138, v138
v_exp_f32 v139, v139
v_exp_f32 v140, v140
v_mfma_f32_16x16x32_bf16 v[32:35], v[212:215], v[144:147], v[32:35]
v_exp_f32 v141, v141
v_exp_f32 v142, v142
v_exp_f32 v143, v143
v_cvt_pk_bf16_f32 v148, v136, v137
v_cvt_pk_bf16_f32 v149, v138, v139
v_cvt_pk_bf16_f32 v150, v140, v141
v_cvt_pk_bf16_f32 v151, v142, v143
v_exp_f32 v112, v112
v_exp_f32 v113, v113
s_waitcnt lgkmcnt(3)
v_mfma_f32_32x32x16_bf16 v[16:31], v[164:167], v[148:151], v[16:31]
ds_read_b128 v[164:167], v7 offset:11264
v_exp_f32 v114, v114
v_exp_f32 v115, v115
v_exp_f32 v116, v116
v_mfma_f32_16x16x32_bf16 v[32:35], v[212:215], v[148:151], v[32:35]
v_exp_f32 v117, v117
s_waitcnt lgkmcnt(3)
v_mfma_f32_32x32x16_bf16 v[128:143], v[152:155], v[96:99], 0
v_exp_f32 v118, v118
v_exp_f32 v119, v119
v_cvt_pk_bf16_f32 v144, v112, v113
v_cvt_pk_bf16_f32 v145, v114, v115
s_waitcnt lgkmcnt(2)
v_mfma_f32_32x32x16_bf16 v[128:143], v[156:159], v[104:107], v[128:143]
v_cvt_pk_bf16_f32 v146, v116, v117
v_cvt_pk_bf16_f32 v147, v118, v119
v_exp_f32 v120, v120
v_exp_f32 v121, v121
s_waitcnt lgkmcnt(1)
v_mfma_f32_32x32x16_bf16 v[16:31], v[160:163], v[144:147], v[16:31]
ds_read_b128 v[160:163], v7 offset:2048
v_exp_f32 v122, v122
v_exp_f32 v123, v123
v_exp_f32 v124, v124
v_mfma_f32_16x16x32_bf16 v[32:35], v[212:215], v[144:147], v[32:35]
v_mov_b32 v8, v7
v_exp_f32 v125, v125
v_exp_f32 v126, v126
v_exp_f32 v127, v127
v_cvt_pk_bf16_f32 v148, v120, v121
v_cvt_pk_bf16_f32 v149, v122, v123
v_cvt_pk_bf16_f32 v150, v124, v125
v_cvt_pk_bf16_f32 v151, v126, v127
.p2align 3
at_102:
v_exp_f32 v128, v128
v_exp_f32 v129, v129
s_waitcnt lgkmcnt(1)
v_mfma_f32_32x32x16_bf16 v[16:31], v[164:167], v[148:151], v[16:31]
ds_read_b128 v[164:167], v8 offset:3072
v_exp_f32 v130, v130
v_exp_f32 v131, v131
v_exp_f32 v132, v132
v_mfma_f32_16x16x32_bf16 v[32:35], v[212:215], v[148:151], v[32:35]
v_exp_f32 v133, v133
v_mfma_f32_32x32x16_bf16 v[112:127], v[152:155], v[80:83], v[216:231]
v_exp_f32 v134, v134
v_exp_f32 v135, v135
v_cvt_pk_bf16_f32 v144, v128, v129
v_cvt_pk_bf16_f32 v145, v130, v131
v_mfma_f32_32x32x16_bf16 v[112:127], v[156:159], v[88:91], v[112:127]
s_sub_u32 s66, s66, 8192
s_cmp_eq_u32 s66, s67
s_cbranch_scc1 cross_109
cback_110:
v_add_u32 v8, s66, v6
ds_read_b128 v[152:155], v8 offset:0
ds_read_b128 v[156:159], v8 offset:1024
v_cvt_pk_bf16_f32 v146, v132, v133
v_cvt_pk_bf16_f32 v147, v134, v135
v_exp_f32 v136, v136
v_exp_f32 v137, v137
s_waitcnt lgkmcnt(3)
v_mfma_f32_32x32x16_bf16 v[16:31], v[160:163], v[144:147], v[16:31]
v_exp_f32 v138, v138
v_exp_f32 v139, v139
v_exp_f32 v140, v140
v_mfma_f32_16x16x32_bf16 v[32:35], v[212:215], v[144:147], v[32:35]
s_cmp_eq_u32 s68, 0
v_exp_f32 v141, v141
v_exp_f32 v142, v142
v_exp_f32 v143, v143
v_cvt_pk_bf16_f32 v148, v136, v137
v_cvt_pk_bf16_f32 v149, v138, v139
v_cvt_pk_bf16_f32 v150, v140, v141
v_cvt_pk_bf16_f32 v151, v142, v143
s_cbranch_scc1 at_106
.p2align 3
at_103:
v_exp_f32 v112, v112
v_exp_f32 v113, v113
s_waitcnt lgkmcnt(2)
v_mfma_f32_32x32x16_bf16 v[16:31], v[164:167], v[148:151], v[16:31]
v_exp_f32 v114, v114
v_exp_f32 v115, v115
v_exp_f32 v116, v116
v_mfma_f32_16x16x32_bf16 v[32:35], v[212:215], v[148:151], v[32:35]
v_exp_f32 v117, v117
s_waitcnt lgkmcnt(1)
v_mfma_f32_32x32x16_bf16 v[128:143], v[152:155], v[96:99], 0
v_exp_f32 v118, v118
v_exp_f32 v119, v119
v_cvt_pk_bf16_f32 v144, v112, v113
v_cvt_pk_bf16_f32 v145, v114, v115
s_waitcnt lgkmcnt(0)
v_mfma_f32_32x32x16_bf16 v[128:143], v[156:159], v[104:107], v[128:143]
v_cvt_pk_bf16_f32 v146, v116, v117
v_cvt_pk_bf16_f32 v147, v118, v119
v_exp_f32 v120, v120
v_exp_f32 v121, v121
v_mfma_f32_32x32x16_bf16 v[192:207], v[160:163], v[144:147], v[192:207]
ds_read_b128 v[160:163], v8 offset:2048
v_exp_f32 v122, v122
v_exp_f32 v123, v123
v_exp_f32 v124, v124
v_mfma_f32_16x16x32_bf16 v[208:211], v[212:215], v[144:147], v[208:211]
v_exp_f32 v125, v125
v_exp_f32 v126, v126
v_exp_f32 v127, v127
v_cvt_pk_bf16_f32 v148, v120, v121
v_cvt_pk_bf16_f32 v149, v122, v123
v_cvt_pk_bf16_f32 v150, v124, v125
v_cvt_pk_bf16_f32 v151, v126, v127
v_exp_f32 v128, v128
v_exp_f32 v129, v129
v_mfma_f32_32x32x16_bf16 v[192:207], v[164:167], v[148:151], v[192:207]
ds_read_b128 v[164:167], v8 offset:3072
v_exp_f32 v130, v130
v_exp_f32 v131, v131
v_exp_f32 v132, v132
v_mfma_f32_16x16x32_bf16 v[208:211], v[212:215], v[148:151], v[208:211]
v_exp_f32 v133, v133
v_mfma_f32_32x32x16_bf16 v[112:127], v[152:155], v[80:83], 0
v_exp_f32 v134, v134
v_exp_f32 v135, v135
v_cvt_pk_bf16_f32 v144, v128, v129
v_cvt_pk_bf16_f32 v145, v130, v131
v_mfma_f32_32x32x16_bf16 v[112:127], v[156:159], v[88:91], v[112:127]
s_sub_u32 s66, s66, 8192
s_cmp_eq_u32 s66, s67
s_cbranch_scc1 cross_111
cback_112:
v_add_u32 v8, s66, v6
ds_read_b128 v[152:155], v8 offset:0
ds_read_b128 v[156:159], v8 offset:1024
v_cvt_pk_bf16_f32 v146, v132, v133
v_cvt_pk_bf16_f32 v147, v134, v135
v_exp_f32 v136, v136
v_exp_f32 v137, v137
s_waitcnt lgkmcnt(3)
v_mfma_f32_32x32x16_bf16 v[16:31], v[160:163], v[144:147], v[16:31]
v_exp_f32 v138, v138
v_exp_f32 v139, v139
v_exp_f32 v140, v140
v_mfma_f32_16x16x32_bf16 v[32:35], v[212:215], v[144:147], v[32:35]
s_sub_u32 s68, s68, 1
s_cmp_eq_u32 s68, 0
v_exp_f32 v141, v141
v_exp_f32 v142, v142
v_exp_f32 v143, v143
v_cvt_pk_bf16_f32 v148, v136, v137
v_cvt_pk_bf16_f32 v149, v138, v139
v_cvt_pk_bf16_f32 v150, v140, v141
v_cvt_pk_bf16_f32 v151, v142, v143
s_cbranch_scc0 at_103
s_cmp_lt_u32 s59, 2
s_cbranch_scc1 at_106
.p2align 3
v_exp_f32 v112, v112
v_exp_f32 v113, v113
s_waitcnt lgkmcnt(2)
v_mfma_f32_32x32x16_bf16 v[16:31], v[164:167], v[148:151], v[16:31]
v_exp_f32 v114, v114
v_exp_f32 v115, v115
v_exp_f32 v116, v116
v_mfma_f32_16x16x32_bf16 v[32:35], v[212:215], v[148:151], v[32:35]
v_exp_f32 v117, v117
s_waitcnt lgkmcnt(1)
v_mfma_f32_32x32x16_bf16 v[128:143], v[152:155], v[96:99], v[216:231]
v_exp_f32 v118, v118
v_exp_f32 v119, v119
v_cvt_pk_bf16_f32 v144, v112, v113
v_cvt_pk_bf16_f32 v145, v114, v115
s_waitcnt lgkmcnt(0)
v_mfma_f32_32x32x16_bf16 v[128:143], v[156:159], v[104:107], v[128:143]
v_cvt_pk_bf16_f32 v146, v116, v117
v_cvt_pk_bf16_f32 v147, v118, v119
v_exp_f32 v120, v120
v_exp_f32 v121, v121
v_mfma_f32_32x32x16_bf16 v[192:207], v[160:163], v[144:147], v[192:207]
ds_read_b128 v[160:163], v8 offset:2048
v_exp_f32 v122, v122
v_exp_f32 v123, v123
v_exp_f32 v124, v124
v_mfma_f32_16x16x32_bf16 v[208:211], v[212:215], v[144:147], v[208:211]
v_exp_f32 v125, v125
v_exp_f32 v126, v126
v_exp_f32 v127, v127
v_cvt_pk_bf16_f32 v148, v120, v121
v_cvt_pk_bf16_f32 v149, v122, v123
v_cvt_pk_bf16_f32 v150, v124, v125
v_cvt_pk_bf16_f32 v151, v126, v127
v_exp_f32 v128, v128
v_exp_f32 v129, v129
v_mfma_f32_32x32x16_bf16 v[192:207], v[164:167], v[148:151], v[192:207]
ds_read_b128 v[164:167], v8 offset:3072
v_exp_f32 v130, v130
v_exp_f32 v131, v131
v_exp_f32 v132, v132
v_mfma_f32_16x16x32_bf16 v[208:211], v[212:215], v[148:151], v[208:211]
v_exp_f32 v133, v133
v_mfma_f32_32x32x16_bf16 v[112:127], v[152:155], v[80:83], 0
v_exp_f32 v134, v134
v_exp_f32 v135, v135
v_cvt_pk_bf16_f32 v144, v128, v129
v_cvt_pk_bf16_f32 v145, v130, v131
v_mfma_f32_32x32x16_bf16 v[112:127], v[156:159], v[88:91], v[112:127]
v_subrev_u32 v8, 8192, v8
ds_read_b128 v[152:155], v8 offset:0
ds_read_b128 v[156:159], v8 offset:1024
v_cvt_pk_bf16_f32 v146, v132, v133
v_cvt_pk_bf16_f32 v147, v134, v135
v_exp_f32 v136, v136
v_exp_f32 v137, v137
s_waitcnt lgkmcnt(3)
v_mfma_f32_32x32x16_bf16 v[16:31], v[160:163], v[144:147], v[16:31]
v_exp_f32 v138, v138
v_exp_f32 v139, v139
v_exp_f32 v140, v140
v_mfma_f32_16x16x32_bf16 v[32:35], v[212:215], v[144:147], v[32:35]
s_cmp_eq_u32 s65, 1
v_exp_f32 v141, v141
v_exp_f32 v142, v142
v_exp_f32 v143, v143
v_cvt_pk_bf16_f32 v148, v136, v137
v_cvt_pk_bf16_f32 v149, v138, v139
v_cvt_pk_bf16_f32 v150, v140, v141
v_cvt_pk_bf16_f32 v151, v142, v143
s_cbranch_scc1 at_105
.p2align 3
v_exp_f32 v112, v112
v_exp_f32 v113, v113
s_waitcnt lgkmcnt(2)
v_mfma_f32_32x32x16_bf16 v[16:31], v[164:167], v[148:151], v[16:31]
v_exp_f32 v114, v114
v_exp_f32 v115, v115
v_exp_f32 v116, v116
v_mfma_f32_16x16x32_bf16 v[32:35], v[212:215], v[148:151], v[32:35]
v_exp_f32 v117, v117
s_waitcnt lgkmcnt(1)
v_mfma_f32_32x32x16_bf16 v[128:143], v[152:155], v[80:83], 0
v_exp_f32 v118, v118
v_exp_f32 v119, v119
v_cvt_pk_bf16_f32 v144, v112, v113
v_cvt_pk_bf16_f32 v145, v114, v115
s_waitcnt lgkmcnt(0)
v_mfma_f32_32x32x16_bf16 v[128:143], v[156:159], v[88:91], v[128:143]
v_subrev_u32 v8, 8192, v8
ds_read_b128 v[152:155], v8 offset:0
ds_read_b128 v[156:159], v8 offset:1024
v_cvt_pk_bf16_f32 v146, v116, v117
v_cvt_pk_bf16_f32 v147, v118, v119
v_exp_f32 v120, v120
v_exp_f32 v121, v121
v_mfma_f32_32x32x16_bf16 v[192:207], v[160:163], v[144:147], v[192:207]
ds_read_b128 v[160:163], v8 offset:10240
v_exp_f32 v122, v122
v_exp_f32 v123, v123
v_exp_f32 v124, v124
v_mfma_f32_16x16x32_bf16 v[208:211], v[212:215], v[144:147], v[208:211]
v_exp_f32 v125, v125
v_exp_f32 v126, v126
v_exp_f32 v127, v127
v_cvt_pk_bf16_f32 v148, v120, v121
v_cvt_pk_bf16_f32 v149, v122, v123
v_cvt_pk_bf16_f32 v150, v124, v125
v_cvt_pk_bf16_f32 v151, v126, v127
v_exp_f32 v128, v128
v_exp_f32 v129, v129
v_mfma_f32_32x32x16_bf16 v[192:207], v[164:167], v[148:151], v[192:207]
ds_read_b128 v[164:167], v8 offset:11264
v_exp_f32 v130, v130
v_exp_f32 v131, v131
v_exp_f32 v132, v132
v_mfma_f32_16x16x32_bf16 v[208:211], v[212:215], v[148:151], v[208:211]
v_exp_f32 v133, v133
s_waitcnt lgkmcnt(3)
v_mfma_f32_32x32x16_bf16 v[112:127], v[152:155], v[80:83], 0
v_exp_f32 v134, v134
v_exp_f32 v135, v135
v_cvt_pk_bf16_f32 v144, v128, v129
v_cvt_pk_bf16_f32 v145, v130, v131
s_waitcnt lgkmcnt(2)
v_mfma_f32_32x32x16_bf16 v[112:127], v[156:159], v[88:91], v[112:127]
v_subrev_u32 v8, 8192, v8
ds_read_b128 v[152:155], v8 offset:0
ds_read_b128 v[156:159], v8 offset:1024
v_cvt_pk_bf16_f32 v146, v132, v133
v_cvt_pk_bf16_f32 v147, v134, v135
v_exp_f32 v136, v136
v_exp_f32 v137, v137
s_waitcnt lgkmcnt(3)
v_mfma_f32_32x32x16_bf16 v[192:207], v[160:163], v[144:147], v[192:207]
ds_read_b128 v[160:163], v8 offset:10240
v_exp_f32 v138, v138
v_exp_f32 v139, v139
v_exp_f32 v140, v140
v_mfma_f32_16x16x32_bf16 v[208:211], v[212:215], v[144:147], v[208:211]
v_exp_f32 v141, v141
v_exp_f32 v142, v142
v_exp_f32 v143, v143
v_cvt_pk_bf16_f32 v148, v136, v137
v_cvt_pk_bf16_f32 v149, v138, v139
v_cvt_pk_bf16_f32 v150, v140, v141
v_cvt_pk_bf16_f32 v151, v142, v143
v_exp_f32 v112, v112
v_exp_f32 v113, v113
s_waitcnt lgkmcnt(3)
v_mfma_f32_32x32x16_bf16 v[192:207], v[164:167], v[148:151], v[192:207]
ds_read_b128 v[164:167], v8 offset:11264
v_exp_f32 v114, v114
v_exp_f32 v115, v115
v_exp_f32 v116, v116
v_mfma_f32_16x16x32_bf16 v[208:211], v[212:215], v[148:151], v[208:211]
v_exp_f32 v117, v117
s_waitcnt lgkmcnt(3)
v_mfma_f32_32x32x16_bf16 v[128:143], v[152:155], v[80:83], v[216:231]
v_exp_f32 v118, v118
v_exp_f32 v119, v119
v_cvt_pk_bf16_f32 v144, v112, v113
v_cvt_pk_bf16_f32 v145, v114, v115
s_waitcnt lgkmcnt(2)
v_mfma_f32_32x32x16_bf16 v[128:143], v[156:159], v[88:91], v[128:143]
v_cvt_pk_bf16_f32 v146, v116, v117
v_cvt_pk_bf16_f32 v147, v118, v119
v_exp_f32 v120, v120
v_exp_f32 v121, v121
s_waitcnt lgkmcnt(1)
v_mfma_f32_32x32x16_bf16 v[192:207], v[160:163], v[144:147], v[192:207]
ds_read_b128 v[160:163], v8 offset:2048
v_exp_f32 v122, v122
v_exp_f32 v123, v123
v_exp_f32 v124, v124
v_mfma_f32_16x16x32_bf16 v[208:211], v[212:215], v[144:147], v[208:211]
v_exp_f32 v125, v125
v_exp_f32 v126, v126
v_exp_f32 v127, v127
v_cvt_pk_bf16_f32 v148, v120, v121
v_cvt_pk_bf16_f32 v149, v122, v123
v_cvt_pk_bf16_f32 v150, v124, v125
v_cvt_pk_bf16_f32 v151, v126, v127
s_branch at_107
.p2align 3
at_106:
v_add_u32 v5, s34, 20
s_mov_b64 exec, 1
ds_write_b32 v3, v5
s_mov_b64 exec, -1
v_exp_f32 v112, v112
v_exp_f32 v113, v113
s_waitcnt lgkmcnt(3)
v_mfma_f32_32x32x16_bf16 v[16:31], v[164:167], v[148:151], v[16:31]
v_exp_f32 v114, v114
v_exp_f32 v115, v115
v_exp_f32 v116, v116
v_mfma_f32_16x16x32_bf16 v[32:35], v[212:215], v[148:151], v[32:35]
v_exp_f32 v117, v117
v_exp_f32 v118, v118
v_exp_f32 v119, v119
v_cvt_pk_bf16_f32 v144, v112, v113
v_cvt_pk_bf16_f32 v145, v114, v115
v_cvt_pk_bf16_f32 v146, v116, v117
v_cvt_pk_bf16_f32 v147, v118, v119
v_exp_f32 v120, v120
v_exp_f32 v121, v121
v_mfma_f32_32x32x16_bf16 v[192:207], v[160:163], v[144:147], v[192:207]
v_exp_f32 v122, v122
v_exp_f32 v123, v123
v_exp_f32 v124, v124
v_mfma_f32_16x16x32_bf16 v[208:211], v[212:215], v[144:147], v[208:211]
v_exp_f32 v125, v125
v_exp_f32 v126, v126
v_exp_f32 v127, v127
v_cvt_pk_bf16_f32 v148, v120, v121
v_cvt_pk_bf16_f32 v149, v122, v123
v_cvt_pk_bf16_f32 v150, v124, v125
v_cvt_pk_bf16_f32 v151, v126, v127
s_branch at_108
.p2align 3
at_105:
v_exp_f32 v112, v112
v_exp_f32 v113, v113
s_waitcnt lgkmcnt(2)
v_mfma_f32_32x32x16_bf16 v[16:31], v[164:167], v[148:151], v[16:31]
v_exp_f32 v114, v114
v_exp_f32 v115, v115
v_exp_f32 v116, v116
v_mfma_f32_16x16x32_bf16 v[32:35], v[212:215], v[148:151], v[32:35]
v_exp_f32 v117, v117
s_waitcnt lgkmcnt(1)
v_mfma_f32_32x32x16_bf16 v[128:143], v[152:155], v[80:83], v[216:231]
v_exp_f32 v118, v118
v_exp_f32 v119, v119
v_cvt_pk_bf16_f32 v144, v112, v113
v_cvt_pk_bf16_f32 v145, v114, v115
s_waitcnt lgkmcnt(0)
v_mfma_f32_32x32x16_bf16 v[128:143], v[156:159], v[88:91], v[128:143]
v_cvt_pk_bf16_f32 v146, v116, v117
v_cvt_pk_bf16_f32 v147, v118, v119
v_exp_f32 v120, v120
v_exp_f32 v121, v121
v_mfma_f32_32x32x16_bf16 v[192:207], v[160:163], v[144:147], v[192:207]
ds_read_b128 v[160:163], v8 offset:2048
v_exp_f32 v122, v122
v_exp_f32 v123, v123
v_exp_f32 v124, v124
v_mfma_f32_16x16x32_bf16 v[208:211], v[212:215], v[144:147], v[208:211]
v_exp_f32 v125, v125
v_exp_f32 v126, v126
v_exp_f32 v127, v127
v_cvt_pk_bf16_f32 v148, v120, v121
v_cvt_pk_bf16_f32 v149, v122, v123
v_cvt_pk_bf16_f32 v150, v124, v125
v_cvt_pk_bf16_f32 v151, v126, v127
.p2align 3
at_107:
v_exp_f32 v128, v128
v_exp_f32 v129, v129
s_waitcnt lgkmcnt(1)
v_mfma_f32_32x32x16_bf16 v[192:207], v[164:167], v[148:151], v[192:207]
ds_read_b128 v[164:167], v8 offset:3072
v_exp_f32 v130, v130
v_exp_f32 v131, v131
v_exp_f32 v132, v132
v_mfma_f32_16x16x32_bf16 v[208:211], v[212:215], v[148:151], v[208:211]
v_exp_f32 v133, v133
v_exp_f32 v134, v134
v_exp_f32 v135, v135
v_cvt_pk_bf16_f32 v144, v128, v129
v_cvt_pk_bf16_f32 v145, v130, v131
v_add_u32 v5, s34, 20
s_mov_b64 exec, 1
ds_write_b32 v3, v5
s_mov_b64 exec, -1
v_cvt_pk_bf16_f32 v146, v132, v133
v_cvt_pk_bf16_f32 v147, v134, v135
v_exp_f32 v136, v136
v_exp_f32 v137, v137
s_waitcnt lgkmcnt(2)
v_mfma_f32_32x32x16_bf16 v[192:207], v[160:163], v[144:147], v[192:207]
v_exp_f32 v138, v138
v_exp_f32 v139, v139
v_exp_f32 v140, v140
v_mfma_f32_16x16x32_bf16 v[208:211], v[212:215], v[144:147], v[208:211]
v_exp_f32 v141, v141
v_exp_f32 v142, v142
v_exp_f32 v143, v143
v_cvt_pk_bf16_f32 v148, v136, v137
v_cvt_pk_bf16_f32 v149, v138, v139
v_cvt_pk_bf16_f32 v150, v140, v141
v_cvt_pk_bf16_f32 v151, v142, v143
at_108:
s_lshl_b32 s66, s59, 18
s_lshl_b32 s67, s63, 22
v_mfma_f32_16x16x32_bf16 v[208:211], v[212:215], v[148:151], v[208:211]
s_add_u32 s66, s66, s67
s_lshl1_add_u32 s67, s60, s64
s_waitcnt lgkmcnt(1)
v_mfma_f32_32x32x16_bf16 v[192:207], v[164:167], v[148:151], v[192:207]
s_lshl_b32 s67, s67, 11
s_add_u32 s66, s66, s67
s_lshl_b32 s68, s65, 16
s_add_u32 s67, s66, 18022400
s_sub_u32 s67, s67, s68
s_add_u32 s66, s66, s68
s_add_u32 s66, s66, 17825792
v_lshlrev_b32 v9, 4, v0
v_subrev_u32 v10, 0x2f800000, v32
v_subrev_u32 v11, 0x2f800000, v208
v_max_u32 v10, v10, v11
v_cmp_lt_u32 vcc, 0x20000000, v10
s_cbranch_vccnz slow_113
sback_114:
s_nop 1
v_rcp_f32 v12, v32
s_nop 1
v_pk_mul_f32 v[16:17], v[16:17], v[12:13] op_sel:[0,0] op_sel_hi:[1,0]
v_pk_mul_f32 v[18:19], v[18:19], v[12:13] op_sel:[0,0] op_sel_hi:[1,0]
v_pk_mul_f32 v[20:21], v[20:21], v[12:13] op_sel:[0,0] op_sel_hi:[1,0]
v_pk_mul_f32 v[22:23], v[22:23], v[12:13] op_sel:[0,0] op_sel_hi:[1,0]
v_pk_mul_f32 v[24:25], v[24:25], v[12:13] op_sel:[0,0] op_sel_hi:[1,0]
v_pk_mul_f32 v[26:27], v[26:27], v[12:13] op_sel:[0,0] op_sel_hi:[1,0]
v_pk_mul_f32 v[28:29], v[28:29], v[12:13] op_sel:[0,0] op_sel_hi:[1,0]
v_pk_mul_f32 v[30:31], v[30:31], v[12:13] op_sel:[0,0] op_sel_hi:[1,0]
v_cvt_pk_bf16_f32 v16, v16, v17
v_cvt_pk_bf16_f32 v17, v18, v19
v_cvt_pk_bf16_f32 v18, v20, v21
v_cvt_pk_bf16_f32 v19, v22, v23
v_cvt_pk_bf16_f32 v20, v24, v25
v_cvt_pk_bf16_f32 v21, v26, v27
v_cvt_pk_bf16_f32 v22, v28, v29
v_cvt_pk_bf16_f32 v23, v30, v31
buffer_store_dwordx4 v[16:19], v9, s[20:23], s67 offen offset:0 sc1
buffer_store_dwordx4 v[20:23], v9, s[20:23], s67 offen offset:1024 sc1
v_rcp_f32 v12, v208
s_nop 0
v_pk_mul_f32 v[192:193], v[192:193], v[12:13] op_sel:[0,0] op_sel_hi:[1,0]
v_pk_mul_f32 v[194:195], v[194:195], v[12:13] op_sel:[0,0] op_sel_hi:[1,0]
v_pk_mul_f32 v[196:197], v[196:197], v[12:13] op_sel:[0,0] op_sel_hi:[1,0]
v_pk_mul_f32 v[198:199], v[198:199], v[12:13] op_sel:[0,0] op_sel_hi:[1,0]
v_pk_mul_f32 v[200:201], v[200:201], v[12:13] op_sel:[0,0] op_sel_hi:[1,0]
v_pk_mul_f32 v[202:203], v[202:203], v[12:13] op_sel:[0,0] op_sel_hi:[1,0]
v_pk_mul_f32 v[204:205], v[204:205], v[12:13] op_sel:[0,0] op_sel_hi:[1,0]
v_pk_mul_f32 v[206:207], v[206:207], v[12:13] op_sel:[0,0] op_sel_hi:[1,0]
v_cvt_pk_bf16_f32 v192, v192, v193
v_cvt_pk_bf16_f32 v193, v194, v195
v_cvt_pk_bf16_f32 v194, v196, v197
v_cvt_pk_bf16_f32 v195, v198, v199
v_cvt_pk_bf16_f32 v196, v200, v201
v_cvt_pk_bf16_f32 v197, v202, v203
v_cvt_pk_bf16_f32 v198, v204, v205
v_cvt_pk_bf16_f32 v199, v206, v207
buffer_store_dwordx4 v[192:195], v9, s[20:23], s66 offen offset:0 sc1
buffer_store_dwordx4 v[196:199], v9, s[20:23], s66 offen offset:1024 sc1
v_bfe_u32 v48, v0, 2, 3
v_lshrrev_b32 v49, 5, v0
v_lshl_add_u32 v48, v49, 4, v48
v_lshlrev_b32 v48, 7, v48
v_bfe_u32 v49, v0, 3, 2
v_lshl_add_u32 v48, v49, 5, v48
v_and_b32 v49, 3, v0
v_lshl_add_u32 v48, v49, 3, v48
v_add_u32 v8, 32768, v48
v_xor_b32 v9, 32, v8
v_xor_b32 v10, 64, v8
v_xor_b32 v11, 96, v8
v_add_u32 v12, 0x10000, v8
v_add_u32 v13, 0x10000, v9
v_add_u32 v14, 0x10000, v10
v_add_u32 v15, 0x10000, v11
v_and_b32 v48, 15, v0
v_lshrrev_b32 v49, 4, v0
s_lshl2_add_u32 s66, s61, s58
s_lshl_b32 s67, s66, 16
s_lshl_b32 s68, s63, 22
s_add_u32 s67, s67, s68
s_add_u32 s67, s67, 17825792
v_lshl_add_u32 v6, v48, 4, s67
v_lshl_add_u32 v6, v49, 9, v6
s_add_u32 s70, s72, 327680
s_mov_b64 exec, 1
s_waitcnt vmcnt(0)
buffer_store_dword v212, v3, s[24:27], s70 offen sc1
s_mov_b64 exec, -1
v_add_u32 v5, s34, 21
s_mov_b64 exec, 1
ds_write_b32 v3, v5
s_mov_b64 exec, -1
s_cmp_eq_u32 s63, 0
s_cbranch_scc0 mo_115
v_permlane16_swap_b32 v240, v242
v_permlane16_swap_b32 v241, v243
v_permlane16_swap_b32 v244, v246
v_permlane16_swap_b32 v245, v247
v_permlane16_swap_b32 v248, v250
v_permlane16_swap_b32 v249, v251
v_permlane16_swap_b32 v252, v254
v_permlane16_swap_b32 v253, v255
mo_116:
v_lshlrev_b32 v16, 16, v240
v_and_b32 v17, 0xffff0000, v240
v_lshlrev_b32 v18, 16, v241
v_and_b32 v19, 0xffff0000, v241
v_lshlrev_b32 v20, 16, v242
v_and_b32 v21, 0xffff0000, v242
v_lshlrev_b32 v22, 16, v243
v_and_b32 v23, 0xffff0000, v243
v_lshlrev_b32 v24, 16, v244
v_and_b32 v25, 0xffff0000, v244
v_lshlrev_b32 v26, 16, v245
v_and_b32 v27, 0xffff0000, v245
v_lshlrev_b32 v28, 16, v246
v_and_b32 v29, 0xffff0000, v246
v_lshlrev_b32 v30, 16, v247
v_and_b32 v31, 0xffff0000, v247
v_lshlrev_b32 v32, 16, v248
v_and_b32 v33, 0xffff0000, v248
v_lshlrev_b32 v34, 16, v249
v_and_b32 v35, 0xffff0000, v249
v_lshlrev_b32 v36, 16, v250
v_and_b32 v37, 0xffff0000, v250
v_lshlrev_b32 v38, 16, v251
v_and_b32 v39, 0xffff0000, v251
v_lshlrev_b32 v40, 16, v252
v_and_b32 v41, 0xffff0000, v252
v_lshlrev_b32 v42, 16, v253
v_and_b32 v43, 0xffff0000, v253
v_lshlrev_b32 v44, 16, v254
v_and_b32 v45, 0xffff0000, v254
v_lshlrev_b32 v46, 16, v255
v_and_b32 v47, 0xffff0000, v255
s_add_u32 s66, s61, s62
s_and_b32 s66, s66, 15
s_lshl_b32 s66, s66, 12
s_add_u32 s35, s34, 18
lw_117:
ds_read_b32 v5, v2 offset:16
s_waitcnt lgkmcnt(0)
v_cmp_gt_i32 vcc, s35, v5
s_cbranch_vccz lwd_118
s_sub_u32 s32, s32, 1
s_cmp_gt_i32 s32, 0
s_cbranch_scc1 lw_117
lwd_118:
buffer_load_dwordx4 v[80:83], v6, s[20:23], s66 offen offset:0 sc1
buffer_load_dwordx4 v[88:91], v6, s[20:23], s66 offen offset:2048 sc1
buffer_load_dwordx4 v[84:87], v6, s[20:23], s66 offen offset:256 sc1
buffer_load_dwordx4 v[92:95], v6, s[20:23], s66 offen offset:2304 sc1
s_add_u32 s66, s66, 4096
s_and_b32 s66, s66, 0xffff
ds_read_b64_tr_b16 v[48:49], v8 offset:0
ds_read_b64_tr_b16 v[50:51], v8 offset:1024
ds_read_b64_tr_b16 v[52:53], v8 offset:4096
ds_read_b64_tr_b16 v[54:55], v8 offset:5120
buffer_load_dwordx4 v[96:99], v6, s[20:23], s66 offen offset:0 sc1
buffer_load_dwordx4 v[104:107], v6, s[20:23], s66 offen offset:2048 sc1
buffer_load_dwordx4 v[100:103], v6, s[20:23], s66 offen offset:256 sc1
buffer_load_dwordx4 v[108:111], v6, s[20:23], s66 offen offset:2304 sc1
s_add_u32 s66, s66, 4096
s_and_b32 s66, s66, 0xffff
ds_read_b64_tr_b16 v[56:57], v9 offset:0
ds_read_b64_tr_b16 v[58:59], v9 offset:1024
ds_read_b64_tr_b16 v[60:61], v9 offset:4096
ds_read_b64_tr_b16 v[62:63], v9 offset:5120
buffer_load_dwordx4 v[112:115], v6, s[20:23], s66 offen offset:0 sc1
buffer_load_dwordx4 v[120:123], v6, s[20:23], s66 offen offset:2048 sc1
buffer_load_dwordx4 v[116:119], v6, s[20:23], s66 offen offset:256 sc1
buffer_load_dwordx4 v[124:127], v6, s[20:23], s66 offen offset:2304 sc1
s_add_u32 s66, s66, 4096
s_and_b32 s66, s66, 0xffff
ds_read_b64_tr_b16 v[64:65], v10 offset:0
ds_read_b64_tr_b16 v[66:67], v10 offset:1024
ds_read_b64_tr_b16 v[68:69], v10 offset:4096
ds_read_b64_tr_b16 v[70:71], v10 offset:5120
buffer_load_dwordx4 v[128:131], v6, s[20:23], s66 offen offset:0 sc1
buffer_load_dwordx4 v[136:139], v6, s[20:23], s66 offen offset:2048 sc1
buffer_load_dwordx4 v[132:135], v6, s[20:23], s66 offen offset:256 sc1
buffer_load_dwordx4 v[140:143], v6, s[20:23], s66 offen offset:2304 sc1
s_add_u32 s66, s66, 4096
s_and_b32 s66, s66, 0xffff
buffer_load_dwordx4 v[144:147], v6, s[20:23], s66 offen offset:0 sc1
buffer_load_dwordx4 v[152:155], v6, s[20:23], s66 offen offset:2048 sc1
buffer_load_dwordx4 v[148:151], v6, s[20:23], s66 offen offset:256 sc1
buffer_load_dwordx4 v[156:159], v6, s[20:23], s66 offen offset:2304 sc1
s_add_u32 s66, s66, 4096
s_and_b32 s66, s66, 0xffff
buffer_load_dwordx4 v[160:163], v6, s[20:23], s66 offen offset:0 sc1
buffer_load_dwordx4 v[168:171], v6, s[20:23], s66 offen offset:2048 sc1
buffer_load_dwordx4 v[164:167], v6, s[20:23], s66 offen offset:256 sc1
buffer_load_dwordx4 v[172:175], v6, s[20:23], s66 offen offset:2304 sc1
s_add_u32 s66, s66, 4096
s_and_b32 s66, s66, 0xffff
buffer_load_dwordx4 v[176:179], v6, s[20:23], s66 offen offset:0 sc1
buffer_load_dwordx4 v[184:187], v6, s[20:23], s66 offen offset:2048 sc1
buffer_load_dwordx4 v[180:183], v6, s[20:23], s66 offen offset:256 sc1
buffer_load_dwordx4 v[188:191], v6, s[20:23], s66 offen offset:2304 sc1
s_add_u32 s66, s66, 4096
s_and_b32 s66, s66, 0xffff
buffer_load_dwordx4 v[192:195], v6, s[20:23], s66 offen offset:0 sc1
buffer_load_dwordx4 v[200:203], v6, s[20:23], s66 offen offset:2048 sc1
buffer_load_dwordx4 v[196:199], v6, s[20:23], s66 offen offset:256 sc1
buffer_load_dwordx4 v[204:207], v6, s[20:23], s66 offen offset:2304 sc1
s_add_u32 s66, s66, 4096
s_and_b32 s66, s66, 0xffff
.p2align 3
s_waitcnt vmcnt(31) lgkmcnt(10)
v_mfma_f32_16x16x32_bf16 v[16:19], v[48:51], v[80:83], v[16:19]
ds_read_b64_tr_b16 v[72:73], v11 offset:0
s_waitcnt vmcnt(30) lgkmcnt(9)
v_mfma_f32_16x16x32_bf16 v[16:19], v[52:55], v[88:91], v[16:19]
ds_read_b64_tr_b16 v[74:75], v11 offset:1024
s_waitcnt vmcnt(29)
v_mfma_f32_16x16x32_bf16 v[32:35], v[48:51], v[84:87], v[32:35]
ds_read_b64_tr_b16 v[76:77], v11 offset:4096
s_waitcnt vmcnt(28)
v_mfma_f32_16x16x32_bf16 v[32:35], v[52:55], v[92:95], v[32:35]
ds_read_b64_tr_b16 v[78:79], v11 offset:5120
s_waitcnt lgkmcnt(10)
v_mfma_f32_16x16x32_bf16 v[20:23], v[56:59], v[80:83], v[20:23]
ds_read_b64_tr_b16 v[48:49], v8 offset:8192
s_waitcnt lgkmcnt(9)
v_mfma_f32_16x16x32_bf16 v[20:23], v[60:63], v[88:91], v[20:23]
ds_read_b64_tr_b16 v[50:51], v8 offset:9216
v_mfma_f32_16x16x32_bf16 v[36:39], v[56:59], v[84:87], v[36:39]
ds_read_b64_tr_b16 v[52:53], v8 offset:12288
v_mfma_f32_16x16x32_bf16 v[36:39], v[60:63], v[92:95], v[36:39]
ds_read_b64_tr_b16 v[54:55], v8 offset:13312
s_waitcnt lgkmcnt(10)
v_mfma_f32_16x16x32_bf16 v[24:27], v[64:67], v[80:83], v[24:27]
ds_read_b64_tr_b16 v[56:57], v9 offset:8192
s_waitcnt lgkmcnt(9)
v_mfma_f32_16x16x32_bf16 v[24:27], v[68:71], v[88:91], v[24:27]
ds_read_b64_tr_b16 v[58:59], v9 offset:9216
v_mfma_f32_16x16x32_bf16 v[40:43], v[64:67], v[84:87], v[40:43]
ds_read_b64_tr_b16 v[60:61], v9 offset:12288
v_mfma_f32_16x16x32_bf16 v[40:43], v[68:71], v[92:95], v[40:43]
ds_read_b64_tr_b16 v[62:63], v9 offset:13312
s_waitcnt lgkmcnt(10)
v_mfma_f32_16x16x32_bf16 v[28:31], v[72:75], v[80:83], v[28:31]
ds_read_b64_tr_b16 v[64:65], v10 offset:8192
s_waitcnt lgkmcnt(9)
v_mfma_f32_16x16x32_bf16 v[28:31], v[76:79], v[88:91], v[28:31]
ds_read_b64_tr_b16 v[66:67], v10 offset:9216
v_mfma_f32_16x16x32_bf16 v[44:47], v[72:75], v[84:87], v[44:47]
ds_read_b64_tr_b16 v[68:69], v10 offset:12288
v_mfma_f32_16x16x32_bf16 v[44:47], v[76:79], v[92:95], v[44:47]
ds_read_b64_tr_b16 v[70:71], v10 offset:13312
s_waitcnt vmcnt(27) lgkmcnt(10)
v_mfma_f32_16x16x32_bf16 v[16:19], v[48:51], v[96:99], v[16:19]
ds_read_b64_tr_b16 v[72:73], v11 offset:8192
buffer_load_dwordx4 v[80:83], v6, s[20:23], s66 offen offset:0 sc1
s_waitcnt vmcnt(27) lgkmcnt(9)
v_mfma_f32_16x16x32_bf16 v[16:19], v[52:55], v[104:107], v[16:19]
ds_read_b64_tr_b16 v[74:75], v11 offset:9216
buffer_load_dwordx4 v[88:91], v6, s[20:23], s66 offen offset:2048 sc1
s_waitcnt vmcnt(27)
v_mfma_f32_16x16x32_bf16 v[32:35], v[48:51], v[100:103], v[32:35]
ds_read_b64_tr_b16 v[76:77], v11 offset:12288
buffer_load_dwordx4 v[84:87], v6, s[20:23], s66 offen offset:256 sc1
s_waitcnt vmcnt(27)
v_mfma_f32_16x16x32_bf16 v[32:35], v[52:55], v[108:111], v[32:35]
ds_read_b64_tr_b16 v[78:79], v11 offset:13312
buffer_load_dwordx4 v[92:95], v6, s[20:23], s66 offen offset:2304 sc1
s_waitcnt lgkmcnt(10)
v_mfma_f32_16x16x32_bf16 v[20:23], v[56:59], v[96:99], v[20:23]
ds_read_b64_tr_b16 v[48:49], v8 offset:16384
s_add_u32 s66, s66, 4096
s_and_b32 s66, s66, 0xffff
s_waitcnt lgkmcnt(9)
v_mfma_f32_16x16x32_bf16 v[20:23], v[60:63], v[104:107], v[20:23]
ds_read_b64_tr_b16 v[50:51], v8 offset:17408
v_mfma_f32_16x16x32_bf16 v[36:39], v[56:59], v[100:103], v[36:39]
ds_read_b64_tr_b16 v[52:53], v8 offset:20480
v_mfma_f32_16x16x32_bf16 v[36:39], v[60:63], v[108:111], v[36:39]
ds_read_b64_tr_b16 v[54:55], v8 offset:21504
s_waitcnt lgkmcnt(10)
v_mfma_f32_16x16x32_bf16 v[24:27], v[64:67], v[96:99], v[24:27]
ds_read_b64_tr_b16 v[56:57], v9 offset:16384
s_waitcnt lgkmcnt(9)
v_mfma_f32_16x16x32_bf16 v[24:27], v[68:71], v[104:107], v[24:27]
ds_read_b64_tr_b16 v[58:59], v9 offset:17408
v_mfma_f32_16x16x32_bf16 v[40:43], v[64:67], v[100:103], v[40:43]
ds_read_b64_tr_b16 v[60:61], v9 offset:20480
v_mfma_f32_16x16x32_bf16 v[40:43], v[68:71], v[108:111], v[40:43]
ds_read_b64_tr_b16 v[62:63], v9 offset:21504
s_waitcnt lgkmcnt(10)
v_mfma_f32_16x16x32_bf16 v[28:31], v[72:75], v[96:99], v[28:31]
ds_read_b64_tr_b16 v[64:65], v10 offset:16384
s_waitcnt lgkmcnt(9)
v_mfma_f32_16x16x32_bf16 v[28:31], v[76:79], v[104:107], v[28:31]
ds_read_b64_tr_b16 v[66:67], v10 offset:17408
v_mfma_f32_16x16x32_bf16 v[44:47], v[72:75], v[100:103], v[44:47]
ds_read_b64_tr_b16 v[68:69], v10 offset:20480
v_mfma_f32_16x16x32_bf16 v[44:47], v[76:79], v[108:111], v[44:47]
ds_read_b64_tr_b16 v[70:71], v10 offset:21504
s_waitcnt vmcnt(27) lgkmcnt(10)
v_mfma_f32_16x16x32_bf16 v[16:19], v[48:51], v[112:115], v[16:19]
ds_read_b64_tr_b16 v[72:73], v11 offset:16384
buffer_load_dwordx4 v[96:99], v6, s[20:23], s66 offen offset:0 sc1
s_waitcnt vmcnt(27) lgkmcnt(9)
v_mfma_f32_16x16x32_bf16 v[16:19], v[52:55], v[120:123], v[16:19]
ds_read_b64_tr_b16 v[74:75], v11 offset:17408
buffer_load_dwordx4 v[104:107], v6, s[20:23], s66 offen offset:2048 sc1
s_waitcnt vmcnt(27)
v_mfma_f32_16x16x32_bf16 v[32:35], v[48:51], v[116:119], v[32:35]
ds_read_b64_tr_b16 v[76:77], v11 offset:20480
buffer_load_dwordx4 v[100:103], v6, s[20:23], s66 offen offset:256 sc1
s_waitcnt vmcnt(27)
v_mfma_f32_16x16x32_bf16 v[32:35], v[52:55], v[124:127], v[32:35]
ds_read_b64_tr_b16 v[78:79], v11 offset:21504
buffer_load_dwordx4 v[108:111], v6, s[20:23], s66 offen offset:2304 sc1
s_waitcnt lgkmcnt(10)
v_mfma_f32_16x16x32_bf16 v[20:23], v[56:59], v[112:115], v[20:23]
ds_read_b64_tr_b16 v[48:49], v8 offset:24576
s_add_u32 s66, s66, 4096
s_and_b32 s66, s66, 0xffff
s_waitcnt lgkmcnt(9)
v_mfma_f32_16x16x32_bf16 v[20:23], v[60:63], v[120:123], v[20:23]
ds_read_b64_tr_b16 v[50:51], v8 offset:25600
v_mfma_f32_16x16x32_bf16 v[36:39], v[56:59], v[116:119], v[36:39]
ds_read_b64_tr_b16 v[52:53], v8 offset:28672
v_mfma_f32_16x16x32_bf16 v[36:39], v[60:63], v[124:127], v[36:39]
ds_read_b64_tr_b16 v[54:55], v8 offset:29696
s_waitcnt lgkmcnt(10)
v_mfma_f32_16x16x32_bf16 v[24:27], v[64:67], v[112:115], v[24:27]
ds_read_b64_tr_b16 v[56:57], v9 offset:24576
s_waitcnt lgkmcnt(9)
v_mfma_f32_16x16x32_bf16 v[24:27], v[68:71], v[120:123], v[24:27]
ds_read_b64_tr_b16 v[58:59], v9 offset:25600
v_mfma_f32_16x16x32_bf16 v[40:43], v[64:67], v[116:119], v[40:43]
ds_read_b64_tr_b16 v[60:61], v9 offset:28672
v_mfma_f32_16x16x32_bf16 v[40:43], v[68:71], v[124:127], v[40:43]
ds_read_b64_tr_b16 v[62:63], v9 offset:29696
s_waitcnt lgkmcnt(10)
v_mfma_f32_16x16x32_bf16 v[28:31], v[72:75], v[112:115], v[28:31]
ds_read_b64_tr_b16 v[64:65], v10 offset:24576
s_waitcnt lgkmcnt(9)
v_mfma_f32_16x16x32_bf16 v[28:31], v[76:79], v[120:123], v[28:31]
ds_read_b64_tr_b16 v[66:67], v10 offset:25600
v_mfma_f32_16x16x32_bf16 v[44:47], v[72:75], v[116:119], v[44:47]
ds_read_b64_tr_b16 v[68:69], v10 offset:28672
v_mfma_f32_16x16x32_bf16 v[44:47], v[76:79], v[124:127], v[44:47]
ds_read_b64_tr_b16 v[70:71], v10 offset:29696
s_waitcnt vmcnt(27) lgkmcnt(10)
v_mfma_f32_16x16x32_bf16 v[16:19], v[48:51], v[128:131], v[16:19]
ds_read_b64_tr_b16 v[72:73], v11 offset:24576
buffer_load_dwordx4 v[112:115], v6, s[20:23], s66 offen offset:0 sc1
s_waitcnt vmcnt(27) lgkmcnt(9)
v_mfma_f32_16x16x32_bf16 v[16:19], v[52:55], v[136:139], v[16:19]
ds_read_b64_tr_b16 v[74:75], v11 offset:25600
buffer_load_dwordx4 v[120:123], v6, s[20:23], s66 offen offset:2048 sc1
s_waitcnt vmcnt(27)
v_mfma_f32_16x16x32_bf16 v[32:35], v[48:51], v[132:135], v[32:35]
ds_read_b64_tr_b16 v[76:77], v11 offset:28672
buffer_load_dwordx4 v[116:119], v6, s[20:23], s66 offen offset:256 sc1
s_waitcnt vmcnt(27)
v_mfma_f32_16x16x32_bf16 v[32:35], v[52:55], v[140:143], v[32:35]
ds_read_b64_tr_b16 v[78:79], v11 offset:29696
buffer_load_dwordx4 v[124:127], v6, s[20:23], s66 offen offset:2304 sc1
s_waitcnt lgkmcnt(10)
v_mfma_f32_16x16x32_bf16 v[20:23], v[56:59], v[128:131], v[20:23]
ds_read_b64_tr_b16 v[48:49], v8 offset:32768
s_add_u32 s66, s66, 4096
s_and_b32 s66, s66, 0xffff
s_waitcnt lgkmcnt(9)
v_mfma_f32_16x16x32_bf16 v[20:23], v[60:63], v[136:139], v[20:23]
ds_read_b64_tr_b16 v[50:51], v8 offset:33792
v_mfma_f32_16x16x32_bf16 v[36:39], v[56:59], v[132:135], v[36:39]
ds_read_b64_tr_b16 v[52:53], v8 offset:36864
v_mfma_f32_16x16x32_bf16 v[36:39], v[60:63], v[140:143], v[36:39]
ds_read_b64_tr_b16 v[54:55], v8 offset:37888
s_waitcnt lgkmcnt(10)
v_mfma_f32_16x16x32_bf16 v[24:27], v[64:67], v[128:131], v[24:27]
ds_read_b64_tr_b16 v[56:57], v9 offset:32768
s_waitcnt lgkmcnt(9)
v_mfma_f32_16x16x32_bf16 v[24:27], v[68:71], v[136:139], v[24:27]
ds_read_b64_tr_b16 v[58:59], v9 offset:33792
v_mfma_f32_16x16x32_bf16 v[40:43], v[64:67], v[132:135], v[40:43]
ds_read_b64_tr_b16 v[60:61], v9 offset:36864
v_mfma_f32_16x16x32_bf16 v[40:43], v[68:71], v[140:143], v[40:43]
ds_read_b64_tr_b16 v[62:63], v9 offset:37888
s_waitcnt lgkmcnt(10)
v_mfma_f32_16x16x32_bf16 v[28:31], v[72:75], v[128:131], v[28:31]
ds_read_b64_tr_b16 v[64:65], v10 offset:32768
s_waitcnt lgkmcnt(9)
v_mfma_f32_16x16x32_bf16 v[28:31], v[76:79], v[136:139], v[28:31]
ds_read_b64_tr_b16 v[66:67], v10 offset:33792
v_mfma_f32_16x16x32_bf16 v[44:47], v[72:75], v[132:135], v[44:47]
ds_read_b64_tr_b16 v[68:69], v10 offset:36864
v_mfma_f32_16x16x32_bf16 v[44:47], v[76:79], v[140:143], v[44:47]
ds_read_b64_tr_b16 v[70:71], v10 offset:37888
s_waitcnt vmcnt(27) lgkmcnt(10)
v_mfma_f32_16x16x32_bf16 v[16:19], v[48:51], v[144:147], v[16:19]
ds_read_b64_tr_b16 v[72:73], v11 offset:32768
buffer_load_dwordx4 v[128:131], v6, s[20:23], s66 offen offset:0 sc1
s_waitcnt vmcnt(27) lgkmcnt(9)
v_mfma_f32_16x16x32_bf16 v[16:19], v[52:55], v[152:155], v[16:19]
ds_read_b64_tr_b16 v[74:75], v11 offset:33792
buffer_load_dwordx4 v[136:139], v6, s[20:23], s66 offen offset:2048 sc1
s_waitcnt vmcnt(27)
v_mfma_f32_16x16x32_bf16 v[32:35], v[48:51], v[148:151], v[32:35]
ds_read_b64_tr_b16 v[76:77], v11 offset:36864
buffer_load_dwordx4 v[132:135], v6, s[20:23], s66 offen offset:256 sc1
s_waitcnt vmcnt(27)
v_mfma_f32_16x16x32_bf16 v[32:35], v[52:55], v[156:159], v[32:35]
ds_read_b64_tr_b16 v[78:79], v11 offset:37888
buffer_load_dwordx4 v[140:143], v6, s[20:23], s66 offen offset:2304 sc1
s_waitcnt lgkmcnt(10)
v_mfma_f32_16x16x32_bf16 v[20:23], v[56:59], v[144:147], v[20:23]
ds_read_b64_tr_b16 v[48:49], v8 offset:40960
s_add_u32 s66, s66, 4096
s_and_b32 s66, s66, 0xffff
s_waitcnt lgkmcnt(9)
v_mfma_f32_16x16x32_bf16 v[20:23], v[60:63], v[152:155], v[20:23]
ds_read_b64_tr_b16 v[50:51], v8 offset:41984
v_mfma_f32_16x16x32_bf16 v[36:39], v[56:59], v[148:151], v[36:39]
ds_read_b64_tr_b16 v[52:53], v8 offset:45056
v_mfma_f32_16x16x32_bf16 v[36:39], v[60:63], v[156:159], v[36:39]
ds_read_b64_tr_b16 v[54:55], v8 offset:46080
s_waitcnt lgkmcnt(10)
v_mfma_f32_16x16x32_bf16 v[24:27], v[64:67], v[144:147], v[24:27]
ds_read_b64_tr_b16 v[56:57], v9 offset:40960
s_waitcnt lgkmcnt(9)
v_mfma_f32_16x16x32_bf16 v[24:27], v[68:71], v[152:155], v[24:27]
ds_read_b64_tr_b16 v[58:59], v9 offset:41984
v_mfma_f32_16x16x32_bf16 v[40:43], v[64:67], v[148:151], v[40:43]
ds_read_b64_tr_b16 v[60:61], v9 offset:45056
v_mfma_f32_16x16x32_bf16 v[40:43], v[68:71], v[156:159], v[40:43]
ds_read_b64_tr_b16 v[62:63], v9 offset:46080
s_waitcnt lgkmcnt(10)
v_mfma_f32_16x16x32_bf16 v[28:31], v[72:75], v[144:147], v[28:31]
ds_read_b64_tr_b16 v[64:65], v10 offset:40960
s_waitcnt lgkmcnt(9)
v_mfma_f32_16x16x32_bf16 v[28:31], v[76:79], v[152:155], v[28:31]
ds_read_b64_tr_b16 v[66:67], v10 offset:41984
v_mfma_f32_16x16x32_bf16 v[44:47], v[72:75], v[148:151], v[44:47]
ds_read_b64_tr_b16 v[68:69], v10 offset:45056
v_mfma_f32_16x16x32_bf16 v[44:47], v[76:79], v[156:159], v[44:47]
ds_read_b64_tr_b16 v[70:71], v10 offset:46080
s_waitcnt vmcnt(27) lgkmcnt(10)
v_mfma_f32_16x16x32_bf16 v[16:19], v[48:51], v[160:163], v[16:19]
ds_read_b64_tr_b16 v[72:73], v11 offset:40960
buffer_load_dwordx4 v[144:147], v6, s[20:23], s66 offen offset:0 sc1
s_waitcnt vmcnt(27) lgkmcnt(9)
v_mfma_f32_16x16x32_bf16 v[16:19], v[52:55], v[168:171], v[16:19]
ds_read_b64_tr_b16 v[74:75], v11 offset:41984
buffer_load_dwordx4 v[152:155], v6, s[20:23], s66 offen offset:2048 sc1
s_waitcnt vmcnt(27)
v_mfma_f32_16x16x32_bf16 v[32:35], v[48:51], v[164:167], v[32:35]
ds_read_b64_tr_b16 v[76:77], v11 offset:45056
buffer_load_dwordx4 v[148:151], v6, s[20:23], s66 offen offset:256 sc1
s_waitcnt vmcnt(27)
v_mfma_f32_16x16x32_bf16 v[32:35], v[52:55], v[172:175], v[32:35]
ds_read_b64_tr_b16 v[78:79], v11 offset:46080
buffer_load_dwordx4 v[156:159], v6, s[20:23], s66 offen offset:2304 sc1
s_waitcnt lgkmcnt(10)
v_mfma_f32_16x16x32_bf16 v[20:23], v[56:59], v[160:163], v[20:23]
ds_read_b64_tr_b16 v[48:49], v8 offset:49152
s_add_u32 s66, s66, 4096
s_and_b32 s66, s66, 0xffff
s_waitcnt lgkmcnt(9)
v_mfma_f32_16x16x32_bf16 v[20:23], v[60:63], v[168:171], v[20:23]
ds_read_b64_tr_b16 v[50:51], v8 offset:50176
v_mfma_f32_16x16x32_bf16 v[36:39], v[56:59], v[164:167], v[36:39]
ds_read_b64_tr_b16 v[52:53], v8 offset:53248
v_mfma_f32_16x16x32_bf16 v[36:39], v[60:63], v[172:175], v[36:39]
ds_read_b64_tr_b16 v[54:55], v8 offset:54272
s_waitcnt lgkmcnt(10)
v_mfma_f32_16x16x32_bf16 v[24:27], v[64:67], v[160:163], v[24:27]
ds_read_b64_tr_b16 v[56:57], v9 offset:49152
s_waitcnt lgkmcnt(9)
v_mfma_f32_16x16x32_bf16 v[24:27], v[68:71], v[168:171], v[24:27]
ds_read_b64_tr_b16 v[58:59], v9 offset:50176
v_mfma_f32_16x16x32_bf16 v[40:43], v[64:67], v[164:167], v[40:43]
ds_read_b64_tr_b16 v[60:61], v9 offset:53248
v_mfma_f32_16x16x32_bf16 v[40:43], v[68:71], v[172:175], v[40:43]
ds_read_b64_tr_b16 v[62:63], v9 offset:54272
s_waitcnt lgkmcnt(10)
v_mfma_f32_16x16x32_bf16 v[28:31], v[72:75], v[160:163], v[28:31]
ds_read_b64_tr_b16 v[64:65], v10 offset:49152
s_waitcnt lgkmcnt(9)
v_mfma_f32_16x16x32_bf16 v[28:31], v[76:79], v[168:171], v[28:31]
ds_read_b64_tr_b16 v[66:67], v10 offset:50176
v_mfma_f32_16x16x32_bf16 v[44:47], v[72:75], v[164:167], v[44:47]
ds_read_b64_tr_b16 v[68:69], v10 offset:53248
v_mfma_f32_16x16x32_bf16 v[44:47], v[76:79], v[172:175], v[44:47]
ds_read_b64_tr_b16 v[70:71], v10 offset:54272
s_waitcnt vmcnt(27) lgkmcnt(10)
v_mfma_f32_16x16x32_bf16 v[16:19], v[48:51], v[176:179], v[16:19]
ds_read_b64_tr_b16 v[72:73], v11 offset:49152
buffer_load_dwordx4 v[160:163], v6, s[20:23], s66 offen offset:0 sc1
s_waitcnt vmcnt(27) lgkmcnt(9)
v_mfma_f32_16x16x32_bf16 v[16:19], v[52:55], v[184:187], v[16:19]
ds_read_b64_tr_b16 v[74:75], v11 offset:50176
buffer_load_dwordx4 v[168:171], v6, s[20:23], s66 offen offset:2048 sc1
s_waitcnt vmcnt(27)
v_mfma_f32_16x16x32_bf16 v[32:35], v[48:51], v[180:183], v[32:35]
ds_read_b64_tr_b16 v[76:77], v11 offset:53248
buffer_load_dwordx4 v[164:167], v6, s[20:23], s66 offen offset:256 sc1
s_waitcnt vmcnt(27)
v_mfma_f32_16x16x32_bf16 v[32:35], v[52:55], v[188:191], v[32:35]
ds_read_b64_tr_b16 v[78:79], v11 offset:54272
buffer_load_dwordx4 v[172:175], v6, s[20:23], s66 offen offset:2304 sc1
s_waitcnt lgkmcnt(10)
v_mfma_f32_16x16x32_bf16 v[20:23], v[56:59], v[176:179], v[20:23]
ds_read_b64_tr_b16 v[48:49], v8 offset:57344
s_add_u32 s66, s66, 4096
s_and_b32 s66, s66, 0xffff
s_waitcnt lgkmcnt(9)
v_mfma_f32_16x16x32_bf16 v[20:23], v[60:63], v[184:187], v[20:23]
ds_read_b64_tr_b16 v[50:51], v8 offset:58368
v_mfma_f32_16x16x32_bf16 v[36:39], v[56:59], v[180:183], v[36:39]
ds_read_b64_tr_b16 v[52:53], v8 offset:61440
v_mfma_f32_16x16x32_bf16 v[36:39], v[60:63], v[188:191], v[36:39]
ds_read_b64_tr_b16 v[54:55], v8 offset:62464
s_waitcnt lgkmcnt(10)
v_mfma_f32_16x16x32_bf16 v[24:27], v[64:67], v[176:179], v[24:27]
ds_read_b64_tr_b16 v[56:57], v9 offset:57344
s_waitcnt lgkmcnt(9)
v_mfma_f32_16x16x32_bf16 v[24:27], v[68:71], v[184:187], v[24:27]
ds_read_b64_tr_b16 v[58:59], v9 offset:58368
v_mfma_f32_16x16x32_bf16 v[40:43], v[64:67], v[180:183], v[40:43]
ds_read_b64_tr_b16 v[60:61], v9 offset:61440
v_mfma_f32_16x16x32_bf16 v[40:43], v[68:71], v[188:191], v[40:43]
ds_read_b64_tr_b16 v[62:63], v9 offset:62464
s_waitcnt lgkmcnt(10)
v_mfma_f32_16x16x32_bf16 v[28:31], v[72:75], v[176:179], v[28:31]
ds_read_b64_tr_b16 v[64:65], v10 offset:57344
s_waitcnt lgkmcnt(9)
v_mfma_f32_16x16x32_bf16 v[28:31], v[76:79], v[184:187], v[28:31]
ds_read_b64_tr_b16 v[66:67], v10 offset:58368
v_mfma_f32_16x16x32_bf16 v[44:47], v[72:75], v[180:183], v[44:47]
ds_read_b64_tr_b16 v[68:69], v10 offset:61440
v_mfma_f32_16x16x32_bf16 v[44:47], v[76:79], v[188:191], v[44:47]
ds_read_b64_tr_b16 v[70:71], v10 offset:62464
s_waitcnt vmcnt(27) lgkmcnt(10)
v_mfma_f32_16x16x32_bf16 v[16:19], v[48:51], v[192:195], v[16:19]
ds_read_b64_tr_b16 v[72:73], v11 offset:57344
buffer_load_dwordx4 v[176:179], v6, s[20:23], s66 offen offset:0 sc1
s_waitcnt vmcnt(27) lgkmcnt(9)
v_mfma_f32_16x16x32_bf16 v[16:19], v[52:55], v[200:203], v[16:19]
ds_read_b64_tr_b16 v[74:75], v11 offset:58368
buffer_load_dwordx4 v[184:187], v6, s[20:23], s66 offen offset:2048 sc1
s_waitcnt vmcnt(27)
v_mfma_f32_16x16x32_bf16 v[32:35], v[48:51], v[196:199], v[32:35]
ds_read_b64_tr_b16 v[76:77], v11 offset:61440
buffer_load_dwordx4 v[180:183], v6, s[20:23], s66 offen offset:256 sc1
s_waitcnt vmcnt(27)
v_mfma_f32_16x16x32_bf16 v[32:35], v[52:55], v[204:207], v[32:35]
ds_read_b64_tr_b16 v[78:79], v11 offset:62464
buffer_load_dwordx4 v[188:191], v6, s[20:23], s66 offen offset:2304 sc1
s_waitcnt lgkmcnt(10)
v_mfma_f32_16x16x32_bf16 v[20:23], v[56:59], v[192:195], v[20:23]
ds_read_b64_tr_b16 v[48:49], v12 offset:0
s_add_u32 s66, s66, 4096
s_and_b32 s66, s66, 0xffff
s_waitcnt lgkmcnt(9)
v_mfma_f32_16x16x32_bf16 v[20:23], v[60:63], v[200:203], v[20:23]
ds_read_b64_tr_b16 v[50:51], v12 offset:1024
v_mfma_f32_16x16x32_bf16 v[36:39], v[56:59], v[196:199], v[36:39]
ds_read_b64_tr_b16 v[52:53], v12 offset:4096
v_mfma_f32_16x16x32_bf16 v[36:39], v[60:63], v[204:207], v[36:39]
ds_read_b64_tr_b16 v[54:55], v12 offset:5120
s_waitcnt lgkmcnt(10)
v_mfma_f32_16x16x32_bf16 v[24:27], v[64:67], v[192:195], v[24:27]
ds_read_b64_tr_b16 v[56:57], v13 offset:0
s_waitcnt lgkmcnt(9)
v_mfma_f32_16x16x32_bf16 v[24:27], v[68:71], v[200:203], v[24:27]
ds_read_b64_tr_b16 v[58:59], v13 offset:1024
v_mfma_f32_16x16x32_bf16 v[40:43], v[64:67], v[196:199], v[40:43]
ds_read_b64_tr_b16 v[60:61], v13 offset:4096
v_mfma_f32_16x16x32_bf16 v[40:43], v[68:71], v[204:207], v[40:43]
ds_read_b64_tr_b16 v[62:63], v13 offset:5120
s_waitcnt lgkmcnt(10)
v_mfma_f32_16x16x32_bf16 v[28:31], v[72:75], v[192:195], v[28:31]
ds_read_b64_tr_b16 v[64:65], v14 offset:0
s_waitcnt lgkmcnt(9)
v_mfma_f32_16x16x32_bf16 v[28:31], v[76:79], v[200:203], v[28:31]
ds_read_b64_tr_b16 v[66:67], v14 offset:1024
v_mfma_f32_16x16x32_bf16 v[44:47], v[72:75], v[196:199], v[44:47]
ds_read_b64_tr_b16 v[68:69], v14 offset:4096
v_mfma_f32_16x16x32_bf16 v[44:47], v[76:79], v[204:207], v[44:47]
ds_read_b64_tr_b16 v[70:71], v14 offset:5120
s_waitcnt vmcnt(27) lgkmcnt(10)
v_mfma_f32_16x16x32_bf16 v[16:19], v[48:51], v[80:83], v[16:19]
ds_read_b64_tr_b16 v[72:73], v15 offset:0
buffer_load_dwordx4 v[192:195], v6, s[20:23], s66 offen offset:0 sc1
s_waitcnt vmcnt(27) lgkmcnt(9)
v_mfma_f32_16x16x32_bf16 v[16:19], v[52:55], v[88:91], v[16:19]
ds_read_b64_tr_b16 v[74:75], v15 offset:1024
buffer_load_dwordx4 v[200:203], v6, s[20:23], s66 offen offset:2048 sc1
s_waitcnt vmcnt(27)
v_mfma_f32_16x16x32_bf16 v[32:35], v[48:51], v[84:87], v[32:35]
ds_read_b64_tr_b16 v[76:77], v15 offset:4096
buffer_load_dwordx4 v[196:199], v6, s[20:23], s66 offen offset:256 sc1
s_waitcnt vmcnt(27)
v_mfma_f32_16x16x32_bf16 v[32:35], v[52:55], v[92:95], v[32:35]
ds_read_b64_tr_b16 v[78:79], v15 offset:5120
buffer_load_dwordx4 v[204:207], v6, s[20:23], s66 offen offset:2304 sc1
s_waitcnt lgkmcnt(10)
v_mfma_f32_16x16x32_bf16 v[20:23], v[56:59], v[80:83], v[20:23]
ds_read_b64_tr_b16 v[48:49], v12 offset:8192
s_add_u32 s66, s66, 4096
s_and_b32 s66, s66, 0xffff
s_waitcnt lgkmcnt(9)
v_mfma_f32_16x16x32_bf16 v[20:23], v[60:63], v[88:91], v[20:23]
ds_read_b64_tr_b16 v[50:51], v12 offset:9216
v_mfma_f32_16x16x32_bf16 v[36:39], v[56:59], v[84:87], v[36:39]
ds_read_b64_tr_b16 v[52:53], v12 offset:12288
v_mfma_f32_16x16x32_bf16 v[36:39], v[60:63], v[92:95], v[36:39]
ds_read_b64_tr_b16 v[54:55], v12 offset:13312
s_waitcnt lgkmcnt(10)
v_mfma_f32_16x16x32_bf16 v[24:27], v[64:67], v[80:83], v[24:27]
ds_read_b64_tr_b16 v[56:57], v13 offset:8192
s_waitcnt lgkmcnt(9)
v_mfma_f32_16x16x32_bf16 v[24:27], v[68:71], v[88:91], v[24:27]
ds_read_b64_tr_b16 v[58:59], v13 offset:9216
v_mfma_f32_16x16x32_bf16 v[40:43], v[64:67], v[84:87], v[40:43]
ds_read_b64_tr_b16 v[60:61], v13 offset:12288
v_mfma_f32_16x16x32_bf16 v[40:43], v[68:71], v[92:95], v[40:43]
ds_read_b64_tr_b16 v[62:63], v13 offset:13312
s_waitcnt lgkmcnt(10)
v_mfma_f32_16x16x32_bf16 v[28:31], v[72:75], v[80:83], v[28:31]
ds_read_b64_tr_b16 v[64:65], v14 offset:8192
s_waitcnt lgkmcnt(9)
v_mfma_f32_16x16x32_bf16 v[28:31], v[76:79], v[88:91], v[28:31]
ds_read_b64_tr_b16 v[66:67], v14 offset:9216
v_mfma_f32_16x16x32_bf16 v[44:47], v[72:75], v[84:87], v[44:47]
ds_read_b64_tr_b16 v[68:69], v14 offset:12288
v_mfma_f32_16x16x32_bf16 v[44:47], v[76:79], v[92:95], v[44:47]
ds_read_b64_tr_b16 v[70:71], v14 offset:13312
s_waitcnt vmcnt(27) lgkmcnt(10)
v_mfma_f32_16x16x32_bf16 v[16:19], v[48:51], v[96:99], v[16:19]
ds_read_b64_tr_b16 v[72:73], v15 offset:8192
s_waitcnt vmcnt(26) lgkmcnt(9)
v_mfma_f32_16x16x32_bf16 v[16:19], v[52:55], v[104:107], v[16:19]
ds_read_b64_tr_b16 v[74:75], v15 offset:9216
s_waitcnt vmcnt(25)
v_mfma_f32_16x16x32_bf16 v[32:35], v[48:51], v[100:103], v[32:35]
ds_read_b64_tr_b16 v[76:77], v15 offset:12288
s_waitcnt vmcnt(24)
v_mfma_f32_16x16x32_bf16 v[32:35], v[52:55], v[108:111], v[32:35]
ds_read_b64_tr_b16 v[78:79], v15 offset:13312
s_waitcnt lgkmcnt(10)
v_mfma_f32_16x16x32_bf16 v[20:23], v[56:59], v[96:99], v[20:23]
ds_read_b64_tr_b16 v[48:49], v12 offset:16384
s_waitcnt lgkmcnt(9)
v_mfma_f32_16x16x32_bf16 v[20:23], v[60:63], v[104:107], v[20:23]
ds_read_b64_tr_b16 v[50:51], v12 offset:17408
v_mfma_f32_16x16x32_bf16 v[36:39], v[56:59], v[100:103], v[36:39]
ds_read_b64_tr_b16 v[52:53], v12 offset:20480
v_mfma_f32_16x16x32_bf16 v[36:39], v[60:63], v[108:111], v[36:39]
ds_read_b64_tr_b16 v[54:55], v12 offset:21504
s_waitcnt lgkmcnt(10)
v_mfma_f32_16x16x32_bf16 v[24:27], v[64:67], v[96:99], v[24:27]
ds_read_b64_tr_b16 v[56:57], v13 offset:16384
s_waitcnt lgkmcnt(9)
v_mfma_f32_16x16x32_bf16 v[24:27], v[68:71], v[104:107], v[24:27]
ds_read_b64_tr_b16 v[58:59], v13 offset:17408
v_mfma_f32_16x16x32_bf16 v[40:43], v[64:67], v[100:103], v[40:43]
ds_read_b64_tr_b16 v[60:61], v13 offset:20480
v_mfma_f32_16x16x32_bf16 v[40:43], v[68:71], v[108:111], v[40:43]
ds_read_b64_tr_b16 v[62:63], v13 offset:21504
s_waitcnt lgkmcnt(10)
v_mfma_f32_16x16x32_bf16 v[28:31], v[72:75], v[96:99], v[28:31]
ds_read_b64_tr_b16 v[64:65], v14 offset:16384
s_waitcnt lgkmcnt(9)
v_mfma_f32_16x16x32_bf16 v[28:31], v[76:79], v[104:107], v[28:31]
ds_read_b64_tr_b16 v[66:67], v14 offset:17408
v_mfma_f32_16x16x32_bf16 v[44:47], v[72:75], v[100:103], v[44:47]
ds_read_b64_tr_b16 v[68:69], v14 offset:20480
v_mfma_f32_16x16x32_bf16 v[44:47], v[76:79], v[108:111], v[44:47]
ds_read_b64_tr_b16 v[70:71], v14 offset:21504
s_waitcnt vmcnt(23) lgkmcnt(10)
v_mfma_f32_16x16x32_bf16 v[16:19], v[48:51], v[112:115], v[16:19]
ds_read_b64_tr_b16 v[72:73], v15 offset:16384
s_waitcnt vmcnt(22) lgkmcnt(9)
v_mfma_f32_16x16x32_bf16 v[16:19], v[52:55], v[120:123], v[16:19]
ds_read_b64_tr_b16 v[74:75], v15 offset:17408
s_waitcnt vmcnt(21)
v_mfma_f32_16x16x32_bf16 v[32:35], v[48:51], v[116:119], v[32:35]
ds_read_b64_tr_b16 v[76:77], v15 offset:20480
s_waitcnt vmcnt(20)
v_mfma_f32_16x16x32_bf16 v[32:35], v[52:55], v[124:127], v[32:35]
ds_read_b64_tr_b16 v[78:79], v15 offset:21504
s_waitcnt lgkmcnt(10)
v_mfma_f32_16x16x32_bf16 v[20:23], v[56:59], v[112:115], v[20:23]
ds_read_b64_tr_b16 v[48:49], v12 offset:24576
s_waitcnt lgkmcnt(9)
v_mfma_f32_16x16x32_bf16 v[20:23], v[60:63], v[120:123], v[20:23]
ds_read_b64_tr_b16 v[50:51], v12 offset:25600
v_mfma_f32_16x16x32_bf16 v[36:39], v[56:59], v[116:119], v[36:39]
ds_read_b64_tr_b16 v[52:53], v12 offset:28672
v_mfma_f32_16x16x32_bf16 v[36:39], v[60:63], v[124:127], v[36:39]
ds_read_b64_tr_b16 v[54:55], v12 offset:29696
s_waitcnt lgkmcnt(10)
v_mfma_f32_16x16x32_bf16 v[24:27], v[64:67], v[112:115], v[24:27]
ds_read_b64_tr_b16 v[56:57], v13 offset:24576
s_waitcnt lgkmcnt(9)
v_mfma_f32_16x16x32_bf16 v[24:27], v[68:71], v[120:123], v[24:27]
ds_read_b64_tr_b16 v[58:59], v13 offset:25600
v_mfma_f32_16x16x32_bf16 v[40:43], v[64:67], v[116:119], v[40:43]
ds_read_b64_tr_b16 v[60:61], v13 offset:28672
v_mfma_f32_16x16x32_bf16 v[40:43], v[68:71], v[124:127], v[40:43]
ds_read_b64_tr_b16 v[62:63], v13 offset:29696
s_waitcnt lgkmcnt(10)
v_mfma_f32_16x16x32_bf16 v[28:31], v[72:75], v[112:115], v[28:31]
ds_read_b64_tr_b16 v[64:65], v14 offset:24576
s_waitcnt lgkmcnt(9)
v_mfma_f32_16x16x32_bf16 v[28:31], v[76:79], v[120:123], v[28:31]
ds_read_b64_tr_b16 v[66:67], v14 offset:25600
v_mfma_f32_16x16x32_bf16 v[44:47], v[72:75], v[116:119], v[44:47]
ds_read_b64_tr_b16 v[68:69], v14 offset:28672
v_mfma_f32_16x16x32_bf16 v[44:47], v[76:79], v[124:127], v[44:47]
ds_read_b64_tr_b16 v[70:71], v14 offset:29696
s_waitcnt vmcnt(19) lgkmcnt(10)
v_mfma_f32_16x16x32_bf16 v[16:19], v[48:51], v[128:131], v[16:19]
ds_read_b64_tr_b16 v[72:73], v15 offset:24576
s_waitcnt vmcnt(18) lgkmcnt(9)
v_mfma_f32_16x16x32_bf16 v[16:19], v[52:55], v[136:139], v[16:19]
ds_read_b64_tr_b16 v[74:75], v15 offset:25600
s_waitcnt vmcnt(17)
v_mfma_f32_16x16x32_bf16 v[32:35], v[48:51], v[132:135], v[32:35]
ds_read_b64_tr_b16 v[76:77], v15 offset:28672
s_waitcnt vmcnt(16)
v_mfma_f32_16x16x32_bf16 v[32:35], v[52:55], v[140:143], v[32:35]
ds_read_b64_tr_b16 v[78:79], v15 offset:29696
s_waitcnt lgkmcnt(10)
v_mfma_f32_16x16x32_bf16 v[20:23], v[56:59], v[128:131], v[20:23]
ds_read_b64_tr_b16 v[48:49], v12 offset:32768
s_waitcnt lgkmcnt(9)
v_mfma_f32_16x16x32_bf16 v[20:23], v[60:63], v[136:139], v[20:23]
ds_read_b64_tr_b16 v[50:51], v12 offset:33792
v_mfma_f32_16x16x32_bf16 v[36:39], v[56:59], v[132:135], v[36:39]
ds_read_b64_tr_b16 v[52:53], v12 offset:36864
v_mfma_f32_16x16x32_bf16 v[36:39], v[60:63], v[140:143], v[36:39]
ds_read_b64_tr_b16 v[54:55], v12 offset:37888
s_waitcnt lgkmcnt(10)
v_mfma_f32_16x16x32_bf16 v[24:27], v[64:67], v[128:131], v[24:27]
ds_read_b64_tr_b16 v[56:57], v13 offset:32768
s_waitcnt lgkmcnt(9)
v_mfma_f32_16x16x32_bf16 v[24:27], v[68:71], v[136:139], v[24:27]
ds_read_b64_tr_b16 v[58:59], v13 offset:33792
v_mfma_f32_16x16x32_bf16 v[40:43], v[64:67], v[132:135], v[40:43]
ds_read_b64_tr_b16 v[60:61], v13 offset:36864
v_mfma_f32_16x16x32_bf16 v[40:43], v[68:71], v[140:143], v[40:43]
ds_read_b64_tr_b16 v[62:63], v13 offset:37888
s_waitcnt lgkmcnt(10)
v_mfma_f32_16x16x32_bf16 v[28:31], v[72:75], v[128:131], v[28:31]
ds_read_b64_tr_b16 v[64:65], v14 offset:32768
s_waitcnt lgkmcnt(9)
v_mfma_f32_16x16x32_bf16 v[28:31], v[76:79], v[136:139], v[28:31]
ds_read_b64_tr_b16 v[66:67], v14 offset:33792
v_mfma_f32_16x16x32_bf16 v[44:47], v[72:75], v[132:135], v[44:47]
ds_read_b64_tr_b16 v[68:69], v14 offset:36864
v_mfma_f32_16x16x32_bf16 v[44:47], v[76:79], v[140:143], v[44:47]
ds_read_b64_tr_b16 v[70:71], v14 offset:37888
s_waitcnt vmcnt(15) lgkmcnt(10)
v_mfma_f32_16x16x32_bf16 v[16:19], v[48:51], v[144:147], v[16:19]
ds_read_b64_tr_b16 v[72:73], v15 offset:32768
s_waitcnt vmcnt(14) lgkmcnt(9)
v_mfma_f32_16x16x32_bf16 v[16:19], v[52:55], v[152:155], v[16:19]
ds_read_b64_tr_b16 v[74:75], v15 offset:33792
s_waitcnt vmcnt(13)
v_mfma_f32_16x16x32_bf16 v[32:35], v[48:51], v[148:151], v[32:35]
ds_read_b64_tr_b16 v[76:77], v15 offset:36864
s_waitcnt vmcnt(12)
v_mfma_f32_16x16x32_bf16 v[32:35], v[52:55], v[156:159], v[32:35]
ds_read_b64_tr_b16 v[78:79], v15 offset:37888
s_waitcnt lgkmcnt(10)
v_mfma_f32_16x16x32_bf16 v[20:23], v[56:59], v[144:147], v[20:23]
ds_read_b64_tr_b16 v[48:49], v12 offset:40960
s_waitcnt lgkmcnt(9)
v_mfma_f32_16x16x32_bf16 v[20:23], v[60:63], v[152:155], v[20:23]
ds_read_b64_tr_b16 v[50:51], v12 offset:41984
v_mfma_f32_16x16x32_bf16 v[36:39], v[56:59], v[148:151], v[36:39]
ds_read_b64_tr_b16 v[52:53], v12 offset:45056
v_mfma_f32_16x16x32_bf16 v[36:39], v[60:63], v[156:159], v[36:39]
ds_read_b64_tr_b16 v[54:55], v12 offset:46080
s_waitcnt lgkmcnt(10)
v_mfma_f32_16x16x32_bf16 v[24:27], v[64:67], v[144:147], v[24:27]
ds_read_b64_tr_b16 v[56:57], v13 offset:40960
s_waitcnt lgkmcnt(9)
v_mfma_f32_16x16x32_bf16 v[24:27], v[68:71], v[152:155], v[24:27]
ds_read_b64_tr_b16 v[58:59], v13 offset:41984
v_mfma_f32_16x16x32_bf16 v[40:43], v[64:67], v[148:151], v[40:43]
ds_read_b64_tr_b16 v[60:61], v13 offset:45056
v_mfma_f32_16x16x32_bf16 v[40:43], v[68:71], v[156:159], v[40:43]
ds_read_b64_tr_b16 v[62:63], v13 offset:46080
s_waitcnt lgkmcnt(10)
v_mfma_f32_16x16x32_bf16 v[28:31], v[72:75], v[144:147], v[28:31]
ds_read_b64_tr_b16 v[64:65], v14 offset:40960
s_waitcnt lgkmcnt(9)
v_mfma_f32_16x16x32_bf16 v[28:31], v[76:79], v[152:155], v[28:31]
ds_read_b64_tr_b16 v[66:67], v14 offset:41984
v_mfma_f32_16x16x32_bf16 v[44:47], v[72:75], v[148:151], v[44:47]
ds_read_b64_tr_b16 v[68:69], v14 offset:45056
v_mfma_f32_16x16x32_bf16 v[44:47], v[76:79], v[156:159], v[44:47]
ds_read_b64_tr_b16 v[70:71], v14 offset:46080
s_waitcnt vmcnt(11) lgkmcnt(10)
v_mfma_f32_16x16x32_bf16 v[16:19], v[48:51], v[160:163], v[16:19]
ds_read_b64_tr_b16 v[72:73], v15 offset:40960
s_waitcnt vmcnt(10) lgkmcnt(9)
v_mfma_f32_16x16x32_bf16 v[16:19], v[52:55], v[168:171], v[16:19]
ds_read_b64_tr_b16 v[74:75], v15 offset:41984
s_waitcnt vmcnt(9)
v_mfma_f32_16x16x32_bf16 v[32:35], v[48:51], v[164:167], v[32:35]
ds_read_b64_tr_b16 v[76:77], v15 offset:45056
s_waitcnt vmcnt(8)
v_mfma_f32_16x16x32_bf16 v[32:35], v[52:55], v[172:175], v[32:35]
ds_read_b64_tr_b16 v[78:79], v15 offset:46080
s_waitcnt lgkmcnt(10)
v_mfma_f32_16x16x32_bf16 v[20:23], v[56:59], v[160:163], v[20:23]
ds_read_b64_tr_b16 v[48:49], v12 offset:49152
s_waitcnt lgkmcnt(9)
v_mfma_f32_16x16x32_bf16 v[20:23], v[60:63], v[168:171], v[20:23]
ds_read_b64_tr_b16 v[50:51], v12 offset:50176
v_mfma_f32_16x16x32_bf16 v[36:39], v[56:59], v[164:167], v[36:39]
ds_read_b64_tr_b16 v[52:53], v12 offset:53248
v_mfma_f32_16x16x32_bf16 v[36:39], v[60:63], v[172:175], v[36:39]
ds_read_b64_tr_b16 v[54:55], v12 offset:54272
s_waitcnt lgkmcnt(10)
v_mfma_f32_16x16x32_bf16 v[24:27], v[64:67], v[160:163], v[24:27]
ds_read_b64_tr_b16 v[56:57], v13 offset:49152
s_waitcnt lgkmcnt(9)
v_mfma_f32_16x16x32_bf16 v[24:27], v[68:71], v[168:171], v[24:27]
ds_read_b64_tr_b16 v[58:59], v13 offset:50176
v_mfma_f32_16x16x32_bf16 v[40:43], v[64:67], v[164:167], v[40:43]
ds_read_b64_tr_b16 v[60:61], v13 offset:53248
v_mfma_f32_16x16x32_bf16 v[40:43], v[68:71], v[172:175], v[40:43]
ds_read_b64_tr_b16 v[62:63], v13 offset:54272
s_waitcnt lgkmcnt(10)
v_mfma_f32_16x16x32_bf16 v[28:31], v[72:75], v[160:163], v[28:31]
ds_read_b64_tr_b16 v[64:65], v14 offset:49152
s_waitcnt lgkmcnt(9)
v_mfma_f32_16x16x32_bf16 v[28:31], v[76:79], v[168:171], v[28:31]
ds_read_b64_tr_b16 v[66:67], v14 offset:50176
v_mfma_f32_16x16x32_bf16 v[44:47], v[72:75], v[164:167], v[44:47]
ds_read_b64_tr_b16 v[68:69], v14 offset:53248
v_mfma_f32_16x16x32_bf16 v[44:47], v[76:79], v[172:175], v[44:47]
ds_read_b64_tr_b16 v[70:71], v14 offset:54272
s_waitcnt vmcnt(7) lgkmcnt(10)
v_mfma_f32_16x16x32_bf16 v[16:19], v[48:51], v[176:179], v[16:19]
ds_read_b64_tr_b16 v[72:73], v15 offset:49152
s_waitcnt vmcnt(6) lgkmcnt(9)
v_mfma_f32_16x16x32_bf16 v[16:19], v[52:55], v[184:187], v[16:19]
ds_read_b64_tr_b16 v[74:75], v15 offset:50176
s_waitcnt vmcnt(5)
v_mfma_f32_16x16x32_bf16 v[32:35], v[48:51], v[180:183], v[32:35]
ds_read_b64_tr_b16 v[76:77], v15 offset:53248
s_waitcnt vmcnt(4)
v_mfma_f32_16x16x32_bf16 v[32:35], v[52:55], v[188:191], v[32:35]
ds_read_b64_tr_b16 v[78:79], v15 offset:54272
s_waitcnt lgkmcnt(10)
v_mfma_f32_16x16x32_bf16 v[20:23], v[56:59], v[176:179], v[20:23]
ds_read_b64_tr_b16 v[48:49], v12 offset:57344
s_waitcnt lgkmcnt(9)
v_mfma_f32_16x16x32_bf16 v[20:23], v[60:63], v[184:187], v[20:23]
ds_read_b64_tr_b16 v[50:51], v12 offset:58368
v_mfma_f32_16x16x32_bf16 v[36:39], v[56:59], v[180:183], v[36:39]
ds_read_b64_tr_b16 v[52:53], v12 offset:61440
v_mfma_f32_16x16x32_bf16 v[36:39], v[60:63], v[188:191], v[36:39]
ds_read_b64_tr_b16 v[54:55], v12 offset:62464
s_waitcnt lgkmcnt(10)
v_mfma_f32_16x16x32_bf16 v[24:27], v[64:67], v[176:179], v[24:27]
ds_read_b64_tr_b16 v[56:57], v13 offset:57344
s_waitcnt lgkmcnt(9)
v_mfma_f32_16x16x32_bf16 v[24:27], v[68:71], v[184:187], v[24:27]
ds_read_b64_tr_b16 v[58:59], v13 offset:58368
v_mfma_f32_16x16x32_bf16 v[40:43], v[64:67], v[180:183], v[40:43]
ds_read_b64_tr_b16 v[60:61], v13 offset:61440
v_mfma_f32_16x16x32_bf16 v[40:43], v[68:71], v[188:191], v[40:43]
ds_read_b64_tr_b16 v[62:63], v13 offset:62464
s_waitcnt lgkmcnt(10)
v_mfma_f32_16x16x32_bf16 v[28:31], v[72:75], v[176:179], v[28:31]
ds_read_b64_tr_b16 v[64:65], v14 offset:57344
s_waitcnt lgkmcnt(9)
v_mfma_f32_16x16x32_bf16 v[28:31], v[76:79], v[184:187], v[28:31]
ds_read_b64_tr_b16 v[66:67], v14 offset:58368
v_mfma_f32_16x16x32_bf16 v[44:47], v[72:75], v[180:183], v[44:47]
ds_read_b64_tr_b16 v[68:69], v14 offset:61440
v_mfma_f32_16x16x32_bf16 v[44:47], v[76:79], v[188:191], v[44:47]
ds_read_b64_tr_b16 v[70:71], v14 offset:62464
s_waitcnt vmcnt(3) lgkmcnt(10)
v_mfma_f32_16x16x32_bf16 v[16:19], v[48:51], v[192:195], v[16:19]
ds_read_b64_tr_b16 v[72:73], v15 offset:57344
s_waitcnt vmcnt(2) lgkmcnt(9)
v_mfma_f32_16x16x32_bf16 v[16:19], v[52:55], v[200:203], v[16:19]
ds_read_b64_tr_b16 v[74:75], v15 offset:58368
s_waitcnt vmcnt(1)
v_mfma_f32_16x16x32_bf16 v[32:35], v[48:51], v[196:199], v[32:35]
ds_read_b64_tr_b16 v[76:77], v15 offset:61440
s_waitcnt vmcnt(0)
v_mfma_f32_16x16x32_bf16 v[32:35], v[52:55], v[204:207], v[32:35]
ds_read_b64_tr_b16 v[78:79], v15 offset:62464
s_waitcnt lgkmcnt(10)
v_mfma_f32_16x16x32_bf16 v[20:23], v[56:59], v[192:195], v[20:23]
v_add_u32 v5, s34, 22
s_mov_b64 exec, 1
ds_write_b32 v3, v5
s_mov_b64 exec, -1
s_waitcnt lgkmcnt(9)
v_mfma_f32_16x16x32_bf16 v[20:23], v[60:63], v[200:203], v[20:23]
v_mfma_f32_16x16x32_bf16 v[36:39], v[56:59], v[196:199], v[36:39]
v_mfma_f32_16x16x32_bf16 v[36:39], v[60:63], v[204:207], v[36:39]
s_waitcnt lgkmcnt(7)
v_mfma_f32_16x16x32_bf16 v[24:27], v[64:67], v[192:195], v[24:27]
s_waitcnt lgkmcnt(5)
v_mfma_f32_16x16x32_bf16 v[24:27], v[68:71], v[200:203], v[24:27]
v_mfma_f32_16x16x32_bf16 v[40:43], v[64:67], v[196:199], v[40:43]
v_mfma_f32_16x16x32_bf16 v[40:43], v[68:71], v[204:207], v[40:43]
s_waitcnt lgkmcnt(3)
v_mfma_f32_16x16x32_bf16 v[28:31], v[72:75], v[192:195], v[28:31]
s_waitcnt lgkmcnt(1)
v_mfma_f32_16x16x32_bf16 v[28:31], v[76:79], v[200:203], v[28:31]
v_mfma_f32_16x16x32_bf16 v[44:47], v[72:75], v[196:199], v[44:47]
v_mfma_f32_16x16x32_bf16 v[44:47], v[76:79], v[204:207], v[44:47]
s_lshl2_add_u32 s73, s61, s58
s_lshl4_add_u32 s66, s61, s62
s_lshl2_add_u32 s68, s66, s58
s_lshl_b32 s68, s68, 12
s_add_u32 s68, s68, 26214400
s_lshl_b32 s66, s66, 7
s_add_u32 s66, s66, 2883584
s_lshl_b32 s74, s73, 13
s_add_u32 s74, s74, 393216
s_lshl_b32 s67, s62, 9
s_add_u32 s67, s67, s74
v_lshlrev_b32 v6, 4, v0
s_mov_b32 s69, 0x3f803f80
v_mov_b32 v8, 0
v_mov_b32 v9, 0
v_mov_b32 v10, 0
v_mov_b32 v11, 0
v_mov_b32 v12, 0
v_mov_b32 v13, 0
v_mov_b32 v14, 0
v_dot2c_f32_bf16 v11, s69, v232
v_dot2c_f32_bf16 v11, s69, v233
v_dot2c_f32_bf16 v11, s69, v234
v_dot2c_f32_bf16 v11, s69, v235
v_dot2c_f32_bf16 v11, s69, v236
v_dot2c_f32_bf16 v11, s69, v237
v_dot2c_f32_bf16 v11, s69, v238
v_dot2c_f32_bf16 v11, s69, v239
s_cmp_eq_u32 s63, 0
v_cvt_pk_bf16_f32 v240, v16, v17
v_cvt_pk_bf16_f32 v241, v18, v19
v_cvt_pk_bf16_f32 v242, v20, v21
v_cvt_pk_bf16_f32 v243, v22, v23
v_cvt_pk_bf16_f32 v244, v24, v25
v_cvt_pk_bf16_f32 v245, v26, v27
v_cvt_pk_bf16_f32 v246, v28, v29
v_cvt_pk_bf16_f32 v247, v30, v31
v_cvt_pk_bf16_f32 v248, v32, v33
v_cvt_pk_bf16_f32 v249, v34, v35
v_cvt_pk_bf16_f32 v250, v36, v37
v_cvt_pk_bf16_f32 v251, v38, v39
v_cvt_pk_bf16_f32 v252, v40, v41
v_cvt_pk_bf16_f32 v253, v42, v43
v_cvt_pk_bf16_f32 v254, v44, v45
v_cvt_pk_bf16_f32 v255, v46, v47
s_cselect_b64 exec, -1, 0
buffer_store_dwordx4 v[240:243], v6, s[20:23], s68 offen offset:0 sc1
buffer_store_dwordx4 v[244:247], v6, s[20:23], s68 offen offset:1024 sc1
buffer_store_dwordx4 v[248:251], v6, s[20:23], s68 offen offset:2048 sc1
buffer_store_dwordx4 v[252:255], v6, s[20:23], s68 offen offset:3072 sc1
s_mov_b64 exec, -1
v_dot2c_f32_bf16 v8, s69, v240
v_dot2c_f32_bf16 v9, v240, v240
v_dot2c_f32_bf16 v10, v232, v240
v_dot2c_f32_bf16 v12, s69, v248
v_dot2c_f32_bf16 v13, v248, v248
v_dot2c_f32_bf16 v14, v232, v248
v_dot2c_f32_bf16 v8, s69, v241
v_dot2c_f32_bf16 v9, v241, v241
v_dot2c_f32_bf16 v10, v233, v241
v_dot2c_f32_bf16 v12, s69, v249
v_dot2c_f32_bf16 v13, v249, v249
v_dot2c_f32_bf16 v14, v233, v249
v_dot2c_f32_bf16 v8, s69, v242
v_dot2c_f32_bf16 v9, v242, v242
v_dot2c_f32_bf16 v10, v234, v242
v_dot2c_f32_bf16 v12, s69, v250
v_dot2c_f32_bf16 v13, v250, v250
v_dot2c_f32_bf16 v14, v234, v250
v_dot2c_f32_bf16 v8, s69, v243
v_dot2c_f32_bf16 v9, v243, v243
v_dot2c_f32_bf16 v10, v235, v243
v_dot2c_f32_bf16 v12, s69, v251
v_dot2c_f32_bf16 v13, v251, v251
v_dot2c_f32_bf16 v14, v235, v251
v_dot2c_f32_bf16 v8, s69, v244
v_dot2c_f32_bf16 v9, v244, v244
v_dot2c_f32_bf16 v10, v236, v244
v_dot2c_f32_bf16 v12, s69, v252
v_dot2c_f32_bf16 v13, v252, v252
v_dot2c_f32_bf16 v14, v236, v252
v_dot2c_f32_bf16 v8, s69, v245
v_dot2c_f32_bf16 v9, v245, v245
v_dot2c_f32_bf16 v10, v237, v245
v_dot2c_f32_bf16 v12, s69, v253
v_dot2c_f32_bf16 v13, v253, v253
v_dot2c_f32_bf16 v14, v237, v253
v_dot2c_f32_bf16 v8, s69, v246
v_dot2c_f32_bf16 v9, v246, v246
v_dot2c_f32_bf16 v10, v238, v246
v_dot2c_f32_bf16 v12, s69, v254
v_dot2c_f32_bf16 v13, v254, v254
v_dot2c_f32_bf16 v14, v238, v254
v_dot2c_f32_bf16 v8, s69, v247
v_dot2c_f32_bf16 v9, v247, v247
v_dot2c_f32_bf16 v10, v239, v247
v_dot2c_f32_bf16 v12, s69, v255
v_dot2c_f32_bf16 v13, v255, v255
v_dot2c_f32_bf16 v14, v239, v255
v_mov_b32 v15, v11
v_lshrrev_b32 v7, 5, v0
v_mul_u32_u24 v7, 3584, v7
v_permlane16_swap_b32 v8, v12
v_permlane16_swap_b32 v9, v13
v_permlane16_swap_b32 v10, v14
v_permlane16_swap_b32 v11, v15
v_pk_add_f32 v[8:9], v[8:9], v[12:13]
v_pk_add_f32 v[10:11], v[10:11], v[14:15]
v_mov_b32 v12, v8
v_mov_b32 v13, v9
v_mov_b32 v14, v10
v_mov_b32 v15, v11
v_permlane32_swap_b32 v12, v8
v_permlane32_swap_b32 v13, v9
v_permlane32_swap_b32 v14, v10
v_permlane32_swap_b32 v15, v11
v_pk_add_f32 v[8:9], v[8:9], v[12:13]
v_pk_add_f32 v[10:11], v[10:11], v[14:15]
v_add_u32 v7, v6, v7
v_max_u32 v8, 1, v8
v_max_u32 v9, 1, v9
v_max_u32 v10, 1, v10
v_max_u32 v11, 1, v11
s_mov_b32 exec_hi, 0
buffer_store_dwordx4 v[8:11], v6, s[24:27], s67 offen sc1
s_mov_b32 exec_hi, -1
v_lshlrev_b32 v16, 16, v240
v_and_b32 v17, 0xffff0000, v240
v_lshlrev_b32 v18, 16, v241
v_and_b32 v19, 0xffff0000, v241
v_lshlrev_b32 v20, 16, v242
v_and_b32 v21, 0xffff0000, v242
v_lshlrev_b32 v22, 16, v243
v_and_b32 v23, 0xffff0000, v243
v_lshlrev_b32 v24, 16, v244
v_and_b32 v25, 0xffff0000, v244
v_lshlrev_b32 v26, 16, v245
v_and_b32 v27, 0xffff0000, v245
v_lshlrev_b32 v28, 16, v246
v_and_b32 v29, 0xffff0000, v246
v_lshlrev_b32 v30, 16, v247
v_and_b32 v31, 0xffff0000, v247
v_lshlrev_b32 v32, 16, v248
v_and_b32 v33, 0xffff0000, v248
v_lshlrev_b32 v34, 16, v249
v_and_b32 v35, 0xffff0000, v249
v_lshlrev_b32 v36, 16, v250
v_and_b32 v37, 0xffff0000, v250
v_lshlrev_b32 v38, 16, v251
v_and_b32 v39, 0xffff0000, v251
v_lshlrev_b32 v40, 16, v252
v_and_b32 v41, 0xffff0000, v252
v_lshlrev_b32 v42, 16, v253
v_and_b32 v43, 0xffff0000, v253
v_lshlrev_b32 v44, 16, v254
v_and_b32 v45, 0xffff0000, v254
v_lshlrev_b32 v46, 16, v255
v_and_b32 v47, 0xffff0000, v255
v_and_b32 v14, 15, v0
v_lshlrev_b32 v14, 11, v14
v_bfe_u32 v15, v0, 4, 1
v_lshl_add_u32 v14, v15, 5, v14
v_lshrrev_b32 v15, 5, v0
v_lshl_add_u32 v14, v15, 4, v14
s_lshl2_add_u32 s70, s61, s58
s_lshl_b32 s70, s70, 16
s_lshl_b32 s71, s62, 7
s_add_u32 s70, s70, s71
s_add_u32 s71, s70, 0x8000
s_lshl4_add_u32 s68, s61, s62
s_lshl_b32 s68, s68, 8
s_add_u32 s69, s68, 2818048
s_add_u32 s68, s68, 2752512
s_lshl_b32 s75, s73, 5
s_add_u32 s75, s75, 1
v_and_b32 v15, 48, v0
v_add_u32 v13, s75, v0
s_mov_b64 exec, 1
s_waitcnt vmcnt(1)
buffer_store_dword v212, v3, s[24:27], s66 offen sc1
s_mov_b64 exec, -1
v_add_u32 v5, s34, 23
s_mov_b64 exec, 1
ds_write_b32 v3, v5
s_mov_b64 exec, -1
s_waitcnt vmcnt(1)
poll_119:
buffer_load_dwordx4 v[80:83], v7, s[24:27], s74 offen offset:0 sc1
buffer_load_dwordx4 v[84:87], v7, s[24:27], s74 offen offset:512 sc1
buffer_load_dwordx4 v[88:91], v7, s[24:27], s74 offen offset:1024 sc1
buffer_load_dwordx4 v[92:95], v7, s[24:27], s74 offen offset:1536 sc1
buffer_load_dwordx4 v[96:99], v7, s[24:27], s74 offen offset:2048 sc1
buffer_load_dwordx4 v[100:103], v7, s[24:27], s74 offen offset:2560 sc1
buffer_load_dwordx4 v[104:107], v7, s[24:27], s74 offen offset:3072 sc1
buffer_load_dwordx4 v[108:111], v7, s[24:27], s74 offen offset:3584 sc1
pchk_120:
s_waitcnt vmcnt(7)
v_min3_u32 v8, v80, v81, v82
s_waitcnt vmcnt(6)
v_min3_u32 v8, v8, v83, v84
v_min3_u32 v8, v8, v85, v86
s_waitcnt vmcnt(5)
v_min3_u32 v8, v8, v87, v88
v_min3_u32 v8, v8, v89, v90
s_waitcnt vmcnt(4)
v_min3_u32 v8, v8, v91, v92
v_min3_u32 v8, v8, v93, v94
s_waitcnt vmcnt(3)
v_min3_u32 v8, v8, v95, v96
v_min3_u32 v8, v8, v97, v98
s_waitcnt vmcnt(2)
v_min3_u32 v8, v8, v99, v100
v_min3_u32 v8, v8, v101, v102
s_waitcnt vmcnt(1)
v_min3_u32 v8, v8, v103, v104
v_min3_u32 v8, v8, v105, v106
s_waitcnt vmcnt(0)
v_min3_u32 v8, v8, v107, v108
v_min3_u32 v8, v8, v109, v110
v_min_u32 v8, v8, v111
v_cmp_eq_u32 vcc, 0, v8
s_cbranch_vccz pdone_121
s_sub_u32 s32, s32, 1
s_cmp_gt_i32 s32, 0
s_cbranch_scc1 poll_119
pdone_121:
v_pk_add_f32 v[80:81], v[80:81], v[96:97]
v_pk_add_f32 v[82:83], v[82:83], v[98:99]
v_pk_add_f32 v[84:85], v[84:85], v[100:101]
v_pk_add_f32 v[86:87], v[86:87], v[102:103]
v_pk_add_f32 v[88:89], v[88:89], v[104:105]
v_pk_add_f32 v[90:91], v[90:91], v[106:107]
v_pk_add_f32 v[92:93], v[92:93], v[108:109]
v_pk_add_f32 v[94:95], v[94:95], v[110:111]
v_pk_add_f32 v[80:81], v[80:81], v[88:89]
v_pk_add_f32 v[82:83], v[82:83], v[90:91]
v_pk_add_f32 v[84:85], v[84:85], v[92:93]
v_pk_add_f32 v[86:87], v[86:87], v[94:95]
v_pk_add_f32 v[80:81], v[80:81], v[84:85]
v_pk_add_f32 v[82:83], v[82:83], v[86:87]
v_mov_b32 v8, v80
v_mov_b32 v9, v81
v_mov_b32 v10, v82
v_mov_b32 v11, v83
v_permlane32_swap_b32 v8, v80
v_permlane32_swap_b32 v9, v81
v_permlane32_swap_b32 v10, v82
v_permlane32_swap_b32 v11, v83
v_pk_add_f32 v[8:9], v[8:9], v[80:81]
v_pk_add_f32 v[10:11], v[10:11], v[82:83]
v_mul_f32 v8, 0xba800000, v8
v_mul_f32 v9, 0x3a800000, v9
v_fma_f32 v9, -v8, v8, v9
v_max_f32 v9, 0, v9
v_add_f32 v12, 0x3727c5ac, v9
v_rsq_f32 v80, v12
v_fma_f32 v10, v8, v11, v10
v_mul_f32 v12, v80, v10
v_max_u32 v12, 1, v12
v_add_u32 v7, s34, v3
v_mov_b32 v6, v12
s_nop 1
v_max_f32_dpp v6, v6, v6 row_ror:1 row_mask:0xf bank_mask:0xf
s_nop 1
v_max_f32_dpp v6, v6, v6 row_ror:2 row_mask:0xf bank_mask:0xf
s_nop 1
v_max_f32_dpp v6, v6, v6 row_ror:4 row_mask:0xf bank_mask:0xf
s_nop 1
v_max_f32_dpp v6, v6, v6 row_ror:8 row_mask:0xf bank_mask:0xf
v_mov_b32 v11, v6
s_nop 1
v_permlane16_swap_b32 v11, v6
v_max_f32 v6, v6, v11
v_cmp_eq_f32 vcc, v6, v12
s_ff1_i32_b64 s66, vcc
s_and_b32 s66, s66, 31
s_mov_b64 exec, 1
ds_write_b32 v7, v6 offset:256
s_mov_b64 exec, -1
v_add_u32 v7, s34, v1
v_mul_f32 v81, v8, v80
v_add_f32 v10, 1.0, v80
v_mov_b32 v82, v80
v_mov_b32 v83, v81
s_and_b32 s67, s66, 15
s_lshl_b32 s67, 0x10001, s67
s_bitcmp0_b32 s66, 4
v_permlane16_swap_b32 v80, v82
v_permlane16_swap_b32 v81, v83
s_cselect_b32 s76, s67, 0
s_cselect_b32 s78, 0, s67
s_cselect_b32 s77, s67, 0
s_cselect_b32 s79, 0, s67
s_add_u32 s75, s75, s66
v_pk_fma_f32 v[48:49], v[16:17], v[80:81], v[80:81] op_sel:[0,0,1] op_sel_hi:[1,0,1]
v_pk_fma_f32 v[50:51], v[18:19], v[80:81], v[80:81] op_sel:[0,0,1] op_sel_hi:[1,0,1]
v_pk_fma_f32 v[52:53], v[20:21], v[80:81], v[80:81] op_sel:[0,0,1] op_sel_hi:[1,0,1]
v_pk_fma_f32 v[54:55], v[22:23], v[80:81], v[80:81] op_sel:[0,0,1] op_sel_hi:[1,0,1]
v_pk_fma_f32 v[56:57], v[24:25], v[80:81], v[80:81] op_sel:[0,0,1] op_sel_hi:[1,0,1]
v_pk_fma_f32 v[58:59], v[26:27], v[80:81], v[80:81] op_sel:[0,0,1] op_sel_hi:[1,0,1]
v_pk_fma_f32 v[60:61], v[28:29], v[80:81], v[80:81] op_sel:[0,0,1] op_sel_hi:[1,0,1]
v_pk_fma_f32 v[62:63], v[30:31], v[80:81], v[80:81] op_sel:[0,0,1] op_sel_hi:[1,0,1]
v_pk_fma_f32 v[64:65], v[32:33], v[82:83], v[82:83] op_sel:[0,0,1] op_sel_hi:[1,0,1]
v_pk_fma_f32 v[66:67], v[34:35], v[82:83], v[82:83] op_sel:[0,0,1] op_sel_hi:[1,0,1]
v_pk_fma_f32 v[68:69], v[36:37], v[82:83], v[82:83] op_sel:[0,0,1] op_sel_hi:[1,0,1]
v_pk_fma_f32 v[70:71], v[38:39], v[82:83], v[82:83] op_sel:[0,0,1] op_sel_hi:[1,0,1]
v_pk_fma_f32 v[72:73], v[40:41], v[82:83], v[82:83] op_sel:[0,0,1] op_sel_hi:[1,0,1]
v_pk_fma_f32 v[74:75], v[42:43], v[82:83], v[82:83] op_sel:[0,0,1] op_sel_hi:[1,0,1]
v_pk_fma_f32 v[76:77], v[44:45], v[82:83], v[82:83] op_sel:[0,0,1] op_sel_hi:[1,0,1]
v_pk_fma_f32 v[78:79], v[46:47], v[82:83], v[82:83] op_sel:[0,0,1] op_sel_hi:[1,0,1]
v_cvt_pk_bf16_f32 v84, v48, v49
v_cvt_pk_bf16_f32 v85, v50, v51
v_cvt_pk_bf16_f32 v86, v52, v53
v_cvt_pk_bf16_f32 v87, v54, v55
v_cvt_pk_bf16_f32 v88, v56, v57
v_cvt_pk_bf16_f32 v89, v58, v59
v_cvt_pk_bf16_f32 v90, v60, v61
v_cvt_pk_bf16_f32 v91, v62, v63
v_cvt_pk_bf16_f32 v92, v64, v65
v_cvt_pk_bf16_f32 v93, v66, v67
v_cvt_pk_bf16_f32 v94, v68, v69
v_cvt_pk_bf16_f32 v95, v70, v71
v_cvt_pk_bf16_f32 v96, v72, v73
v_cvt_pk_bf16_f32 v97, v74, v75
v_cvt_pk_bf16_f32 v98, v76, v77
v_cvt_pk_bf16_f32 v99, v78, v79
ds_read_b32 v11, v7 offset:256
v_max_u32 v84, 1, v84
v_max_u32 v85, 1, v85
v_max_u32 v86, 1, v86
v_max_u32 v87, 1, v87
v_max_u32 v88, 1, v88
v_max_u32 v89, 1, v89
v_max_u32 v90, 1, v90
v_max_u32 v91, 1, v91
v_max_u32 v92, 1, v92
v_max_u32 v93, 1, v93
v_max_u32 v94, 1, v94
v_max_u32 v95, 1, v95
v_max_u32 v96, 1, v96
v_max_u32 v97, 1, v97
v_max_u32 v98, 1, v98
v_max_u32 v99, 1, v99
s_branch pchk_123
poll_122:
ds_read_b32 v11, v7 offset:256
pchk_123:
s_waitcnt lgkmcnt(0)
v_cmp_eq_u32 vcc, 0, v11
s_cbranch_vccz pdone_124
s_sub_u32 s32, s32, 1
s_cmp_gt_i32 s32, 0
s_cbranch_scc1 poll_122
pdone_124:
v_cmp_eq_f32 vcc, v11, v6
s_bfm_b32 s67, s58, 0
s_and_b32 s67, s67, vcc_lo
v_cmp_gt_f32 vcc, v11, v6
s_lshl_b32 s66, 1, s66
s_or_b32 s67, s67, vcc_lo
s_cselect_b64 s[76:77], 0, s[76:77]
s_cselect_b64 s[78:79], 0, s[78:79]
s_cselect_b64 exec, 0, s[66:67]
buffer_store_dwordx2 v[12:13], off, s[24:27], s68 offset:64 sc1
buffer_store_dwordx2 v[12:13], off, s[24:27], s68 offset:192 sc1
s_mov_b64 exec, s[76:77]
buffer_store_dwordx4 v[84:87], v15, s[24:27], s68 offen offset:0 sc1
buffer_store_dwordx4 v[88:91], v15, s[24:27], s68 offen offset:128 sc1
s_mov_b64 exec, s[78:79]
buffer_store_dwordx4 v[92:95], v15, s[24:27], s68 offen offset:0 sc1
buffer_store_dwordx4 v[96:99], v15, s[24:27], s68 offen offset:128 sc1
s_mov_b64 exec, -1
v_add_u32 v5, s34, 24
s_mov_b64 exec, 1
ds_write_b32 v3, v5
s_mov_b64 exec, -1
v_pk_add_f32 v[16:17], v[16:17], v[48:49]
v_pk_add_f32 v[18:19], v[18:19], v[50:51]
v_pk_add_f32 v[20:21], v[20:21], v[52:53]
v_pk_add_f32 v[22:23], v[22:23], v[54:55]
v_pk_add_f32 v[24:25], v[24:25], v[56:57]
v_pk_add_f32 v[26:27], v[26:27], v[58:59]
v_pk_add_f32 v[28:29], v[28:29], v[60:61]
v_pk_add_f32 v[30:31], v[30:31], v[62:63]
v_pk_add_f32 v[32:33], v[32:33], v[64:65]
v_pk_add_f32 v[34:35], v[34:35], v[66:67]
v_pk_add_f32 v[36:37], v[36:37], v[68:69]
v_pk_add_f32 v[38:39], v[38:39], v[70:71]
v_pk_add_f32 v[40:41], v[40:41], v[72:73]
v_pk_add_f32 v[42:43], v[42:43], v[74:75]
v_pk_add_f32 v[44:45], v[44:45], v[76:77]
v_pk_add_f32 v[46:47], v[46:47], v[78:79]
v_cvt_pk_bf16_f32 v240, v16, v17
v_cvt_pk_bf16_f32 v241, v18, v19
v_cvt_pk_bf16_f32 v242, v20, v21
v_cvt_pk_bf16_f32 v243, v22, v23
v_cvt_pk_bf16_f32 v244, v24, v25
v_cvt_pk_bf16_f32 v245, v26, v27
v_cvt_pk_bf16_f32 v246, v28, v29
v_cvt_pk_bf16_f32 v247, v30, v31
v_cvt_pk_bf16_f32 v248, v32, v33
v_cvt_pk_bf16_f32 v249, v34, v35
v_cvt_pk_bf16_f32 v250, v36, v37
v_cvt_pk_bf16_f32 v251, v38, v39
v_cvt_pk_bf16_f32 v252, v40, v41
v_cvt_pk_bf16_f32 v253, v42, v43
v_cvt_pk_bf16_f32 v254, v44, v45
v_cvt_pk_bf16_f32 v255, v46, v47
v_max_u32 v16, 1, v16
v_max_u32 v17, 1, v17
v_max_u32 v18, 1, v18
v_max_u32 v19, 1, v19
v_max_u32 v20, 1, v20
v_max_u32 v21, 1, v21
v_max_u32 v22, 1, v22
v_max_u32 v23, 1, v23
v_max_u32 v24, 1, v24
v_max_u32 v25, 1, v25
v_max_u32 v26, 1, v26
v_max_u32 v27, 1, v27
v_max_u32 v28, 1, v28
v_max_u32 v29, 1, v29
v_max_u32 v30, 1, v30
v_max_u32 v31, 1, v31
v_max_u32 v32, 1, v32
v_max_u32 v33, 1, v33
v_max_u32 v34, 1, v34
v_max_u32 v35, 1, v35
v_max_u32 v36, 1, v36
v_max_u32 v37, 1, v37
v_max_u32 v38, 1, v38
v_max_u32 v39, 1, v39
v_max_u32 v40, 1, v40
v_max_u32 v41, 1, v41
v_max_u32 v42, 1, v42
v_max_u32 v43, 1, v43
v_max_u32 v44, 1, v44
v_max_u32 v45, 1, v45
v_max_u32 v46, 1, v46
v_max_u32 v47, 1, v47
s_mov_b64 exec, s[76:77]
buffer_store_dwordx4 v[16:19], v15, s[24:27], s69 offen offset:0 sc1
buffer_store_dwordx4 v[20:23], v15, s[24:27], s69 offen offset:64 sc1
buffer_store_dwordx4 v[24:27], v15, s[24:27], s69 offen offset:128 sc1
buffer_store_dwordx4 v[28:31], v15, s[24:27], s69 offen offset:192 sc1
s_mov_b64 exec, s[78:79]
buffer_store_dwordx4 v[32:35], v15, s[24:27], s69 offen offset:0 sc1
buffer_store_dwordx4 v[36:39], v15, s[24:27], s69 offen offset:64 sc1
buffer_store_dwordx4 v[40:43], v15, s[24:27], s69 offen offset:128 sc1
buffer_store_dwordx4 v[44:47], v15, s[24:27], s69 offen offset:192 sc1
s_mov_b64 exec, -1
s_cmp_eq_u32 s63, 0
s_cbranch_scc0 mout_125
v_mul_f32 v11, v10, v10
v_mov_b32 v12, 0x3727c5ac
v_fma_f32 v11, v11, v9, v12
v_rsq_f32 v11, v11
v_lshrrev_b32 v12, 3, v0
v_lshlrev_b32 v12, 6, v12
v_lshl_add_u32 v12, v0, 3, v12
v_mul_f32 v10, v10, v11
v_mul_f32 v11, v8, v10
s_lshl_b32 s66, s73, 9
s_add_u32 s66, s66, 3211264
v_max_u32 v11, 1, v11
s_cmp_eq_u32 s62, 8
s_cselect_b32 exec_lo, -1, 0
s_mov_b32 exec_hi, 0
buffer_store_dwordx2 v[10:11], v12, s[24:27], s66 offen sc1
s_mov_b64 exec, -1
s_mov_b32 s63, 1
s_mov_b32 s34, 32
s_add_u32 s24, s24, 2949120
s_addc_u32 s25, s25, 0
s_mov_b32 s26, 2949120
s_branch L_mtop
mout_125:
v_permlane16_swap_b32 v240, v242
v_permlane16_swap_b32 v241, v243
v_permlane16_swap_b32 v244, v246
v_permlane16_swap_b32 v245, v247
v_permlane16_swap_b32 v248, v250
v_permlane16_swap_b32 v249, v251
v_permlane16_swap_b32 v252, v254
v_permlane16_swap_b32 v253, v255
s_not_b64 exec, s[76:77]
buffer_store_dwordx4 v[240:243], v14, s[28:31], s70 offen offset:0
buffer_store_dwordx4 v[244:247], v14, s[28:31], s70 offen offset:64
s_not_b64 exec, s[78:79]
buffer_store_dwordx4 v[248:251], v14, s[28:31], s71 offen offset:0
buffer_store_dwordx4 v[252:255], v14, s[28:31], s71 offen offset:64
s_mov_b64 exec, -1
s_or_b32 s66, s76, s78
s_cbranch_scc0 L_end
v_mov_b32 v11, 0
s_add_u32 s35, s34, 3
lw_126:
ds_read_b32 v5, v2 offset:24
s_waitcnt lgkmcnt(0)
v_cmp_gt_i32 vcc, s35, v5
s_cbranch_vccz lwd_127
s_sleep 2
s_sub_u32 s32, s32, 1
s_cmp_gt_i32 s32, 0
s_cbranch_scc1 lw_126
lwd_127:
ds_read_b32 v11, v11 offset:32
s_waitcnt lgkmcnt(0)
v_cmp_eq_u32 vcc, s75, v11
s_cbranch_vccnz L_end
s_mov_b64 exec, s[76:77]
buffer_store_dwordx4 v[240:243], v14, s[28:31], s70 offen offset:0
buffer_store_dwordx4 v[244:247], v14, s[28:31], s70 offen offset:64
s_mov_b64 exec, s[78:79]
buffer_store_dwordx4 v[248:251], v14, s[28:31], s71 offen offset:0
buffer_store_dwordx4 v[252:255], v14, s[28:31], s71 offen offset:64
s_mov_b64 exec, -1
s_branch L_end
mspin_94:
s_cmp_eq_u32 s66, 1
s_cbranch_scc1 mback_95
msp_128:
ds_read_b32 v5, v2 offset:16
s_waitcnt lgkmcnt(0)
v_cmp_ge_u32 vcc, v4, v5
s_cbranch_vccz mback_95
s_sub_u32 s32, s32, 1
s_cmp_gt_i32 s32, 0
s_cbranch_scc1 msp_128
s_branch mback_95
patch_98:
s_bfe_u32 s66, s33, 0x20005
s_lshr_b32 s67, s66, 1
s_xor_b32 s66, s66, s67
s_and_b32 s66, s66, 1
s_cmp_eq_u32 s66, s65
s_cbranch_scc0 pback_99
s_lshl_b32 s67, s67, 5
s_and_b32 s66, s33, 31
s_add_u32 s66, s66, s67
v_and_b32 v10, 15, v0
v_sub_u32 v10, s66, v10
v_lshrrev_b32 v11, 4, v0
v_lshlrev_b32 v11, 2, v11
v_sub_u32 v11, s66, v11
v_cmp_eq_u32 vcc, 0, v10
s_mov_b64 exec, vcc
ds_read_b128 v[16:19], v9 offset:3456
ds_read_b128 v[20:23], v9 offset:3520
ds_read_b128 v[80:83], v9 offset:3328
ds_read_b128 v[84:87], v9 offset:3392
s_mov_b64 exec, -1
v_cmp_eq_u32 vcc, 0, v11
s_mov_b64 exec, vcc
ds_read_b32 v48, v8 offset:3584
ds_read_b32 v52, v8 offset:3648
s_mov_b64 exec, -1
v_cmp_eq_u32 vcc, 1, v11
s_mov_b64 exec, vcc
ds_read_b32 v49, v8 offset:3584
ds_read_b32 v53, v8 offset:3648
s_mov_b64 exec, -1
v_cmp_eq_u32 vcc, 2, v11
s_mov_b64 exec, vcc
ds_read_b32 v50, v8 offset:3584
ds_read_b32 v54, v8 offset:3648
s_mov_b64 exec, -1
v_cmp_eq_u32 vcc, 3, v11
s_mov_b64 exec, vcc
ds_read_b32 v51, v8 offset:3584
ds_read_b32 v55, v8 offset:3648
s_mov_b64 exec, -1
s_waitcnt lgkmcnt(0)
v_cmp_eq_u32 vcc, 16, v10
s_mov_b64 exec, vcc
ds_read_b128 v[24:27], v9 offset:3456
ds_read_b128 v[28:31], v9 offset:3520
ds_read_b128 v[88:91], v9 offset:3328
ds_read_b128 v[92:95], v9 offset:3392
s_mov_b64 exec, -1
v_cmp_eq_u32 vcc, 16, v11
s_mov_b64 exec, vcc
ds_read_b32 v56, v8 offset:3584
ds_read_b32 v60, v8 offset:3648
s_mov_b64 exec, -1
v_cmp_eq_u32 vcc, 17, v11
s_mov_b64 exec, vcc
ds_read_b32 v57, v8 offset:3584
ds_read_b32 v61, v8 offset:3648
s_mov_b64 exec, -1
v_cmp_eq_u32 vcc, 18, v11
s_mov_b64 exec, vcc
ds_read_b32 v58, v8 offset:3584
ds_read_b32 v62, v8 offset:3648
s_mov_b64 exec, -1
v_cmp_eq_u32 vcc, 19, v11
s_mov_b64 exec, vcc
ds_read_b32 v59, v8 offset:3584
ds_read_b32 v63, v8 offset:3648
s_mov_b64 exec, -1
s_waitcnt lgkmcnt(0)
v_cmp_eq_u32 vcc, 32, v10
s_mov_b64 exec, vcc
ds_read_b128 v[32:35], v9 offset:3456
ds_read_b128 v[36:39], v9 offset:3520
ds_read_b128 v[96:99], v9 offset:3328
ds_read_b128 v[100:103], v9 offset:3392
s_mov_b64 exec, -1
v_cmp_eq_u32 vcc, 32, v11
s_mov_b64 exec, vcc
ds_read_b32 v64, v8 offset:3584
ds_read_b32 v68, v8 offset:3648
s_mov_b64 exec, -1
v_cmp_eq_u32 vcc, 33, v11
s_mov_b64 exec, vcc
ds_read_b32 v65, v8 offset:3584
ds_read_b32 v69, v8 offset:3648
s_mov_b64 exec, -1
v_cmp_eq_u32 vcc, 34, v11
s_mov_b64 exec, vcc
ds_read_b32 v66, v8 offset:3584
ds_read_b32 v70, v8 offset:3648
s_mov_b64 exec, -1
v_cmp_eq_u32 vcc, 35, v11
s_mov_b64 exec, vcc
ds_read_b32 v67, v8 offset:3584
ds_read_b32 v71, v8 offset:3648
s_mov_b64 exec, -1
s_waitcnt lgkmcnt(0)
v_cmp_eq_u32 vcc, 48, v10
s_mov_b64 exec, vcc
ds_read_b128 v[40:43], v9 offset:3456
ds_read_b128 v[44:47], v9 offset:3520
ds_read_b128 v[104:107], v9 offset:3328
ds_read_b128 v[108:111], v9 offset:3392
s_mov_b64 exec, -1
v_cmp_eq_u32 vcc, 48, v11
s_mov_b64 exec, vcc
ds_read_b32 v72, v8 offset:3584
ds_read_b32 v76, v8 offset:3648
s_mov_b64 exec, -1
v_cmp_eq_u32 vcc, 49, v11
s_mov_b64 exec, vcc
ds_read_b32 v73, v8 offset:3584
ds_read_b32 v77, v8 offset:3648
s_mov_b64 exec, -1
v_cmp_eq_u32 vcc, 50, v11
s_mov_b64 exec, vcc
ds_read_b32 v74, v8 offset:3584
ds_read_b32 v78, v8 offset:3648
s_mov_b64 exec, -1
v_cmp_eq_u32 vcc, 51, v11
s_mov_b64 exec, vcc
ds_read_b32 v75, v8 offset:3584
ds_read_b32 v79, v8 offset:3648
s_mov_b64 exec, -1
s_waitcnt lgkmcnt(0)
s_branch pback_99
cross_109:
s_cmp_eq_u32 s67, 122880
s_cbranch_scc0 cr2_129
v_add_u32 v5, s34, 18
s_mov_b64 exec, 1
ds_write_b32 v3, v5
s_mov_b64 exec, -1
s_add_u32 s70, s72, 360448
s_mov_b64 exec, 1
s_waitcnt vmcnt(0)
buffer_store_dword v5, v3, s[24:27], s70 offen sc1
s_mov_b64 exec, -1
v_mov_b32 v9, 0xf149f2ca
v_xor_b32 v216, v9, v216
v_xor_b32 v217, v9, v217
v_xor_b32 v218, v9, v218
v_xor_b32 v219, v9, v219
v_xor_b32 v220, v9, v220
v_xor_b32 v221, v9, v221
v_xor_b32 v222, v9, v222
v_xor_b32 v223, v9, v223
v_xor_b32 v224, v9, v224
v_xor_b32 v225, v9, v225
v_xor_b32 v226, v9, v226
v_xor_b32 v227, v9, v227
v_xor_b32 v228, v9, v228
v_xor_b32 v229, v9, v229
v_xor_b32 v230, v9, v230
v_xor_b32 v231, v9, v231
s_mov_b32 s67, 90112
s_cmp_eq_u32 s63, 0
s_cbranch_scc0 cr3_130
v_and_b32 v9, 15, v0
v_lshlrev_b32 v9, 11, v9
v_bfe_u32 v10, v0, 4, 1
v_lshl_add_u32 v9, v10, 5, v9
v_lshrrev_b32 v10, 5, v0
v_lshl_add_u32 v9, v10, 4, v9
s_lshl2_add_u32 s70, s61, s58
s_lshl_b32 s70, s70, 16
s_lshl_b32 s71, s62, 7
s_add_u32 s70, s70, s71
s_add_u32 s71, s70, 0x8000
buffer_load_dwordx4 v[240:243], v9, s[8:11], s70 offen offset:0
buffer_load_dwordx4 v[244:247], v9, s[8:11], s70 offen offset:64
buffer_load_dwordx4 v[248:251], v9, s[8:11], s71 offen offset:0
buffer_load_dwordx4 v[252:255], v9, s[8:11], s71 offen offset:64
cr3_130:
s_cmp_eq_u32 s59, 0
s_cbranch_scc1 cback_110
v_mov_b32 v9, 0
s_add_u32 s35, s34, 17
lw_131:
ds_read_b32 v5, v9 offset:16
s_waitcnt lgkmcnt(0)
v_cmp_gt_i32 vcc, s35, v5
s_cbranch_vccz lwd_132
s_sub_u32 s32, s32, 1
s_cmp_gt_i32 s32, 0
s_cbranch_scc1 lw_131
lwd_132:
s_branch cback_110
cr2_129:
v_add_u32 v5, s34, 19
s_mov_b64 exec, 1
ds_write_b32 v3, v5
s_mov_b64 exec, -1
s_mov_b32 s66, 28672
s_cmp_lt_u32 s59, 2
s_cbranch_scc1 cback_110
s_add_u32 s35, s34, 17
lw_133:
ds_read_b32 v5, v2 offset:16
s_waitcnt lgkmcnt(0)
v_cmp_gt_i32 vcc, s35, v5
s_cbranch_vccz lwd_134
s_sub_u32 s32, s32, 1
s_cmp_gt_i32 s32, 0
s_cbranch_scc1 lw_133
lwd_134:
s_branch cback_110
cross_111:
s_cmp_eq_u32 s67, 122880
s_cbranch_scc0 cr2_135
v_add_u32 v5, s34, 18
s_mov_b64 exec, 1
ds_write_b32 v3, v5
s_mov_b64 exec, -1
s_add_u32 s70, s72, 360448
s_mov_b64 exec, 1
s_waitcnt vmcnt(0)
buffer_store_dword v5, v3, s[24:27], s70 offen sc1
s_mov_b64 exec, -1
v_mov_b32 v9, 0xf149f2ca
v_xor_b32 v216, v9, v216
v_xor_b32 v217, v9, v217
v_xor_b32 v218, v9, v218
v_xor_b32 v219, v9, v219
v_xor_b32 v220, v9, v220
v_xor_b32 v221, v9, v221
v_xor_b32 v222, v9, v222
v_xor_b32 v223, v9, v223
v_xor_b32 v224, v9, v224
v_xor_b32 v225, v9, v225
v_xor_b32 v226, v9, v226
v_xor_b32 v227, v9, v227
v_xor_b32 v228, v9, v228
v_xor_b32 v229, v9, v229
v_xor_b32 v230, v9, v230
v_xor_b32 v231, v9, v231
s_mov_b32 s67, 90112
s_cmp_eq_u32 s63, 0
s_cbranch_scc0 cr3_136
v_and_b32 v9, 15, v0
v_lshlrev_b32 v9, 11, v9
v_bfe_u32 v10, v0, 4, 1
v_lshl_add_u32 v9, v10, 5, v9
v_lshrrev_b32 v10, 5, v0
v_lshl_add_u32 v9, v10, 4, v9
s_lshl2_add_u32 s70, s61, s58
s_lshl_b32 s70, s70, 16
s_lshl_b32 s71, s62, 7
s_add_u32 s70, s70, s71
s_add_u32 s71, s70, 0x8000
buffer_load_dwordx4 v[240:243], v9, s[8:11], s70 offen offset:0
buffer_load_dwordx4 v[244:247], v9, s[8:11], s70 offen offset:64
buffer_load_dwordx4 v[248:251], v9, s[8:11], s71 offen offset:0
buffer_load_dwordx4 v[252:255], v9, s[8:11], s71 offen offset:64
cr3_136:
s_cmp_eq_u32 s59, 0
s_cbranch_scc1 cback_112
v_mov_b32 v9, 0
s_add_u32 s35, s34, 17
lw_137:
ds_read_b32 v5, v9 offset:16
s_waitcnt lgkmcnt(0)
v_cmp_gt_i32 vcc, s35, v5
s_cbranch_vccz lwd_138
s_sub_u32 s32, s32, 1
s_cmp_gt_i32 s32, 0
s_cbranch_scc1 lw_137
lwd_138:
s_branch cback_112
cr2_135:
v_add_u32 v5, s34, 19
s_mov_b64 exec, 1
ds_write_b32 v3, v5
s_mov_b64 exec, -1
s_mov_b32 s66, 28672
s_cmp_lt_u32 s59, 2
s_cbranch_scc1 cback_112
s_add_u32 s35, s34, 17
lw_139:
ds_read_b32 v5, v2 offset:16
s_waitcnt lgkmcnt(0)
v_cmp_gt_i32 vcc, s35, v5
s_cbranch_vccz lwd_140
s_sub_u32 s32, s32, 1
s_cmp_gt_i32 s32, 0
s_cbranch_scc1 lw_139
lwd_140:
s_branch cback_112
slow_113:
s_add_u32 s70, s72, 360448
poll_141:
buffer_load_dword v10, v1, s[24:27], s70 offen sc1
pchk_142:
s_waitcnt vmcnt(0)
v_cmp_eq_u32 vcc, 0, v10
s_cbranch_vccz pdone_143
s_sub_u32 s32, s32, 1
s_cmp_gt_i32 s32, 0
s_cbranch_scc1 poll_141
pdone_143:
s_lshl_b32 s73, s60, 15
s_lshl_b32 s74, s63, 23
s_add_u32 s73, s73, s74
s_add_u32 s73, s73, 1048576
v_mov_b32 v10, 0xf149f2ca
v_mov_b32 v11, 0
v_mov_b32 v192, 0
v_mov_b32 v193, 0
v_mov_b32 v194, 0
v_mov_b32 v195, 0
v_mov_b32 v196, 0
v_mov_b32 v197, 0
v_mov_b32 v198, 0
v_mov_b32 v199, 0
v_mov_b32 v200, 0
v_mov_b32 v201, 0
v_mov_b32 v202, 0
v_mov_b32 v203, 0
v_mov_b32 v204, 0
v_mov_b32 v205, 0
v_mov_b32 v206, 0
v_mov_b32 v207, 0
v_mov_b32 v208, 0
v_mov_b32 v209, 0
v_mov_b32 v210, 0
v_mov_b32 v211, 0
s_lshl2_add_u32 s74, s59, s65
s_mov_b32 s75, 0
sl_144:
s_lshr_b32 s76, s74, 2
s_lshl_b32 s76, s76, 19
s_and_b32 s77, s74, 3
s_lshl_b32 s77, s77, 13
s_add_u32 s76, s76, s77
s_add_u32 s76, s76, s73
buffer_load_dwordx4 v[152:155], v6, s[20:23], s76 offen offset:0 sc1
buffer_load_dwordx4 v[156:159], v6, s[20:23], s76 offen offset:1024 sc1
s_cmp_eq_u32 s75, 0
s_cselect_b32 s76, 0xf149f2ca, 0
s_and_b32 s77, s75, 7
s_cselect_b32 s77, 0, -1
v_xor_b32 v112, s76, v216
v_and_b32 v112, s77, v112
v_xor_b32 v113, s76, v217
v_and_b32 v113, s77, v113
v_xor_b32 v114, s76, v218
v_and_b32 v114, s77, v114
v_xor_b32 v115, s76, v219
v_and_b32 v115, s77, v115
v_xor_b32 v116, s76, v220
v_and_b32 v116, s77, v116
v_xor_b32 v117, s76, v221
v_and_b32 v117, s77, v117
v_xor_b32 v118, s76, v222
v_and_b32 v118, s77, v118
v_xor_b32 v119, s76, v223
v_and_b32 v119, s77, v119
v_xor_b32 v120, s76, v224
v_and_b32 v120, s77, v120
v_xor_b32 v121, s76, v225
v_and_b32 v121, s77, v121
v_xor_b32 v122, s76, v226
v_and_b32 v122, s77, v122
v_xor_b32 v123, s76, v227
v_and_b32 v123, s77, v123
v_xor_b32 v124, s76, v228
v_and_b32 v124, s77, v124
v_xor_b32 v125, s76, v229
v_and_b32 v125, s77, v125
v_xor_b32 v126, s76, v230
v_and_b32 v126, s77, v126
v_xor_b32 v127, s76, v231
v_and_b32 v127, s77, v127
s_waitcnt vmcnt(1)
s_nop 0
v_mfma_f32_32x32x16_bf16 v[112:127], v[152:155], v[80:83], v[112:127]
s_waitcnt vmcnt(0)
v_mfma_f32_32x32x16_bf16 v[112:127], v[156:159], v[88:91], v[112:127]
s_nop 11
v_max3_f32 v10, v10, v112, v113
v_max3_f32 v10, v10, v114, v115
v_max3_f32 v10, v10, v116, v117
v_max3_f32 v10, v10, v118, v119
v_max3_f32 v10, v10, v120, v121
v_max3_f32 v10, v10, v122, v123
v_max3_f32 v10, v10, v124, v125
v_max3_f32 v10, v10, v126, v127
s_add_u32 s75, s75, 1
s_sub_u32 s74, s74, 1
s_cselect_b32 s75, 9, s75
s_cmp_lt_u32 s75, 9
s_cbranch_scc1 sl_144
v_mov_b32 v11, v10
s_nop 1
v_permlane32_swap_b32 v11, v10
v_max_f32 v10, v10, v11
s_lshl2_add_u32 s74, s59, s65
s_mov_b32 s75, 0
sl_145:
s_lshr_b32 s76, s74, 2
s_lshl_b32 s76, s76, 19
s_and_b32 s77, s74, 3
s_lshl_b32 s77, s77, 13
s_add_u32 s76, s76, s77
s_add_u32 s76, s76, s73
buffer_load_dwordx4 v[152:155], v6, s[20:23], s76 offen offset:0 sc1
buffer_load_dwordx4 v[156:159], v6, s[20:23], s76 offen offset:1024 sc1
buffer_load_dwordx4 v[160:163], v6, s[20:23], s76 offen offset:2048 sc1
buffer_load_dwordx4 v[164:167], v6, s[20:23], s76 offen offset:3072 sc1
s_cmp_eq_u32 s75, 0
s_cselect_b32 s76, 0xf149f2ca, 0
s_and_b32 s77, s75, 7
s_cselect_b32 s77, 0, -1
v_xor_b32 v112, s76, v216
v_and_b32 v112, s77, v112
v_sub_f32 v112, v112, v10
v_xor_b32 v113, s76, v217
v_and_b32 v113, s77, v113
v_sub_f32 v113, v113, v10
v_xor_b32 v114, s76, v218
v_and_b32 v114, s77, v114
v_sub_f32 v114, v114, v10
v_xor_b32 v115, s76, v219
v_and_b32 v115, s77, v115
v_sub_f32 v115, v115, v10
v_xor_b32 v116, s76, v220
v_and_b32 v116, s77, v116
v_sub_f32 v116, v116, v10
v_xor_b32 v117, s76, v221
v_and_b32 v117, s77, v117
v_sub_f32 v117, v117, v10
v_xor_b32 v118, s76, v222
v_and_b32 v118, s77, v118
v_sub_f32 v118, v118, v10
v_xor_b32 v119, s76, v223
v_and_b32 v119, s77, v119
v_sub_f32 v119, v119, v10
v_xor_b32 v120, s76, v224
v_and_b32 v120, s77, v120
v_sub_f32 v120, v120, v10
v_xor_b32 v121, s76, v225
v_and_b32 v121, s77, v121
v_sub_f32 v121, v121, v10
v_xor_b32 v122, s76, v226
v_and_b32 v122, s77, v122
v_sub_f32 v122, v122, v10
v_xor_b32 v123, s76, v227
v_and_b32 v123, s77, v123
v_sub_f32 v123, v123, v10
v_xor_b32 v124, s76, v228
v_and_b32 v124, s77, v124
v_sub_f32 v124, v124, v10
v_xor_b32 v125, s76, v229
v_and_b32 v125, s77, v125
v_sub_f32 v125, v125, v10
v_xor_b32 v126, s76, v230
v_and_b32 v126, s77, v126
v_sub_f32 v126, v126, v10
v_xor_b32 v127, s76, v231
v_and_b32 v127, s77, v127
v_sub_f32 v127, v127, v10
s_waitcnt vmcnt(3)
s_nop 0
v_mfma_f32_32x32x16_bf16 v[112:127], v[152:155], v[80:83], v[112:127]
s_waitcnt vmcnt(2)
v_mfma_f32_32x32x16_bf16 v[112:127], v[156:159], v[88:91], v[112:127]
s_nop 11
v_exp_f32 v112, v112
v_exp_f32 v113, v113
v_exp_f32 v114, v114
v_exp_f32 v115, v115
v_exp_f32 v116, v116
v_exp_f32 v117, v117
v_exp_f32 v118, v118
v_exp_f32 v119, v119
v_exp_f32 v120, v120
v_exp_f32 v121, v121
v_exp_f32 v122, v122
v_exp_f32 v123, v123
v_exp_f32 v124, v124
v_exp_f32 v125, v125
v_exp_f32 v126, v126
v_exp_f32 v127, v127
v_cvt_pk_bf16_f32 v144, v112, v113
v_cvt_pk_bf16_f32 v145, v114, v115
v_cvt_pk_bf16_f32 v146, v116, v117
v_cvt_pk_bf16_f32 v147, v118, v119
v_cvt_pk_bf16_f32 v148, v120, v121
v_cvt_pk_bf16_f32 v149, v122, v123
v_cvt_pk_bf16_f32 v150, v124, v125
v_cvt_pk_bf16_f32 v151, v126, v127
s_waitcnt vmcnt(1)
v_mfma_f32_32x32x16_bf16 v[192:207], v[160:163], v[144:147], v[192:207]
v_mfma_f32_16x16x32_bf16 v[208:211], v[212:215], v[144:147], v[208:211]
s_waitcnt vmcnt(0)
v_mfma_f32_32x32x16_bf16 v[192:207], v[164:167], v[148:151], v[192:207]
v_mfma_f32_16x16x32_bf16 v[208:211], v[212:215], v[148:151], v[208:211]
s_add_u32 s75, s75, 1
s_sub_u32 s74, s74, 1
s_cselect_b32 s75, 9, s75
s_cmp_lt_u32 s75, 9
s_cbranch_scc1 sl_145
v_mov_b32 v10, 0xf149f2ca
v_mov_b32 v11, 0
v_mov_b32 v16, 0
v_mov_b32 v17, 0
v_mov_b32 v18, 0
v_mov_b32 v19, 0
v_mov_b32 v20, 0
v_mov_b32 v21, 0
v_mov_b32 v22, 0
v_mov_b32 v23, 0
v_mov_b32 v24, 0
v_mov_b32 v25, 0
v_mov_b32 v26, 0
v_mov_b32 v27, 0
v_mov_b32 v28, 0
v_mov_b32 v29, 0
v_mov_b32 v30, 0
v_mov_b32 v31, 0
v_mov_b32 v32, 0
v_mov_b32 v33, 0
v_mov_b32 v34, 0
v_mov_b32 v35, 0
s_sub_u32 s74, 3, s65
s_lshl2_add_u32 s74, s59, s74
s_mov_b32 s75, 0
sl_146:
s_lshr_b32 s76, s74, 2
s_lshl_b32 s76, s76, 19
s_and_b32 s77, s74, 3
s_lshl_b32 s77, s77, 13
s_add_u32 s76, s76, s77
s_add_u32 s76, s76, s73
buffer_load_dwordx4 v[152:155], v6, s[20:23], s76 offen offset:0 sc1
buffer_load_dwordx4 v[156:159], v6, s[20:23], s76 offen offset:1024 sc1
s_cmp_eq_u32 s75, 0
s_cselect_b32 s76, 0xf149f2ca, 0
s_and_b32 s77, s75, 7
s_cselect_b32 s77, 0, -1
v_xor_b32 v112, s76, v216
v_and_b32 v112, s77, v112
v_xor_b32 v113, s76, v217
v_and_b32 v113, s77, v113
v_xor_b32 v114, s76, v218
v_and_b32 v114, s77, v114
v_xor_b32 v115, s76, v219
v_and_b32 v115, s77, v115
v_xor_b32 v116, s76, v220
v_and_b32 v116, s77, v116
v_xor_b32 v117, s76, v221
v_and_b32 v117, s77, v117
v_xor_b32 v118, s76, v222
v_and_b32 v118, s77, v118
v_xor_b32 v119, s76, v223
v_and_b32 v119, s77, v119
v_xor_b32 v120, s76, v224
v_and_b32 v120, s77, v120
v_xor_b32 v121, s76, v225
v_and_b32 v121, s77, v121
v_xor_b32 v122, s76, v226
v_and_b32 v122, s77, v122
v_xor_b32 v123, s76, v227
v_and_b32 v123, s77, v123
v_xor_b32 v124, s76, v228
v_and_b32 v124, s77, v124
v_xor_b32 v125, s76, v229
v_and_b32 v125, s77, v125
v_xor_b32 v126, s76, v230
v_and_b32 v126, s77, v126
v_xor_b32 v127, s76, v231
v_and_b32 v127, s77, v127
s_waitcnt vmcnt(1)
s_nop 0
v_mfma_f32_32x32x16_bf16 v[112:127], v[152:155], v[96:99], v[112:127]
s_waitcnt vmcnt(0)
v_mfma_f32_32x32x16_bf16 v[112:127], v[156:159], v[104:107], v[112:127]
s_nop 11
v_max3_f32 v10, v10, v112, v113
v_max3_f32 v10, v10, v114, v115
v_max3_f32 v10, v10, v116, v117
v_max3_f32 v10, v10, v118, v119
v_max3_f32 v10, v10, v120, v121
v_max3_f32 v10, v10, v122, v123
v_max3_f32 v10, v10, v124, v125
v_max3_f32 v10, v10, v126, v127
s_add_u32 s75, s75, 1
s_sub_u32 s74, s74, 1
s_cselect_b32 s75, 9, s75
s_cmp_lt_u32 s75, 9
s_cbranch_scc1 sl_146
v_mov_b32 v11, v10
s_nop 1
v_permlane32_swap_b32 v11, v10
v_max_f32 v10, v10, v11
s_sub_u32 s74, 3, s65
s_lshl2_add_u32 s74, s59, s74
s_mov_b32 s75, 0
sl_147:
s_lshr_b32 s76, s74, 2
s_lshl_b32 s76, s76, 19
s_and_b32 s77, s74, 3
s_lshl_b32 s77, s77, 13
s_add_u32 s76, s76, s77
s_add_u32 s76, s76, s73
buffer_load_dwordx4 v[152:155], v6, s[20:23], s76 offen offset:0 sc1
buffer_load_dwordx4 v[156:159], v6, s[20:23], s76 offen offset:1024 sc1
buffer_load_dwordx4 v[160:163], v6, s[20:23], s76 offen offset:2048 sc1
buffer_load_dwordx4 v[164:167], v6, s[20:23], s76 offen offset:3072 sc1
s_cmp_eq_u32 s75, 0
s_cselect_b32 s76, 0xf149f2ca, 0
s_and_b32 s77, s75, 7
s_cselect_b32 s77, 0, -1
v_xor_b32 v112, s76, v216
v_and_b32 v112, s77, v112
v_sub_f32 v112, v112, v10
v_xor_b32 v113, s76, v217
v_and_b32 v113, s77, v113
v_sub_f32 v113, v113, v10
v_xor_b32 v114, s76, v218
v_and_b32 v114, s77, v114
v_sub_f32 v114, v114, v10
v_xor_b32 v115, s76, v219
v_and_b32 v115, s77, v115
v_sub_f32 v115, v115, v10
v_xor_b32 v116, s76, v220
v_and_b32 v116, s77, v116
v_sub_f32 v116, v116, v10
v_xor_b32 v117, s76, v221
v_and_b32 v117, s77, v117
v_sub_f32 v117, v117, v10
v_xor_b32 v118, s76, v222
v_and_b32 v118, s77, v118
v_sub_f32 v118, v118, v10
v_xor_b32 v119, s76, v223
v_and_b32 v119, s77, v119
v_sub_f32 v119, v119, v10
v_xor_b32 v120, s76, v224
v_and_b32 v120, s77, v120
v_sub_f32 v120, v120, v10
v_xor_b32 v121, s76, v225
v_and_b32 v121, s77, v121
v_sub_f32 v121, v121, v10
v_xor_b32 v122, s76, v226
v_and_b32 v122, s77, v122
v_sub_f32 v122, v122, v10
v_xor_b32 v123, s76, v227
v_and_b32 v123, s77, v123
v_sub_f32 v123, v123, v10
v_xor_b32 v124, s76, v228
v_and_b32 v124, s77, v124
v_sub_f32 v124, v124, v10
v_xor_b32 v125, s76, v229
v_and_b32 v125, s77, v125
v_sub_f32 v125, v125, v10
v_xor_b32 v126, s76, v230
v_and_b32 v126, s77, v126
v_sub_f32 v126, v126, v10
v_xor_b32 v127, s76, v231
v_and_b32 v127, s77, v127
v_sub_f32 v127, v127, v10
s_waitcnt vmcnt(3)
s_nop 0
v_mfma_f32_32x32x16_bf16 v[112:127], v[152:155], v[96:99], v[112:127]
s_waitcnt vmcnt(2)
v_mfma_f32_32x32x16_bf16 v[112:127], v[156:159], v[104:107], v[112:127]
s_nop 11
v_exp_f32 v112, v112
v_exp_f32 v113, v113
v_exp_f32 v114, v114
v_exp_f32 v115, v115
v_exp_f32 v116, v116
v_exp_f32 v117, v117
v_exp_f32 v118, v118
v_exp_f32 v119, v119
v_exp_f32 v120, v120
v_exp_f32 v121, v121
v_exp_f32 v122, v122
v_exp_f32 v123, v123
v_exp_f32 v124, v124
v_exp_f32 v125, v125
v_exp_f32 v126, v126
v_exp_f32 v127, v127
v_cvt_pk_bf16_f32 v144, v112, v113
v_cvt_pk_bf16_f32 v145, v114, v115
v_cvt_pk_bf16_f32 v146, v116, v117
v_cvt_pk_bf16_f32 v147, v118, v119
v_cvt_pk_bf16_f32 v148, v120, v121
v_cvt_pk_bf16_f32 v149, v122, v123
v_cvt_pk_bf16_f32 v150, v124, v125
v_cvt_pk_bf16_f32 v151, v126, v127
s_waitcnt vmcnt(1)
v_mfma_f32_32x32x16_bf16 v[16:31], v[160:163], v[144:147], v[16:31]
v_mfma_f32_16x16x32_bf16 v[32:35], v[212:215], v[144:147], v[32:35]
s_waitcnt vmcnt(0)
v_mfma_f32_32x32x16_bf16 v[16:31], v[164:167], v[148:151], v[16:31]
v_mfma_f32_16x16x32_bf16 v[32:35], v[212:215], v[148:151], v[32:35]
s_add_u32 s75, s75, 1
s_sub_u32 s74, s74, 1
s_cselect_b32 s75, 9, s75
s_cmp_lt_u32 s75, 9
s_cbranch_scc1 sl_147
s_branch sback_114
mo_115:
s_lshr_b32 s67, s33, 5
s_cmp_eq_u32 s67, s66
s_cbranch_scc0 mo_116
s_and_b32 s67, s33, 31
v_sub_u32 v48, s67, v48
v_lshlrev_b32 v49, 7, v49
s_lshl_b32 s67, s62, 11
s_add_u32 s67, s67, 33325056
poll_148:
buffer_load_dwordx2 v[56:57], v49, s[20:23], s67 offen offset:0 sc1
buffer_load_dwordx2 v[58:59], v49, s[20:23], s67 offen offset:512 sc1
buffer_load_dwordx2 v[60:61], v49, s[20:23], s67 offen offset:1024 sc1
buffer_load_dwordx2 v[62:63], v49, s[20:23], s67 offen offset:1536 sc1
pchk_149:
s_waitcnt vmcnt(2)
v_min3_u32 v50, v56, v57, v58
s_waitcnt vmcnt(1)
v_min3_u32 v50, v50, v59, v60
s_waitcnt vmcnt(0)
v_min3_u32 v50, v50, v61, v62
v_min_u32 v50, v50, v63
v_cmp_eq_u32 vcc, 0, v50
s_cbranch_vccz pdone_150
s_sub_u32 s32, s32, 1
s_cmp_gt_i32 s32, 0
s_cbranch_scc1 poll_148
pdone_150:
v_cmp_eq_u32 vcc, 0, v48
s_nop 1
v_cndmask_b32 v240, v240, v56, vcc
v_cndmask_b32 v241, v241, v57, vcc
v_cndmask_b32 v242, v242, v58, vcc
v_cndmask_b32 v243, v243, v59, vcc
v_cndmask_b32 v244, v244, v60, vcc
v_cndmask_b32 v245, v245, v61, vcc
v_cndmask_b32 v246, v246, v62, vcc
v_cndmask_b32 v247, v247, v63, vcc
v_cmp_eq_u32 vcc, 16, v48
s_nop 1
v_cndmask_b32 v248, v248, v56, vcc
v_cndmask_b32 v249, v249, v57, vcc
v_cndmask_b32 v250, v250, v58, vcc
v_cndmask_b32 v251, v251, v59, vcc
v_cndmask_b32 v252, v252, v60, vcc
v_cndmask_b32 v253, v253, v61, vcc
v_cndmask_b32 v254, v254, v62, vcc
v_cndmask_b32 v255, v255, v63, vcc
s_branch mo_116
L_end:
L_fin:
s_endpgm
.section .rodata,"a"
.p2align 6
.amdhsa_kernel interleave_layers__sliding_block__moe_arch_mod__prompt_kernel
  .amdhsa_next_free_vgpr 256
  .amdhsa_next_free_sgpr 102
  .amdhsa_accum_offset 256
  .amdhsa_group_segment_fixed_size 0
  .amdhsa_kernarg_size 88
  .amdhsa_user_sgpr_count 2
  .amdhsa_user_sgpr_kernarg_segment_ptr 1
  .amdhsa_system_sgpr_workgroup_id_x 1
  .amdhsa_float_denorm_mode_32 3
.end_amdhsa_kernel
```

```asm
; @launch grid=(256,1,1) block=(512,1,1) lds=163840
.amdgcn_target "amdgcn-amd-amdhsa--gfx950"
.text
.globl interleave_layers__sliding_block__moe_arch_mod__prompt_kernel
.p2align 8
.type interleave_layers__sliding_block__moe_arch_mod__prompt_kernel,@function
interleave_layers__sliding_block__moe_arch_mod__prompt_kernel:
s_cmp_ge_u32 s2, 256
s_cbranch_scc1 L_fin
s_load_dwordx16 s[36:51], s[0:1], 0
s_load_dwordx4 s[52:55], s[0:1], 64
s_load_dwordx2 s[56:57], s[0:1], 80
v_lshrrev_b32 v1, 6, v0
v_and_b32 v0, 63, v0
s_and_b32 s64, s2, 7
v_readfirstlane_b32 s3, v1
s_lshr_b32 s65, s2, 3
s_and_b32 s66, s65, 7
s_and_b32 s67, s64, 1
s_lshl3_add_u32 s59, s67, s66
s_lshr_b32 s66, s65, 3
s_lshr_b32 s67, s64, 1
s_lshl2_add_u32 s60, s67, s66
s_and_b32 s66, s65, 1
s_lshl1_add_u32 s61, s64, s66
s_lshr_b32 s62, s65, 1
s_mov_b32 s63, 0
s_mov_b32 s34, 0
s_mov_b32 s32, 200000
s_mov_b32 s33, -1
s_cmp_ge_u32 s3, 4
s_cselect_b32 s66, 3, 1
s_and_b32 s58, s3, s66
s_waitcnt lgkmcnt(0)
s_mov_b32 s8, s36
s_mov_b32 s9, s37
s_mov_b32 s10, 0x400000
s_mov_b32 s11, 0x00020000
s_mov_b32 s12, s38
s_mov_b32 s13, s39
s_mov_b32 s14, 0x600000
s_mov_b32 s15, 0x00020000
s_mov_b32 s16, s40
s_mov_b32 s17, s41
s_mov_b32 s18, 0x200000
s_mov_b32 s19, 0x00020000
s_mov_b32 s20, s56
s_mov_b32 s21, s57
s_mov_b32 s22, 0x2500000
s_mov_b32 s23, 0x00020000
s_add_u32 s24, s56, 30408704
s_addc_u32 s25, s57, 0
s_mov_b32 s26, 5898240
s_mov_b32 s27, 0x00020000
s_mov_b32 s28, s52
s_mov_b32 s29, s53
s_mov_b32 s30, 0x400000
s_mov_b32 s31, 0x00020000
s_cmp_ge_u32 s3, 4
s_cbranch_scc1 L_m
s_cmp_ge_u32 s3, 2
s_cbranch_scc1 L_f
s_setprio 1
v_and_b32 v22, 7, v0
v_lshrrev_b32 v23, 4, v0
v_lshrrev_b32 v6, 3, v0
v_xor_b32 v7, v22, v23
v_lshlrev_b32 v7, 4, v7
v_lshl_add_u32 v8, v6, 11, v7
v_xor_b32 v7, 64, v8
v_add_u32 v9, 15360, v7
v_add_u32 v10, 30720, v8
v_add_u32 v11, 46080, v7
s_lshl_b32 s70, s59, 18
s_lshl_b32 s71, s58, 16
s_add_u32 s68, s70, s71
s_sub_u32 s69, s70, s71
s_add_u32 s69, s69, 196608
s_mov_b32 s67, 128
s_lshl_b32 s75, s58, 13
s_mov_b32 s65, 86016
s_lshr_b32 s70, s59, 3
s_lshl1_add_u32 s70, s59, s70
s_lshr_b32 s71, s60, 2
s_lshl2_add_u32 s71, s60, s71
s_add_u32 s70, s70, s71
s_and_b32 s64, s70, 15
s_mul_i32 s70, s64, s67
s_add_u32 m0, s65, s75
s_add_u32 s71, s70, s68
buffer_load_dwordx4 v8, s[8:11], s71 offen offset:0 lds
buffer_load_dwordx4 v9, s[8:11], s71 offen offset:1024 lds
buffer_load_dwordx4 v10, s[8:11], s71 offen offset:2048 lds
buffer_load_dwordx4 v11, s[8:11], s71 offen offset:3072 lds
s_add_u32 m0, m0, 4096
s_add_u32 s71, s70, s69
buffer_load_dwordx4 v8, s[8:11], s71 offen offset:0 lds
buffer_load_dwordx4 v9, s[8:11], s71 offen offset:1024 lds
buffer_load_dwordx4 v10, s[8:11], s71 offen offset:2048 lds
buffer_load_dwordx4 v11, s[8:11], s71 offen offset:3072 lds
v_and_b32 v7, 2, v6
v_xor_b32 v7, v7, v22
v_mul_u32_u24 v6, 6144, v6
v_lshl_add_u32 v12, v7, 4, v6
v_xor_b32 v6, 64, v12
v_add_u32 v13, 48128, v6
v_add_u32 v14, 96256, v12
v_add_u32 v15, 144384, v6
s_mul_i32 s76, s58, 12288
s_add_u32 s76, s76, 16384
s_lshl_b32 s70, s60, 7
s_cmp_eq_u32 s58, 0
s_mov_b32 s71, 198656
s_cselect_b32 s72, 0, s71
s_mov_b32 s71, 4096
s_cselect_b32 s73, 196608, s71
s_mov_b32 s71, 200704
s_cselect_b32 s74, 2048, s71
s_add_u32 s72, s72, s70
s_add_u32 s73, s73, s70
s_add_u32 s74, s74, s70
s_mul_i32 s70, s64, 393216
s_add_u32 m0, s65, s76
s_add_u32 s71, s70, s72
buffer_load_dwordx4 v12, s[12:15], s71 offen offset:0 lds
buffer_load_dwordx4 v13, s[12:15], s71 offen offset:1024 lds
buffer_load_dwordx4 v14, s[12:15], s71 offen offset:2048 lds
buffer_load_dwordx4 v15, s[12:15], s71 offen offset:3072 lds
s_add_u32 m0, m0, 4096
s_add_u32 s71, s70, s73
buffer_load_dwordx4 v12, s[12:15], s71 offen offset:0 lds
buffer_load_dwordx4 v13, s[12:15], s71 offen offset:1024 lds
buffer_load_dwordx4 v14, s[12:15], s71 offen offset:2048 lds
buffer_load_dwordx4 v15, s[12:15], s71 offen offset:3072 lds
s_add_u32 m0, m0, 4096
s_add_u32 s71, s70, s74
buffer_load_dwordx4 v12, s[12:15], s71 offen offset:0 lds
buffer_load_dwordx4 v13, s[12:15], s71 offen offset:1024 lds
buffer_load_dwordx4 v14, s[12:15], s71 offen offset:2048 lds
buffer_load_dwordx4 v15, s[12:15], s71 offen offset:3072 lds
s_add_u32 s64, s64, 1
s_and_b32 s64, s64, 15
s_sub_u32 s65, s65, 40960
s_cselect_b32 s65, 86016, s65
v_and_b32 v1, 3, v0
v_lshlrev_b32 v1, 2, v1
v_and_b32 v2, 4, v1
s_lshl2_add_u32 s35, s58, 16
v_mov_b32 v3, s35
v_lshlrev_b32 v20, 4, v0
v_lshrrev_b32 v6, 2, v0
v_lshl_add_u32 v21, v6, 7, v1
v_lshrrev_b32 v6, 3, v0
v_lshlrev_b32 v23, 1, v23
v_xor_b32 v23, v23, v22
v_lshlrev_b32 v23, 4, v23
v_lshl_add_u32 v23, v6, 11, v23
s_lshl_b32 s70, s62, 7
s_lshl_b32 s71, s58, 16
s_add_u32 s70, s70, s71
v_add_u32 v16, s70, v23
v_add_u32 v17, 15360, v16
v_add_u32 v18, 30720, v16
v_add_u32 v19, 46080, v16
s_add_u32 s77, s61, s62
s_lshl_b32 s77, s77, 17
s_lshl_b32 s78, s58, 12
s_mov_b32 s66, -2
s_barrier
.p2align 4
lq_1:
s_add_u32 s35, s66, 1
lw_4:
ds_read_b32 v5, v1 offset:0
s_waitcnt lgkmcnt(0)
v_cmp_gt_i32 vcc, s35, v5
s_cbranch_vccz lwd_5
s_sub_u32 s32, s32, 1
s_cmp_gt_i32 s32, 0
s_cbranch_scc1 lw_4
lwd_5:
s_cmp_eq_u32 s66, 0
s_cbranch_scc1 lcs_2
lcb_3:
s_mul_i32 s70, s64, s67
s_add_u32 m0, s65, s75
s_add_u32 s71, s70, s68
buffer_load_dwordx4 v8, s[8:11], s71 offen offset:0 sc1 lds
buffer_load_dwordx4 v9, s[8:11], s71 offen offset:1024 sc1 lds
buffer_load_dwordx4 v10, s[8:11], s71 offen offset:2048 sc1 lds
buffer_load_dwordx4 v11, s[8:11], s71 offen offset:3072 sc1 lds
buffer_load_dword v30, off, s[12:15], 0
s_add_u32 m0, m0, 4096
s_add_u32 s71, s70, s69
buffer_load_dwordx4 v8, s[8:11], s71 offen offset:0 sc1 lds
buffer_load_dwordx4 v9, s[8:11], s71 offen offset:1024 sc1 lds
buffer_load_dwordx4 v10, s[8:11], s71 offen offset:2048 sc1 lds
buffer_load_dwordx4 v11, s[8:11], s71 offen offset:3072 sc1 lds
buffer_load_dword v30, off, s[12:15], 0
s_mul_i32 s70, s64, 393216
s_add_u32 m0, s65, s76
s_add_u32 s71, s70, s72
buffer_load_dwordx4 v12, s[12:15], s71 offen offset:0 lds
buffer_load_dwordx4 v13, s[12:15], s71 offen offset:1024 lds
buffer_load_dwordx4 v14, s[12:15], s71 offen offset:2048 lds
buffer_load_dwordx4 v15, s[12:15], s71 offen offset:3072 lds
buffer_load_dword v30, off, s[12:15], 0
v_add_u32 v5, s66, 3
s_mov_b64 exec, 1
s_waitcnt vmcnt(15)
ds_write_b32 v3, v5
s_mov_b64 exec, -1
s_mul_i32 s70, s64, 393216
s_add_u32 m0, m0, 4096
s_add_u32 s71, s70, s73
buffer_load_dwordx4 v12, s[12:15], s71 offen offset:0 lds
buffer_load_dwordx4 v13, s[12:15], s71 offen offset:1024 lds
buffer_load_dwordx4 v14, s[12:15], s71 offen offset:2048 lds
buffer_load_dwordx4 v15, s[12:15], s71 offen offset:3072 lds
buffer_load_dword v30, off, s[12:15], 0
s_mul_i32 s70, s64, 393216
s_add_u32 m0, m0, 4096
s_add_u32 s71, s70, s74
buffer_load_dwordx4 v12, s[12:15], s71 offen offset:0 lds
buffer_load_dwordx4 v13, s[12:15], s71 offen offset:1024 lds
buffer_load_dwordx4 v14, s[12:15], s71 offen offset:2048 lds
buffer_load_dwordx4 v15, s[12:15], s71 offen offset:3072 lds
buffer_load_dword v30, off, s[12:15], 0
s_add_u32 s64, s64, 1
s_and_b32 s64, s64, 15
s_sub_u32 s65, s65, 40960
s_cselect_b32 s65, 86016, s65
s_add_u32 s66, s66, 1
s_and_b32 s70, s66, 31
s_cmp_eq_u32 s70, 13
s_cbranch_scc0 lq_1
s_waitcnt vmcnt(0)
v_add_u32 v5, s34, 16
s_mov_b64 exec, 1
ds_write_b32 v3, v5
s_mov_b64 exec, -1
s_add_u32 s35, s34, 14
lw_6:
ds_read_b32 v5, v1 offset:0
s_waitcnt lgkmcnt(0)
v_cmp_gt_i32 vcc, s35, v5
s_cbranch_vccz lwd_7
s_sleep 1
s_sub_u32 s32, s32, 1
s_cmp_gt_i32 s32, 0
s_cbranch_scc1 lw_6
lwd_7:
s_add_u32 s70, s77, 262144
s_add_u32 m0, s78, 49152
s_and_b32 s70, s70, 0x1fffff
buffer_load_dwordx4 v16, s[16:19], s70 offen offset:0 lds
buffer_load_dwordx4 v17, s[16:19], s70 offen offset:1024 lds
buffer_load_dwordx4 v18, s[16:19], s70 offen offset:2048 lds
buffer_load_dwordx4 v19, s[16:19], s70 offen offset:3072 lds
buffer_load_dword v30, off, s[12:15], 0
s_add_u32 s70, s77, 393216
s_add_u32 m0, s78, 57344
s_and_b32 s70, s70, 0x1fffff
buffer_load_dwordx4 v16, s[16:19], s70 offen offset:0 lds
buffer_load_dwordx4 v17, s[16:19], s70 offen offset:1024 lds
buffer_load_dwordx4 v18, s[16:19], s70 offen offset:2048 lds
buffer_load_dwordx4 v19, s[16:19], s70 offen offset:3072 lds
buffer_load_dword v30, off, s[12:15], 0
s_add_u32 s70, s77, 524288
s_add_u32 m0, s78, 65536
s_and_b32 s70, s70, 0x1fffff
buffer_load_dwordx4 v16, s[16:19], s70 offen offset:0 lds
buffer_load_dwordx4 v17, s[16:19], s70 offen offset:1024 lds
buffer_load_dwordx4 v18, s[16:19], s70 offen offset:2048 lds
buffer_load_dwordx4 v19, s[16:19], s70 offen offset:3072 lds
buffer_load_dword v30, off, s[12:15], 0
s_add_u32 s70, s77, 655360
s_add_u32 m0, s78, 73728
s_and_b32 s70, s70, 0x1fffff
buffer_load_dwordx4 v16, s[16:19], s70 offen offset:0 lds
buffer_load_dwordx4 v17, s[16:19], s70 offen offset:1024 lds
buffer_load_dwordx4 v18, s[16:19], s70 offen offset:2048 lds
buffer_load_dwordx4 v19, s[16:19], s70 offen offset:3072 lds
buffer_load_dword v30, off, s[12:15], 0
s_sub_u32 s70, s59, s58
s_lshl4_add_u32 s70, s70, s60
s_sub_u32 s70, s70, 16
s_lshl_b32 s66, s70, 7
s_add_u32 s66, s66, 360448
s_lshl_b32 s70, s70, 15
s_lshl_b32 s71, s63, 23
s_add_u32 s70, s70, s71
s_add_u32 s64, s70, 1077248
s_mul_i32 s65, s58, -94208
s_add_u32 s35, s34, 16
lw_8:
ds_read_b32 v5, v1 offset:0
s_waitcnt lgkmcnt(0)
v_cmp_gt_i32 vcc, s35, v5
s_cbranch_vccz lwd_9
s_sleep 1
s_sub_u32 s32, s32, 1
s_cmp_gt_i32 s32, 0
s_cbranch_scc1 lw_8
lwd_9:
s_add_u32 s70, s77, 131072
s_add_u32 m0, s78, 40960
s_and_b32 s70, s70, 0x1fffff
buffer_load_dwordx4 v16, s[16:19], s70 offen offset:0 lds
buffer_load_dwordx4 v17, s[16:19], s70 offen offset:1024 lds
buffer_load_dwordx4 v18, s[16:19], s70 offen offset:2048 lds
buffer_load_dwordx4 v19, s[16:19], s70 offen offset:3072 lds
buffer_load_dword v30, off, s[12:15], 0
s_add_u32 s70, s77, 786432
s_add_u32 m0, s78, 81920
s_and_b32 s70, s70, 0x1fffff
buffer_load_dwordx4 v16, s[16:19], s70 offen offset:0 lds
buffer_load_dwordx4 v17, s[16:19], s70 offen offset:1024 lds
buffer_load_dwordx4 v18, s[16:19], s70 offen offset:2048 lds
buffer_load_dwordx4 v19, s[16:19], s70 offen offset:3072 lds
buffer_load_dword v30, off, s[12:15], 0
s_add_u32 s70, s77, 917504
s_add_u32 m0, s78, 90112
s_and_b32 s70, s70, 0x1fffff
buffer_load_dwordx4 v16, s[16:19], s70 offen offset:0 lds
buffer_load_dwordx4 v17, s[16:19], s70 offen offset:1024 lds
buffer_load_dwordx4 v18, s[16:19], s70 offen offset:2048 lds
buffer_load_dwordx4 v19, s[16:19], s70 offen offset:3072 lds
buffer_load_dword v30, off, s[12:15], 0
s_add_u32 s35, s34, 17
lw_11:
ds_read_b32 v5, v1 offset:0
s_waitcnt lgkmcnt(0)
v_cmp_gt_i32 vcc, s35, v5
s_cbranch_vccz lwd_12
s_sleep 1
s_sub_u32 s32, s32, 1
s_cmp_gt_i32 s32, 0
s_cbranch_scc1 lw_11
lwd_12:
s_cmp_gt_u32 s59, s58
s_cbranch_scc0 nokv_10
poll_13:
buffer_load_dword v6, v1, s[24:27], s66 offen sc1
pchk_14:
s_waitcnt vmcnt(0)
v_cmp_eq_u32 vcc, 0, v6
s_cbranch_vccz pdone_15
s_sub_u32 s32, s32, 1
s_cmp_gt_i32 s32, 0
s_cbranch_scc1 poll_13
pdone_15:
s_add_u32 m0, s65, 126976
s_nop 0
buffer_load_dwordx4 v20, s[20:23], s64 offen offset:0 sc1 lds
buffer_load_dwordx4 v20, s[20:23], s64 offen offset:1024 sc1 lds
buffer_load_dwordx4 v20, s[20:23], s64 offen offset:2048 sc1 lds
buffer_load_dwordx4 v20, s[20:23], s64 offen offset:3072 sc1 lds
buffer_load_dword v30, off, s[12:15], 0
s_add_u32 m0, s65, 122880
s_sub_u32 s64, s64, 4096
buffer_load_dwordx4 v20, s[20:23], s64 offen offset:0 sc1 lds
buffer_load_dwordx4 v20, s[20:23], s64 offen offset:1024 sc1 lds
buffer_load_dwordx4 v20, s[20:23], s64 offen offset:2048 sc1 lds
buffer_load_dwordx4 v20, s[20:23], s64 offen offset:3072 sc1 lds
buffer_load_dword v30, off, s[12:15], 0
s_add_u32 m0, s65, 118784
s_sub_u32 s64, s64, 4096
buffer_load_dwordx4 v20, s[20:23], s64 offen offset:0 sc1 lds
buffer_load_dwordx4 v20, s[20:23], s64 offen offset:1024 sc1 lds
buffer_load_dwordx4 v20, s[20:23], s64 offen offset:2048 sc1 lds
buffer_load_dwordx4 v20, s[20:23], s64 offen offset:3072 sc1 lds
buffer_load_dword v30, off, s[12:15], 0
s_add_u32 m0, s65, 114688
s_sub_u32 s64, s64, 4096
buffer_load_dwordx4 v20, s[20:23], s64 offen offset:0 sc1 lds
buffer_load_dwordx4 v20, s[20:23], s64 offen offset:1024 sc1 lds
buffer_load_dwordx4 v20, s[20:23], s64 offen offset:2048 sc1 lds
buffer_load_dwordx4 v20, s[20:23], s64 offen offset:3072 sc1 lds
buffer_load_dword v30, off, s[12:15], 0
s_add_u32 m0, s65, 110592
s_sub_u32 s64, s64, 4096
buffer_load_dwordx4 v20, s[20:23], s64 offen offset:0 sc1 lds
buffer_load_dwordx4 v20, s[20:23], s64 offen offset:1024 sc1 lds
buffer_load_dwordx4 v20, s[20:23], s64 offen offset:2048 sc1 lds
buffer_load_dwordx4 v20, s[20:23], s64 offen offset:3072 sc1 lds
buffer_load_dword v30, off, s[12:15], 0
s_add_u32 m0, s65, 106496
s_sub_u32 s64, s64, 4096
buffer_load_dwordx4 v20, s[20:23], s64 offen offset:0 sc1 lds
buffer_load_dwordx4 v20, s[20:23], s64 offen offset:1024 sc1 lds
buffer_load_dwordx4 v20, s[20:23], s64 offen offset:2048 sc1 lds
buffer_load_dwordx4 v20, s[20:23], s64 offen offset:3072 sc1 lds
buffer_load_dword v30, off, s[12:15], 0
s_add_u32 m0, s65, 102400
s_sub_u32 s64, s64, 4096
buffer_load_dwordx4 v20, s[20:23], s64 offen offset:0 sc1 lds
buffer_load_dwordx4 v20, s[20:23], s64 offen offset:1024 sc1 lds
buffer_load_dwordx4 v20, s[20:23], s64 offen offset:2048 sc1 lds
buffer_load_dwordx4 v20, s[20:23], s64 offen offset:3072 sc1 lds
buffer_load_dword v30, off, s[12:15], 0
s_add_u32 m0, s65, 98304
s_sub_u32 s64, s64, 4096
buffer_load_dwordx4 v20, s[20:23], s64 offen offset:0 sc1 lds
buffer_load_dwordx4 v20, s[20:23], s64 offen offset:1024 sc1 lds
buffer_load_dwordx4 v20, s[20:23], s64 offen offset:2048 sc1 lds
buffer_load_dwordx4 v20, s[20:23], s64 offen offset:3072 sc1 lds
buffer_load_dword v30, off, s[12:15], 0
nokv_10:
s_waitcnt vmcnt(0)
v_add_u32 v5, s34, 17
s_mov_b64 exec, 1
ds_write_b32 v3, v5
s_mov_b64 exec, -1
s_add_u32 s35, s34, 18
lw_16:
ds_read_b32 v5, v1 offset:0
s_waitcnt lgkmcnt(0)
v_cmp_gt_i32 vcc, s35, v5
s_cbranch_vccz lwd_17
s_sleep 1
s_sub_u32 s32, s32, 1
s_cmp_gt_i32 s32, 0
s_cbranch_scc1 lw_16
lwd_17:
s_add_u32 s70, s77, 1572864
s_add_u32 m0, s78, 131072
s_and_b32 s70, s70, 0x1fffff
buffer_load_dwordx4 v16, s[16:19], s70 offen offset:0 lds
buffer_load_dwordx4 v17, s[16:19], s70 offen offset:1024 lds
buffer_load_dwordx4 v18, s[16:19], s70 offen offset:2048 lds
buffer_load_dwordx4 v19, s[16:19], s70 offen offset:3072 lds
buffer_load_dword v30, off, s[12:15], 0
s_add_u32 s70, s77, 1703936
s_add_u32 m0, s78, 139264
s_and_b32 s70, s70, 0x1fffff
buffer_load_dwordx4 v16, s[16:19], s70 offen offset:0 lds
buffer_load_dwordx4 v17, s[16:19], s70 offen offset:1024 lds
buffer_load_dwordx4 v18, s[16:19], s70 offen offset:2048 lds
buffer_load_dwordx4 v19, s[16:19], s70 offen offset:3072 lds
buffer_load_dword v30, off, s[12:15], 0
s_add_u32 s70, s77, 1835008
s_add_u32 m0, s78, 147456
s_and_b32 s70, s70, 0x1fffff
buffer_load_dwordx4 v16, s[16:19], s70 offen offset:0 lds
buffer_load_dwordx4 v17, s[16:19], s70 offen offset:1024 lds
buffer_load_dwordx4 v18, s[16:19], s70 offen offset:2048 lds
buffer_load_dwordx4 v19, s[16:19], s70 offen offset:3072 lds
buffer_load_dword v30, off, s[12:15], 0
s_add_u32 s70, s77, 1966080
s_add_u32 m0, s78, 155648
s_and_b32 s70, s70, 0x1fffff
buffer_load_dwordx4 v16, s[16:19], s70 offen offset:0 lds
buffer_load_dwordx4 v17, s[16:19], s70 offen offset:1024 lds
buffer_load_dwordx4 v18, s[16:19], s70 offen offset:2048 lds
buffer_load_dwordx4 v19, s[16:19], s70 offen offset:3072 lds
buffer_load_dword v30, off, s[12:15], 0
s_add_u32 s35, s34, 19
lw_18:
ds_read_b32 v5, v1 offset:0
s_waitcnt lgkmcnt(0)
v_cmp_gt_i32 vcc, s35, v5
s_cbranch_vccz lwd_19
s_sleep 2
s_sub_u32 s32, s32, 1
s_cmp_gt_i32 s32, 0
s_cbranch_scc1 lw_18
lwd_19:
s_add_u32 s70, s77, 1048576
s_add_u32 m0, s78, 98304
s_and_b32 s70, s70, 0x1fffff
buffer_load_dwordx4 v16, s[16:19], s70 offen offset:0 lds
buffer_load_dwordx4 v17, s[16:19], s70 offen offset:1024 lds
buffer_load_dwordx4 v18, s[16:19], s70 offen offset:2048 lds
buffer_load_dwordx4 v19, s[16:19], s70 offen offset:3072 lds
buffer_load_dword v30, off, s[12:15], 0
s_add_u32 s70, s77, 1179648
s_add_u32 m0, s78, 106496
s_and_b32 s70, s70, 0x1fffff
buffer_load_dwordx4 v16, s[16:19], s70 offen offset:0 lds
buffer_load_dwordx4 v17, s[16:19], s70 offen offset:1024 lds
buffer_load_dwordx4 v18, s[16:19], s70 offen offset:2048 lds
buffer_load_dwordx4 v19, s[16:19], s70 offen offset:3072 lds
buffer_load_dword v30, off, s[12:15], 0
s_add_u32 s70, s77, 1310720
s_add_u32 m0, s78, 114688
s_and_b32 s70, s70, 0x1fffff
buffer_load_dwordx4 v16, s[16:19], s70 offen offset:0 lds
buffer_load_dwordx4 v17, s[16:19], s70 offen offset:1024 lds
buffer_load_dwordx4 v18, s[16:19], s70 offen offset:2048 lds
buffer_load_dwordx4 v19, s[16:19], s70 offen offset:3072 lds
buffer_load_dword v30, off, s[12:15], 0
s_add_u32 s70, s77, 1441792
s_add_u32 m0, s78, 122880
s_and_b32 s70, s70, 0x1fffff
buffer_load_dwordx4 v16, s[16:19], s70 offen offset:0 lds
buffer_load_dwordx4 v17, s[16:19], s70 offen offset:1024 lds
buffer_load_dwordx4 v18, s[16:19], s70 offen offset:2048 lds
buffer_load_dwordx4 v19, s[16:19], s70 offen offset:3072 lds
buffer_load_dword v30, off, s[12:15], 0
s_add_u32 s35, s34, 20
lw_20:
ds_read_b32 v5, v1 offset:0
s_waitcnt lgkmcnt(0)
v_cmp_gt_i32 vcc, s35, v5
s_cbranch_vccz lwd_21
s_sleep 2
s_sub_u32 s32, s32, 1
s_cmp_gt_i32 s32, 0
s_cbranch_scc1 lw_20
lwd_21:
s_add_u32 s70, s77, 0
s_add_u32 m0, s78, 32768
s_and_b32 s70, s70, 0x1fffff
buffer_load_dwordx4 v16, s[16:19], s70 offen offset:0 lds
buffer_load_dwordx4 v17, s[16:19], s70 offen offset:1024 lds
buffer_load_dwordx4 v18, s[16:19], s70 offen offset:2048 lds
buffer_load_dwordx4 v19, s[16:19], s70 offen offset:3072 lds
buffer_load_dword v30, off, s[12:15], 0
s_lshl_b32 s66, s61, 11
s_add_u32 s66, s66, 327680
s_cmp_eq_u32 s58, 0
s_cbranch_scc0 nofo_22
s_add_u32 s35, s34, 21
lw_23:
ds_read_b32 v5, v1 offset:0
s_waitcnt lgkmcnt(0)
v_cmp_gt_i32 vcc, s35, v5
s_cbranch_vccz lwd_24
s_sleep 1
s_sub_u32 s32, s32, 1
s_cmp_gt_i32 s32, 0
s_cbranch_scc1 lw_23
lwd_24:
poll_25:
buffer_load_dword v6, v21, s[24:27], s66 offen sc1
pchk_26:
s_waitcnt vmcnt(0)
v_cmp_eq_u32 vcc, 0, v6
s_cbranch_vccz pdone_27
s_sub_u32 s32, s32, 1
s_cmp_gt_i32 s32, 0
s_cbranch_scc1 poll_25
pdone_27:
nofo_22:
s_waitcnt vmcnt(0)
v_add_u32 v5, s34, 18
s_mov_b64 exec, 1
ds_write_b32 v3, v5
s_mov_b64 exec, -1
s_cmp_eq_u32 s63, 0
s_cbranch_scc0 L_end
v_bfe_u32 v6, v0, 3, 2
v_and_b32 v7, 2, v6
v_xor_b32 v7, v7, v22
v_lshrrev_b32 v23, 5, v0
v_lshl_add_u32 v6, v23, 4, v6
v_mul_u32_u24 v6, 6144, v6
v_lshl_add_u32 v12, v7, 4, v6
v_xor_b32 v6, 64, v12
v_add_u32 v13, 23552, v6
v_add_u32 v14, 47104, v12
v_add_u32 v15, 70656, v6
v_mov_b32 v8, v20
v_mov_b32 v9, v20
v_mov_b32 v10, v20
v_mov_b32 v11, v20
s_mov_b32 s8, s56
s_mov_b32 s9, s57
s_mov_b32 s10, 0x2500000
s_mov_b32 s11, 0x00020000
s_lshl_b32 s70, s59, 18
s_add_u32 s70, s70, 26214400
s_add_u32 s68, s70, s78
s_sub_u32 s69, s70, s78
s_add_u32 s69, s69, 12288
s_mov_b32 s67, 16384
s_lshl_b32 s66, s59, 11
s_add_u32 s66, s66, 2883584
s_and_b32 s64, s61, 14
s_mov_b32 s65, 86016
s_add_u32 s35, s34, 22
lw_28:
ds_read_b32 v5, v1 offset:0
s_waitcnt lgkmcnt(0)
v_cmp_gt_i32 vcc, s35, v5
s_cbranch_vccz lwd_29
s_sleep 2
s_sub_u32 s32, s32, 1
s_cmp_gt_i32 s32, 0
s_cbranch_scc1 lw_28
lwd_29:
s_mul_i32 s70, s64, 393216
s_add_u32 m0, s65, s76
s_add_u32 s71, s70, s72
buffer_load_dwordx4 v12, s[12:15], s71 offen offset:0 lds
buffer_load_dwordx4 v13, s[12:15], s71 offen offset:1024 lds
buffer_load_dwordx4 v14, s[12:15], s71 offen offset:2048 lds
buffer_load_dwordx4 v15, s[12:15], s71 offen offset:3072 lds
buffer_load_dword v30, off, s[12:15], 0
s_add_u32 m0, m0, 4096
s_add_u32 s71, s70, s73
buffer_load_dwordx4 v12, s[12:15], s71 offen offset:0 lds
buffer_load_dwordx4 v13, s[12:15], s71 offen offset:1024 lds
buffer_load_dwordx4 v14, s[12:15], s71 offen offset:2048 lds
buffer_load_dwordx4 v15, s[12:15], s71 offen offset:3072 lds
buffer_load_dword v30, off, s[12:15], 0
s_add_u32 m0, m0, 4096
s_add_u32 s71, s70, s74
buffer_load_dwordx4 v12, s[12:15], s71 offen offset:0 lds
buffer_load_dwordx4 v13, s[12:15], s71 offen offset:1024 lds
buffer_load_dwordx4 v14, s[12:15], s71 offen offset:2048 lds
buffer_load_dwordx4 v15, s[12:15], s71 offen offset:3072 lds
buffer_load_dword v30, off, s[12:15], 0
s_add_u32 s64, s64, 1
s_and_b32 s64, s64, 15
s_sub_u32 s65, s65, 40960
s_cselect_b32 s65, 86016, s65
s_mul_i32 s70, s64, 393216
s_add_u32 m0, s65, s76
s_add_u32 s71, s70, s72
buffer_load_dwordx4 v12, s[12:15], s71 offen offset:0 lds
buffer_load_dwordx4 v13, s[12:15], s71 offen offset:1024 lds
buffer_load_dwordx4 v14, s[12:15], s71 offen offset:2048 lds
buffer_load_dwordx4 v15, s[12:15], s71 offen offset:3072 lds
buffer_load_dword v30, off, s[12:15], 0
s_add_u32 m0, m0, 4096
s_add_u32 s71, s70, s73
buffer_load_dwordx4 v12, s[12:15], s71 offen offset:0 lds
buffer_load_dwordx4 v13, s[12:15], s71 offen offset:1024 lds
buffer_load_dwordx4 v14, s[12:15], s71 offen offset:2048 lds
buffer_load_dwordx4 v15, s[12:15], s71 offen offset:3072 lds
buffer_load_dword v30, off, s[12:15], 0
s_add_u32 m0, m0, 4096
s_add_u32 s71, s70, s74
buffer_load_dwordx4 v12, s[12:15], s71 offen offset:0 lds
buffer_load_dwordx4 v13, s[12:15], s71 offen offset:1024 lds
buffer_load_dwordx4 v14, s[12:15], s71 offen offset:2048 lds
buffer_load_dwordx4 v15, s[12:15], s71 offen offset:3072 lds
buffer_load_dword v30, off, s[12:15], 0
s_add_u32 s64, s64, 1
s_and_b32 s64, s64, 15
s_sub_u32 s65, s65, 40960
s_cselect_b32 s65, 86016, s65
s_mul_i32 s70, s64, 393216
s_add_u32 m0, s65, s76
s_add_u32 s71, s70, s72
buffer_load_dwordx4 v12, s[12:15], s71 offen offset:0 lds
buffer_load_dwordx4 v13, s[12:15], s71 offen offset:1024 lds
buffer_load_dwordx4 v14, s[12:15], s71 offen offset:2048 lds
buffer_load_dwordx4 v15, s[12:15], s71 offen offset:3072 lds
buffer_load_dword v30, off, s[12:15], 0
s_add_u32 m0, m0, 4096
s_add_u32 s71, s70, s73
buffer_load_dwordx4 v12, s[12:15], s71 offen offset:0 lds
buffer_load_dwordx4 v13, s[12:15], s71 offen offset:1024 lds
buffer_load_dwordx4 v14, s[12:15], s71 offen offset:2048 lds
buffer_load_dwordx4 v15, s[12:15], s71 offen offset:3072 lds
buffer_load_dword v30, off, s[12:15], 0
s_add_u32 m0, m0, 4096
s_add_u32 s71, s70, s74
buffer_load_dwordx4 v12, s[12:15], s71 offen offset:0 lds
buffer_load_dwordx4 v13, s[12:15], s71 offen offset:1024 lds
buffer_load_dwordx4 v14, s[12:15], s71 offen offset:2048 lds
buffer_load_dwordx4 v15, s[12:15], s71 offen offset:3072 lds
buffer_load_dword v30, off, s[12:15], 0
s_add_u32 s64, s64, 1
s_and_b32 s64, s64, 15
s_sub_u32 s65, s65, 40960
s_cselect_b32 s65, 86016, s65
s_mov_b32 s36, s64
s_mov_b32 s37, s65
s_mov_b32 s64, s59
s_mov_b32 s65, 114688
s_mul_i32 s70, s64, 393216
s_add_u32 m0, s65, s76
s_add_u32 s71, s70, s72
buffer_load_dwordx4 v12, s[12:15], s71 offen offset:0 lds
buffer_load_dwordx4 v13, s[12:15], s71 offen offset:1024 lds
buffer_load_dwordx4 v14, s[12:15], s71 offen offset:2048 lds
buffer_load_dwordx4 v15, s[12:15], s71 offen offset:3072 lds
buffer_load_dword v30, off, s[12:15], 0
s_add_u32 m0, m0, 4096
s_add_u32 s71, s70, s73
buffer_load_dwordx4 v12, s[12:15], s71 offen offset:0 lds
buffer_load_dwordx4 v13, s[12:15], s71 offen offset:1024 lds
buffer_load_dwordx4 v14, s[12:15], s71 offen offset:2048 lds
buffer_load_dwordx4 v15, s[12:15], s71 offen offset:3072 lds
buffer_load_dword v30, off, s[12:15], 0
s_add_u32 m0, m0, 4096
s_add_u32 s71, s70, s74
buffer_load_dwordx4 v12, s[12:15], s71 offen offset:0 lds
buffer_load_dwordx4 v13, s[12:15], s71 offen offset:1024 lds
buffer_load_dwordx4 v14, s[12:15], s71 offen offset:2048 lds
buffer_load_dwordx4 v15, s[12:15], s71 offen offset:3072 lds
buffer_load_dword v30, off, s[12:15], 0
s_mov_b32 s64, s36
s_mov_b32 s65, s37
s_and_b32 s64, s61, 14
s_mov_b32 s65, 86016
s_add_u32 s35, s34, 23
lw_30:
ds_read_b32 v5, v1 offset:0
s_waitcnt lgkmcnt(0)
v_cmp_gt_i32 vcc, s35, v5
s_cbranch_vccz lwd_31
s_sleep 1
s_sub_u32 s32, s32, 1
s_cmp_gt_i32 s32, 0
s_cbranch_scc1 lw_30
lwd_31:
poll_32:
buffer_load_dword v6, v21, s[24:27], s66 offen sc1
pchk_33:
s_waitcnt vmcnt(0)
v_cmp_eq_u32 vcc, 0, v6
s_cbranch_vccz pdone_34
s_sub_u32 s32, s32, 1
s_cmp_gt_i32 s32, 0
s_cbranch_scc1 poll_32
pdone_34:
s_mul_i32 s70, s64, s67
s_add_u32 m0, s65, s75
s_add_u32 s71, s70, s68
buffer_load_dwordx4 v8, s[8:11], s71 offen offset:0 sc1 lds
buffer_load_dwordx4 v9, s[8:11], s71 offen offset:1024 sc1 lds
buffer_load_dwordx4 v10, s[8:11], s71 offen offset:2048 sc1 lds
buffer_load_dwordx4 v11, s[8:11], s71 offen offset:3072 sc1 lds
buffer_load_dword v30, off, s[12:15], 0
s_add_u32 m0, m0, 4096
s_add_u32 s71, s70, s69
buffer_load_dwordx4 v8, s[8:11], s71 offen offset:0 sc1 lds
buffer_load_dwordx4 v9, s[8:11], s71 offen offset:1024 sc1 lds
buffer_load_dwordx4 v10, s[8:11], s71 offen offset:2048 sc1 lds
buffer_load_dwordx4 v11, s[8:11], s71 offen offset:3072 sc1 lds
buffer_load_dword v30, off, s[12:15], 0
s_add_u32 s64, s64, 1
s_and_b32 s64, s64, 15
s_sub_u32 s65, s65, 40960
s_cselect_b32 s65, 86016, s65
s_mul_i32 s70, s64, s67
s_add_u32 m0, s65, s75
s_add_u32 s71, s70, s68
buffer_load_dwordx4 v8, s[8:11], s71 offen offset:0 sc1 lds
buffer_load_dwordx4 v9, s[8:11], s71 offen offset:1024 sc1 lds
buffer_load_dwordx4 v10, s[8:11], s71 offen offset:2048 sc1 lds
buffer_load_dwordx4 v11, s[8:11], s71 offen offset:3072 sc1 lds
buffer_load_dword v30, off, s[12:15], 0
s_add_u32 m0, m0, 4096
s_add_u32 s71, s70, s69
buffer_load_dwordx4 v8, s[8:11], s71 offen offset:0 sc1 lds
buffer_load_dwordx4 v9, s[8:11], s71 offen offset:1024 sc1 lds
buffer_load_dwordx4 v10, s[8:11], s71 offen offset:2048 sc1 lds
buffer_load_dwordx4 v11, s[8:11], s71 offen offset:3072 sc1 lds
buffer_load_dword v30, off, s[12:15], 0
s_add_u32 s64, s64, 1
s_and_b32 s64, s64, 15
s_sub_u32 s65, s65, 40960
s_cselect_b32 s65, 86016, s65
s_mul_i32 s70, s64, s67
s_add_u32 m0, s65, s75
s_add_u32 s71, s70, s68
buffer_load_dwordx4 v8, s[8:11], s71 offen offset:0 sc1 lds
buffer_load_dwordx4 v9, s[8:11], s71 offen offset:1024 sc1 lds
buffer_load_dwordx4 v10, s[8:11], s71 offen offset:2048 sc1 lds
buffer_load_dwordx4 v11, s[8:11], s71 offen offset:3072 sc1 lds
buffer_load_dword v30, off, s[12:15], 0
s_add_u32 m0, m0, 4096
s_add_u32 s71, s70, s69
buffer_load_dwordx4 v8, s[8:11], s71 offen offset:0 sc1 lds
buffer_load_dwordx4 v9, s[8:11], s71 offen offset:1024 sc1 lds
buffer_load_dwordx4 v10, s[8:11], s71 offen offset:2048 sc1 lds
buffer_load_dwordx4 v11, s[8:11], s71 offen offset:3072 sc1 lds
buffer_load_dword v30, off, s[12:15], 0
s_add_u32 s64, s64, 1
s_and_b32 s64, s64, 15
s_sub_u32 s65, s65, 40960
s_cselect_b32 s65, 86016, s65
s_waitcnt vmcnt(20)
v_add_u32 v5, s34, 33
s_mov_b64 exec, 1
ds_write_b32 v3, v5
s_mov_b64 exec, -1
s_waitcnt vmcnt(10)
v_add_u32 v5, s34, 34
s_mov_b64 exec, 1
ds_write_b32 v3, v5
s_mov_b64 exec, -1
s_mov_b32 s63, 1
s_mov_b32 s34, 32
s_add_u32 s24, s24, 2949120
s_addc_u32 s25, s25, 0
s_mov_b32 s26, 2949120
s_mov_b32 s66, 32
s_branch lq_1
lcs_2:
s_add_u32 s35, s34, 1
lw_35:
ds_read_b32 v5, v2 offset:24
s_waitcnt lgkmcnt(0)
v_cmp_gt_i32 vcc, s35, v5
s_cbranch_vccz lwd_36
s_sub_u32 s32, s32, 1
s_cmp_gt_i32 s32, 0
s_cbranch_scc1 lw_35
lwd_36:
s_branch lcb_3
L_f:
s_cmp_eq_u32 s58, 0
s_cbranch_scc0 fz_37
v_lshlrev_b32 v14, 4, v0
v_mov_b32 v56, 0
v_mov_b32 v57, 0
v_mov_b32 v58, 0
v_mov_b32 v59, 0
s_mul_i32 s70, s2, 1280
buffer_store_dwordx4 v[56:59], v14, s[24:27], s70 offen offset:0 sc1
buffer_store_dwordx4 v[56:59], v14, s[24:27], s70 offen offset:256 sc1
fz_37:
v_and_b32 v1, 3, v0
v_lshlrev_b32 v1, 2, v1
v_and_b32 v2, 4, v1
s_lshl2_add_u32 s35, s58, 24
v_mov_b32 v3, s35
s_mov_b32 s4, s54
s_mov_b32 s5, s55
s_mov_b32 s6, 0x100
s_mov_b32 s7, 0x00020000
s_and_b32 s70, s2, 7
s_lshr_b32 s71, s2, 3
s_mul_i32 s64, s70, 28
s_add_u32 s64, s64, s71
s_lshl_b32 s65, s70, 5
s_add_u32 s65, s65, s71
s_mov_b32 s69, 0x3f803f80
s_barrier
s_cmp_eq_u32 s58, 0
s_cselect_b32 s16, s46, s48
s_cselect_b32 s17, s47, s49
s_mov_b32 s12, s50
s_mov_b32 s13, s51
s_mov_b32 s14, 0x0
s_mov_b32 s15, 0x00020000
s_cmp_lt_u32 s2, 224
s_cselect_b32 s18, 7340032, 0
s_mov_b32 s14, s18
s_mov_b32 s70, s64
s_lshr_b32 s71, s70, 1
s_lshl_b32 s66, s71, 16
s_and_b32 s71, s70, 1
s_lshl3_add_u32 s71, s71, s58
s_lshl_b32 s71, s71, 10
s_add_u32 s66, s66, s71
s_and_b32 s71, s70, 31
s_mul_i32 s71, s71, 229376
s_lshr_b32 s70, s70, 5
s_lshl_b32 s70, s70, 10
s_add_u32 s77, s71, s70
v_lshlrev_b32 v4, 4, v0
s_and_b32 s73, s2, 3
s_lshl_b32 s73, s73, 6
v_mov_b32 v14, 1
s_sub_u32 exec_lo, 1, s58
s_mov_b32 exec_hi, 0
s_waitcnt vmcnt(0)
buffer_atomic_add v14, off, s[4:7], s73 sc1
s_mov_b64 exec, -1
v_mov_b32 v8, s69
v_mov_b32 v9, s69
v_mov_b32 v10, s69
v_mov_b32 v11, s69
v_mov_b32 v12, s69
v_mov_b32 v13, s69
v_mov_b32 v14, s69
v_mov_b32 v15, s69
s_mov_b32 s70, 102400
ftop_38:
v_lshrrev_b32 v6, 4, v0
v_bfe_u32 v7, v0, 2, 2
v_lshl_add_u32 v6, v6, 3, v7
v_bfe_u32 v7, v0, 3, 2
s_lshl_b32 s71, s58, 1
v_xor_b32 v7, s71, v7
v_lshl_add_u32 v7, v7, 5, s70
v_lshl_add_u32 v6, v6, 7, v7
v_lshl_add_u32 v6, v1, 1, v6
v_xor_b32 v7, 32, v6
v_mov_b32 v16, 0
v_mov_b32 v17, 0
v_mov_b32 v18, 0
v_mov_b32 v19, 0
v_mov_b32 v20, 0
v_mov_b32 v21, 0
v_mov_b32 v22, 0
v_mov_b32 v23, 0
s_lshl1_add_u32 s71, s63, s34
s_add_u32 s35, s71, 1
lw_39:
ds_read_b32 v5, v2 offset:16
s_waitcnt lgkmcnt(0)
v_cmp_gt_i32 vcc, s35, v5
s_cbranch_vccz lwd_40
s_sleep 1
s_sub_u32 s32, s32, 1
s_cmp_gt_i32 s32, 0
s_cbranch_scc1 lw_39
lwd_40:
ds_read_b64_tr_b16 v[24:25], v6 offset:0
ds_read_b64_tr_b16 v[26:27], v6 offset:512
ds_read_b64_tr_b16 v[28:29], v6 offset:4096
ds_read_b64_tr_b16 v[30:31], v6 offset:4608
ds_read_b64_tr_b16 v[32:33], v7 offset:0
ds_read_b64_tr_b16 v[34:35], v7 offset:512
ds_read_b64_tr_b16 v[36:37], v7 offset:4096
ds_read_b64_tr_b16 v[38:39], v7 offset:4608
ds_read_b64_tr_b16 v[40:41], v6 offset:8192
ds_read_b64_tr_b16 v[42:43], v6 offset:8704
ds_read_b64_tr_b16 v[44:45], v6 offset:12288
ds_read_b64_tr_b16 v[46:47], v6 offset:12800
ds_read_b64_tr_b16 v[48:49], v7 offset:8192
ds_read_b64_tr_b16 v[50:51], v7 offset:8704
ds_read_b64_tr_b16 v[52:53], v7 offset:12288
ds_read_b64_tr_b16 v[54:55], v7 offset:12800
v_dot2c_f32_bf16 v22, s69, v8
v_dot2c_f32_bf16 v23, v8, v8
v_dot2c_f32_bf16 v22, s69, v9
v_dot2c_f32_bf16 v23, v9, v9
v_dot2c_f32_bf16 v22, s69, v10
v_dot2c_f32_bf16 v23, v10, v10
v_dot2c_f32_bf16 v22, s69, v11
v_dot2c_f32_bf16 v23, v11, v11
v_dot2c_f32_bf16 v22, s69, v12
v_dot2c_f32_bf16 v23, v12, v12
v_dot2c_f32_bf16 v22, s69, v13
v_dot2c_f32_bf16 v23, v13, v13
v_dot2c_f32_bf16 v22, s69, v14
v_dot2c_f32_bf16 v23, v14, v14
v_dot2c_f32_bf16 v22, s69, v15
v_dot2c_f32_bf16 v23, v15, v15
s_waitcnt lgkmcnt(14)
v_dot2c_f32_bf16 v16, v8, v24
s_waitcnt lgkmcnt(11)
v_dot2c_f32_bf16 v17, v8, v32
v_dot2c_f32_bf16 v16, v9, v25
v_dot2c_f32_bf16 v17, v9, v33
v_dot2c_f32_bf16 v16, v10, v26
s_waitcnt lgkmcnt(10)
v_dot2c_f32_bf16 v17, v10, v34
v_dot2c_f32_bf16 v16, v11, v27
v_dot2c_f32_bf16 v17, v11, v35
v_dot2c_f32_bf16 v16, v12, v28
s_waitcnt lgkmcnt(9)
v_dot2c_f32_bf16 v17, v12, v36
v_dot2c_f32_bf16 v16, v13, v29
v_dot2c_f32_bf16 v17, v13, v37
v_dot2c_f32_bf16 v16, v14, v30
s_waitcnt lgkmcnt(8)
v_dot2c_f32_bf16 v17, v14, v38
v_dot2c_f32_bf16 v16, v15, v31
v_dot2c_f32_bf16 v17, v15, v39
ds_read_b64_tr_b16 v[24:25], v6 offset:16384
ds_read_b64_tr_b16 v[26:27], v6 offset:16896
ds_read_b64_tr_b16 v[28:29], v6 offset:20480
ds_read_b64_tr_b16 v[30:31], v6 offset:20992
ds_read_b64_tr_b16 v[32:33], v7 offset:16384
ds_read_b64_tr_b16 v[34:35], v7 offset:16896
ds_read_b64_tr_b16 v[36:37], v7 offset:20480
ds_read_b64_tr_b16 v[38:39], v7 offset:20992
v_add_u32 v5, s34, 1
s_mov_b64 exec, 1
ds_write_b32 v3, v5
s_mov_b64 exec, -1
s_waitcnt lgkmcnt(14)
v_dot2c_f32_bf16 v18, v8, v40
s_waitcnt lgkmcnt(12)
v_dot2c_f32_bf16 v19, v8, v48
v_dot2c_f32_bf16 v18, v9, v41
v_dot2c_f32_bf16 v19, v9, v49
v_dot2c_f32_bf16 v18, v10, v42
s_waitcnt lgkmcnt(11)
v_dot2c_f32_bf16 v19, v10, v50
v_dot2c_f32_bf16 v18, v11, v43
v_dot2c_f32_bf16 v19, v11, v51
v_dot2c_f32_bf16 v18, v12, v44
s_waitcnt lgkmcnt(10)
v_dot2c_f32_bf16 v19, v12, v52
v_dot2c_f32_bf16 v18, v13, v45
v_dot2c_f32_bf16 v19, v13, v53
v_dot2c_f32_bf16 v18, v14, v46
s_waitcnt lgkmcnt(9)
v_dot2c_f32_bf16 v19, v14, v54
v_dot2c_f32_bf16 v18, v15, v47
v_dot2c_f32_bf16 v19, v15, v55
s_waitcnt lgkmcnt(8)
v_dot2c_f32_bf16 v20, v8, v24
s_waitcnt lgkmcnt(4)
v_dot2c_f32_bf16 v21, v8, v32
v_dot2c_f32_bf16 v20, v9, v25
v_dot2c_f32_bf16 v21, v9, v33
v_dot2c_f32_bf16 v20, v10, v26
s_waitcnt lgkmcnt(3)
v_dot2c_f32_bf16 v21, v10, v34
v_dot2c_f32_bf16 v20, v11, v27
v_dot2c_f32_bf16 v21, v11, v35
v_dot2c_f32_bf16 v20, v12, v28
s_waitcnt lgkmcnt(2)
v_dot2c_f32_bf16 v21, v12, v36
v_dot2c_f32_bf16 v20, v13, v29
v_dot2c_f32_bf16 v21, v13, v37
v_dot2c_f32_bf16 v20, v14, v30
s_waitcnt lgkmcnt(1)
v_dot2c_f32_bf16 v21, v14, v38
v_dot2c_f32_bf16 v20, v15, v31
v_dot2c_f32_bf16 v21, v15, v39
s_lshl_b32 s72, s60, 14
s_lshl_b32 s70, s58, 9
s_add_u32 s72, s72, s70
s_lshl_b32 s70, s59, 10
s_add_u32 s71, s72, s70
v_lshlrev_b32 v6, 3, v0
v_permlane32_swap_b32 v16, v20
v_permlane32_swap_b32 v17, v21
v_permlane32_swap_b32 v18, v22
v_permlane32_swap_b32 v19, v23
v_pk_add_f32 v[16:17], v[16:17], v[20:21]
v_pk_add_f32 v[18:19], v[18:19], v[22:23]
s_nop 1
v_permlane16_swap_b32 v16, v18
v_permlane16_swap_b32 v17, v19
v_pk_add_f32 v[16:17], v[16:17], v[18:19]
s_lshl_b32 s76, s59, 11
s_add_u32 s76, s76, 262144
v_max_u32 v16, 1, v16
v_max_u32 v17, 1, v17
s_cmp_eq_u32 s63, 0
s_cbranch_scc1 fst_41
fsb_42:
buffer_store_dwordx2 v[16:17], v6, s[24:27], s71 offen sc1
s_add_u32 s73, s72, 4096
s_add_u32 s74, s72, 8192
s_add_u32 s75, s72, 12288
v_lshrrev_b32 v7, 2, v0
v_lshlrev_b32 v7, 7, v7
v_lshl_add_u32 v7, v1, 2, v7
v_lshrrev_b32 v8, 5, v0
v_lshrrev_b32 v9, 4, v0
v_xor_b32 v10, v8, v9
v_and_b32 v10, 1, v10
v_lshl_add_u32 v8, v10, 1, v8
v_and_b32 v10, 15, v0
v_lshlrev_b32 v8, 7, v8
v_lshl_add_u32 v8, v10, 3, v8
v_add_u32 v8, 1280, v8
s_mul_i32 s70, s58, 384
s_lshl_b32 s71, s63, 10
s_add_u32 s70, s70, s71
s_add_u32 s70, s70, 2304
v_lshl_add_u32 v9, v9, 7, s70
v_lshl_add_u32 v9, v10, 2, v9
s_cmp_eq_u32 s63, 0
s_cbranch_scc1 fg_43
fg_44:
poll_45:
buffer_load_dwordx4 v[12:15], v7, s[24:27], s76 offen sc1
pchk_46:
s_waitcnt vmcnt(0)
v_min3_u32 v10, v12, v13, v14
v_min_u32 v10, v10, v15
v_cmp_eq_u32 vcc, 0, v10
s_cbranch_vccz pdone_47
s_sub_u32 s32, s32, 1
s_cmp_gt_i32 s32, 0
s_cbranch_scc1 poll_45
pdone_47:
s_lshr_b32 s70, s33, 7
s_sub_u32 s70, s70, s59
s_mul_i32 s70, s70, s63
s_cmp_eq_u32 s70, 0
s_cbranch_scc0 fng_48
poll_49:
buffer_load_dwordx2 v[24:25], v6, s[24:27], s72 offen offset:0 sc1
buffer_load_dwordx2 v[26:27], v6, s[24:27], s72 offen offset:1024 sc1
buffer_load_dwordx2 v[28:29], v6, s[24:27], s72 offen offset:2048 sc1
buffer_load_dwordx2 v[30:31], v6, s[24:27], s72 offen offset:3072 sc1
buffer_load_dwordx2 v[32:33], v6, s[24:27], s73 offen offset:0 sc1
buffer_load_dwordx2 v[34:35], v6, s[24:27], s73 offen offset:1024 sc1
buffer_load_dwordx2 v[36:37], v6, s[24:27], s73 offen offset:2048 sc1
buffer_load_dwordx2 v[38:39], v6, s[24:27], s73 offen offset:3072 sc1
buffer_load_dwordx2 v[40:41], v6, s[24:27], s74 offen offset:0 sc1
buffer_load_dwordx2 v[42:43], v6, s[24:27], s74 offen offset:1024 sc1
buffer_load_dwordx2 v[44:45], v6, s[24:27], s74 offen offset:2048 sc1
buffer_load_dwordx2 v[46:47], v6, s[24:27], s74 offen offset:3072 sc1
buffer_load_dwordx2 v[48:49], v6, s[24:27], s75 offen offset:0 sc1
buffer_load_dwordx2 v[50:51], v6, s[24:27], s75 offen offset:1024 sc1
buffer_load_dwordx2 v[52:53], v6, s[24:27], s75 offen offset:2048 sc1
buffer_load_dwordx2 v[54:55], v6, s[24:27], s75 offen offset:3072 sc1
pchk_50:
s_waitcnt vmcnt(14)
v_min3_u32 v10, v24, v25, v26
s_waitcnt vmcnt(13)
v_min3_u32 v10, v10, v27, v28
s_waitcnt vmcnt(12)
v_min3_u32 v10, v10, v29, v30
s_waitcnt vmcnt(11)
v_min3_u32 v10, v10, v31, v32
s_waitcnt vmcnt(10)
v_min3_u32 v10, v10, v33, v34
s_waitcnt vmcnt(9)
v_min3_u32 v10, v10, v35, v36
s_waitcnt vmcnt(8)
v_min3_u32 v10, v10, v37, v38
s_waitcnt vmcnt(7)
v_min3_u32 v10, v10, v39, v40
s_waitcnt vmcnt(6)
v_min3_u32 v10, v10, v41, v42
s_waitcnt vmcnt(5)
v_min3_u32 v10, v10, v43, v44
s_waitcnt vmcnt(4)
v_min3_u32 v10, v10, v45, v46
s_waitcnt vmcnt(3)
v_min3_u32 v10, v10, v47, v48
s_waitcnt vmcnt(2)
v_min3_u32 v10, v10, v49, v50
s_waitcnt vmcnt(1)
v_min3_u32 v10, v10, v51, v52
s_waitcnt vmcnt(0)
v_min3_u32 v10, v10, v53, v54
v_min_u32 v10, v10, v55
v_cmp_eq_u32 vcc, 0, v10
s_cbranch_vccz pdone_51
s_sub_u32 s32, s32, 1
s_cmp_gt_i32 s32, 0
s_cbranch_scc1 poll_49
pdone_51:
v_pk_add_f32 v[24:25], v[24:25], v[40:41]
v_pk_add_f32 v[26:27], v[26:27], v[42:43]
v_pk_add_f32 v[28:29], v[28:29], v[44:45]
v_pk_add_f32 v[30:31], v[30:31], v[46:47]
v_pk_add_f32 v[32:33], v[32:33], v[48:49]
v_pk_add_f32 v[34:35], v[34:35], v[50:51]
v_pk_add_f32 v[36:37], v[36:37], v[52:53]
v_pk_add_f32 v[38:39], v[38:39], v[54:55]
v_pk_add_f32 v[24:25], v[24:25], v[32:33]
v_pk_add_f32 v[26:27], v[26:27], v[34:35]
v_pk_add_f32 v[28:29], v[28:29], v[36:37]
v_pk_add_f32 v[30:31], v[30:31], v[38:39]
v_pk_add_f32 v[24:25], v[24:25], v[28:29]
v_pk_add_f32 v[26:27], v[26:27], v[30:31]
v_pk_add_f32 v[24:25], v[24:25], v[26:27]
s_mov_b32 exec_hi, 0xffff
ds_write2_b32 v9, v24, v25 offset1:16
s_mov_b32 exec_hi, -1
v_mul_f32 v5, 0xba800000, v24
v_mul_f32 v25, 0x3a800000, v25
v_fma_f32 v25, -v5, v5, v25
v_max_f32 v25, 0, v25
v_add_f32 v25, 0x3727c5ac, v25
v_rsq_f32 v24, v25
s_nop 0
v_mul_f32 v25, v5, v24
s_lshl_b32 s70, s59, 7
s_sub_u32 s70, s33, s70
v_lshlrev_b32 v10, 1, v0
v_sub_u32 v10, s70, v10
v_readlane_b32 s70, v24, 48
v_readlane_b32 s71, v25, 48
v_cmp_eq_u32 vcc, 0, v10
s_mov_b64 exec, vcc
v_mov_b32 v12, s70
v_mov_b32 v13, s71
s_mov_b64 exec, -1
v_cmp_eq_u32 vcc, 1, v10
s_mov_b64 exec, vcc
v_mov_b32 v14, s70
v_mov_b32 v15, s71
s_mov_b64 exec, -1
fng_48:
ds_write2_b32 v8, v12, v14 offset1:1
ds_write2_b32 v8, v13, v15 offset0:128 offset1:129
v_add_u32 v5, s34, 2
s_mov_b64 exec, 1
ds_write_b32 v3, v5
s_mov_b64 exec, -1
s_setprio 0
s_lshl_b32 s70, s63, 8
s_add_u32 s70, s70, s2
s_cmp_lt_u32 s70, 224
s_cbranch_scc1 fnw_52
fnw_53:
s_and_b32 s70, s64, 31
s_lshl_b32 s70, s70, 7
s_add_u32 s72, s70, 2752512
v_lshrrev_b32 v6, 2, v0
v_lshlrev_b32 v6, 12, v6
v_lshl_add_u32 v7, v1, 2, v6
v_mov_b32 v16, 0
v_mov_b32 v17, 0
v_mov_b32 v18, 0
v_mov_b32 v19, 0
v_mov_b32 v20, 0
v_mov_b32 v21, 0
v_mov_b32 v22, 0
v_mov_b32 v23, 0
s_add_u32 s35, s34, 22
lw_54:
ds_read_b32 v5, v1 offset:0
s_waitcnt lgkmcnt(0)
v_cmp_gt_i32 vcc, s35, v5
s_cbranch_vccz lwd_55
s_sleep 4
s_sub_u32 s32, s32, 1
s_cmp_gt_i32 s32, 0
s_cbranch_scc1 lw_54
lwd_55:
s_setprio 3
s_add_u32 s35, s34, 24
lw_56:
ds_read_b32 v5, v1 offset:0
s_waitcnt lgkmcnt(0)
v_cmp_gt_i32 vcc, s35, v5
s_cbranch_vccz lwd_57
s_sleep 2
s_sub_u32 s32, s32, 1
s_cmp_gt_i32 s32, 0
s_cbranch_scc1 lw_56
lwd_57:
poll_58:
buffer_load_dwordx4 v[24:27], v7, s[24:27], s72 offen sc1
buffer_load_dwordx2 v[28:29], v6, s[24:27], s72 offen offset:64 sc1
pchk_59:
s_waitcnt vmcnt(1)
v_min3_u32 v10, v24, v25, v26
s_waitcnt vmcnt(0)
v_min3_u32 v10, v10, v27, v28
v_min_u32 v10, v10, v29
v_cmp_eq_u32 vcc, 0, v10
s_cbranch_vccz pdone_60
s_sub_u32 s32, s32, 1
s_cmp_gt_i32 s32, 0
s_cbranch_scc1 poll_58
pdone_60:
v_mov_b32 v10, v28
s_nop 1
v_max_f32_dpp v10, v10, v10 row_ror:4 row_mask:0xf bank_mask:0xf
s_nop 1
v_max_f32_dpp v10, v10, v10 row_ror:8 row_mask:0xf bank_mask:0xf
v_mov_b32 v11, v10
s_nop 1
v_permlane16_swap_b32 v11, v10
v_max_f32 v10, v10, v11
v_mov_b32 v11, v10
s_nop 1
v_permlane32_swap_b32 v11, v10
v_max_f32 v10, v10, v11
v_cmp_eq_f32 vcc, v10, v28
s_ff1_i32_b64 s68, vcc
s_and_b32 s68, s68, 60
v_readlane_b32 s33, v29, s68
v_readlane_b32 s67, v28, s68
v_readlane_b32 s36, v24, s68
v_readlane_b32 s37, v25, s68
v_readlane_b32 s44, v26, s68
v_readlane_b32 s45, v27, s68
s_add_u32 s68, s68, 1
v_readlane_b32 s38, v24, s68
v_readlane_b32 s39, v25, s68
v_readlane_b32 s46, v26, s68
v_readlane_b32 s47, v27, s68
s_add_u32 s68, s68, 1
v_readlane_b32 s40, v24, s68
v_readlane_b32 s41, v25, s68
v_readlane_b32 s48, v26, s68
v_readlane_b32 s49, v27, s68
s_add_u32 s68, s68, 1
v_readlane_b32 s42, v24, s68
v_readlane_b32 s43, v25, s68
v_readlane_b32 s50, v26, s68
v_readlane_b32 s51, v27, s68
s_lshr_b32 s68, s68, 2
v_mov_b32 v11, s33
ds_write_b32 v16, v11 offset:32
v_add_u32 v5, s34, 3
s_mov_b64 exec, 1
ds_write_b32 v3, v5
s_mov_b64 exec, -1
s_sub_u32 s33, s33, 1
s_and_b32 s33, s33, 2047
s_cmp_lt_u32 s2, 224
s_cbranch_scc0 fnd_61
s_lshl1_add_u32 s70, s64, s58
s_lshl_b32 s70, s70, 11
s_add_u32 s71, s70, 1835008
s_add_u32 s70, s70, 917504
v_dot2c_f32_bf16 v16, s36, v56
v_dot2c_f32_bf16 v17, s36, v57
v_dot2c_f32_bf16 v18, s36, v58
v_dot2c_f32_bf16 v19, s36, v59
v_dot2c_f32_bf16 v20, s36, v60
v_dot2c_f32_bf16 v21, s36, v61
v_dot2c_f32_bf16 v22, s36, v62
v_dot2c_f32_bf16 v23, s36, v63
v_dot2c_f32_bf16 v16, s37, v64
v_dot2c_f32_bf16 v17, s37, v65
v_dot2c_f32_bf16 v18, s37, v66
v_dot2c_f32_bf16 v19, s37, v67
v_dot2c_f32_bf16 v20, s37, v68
v_dot2c_f32_bf16 v21, s37, v69
v_dot2c_f32_bf16 v22, s37, v70
v_dot2c_f32_bf16 v23, s37, v71
v_dot2c_f32_bf16 v16, s38, v72
v_dot2c_f32_bf16 v17, s38, v73
v_dot2c_f32_bf16 v18, s38, v74
v_dot2c_f32_bf16 v19, s38, v75
v_dot2c_f32_bf16 v20, s38, v76
v_dot2c_f32_bf16 v21, s38, v77
v_dot2c_f32_bf16 v22, s38, v78
v_dot2c_f32_bf16 v23, s38, v79
v_dot2c_f32_bf16 v16, s39, v80
v_dot2c_f32_bf16 v17, s39, v81
v_dot2c_f32_bf16 v18, s39, v82
v_dot2c_f32_bf16 v19, s39, v83
v_dot2c_f32_bf16 v20, s39, v84
v_dot2c_f32_bf16 v21, s39, v85
v_dot2c_f32_bf16 v22, s39, v86
v_dot2c_f32_bf16 v23, s39, v87
v_dot2c_f32_bf16 v16, s40, v88
v_dot2c_f32_bf16 v17, s40, v89
v_dot2c_f32_bf16 v18, s40, v90
v_dot2c_f32_bf16 v19, s40, v91
v_dot2c_f32_bf16 v20, s40, v92
v_dot2c_f32_bf16 v21, s40, v93
v_dot2c_f32_bf16 v22, s40, v94
v_dot2c_f32_bf16 v23, s40, v95
v_dot2c_f32_bf16 v16, s41, v96
v_dot2c_f32_bf16 v17, s41, v97
v_dot2c_f32_bf16 v18, s41, v98
v_dot2c_f32_bf16 v19, s41, v99
v_dot2c_f32_bf16 v20, s41, v100
v_dot2c_f32_bf16 v21, s41, v101
v_dot2c_f32_bf16 v22, s41, v102
v_dot2c_f32_bf16 v23, s41, v103
v_dot2c_f32_bf16 v16, s42, v104
v_dot2c_f32_bf16 v17, s42, v105
v_dot2c_f32_bf16 v18, s42, v106
v_dot2c_f32_bf16 v19, s42, v107
v_dot2c_f32_bf16 v20, s42, v108
v_dot2c_f32_bf16 v21, s42, v109
v_dot2c_f32_bf16 v22, s42, v110
v_dot2c_f32_bf16 v23, s42, v111
v_dot2c_f32_bf16 v16, s43, v112
v_dot2c_f32_bf16 v17, s43, v113
v_dot2c_f32_bf16 v18, s43, v114
v_dot2c_f32_bf16 v19, s43, v115
v_dot2c_f32_bf16 v20, s43, v116
v_dot2c_f32_bf16 v21, s43, v117
v_dot2c_f32_bf16 v22, s43, v118
v_dot2c_f32_bf16 v23, s43, v119
v_dot2c_f32_bf16 v16, s44, v120
v_dot2c_f32_bf16 v17, s44, v121
v_dot2c_f32_bf16 v18, s44, v122
v_dot2c_f32_bf16 v19, s44, v123
v_dot2c_f32_bf16 v20, s44, v124
v_dot2c_f32_bf16 v21, s44, v125
v_dot2c_f32_bf16 v22, s44, v126
v_dot2c_f32_bf16 v23, s44, v127
v_dot2c_f32_bf16 v16, s45, v128
v_dot2c_f32_bf16 v17, s45, v129
v_dot2c_f32_bf16 v18, s45, v130
v_dot2c_f32_bf16 v19, s45, v131
v_dot2c_f32_bf16 v20, s45, v132
v_dot2c_f32_bf16 v21, s45, v133
v_dot2c_f32_bf16 v22, s45, v134
v_dot2c_f32_bf16 v23, s45, v135
v_dot2c_f32_bf16 v16, s46, v136
v_dot2c_f32_bf16 v17, s46, v137
v_dot2c_f32_bf16 v18, s46, v138
v_dot2c_f32_bf16 v19, s46, v139
v_dot2c_f32_bf16 v20, s46, v140
v_dot2c_f32_bf16 v21, s46, v141
v_dot2c_f32_bf16 v22, s46, v142
v_dot2c_f32_bf16 v23, s46, v143
v_dot2c_f32_bf16 v16, s47, v144
v_dot2c_f32_bf16 v17, s47, v145
v_dot2c_f32_bf16 v18, s47, v146
v_dot2c_f32_bf16 v19, s47, v147
v_dot2c_f32_bf16 v20, s47, v148
v_dot2c_f32_bf16 v21, s47, v149
v_dot2c_f32_bf16 v22, s47, v150
v_dot2c_f32_bf16 v23, s47, v151
v_dot2c_f32_bf16 v16, s48, v152
v_dot2c_f32_bf16 v17, s48, v153
v_dot2c_f32_bf16 v18, s48, v154
v_dot2c_f32_bf16 v19, s48, v155
v_dot2c_f32_bf16 v20, s48, v156
v_dot2c_f32_bf16 v21, s48, v157
v_dot2c_f32_bf16 v22, s48, v158
v_dot2c_f32_bf16 v23, s48, v159
v_dot2c_f32_bf16 v16, s49, v160
v_dot2c_f32_bf16 v17, s49, v161
v_dot2c_f32_bf16 v18, s49, v162
v_dot2c_f32_bf16 v19, s49, v163
v_dot2c_f32_bf16 v20, s49, v164
v_dot2c_f32_bf16 v21, s49, v165
v_dot2c_f32_bf16 v22, s49, v166
v_dot2c_f32_bf16 v23, s49, v167
v_dot2c_f32_bf16 v16, s50, v168
v_dot2c_f32_bf16 v17, s50, v169
v_dot2c_f32_bf16 v18, s50, v170
v_dot2c_f32_bf16 v19, s50, v171
v_dot2c_f32_bf16 v20, s50, v172
v_dot2c_f32_bf16 v21, s50, v173
v_dot2c_f32_bf16 v22, s50, v174
v_dot2c_f32_bf16 v23, s50, v175
v_dot2c_f32_bf16 v16, s51, v176
v_dot2c_f32_bf16 v17, s51, v177
v_dot2c_f32_bf16 v18, s51, v178
v_dot2c_f32_bf16 v19, s51, v179
v_dot2c_f32_bf16 v20, s51, v180
v_dot2c_f32_bf16 v21, s51, v181
v_dot2c_f32_bf16 v22, s51, v182
v_dot2c_f32_bf16 v23, s51, v183
v_max_u32 v16, 1, v16
v_max_u32 v17, 1, v17
v_max_u32 v18, 1, v18
v_max_u32 v19, 1, v19
v_max_u32 v20, 1, v20
v_max_u32 v21, 1, v21
v_max_u32 v22, 1, v22
v_max_u32 v23, 1, v23
buffer_store_dwordx4 v[16:19], v4, s[24:27], s71 offen offset:0 sc1
buffer_store_dwordx4 v[20:23], v4, s[24:27], s71 offen offset:1024 sc1
s_lshr_b32 s71, s64, 5
s_lshl_b32 s71, s71, 17
s_and_b32 s72, s64, 1
s_bfe_u32 s73, s64, 0x40001
s_lshl4_add_u32 s72, s72, s73
s_lshl_b32 s72, s72, 6
s_add_u32 s71, s71, s72
s_add_u32 s72, s71, 1835008
s_add_u32 s73, s71, 1900544
s_waitcnt vmcnt(0)
v_mov_b32 v16, 0
v_mov_b32 v17, 0
v_mov_b32 v18, 0
v_mov_b32 v19, 0
v_mov_b32 v20, 0
v_mov_b32 v21, 0
v_mov_b32 v22, 0
v_mov_b32 v23, 0
poll_62:
buffer_load_dwordx4 v[24:27], v7, s[24:27], s72 offen offset:0 sc1
buffer_load_dwordx4 v[28:31], v7, s[24:27], s72 offen offset:2048 sc1
buffer_load_dwordx4 v[32:35], v7, s[24:27], s73 offen offset:0 sc1
buffer_load_dwordx4 v[36:39], v7, s[24:27], s73 offen offset:2048 sc1
pchk_63:
s_waitcnt vmcnt(3)
v_min3_u32 v10, v24, v25, v26
s_waitcnt vmcnt(2)
v_min3_u32 v10, v10, v27, v28
v_min3_u32 v10, v10, v29, v30
s_waitcnt vmcnt(1)
v_min3_u32 v10, v10, v31, v32
v_min3_u32 v10, v10, v33, v34
s_waitcnt vmcnt(0)
v_min3_u32 v10, v10, v35, v36
v_min3_u32 v10, v10, v37, v38
v_min_u32 v10, v10, v39
v_cmp_eq_u32 vcc, 0, v10
s_cbranch_vccz pdone_64
s_sub_u32 s32, s32, 1
s_cmp_gt_i32 s32, 0
s_cbranch_scc1 poll_62
pdone_64:
v_pk_add_f32 v[8:9], v[24:25], v[32:33]
v_pk_add_f32 v[10:11], v[26:27], v[34:35]
v_pk_add_f32 v[12:13], v[28:29], v[36:37]
v_pk_add_f32 v[14:15], v[30:31], v[38:39]
s_nop 0
v_permlane32_swap_b32 v8, v12
v_permlane32_swap_b32 v9, v13
v_permlane32_swap_b32 v10, v14
v_permlane32_swap_b32 v11, v15
v_pk_add_f32 v[8:9], v[8:9], v[12:13]
v_pk_add_f32 v[10:11], v[10:11], v[14:15]
s_nop 1
v_permlane16_swap_b32 v8, v10
v_permlane16_swap_b32 v9, v11
v_pk_add_f32 v[8:9], v[8:9], v[10:11]
s_nop 1
v_add_f32_dpp v8, v8, v8 row_ror:4 row_mask:0xf bank_mask:0xf
v_add_f32_dpp v9, v9, v9 row_ror:4 row_mask:0xf bank_mask:0xf
s_nop 0
v_add_f32_dpp v8, v8, v8 row_ror:8 row_mask:0xf bank_mask:0xf
v_add_f32_dpp v9, v9, v9 row_ror:8 row_mask:0xf bank_mask:0xf
v_mov_b32 v10, v8
v_mov_b32 v11, v9
s_nop 0
v_permlane32_swap_b32 v8, v10
v_permlane32_swap_b32 v9, v11
v_mul_f32 v12, 0xbfb8aa3b, v8
v_mul_f32 v13, 0xbfb8aa3b, v9
v_exp_f32 v12, v12
v_exp_f32 v13, v13
v_pk_mul_f32 v[8:9], v[8:9], v[10:11]
v_add_f32 v12, 1.0, v12
v_add_f32 v13, 1.0, v13
v_rcp_f32 v12, v12
v_rcp_f32 v13, v13
s_nop 0
v_pk_mul_f32 v[8:9], v[8:9], v[12:13]
v_cvt_pk_bf16_f32 v8, v8, v9
s_nop 0
v_readlane_b32 s36, v8, 0
v_readlane_b32 s37, v8, 16
v_readlane_b32 s38, v8, 1
v_readlane_b32 s39, v8, 17
v_readlane_b32 s40, v8, 2
v_readlane_b32 s41, v8, 18
v_readlane_b32 s42, v8, 3
v_readlane_b32 s43, v8, 19
v_dot2c_f32_bf16 v16, s36, v184
v_dot2c_f32_bf16 v17, s36, v185
v_dot2c_f32_bf16 v18, s36, v186
v_dot2c_f32_bf16 v19, s36, v187
v_dot2c_f32_bf16 v20, s36, v188
v_dot2c_f32_bf16 v21, s36, v189
v_dot2c_f32_bf16 v22, s36, v190
v_dot2c_f32_bf16 v23, s36, v191
v_dot2c_f32_bf16 v16, s37, v192
v_dot2c_f32_bf16 v17, s37, v193
v_dot2c_f32_bf16 v18, s37, v194
v_dot2c_f32_bf16 v19, s37, v195
v_dot2c_f32_bf16 v20, s37, v196
v_dot2c_f32_bf16 v21, s37, v197
v_dot2c_f32_bf16 v22, s37, v198
v_dot2c_f32_bf16 v23, s37, v199
v_dot2c_f32_bf16 v16, s38, v200
v_dot2c_f32_bf16 v17, s38, v201
v_dot2c_f32_bf16 v18, s38, v202
v_dot2c_f32_bf16 v19, s38, v203
v_dot2c_f32_bf16 v20, s38, v204
v_dot2c_f32_bf16 v21, s38, v205
v_dot2c_f32_bf16 v22, s38, v206
v_dot2c_f32_bf16 v23, s38, v207
v_dot2c_f32_bf16 v16, s39, v208
v_dot2c_f32_bf16 v17, s39, v209
v_dot2c_f32_bf16 v18, s39, v210
v_dot2c_f32_bf16 v19, s39, v211
v_dot2c_f32_bf16 v20, s39, v212
v_dot2c_f32_bf16 v21, s39, v213
v_dot2c_f32_bf16 v22, s39, v214
v_dot2c_f32_bf16 v23, s39, v215
v_dot2c_f32_bf16 v16, s40, v216
v_dot2c_f32_bf16 v17, s40, v217
v_dot2c_f32_bf16 v18, s40, v218
v_dot2c_f32_bf16 v19, s40, v219
v_dot2c_f32_bf16 v20, s40, v220
v_dot2c_f32_bf16 v21, s40, v221
v_dot2c_f32_bf16 v22, s40, v222
v_dot2c_f32_bf16 v23, s40, v223
v_dot2c_f32_bf16 v16, s41, v224
v_dot2c_f32_bf16 v17, s41, v225
v_dot2c_f32_bf16 v18, s41, v226
v_dot2c_f32_bf16 v19, s41, v227
v_dot2c_f32_bf16 v20, s41, v228
v_dot2c_f32_bf16 v21, s41, v229
v_dot2c_f32_bf16 v22, s41, v230
v_dot2c_f32_bf16 v23, s41, v231
v_dot2c_f32_bf16 v16, s42, v232
v_dot2c_f32_bf16 v17, s42, v233
v_dot2c_f32_bf16 v18, s42, v234
v_dot2c_f32_bf16 v19, s42, v235
v_dot2c_f32_bf16 v20, s42, v236
v_dot2c_f32_bf16 v21, s42, v237
v_dot2c_f32_bf16 v22, s42, v238
v_dot2c_f32_bf16 v23, s42, v239
v_dot2c_f32_bf16 v16, s43, v240
v_dot2c_f32_bf16 v17, s43, v241
v_dot2c_f32_bf16 v18, s43, v242
v_dot2c_f32_bf16 v19, s43, v243
v_dot2c_f32_bf16 v20, s43, v244
v_dot2c_f32_bf16 v21, s43, v245
v_dot2c_f32_bf16 v22, s43, v246
v_dot2c_f32_bf16 v23, s43, v247
v_max_u32 v16, 1, v16
v_max_u32 v17, 1, v17
v_max_u32 v18, 1, v18
v_max_u32 v19, 1, v19
v_max_u32 v20, 1, v20
v_max_u32 v21, 1, v21
v_max_u32 v22, 1, v22
v_max_u32 v23, 1, v23
buffer_store_dwordx4 v[16:19], v4, s[24:27], s70 offen offset:0 sc1
buffer_store_dwordx4 v[20:23], v4, s[24:27], s70 offen offset:1024 sc1
fnd_61:
s_cmp_eq_u32 s58, 0
s_cbranch_scc0 fnr_65
v_min_u32 v6, 55, v0
v_lshlrev_b32 v6, 12, v6
s_lshr_b32 s70, s65, 7
s_and_b32 s71, s65, 1
s_lshl1_add_u32 s70, s70, s71
s_lshl_b32 s70, s70, 10
s_bfe_u32 s71, s65, 0x60001
s_lshl4_add_u32 s70, s71, s70
s_add_u32 s72, s70, 917504
s_add_u32 s73, s70, 1146880
s_add_u32 s74, s70, 1376256
s_add_u32 s75, s70, 1605632
s_lshl_b32 s70, s68, 12
s_lshl4_add_u32 s70, s65, s70
s_add_u32 s76, s70, 2818048
v_mov_b32 v12, s67
v_mul_f32 v12, 0xbfb8aa3b, v12
v_exp_f32 v12, v12
v_cmp_gt_u32 vcc, 56, v0
v_add_f32 v12, 1.0, v12
v_rcp_f32 v12, v12
s_lshl_b32 s70, s33, 11
s_lshl3_add_u32 s70, s65, s70
s_lshl_b32 s71, s65, 7
s_add_u32 s71, s71, 2916352
v_cndmask_b32 v12, 0, v12, vcc
s_waitcnt vmcnt(0)
poll_67:
buffer_load_dwordx4 v[40:43], off, s[24:27], s76 sc1
buffer_load_dwordx4 v[24:27], v6, s[24:27], s72 offen sc1
buffer_load_dwordx4 v[28:31], v6, s[24:27], s73 offen sc1
buffer_load_dwordx4 v[32:35], v6, s[24:27], s74 offen sc1
buffer_load_dwordx4 v[36:39], v6, s[24:27], s75 offen sc1
pchk_68:
s_waitcnt vmcnt(3)
v_min3_u32 v10, v24, v25, v26
s_waitcnt vmcnt(2)
v_min3_u32 v10, v10, v27, v28
v_min3_u32 v10, v10, v29, v30
s_waitcnt vmcnt(1)
v_min3_u32 v10, v10, v31, v32
v_min3_u32 v10, v10, v33, v34
s_waitcnt vmcnt(0)
v_min3_u32 v10, v10, v35, v36
v_min3_u32 v10, v10, v37, v38
v_min3_u32 v10, v10, v39, v40
v_min3_u32 v10, v10, v41, v42
v_min_u32 v10, v10, v43
v_cmp_eq_u32 vcc, 0, v10
s_cbranch_vccz pdone_69
s_sub_u32 s32, s32, 1
s_cmp_gt_i32 s32, 0
s_cbranch_scc1 poll_67
pdone_69:
v_pk_add_f32 v[24:25], v[24:25], v[32:33]
v_pk_add_f32 v[26:27], v[26:27], v[34:35]
v_pk_add_f32 v[28:29], v[28:29], v[36:37]
v_pk_add_f32 v[30:31], v[30:31], v[38:39]
v_pk_add_f32 v[24:25], v[24:25], v[28:29]
v_pk_add_f32 v[26:27], v[26:27], v[30:31]
v_pk_mul_f32 v[24:25], v[24:25], v[12:13] op_sel:[0,0] op_sel_hi:[1,0]
v_pk_mul_f32 v[26:27], v[26:27], v[12:13] op_sel:[0,0] op_sel_hi:[1,0]
s_nop 0
v_add_f32_dpp v24, v24, v24 row_ror:1 row_mask:0xf bank_mask:0xf
v_add_f32_dpp v25, v25, v25 row_ror:1 row_mask:0xf bank_mask:0xf
v_add_f32_dpp v26, v26, v26 row_ror:1 row_mask:0xf bank_mask:0xf
v_add_f32_dpp v27, v27, v27 row_ror:1 row_mask:0xf bank_mask:0xf
v_add_f32_dpp v24, v24, v24 row_ror:2 row_mask:0xf bank_mask:0xf
v_add_f32_dpp v25, v25, v25 row_ror:2 row_mask:0xf bank_mask:0xf
v_add_f32_dpp v26, v26, v26 row_ror:2 row_mask:0xf bank_mask:0xf
v_add_f32_dpp v27, v27, v27 row_ror:2 row_mask:0xf bank_mask:0xf
v_add_f32_dpp v24, v24, v24 row_ror:4 row_mask:0xf bank_mask:0xf
v_add_f32_dpp v25, v25, v25 row_ror:4 row_mask:0xf bank_mask:0xf
v_add_f32_dpp v26, v26, v26 row_ror:4 row_mask:0xf bank_mask:0xf
v_add_f32_dpp v27, v27, v27 row_ror:4 row_mask:0xf bank_mask:0xf
v_add_f32_dpp v24, v24, v24 row_ror:8 row_mask:0xf bank_mask:0xf
v_add_f32_dpp v25, v25, v25 row_ror:8 row_mask:0xf bank_mask:0xf
v_add_f32_dpp v26, v26, v26 row_ror:8 row_mask:0xf bank_mask:0xf
v_add_f32_dpp v27, v27, v27 row_ror:8 row_mask:0xf bank_mask:0xf
v_mov_b32 v28, v24
v_mov_b32 v29, v25
v_mov_b32 v30, v26
v_mov_b32 v31, v27
v_permlane16_swap_b32 v28, v24
v_permlane16_swap_b32 v29, v25
v_permlane16_swap_b32 v30, v26
v_permlane16_swap_b32 v31, v27
v_add_f32 v24, v24, v28
v_add_f32 v25, v25, v29
v_add_f32 v26, v26, v30
v_add_f32 v27, v27, v31
v_mov_b32 v28, v24
v_mov_b32 v29, v25
v_mov_b32 v30, v26
v_mov_b32 v31, v27
v_permlane32_swap_b32 v28, v24
v_permlane32_swap_b32 v29, v25
v_permlane32_swap_b32 v30, v26
v_permlane32_swap_b32 v31, v27
v_add_f32 v24, v24, v28
v_add_f32 v25, v25, v29
v_add_f32 v26, v26, v30
v_add_f32 v27, v27, v31
v_pk_add_f32 v[24:25], v[24:25], v[40:41]
v_pk_add_f32 v[26:27], v[26:27], v[42:43]
v_cvt_pk_bf16_f32 v8, v24, v25
v_cvt_pk_bf16_f32 v9, v26, v27
s_mov_b64 exec, 1
s_cmp_eq_u32 s63, 0
s_cbranch_scc1 fl0_66
buffer_store_dwordx2 v[8:9], off, s[28:31], s70
s_mov_b64 exec, -1
s_branch L_end
fl0_66:
v_max_u32 v8, 1, v8
v_max_u32 v9, 1, v9
buffer_store_dwordx2 v[8:9], off, s[24:27], s71 sc1
s_mov_b64 exec, -1
s_waitcnt vmcnt(0)
fnr_65:
s_cmp_eq_u32 s63, 0
s_cbranch_scc0 L_end
v_add_u32 v5, s34, 4
s_mov_b64 exec, 1
ds_write_b32 v3, v5
s_mov_b64 exec, -1
v_and_b32 v6, 48, v0
v_lshlrev_b32 v6, 3, v6
s_lshl_b32 s70, s59, 11
s_add_u32 s70, s70, 2916352
s_add_u32 s35, s34, 4
lw_70:
ds_read_b32 v5, v2 offset:24
s_waitcnt lgkmcnt(0)
v_cmp_gt_i32 vcc, s35, v5
s_cbranch_vccz lwd_71
s_sleep 2
s_sub_u32 s32, s32, 1
s_cmp_gt_i32 s32, 0
s_cbranch_scc1 lw_70
lwd_71:
poll_72:
buffer_load_dwordx2 v[8:9], v6, s[24:27], s70 offen offset:0 sc1
buffer_load_dwordx2 v[10:11], v6, s[24:27], s70 offen offset:512 sc1
buffer_load_dwordx2 v[12:13], v6, s[24:27], s70 offen offset:1024 sc1
buffer_load_dwordx2 v[14:15], v6, s[24:27], s70 offen offset:1536 sc1
pchk_73:
s_waitcnt vmcnt(2)
v_min3_u32 v7, v8, v9, v10
s_waitcnt vmcnt(1)
v_min3_u32 v7, v7, v11, v12
s_waitcnt vmcnt(0)
v_min3_u32 v7, v7, v13, v14
v_min_u32 v7, v7, v15
v_cmp_eq_u32 vcc, 0, v7
s_cbranch_vccz pdone_74
s_sub_u32 s32, s32, 1
s_cmp_gt_i32 s32, 0
s_cbranch_scc1 poll_72
pdone_74:
s_mov_b32 s63, 1
s_mov_b32 s34, 32
s_add_u32 s24, s24, 2949120
s_addc_u32 s25, s25, 0
s_mov_b32 s26, 2949120
s_mov_b32 s70, 131072
s_branch ftop_38
fst_41:
s_lshl4_add_u32 s70, s59, s60
s_lshl1_add_u32 s70, s70, s58
s_lshl_b32 s70, s70, 13
v_lshrrev_b32 v7, 4, v0
v_and_b32 v8, 15, v0
v_lshlrev_b32 v8, 4, v8
v_lshl_add_u32 v8, v7, 11, v8
buffer_load_dwordx4 v[24:27], v8, s[8:11], s70 offen offset:0
buffer_load_dwordx4 v[28:31], v8, s[8:11], s70 offen offset:256
buffer_load_dwordx4 v[32:35], v8, s[8:11], s70 offen offset:512
buffer_load_dwordx4 v[36:39], v8, s[8:11], s70 offen offset:768
buffer_load_dwordx4 v[40:43], v8, s[8:11], s70 offen offset:1024
buffer_load_dwordx4 v[44:47], v8, s[8:11], s70 offen offset:1280
buffer_load_dwordx4 v[48:51], v8, s[8:11], s70 offen offset:1536
buffer_load_dwordx4 v[52:55], v8, s[8:11], s70 offen offset:1792
s_cmp_eq_u32 s58, 1
s_cbranch_scc0 fz_75
v_lshlrev_b32 v14, 4, v0
v_mov_b32 v56, 0
v_mov_b32 v57, 0
v_mov_b32 v58, 0
v_mov_b32 v59, 0
s_mul_i32 s70, s2, 21504
s_add_u32 s70, s70, 327680
buffer_store_dwordx4 v[56:59], v14, s[24:27], s70 offen offset:0 sc1
buffer_store_dwordx4 v[56:59], v14, s[24:27], s70 offen offset:1024 sc1
buffer_store_dwordx4 v[56:59], v14, s[24:27], s70 offen offset:2048 sc1
buffer_store_dwordx4 v[56:59], v14, s[24:27], s70 offen offset:3072 sc1
s_add_u32 s70, s70, 4096
buffer_store_dwordx4 v[56:59], v14, s[24:27], s70 offen offset:0 sc1
buffer_store_dwordx4 v[56:59], v14, s[24:27], s70 offen offset:1024 sc1
buffer_store_dwordx4 v[56:59], v14, s[24:27], s70 offen offset:2048 sc1
buffer_store_dwordx4 v[56:59], v14, s[24:27], s70 offen offset:3072 sc1
s_add_u32 s70, s70, 4096
buffer_store_dwordx4 v[56:59], v14, s[24:27], s70 offen offset:0 sc1
buffer_store_dwordx4 v[56:59], v14, s[24:27], s70 offen offset:1024 sc1
buffer_store_dwordx4 v[56:59], v14, s[24:27], s70 offen offset:2048 sc1
buffer_store_dwordx4 v[56:59], v14, s[24:27], s70 offen offset:3072 sc1
s_add_u32 s70, s70, 4096
buffer_store_dwordx4 v[56:59], v14, s[24:27], s70 offen offset:0 sc1
buffer_store_dwordx4 v[56:59], v14, s[24:27], s70 offen offset:1024 sc1
buffer_store_dwordx4 v[56:59], v14, s[24:27], s70 offen offset:2048 sc1
buffer_store_dwordx4 v[56:59], v14, s[24:27], s70 offen offset:3072 sc1
s_add_u32 s70, s70, 4096
buffer_store_dwordx4 v[56:59], v14, s[24:27], s70 offen offset:0 sc1
buffer_store_dwordx4 v[56:59], v14, s[24:27], s70 offen offset:1024 sc1
buffer_store_dwordx4 v[56:59], v14, s[24:27], s70 offen offset:2048 sc1
buffer_store_dwordx4 v[56:59], v14, s[24:27], s70 offen offset:3072 sc1
s_add_u32 s70, s70, 4096
buffer_store_dwordx4 v[56:59], v14, s[24:27], s70 offen offset:0 sc1
fz_75:
v_lshlrev_b32 v9, 4, v1
v_mov_b32 v10, 0
v_mov_b32 v11, 0
s_waitcnt vmcnt(7)
v_dot2c_f32_bf16 v10, s69, v24
v_dot2c_f32_bf16 v11, v24, v24
v_dot2c_f32_bf16 v10, s69, v25
v_dot2c_f32_bf16 v11, v25, v25
v_dot2c_f32_bf16 v10, s69, v26
v_dot2c_f32_bf16 v11, v26, v26
v_dot2c_f32_bf16 v10, s69, v27
v_dot2c_f32_bf16 v11, v27, v27
s_waitcnt vmcnt(6)
v_dot2c_f32_bf16 v10, s69, v28
v_dot2c_f32_bf16 v11, v28, v28
v_dot2c_f32_bf16 v10, s69, v29
v_dot2c_f32_bf16 v11, v29, v29
v_dot2c_f32_bf16 v10, s69, v30
v_dot2c_f32_bf16 v11, v30, v30
v_dot2c_f32_bf16 v10, s69, v31
v_dot2c_f32_bf16 v11, v31, v31
s_waitcnt vmcnt(5)
v_dot2c_f32_bf16 v10, s69, v32
v_dot2c_f32_bf16 v11, v32, v32
v_dot2c_f32_bf16 v10, s69, v33
v_dot2c_f32_bf16 v11, v33, v33
v_dot2c_f32_bf16 v10, s69, v34
v_dot2c_f32_bf16 v11, v34, v34
v_dot2c_f32_bf16 v10, s69, v35
v_dot2c_f32_bf16 v11, v35, v35
s_waitcnt vmcnt(4)
v_dot2c_f32_bf16 v10, s69, v36
v_dot2c_f32_bf16 v11, v36, v36
v_dot2c_f32_bf16 v10, s69, v37
v_dot2c_f32_bf16 v11, v37, v37
v_dot2c_f32_bf16 v10, s69, v38
v_dot2c_f32_bf16 v11, v38, v38
v_dot2c_f32_bf16 v10, s69, v39
v_dot2c_f32_bf16 v11, v39, v39
s_waitcnt vmcnt(3)
v_dot2c_f32_bf16 v10, s69, v40
v_dot2c_f32_bf16 v11, v40, v40
v_dot2c_f32_bf16 v10, s69, v41
v_dot2c_f32_bf16 v11, v41, v41
v_dot2c_f32_bf16 v10, s69, v42
v_dot2c_f32_bf16 v11, v42, v42
v_dot2c_f32_bf16 v10, s69, v43
v_dot2c_f32_bf16 v11, v43, v43
s_waitcnt vmcnt(2)
v_dot2c_f32_bf16 v10, s69, v44
v_dot2c_f32_bf16 v11, v44, v44
v_dot2c_f32_bf16 v10, s69, v45
v_dot2c_f32_bf16 v11, v45, v45
v_dot2c_f32_bf16 v10, s69, v46
v_dot2c_f32_bf16 v11, v46, v46
v_dot2c_f32_bf16 v10, s69, v47
v_dot2c_f32_bf16 v11, v47, v47
s_waitcnt vmcnt(1)
v_dot2c_f32_bf16 v10, s69, v48
v_dot2c_f32_bf16 v11, v48, v48
v_dot2c_f32_bf16 v10, s69, v49
v_dot2c_f32_bf16 v11, v49, v49
v_dot2c_f32_bf16 v10, s69, v50
v_dot2c_f32_bf16 v11, v50, v50
v_dot2c_f32_bf16 v10, s69, v51
v_dot2c_f32_bf16 v11, v51, v51
s_waitcnt vmcnt(0)
v_dot2c_f32_bf16 v10, s69, v52
v_dot2c_f32_bf16 v11, v52, v52
v_dot2c_f32_bf16 v10, s69, v53
v_dot2c_f32_bf16 v11, v53, v53
v_dot2c_f32_bf16 v10, s69, v54
v_dot2c_f32_bf16 v11, v54, v54
v_dot2c_f32_bf16 v10, s69, v55
v_dot2c_f32_bf16 v11, v55, v55
s_nop 1
v_add_f32_dpp v10, v10, v10 row_ror:1 row_mask:0xf bank_mask:0xf
v_add_f32_dpp v11, v11, v11 row_ror:1 row_mask:0xf bank_mask:0xf
s_nop 0
v_add_f32_dpp v10, v10, v10 row_ror:2 row_mask:0xf bank_mask:0xf
v_add_f32_dpp v11, v11, v11 row_ror:2 row_mask:0xf bank_mask:0xf
s_nop 0
v_add_f32_dpp v10, v10, v10 row_ror:4 row_mask:0xf bank_mask:0xf
v_add_f32_dpp v11, v11, v11 row_ror:4 row_mask:0xf bank_mask:0xf
s_nop 0
v_add_f32_dpp v10, v10, v10 row_ror:8 row_mask:0xf bank_mask:0xf
v_add_f32_dpp v11, v11, v11 row_ror:8 row_mask:0xf bank_mask:0xf
v_mul_f32 v5, 0xba800000, v10
v_mul_f32 v11, 0x3a800000, v11
v_fma_f32 v11, -v5, v5, v11
v_max_f32 v11, 0, v11
v_add_f32 v11, 0x3727c5ac, v11
v_rsq_f32 v10, v11
s_nop 0
v_mul_f32 v11, v5, v10
v_max_u32 v11, 1, v11
s_lshl_b32 s70, s60, 7
s_add_u32 s70, s70, s76
s_lshl_b32 s73, s58, 5
s_add_u32 s70, s70, s73
v_lshlrev_b32 v7, 3, v7
s_add_u32 s35, s34, 5
lw_76:
ds_read_b32 v5, v2 offset:16
s_waitcnt lgkmcnt(0)
v_cmp_gt_i32 vcc, s35, v5
s_cbranch_vccz lwd_77
s_sleep 4
s_sub_u32 s32, s32, 1
s_cmp_gt_i32 s32, 0
s_cbranch_scc1 lw_76
lwd_77:
poll_78:
buffer_load_dword v12, v9, s[4:7], 0 offen sc1
pchk_79:
s_waitcnt vmcnt(0)
v_cmp_gt_u32 vcc, 64, v12
s_cbranch_vccz pdone_80
s_sleep 16
s_sub_u32 s32, s32, 1
s_cmp_gt_i32 s32, 0
s_cbranch_scc1 poll_78
pdone_80:
s_and_b32 s73, s2, 7
s_lshl_b32 s73, s73, 7
s_add_u32 s73, s73, 294912
v_mov_b32 v14, 1
s_mov_b32 exec_lo, s58
s_mov_b32 exec_hi, 0
s_waitcnt vmcnt(0)
buffer_atomic_add v14, off, s[24:27], s73 sc1
s_mov_b64 exec, -1
s_mov_b32 exec_lo, 0x10001
s_mov_b32 exec_hi, 0x10001
buffer_store_dwordx2 v[10:11], v7, s[24:27], s70 offen sc1
s_mov_b64 exec, -1
s_branch fsb_42
fg_43:
s_lshl1_add_u32 s35, s2, s58
s_lshl_b32 s35, s35, 12
s_add_u32 s44, s40, s35
s_addc_u32 s45, s41, 0
s_mov_b32 s35, 4
ft_81:
s_load_dwordx2 s[42:43], s[44:45], 60
s_load_dwordx2 s[42:43], s[44:45], 188
s_load_dwordx2 s[42:43], s[44:45], 316
s_load_dwordx2 s[42:43], s[44:45], 444
s_load_dwordx2 s[42:43], s[44:45], 572
s_load_dwordx2 s[42:43], s[44:45], 700
s_load_dwordx2 s[42:43], s[44:45], 828
s_load_dwordx2 s[42:43], s[44:45], 956
s_add_u32 s44, s44, 1024
s_addc_u32 s45, s45, 0
s_sub_u32 s35, s35, 1
s_cmp_eq_u32 s35, 0
s_cbranch_scc0 ft_81
buffer_load_dwordx4 v[64:67], v4, s[16:19], s77 offen nt
s_add_u32 s77, s77, 7168
buffer_load_dwordx4 v[68:71], v4, s[16:19], s77 offen nt
s_add_u32 s77, s77, 7168
buffer_load_dwordx4 v[72:75], v4, s[16:19], s77 offen nt
s_add_u32 s77, s77, 7168
buffer_load_dwordx4 v[76:79], v4, s[16:19], s77 offen nt
s_add_u32 s77, s77, 7168
buffer_load_dwordx4 v[80:83], v4, s[16:19], s77 offen nt
s_add_u32 s77, s77, 7168
buffer_load_dwordx4 v[84:87], v4, s[16:19], s77 offen nt
s_add_u32 s77, s77, 7168
buffer_load_dwordx4 v[88:91], v4, s[16:19], s77 offen nt
s_add_u32 s77, s77, 7168
buffer_load_dwordx4 v[92:95], v4, s[16:19], s77 offen nt
s_add_u32 s77, s77, 7168
buffer_load_dwordx4 v[96:99], v4, s[16:19], s77 offen nt
s_add_u32 s77, s77, 7168
buffer_load_dwordx4 v[100:103], v4, s[16:19], s77 offen nt
s_add_u32 s77, s77, 7168
buffer_load_dwordx4 v[104:107], v4, s[16:19], s77 offen nt
s_add_u32 s77, s77, 7168
buffer_load_dwordx4 v[108:111], v4, s[16:19], s77 offen nt
s_add_u32 s77, s77, 7168
buffer_load_dwordx4 v[112:115], v4, s[16:19], s77 offen nt
s_add_u32 s77, s77, 7168
buffer_load_dwordx4 v[116:119], v4, s[16:19], s77 offen nt
s_add_u32 s77, s77, 7168
buffer_load_dwordx4 v[120:123], v4, s[16:19], s77 offen nt
s_add_u32 s77, s77, 7168
buffer_load_dwordx4 v[124:127], v4, s[16:19], s77 offen nt
s_add_u32 s77, s77, 7168
v_and_b32 v10, 7, v0
v_lshlrev_b32 v10, 7, v10
s_mov_b32 s70, 294912
s_add_u32 s35, s34, 10
lw_82:
ds_read_b32 v5, v2 offset:16
s_waitcnt lgkmcnt(0)
v_cmp_gt_i32 vcc, s35, v5
s_cbranch_vccz lwd_83
s_sleep 4
s_sub_u32 s32, s32, 1
s_cmp_gt_i32 s32, 0
s_cbranch_scc1 lw_82
lwd_83:
poll_84:
buffer_load_dword v12, v10, s[24:27], s70 offen sc1
pchk_85:
s_waitcnt vmcnt(0)
v_cmp_gt_u32 vcc, 32, v12
s_cbranch_vccz pdone_86
s_sleep 16
s_sub_u32 s32, s32, 1
s_cmp_gt_i32 s32, 0
s_cbranch_scc1 poll_84
pdone_86:
s_branch fg_44
fnw_52:
s_mov_b32 s72, 0x05040100
s_mov_b32 s73, 0x07060302
s_add_u32 s35, s34, 17
lw_87:
ds_read_b32 v5, v2 offset:16
s_waitcnt lgkmcnt(0)
v_cmp_gt_i32 vcc, s35, v5
s_cbranch_vccz lwd_88
s_sleep 4
s_sub_u32 s32, s32, 1
s_cmp_gt_i32 s32, 0
s_cbranch_scc1 lw_87
lwd_88:
buffer_load_dwordx4 v[128:131], v4, s[16:19], s77 offen nt
s_add_u32 s77, s77, 7168
buffer_load_dwordx4 v[132:135], v4, s[16:19], s77 offen nt
s_add_u32 s77, s77, 7168
buffer_load_dwordx4 v[136:139], v4, s[16:19], s77 offen nt
s_add_u32 s77, s77, 7168
buffer_load_dwordx4 v[140:143], v4, s[16:19], s77 offen nt
s_add_u32 s77, s77, 7168
buffer_load_dwordx4 v[144:147], v4, s[16:19], s77 offen nt
s_add_u32 s77, s77, 7168
buffer_load_dwordx4 v[148:151], v4, s[16:19], s77 offen nt
s_add_u32 s77, s77, 7168
buffer_load_dwordx4 v[152:155], v4, s[16:19], s77 offen nt
s_add_u32 s77, s77, 7168
buffer_load_dwordx4 v[156:159], v4, s[16:19], s77 offen nt
s_add_u32 s77, s77, 7168
buffer_load_dwordx4 v[160:163], v4, s[16:19], s77 offen nt
s_add_u32 s77, s77, 7168
buffer_load_dwordx4 v[164:167], v4, s[16:19], s77 offen nt
s_add_u32 s77, s77, 7168
buffer_load_dwordx4 v[168:171], v4, s[16:19], s77 offen nt
s_add_u32 s77, s77, 7168
buffer_load_dwordx4 v[172:175], v4, s[16:19], s77 offen nt
s_add_u32 s77, s77, 7168
buffer_load_dwordx4 v[176:179], v4, s[16:19], s77 offen nt
s_add_u32 s77, s77, 7168
buffer_load_dwordx4 v[180:183], v4, s[16:19], s77 offen nt
s_add_u32 s77, s77, 7168
buffer_load_dwordx4 v[184:187], v4, s[16:19], s77 offen nt
s_add_u32 s77, s77, 7168
buffer_load_dwordx4 v[188:191], v4, s[16:19], s77 offen nt
s_add_u32 s77, s77, 7168
buffer_load_dwordx4 v[192:195], v4, s[12:15], s66 offen offset:0 nt
buffer_load_dwordx4 v[196:199], v4, s[12:15], s66 offen offset:2048 nt
s_add_u32 s66, s66, 4096
buffer_load_dwordx4 v[200:203], v4, s[12:15], s66 offen offset:0 nt
buffer_load_dwordx4 v[204:207], v4, s[12:15], s66 offen offset:2048 nt
s_add_u32 s66, s66, 12288
buffer_load_dwordx4 v[208:211], v4, s[12:15], s66 offen offset:0 nt
buffer_load_dwordx4 v[212:215], v4, s[12:15], s66 offen offset:2048 nt
s_add_u32 s66, s66, 4096
buffer_load_dwordx4 v[216:219], v4, s[12:15], s66 offen offset:0 nt
buffer_load_dwordx4 v[220:223], v4, s[12:15], s66 offen offset:2048 nt
s_add_u32 s66, s66, 12288
buffer_load_dwordx4 v[224:227], v4, s[12:15], s66 offen offset:0 nt
buffer_load_dwordx4 v[228:231], v4, s[12:15], s66 offen offset:2048 nt
s_add_u32 s66, s66, 4096
buffer_load_dwordx4 v[232:235], v4, s[12:15], s66 offen offset:0 nt
buffer_load_dwordx4 v[236:239], v4, s[12:15], s66 offen offset:2048 nt
s_add_u32 s66, s66, 12288
buffer_load_dwordx4 v[240:243], v4, s[12:15], s66 offen offset:0 nt
buffer_load_dwordx4 v[244:247], v4, s[12:15], s66 offen offset:2048 nt
s_add_u32 s66, s66, 4096
buffer_load_dwordx4 v[248:251], v4, s[12:15], s66 offen offset:0 nt
buffer_load_dwordx4 v[252:255], v4, s[12:15], s66 offen offset:2048 nt
s_add_u32 s66, s66, 12288
v_perm_b32 v56, v68, v64, s72
v_perm_b32 v57, v68, v64, s73
v_perm_b32 v58, v69, v65, s72
v_perm_b32 v59, v69, v65, s73
v_perm_b32 v60, v70, v66, s72
v_perm_b32 v61, v70, v66, s73
v_perm_b32 v62, v71, v67, s72
v_perm_b32 v63, v71, v67, s73
v_perm_b32 v64, v76, v72, s72
v_perm_b32 v65, v76, v72, s73
v_perm_b32 v66, v77, v73, s72
v_perm_b32 v67, v77, v73, s73
v_perm_b32 v68, v78, v74, s72
v_perm_b32 v69, v78, v74, s73
v_perm_b32 v70, v79, v75, s72
v_perm_b32 v71, v79, v75, s73
v_perm_b32 v72, v84, v80, s72
v_perm_b32 v73, v84, v80, s73
v_perm_b32 v74, v85, v81, s72
v_perm_b32 v75, v85, v81, s73
v_perm_b32 v76, v86, v82, s72
v_perm_b32 v77, v86, v82, s73
v_perm_b32 v78, v87, v83, s72
v_perm_b32 v79, v87, v83, s73
v_perm_b32 v80, v92, v88, s72
v_perm_b32 v81, v92, v88, s73
v_perm_b32 v82, v93, v89, s72
v_perm_b32 v83, v93, v89, s73
v_perm_b32 v84, v94, v90, s72
v_perm_b32 v85, v94, v90, s73
v_perm_b32 v86, v95, v91, s72
v_perm_b32 v87, v95, v91, s73
v_perm_b32 v88, v100, v96, s72
v_perm_b32 v89, v100, v96, s73
v_perm_b32 v90, v101, v97, s72
v_perm_b32 v91, v101, v97, s73
v_perm_b32 v92, v102, v98, s72
v_perm_b32 v93, v102, v98, s73
v_perm_b32 v94, v103, v99, s72
v_perm_b32 v95, v103, v99, s73
v_perm_b32 v96, v108, v104, s72
v_perm_b32 v97, v108, v104, s73
v_perm_b32 v98, v109, v105, s72
v_perm_b32 v99, v109, v105, s73
v_perm_b32 v100, v110, v106, s72
v_perm_b32 v101, v110, v106, s73
v_perm_b32 v102, v111, v107, s72
v_perm_b32 v103, v111, v107, s73
v_perm_b32 v104, v116, v112, s72
v_perm_b32 v105, v116, v112, s73
v_perm_b32 v106, v117, v113, s72
v_perm_b32 v107, v117, v113, s73
v_perm_b32 v108, v118, v114, s72
v_perm_b32 v109, v118, v114, s73
v_perm_b32 v110, v119, v115, s72
v_perm_b32 v111, v119, v115, s73
v_perm_b32 v112, v124, v120, s72
v_perm_b32 v113, v124, v120, s73
v_perm_b32 v114, v125, v121, s72
v_perm_b32 v115, v125, v121, s73
v_perm_b32 v116, v126, v122, s72
v_perm_b32 v117, v126, v122, s73
v_perm_b32 v118, v127, v123, s72
v_perm_b32 v119, v127, v123, s73
s_waitcnt vmcnt(30)
v_perm_b32 v120, v132, v128, s72
v_perm_b32 v121, v132, v128, s73
v_perm_b32 v122, v133, v129, s72
v_perm_b32 v123, v133, v129, s73
v_perm_b32 v124, v134, v130, s72
v_perm_b32 v125, v134, v130, s73
v_perm_b32 v126, v135, v131, s72
v_perm_b32 v127, v135, v131, s73
s_waitcnt vmcnt(28)
v_perm_b32 v128, v140, v136, s72
v_perm_b32 v129, v140, v136, s73
v_perm_b32 v130, v141, v137, s72
v_perm_b32 v131, v141, v137, s73
v_perm_b32 v132, v142, v138, s72
v_perm_b32 v133, v142, v138, s73
v_perm_b32 v134, v143, v139, s72
v_perm_b32 v135, v143, v139, s73
s_waitcnt vmcnt(26)
v_perm_b32 v136, v148, v144, s72
v_perm_b32 v137, v148, v144, s73
v_perm_b32 v138, v149, v145, s72
v_perm_b32 v139, v149, v145, s73
v_perm_b32 v140, v150, v146, s72
v_perm_b32 v141, v150, v146, s73
v_perm_b32 v142, v151, v147, s72
v_perm_b32 v143, v151, v147, s73
s_waitcnt vmcnt(24)
v_perm_b32 v144, v156, v152, s72
v_perm_b32 v145, v156, v152, s73
v_perm_b32 v146, v157, v153, s72
v_perm_b32 v147, v157, v153, s73
v_perm_b32 v148, v158, v154, s72
v_perm_b32 v149, v158, v154, s73
v_perm_b32 v150, v159, v155, s72
v_perm_b32 v151, v159, v155, s73
s_waitcnt vmcnt(22)
v_perm_b32 v152, v164, v160, s72
v_perm_b32 v153, v164, v160, s73
v_perm_b32 v154, v165, v161, s72
v_perm_b32 v155, v165, v161, s73
v_perm_b32 v156, v166, v162, s72
v_perm_b32 v157, v166, v162, s73
v_perm_b32 v158, v167, v163, s72
v_perm_b32 v159, v167, v163, s73
s_waitcnt vmcnt(20)
v_perm_b32 v160, v172, v168, s72
v_perm_b32 v161, v172, v168, s73
v_perm_b32 v162, v173, v169, s72
v_perm_b32 v163, v173, v169, s73
v_perm_b32 v164, v174, v170, s72
v_perm_b32 v165, v174, v170, s73
v_perm_b32 v166, v175, v171, s72
v_perm_b32 v167, v175, v171, s73
s_waitcnt vmcnt(18)
v_perm_b32 v168, v180, v176, s72
v_perm_b32 v169, v180, v176, s73
v_perm_b32 v170, v181, v177, s72
v_perm_b32 v171, v181, v177, s73
v_perm_b32 v172, v182, v178, s72
v_perm_b32 v173, v182, v178, s73
v_perm_b32 v174, v183, v179, s72
v_perm_b32 v175, v183, v179, s73
s_waitcnt vmcnt(16)
v_perm_b32 v176, v188, v184, s72
v_perm_b32 v177, v188, v184, s73
v_perm_b32 v178, v189, v185, s72
v_perm_b32 v179, v189, v185, s73
v_perm_b32 v180, v190, v186, s72
v_perm_b32 v181, v190, v186, s73
v_perm_b32 v182, v191, v187, s72
v_perm_b32 v183, v191, v187, s73
s_waitcnt vmcnt(14)
v_perm_b32 v184, v196, v192, s72
v_perm_b32 v185, v196, v192, s73
v_perm_b32 v186, v197, v193, s72
v_perm_b32 v187, v197, v193, s73
v_perm_b32 v188, v198, v194, s72
v_perm_b32 v189, v198, v194, s73
v_perm_b32 v190, v199, v195, s72
v_perm_b32 v191, v199, v195, s73
s_waitcnt vmcnt(12)
v_perm_b32 v192, v204, v200, s72
v_perm_b32 v193, v204, v200, s73
v_perm_b32 v194, v205, v201, s72
v_perm_b32 v195, v205, v201, s73
v_perm_b32 v196, v206, v202, s72
v_perm_b32 v197, v206, v202, s73
v_perm_b32 v198, v207, v203, s72
v_perm_b32 v199, v207, v203, s73
s_waitcnt vmcnt(10)
v_perm_b32 v200, v212, v208, s72
v_perm_b32 v201, v212, v208, s73
v_perm_b32 v202, v213, v209, s72
v_perm_b32 v203, v213, v209, s73
v_perm_b32 v204, v214, v210, s72
v_perm_b32 v205, v214, v210, s73
v_perm_b32 v206, v215, v211, s72
v_perm_b32 v207, v215, v211, s73
s_waitcnt vmcnt(8)
v_perm_b32 v208, v220, v216, s72
v_perm_b32 v209, v220, v216, s73
v_perm_b32 v210, v221, v217, s72
v_perm_b32 v211, v221, v217, s73
v_perm_b32 v212, v222, v218, s72
v_perm_b32 v213, v222, v218, s73
v_perm_b32 v214, v223, v219, s72
v_perm_b32 v215, v223, v219, s73
s_waitcnt vmcnt(6)
v_perm_b32 v216, v228, v224, s72
v_perm_b32 v217, v228, v224, s73
v_perm_b32 v218, v229, v225, s72
v_perm_b32 v219, v229, v225, s73
v_perm_b32 v220, v230, v226, s72
v_perm_b32 v221, v230, v226, s73
v_perm_b32 v222, v231, v227, s72
v_perm_b32 v223, v231, v227, s73
s_waitcnt vmcnt(4)
v_perm_b32 v224, v236, v232, s72
v_perm_b32 v225, v236, v232, s73
v_perm_b32 v226, v237, v233, s72
v_perm_b32 v227, v237, v233, s73
v_perm_b32 v228, v238, v234, s72
v_perm_b32 v229, v238, v234, s73
v_perm_b32 v230, v239, v235, s72
v_perm_b32 v231, v239, v235, s73
s_waitcnt vmcnt(2)
v_perm_b32 v232, v244, v240, s72
v_perm_b32 v233, v244, v240, s73
v_perm_b32 v234, v245, v241, s72
v_perm_b32 v235, v245, v241, s73
v_perm_b32 v236, v246, v242, s72
v_perm_b32 v237, v246, v242, s73
v_perm_b32 v238, v247, v243, s72
v_perm_b32 v239, v247, v243, s73
s_waitcnt vmcnt(0)
v_perm_b32 v240, v252, v248, s72
v_perm_b32 v241, v252, v248, s73
v_perm_b32 v242, v253, v249, s72
v_perm_b32 v243, v253, v249, s73
v_perm_b32 v244, v254, v250, s72
v_perm_b32 v245, v254, v250, s73
v_perm_b32 v246, v255, v251, s72
v_perm_b32 v247, v255, v251, s73
s_branch fnw_53
L_m:
s_setprio 2
v_mov_b32 v6, 0
v_mov_b32 v7, 0
v_lshlrev_b32 v8, 3, v0
ds_write_b64 v8, v[6:7]
s_waitcnt lgkmcnt(0)
s_barrier
s_lshr_b32 s64, s58, 1
s_and_b32 s65, s58, 1
v_and_b32 v1, 3, v0
v_lshlrev_b32 v1, 2, v1
v_and_b32 v2, 4, v1
s_lshl2_add_u32 s35, s58, 0
v_mov_b32 v3, s35
s_mov_b32 s4, s44
s_mov_b32 s5, s45
s_mov_b32 s6, 0x800
s_mov_b32 s7, 0x00020000
v_lshrrev_b32 v6, 4, v0
v_lshlrev_b32 v6, 3, v6
s_lshl_b32 s66, s62, 7
buffer_load_dwordx2 v[232:233], v6, s[4:7], s66 offen offset:0
buffer_load_dwordx2 v[234:235], v6, s[4:7], s66 offen offset:32
buffer_load_dwordx2 v[236:237], v6, s[4:7], s66 offen offset:64
buffer_load_dwordx2 v[238:239], v6, s[4:7], s66 offen offset:96
v_and_b32 v6, 31, v0
v_lshrrev_b32 v7, 5, v0
v_lshlrev_b32 v7, 3, v7
v_sub_u32 v6, v6, v7
v_mov_b32 v7, 0xf149f2ca
v_cmp_le_i32 vcc, 0, v6
s_nop 1
v_cndmask_b32 v216, 0, v7, vcc
v_cmp_le_i32 vcc, 1, v6
s_nop 1
v_cndmask_b32 v217, 0, v7, vcc
v_cmp_le_i32 vcc, 2, v6
s_nop 1
v_cndmask_b32 v218, 0, v7, vcc
v_cmp_le_i32 vcc, 3, v6
s_nop 1
v_cndmask_b32 v219, 0, v7, vcc
v_cmp_le_i32 vcc, 16, v6
s_nop 1
v_cndmask_b32 v220, 0, v7, vcc
v_cmp_le_i32 vcc, 17, v6
s_nop 1
v_cndmask_b32 v221, 0, v7, vcc
v_cmp_le_i32 vcc, 18, v6
s_nop 1
v_cndmask_b32 v222, 0, v7, vcc
v_cmp_le_i32 vcc, 19, v6
s_nop 1
v_cndmask_b32 v223, 0, v7, vcc
v_cmp_le_i32 vcc, 4, v6
s_nop 1
v_cndmask_b32 v224, 0, v7, vcc
v_cmp_le_i32 vcc, 5, v6
s_nop 1
v_cndmask_b32 v225, 0, v7, vcc
v_cmp_le_i32 vcc, 6, v6
s_nop 1
v_cndmask_b32 v226, 0, v7, vcc
v_cmp_le_i32 vcc, 7, v6
s_nop 1
v_cndmask_b32 v227, 0, v7, vcc
v_cmp_le_i32 vcc, 20, v6
s_nop 1
v_cndmask_b32 v228, 0, v7, vcc
v_cmp_le_i32 vcc, 21, v6
s_nop 1
v_cndmask_b32 v229, 0, v7, vcc
v_cmp_le_i32 vcc, 22, v6
s_nop 1
v_cndmask_b32 v230, 0, v7, vcc
v_cmp_le_i32 vcc, 23, v6
s_nop 1
v_cndmask_b32 v231, 0, v7, vcc
v_lshrrev_b32 v6, 2, v0
v_xor_b32 v6, v6, v0
v_and_b32 v6, 4, v6
v_mov_b32 v7, 0x3f803f80
v_cmp_eq_u32 vcc, 0, v6
s_nop 1
v_cndmask_b32 v212, 0, v7, vcc
v_cndmask_b32 v213, 0, v7, vcc
v_cndmask_b32 v214, 0, v7, vcc
v_cndmask_b32 v215, 0, v7, vcc
L_mtop:
v_lshrrev_b32 v10, 4, v0
s_cmp_eq_u32 s63, 0
s_cbranch_scc0 mq_89
v_bfe_u32 v11, v0, 1, 3
v_xor_b32 v11, v11, v10
v_lshlrev_b32 v11, 4, v11
v_and_b32 v12, 15, v0
v_lshl_add_u32 v6, v12, 7, v11
v_xor_b32 v7, 64, v6
s_branch mq_90
mq_89:
v_lshlrev_b32 v6, 4, v0
v_add_u32 v7, 1024, v6
mq_90:
s_lshl_b32 s66, s65, 13
s_add_u32 s66, s66, 86016
v_add_u32 v6, s66, v6
v_add_u32 v7, s66, v7
v_bfe_u32 v11, v0, 2, 2
v_lshl_add_u32 v11, v10, 3, v11
v_bfe_u32 v12, v0, 3, 2
s_lshl_b32 s66, s64, 1
v_xor_b32 v12, s66, v12
v_lshlrev_b32 v12, 5, v12
v_lshl_add_u32 v11, v11, 7, v12
v_and_b32 v12, 3, v0
v_lshl_add_u32 v11, v12, 3, v11
v_add_u32 v8, 102400, v11
v_xor_b32 v9, 32, v8
v_mov_b32 v11, 0xf149f2ca
v_xor_b32 v216, v11, v216
v_xor_b32 v217, v11, v217
v_xor_b32 v218, v11, v218
v_xor_b32 v219, v11, v219
v_xor_b32 v220, v11, v220
v_xor_b32 v221, v11, v221
v_xor_b32 v222, v11, v222
v_xor_b32 v223, v11, v223
v_xor_b32 v224, v11, v224
v_xor_b32 v225, v11, v225
v_xor_b32 v226, v11, v226
v_xor_b32 v227, v11, v227
v_xor_b32 v228, v11, v228
v_xor_b32 v229, v11, v229
v_xor_b32 v230, v11, v230
v_xor_b32 v231, v11, v231
v_mov_b32 v16, 0
v_mov_b32 v17, 0
v_mov_b32 v18, 0
v_mov_b32 v19, 0
v_mov_b32 v20, 0
v_mov_b32 v21, 0
v_mov_b32 v22, 0
v_mov_b32 v23, 0
v_mov_b32 v24, 0
v_mov_b32 v25, 0
v_mov_b32 v26, 0
v_mov_b32 v27, 0
v_mov_b32 v28, 0
v_mov_b32 v29, 0
v_mov_b32 v30, 0
v_mov_b32 v31, 0
v_mov_b32 v32, 0
v_mov_b32 v33, 0
v_mov_b32 v34, 0
v_mov_b32 v35, 0
v_mov_b32 v36, 0
v_mov_b32 v37, 0
v_mov_b32 v38, 0
v_mov_b32 v39, 0
v_mov_b32 v40, 0
v_mov_b32 v41, 0
v_mov_b32 v42, 0
v_mov_b32 v43, 0
v_mov_b32 v44, 0
v_mov_b32 v45, 0
v_mov_b32 v46, 0
v_mov_b32 v47, 0
v_mov_b32 v48, 0
v_mov_b32 v49, 0
v_mov_b32 v50, 0
v_mov_b32 v51, 0
v_mov_b32 v52, 0
v_mov_b32 v53, 0
v_mov_b32 v54, 0
v_mov_b32 v55, 0
v_mov_b32 v56, 0
v_mov_b32 v57, 0
v_mov_b32 v58, 0
v_mov_b32 v59, 0
v_mov_b32 v60, 0
v_mov_b32 v61, 0
v_mov_b32 v62, 0
v_mov_b32 v63, 0
v_mov_b32 v64, 0
v_mov_b32 v65, 0
v_mov_b32 v66, 0
v_mov_b32 v67, 0
v_mov_b32 v68, 0
v_mov_b32 v69, 0
v_mov_b32 v70, 0
v_mov_b32 v71, 0
v_mov_b32 v72, 0
v_mov_b32 v73, 0
v_mov_b32 v74, 0
v_mov_b32 v75, 0
v_mov_b32 v76, 0
v_mov_b32 v77, 0
v_mov_b32 v78, 0
v_mov_b32 v79, 0
v_mov_b32 v80, 0
v_mov_b32 v81, 0
v_mov_b32 v82, 0
v_mov_b32 v83, 0
v_mov_b32 v84, 0
v_mov_b32 v85, 0
v_mov_b32 v86, 0
v_mov_b32 v87, 0
v_mov_b32 v88, 0
v_mov_b32 v89, 0
v_mov_b32 v90, 0
v_mov_b32 v91, 0
v_mov_b32 v92, 0
v_mov_b32 v93, 0
v_mov_b32 v94, 0
v_mov_b32 v95, 0
v_mov_b32 v96, 0
v_mov_b32 v97, 0
v_mov_b32 v98, 0
v_mov_b32 v99, 0
v_mov_b32 v100, 0
v_mov_b32 v101, 0
v_mov_b32 v102, 0
v_mov_b32 v103, 0
v_mov_b32 v104, 0
v_mov_b32 v105, 0
v_mov_b32 v106, 0
v_mov_b32 v107, 0
v_mov_b32 v108, 0
v_mov_b32 v109, 0
v_mov_b32 v110, 0
v_mov_b32 v111, 0
v_mov_b32 v192, 0
v_mov_b32 v193, 0
v_mov_b32 v194, 0
v_mov_b32 v195, 0
v_mov_b32 v196, 0
v_mov_b32 v197, 0
v_mov_b32 v198, 0
v_mov_b32 v199, 0
v_mov_b32 v200, 0
v_mov_b32 v201, 0
v_mov_b32 v202, 0
v_mov_b32 v203, 0
v_mov_b32 v204, 0
v_mov_b32 v205, 0
v_mov_b32 v206, 0
v_mov_b32 v207, 0
v_mov_b32 v208, 0
v_mov_b32 v209, 0
v_mov_b32 v210, 0
v_mov_b32 v211, 0
v_add_u32 v4, s34, 1
s_mov_b32 s66, 16
s_mov_b32 s67, -40960
s_mov_b32 s68, -40960
s_mov_b32 s69, 81920
s_add_u32 s35, s34, 1
lw_91:
ds_read_b32 v5, v2 offset:16
s_waitcnt lgkmcnt(0)
v_cmp_gt_i32 vcc, s35, v5
s_cbranch_vccz lwd_92
s_sub_u32 s32, s32, 1
s_cmp_gt_i32 s32, 0
s_cbranch_scc1 lw_91
lwd_92:
ds_read_b64_tr_b16 v[144:145], v8 offset:8192
ds_read_b64_tr_b16 v[146:147], v8 offset:8704
ds_read_b64_tr_b16 v[148:149], v8 offset:12288
ds_read_b64_tr_b16 v[150:151], v8 offset:12800
ds_read_b128 v[112:115], v6 offset:0
ds_read_b128 v[116:119], v7 offset:0
ds_read_b64_tr_b16 v[152:153], v9 offset:8192
ds_read_b64_tr_b16 v[154:155], v9 offset:8704
ds_read_b64_tr_b16 v[156:157], v9 offset:12288
ds_read_b64_tr_b16 v[158:159], v9 offset:12800
ds_read_b128 v[120:123], v6 offset:2048
ds_read_b128 v[124:127], v7 offset:2048
ds_read_b128 v[128:131], v6 offset:4096
ds_read_b128 v[132:135], v7 offset:4096
ds_read_b128 v[136:139], v6 offset:6144
ds_read_b128 v[140:143], v7 offset:6144
.p2align 6
mqkv_93:
s_waitcnt lgkmcnt(7)
v_mfma_f32_16x16x32_bf16 v[16:19], v[144:147], v[112:115], v[16:19]
ds_read_b64_tr_b16 v[160:161], v8 offset:16384
s_waitcnt lgkmcnt(7)
v_mfma_f32_16x16x32_bf16 v[16:19], v[148:151], v[116:119], v[16:19]
ds_read_b64_tr_b16 v[162:163], v8 offset:16896
v_mfma_f32_16x16x32_bf16 v[20:23], v[152:155], v[112:115], v[20:23]
ds_read_b64_tr_b16 v[164:165], v8 offset:20480
v_mfma_f32_16x16x32_bf16 v[20:23], v[156:159], v[116:119], v[20:23]
ds_read_b64_tr_b16 v[166:167], v8 offset:20992
s_waitcnt lgkmcnt(9)
v_mfma_f32_16x16x32_bf16 v[24:27], v[144:147], v[120:123], v[24:27]
ds_read_b64_tr_b16 v[168:169], v9 offset:16384
s_waitcnt lgkmcnt(9)
v_mfma_f32_16x16x32_bf16 v[24:27], v[148:151], v[124:127], v[24:27]
ds_read_b64_tr_b16 v[170:171], v9 offset:16896
v_mfma_f32_16x16x32_bf16 v[28:31], v[152:155], v[120:123], v[28:31]
ds_read_b64_tr_b16 v[172:173], v9 offset:20480
v_mfma_f32_16x16x32_bf16 v[28:31], v[156:159], v[124:127], v[28:31]
ds_read_b64_tr_b16 v[174:175], v9 offset:20992
s_waitcnt lgkmcnt(11)
v_mfma_f32_16x16x32_bf16 v[32:35], v[144:147], v[128:131], v[32:35]
ds_read_b64_tr_b16 v[176:177], v8 offset:0
s_waitcnt lgkmcnt(11)
v_mfma_f32_16x16x32_bf16 v[32:35], v[148:151], v[132:135], v[32:35]
ds_read_b64_tr_b16 v[178:179], v8 offset:512
v_mfma_f32_16x16x32_bf16 v[36:39], v[152:155], v[128:131], v[36:39]
ds_read_b64_tr_b16 v[180:181], v8 offset:4096
v_mfma_f32_16x16x32_bf16 v[36:39], v[156:159], v[132:135], v[36:39]
ds_read_b64_tr_b16 v[182:183], v8 offset:4608
s_waitcnt lgkmcnt(13)
v_mfma_f32_16x16x32_bf16 v[40:43], v[144:147], v[136:139], v[40:43]
ds_read_b64_tr_b16 v[184:185], v9 offset:0
s_waitcnt lgkmcnt(13)
v_mfma_f32_16x16x32_bf16 v[40:43], v[148:151], v[140:143], v[40:43]
ds_read_b64_tr_b16 v[186:187], v9 offset:512
v_mfma_f32_16x16x32_bf16 v[44:47], v[152:155], v[136:139], v[44:47]
ds_read_b64_tr_b16 v[188:189], v9 offset:4096
v_mfma_f32_16x16x32_bf16 v[44:47], v[156:159], v[140:143], v[44:47]
ds_read_b64_tr_b16 v[190:191], v9 offset:4608
s_waitcnt lgkmcnt(14)
v_mfma_f32_16x16x32_bf16 v[48:51], v[112:115], v[160:163], v[48:51]
s_mov_b64 exec, 1
ds_write_b32 v3, v4
s_mov_b64 exec, -1
s_waitcnt lgkmcnt(13)
v_mfma_f32_16x16x32_bf16 v[48:51], v[116:119], v[164:167], v[48:51]
v_add_u32 v8, s67, v8
v_add_u32 v9, s67, v9
s_waitcnt lgkmcnt(11)
v_mfma_f32_16x16x32_bf16 v[52:55], v[112:115], v[168:171], v[52:55]
v_add_u32 v6, s67, v6
v_add_u32 v7, s67, v7
s_waitcnt lgkmcnt(9)
v_mfma_f32_16x16x32_bf16 v[52:55], v[116:119], v[172:175], v[52:55]
s_mov_b32 s70, s67
s_mov_b32 s67, s68
s_mov_b32 s68, s69
s_mov_b32 s69, s70
v_mfma_f32_16x16x32_bf16 v[56:59], v[120:123], v[160:163], v[56:59]
ds_read_b32 v5, v2 offset:16
v_mfma_f32_16x16x32_bf16 v[56:59], v[124:127], v[164:167], v[56:59]
v_mfma_f32_16x16x32_bf16 v[60:63], v[120:123], v[168:171], v[60:63]
v_mfma_f32_16x16x32_bf16 v[60:63], v[124:127], v[172:175], v[60:63]
v_mfma_f32_16x16x32_bf16 v[64:67], v[128:131], v[160:163], v[64:67]
s_waitcnt lgkmcnt(0)
v_cmp_ge_u32 vcc, v4, v5
s_cbranch_vccnz mspin_94
mback_95:
v_add_u32 v4, 1, v4
v_mfma_f32_16x16x32_bf16 v[64:67], v[132:135], v[164:167], v[64:67]
ds_read_b64_tr_b16 v[144:145], v8 offset:8192
v_mfma_f32_16x16x32_bf16 v[68:71], v[128:131], v[168:171], v[68:71]
ds_read_b64_tr_b16 v[146:147], v8 offset:8704
v_mfma_f32_16x16x32_bf16 v[68:71], v[132:135], v[172:175], v[68:71]
ds_read_b64_tr_b16 v[148:149], v8 offset:12288
v_mfma_f32_16x16x32_bf16 v[72:75], v[136:139], v[160:163], v[72:75]
ds_read_b64_tr_b16 v[150:151], v8 offset:12800
v_mfma_f32_16x16x32_bf16 v[72:75], v[140:143], v[164:167], v[72:75]
ds_read_b64_tr_b16 v[152:153], v9 offset:8192
v_mfma_f32_16x16x32_bf16 v[76:79], v[136:139], v[168:171], v[76:79]
ds_read_b64_tr_b16 v[154:155], v9 offset:8704
v_mfma_f32_16x16x32_bf16 v[76:79], v[140:143], v[172:175], v[76:79]
ds_read_b64_tr_b16 v[156:157], v9 offset:12288
v_mfma_f32_16x16x32_bf16 v[80:83], v[176:179], v[112:115], v[80:83]
ds_read_b64_tr_b16 v[158:159], v9 offset:12800
v_mfma_f32_16x16x32_bf16 v[80:83], v[180:183], v[116:119], v[80:83]
v_mfma_f32_16x16x32_bf16 v[84:87], v[184:187], v[112:115], v[84:87]
v_mfma_f32_16x16x32_bf16 v[84:87], v[188:191], v[116:119], v[84:87]
ds_read_b128 v[112:115], v6 offset:0
ds_read_b128 v[116:119], v7 offset:0
v_mfma_f32_16x16x32_bf16 v[88:91], v[176:179], v[120:123], v[88:91]
v_mfma_f32_16x16x32_bf16 v[88:91], v[180:183], v[124:127], v[88:91]
v_mfma_f32_16x16x32_bf16 v[92:95], v[184:187], v[120:123], v[92:95]
v_mfma_f32_16x16x32_bf16 v[92:95], v[188:191], v[124:127], v[92:95]
ds_read_b128 v[120:123], v6 offset:2048
ds_read_b128 v[124:127], v7 offset:2048
v_mfma_f32_16x16x32_bf16 v[96:99], v[176:179], v[128:131], v[96:99]
v_mfma_f32_16x16x32_bf16 v[96:99], v[180:183], v[132:135], v[96:99]
v_mfma_f32_16x16x32_bf16 v[100:103], v[184:187], v[128:131], v[100:103]
v_mfma_f32_16x16x32_bf16 v[100:103], v[188:191], v[132:135], v[100:103]
ds_read_b128 v[128:131], v6 offset:4096
ds_read_b128 v[132:135], v7 offset:4096
v_mfma_f32_16x16x32_bf16 v[104:107], v[176:179], v[136:139], v[104:107]
v_mfma_f32_16x16x32_bf16 v[104:107], v[180:183], v[140:143], v[104:107]
s_sub_u32 s66, s66, 1
s_cmp_eq_u32 s66, 0
v_mfma_f32_16x16x32_bf16 v[108:111], v[184:187], v[136:139], v[108:111]
v_mfma_f32_16x16x32_bf16 v[108:111], v[188:191], v[140:143], v[108:111]
ds_read_b128 v[136:139], v6 offset:6144
ds_read_b128 v[140:143], v7 offset:6144
s_cbranch_scc0 mqkv_93
v_and_b32 v10, 15, v0
v_lshrrev_b32 v11, 4, v0
s_lshl_b32 s66, s65, 8
s_add_u32 s66, s66, 1280
s_mul_i32 s67, s64, 384
v_lshl_add_u32 v6, v10, 2, s66
v_lshl_add_u32 v7, v11, 4, s66
v_lshl_add_u32 v8, v10, 2, s67
v_lshl_add_u32 v9, v11, 4, s67
v_and_b32 v12, 1, v11
v_lshrrev_b32 v11, 1, v11
v_lshlrev_b32 v11, 9, v11
v_lshl_add_u32 v11, v12, 10, v11
s_lshl_b32 s66, s64, 12
s_lshl_b32 s67, s65, 13
s_add_u32 s66, s66, 131072
s_add_u32 s68, s66, 24576
s_sub_u32 s68, s68, s67
s_add_u32 s67, s66, s67
v_lshl_add_u32 v14, v10, 4, v11
v_and_b32 v12, 3, v0
v_lshl_add_u32 v11, v12, 4, v11
v_bfe_u32 v12, v0, 3, 1
v_lshl_add_u32 v11, v12, 6, v11
v_bfe_u32 v12, v0, 2, 1
v_lshl_add_u32 v12, v12, 8, v11
v_add_u32 v13, s68, v12
v_add_u32 v12, s67, v12
v_add_u32 v15, s68, v14
v_add_u32 v14, s67, v14
s_lshl_b32 s66, s59, 4
s_add_u32 s66, s66, s60
s_lshl_b32 s72, s66, 7
s_lshl_b32 s66, s66, 15
s_lshl_b32 s67, s63, 23
s_add_u32 s66, s66, s67
s_add_u32 s71, s66, 917504
s_add_u32 s35, s34, 2
lw_96:
ds_read_b32 v5, v2 offset:24
s_waitcnt lgkmcnt(0)
v_cmp_gt_i32 vcc, s35, v5
s_cbranch_vccz lwd_97
s_sub_u32 s32, s32, 1
s_cmp_gt_i32 s32, 0
s_cbranch_scc1 lw_96
lwd_97:
v_mov_b32 v10, 0
ds_read_b32 v10, v10 offset:32
ds_read2_b32 v[144:145], v6 offset0:0 offset1:128
ds_read2_b32 v[146:147], v6 offset0:16 offset1:144
ds_read2_b32 v[148:149], v6 offset0:32 offset1:160
ds_read2_b32 v[150:151], v6 offset0:48 offset1:176
ds_read_b128 v[152:155], v9 offset:2432
ds_read_b128 v[156:159], v9 offset:2496
ds_read_b32 v168, v8 offset:2560
ds_read_b32 v169, v8 offset:2624
ds_read_b128 v[112:115], v7 offset:0
ds_read_b128 v[128:131], v7 offset:512
ds_read_b128 v[116:119], v7 offset:64
ds_read_b128 v[132:135], v7 offset:576
s_waitcnt lgkmcnt(12)
v_readfirstlane_b32 s33, v10
s_sub_u32 s33, s33, 1
s_lshr_b32 s66, s33, 7
s_cmp_eq_u32 s66, s59
s_cbranch_scc1 patch_98
pback_99:
s_waitcnt lgkmcnt(11)
v_pk_mul_f32 v[16:17], v[16:17], v[144:145] op_sel:[0,0] op_sel_hi:[1,0]
v_pk_mul_f32 v[18:19], v[18:19], v[144:145] op_sel:[0,0] op_sel_hi:[1,0]
v_pk_mul_f32 v[20:21], v[20:21], v[144:145] op_sel:[0,0] op_sel_hi:[1,0]
v_pk_mul_f32 v[22:23], v[22:23], v[144:145] op_sel:[0,0] op_sel_hi:[1,0]
s_waitcnt lgkmcnt(7)
v_pk_fma_f32 v[16:17], v[152:153], v[144:145], v[16:17] op_sel:[0,1,0] op_sel_hi:[1,1,1]
v_pk_fma_f32 v[18:19], v[154:155], v[144:145], v[18:19] op_sel:[0,1,0] op_sel_hi:[1,1,1]
s_waitcnt lgkmcnt(6)
v_pk_fma_f32 v[20:21], v[156:157], v[144:145], v[20:21] op_sel:[0,1,0] op_sel_hi:[1,1,1]
v_pk_fma_f32 v[22:23], v[158:159], v[144:145], v[22:23] op_sel:[0,1,0] op_sel_hi:[1,1,1]
v_cvt_pk_bf16_f32 v16, v16, v17
v_cvt_pk_bf16_f32 v17, v18, v19
v_cvt_pk_bf16_f32 v18, v20, v21
v_cvt_pk_bf16_f32 v19, v22, v23
buffer_store_dwordx4 v[16:19], v12, s[20:23], s71 offen offset:0 sc1
ds_write_b128 v12, v[16:19] offset:0
ds_read_b128 v[120:123], v7 offset:128
ds_read_b128 v[136:139], v7 offset:640
ds_read_b128 v[124:127], v7 offset:192
ds_read_b128 v[140:143], v7 offset:704
ds_read_b128 v[160:163], v9 offset:2304
ds_read_b128 v[164:167], v9 offset:2368
v_pk_mul_f32 v[24:25], v[24:25], v[146:147] op_sel:[0,0] op_sel_hi:[1,0]
v_pk_mul_f32 v[26:27], v[26:27], v[146:147] op_sel:[0,0] op_sel_hi:[1,0]
v_pk_mul_f32 v[28:29], v[28:29], v[146:147] op_sel:[0,0] op_sel_hi:[1,0]
v_pk_mul_f32 v[30:31], v[30:31], v[146:147] op_sel:[0,0] op_sel_hi:[1,0]
v_pk_fma_f32 v[24:25], v[152:153], v[146:147], v[24:25] op_sel:[0,1,0] op_sel_hi:[1,1,1]
v_pk_fma_f32 v[26:27], v[154:155], v[146:147], v[26:27] op_sel:[0,1,0] op_sel_hi:[1,1,1]
v_pk_fma_f32 v[28:29], v[156:157], v[146:147], v[28:29] op_sel:[0,1,0] op_sel_hi:[1,1,1]
v_pk_fma_f32 v[30:31], v[158:159], v[146:147], v[30:31] op_sel:[0,1,0] op_sel_hi:[1,1,1]
v_cvt_pk_bf16_f32 v24, v24, v25
v_cvt_pk_bf16_f32 v25, v26, v27
v_cvt_pk_bf16_f32 v26, v28, v29
v_cvt_pk_bf16_f32 v27, v30, v31
buffer_store_dwordx4 v[24:27], v12, s[20:23], s71 offen offset:128 sc1
ds_write_b128 v12, v[24:27] offset:128
v_pk_mul_f32 v[32:33], v[32:33], v[148:149] op_sel:[0,0] op_sel_hi:[1,0]
v_pk_mul_f32 v[34:35], v[34:35], v[148:149] op_sel:[0,0] op_sel_hi:[1,0]
v_pk_mul_f32 v[36:37], v[36:37], v[148:149] op_sel:[0,0] op_sel_hi:[1,0]
v_pk_mul_f32 v[38:39], v[38:39], v[148:149] op_sel:[0,0] op_sel_hi:[1,0]
v_pk_fma_f32 v[32:33], v[152:153], v[148:149], v[32:33] op_sel:[0,1,0] op_sel_hi:[1,1,1]
v_pk_fma_f32 v[34:35], v[154:155], v[148:149], v[34:35] op_sel:[0,1,0] op_sel_hi:[1,1,1]
v_pk_fma_f32 v[36:37], v[156:157], v[148:149], v[36:37] op_sel:[0,1,0] op_sel_hi:[1,1,1]
v_pk_fma_f32 v[38:39], v[158:159], v[148:149], v[38:39] op_sel:[0,1,0] op_sel_hi:[1,1,1]
v_cvt_pk_bf16_f32 v32, v32, v33
v_cvt_pk_bf16_f32 v33, v34, v35
v_cvt_pk_bf16_f32 v34, v36, v37
v_cvt_pk_bf16_f32 v35, v38, v39
buffer_store_dwordx4 v[32:35], v13, s[20:23], s71 offen offset:0 sc1
ds_write_b128 v13, v[32:35] offset:0
v_pk_mul_f32 v[40:41], v[40:41], v[150:151] op_sel:[0,0] op_sel_hi:[1,0]
v_pk_mul_f32 v[42:43], v[42:43], v[150:151] op_sel:[0,0] op_sel_hi:[1,0]
v_pk_mul_f32 v[44:45], v[44:45], v[150:151] op_sel:[0,0] op_sel_hi:[1,0]
v_pk_mul_f32 v[46:47], v[46:47], v[150:151] op_sel:[0,0] op_sel_hi:[1,0]
v_pk_fma_f32 v[40:41], v[152:153], v[150:151], v[40:41] op_sel:[0,1,0] op_sel_hi:[1,1,1]
v_pk_fma_f32 v[42:43], v[154:155], v[150:151], v[42:43] op_sel:[0,1,0] op_sel_hi:[1,1,1]
v_pk_fma_f32 v[44:45], v[156:157], v[150:151], v[44:45] op_sel:[0,1,0] op_sel_hi:[1,1,1]
v_pk_fma_f32 v[46:47], v[158:159], v[150:151], v[46:47] op_sel:[0,1,0] op_sel_hi:[1,1,1]
v_cvt_pk_bf16_f32 v40, v40, v41
v_cvt_pk_bf16_f32 v41, v42, v43
v_cvt_pk_bf16_f32 v42, v44, v45
v_cvt_pk_bf16_f32 v43, v46, v47
buffer_store_dwordx4 v[40:43], v13, s[20:23], s71 offen offset:128 sc1
ds_write_b128 v13, v[40:43] offset:128
s_waitcnt lgkmcnt(13)
v_pk_mul_f32 v[48:49], v[48:49], v[112:113]
v_pk_mul_f32 v[50:51], v[50:51], v[114:115]
s_waitcnt lgkmcnt(12)
v_pk_fma_f32 v[48:49], v[128:129], v[168:169], v[48:49] op_sel:[0,0,0] op_sel_hi:[1,0,1]
v_pk_fma_f32 v[50:51], v[130:131], v[168:169], v[50:51] op_sel:[0,0,0] op_sel_hi:[1,0,1]
s_waitcnt lgkmcnt(11)
v_pk_mul_f32 v[56:57], v[56:57], v[116:117]
v_pk_mul_f32 v[58:59], v[58:59], v[118:119]
s_waitcnt lgkmcnt(10)
v_pk_fma_f32 v[56:57], v[132:133], v[168:169], v[56:57] op_sel:[0,0,0] op_sel_hi:[1,0,1]
v_pk_fma_f32 v[58:59], v[134:135], v[168:169], v[58:59] op_sel:[0,0,0] op_sel_hi:[1,0,1]
v_cvt_pk_bf16_f32 v48, v48, v49
v_cvt_pk_bf16_f32 v49, v50, v51
v_cvt_pk_bf16_f32 v50, v56, v57
v_cvt_pk_bf16_f32 v51, v58, v59
buffer_store_dwordx4 v[48:51], v14, s[20:23], s71 offen offset:2048 sc1
ds_write_b128 v14, v[48:51] offset:2048
v_pk_mul_f32 v[52:53], v[52:53], v[112:113]
v_pk_mul_f32 v[54:55], v[54:55], v[114:115]
v_pk_fma_f32 v[52:53], v[128:129], v[168:169], v[52:53] op_sel:[0,1,0] op_sel_hi:[1,1,1]
v_pk_fma_f32 v[54:55], v[130:131], v[168:169], v[54:55] op_sel:[0,1,0] op_sel_hi:[1,1,1]
v_pk_mul_f32 v[60:61], v[60:61], v[116:117]
v_pk_mul_f32 v[62:63], v[62:63], v[118:119]
v_pk_fma_f32 v[60:61], v[132:133], v[168:169], v[60:61] op_sel:[0,1,0] op_sel_hi:[1,1,1]
v_pk_fma_f32 v[62:63], v[134:135], v[168:169], v[62:63] op_sel:[0,1,0] op_sel_hi:[1,1,1]
v_cvt_pk_bf16_f32 v52, v52, v53
v_cvt_pk_bf16_f32 v53, v54, v55
v_cvt_pk_bf16_f32 v54, v60, v61
v_cvt_pk_bf16_f32 v55, v62, v63
buffer_store_dwordx4 v[52:55], v14, s[20:23], s71 offen offset:2304 sc1
ds_write_b128 v14, v[52:55] offset:2304
s_waitcnt lgkmcnt(10)
v_pk_mul_f32 v[64:65], v[64:65], v[120:121]
v_pk_mul_f32 v[66:67], v[66:67], v[122:123]
s_waitcnt lgkmcnt(9)
v_pk_fma_f32 v[64:65], v[136:137], v[168:169], v[64:65] op_sel:[0,0,0] op_sel_hi:[1,0,1]
v_pk_fma_f32 v[66:67], v[138:139], v[168:169], v[66:67] op_sel:[0,0,0] op_sel_hi:[1,0,1]
s_waitcnt lgkmcnt(8)
v_pk_mul_f32 v[72:73], v[72:73], v[124:125]
v_pk_mul_f32 v[74:75], v[74:75], v[126:127]
s_waitcnt lgkmcnt(7)
v_pk_fma_f32 v[72:73], v[140:141], v[168:169], v[72:73] op_sel:[0,0,0] op_sel_hi:[1,0,1]
v_pk_fma_f32 v[74:75], v[142:143], v[168:169], v[74:75] op_sel:[0,0,0] op_sel_hi:[1,0,1]
v_cvt_pk_bf16_f32 v64, v64, v65
v_cvt_pk_bf16_f32 v65, v66, v67
v_cvt_pk_bf16_f32 v66, v72, v73
v_cvt_pk_bf16_f32 v67, v74, v75
buffer_store_dwordx4 v[64:67], v15, s[20:23], s71 offen offset:2048 sc1
ds_write_b128 v15, v[64:67] offset:2048
v_pk_mul_f32 v[68:69], v[68:69], v[120:121]
v_pk_mul_f32 v[70:71], v[70:71], v[122:123]
v_pk_fma_f32 v[68:69], v[136:137], v[168:169], v[68:69] op_sel:[0,1,0] op_sel_hi:[1,1,1]
v_pk_fma_f32 v[70:71], v[138:139], v[168:169], v[70:71] op_sel:[0,1,0] op_sel_hi:[1,1,1]
v_pk_mul_f32 v[76:77], v[76:77], v[124:125]
v_pk_mul_f32 v[78:79], v[78:79], v[126:127]
v_pk_fma_f32 v[76:77], v[140:141], v[168:169], v[76:77] op_sel:[0,1,0] op_sel_hi:[1,1,1]
v_pk_fma_f32 v[78:79], v[142:143], v[168:169], v[78:79] op_sel:[0,1,0] op_sel_hi:[1,1,1]
v_cvt_pk_bf16_f32 v68, v68, v69
v_cvt_pk_bf16_f32 v69, v70, v71
v_cvt_pk_bf16_f32 v70, v76, v77
v_cvt_pk_bf16_f32 v71, v78, v79
buffer_store_dwordx4 v[68:71], v15, s[20:23], s71 offen offset:2304 sc1
ds_write_b128 v15, v[68:71] offset:2304
v_add_u32 v5, s34, 17
s_mov_b64 exec, 1
ds_write_b32 v3, v5
s_mov_b64 exec, -1
s_mov_b32 s66, 0x3e8293ee
v_mul_f32 v144, s66, v144
v_mul_f32 v145, s66, v145
v_mul_f32 v146, s66, v146
v_mul_f32 v147, s66, v147
v_mul_f32 v148, s66, v148
v_mul_f32 v149, s66, v149
v_mul_f32 v150, s66, v150
v_mul_f32 v151, s66, v151
v_pk_mul_f32 v[96:97], v[96:97], v[148:149] op_sel:[0,0] op_sel_hi:[1,0]
v_pk_mul_f32 v[98:99], v[98:99], v[148:149] op_sel:[0,0] op_sel_hi:[1,0]
v_pk_mul_f32 v[100:101], v[100:101], v[148:149] op_sel:[0,0] op_sel_hi:[1,0]
v_pk_mul_f32 v[102:103], v[102:103], v[148:149] op_sel:[0,0] op_sel_hi:[1,0]
s_waitcnt lgkmcnt(9)
v_pk_fma_f32 v[96:97], v[160:161], v[148:149], v[96:97] op_sel:[0,1,0] op_sel_hi:[1,1,1]
v_pk_fma_f32 v[98:99], v[162:163], v[148:149], v[98:99] op_sel:[0,1,0] op_sel_hi:[1,1,1]
s_waitcnt lgkmcnt(8)
v_pk_fma_f32 v[100:101], v[164:165], v[148:149], v[100:101] op_sel:[0,1,0] op_sel_hi:[1,1,1]
v_pk_fma_f32 v[102:103], v[166:167], v[148:149], v[102:103] op_sel:[0,1,0] op_sel_hi:[1,1,1]
v_cvt_pk_bf16_f32 v96, v96, v97
v_cvt_pk_bf16_f32 v97, v98, v99
v_cvt_pk_bf16_f32 v98, v100, v101
v_cvt_pk_bf16_f32 v99, v102, v103
v_pk_mul_f32 v[104:105], v[104:105], v[150:151] op_sel:[0,0] op_sel_hi:[1,0]
v_pk_mul_f32 v[106:107], v[106:107], v[150:151] op_sel:[0,0] op_sel_hi:[1,0]
v_pk_mul_f32 v[108:109], v[108:109], v[150:151] op_sel:[0,0] op_sel_hi:[1,0]
v_pk_mul_f32 v[110:111], v[110:111], v[150:151] op_sel:[0,0] op_sel_hi:[1,0]
v_pk_fma_f32 v[104:105], v[160:161], v[150:151], v[104:105] op_sel:[0,1,0] op_sel_hi:[1,1,1]
v_pk_fma_f32 v[106:107], v[162:163], v[150:151], v[106:107] op_sel:[0,1,0] op_sel_hi:[1,1,1]
v_pk_fma_f32 v[108:109], v[164:165], v[150:151], v[108:109] op_sel:[0,1,0] op_sel_hi:[1,1,1]
v_pk_fma_f32 v[110:111], v[166:167], v[150:151], v[110:111] op_sel:[0,1,0] op_sel_hi:[1,1,1]
v_cvt_pk_bf16_f32 v104, v104, v105
v_cvt_pk_bf16_f32 v105, v106, v107
v_cvt_pk_bf16_f32 v106, v108, v109
v_cvt_pk_bf16_f32 v107, v110, v111
v_pk_mul_f32 v[80:81], v[80:81], v[144:145] op_sel:[0,0] op_sel_hi:[1,0]
v_pk_mul_f32 v[82:83], v[82:83], v[144:145] op_sel:[0,0] op_sel_hi:[1,0]
v_pk_mul_f32 v[84:85], v[84:85], v[144:145] op_sel:[0,0] op_sel_hi:[1,0]
v_pk_mul_f32 v[86:87], v[86:87], v[144:145] op_sel:[0,0] op_sel_hi:[1,0]
v_pk_fma_f32 v[80:81], v[160:161], v[144:145], v[80:81] op_sel:[0,1,0] op_sel_hi:[1,1,1]
v_pk_fma_f32 v[82:83], v[162:163], v[144:145], v[82:83] op_sel:[0,1,0] op_sel_hi:[1,1,1]
v_pk_fma_f32 v[84:85], v[164:165], v[144:145], v[84:85] op_sel:[0,1,0] op_sel_hi:[1,1,1]
v_pk_fma_f32 v[86:87], v[166:167], v[144:145], v[86:87] op_sel:[0,1,0] op_sel_hi:[1,1,1]
v_cvt_pk_bf16_f32 v80, v80, v81
v_cvt_pk_bf16_f32 v81, v82, v83
v_cvt_pk_bf16_f32 v82, v84, v85
v_cvt_pk_bf16_f32 v83, v86, v87
v_pk_mul_f32 v[88:89], v[88:89], v[146:147] op_sel:[0,0] op_sel_hi:[1,0]
v_pk_mul_f32 v[90:91], v[90:91], v[146:147] op_sel:[0,0] op_sel_hi:[1,0]
v_pk_mul_f32 v[92:93], v[92:93], v[146:147] op_sel:[0,0] op_sel_hi:[1,0]
v_pk_mul_f32 v[94:95], v[94:95], v[146:147] op_sel:[0,0] op_sel_hi:[1,0]
v_pk_fma_f32 v[88:89], v[160:161], v[146:147], v[88:89] op_sel:[0,1,0] op_sel_hi:[1,1,1]
v_pk_fma_f32 v[90:91], v[162:163], v[146:147], v[90:91] op_sel:[0,1,0] op_sel_hi:[1,1,1]
v_pk_fma_f32 v[92:93], v[164:165], v[146:147], v[92:93] op_sel:[0,1,0] op_sel_hi:[1,1,1]
v_pk_fma_f32 v[94:95], v[166:167], v[146:147], v[94:95] op_sel:[0,1,0] op_sel_hi:[1,1,1]
v_cvt_pk_bf16_f32 v88, v88, v89
v_cvt_pk_bf16_f32 v89, v90, v91
v_cvt_pk_bf16_f32 v90, v92, v93
v_cvt_pk_bf16_f32 v91, v94, v95
v_permlane16_swap_b32 v96, v104
v_permlane16_swap_b32 v97, v105
v_permlane16_swap_b32 v98, v106
v_permlane16_swap_b32 v99, v107
v_permlane16_swap_b32 v80, v88
v_permlane16_swap_b32 v81, v89
v_permlane16_swap_b32 v82, v90
v_permlane16_swap_b32 v83, v91
s_lshl_b32 s69, s64, 12
v_lshl_add_u32 v6, v0, 4, s69
v_add_u32 v7, 131072, v6
s_lshl_b32 s69, s65, 13
s_add_u32 s66, s69, 131072
s_sub_u32 s69, 147456, s69
v_add_u32 v8, s69, v6
ds_read_b128 v[152:155], v8 offset:8192
ds_read_b128 v[156:159], v8 offset:9216
s_mov_b32 s67, 122880
s_min_u32 s69, s59, 1
s_lshl2_add_u32 s68, s69, s65
s_cmp_ge_u32 s59, 2
s_cselect_b32 s69, s65, 0
s_add_u32 s68, s68, s69
ds_read_b128 v[160:163], v8 offset:10240
ds_read_b128 v[164:167], v8 offset:11264
s_waitcnt lgkmcnt(3)
v_mfma_f32_32x32x16_bf16 v[112:127], v[152:155], v[96:99], v[216:231]
s_waitcnt lgkmcnt(2)
v_mfma_f32_32x32x16_bf16 v[112:127], v[156:159], v[104:107], v[112:127]
s_add_u32 s35, s34, 17
lw_100:
ds_read_b32 v5, v1 offset:0
s_waitcnt lgkmcnt(0)
v_cmp_gt_i32 vcc, s35, v5
s_cbranch_vccz lwd_101
s_sub_u32 s32, s32, 1
s_cmp_gt_i32 s32, 0
s_cbranch_scc1 lw_100
lwd_101:
ds_read_b128 v[152:155], v8 offset:0
ds_read_b128 v[156:159], v8 offset:1024
.p2align 3
s_nop 4
v_exp_f32 v112, v112
v_exp_f32 v113, v113
v_exp_f32 v114, v114
v_exp_f32 v115, v115
v_exp_f32 v116, v116
v_exp_f32 v117, v117
s_waitcnt lgkmcnt(1)
v_mfma_f32_32x32x16_bf16 v[128:143], v[152:155], v[96:99], 0
v_exp_f32 v118, v118
v_exp_f32 v119, v119
v_cvt_pk_bf16_f32 v144, v112, v113
v_cvt_pk_bf16_f32 v145, v114, v115
s_waitcnt lgkmcnt(0)
v_mfma_f32_32x32x16_bf16 v[128:143], v[156:159], v[104:107], v[128:143]
ds_read_b128 v[152:155], v7 offset:8192
ds_read_b128 v[156:159], v7 offset:9216
v_cvt_pk_bf16_f32 v146, v116, v117
v_cvt_pk_bf16_f32 v147, v118, v119
v_exp_f32 v120, v120
v_exp_f32 v121, v121
v_mfma_f32_32x32x16_bf16 v[16:31], v[160:163], v[144:147], 0
ds_read_b128 v[160:163], v8 offset:2048
v_exp_f32 v122, v122
v_exp_f32 v123, v123
v_exp_f32 v124, v124
v_mfma_f32_16x16x32_bf16 v[32:35], v[212:215], v[144:147], 0
s_cmp_eq_u32 s65, 1
v_exp_f32 v125, v125
v_exp_f32 v126, v126
v_exp_f32 v127, v127
v_cvt_pk_bf16_f32 v148, v120, v121
v_cvt_pk_bf16_f32 v149, v122, v123
v_cvt_pk_bf16_f32 v150, v124, v125
v_cvt_pk_bf16_f32 v151, v126, v127
s_cbranch_scc1 at_102
v_exp_f32 v128, v128
v_exp_f32 v129, v129
v_mfma_f32_32x32x16_bf16 v[16:31], v[164:167], v[148:151], v[16:31]
ds_read_b128 v[164:167], v8 offset:3072
v_exp_f32 v130, v130
v_exp_f32 v131, v131
v_exp_f32 v132, v132
v_mfma_f32_16x16x32_bf16 v[32:35], v[212:215], v[148:151], v[32:35]
v_exp_f32 v133, v133
s_waitcnt lgkmcnt(3)
v_mfma_f32_32x32x16_bf16 v[112:127], v[152:155], v[96:99], 0
v_exp_f32 v134, v134
v_exp_f32 v135, v135
v_cvt_pk_bf16_f32 v144, v128, v129
v_cvt_pk_bf16_f32 v145, v130, v131
s_waitcnt lgkmcnt(2)
v_mfma_f32_32x32x16_bf16 v[112:127], v[156:159], v[104:107], v[112:127]
ds_read_b128 v[152:155], v7 offset:0
ds_read_b128 v[156:159], v7 offset:1024
v_cvt_pk_bf16_f32 v146, v132, v133
v_cvt_pk_bf16_f32 v147, v134, v135
v_exp_f32 v136, v136
v_exp_f32 v137, v137
s_waitcnt lgkmcnt(3)
v_mfma_f32_32x32x16_bf16 v[16:31], v[160:163], v[144:147], v[16:31]
ds_read_b128 v[160:163], v7 offset:10240
v_exp_f32 v138, v138
v_exp_f32 v139, v139
v_exp_f32 v140, v140
v_mfma_f32_16x16x32_bf16 v[32:35], v[212:215], v[144:147], v[32:35]
v_exp_f32 v141, v141
v_exp_f32 v142, v142
v_exp_f32 v143, v143
v_cvt_pk_bf16_f32 v148, v136, v137
v_cvt_pk_bf16_f32 v149, v138, v139
v_cvt_pk_bf16_f32 v150, v140, v141
v_cvt_pk_bf16_f32 v151, v142, v143
v_exp_f32 v112, v112
v_exp_f32 v113, v113
s_waitcnt lgkmcnt(3)
v_mfma_f32_32x32x16_bf16 v[16:31], v[164:167], v[148:151], v[16:31]
ds_read_b128 v[164:167], v7 offset:11264
v_exp_f32 v114, v114
v_exp_f32 v115, v115
v_exp_f32 v116, v116
v_mfma_f32_16x16x32_bf16 v[32:35], v[212:215], v[148:151], v[32:35]
v_exp_f32 v117, v117
s_waitcnt lgkmcnt(3)
v_mfma_f32_32x32x16_bf16 v[128:143], v[152:155], v[96:99], 0
v_exp_f32 v118, v118
v_exp_f32 v119, v119
v_cvt_pk_bf16_f32 v144, v112, v113
v_cvt_pk_bf16_f32 v145, v114, v115
s_waitcnt lgkmcnt(2)
v_mfma_f32_32x32x16_bf16 v[128:143], v[156:159], v[104:107], v[128:143]
v_cvt_pk_bf16_f32 v146, v116, v117
v_cvt_pk_bf16_f32 v147, v118, v119
v_exp_f32 v120, v120
v_exp_f32 v121, v121
s_waitcnt lgkmcnt(1)
v_mfma_f32_32x32x16_bf16 v[16:31], v[160:163], v[144:147], v[16:31]
ds_read_b128 v[160:163], v7 offset:2048
v_exp_f32 v122, v122
v_exp_f32 v123, v123
v_exp_f32 v124, v124
v_mfma_f32_16x16x32_bf16 v[32:35], v[212:215], v[144:147], v[32:35]
v_mov_b32 v8, v7
v_exp_f32 v125, v125
v_exp_f32 v126, v126
v_exp_f32 v127, v127
v_cvt_pk_bf16_f32 v148, v120, v121
v_cvt_pk_bf16_f32 v149, v122, v123
v_cvt_pk_bf16_f32 v150, v124, v125
v_cvt_pk_bf16_f32 v151, v126, v127
.p2align 3
at_102:
v_exp_f32 v128, v128
v_exp_f32 v129, v129
s_waitcnt lgkmcnt(1)
v_mfma_f32_32x32x16_bf16 v[16:31], v[164:167], v[148:151], v[16:31]
ds_read_b128 v[164:167], v8 offset:3072
v_exp_f32 v130, v130
v_exp_f32 v131, v131
v_exp_f32 v132, v132
v_mfma_f32_16x16x32_bf16 v[32:35], v[212:215], v[148:151], v[32:35]
v_exp_f32 v133, v133
v_mfma_f32_32x32x16_bf16 v[112:127], v[152:155], v[80:83], v[216:231]
v_exp_f32 v134, v134
v_exp_f32 v135, v135
v_cvt_pk_bf16_f32 v144, v128, v129
v_cvt_pk_bf16_f32 v145, v130, v131
v_mfma_f32_32x32x16_bf16 v[112:127], v[156:159], v[88:91], v[112:127]
s_sub_u32 s66, s66, 8192
s_cmp_eq_u32 s66, s67
s_cbranch_scc1 cross_109
cback_110:
v_add_u32 v8, s66, v6
ds_read_b128 v[152:155], v8 offset:0
ds_read_b128 v[156:159], v8 offset:1024
v_cvt_pk_bf16_f32 v146, v132, v133
v_cvt_pk_bf16_f32 v147, v134, v135
v_exp_f32 v136, v136
v_exp_f32 v137, v137
s_waitcnt lgkmcnt(3)
v_mfma_f32_32x32x16_bf16 v[16:31], v[160:163], v[144:147], v[16:31]
v_exp_f32 v138, v138
v_exp_f32 v139, v139
v_exp_f32 v140, v140
v_mfma_f32_16x16x32_bf16 v[32:35], v[212:215], v[144:147], v[32:35]
s_cmp_eq_u32 s68, 0
v_exp_f32 v141, v141
v_exp_f32 v142, v142
v_exp_f32 v143, v143
v_cvt_pk_bf16_f32 v148, v136, v137
v_cvt_pk_bf16_f32 v149, v138, v139
v_cvt_pk_bf16_f32 v150, v140, v141
v_cvt_pk_bf16_f32 v151, v142, v143
s_cbranch_scc1 at_106
.p2align 3
at_103:
v_exp_f32 v112, v112
v_exp_f32 v113, v113
s_waitcnt lgkmcnt(2)
v_mfma_f32_32x32x16_bf16 v[16:31], v[164:167], v[148:151], v[16:31]
v_exp_f32 v114, v114
v_exp_f32 v115, v115
v_exp_f32 v116, v116
v_mfma_f32_16x16x32_bf16 v[32:35], v[212:215], v[148:151], v[32:35]
v_exp_f32 v117, v117
s_waitcnt lgkmcnt(1)
v_mfma_f32_32x32x16_bf16 v[128:143], v[152:155], v[96:99], 0
v_exp_f32 v118, v118
v_exp_f32 v119, v119
v_cvt_pk_bf16_f32 v144, v112, v113
v_cvt_pk_bf16_f32 v145, v114, v115
s_waitcnt lgkmcnt(0)
v_mfma_f32_32x32x16_bf16 v[128:143], v[156:159], v[104:107], v[128:143]
v_cvt_pk_bf16_f32 v146, v116, v117
v_cvt_pk_bf16_f32 v147, v118, v119
v_exp_f32 v120, v120
v_exp_f32 v121, v121
v_mfma_f32_32x32x16_bf16 v[192:207], v[160:163], v[144:147], v[192:207]
ds_read_b128 v[160:163], v8 offset:2048
v_exp_f32 v122, v122
v_exp_f32 v123, v123
v_exp_f32 v124, v124
v_mfma_f32_16x16x32_bf16 v[208:211], v[212:215], v[144:147], v[208:211]
v_exp_f32 v125, v125
v_exp_f32 v126, v126
v_exp_f32 v127, v127
v_cvt_pk_bf16_f32 v148, v120, v121
v_cvt_pk_bf16_f32 v149, v122, v123
v_cvt_pk_bf16_f32 v150, v124, v125
v_cvt_pk_bf16_f32 v151, v126, v127
v_exp_f32 v128, v128
v_exp_f32 v129, v129
v_mfma_f32_32x32x16_bf16 v[192:207], v[164:167], v[148:151], v[192:207]
ds_read_b128 v[164:167], v8 offset:3072
v_exp_f32 v130, v130
v_exp_f32 v131, v131
v_exp_f32 v132, v132
v_mfma_f32_16x16x32_bf16 v[208:211], v[212:215], v[148:151], v[208:211]
v_exp_f32 v133, v133
v_mfma_f32_32x32x16_bf16 v[112:127], v[152:155], v[80:83], 0
v_exp_f32 v134, v134
v_exp_f32 v135, v135
v_cvt_pk_bf16_f32 v144, v128, v129
v_cvt_pk_bf16_f32 v145, v130, v131
v_mfma_f32_32x32x16_bf16 v[112:127], v[156:159], v[88:91], v[112:127]
s_sub_u32 s66, s66, 8192
s_cmp_eq_u32 s66, s67
s_cbranch_scc1 cross_111
cback_112:
v_add_u32 v8, s66, v6
ds_read_b128 v[152:155], v8 offset:0
ds_read_b128 v[156:159], v8 offset:1024
v_cvt_pk_bf16_f32 v146, v132, v133
v_cvt_pk_bf16_f32 v147, v134, v135
v_exp_f32 v136, v136
v_exp_f32 v137, v137
s_waitcnt lgkmcnt(3)
v_mfma_f32_32x32x16_bf16 v[16:31], v[160:163], v[144:147], v[16:31]
v_exp_f32 v138, v138
v_exp_f32 v139, v139
v_exp_f32 v140, v140
v_mfma_f32_16x16x32_bf16 v[32:35], v[212:215], v[144:147], v[32:35]
s_sub_u32 s68, s68, 1
s_cmp_eq_u32 s68, 0
v_exp_f32 v141, v141
v_exp_f32 v142, v142
v_exp_f32 v143, v143
v_cvt_pk_bf16_f32 v148, v136, v137
v_cvt_pk_bf16_f32 v149, v138, v139
v_cvt_pk_bf16_f32 v150, v140, v141
v_cvt_pk_bf16_f32 v151, v142, v143
s_cbranch_scc0 at_103
s_cmp_lt_u32 s59, 2
s_cbranch_scc1 at_106
.p2align 3
v_exp_f32 v112, v112
v_exp_f32 v113, v113
s_waitcnt lgkmcnt(2)
v_mfma_f32_32x32x16_bf16 v[16:31], v[164:167], v[148:151], v[16:31]
v_exp_f32 v114, v114
v_exp_f32 v115, v115
v_exp_f32 v116, v116
v_mfma_f32_16x16x32_bf16 v[32:35], v[212:215], v[148:151], v[32:35]
v_exp_f32 v117, v117
s_waitcnt lgkmcnt(1)
v_mfma_f32_32x32x16_bf16 v[128:143], v[152:155], v[96:99], v[216:231]
v_exp_f32 v118, v118
v_exp_f32 v119, v119
v_cvt_pk_bf16_f32 v144, v112, v113
v_cvt_pk_bf16_f32 v145, v114, v115
s_waitcnt lgkmcnt(0)
v_mfma_f32_32x32x16_bf16 v[128:143], v[156:159], v[104:107], v[128:143]
v_cvt_pk_bf16_f32 v146, v116, v117
v_cvt_pk_bf16_f32 v147, v118, v119
v_exp_f32 v120, v120
v_exp_f32 v121, v121
v_mfma_f32_32x32x16_bf16 v[192:207], v[160:163], v[144:147], v[192:207]
ds_read_b128 v[160:163], v8 offset:2048
v_exp_f32 v122, v122
v_exp_f32 v123, v123
v_exp_f32 v124, v124
v_mfma_f32_16x16x32_bf16 v[208:211], v[212:215], v[144:147], v[208:211]
v_exp_f32 v125, v125
v_exp_f32 v126, v126
v_exp_f32 v127, v127
v_cvt_pk_bf16_f32 v148, v120, v121
v_cvt_pk_bf16_f32 v149, v122, v123
v_cvt_pk_bf16_f32 v150, v124, v125
v_cvt_pk_bf16_f32 v151, v126, v127
v_exp_f32 v128, v128
v_exp_f32 v129, v129
v_mfma_f32_32x32x16_bf16 v[192:207], v[164:167], v[148:151], v[192:207]
ds_read_b128 v[164:167], v8 offset:3072
v_exp_f32 v130, v130
v_exp_f32 v131, v131
v_exp_f32 v132, v132
v_mfma_f32_16x16x32_bf16 v[208:211], v[212:215], v[148:151], v[208:211]
v_exp_f32 v133, v133
v_mfma_f32_32x32x16_bf16 v[112:127], v[152:155], v[80:83], 0
v_exp_f32 v134, v134
v_exp_f32 v135, v135
v_cvt_pk_bf16_f32 v144, v128, v129
v_cvt_pk_bf16_f32 v145, v130, v131
v_mfma_f32_32x32x16_bf16 v[112:127], v[156:159], v[88:91], v[112:127]
v_subrev_u32 v8, 8192, v8
ds_read_b128 v[152:155], v8 offset:0
ds_read_b128 v[156:159], v8 offset:1024
v_cvt_pk_bf16_f32 v146, v132, v133
v_cvt_pk_bf16_f32 v147, v134, v135
v_exp_f32 v136, v136
v_exp_f32 v137, v137
s_waitcnt lgkmcnt(3)
v_mfma_f32_32x32x16_bf16 v[16:31], v[160:163], v[144:147], v[16:31]
v_exp_f32 v138, v138
v_exp_f32 v139, v139
v_exp_f32 v140, v140
v_mfma_f32_16x16x32_bf16 v[32:35], v[212:215], v[144:147], v[32:35]
s_cmp_eq_u32 s65, 1
v_exp_f32 v141, v141
v_exp_f32 v142, v142
v_exp_f32 v143, v143
v_cvt_pk_bf16_f32 v148, v136, v137
v_cvt_pk_bf16_f32 v149, v138, v139
v_cvt_pk_bf16_f32 v150, v140, v141
v_cvt_pk_bf16_f32 v151, v142, v143
s_cbranch_scc1 at_105
.p2align 3
v_exp_f32 v112, v112
v_exp_f32 v113, v113
s_waitcnt lgkmcnt(2)
v_mfma_f32_32x32x16_bf16 v[16:31], v[164:167], v[148:151], v[16:31]
v_exp_f32 v114, v114
v_exp_f32 v115, v115
v_exp_f32 v116, v116
v_mfma_f32_16x16x32_bf16 v[32:35], v[212:215], v[148:151], v[32:35]
v_exp_f32 v117, v117
s_waitcnt lgkmcnt(1)
v_mfma_f32_32x32x16_bf16 v[128:143], v[152:155], v[80:83], 0
v_exp_f32 v118, v118
v_exp_f32 v119, v119
v_cvt_pk_bf16_f32 v144, v112, v113
v_cvt_pk_bf16_f32 v145, v114, v115
s_waitcnt lgkmcnt(0)
v_mfma_f32_32x32x16_bf16 v[128:143], v[156:159], v[88:91], v[128:143]
v_subrev_u32 v8, 8192, v8
ds_read_b128 v[152:155], v8 offset:0
ds_read_b128 v[156:159], v8 offset:1024
v_cvt_pk_bf16_f32 v146, v116, v117
v_cvt_pk_bf16_f32 v147, v118, v119
v_exp_f32 v120, v120
v_exp_f32 v121, v121
v_mfma_f32_32x32x16_bf16 v[192:207], v[160:163], v[144:147], v[192:207]
ds_read_b128 v[160:163], v8 offset:10240
v_exp_f32 v122, v122
v_exp_f32 v123, v123
v_exp_f32 v124, v124
v_mfma_f32_16x16x32_bf16 v[208:211], v[212:215], v[144:147], v[208:211]
v_exp_f32 v125, v125
v_exp_f32 v126, v126
v_exp_f32 v127, v127
v_cvt_pk_bf16_f32 v148, v120, v121
v_cvt_pk_bf16_f32 v149, v122, v123
v_cvt_pk_bf16_f32 v150, v124, v125
v_cvt_pk_bf16_f32 v151, v126, v127
v_exp_f32 v128, v128
v_exp_f32 v129, v129
v_mfma_f32_32x32x16_bf16 v[192:207], v[164:167], v[148:151], v[192:207]
ds_read_b128 v[164:167], v8 offset:11264
v_exp_f32 v130, v130
v_exp_f32 v131, v131
v_exp_f32 v132, v132
v_mfma_f32_16x16x32_bf16 v[208:211], v[212:215], v[148:151], v[208:211]
v_exp_f32 v133, v133
s_waitcnt lgkmcnt(3)
v_mfma_f32_32x32x16_bf16 v[112:127], v[152:155], v[80:83], 0
v_exp_f32 v134, v134
v_exp_f32 v135, v135
v_cvt_pk_bf16_f32 v144, v128, v129
v_cvt_pk_bf16_f32 v145, v130, v131
s_waitcnt lgkmcnt(2)
v_mfma_f32_32x32x16_bf16 v[112:127], v[156:159], v[88:91], v[112:127]
v_subrev_u32 v8, 8192, v8
ds_read_b128 v[152:155], v8 offset:0
ds_read_b128 v[156:159], v8 offset:1024
v_cvt_pk_bf16_f32 v146, v132, v133
v_cvt_pk_bf16_f32 v147, v134, v135
v_exp_f32 v136, v136
v_exp_f32 v137, v137
s_waitcnt lgkmcnt(3)
v_mfma_f32_32x32x16_bf16 v[192:207], v[160:163], v[144:147], v[192:207]
ds_read_b128 v[160:163], v8 offset:10240
v_exp_f32 v138, v138
v_exp_f32 v139, v139
v_exp_f32 v140, v140
v_mfma_f32_16x16x32_bf16 v[208:211], v[212:215], v[144:147], v[208:211]
v_exp_f32 v141, v141
v_exp_f32 v142, v142
v_exp_f32 v143, v143
v_cvt_pk_bf16_f32 v148, v136, v137
v_cvt_pk_bf16_f32 v149, v138, v139
v_cvt_pk_bf16_f32 v150, v140, v141
v_cvt_pk_bf16_f32 v151, v142, v143
v_exp_f32 v112, v112
v_exp_f32 v113, v113
s_waitcnt lgkmcnt(3)
v_mfma_f32_32x32x16_bf16 v[192:207], v[164:167], v[148:151], v[192:207]
ds_read_b128 v[164:167], v8 offset:11264
v_exp_f32 v114, v114
v_exp_f32 v115, v115
v_exp_f32 v116, v116
v_mfma_f32_16x16x32_bf16 v[208:211], v[212:215], v[148:151], v[208:211]
v_exp_f32 v117, v117
s_waitcnt lgkmcnt(3)
v_mfma_f32_32x32x16_bf16 v[128:143], v[152:155], v[80:83], v[216:231]
v_exp_f32 v118, v118
v_exp_f32 v119, v119
v_cvt_pk_bf16_f32 v144, v112, v113
v_cvt_pk_bf16_f32 v145, v114, v115
s_waitcnt lgkmcnt(2)
v_mfma_f32_32x32x16_bf16 v[128:143], v[156:159], v[88:91], v[128:143]
v_cvt_pk_bf16_f32 v146, v116, v117
v_cvt_pk_bf16_f32 v147, v118, v119
v_exp_f32 v120, v120
v_exp_f32 v121, v121
s_waitcnt lgkmcnt(1)
v_mfma_f32_32x32x16_bf16 v[192:207], v[160:163], v[144:147], v[192:207]
ds_read_b128 v[160:163], v8 offset:2048
v_exp_f32 v122, v122
v_exp_f32 v123, v123
v_exp_f32 v124, v124
v_mfma_f32_16x16x32_bf16 v[208:211], v[212:215], v[144:147], v[208:211]
v_exp_f32 v125, v125
v_exp_f32 v126, v126
v_exp_f32 v127, v127
v_cvt_pk_bf16_f32 v148, v120, v121
v_cvt_pk_bf16_f32 v149, v122, v123
v_cvt_pk_bf16_f32 v150, v124, v125
v_cvt_pk_bf16_f32 v151, v126, v127
s_branch at_107
.p2align 3
at_106:
v_add_u32 v5, s34, 20
s_mov_b64 exec, 1
ds_write_b32 v3, v5
s_mov_b64 exec, -1
v_exp_f32 v112, v112
v_exp_f32 v113, v113
s_waitcnt lgkmcnt(3)
v_mfma_f32_32x32x16_bf16 v[16:31], v[164:167], v[148:151], v[16:31]
v_exp_f32 v114, v114
v_exp_f32 v115, v115
v_exp_f32 v116, v116
v_mfma_f32_16x16x32_bf16 v[32:35], v[212:215], v[148:151], v[32:35]
v_exp_f32 v117, v117
v_exp_f32 v118, v118
v_exp_f32 v119, v119
v_cvt_pk_bf16_f32 v144, v112, v113
v_cvt_pk_bf16_f32 v145, v114, v115
v_cvt_pk_bf16_f32 v146, v116, v117
v_cvt_pk_bf16_f32 v147, v118, v119
v_exp_f32 v120, v120
v_exp_f32 v121, v121
v_mfma_f32_32x32x16_bf16 v[192:207], v[160:163], v[144:147], v[192:207]
v_exp_f32 v122, v122
v_exp_f32 v123, v123
v_exp_f32 v124, v124
v_mfma_f32_16x16x32_bf16 v[208:211], v[212:215], v[144:147], v[208:211]
v_exp_f32 v125, v125
v_exp_f32 v126, v126
v_exp_f32 v127, v127
v_cvt_pk_bf16_f32 v148, v120, v121
v_cvt_pk_bf16_f32 v149, v122, v123
v_cvt_pk_bf16_f32 v150, v124, v125
v_cvt_pk_bf16_f32 v151, v126, v127
s_branch at_108
.p2align 3
at_105:
v_exp_f32 v112, v112
v_exp_f32 v113, v113
s_waitcnt lgkmcnt(2)
v_mfma_f32_32x32x16_bf16 v[16:31], v[164:167], v[148:151], v[16:31]
v_exp_f32 v114, v114
v_exp_f32 v115, v115
v_exp_f32 v116, v116
v_mfma_f32_16x16x32_bf16 v[32:35], v[212:215], v[148:151], v[32:35]
v_exp_f32 v117, v117
s_waitcnt lgkmcnt(1)
v_mfma_f32_32x32x16_bf16 v[128:143], v[152:155], v[80:83], v[216:231]
v_exp_f32 v118, v118
v_exp_f32 v119, v119
v_cvt_pk_bf16_f32 v144, v112, v113
v_cvt_pk_bf16_f32 v145, v114, v115
s_waitcnt lgkmcnt(0)
v_mfma_f32_32x32x16_bf16 v[128:143], v[156:159], v[88:91], v[128:143]
v_cvt_pk_bf16_f32 v146, v116, v117
v_cvt_pk_bf16_f32 v147, v118, v119
v_exp_f32 v120, v120
v_exp_f32 v121, v121
v_mfma_f32_32x32x16_bf16 v[192:207], v[160:163], v[144:147], v[192:207]
ds_read_b128 v[160:163], v8 offset:2048
v_exp_f32 v122, v122
v_exp_f32 v123, v123
v_exp_f32 v124, v124
v_mfma_f32_16x16x32_bf16 v[208:211], v[212:215], v[144:147], v[208:211]
v_exp_f32 v125, v125
v_exp_f32 v126, v126
v_exp_f32 v127, v127
v_cvt_pk_bf16_f32 v148, v120, v121
v_cvt_pk_bf16_f32 v149, v122, v123
v_cvt_pk_bf16_f32 v150, v124, v125
v_cvt_pk_bf16_f32 v151, v126, v127
.p2align 3
at_107:
v_exp_f32 v128, v128
v_exp_f32 v129, v129
s_waitcnt lgkmcnt(1)
v_mfma_f32_32x32x16_bf16 v[192:207], v[164:167], v[148:151], v[192:207]
ds_read_b128 v[164:167], v8 offset:3072
v_exp_f32 v130, v130
v_exp_f32 v131, v131
v_exp_f32 v132, v132
v_mfma_f32_16x16x32_bf16 v[208:211], v[212:215], v[148:151], v[208:211]
v_exp_f32 v133, v133
v_exp_f32 v134, v134
v_exp_f32 v135, v135
v_cvt_pk_bf16_f32 v144, v128, v129
v_cvt_pk_bf16_f32 v145, v130, v131
v_add_u32 v5, s34, 20
s_mov_b64 exec, 1
ds_write_b32 v3, v5
s_mov_b64 exec, -1
v_cvt_pk_bf16_f32 v146, v132, v133
v_cvt_pk_bf16_f32 v147, v134, v135
v_exp_f32 v136, v136
v_exp_f32 v137, v137
s_waitcnt lgkmcnt(2)
v_mfma_f32_32x32x16_bf16 v[192:207], v[160:163], v[144:147], v[192:207]
v_exp_f32 v138, v138
v_exp_f32 v139, v139
v_exp_f32 v140, v140
v_mfma_f32_16x16x32_bf16 v[208:211], v[212:215], v[144:147], v[208:211]
v_exp_f32 v141, v141
v_exp_f32 v142, v142
v_exp_f32 v143, v143
v_cvt_pk_bf16_f32 v148, v136, v137
v_cvt_pk_bf16_f32 v149, v138, v139
v_cvt_pk_bf16_f32 v150, v140, v141
v_cvt_pk_bf16_f32 v151, v142, v143
at_108:
s_lshl_b32 s66, s59, 18
s_lshl_b32 s67, s63, 22
v_mfma_f32_16x16x32_bf16 v[208:211], v[212:215], v[148:151], v[208:211]
s_add_u32 s66, s66, s67
s_lshl1_add_u32 s67, s60, s64
s_waitcnt lgkmcnt(1)
v_mfma_f32_32x32x16_bf16 v[192:207], v[164:167], v[148:151], v[192:207]
s_lshl_b32 s67, s67, 11
s_add_u32 s66, s66, s67
s_lshl_b32 s68, s65, 16
s_add_u32 s67, s66, 18022400
s_sub_u32 s67, s67, s68
s_add_u32 s66, s66, s68
s_add_u32 s66, s66, 17825792
v_lshlrev_b32 v9, 4, v0
v_subrev_u32 v10, 0x2f800000, v32
v_subrev_u32 v11, 0x2f800000, v208
v_max_u32 v10, v10, v11
v_cmp_lt_u32 vcc, 0x20000000, v10
s_cbranch_vccnz slow_113
sback_114:
s_nop 1
v_rcp_f32 v12, v32
s_nop 1
v_pk_mul_f32 v[16:17], v[16:17], v[12:13] op_sel:[0,0] op_sel_hi:[1,0]
v_pk_mul_f32 v[18:19], v[18:19], v[12:13] op_sel:[0,0] op_sel_hi:[1,0]
v_pk_mul_f32 v[20:21], v[20:21], v[12:13] op_sel:[0,0] op_sel_hi:[1,0]
v_pk_mul_f32 v[22:23], v[22:23], v[12:13] op_sel:[0,0] op_sel_hi:[1,0]
v_pk_mul_f32 v[24:25], v[24:25], v[12:13] op_sel:[0,0] op_sel_hi:[1,0]
v_pk_mul_f32 v[26:27], v[26:27], v[12:13] op_sel:[0,0] op_sel_hi:[1,0]
v_pk_mul_f32 v[28:29], v[28:29], v[12:13] op_sel:[0,0] op_sel_hi:[1,0]
v_pk_mul_f32 v[30:31], v[30:31], v[12:13] op_sel:[0,0] op_sel_hi:[1,0]
v_cvt_pk_bf16_f32 v16, v16, v17
v_cvt_pk_bf16_f32 v17, v18, v19
v_cvt_pk_bf16_f32 v18, v20, v21
v_cvt_pk_bf16_f32 v19, v22, v23
v_cvt_pk_bf16_f32 v20, v24, v25
v_cvt_pk_bf16_f32 v21, v26, v27
v_cvt_pk_bf16_f32 v22, v28, v29
v_cvt_pk_bf16_f32 v23, v30, v31
buffer_store_dwordx4 v[16:19], v9, s[20:23], s67 offen offset:0 sc1
buffer_store_dwordx4 v[20:23], v9, s[20:23], s67 offen offset:1024 sc1
v_rcp_f32 v12, v208
s_nop 0
v_pk_mul_f32 v[192:193], v[192:193], v[12:13] op_sel:[0,0] op_sel_hi:[1,0]
v_pk_mul_f32 v[194:195], v[194:195], v[12:13] op_sel:[0,0] op_sel_hi:[1,0]
v_pk_mul_f32 v[196:197], v[196:197], v[12:13] op_sel:[0,0] op_sel_hi:[1,0]
v_pk_mul_f32 v[198:199], v[198:199], v[12:13] op_sel:[0,0] op_sel_hi:[1,0]
v_pk_mul_f32 v[200:201], v[200:201], v[12:13] op_sel:[0,0] op_sel_hi:[1,0]
v_pk_mul_f32 v[202:203], v[202:203], v[12:13] op_sel:[0,0] op_sel_hi:[1,0]
v_pk_mul_f32 v[204:205], v[204:205], v[12:13] op_sel:[0,0] op_sel_hi:[1,0]
v_pk_mul_f32 v[206:207], v[206:207], v[12:13] op_sel:[0,0] op_sel_hi:[1,0]
v_cvt_pk_bf16_f32 v192, v192, v193
v_cvt_pk_bf16_f32 v193, v194, v195
v_cvt_pk_bf16_f32 v194, v196, v197
v_cvt_pk_bf16_f32 v195, v198, v199
v_cvt_pk_bf16_f32 v196, v200, v201
v_cvt_pk_bf16_f32 v197, v202, v203
v_cvt_pk_bf16_f32 v198, v204, v205
v_cvt_pk_bf16_f32 v199, v206, v207
buffer_store_dwordx4 v[192:195], v9, s[20:23], s66 offen offset:0 sc1
buffer_store_dwordx4 v[196:199], v9, s[20:23], s66 offen offset:1024 sc1
v_bfe_u32 v48, v0, 2, 3
v_lshrrev_b32 v49, 5, v0
v_lshl_add_u32 v48, v49, 4, v48
v_lshlrev_b32 v48, 7, v48
v_bfe_u32 v49, v0, 3, 2
v_lshl_add_u32 v48, v49, 5, v48
v_and_b32 v49, 3, v0
v_lshl_add_u32 v48, v49, 3, v48
v_add_u32 v8, 32768, v48
v_xor_b32 v9, 32, v8
v_xor_b32 v10, 64, v8
v_xor_b32 v11, 96, v8
v_add_u32 v12, 0x10000, v8
v_add_u32 v13, 0x10000, v9
v_add_u32 v14, 0x10000, v10
v_add_u32 v15, 0x10000, v11
v_and_b32 v48, 15, v0
v_lshrrev_b32 v49, 4, v0
s_lshl2_add_u32 s66, s61, s58
s_lshl_b32 s67, s66, 16
s_lshl_b32 s68, s63, 22
s_add_u32 s67, s67, s68
s_add_u32 s67, s67, 17825792
v_lshl_add_u32 v6, v48, 4, s67
v_lshl_add_u32 v6, v49, 9, v6
s_add_u32 s70, s72, 327680
s_mov_b64 exec, 1
s_waitcnt vmcnt(0)
buffer_store_dword v212, v3, s[24:27], s70 offen sc1
s_mov_b64 exec, -1
v_add_u32 v5, s34, 21
s_mov_b64 exec, 1
ds_write_b32 v3, v5
s_mov_b64 exec, -1
s_cmp_eq_u32 s63, 0
s_cbranch_scc0 mo_115
v_permlane16_swap_b32 v240, v242
v_permlane16_swap_b32 v241, v243
v_permlane16_swap_b32 v244, v246
v_permlane16_swap_b32 v245, v247
v_permlane16_swap_b32 v248, v250
v_permlane16_swap_b32 v249, v251
v_permlane16_swap_b32 v252, v254
v_permlane16_swap_b32 v253, v255
mo_116:
v_lshlrev_b32 v16, 16, v240
v_and_b32 v17, 0xffff0000, v240
v_lshlrev_b32 v18, 16, v241
v_and_b32 v19, 0xffff0000, v241
v_lshlrev_b32 v20, 16, v242
v_and_b32 v21, 0xffff0000, v242
v_lshlrev_b32 v22, 16, v243
v_and_b32 v23, 0xffff0000, v243
v_lshlrev_b32 v24, 16, v244
v_and_b32 v25, 0xffff0000, v244
v_lshlrev_b32 v26, 16, v245
v_and_b32 v27, 0xffff0000, v245
v_lshlrev_b32 v28, 16, v246
v_and_b32 v29, 0xffff0000, v246
v_lshlrev_b32 v30, 16, v247
v_and_b32 v31, 0xffff0000, v247
v_lshlrev_b32 v32, 16, v248
v_and_b32 v33, 0xffff0000, v248
v_lshlrev_b32 v34, 16, v249
v_and_b32 v35, 0xffff0000, v249
v_lshlrev_b32 v36, 16, v250
v_and_b32 v37, 0xffff0000, v250
v_lshlrev_b32 v38, 16, v251
v_and_b32 v39, 0xffff0000, v251
v_lshlrev_b32 v40, 16, v252
v_and_b32 v41, 0xffff0000, v252
v_lshlrev_b32 v42, 16, v253
v_and_b32 v43, 0xffff0000, v253
v_lshlrev_b32 v44, 16, v254
v_and_b32 v45, 0xffff0000, v254
v_lshlrev_b32 v46, 16, v255
v_and_b32 v47, 0xffff0000, v255
s_add_u32 s66, s61, s62
s_and_b32 s66, s66, 15
s_lshl_b32 s66, s66, 12
s_add_u32 s35, s34, 18
lw_117:
ds_read_b32 v5, v2 offset:16
s_waitcnt lgkmcnt(0)
v_cmp_gt_i32 vcc, s35, v5
s_cbranch_vccz lwd_118
s_sub_u32 s32, s32, 1
s_cmp_gt_i32 s32, 0
s_cbranch_scc1 lw_117
lwd_118:
buffer_load_dwordx4 v[80:83], v6, s[20:23], s66 offen offset:0 sc1
buffer_load_dwordx4 v[88:91], v6, s[20:23], s66 offen offset:2048 sc1
buffer_load_dwordx4 v[84:87], v6, s[20:23], s66 offen offset:256 sc1
buffer_load_dwordx4 v[92:95], v6, s[20:23], s66 offen offset:2304 sc1
s_add_u32 s66, s66, 4096
s_and_b32 s66, s66, 0xffff
ds_read_b64_tr_b16 v[48:49], v8 offset:0
ds_read_b64_tr_b16 v[50:51], v8 offset:1024
ds_read_b64_tr_b16 v[52:53], v8 offset:4096
ds_read_b64_tr_b16 v[54:55], v8 offset:5120
buffer_load_dwordx4 v[96:99], v6, s[20:23], s66 offen offset:0 sc1
buffer_load_dwordx4 v[104:107], v6, s[20:23], s66 offen offset:2048 sc1
buffer_load_dwordx4 v[100:103], v6, s[20:23], s66 offen offset:256 sc1
buffer_load_dwordx4 v[108:111], v6, s[20:23], s66 offen offset:2304 sc1
s_add_u32 s66, s66, 4096
s_and_b32 s66, s66, 0xffff
ds_read_b64_tr_b16 v[56:57], v9 offset:0
ds_read_b64_tr_b16 v[58:59], v9 offset:1024
ds_read_b64_tr_b16 v[60:61], v9 offset:4096
ds_read_b64_tr_b16 v[62:63], v9 offset:5120
buffer_load_dwordx4 v[112:115], v6, s[20:23], s66 offen offset:0 sc1
buffer_load_dwordx4 v[120:123], v6, s[20:23], s66 offen offset:2048 sc1
buffer_load_dwordx4 v[116:119], v6, s[20:23], s66 offen offset:256 sc1
buffer_load_dwordx4 v[124:127], v6, s[20:23], s66 offen offset:2304 sc1
s_add_u32 s66, s66, 4096
s_and_b32 s66, s66, 0xffff
ds_read_b64_tr_b16 v[64:65], v10 offset:0
ds_read_b64_tr_b16 v[66:67], v10 offset:1024
ds_read_b64_tr_b16 v[68:69], v10 offset:4096
ds_read_b64_tr_b16 v[70:71], v10 offset:5120
buffer_load_dwordx4 v[128:131], v6, s[20:23], s66 offen offset:0 sc1
buffer_load_dwordx4 v[136:139], v6, s[20:23], s66 offen offset:2048 sc1
buffer_load_dwordx4 v[132:135], v6, s[20:23], s66 offen offset:256 sc1
buffer_load_dwordx4 v[140:143], v6, s[20:23], s66 offen offset:2304 sc1
s_add_u32 s66, s66, 4096
s_and_b32 s66, s66, 0xffff
buffer_load_dwordx4 v[144:147], v6, s[20:23], s66 offen offset:0 sc1
buffer_load_dwordx4 v[152:155], v6, s[20:23], s66 offen offset:2048 sc1
buffer_load_dwordx4 v[148:151], v6, s[20:23], s66 offen offset:256 sc1
buffer_load_dwordx4 v[156:159], v6, s[20:23], s66 offen offset:2304 sc1
s_add_u32 s66, s66, 4096
s_and_b32 s66, s66, 0xffff
buffer_load_dwordx4 v[160:163], v6, s[20:23], s66 offen offset:0 sc1
buffer_load_dwordx4 v[168:171], v6, s[20:23], s66 offen offset:2048 sc1
buffer_load_dwordx4 v[164:167], v6, s[20:23], s66 offen offset:256 sc1
buffer_load_dwordx4 v[172:175], v6, s[20:23], s66 offen offset:2304 sc1
s_add_u32 s66, s66, 4096
s_and_b32 s66, s66, 0xffff
buffer_load_dwordx4 v[176:179], v6, s[20:23], s66 offen offset:0 sc1
buffer_load_dwordx4 v[184:187], v6, s[20:23], s66 offen offset:2048 sc1
buffer_load_dwordx4 v[180:183], v6, s[20:23], s66 offen offset:256 sc1
buffer_load_dwordx4 v[188:191], v6, s[20:23], s66 offen offset:2304 sc1
s_add_u32 s66, s66, 4096
s_and_b32 s66, s66, 0xffff
buffer_load_dwordx4 v[192:195], v6, s[20:23], s66 offen offset:0 sc1
buffer_load_dwordx4 v[200:203], v6, s[20:23], s66 offen offset:2048 sc1
buffer_load_dwordx4 v[196:199], v6, s[20:23], s66 offen offset:256 sc1
buffer_load_dwordx4 v[204:207], v6, s[20:23], s66 offen offset:2304 sc1
s_add_u32 s66, s66, 4096
s_and_b32 s66, s66, 0xffff
.p2align 3
s_waitcnt vmcnt(31) lgkmcnt(10)
v_mfma_f32_16x16x32_bf16 v[16:19], v[48:51], v[80:83], v[16:19]
ds_read_b64_tr_b16 v[72:73], v11 offset:0
s_waitcnt vmcnt(30) lgkmcnt(9)
v_mfma_f32_16x16x32_bf16 v[16:19], v[52:55], v[88:91], v[16:19]
ds_read_b64_tr_b16 v[74:75], v11 offset:1024
s_waitcnt vmcnt(29)
v_mfma_f32_16x16x32_bf16 v[32:35], v[48:51], v[84:87], v[32:35]
ds_read_b64_tr_b16 v[76:77], v11 offset:4096
s_waitcnt vmcnt(28)
v_mfma_f32_16x16x32_bf16 v[32:35], v[52:55], v[92:95], v[32:35]
ds_read_b64_tr_b16 v[78:79], v11 offset:5120
s_waitcnt lgkmcnt(10)
v_mfma_f32_16x16x32_bf16 v[20:23], v[56:59], v[80:83], v[20:23]
ds_read_b64_tr_b16 v[48:49], v8 offset:8192
s_waitcnt lgkmcnt(9)
v_mfma_f32_16x16x32_bf16 v[20:23], v[60:63], v[88:91], v[20:23]
ds_read_b64_tr_b16 v[50:51], v8 offset:9216
v_mfma_f32_16x16x32_bf16 v[36:39], v[56:59], v[84:87], v[36:39]
ds_read_b64_tr_b16 v[52:53], v8 offset:12288
v_mfma_f32_16x16x32_bf16 v[36:39], v[60:63], v[92:95], v[36:39]
ds_read_b64_tr_b16 v[54:55], v8 offset:13312
s_waitcnt lgkmcnt(10)
v_mfma_f32_16x16x32_bf16 v[24:27], v[64:67], v[80:83], v[24:27]
ds_read_b64_tr_b16 v[56:57], v9 offset:8192
s_waitcnt lgkmcnt(9)
v_mfma_f32_16x16x32_bf16 v[24:27], v[68:71], v[88:91], v[24:27]
ds_read_b64_tr_b16 v[58:59], v9 offset:9216
v_mfma_f32_16x16x32_bf16 v[40:43], v[64:67], v[84:87], v[40:43]
ds_read_b64_tr_b16 v[60:61], v9 offset:12288
v_mfma_f32_16x16x32_bf16 v[40:43], v[68:71], v[92:95], v[40:43]
ds_read_b64_tr_b16 v[62:63], v9 offset:13312
s_waitcnt lgkmcnt(10)
v_mfma_f32_16x16x32_bf16 v[28:31], v[72:75], v[80:83], v[28:31]
ds_read_b64_tr_b16 v[64:65], v10 offset:8192
s_waitcnt lgkmcnt(9)
v_mfma_f32_16x16x32_bf16 v[28:31], v[76:79], v[88:91], v[28:31]
ds_read_b64_tr_b16 v[66:67], v10 offset:9216
v_mfma_f32_16x16x32_bf16 v[44:47], v[72:75], v[84:87], v[44:47]
ds_read_b64_tr_b16 v[68:69], v10 offset:12288
v_mfma_f32_16x16x32_bf16 v[44:47], v[76:79], v[92:95], v[44:47]
ds_read_b64_tr_b16 v[70:71], v10 offset:13312
s_waitcnt vmcnt(27) lgkmcnt(10)
v_mfma_f32_16x16x32_bf16 v[16:19], v[48:51], v[96:99], v[16:19]
ds_read_b64_tr_b16 v[72:73], v11 offset:8192
buffer_load_dwordx4 v[80:83], v6, s[20:23], s66 offen offset:0 sc1
s_waitcnt vmcnt(27) lgkmcnt(9)
v_mfma_f32_16x16x32_bf16 v[16:19], v[52:55], v[104:107], v[16:19]
ds_read_b64_tr_b16 v[74:75], v11 offset:9216
buffer_load_dwordx4 v[88:91], v6, s[20:23], s66 offen offset:2048 sc1
s_waitcnt vmcnt(27)
v_mfma_f32_16x16x32_bf16 v[32:35], v[48:51], v[100:103], v[32:35]
ds_read_b64_tr_b16 v[76:77], v11 offset:12288
buffer_load_dwordx4 v[84:87], v6, s[20:23], s66 offen offset:256 sc1
s_waitcnt vmcnt(27)
v_mfma_f32_16x16x32_bf16 v[32:35], v[52:55], v[108:111], v[32:35]
ds_read_b64_tr_b16 v[78:79], v11 offset:13312
buffer_load_dwordx4 v[92:95], v6, s[20:23], s66 offen offset:2304 sc1
s_waitcnt lgkmcnt(10)
v_mfma_f32_16x16x32_bf16 v[20:23], v[56:59], v[96:99], v[20:23]
ds_read_b64_tr_b16 v[48:49], v8 offset:16384
s_add_u32 s66, s66, 4096
s_and_b32 s66, s66, 0xffff
s_waitcnt lgkmcnt(9)
v_mfma_f32_16x16x32_bf16 v[20:23], v[60:63], v[104:107], v[20:23]
ds_read_b64_tr_b16 v[50:51], v8 offset:17408
v_mfma_f32_16x16x32_bf16 v[36:39], v[56:59], v[100:103], v[36:39]
ds_read_b64_tr_b16 v[52:53], v8 offset:20480
v_mfma_f32_16x16x32_bf16 v[36:39], v[60:63], v[108:111], v[36:39]
ds_read_b64_tr_b16 v[54:55], v8 offset:21504
s_waitcnt lgkmcnt(10)
v_mfma_f32_16x16x32_bf16 v[24:27], v[64:67], v[96:99], v[24:27]
ds_read_b64_tr_b16 v[56:57], v9 offset:16384
s_waitcnt lgkmcnt(9)
v_mfma_f32_16x16x32_bf16 v[24:27], v[68:71], v[104:107], v[24:27]
ds_read_b64_tr_b16 v[58:59], v9 offset:17408
v_mfma_f32_16x16x32_bf16 v[40:43], v[64:67], v[100:103], v[40:43]
ds_read_b64_tr_b16 v[60:61], v9 offset:20480
v_mfma_f32_16x16x32_bf16 v[40:43], v[68:71], v[108:111], v[40:43]
ds_read_b64_tr_b16 v[62:63], v9 offset:21504
s_waitcnt lgkmcnt(10)
v_mfma_f32_16x16x32_bf16 v[28:31], v[72:75], v[96:99], v[28:31]
ds_read_b64_tr_b16 v[64:65], v10 offset:16384
s_waitcnt lgkmcnt(9)
v_mfma_f32_16x16x32_bf16 v[28:31], v[76:79], v[104:107], v[28:31]
ds_read_b64_tr_b16 v[66:67], v10 offset:17408
v_mfma_f32_16x16x32_bf16 v[44:47], v[72:75], v[100:103], v[44:47]
ds_read_b64_tr_b16 v[68:69], v10 offset:20480
v_mfma_f32_16x16x32_bf16 v[44:47], v[76:79], v[108:111], v[44:47]
ds_read_b64_tr_b16 v[70:71], v10 offset:21504
s_waitcnt vmcnt(27) lgkmcnt(10)
v_mfma_f32_16x16x32_bf16 v[16:19], v[48:51], v[112:115], v[16:19]
ds_read_b64_tr_b16 v[72:73], v11 offset:16384
buffer_load_dwordx4 v[96:99], v6, s[20:23], s66 offen offset:0 sc1
s_waitcnt vmcnt(27) lgkmcnt(9)
v_mfma_f32_16x16x32_bf16 v[16:19], v[52:55], v[120:123], v[16:19]
ds_read_b64_tr_b16 v[74:75], v11 offset:17408
buffer_load_dwordx4 v[104:107], v6, s[20:23], s66 offen offset:2048 sc1
s_waitcnt vmcnt(27)
v_mfma_f32_16x16x32_bf16 v[32:35], v[48:51], v[116:119], v[32:35]
ds_read_b64_tr_b16 v[76:77], v11 offset:20480
buffer_load_dwordx4 v[100:103], v6, s[20:23], s66 offen offset:256 sc1
s_waitcnt vmcnt(27)
v_mfma_f32_16x16x32_bf16 v[32:35], v[52:55], v[124:127], v[32:35]
ds_read_b64_tr_b16 v[78:79], v11 offset:21504
buffer_load_dwordx4 v[108:111], v6, s[20:23], s66 offen offset:2304 sc1
s_waitcnt lgkmcnt(10)
v_mfma_f32_16x16x32_bf16 v[20:23], v[56:59], v[112:115], v[20:23]
ds_read_b64_tr_b16 v[48:49], v8 offset:24576
s_add_u32 s66, s66, 4096
s_and_b32 s66, s66, 0xffff
s_waitcnt lgkmcnt(9)
v_mfma_f32_16x16x32_bf16 v[20:23], v[60:63], v[120:123], v[20:23]
ds_read_b64_tr_b16 v[50:51], v8 offset:25600
v_mfma_f32_16x16x32_bf16 v[36:39], v[56:59], v[116:119], v[36:39]
ds_read_b64_tr_b16 v[52:53], v8 offset:28672
v_mfma_f32_16x16x32_bf16 v[36:39], v[60:63], v[124:127], v[36:39]
ds_read_b64_tr_b16 v[54:55], v8 offset:29696
s_waitcnt lgkmcnt(10)
v_mfma_f32_16x16x32_bf16 v[24:27], v[64:67], v[112:115], v[24:27]
ds_read_b64_tr_b16 v[56:57], v9 offset:24576
s_waitcnt lgkmcnt(9)
v_mfma_f32_16x16x32_bf16 v[24:27], v[68:71], v[120:123], v[24:27]
ds_read_b64_tr_b16 v[58:59], v9 offset:25600
v_mfma_f32_16x16x32_bf16 v[40:43], v[64:67], v[116:119], v[40:43]
ds_read_b64_tr_b16 v[60:61], v9 offset:28672
v_mfma_f32_16x16x32_bf16 v[40:43], v[68:71], v[124:127], v[40:43]
ds_read_b64_tr_b16 v[62:63], v9 offset:29696
s_waitcnt lgkmcnt(10)
v_mfma_f32_16x16x32_bf16 v[28:31], v[72:75], v[112:115], v[28:31]
ds_read_b64_tr_b16 v[64:65], v10 offset:24576
s_waitcnt lgkmcnt(9)
v_mfma_f32_16x16x32_bf16 v[28:31], v[76:79], v[120:123], v[28:31]
ds_read_b64_tr_b16 v[66:67], v10 offset:25600
v_mfma_f32_16x16x32_bf16 v[44:47], v[72:75], v[116:119], v[44:47]
ds_read_b64_tr_b16 v[68:69], v10 offset:28672
v_mfma_f32_16x16x32_bf16 v[44:47], v[76:79], v[124:127], v[44:47]
ds_read_b64_tr_b16 v[70:71], v10 offset:29696
s_waitcnt vmcnt(27) lgkmcnt(10)
v_mfma_f32_16x16x32_bf16 v[16:19], v[48:51], v[128:131], v[16:19]
ds_read_b64_tr_b16 v[72:73], v11 offset:24576
buffer_load_dwordx4 v[112:115], v6, s[20:23], s66 offen offset:0 sc1
s_waitcnt vmcnt(27) lgkmcnt(9)
v_mfma_f32_16x16x32_bf16 v[16:19], v[52:55], v[136:139], v[16:19]
ds_read_b64_tr_b16 v[74:75], v11 offset:25600
buffer_load_dwordx4 v[120:123], v6, s[20:23], s66 offen offset:2048 sc1
s_waitcnt vmcnt(27)
v_mfma_f32_16x16x32_bf16 v[32:35], v[48:51], v[132:135], v[32:35]
ds_read_b64_tr_b16 v[76:77], v11 offset:28672
buffer_load_dwordx4 v[116:119], v6, s[20:23], s66 offen offset:256 sc1
s_waitcnt vmcnt(27)
v_mfma_f32_16x16x32_bf16 v[32:35], v[52:55], v[140:143], v[32:35]
ds_read_b64_tr_b16 v[78:79], v11 offset:29696
buffer_load_dwordx4 v[124:127], v6, s[20:23], s66 offen offset:2304 sc1
s_waitcnt lgkmcnt(10)
v_mfma_f32_16x16x32_bf16 v[20:23], v[56:59], v[128:131], v[20:23]
ds_read_b64_tr_b16 v[48:49], v8 offset:32768
s_add_u32 s66, s66, 4096
s_and_b32 s66, s66, 0xffff
s_waitcnt lgkmcnt(9)
v_mfma_f32_16x16x32_bf16 v[20:23], v[60:63], v[136:139], v[20:23]
ds_read_b64_tr_b16 v[50:51], v8 offset:33792
v_mfma_f32_16x16x32_bf16 v[36:39], v[56:59], v[132:135], v[36:39]
ds_read_b64_tr_b16 v[52:53], v8 offset:36864
v_mfma_f32_16x16x32_bf16 v[36:39], v[60:63], v[140:143], v[36:39]
ds_read_b64_tr_b16 v[54:55], v8 offset:37888
s_waitcnt lgkmcnt(10)
v_mfma_f32_16x16x32_bf16 v[24:27], v[64:67], v[128:131], v[24:27]
ds_read_b64_tr_b16 v[56:57], v9 offset:32768
s_waitcnt lgkmcnt(9)
v_mfma_f32_16x16x32_bf16 v[24:27], v[68:71], v[136:139], v[24:27]
ds_read_b64_tr_b16 v[58:59], v9 offset:33792
v_mfma_f32_16x16x32_bf16 v[40:43], v[64:67], v[132:135], v[40:43]
ds_read_b64_tr_b16 v[60:61], v9 offset:36864
v_mfma_f32_16x16x32_bf16 v[40:43], v[68:71], v[140:143], v[40:43]
ds_read_b64_tr_b16 v[62:63], v9 offset:37888
s_waitcnt lgkmcnt(10)
v_mfma_f32_16x16x32_bf16 v[28:31], v[72:75], v[128:131], v[28:31]
ds_read_b64_tr_b16 v[64:65], v10 offset:32768
s_waitcnt lgkmcnt(9)
v_mfma_f32_16x16x32_bf16 v[28:31], v[76:79], v[136:139], v[28:31]
ds_read_b64_tr_b16 v[66:67], v10 offset:33792
v_mfma_f32_16x16x32_bf16 v[44:47], v[72:75], v[132:135], v[44:47]
ds_read_b64_tr_b16 v[68:69], v10 offset:36864
v_mfma_f32_16x16x32_bf16 v[44:47], v[76:79], v[140:143], v[44:47]
ds_read_b64_tr_b16 v[70:71], v10 offset:37888
s_waitcnt vmcnt(27) lgkmcnt(10)
v_mfma_f32_16x16x32_bf16 v[16:19], v[48:51], v[144:147], v[16:19]
ds_read_b64_tr_b16 v[72:73], v11 offset:32768
buffer_load_dwordx4 v[128:131], v6, s[20:23], s66 offen offset:0 sc1
s_waitcnt vmcnt(27) lgkmcnt(9)
v_mfma_f32_16x16x32_bf16 v[16:19], v[52:55], v[152:155], v[16:19]
ds_read_b64_tr_b16 v[74:75], v11 offset:33792
buffer_load_dwordx4 v[136:139], v6, s[20:23], s66 offen offset:2048 sc1
s_waitcnt vmcnt(27)
v_mfma_f32_16x16x32_bf16 v[32:35], v[48:51], v[148:151], v[32:35]
ds_read_b64_tr_b16 v[76:77], v11 offset:36864
buffer_load_dwordx4 v[132:135], v6, s[20:23], s66 offen offset:256 sc1
s_waitcnt vmcnt(27)
v_mfma_f32_16x16x32_bf16 v[32:35], v[52:55], v[156:159], v[32:35]
ds_read_b64_tr_b16 v[78:79], v11 offset:37888
buffer_load_dwordx4 v[140:143], v6, s[20:23], s66 offen offset:2304 sc1
s_waitcnt lgkmcnt(10)
v_mfma_f32_16x16x32_bf16 v[20:23], v[56:59], v[144:147], v[20:23]
ds_read_b64_tr_b16 v[48:49], v8 offset:40960
s_add_u32 s66, s66, 4096
s_and_b32 s66, s66, 0xffff
s_waitcnt lgkmcnt(9)
v_mfma_f32_16x16x32_bf16 v[20:23], v[60:63], v[152:155], v[20:23]
ds_read_b64_tr_b16 v[50:51], v8 offset:41984
v_mfma_f32_16x16x32_bf16 v[36:39], v[56:59], v[148:151], v[36:39]
ds_read_b64_tr_b16 v[52:53], v8 offset:45056
v_mfma_f32_16x16x32_bf16 v[36:39], v[60:63], v[156:159], v[36:39]
ds_read_b64_tr_b16 v[54:55], v8 offset:46080
s_waitcnt lgkmcnt(10)
v_mfma_f32_16x16x32_bf16 v[24:27], v[64:67], v[144:147], v[24:27]
ds_read_b64_tr_b16 v[56:57], v9 offset:40960
s_waitcnt lgkmcnt(9)
v_mfma_f32_16x16x32_bf16 v[24:27], v[68:71], v[152:155], v[24:27]
ds_read_b64_tr_b16 v[58:59], v9 offset:41984
v_mfma_f32_16x16x32_bf16 v[40:43], v[64:67], v[148:151], v[40:43]
ds_read_b64_tr_b16 v[60:61], v9 offset:45056
v_mfma_f32_16x16x32_bf16 v[40:43], v[68:71], v[156:159], v[40:43]
ds_read_b64_tr_b16 v[62:63], v9 offset:46080
s_waitcnt lgkmcnt(10)
v_mfma_f32_16x16x32_bf16 v[28:31], v[72:75], v[144:147], v[28:31]
ds_read_b64_tr_b16 v[64:65], v10 offset:40960
s_waitcnt lgkmcnt(9)
v_mfma_f32_16x16x32_bf16 v[28:31], v[76:79], v[152:155], v[28:31]
ds_read_b64_tr_b16 v[66:67], v10 offset:41984
v_mfma_f32_16x16x32_bf16 v[44:47], v[72:75], v[148:151], v[44:47]
ds_read_b64_tr_b16 v[68:69], v10 offset:45056
v_mfma_f32_16x16x32_bf16 v[44:47], v[76:79], v[156:159], v[44:47]
ds_read_b64_tr_b16 v[70:71], v10 offset:46080
s_waitcnt vmcnt(27) lgkmcnt(10)
v_mfma_f32_16x16x32_bf16 v[16:19], v[48:51], v[160:163], v[16:19]
ds_read_b64_tr_b16 v[72:73], v11 offset:40960
buffer_load_dwordx4 v[144:147], v6, s[20:23], s66 offen offset:0 sc1
s_waitcnt vmcnt(27) lgkmcnt(9)
v_mfma_f32_16x16x32_bf16 v[16:19], v[52:55], v[168:171], v[16:19]
ds_read_b64_tr_b16 v[74:75], v11 offset:41984
buffer_load_dwordx4 v[152:155], v6, s[20:23], s66 offen offset:2048 sc1
s_waitcnt vmcnt(27)
v_mfma_f32_16x16x32_bf16 v[32:35], v[48:51], v[164:167], v[32:35]
ds_read_b64_tr_b16 v[76:77], v11 offset:45056
buffer_load_dwordx4 v[148:151], v6, s[20:23], s66 offen offset:256 sc1
s_waitcnt vmcnt(27)
v_mfma_f32_16x16x32_bf16 v[32:35], v[52:55], v[172:175], v[32:35]
ds_read_b64_tr_b16 v[78:79], v11 offset:46080
buffer_load_dwordx4 v[156:159], v6, s[20:23], s66 offen offset:2304 sc1
s_waitcnt lgkmcnt(10)
v_mfma_f32_16x16x32_bf16 v[20:23], v[56:59], v[160:163], v[20:23]
ds_read_b64_tr_b16 v[48:49], v8 offset:49152
s_add_u32 s66, s66, 4096
s_and_b32 s66, s66, 0xffff
s_waitcnt lgkmcnt(9)
v_mfma_f32_16x16x32_bf16 v[20:23], v[60:63], v[168:171], v[20:23]
ds_read_b64_tr_b16 v[50:51], v8 offset:50176
v_mfma_f32_16x16x32_bf16 v[36:39], v[56:59], v[164:167], v[36:39]
ds_read_b64_tr_b16 v[52:53], v8 offset:53248
v_mfma_f32_16x16x32_bf16 v[36:39], v[60:63], v[172:175], v[36:39]
ds_read_b64_tr_b16 v[54:55], v8 offset:54272
s_waitcnt lgkmcnt(10)
v_mfma_f32_16x16x32_bf16 v[24:27], v[64:67], v[160:163], v[24:27]
ds_read_b64_tr_b16 v[56:57], v9 offset:49152
s_waitcnt lgkmcnt(9)
v_mfma_f32_16x16x32_bf16 v[24:27], v[68:71], v[168:171], v[24:27]
ds_read_b64_tr_b16 v[58:59], v9 offset:50176
v_mfma_f32_16x16x32_bf16 v[40:43], v[64:67], v[164:167], v[40:43]
ds_read_b64_tr_b16 v[60:61], v9 offset:53248
v_mfma_f32_16x16x32_bf16 v[40:43], v[68:71], v[172:175], v[40:43]
ds_read_b64_tr_b16 v[62:63], v9 offset:54272
s_waitcnt lgkmcnt(10)
v_mfma_f32_16x16x32_bf16 v[28:31], v[72:75], v[160:163], v[28:31]
ds_read_b64_tr_b16 v[64:65], v10 offset:49152
s_waitcnt lgkmcnt(9)
v_mfma_f32_16x16x32_bf16 v[28:31], v[76:79], v[168:171], v[28:31]
ds_read_b64_tr_b16 v[66:67], v10 offset:50176
v_mfma_f32_16x16x32_bf16 v[44:47], v[72:75], v[164:167], v[44:47]
ds_read_b64_tr_b16 v[68:69], v10 offset:53248
v_mfma_f32_16x16x32_bf16 v[44:47], v[76:79], v[172:175], v[44:47]
ds_read_b64_tr_b16 v[70:71], v10 offset:54272
s_waitcnt vmcnt(27) lgkmcnt(10)
v_mfma_f32_16x16x32_bf16 v[16:19], v[48:51], v[176:179], v[16:19]
ds_read_b64_tr_b16 v[72:73], v11 offset:49152
buffer_load_dwordx4 v[160:163], v6, s[20:23], s66 offen offset:0 sc1
s_waitcnt vmcnt(27) lgkmcnt(9)
v_mfma_f32_16x16x32_bf16 v[16:19], v[52:55], v[184:187], v[16:19]
ds_read_b64_tr_b16 v[74:75], v11 offset:50176
buffer_load_dwordx4 v[168:171], v6, s[20:23], s66 offen offset:2048 sc1
s_waitcnt vmcnt(27)
v_mfma_f32_16x16x32_bf16 v[32:35], v[48:51], v[180:183], v[32:35]
ds_read_b64_tr_b16 v[76:77], v11 offset:53248
buffer_load_dwordx4 v[164:167], v6, s[20:23], s66 offen offset:256 sc1
s_waitcnt vmcnt(27)
v_mfma_f32_16x16x32_bf16 v[32:35], v[52:55], v[188:191], v[32:35]
ds_read_b64_tr_b16 v[78:79], v11 offset:54272
buffer_load_dwordx4 v[172:175], v6, s[20:23], s66 offen offset:2304 sc1
s_waitcnt lgkmcnt(10)
v_mfma_f32_16x16x32_bf16 v[20:23], v[56:59], v[176:179], v[20:23]
ds_read_b64_tr_b16 v[48:49], v8 offset:57344
s_add_u32 s66, s66, 4096
s_and_b32 s66, s66, 0xffff
s_waitcnt lgkmcnt(9)
v_mfma_f32_16x16x32_bf16 v[20:23], v[60:63], v[184:187], v[20:23]
ds_read_b64_tr_b16 v[50:51], v8 offset:58368
v_mfma_f32_16x16x32_bf16 v[36:39], v[56:59], v[180:183], v[36:39]
ds_read_b64_tr_b16 v[52:53], v8 offset:61440
v_mfma_f32_16x16x32_bf16 v[36:39], v[60:63], v[188:191], v[36:39]
ds_read_b64_tr_b16 v[54:55], v8 offset:62464
s_waitcnt lgkmcnt(10)
v_mfma_f32_16x16x32_bf16 v[24:27], v[64:67], v[176:179], v[24:27]
ds_read_b64_tr_b16 v[56:57], v9 offset:57344
s_waitcnt lgkmcnt(9)
v_mfma_f32_16x16x32_bf16 v[24:27], v[68:71], v[184:187], v[24:27]
ds_read_b64_tr_b16 v[58:59], v9 offset:58368
v_mfma_f32_16x16x32_bf16 v[40:43], v[64:67], v[180:183], v[40:43]
ds_read_b64_tr_b16 v[60:61], v9 offset:61440
v_mfma_f32_16x16x32_bf16 v[40:43], v[68:71], v[188:191], v[40:43]
ds_read_b64_tr_b16 v[62:63], v9 offset:62464
s_waitcnt lgkmcnt(10)
v_mfma_f32_16x16x32_bf16 v[28:31], v[72:75], v[176:179], v[28:31]
ds_read_b64_tr_b16 v[64:65], v10 offset:57344
s_waitcnt lgkmcnt(9)
v_mfma_f32_16x16x32_bf16 v[28:31], v[76:79], v[184:187], v[28:31]
ds_read_b64_tr_b16 v[66:67], v10 offset:58368
v_mfma_f32_16x16x32_bf16 v[44:47], v[72:75], v[180:183], v[44:47]
ds_read_b64_tr_b16 v[68:69], v10 offset:61440
v_mfma_f32_16x16x32_bf16 v[44:47], v[76:79], v[188:191], v[44:47]
ds_read_b64_tr_b16 v[70:71], v10 offset:62464
s_waitcnt vmcnt(27) lgkmcnt(10)
v_mfma_f32_16x16x32_bf16 v[16:19], v[48:51], v[192:195], v[16:19]
ds_read_b64_tr_b16 v[72:73], v11 offset:57344
buffer_load_dwordx4 v[176:179], v6, s[20:23], s66 offen offset:0 sc1
s_waitcnt vmcnt(27) lgkmcnt(9)
v_mfma_f32_16x16x32_bf16 v[16:19], v[52:55], v[200:203], v[16:19]
ds_read_b64_tr_b16 v[74:75], v11 offset:58368
buffer_load_dwordx4 v[184:187], v6, s[20:23], s66 offen offset:2048 sc1
s_waitcnt vmcnt(27)
v_mfma_f32_16x16x32_bf16 v[32:35], v[48:51], v[196:199], v[32:35]
ds_read_b64_tr_b16 v[76:77], v11 offset:61440
buffer_load_dwordx4 v[180:183], v6, s[20:23], s66 offen offset:256 sc1
s_waitcnt vmcnt(27)
v_mfma_f32_16x16x32_bf16 v[32:35], v[52:55], v[204:207], v[32:35]
ds_read_b64_tr_b16 v[78:79], v11 offset:62464
buffer_load_dwordx4 v[188:191], v6, s[20:23], s66 offen offset:2304 sc1
s_waitcnt lgkmcnt(10)
v_mfma_f32_16x16x32_bf16 v[20:23], v[56:59], v[192:195], v[20:23]
ds_read_b64_tr_b16 v[48:49], v12 offset:0
s_add_u32 s66, s66, 4096
s_and_b32 s66, s66, 0xffff
s_waitcnt lgkmcnt(9)
v_mfma_f32_16x16x32_bf16 v[20:23], v[60:63], v[200:203], v[20:23]
ds_read_b64_tr_b16 v[50:51], v12 offset:1024
v_mfma_f32_16x16x32_bf16 v[36:39], v[56:59], v[196:199], v[36:39]
ds_read_b64_tr_b16 v[52:53], v12 offset:4096
v_mfma_f32_16x16x32_bf16 v[36:39], v[60:63], v[204:207], v[36:39]
ds_read_b64_tr_b16 v[54:55], v12 offset:5120
s_waitcnt lgkmcnt(10)
v_mfma_f32_16x16x32_bf16 v[24:27], v[64:67], v[192:195], v[24:27]
ds_read_b64_tr_b16 v[56:57], v13 offset:0
s_waitcnt lgkmcnt(9)
v_mfma_f32_16x16x32_bf16 v[24:27], v[68:71], v[200:203], v[24:27]
ds_read_b64_tr_b16 v[58:59], v13 offset:1024
v_mfma_f32_16x16x32_bf16 v[40:43], v[64:67], v[196:199], v[40:43]
ds_read_b64_tr_b16 v[60:61], v13 offset:4096
v_mfma_f32_16x16x32_bf16 v[40:43], v[68:71], v[204:207], v[40:43]
ds_read_b64_tr_b16 v[62:63], v13 offset:5120
s_waitcnt lgkmcnt(10)
v_mfma_f32_16x16x32_bf16 v[28:31], v[72:75], v[192:195], v[28:31]
ds_read_b64_tr_b16 v[64:65], v14 offset:0
s_waitcnt lgkmcnt(9)
v_mfma_f32_16x16x32_bf16 v[28:31], v[76:79], v[200:203], v[28:31]
ds_read_b64_tr_b16 v[66:67], v14 offset:1024
v_mfma_f32_16x16x32_bf16 v[44:47], v[72:75], v[196:199], v[44:47]
ds_read_b64_tr_b16 v[68:69], v14 offset:4096
v_mfma_f32_16x16x32_bf16 v[44:47], v[76:79], v[204:207], v[44:47]
ds_read_b64_tr_b16 v[70:71], v14 offset:5120
s_waitcnt vmcnt(27) lgkmcnt(10)
v_mfma_f32_16x16x32_bf16 v[16:19], v[48:51], v[80:83], v[16:19]
ds_read_b64_tr_b16 v[72:73], v15 offset:0
buffer_load_dwordx4 v[192:195], v6, s[20:23], s66 offen offset:0 sc1
s_waitcnt vmcnt(27) lgkmcnt(9)
v_mfma_f32_16x16x32_bf16 v[16:19], v[52:55], v[88:91], v[16:19]
ds_read_b64_tr_b16 v[74:75], v15 offset:1024
buffer_load_dwordx4 v[200:203], v6, s[20:23], s66 offen offset:2048 sc1
s_waitcnt vmcnt(27)
v_mfma_f32_16x16x32_bf16 v[32:35], v[48:51], v[84:87], v[32:35]
ds_read_b64_tr_b16 v[76:77], v15 offset:4096
buffer_load_dwordx4 v[196:199], v6, s[20:23], s66 offen offset:256 sc1
s_waitcnt vmcnt(27)
v_mfma_f32_16x16x32_bf16 v[32:35], v[52:55], v[92:95], v[32:35]
ds_read_b64_tr_b16 v[78:79], v15 offset:5120
buffer_load_dwordx4 v[204:207], v6, s[20:23], s66 offen offset:2304 sc1
s_waitcnt lgkmcnt(10)
v_mfma_f32_16x16x32_bf16 v[20:23], v[56:59], v[80:83], v[20:23]
ds_read_b64_tr_b16 v[48:49], v12 offset:8192
s_add_u32 s66, s66, 4096
s_and_b32 s66, s66, 0xffff
s_waitcnt lgkmcnt(9)
v_mfma_f32_16x16x32_bf16 v[20:23], v[60:63], v[88:91], v[20:23]
ds_read_b64_tr_b16 v[50:51], v12 offset:9216
v_mfma_f32_16x16x32_bf16 v[36:39], v[56:59], v[84:87], v[36:39]
ds_read_b64_tr_b16 v[52:53], v12 offset:12288
v_mfma_f32_16x16x32_bf16 v[36:39], v[60:63], v[92:95], v[36:39]
ds_read_b64_tr_b16 v[54:55], v12 offset:13312
s_waitcnt lgkmcnt(10)
v_mfma_f32_16x16x32_bf16 v[24:27], v[64:67], v[80:83], v[24:27]
ds_read_b64_tr_b16 v[56:57], v13 offset:8192
s_waitcnt lgkmcnt(9)
v_mfma_f32_16x16x32_bf16 v[24:27], v[68:71], v[88:91], v[24:27]
ds_read_b64_tr_b16 v[58:59], v13 offset:9216
v_mfma_f32_16x16x32_bf16 v[40:43], v[64:67], v[84:87], v[40:43]
ds_read_b64_tr_b16 v[60:61], v13 offset:12288
v_mfma_f32_16x16x32_bf16 v[40:43], v[68:71], v[92:95], v[40:43]
ds_read_b64_tr_b16 v[62:63], v13 offset:13312
s_waitcnt lgkmcnt(10)
v_mfma_f32_16x16x32_bf16 v[28:31], v[72:75], v[80:83], v[28:31]
ds_read_b64_tr_b16 v[64:65], v14 offset:8192
s_waitcnt lgkmcnt(9)
v_mfma_f32_16x16x32_bf16 v[28:31], v[76:79], v[88:91], v[28:31]
ds_read_b64_tr_b16 v[66:67], v14 offset:9216
v_mfma_f32_16x16x32_bf16 v[44:47], v[72:75], v[84:87], v[44:47]
ds_read_b64_tr_b16 v[68:69], v14 offset:12288
v_mfma_f32_16x16x32_bf16 v[44:47], v[76:79], v[92:95], v[44:47]
ds_read_b64_tr_b16 v[70:71], v14 offset:13312
s_waitcnt vmcnt(27) lgkmcnt(10)
v_mfma_f32_16x16x32_bf16 v[16:19], v[48:51], v[96:99], v[16:19]
ds_read_b64_tr_b16 v[72:73], v15 offset:8192
s_waitcnt vmcnt(26) lgkmcnt(9)
v_mfma_f32_16x16x32_bf16 v[16:19], v[52:55], v[104:107], v[16:19]
ds_read_b64_tr_b16 v[74:75], v15 offset:9216
s_waitcnt vmcnt(25)
v_mfma_f32_16x16x32_bf16 v[32:35], v[48:51], v[100:103], v[32:35]
ds_read_b64_tr_b16 v[76:77], v15 offset:12288
s_waitcnt vmcnt(24)
v_mfma_f32_16x16x32_bf16 v[32:35], v[52:55], v[108:111], v[32:35]
ds_read_b64_tr_b16 v[78:79], v15 offset:13312
s_waitcnt lgkmcnt(10)
v_mfma_f32_16x16x32_bf16 v[20:23], v[56:59], v[96:99], v[20:23]
ds_read_b64_tr_b16 v[48:49], v12 offset:16384
s_waitcnt lgkmcnt(9)
v_mfma_f32_16x16x32_bf16 v[20:23], v[60:63], v[104:107], v[20:23]
ds_read_b64_tr_b16 v[50:51], v12 offset:17408
v_mfma_f32_16x16x32_bf16 v[36:39], v[56:59], v[100:103], v[36:39]
ds_read_b64_tr_b16 v[52:53], v12 offset:20480
v_mfma_f32_16x16x32_bf16 v[36:39], v[60:63], v[108:111], v[36:39]
ds_read_b64_tr_b16 v[54:55], v12 offset:21504
s_waitcnt lgkmcnt(10)
v_mfma_f32_16x16x32_bf16 v[24:27], v[64:67], v[96:99], v[24:27]
ds_read_b64_tr_b16 v[56:57], v13 offset:16384
s_waitcnt lgkmcnt(9)
v_mfma_f32_16x16x32_bf16 v[24:27], v[68:71], v[104:107], v[24:27]
ds_read_b64_tr_b16 v[58:59], v13 offset:17408
v_mfma_f32_16x16x32_bf16 v[40:43], v[64:67], v[100:103], v[40:43]
ds_read_b64_tr_b16 v[60:61], v13 offset:20480
v_mfma_f32_16x16x32_bf16 v[40:43], v[68:71], v[108:111], v[40:43]
ds_read_b64_tr_b16 v[62:63], v13 offset:21504
s_waitcnt lgkmcnt(10)
v_mfma_f32_16x16x32_bf16 v[28:31], v[72:75], v[96:99], v[28:31]
ds_read_b64_tr_b16 v[64:65], v14 offset:16384
s_waitcnt lgkmcnt(9)
v_mfma_f32_16x16x32_bf16 v[28:31], v[76:79], v[104:107], v[28:31]
ds_read_b64_tr_b16 v[66:67], v14 offset:17408
v_mfma_f32_16x16x32_bf16 v[44:47], v[72:75], v[100:103], v[44:47]
ds_read_b64_tr_b16 v[68:69], v14 offset:20480
v_mfma_f32_16x16x32_bf16 v[44:47], v[76:79], v[108:111], v[44:47]
ds_read_b64_tr_b16 v[70:71], v14 offset:21504
s_waitcnt vmcnt(23) lgkmcnt(10)
v_mfma_f32_16x16x32_bf16 v[16:19], v[48:51], v[112:115], v[16:19]
ds_read_b64_tr_b16 v[72:73], v15 offset:16384
s_waitcnt vmcnt(22) lgkmcnt(9)
v_mfma_f32_16x16x32_bf16 v[16:19], v[52:55], v[120:123], v[16:19]
ds_read_b64_tr_b16 v[74:75], v15 offset:17408
s_waitcnt vmcnt(21)
v_mfma_f32_16x16x32_bf16 v[32:35], v[48:51], v[116:119], v[32:35]
ds_read_b64_tr_b16 v[76:77], v15 offset:20480
s_waitcnt vmcnt(20)
v_mfma_f32_16x16x32_bf16 v[32:35], v[52:55], v[124:127], v[32:35]
ds_read_b64_tr_b16 v[78:79], v15 offset:21504
s_waitcnt lgkmcnt(10)
v_mfma_f32_16x16x32_bf16 v[20:23], v[56:59], v[112:115], v[20:23]
ds_read_b64_tr_b16 v[48:49], v12 offset:24576
s_waitcnt lgkmcnt(9)
v_mfma_f32_16x16x32_bf16 v[20:23], v[60:63], v[120:123], v[20:23]
ds_read_b64_tr_b16 v[50:51], v12 offset:25600
v_mfma_f32_16x16x32_bf16 v[36:39], v[56:59], v[116:119], v[36:39]
ds_read_b64_tr_b16 v[52:53], v12 offset:28672
v_mfma_f32_16x16x32_bf16 v[36:39], v[60:63], v[124:127], v[36:39]
ds_read_b64_tr_b16 v[54:55], v12 offset:29696
s_waitcnt lgkmcnt(10)
v_mfma_f32_16x16x32_bf16 v[24:27], v[64:67], v[112:115], v[24:27]
ds_read_b64_tr_b16 v[56:57], v13 offset:24576
s_waitcnt lgkmcnt(9)
v_mfma_f32_16x16x32_bf16 v[24:27], v[68:71], v[120:123], v[24:27]
ds_read_b64_tr_b16 v[58:59], v13 offset:25600
v_mfma_f32_16x16x32_bf16 v[40:43], v[64:67], v[116:119], v[40:43]
ds_read_b64_tr_b16 v[60:61], v13 offset:28672
v_mfma_f32_16x16x32_bf16 v[40:43], v[68:71], v[124:127], v[40:43]
ds_read_b64_tr_b16 v[62:63], v13 offset:29696
s_waitcnt lgkmcnt(10)
v_mfma_f32_16x16x32_bf16 v[28:31], v[72:75], v[112:115], v[28:31]
ds_read_b64_tr_b16 v[64:65], v14 offset:24576
s_waitcnt lgkmcnt(9)
v_mfma_f32_16x16x32_bf16 v[28:31], v[76:79], v[120:123], v[28:31]
ds_read_b64_tr_b16 v[66:67], v14 offset:25600
v_mfma_f32_16x16x32_bf16 v[44:47], v[72:75], v[116:119], v[44:47]
ds_read_b64_tr_b16 v[68:69], v14 offset:28672
v_mfma_f32_16x16x32_bf16 v[44:47], v[76:79], v[124:127], v[44:47]
ds_read_b64_tr_b16 v[70:71], v14 offset:29696
s_waitcnt vmcnt(19) lgkmcnt(10)
v_mfma_f32_16x16x32_bf16 v[16:19], v[48:51], v[128:131], v[16:19]
ds_read_b64_tr_b16 v[72:73], v15 offset:24576
s_waitcnt vmcnt(18) lgkmcnt(9)
v_mfma_f32_16x16x32_bf16 v[16:19], v[52:55], v[136:139], v[16:19]
ds_read_b64_tr_b16 v[74:75], v15 offset:25600
s_waitcnt vmcnt(17)
v_mfma_f32_16x16x32_bf16 v[32:35], v[48:51], v[132:135], v[32:35]
ds_read_b64_tr_b16 v[76:77], v15 offset:28672
s_waitcnt vmcnt(16)
v_mfma_f32_16x16x32_bf16 v[32:35], v[52:55], v[140:143], v[32:35]
ds_read_b64_tr_b16 v[78:79], v15 offset:29696
s_waitcnt lgkmcnt(10)
v_mfma_f32_16x16x32_bf16 v[20:23], v[56:59], v[128:131], v[20:23]
ds_read_b64_tr_b16 v[48:49], v12 offset:32768
s_waitcnt lgkmcnt(9)
v_mfma_f32_16x16x32_bf16 v[20:23], v[60:63], v[136:139], v[20:23]
ds_read_b64_tr_b16 v[50:51], v12 offset:33792
v_mfma_f32_16x16x32_bf16 v[36:39], v[56:59], v[132:135], v[36:39]
ds_read_b64_tr_b16 v[52:53], v12 offset:36864
v_mfma_f32_16x16x32_bf16 v[36:39], v[60:63], v[140:143], v[36:39]
ds_read_b64_tr_b16 v[54:55], v12 offset:37888
s_waitcnt lgkmcnt(10)
v_mfma_f32_16x16x32_bf16 v[24:27], v[64:67], v[128:131], v[24:27]
ds_read_b64_tr_b16 v[56:57], v13 offset:32768
s_waitcnt lgkmcnt(9)
v_mfma_f32_16x16x32_bf16 v[24:27], v[68:71], v[136:139], v[24:27]
ds_read_b64_tr_b16 v[58:59], v13 offset:33792
v_mfma_f32_16x16x32_bf16 v[40:43], v[64:67], v[132:135], v[40:43]
ds_read_b64_tr_b16 v[60:61], v13 offset:36864
v_mfma_f32_16x16x32_bf16 v[40:43], v[68:71], v[140:143], v[40:43]
ds_read_b64_tr_b16 v[62:63], v13 offset:37888
s_waitcnt lgkmcnt(10)
v_mfma_f32_16x16x32_bf16 v[28:31], v[72:75], v[128:131], v[28:31]
ds_read_b64_tr_b16 v[64:65], v14 offset:32768
s_waitcnt lgkmcnt(9)
v_mfma_f32_16x16x32_bf16 v[28:31], v[76:79], v[136:139], v[28:31]
ds_read_b64_tr_b16 v[66:67], v14 offset:33792
v_mfma_f32_16x16x32_bf16 v[44:47], v[72:75], v[132:135], v[44:47]
ds_read_b64_tr_b16 v[68:69], v14 offset:36864
v_mfma_f32_16x16x32_bf16 v[44:47], v[76:79], v[140:143], v[44:47]
ds_read_b64_tr_b16 v[70:71], v14 offset:37888
s_waitcnt vmcnt(15) lgkmcnt(10)
v_mfma_f32_16x16x32_bf16 v[16:19], v[48:51], v[144:147], v[16:19]
ds_read_b64_tr_b16 v[72:73], v15 offset:32768
s_waitcnt vmcnt(14) lgkmcnt(9)
v_mfma_f32_16x16x32_bf16 v[16:19], v[52:55], v[152:155], v[16:19]
ds_read_b64_tr_b16 v[74:75], v15 offset:33792
s_waitcnt vmcnt(13)
v_mfma_f32_16x16x32_bf16 v[32:35], v[48:51], v[148:151], v[32:35]
ds_read_b64_tr_b16 v[76:77], v15 offset:36864
s_waitcnt vmcnt(12)
v_mfma_f32_16x16x32_bf16 v[32:35], v[52:55], v[156:159], v[32:35]
ds_read_b64_tr_b16 v[78:79], v15 offset:37888
s_waitcnt lgkmcnt(10)
v_mfma_f32_16x16x32_bf16 v[20:23], v[56:59], v[144:147], v[20:23]
ds_read_b64_tr_b16 v[48:49], v12 offset:40960
s_waitcnt lgkmcnt(9)
v_mfma_f32_16x16x32_bf16 v[20:23], v[60:63], v[152:155], v[20:23]
ds_read_b64_tr_b16 v[50:51], v12 offset:41984
v_mfma_f32_16x16x32_bf16 v[36:39], v[56:59], v[148:151], v[36:39]
ds_read_b64_tr_b16 v[52:53], v12 offset:45056
v_mfma_f32_16x16x32_bf16 v[36:39], v[60:63], v[156:159], v[36:39]
ds_read_b64_tr_b16 v[54:55], v12 offset:46080
s_waitcnt lgkmcnt(10)
v_mfma_f32_16x16x32_bf16 v[24:27], v[64:67], v[144:147], v[24:27]
ds_read_b64_tr_b16 v[56:57], v13 offset:40960
s_waitcnt lgkmcnt(9)
v_mfma_f32_16x16x32_bf16 v[24:27], v[68:71], v[152:155], v[24:27]
ds_read_b64_tr_b16 v[58:59], v13 offset:41984
v_mfma_f32_16x16x32_bf16 v[40:43], v[64:67], v[148:151], v[40:43]
ds_read_b64_tr_b16 v[60:61], v13 offset:45056
v_mfma_f32_16x16x32_bf16 v[40:43], v[68:71], v[156:159], v[40:43]
ds_read_b64_tr_b16 v[62:63], v13 offset:46080
s_waitcnt lgkmcnt(10)
v_mfma_f32_16x16x32_bf16 v[28:31], v[72:75], v[144:147], v[28:31]
ds_read_b64_tr_b16 v[64:65], v14 offset:40960
s_waitcnt lgkmcnt(9)
v_mfma_f32_16x16x32_bf16 v[28:31], v[76:79], v[152:155], v[28:31]
ds_read_b64_tr_b16 v[66:67], v14 offset:41984
v_mfma_f32_16x16x32_bf16 v[44:47], v[72:75], v[148:151], v[44:47]
ds_read_b64_tr_b16 v[68:69], v14 offset:45056
v_mfma_f32_16x16x32_bf16 v[44:47], v[76:79], v[156:159], v[44:47]
ds_read_b64_tr_b16 v[70:71], v14 offset:46080
s_waitcnt vmcnt(11) lgkmcnt(10)
v_mfma_f32_16x16x32_bf16 v[16:19], v[48:51], v[160:163], v[16:19]
ds_read_b64_tr_b16 v[72:73], v15 offset:40960
s_waitcnt vmcnt(10) lgkmcnt(9)
v_mfma_f32_16x16x32_bf16 v[16:19], v[52:55], v[168:171], v[16:19]
ds_read_b64_tr_b16 v[74:75], v15 offset:41984
s_waitcnt vmcnt(9)
v_mfma_f32_16x16x32_bf16 v[32:35], v[48:51], v[164:167], v[32:35]
ds_read_b64_tr_b16 v[76:77], v15 offset:45056
s_waitcnt vmcnt(8)
v_mfma_f32_16x16x32_bf16 v[32:35], v[52:55], v[172:175], v[32:35]
ds_read_b64_tr_b16 v[78:79], v15 offset:46080
s_waitcnt lgkmcnt(10)
v_mfma_f32_16x16x32_bf16 v[20:23], v[56:59], v[160:163], v[20:23]
ds_read_b64_tr_b16 v[48:49], v12 offset:49152
s_waitcnt lgkmcnt(9)
v_mfma_f32_16x16x32_bf16 v[20:23], v[60:63], v[168:171], v[20:23]
ds_read_b64_tr_b16 v[50:51], v12 offset:50176
v_mfma_f32_16x16x32_bf16 v[36:39], v[56:59], v[164:167], v[36:39]
ds_read_b64_tr_b16 v[52:53], v12 offset:53248
v_mfma_f32_16x16x32_bf16 v[36:39], v[60:63], v[172:175], v[36:39]
ds_read_b64_tr_b16 v[54:55], v12 offset:54272
s_waitcnt lgkmcnt(10)
v_mfma_f32_16x16x32_bf16 v[24:27], v[64:67], v[160:163], v[24:27]
ds_read_b64_tr_b16 v[56:57], v13 offset:49152
s_waitcnt lgkmcnt(9)
v_mfma_f32_16x16x32_bf16 v[24:27], v[68:71], v[168:171], v[24:27]
ds_read_b64_tr_b16 v[58:59], v13 offset:50176
v_mfma_f32_16x16x32_bf16 v[40:43], v[64:67], v[164:167], v[40:43]
ds_read_b64_tr_b16 v[60:61], v13 offset:53248
v_mfma_f32_16x16x32_bf16 v[40:43], v[68:71], v[172:175], v[40:43]
ds_read_b64_tr_b16 v[62:63], v13 offset:54272
s_waitcnt lgkmcnt(10)
v_mfma_f32_16x16x32_bf16 v[28:31], v[72:75], v[160:163], v[28:31]
ds_read_b64_tr_b16 v[64:65], v14 offset:49152
s_waitcnt lgkmcnt(9)
v_mfma_f32_16x16x32_bf16 v[28:31], v[76:79], v[168:171], v[28:31]
ds_read_b64_tr_b16 v[66:67], v14 offset:50176
v_mfma_f32_16x16x32_bf16 v[44:47], v[72:75], v[164:167], v[44:47]
ds_read_b64_tr_b16 v[68:69], v14 offset:53248
v_mfma_f32_16x16x32_bf16 v[44:47], v[76:79], v[172:175], v[44:47]
ds_read_b64_tr_b16 v[70:71], v14 offset:54272
s_waitcnt vmcnt(7) lgkmcnt(10)
v_mfma_f32_16x16x32_bf16 v[16:19], v[48:51], v[176:179], v[16:19]
ds_read_b64_tr_b16 v[72:73], v15 offset:49152
s_waitcnt vmcnt(6) lgkmcnt(9)
v_mfma_f32_16x16x32_bf16 v[16:19], v[52:55], v[184:187], v[16:19]
ds_read_b64_tr_b16 v[74:75], v15 offset:50176
s_waitcnt vmcnt(5)
v_mfma_f32_16x16x32_bf16 v[32:35], v[48:51], v[180:183], v[32:35]
ds_read_b64_tr_b16 v[76:77], v15 offset:53248
s_waitcnt vmcnt(4)
v_mfma_f32_16x16x32_bf16 v[32:35], v[52:55], v[188:191], v[32:35]
ds_read_b64_tr_b16 v[78:79], v15 offset:54272
s_waitcnt lgkmcnt(10)
v_mfma_f32_16x16x32_bf16 v[20:23], v[56:59], v[176:179], v[20:23]
ds_read_b64_tr_b16 v[48:49], v12 offset:57344
s_waitcnt lgkmcnt(9)
v_mfma_f32_16x16x32_bf16 v[20:23], v[60:63], v[184:187], v[20:23]
ds_read_b64_tr_b16 v[50:51], v12 offset:58368
v_mfma_f32_16x16x32_bf16 v[36:39], v[56:59], v[180:183], v[36:39]
ds_read_b64_tr_b16 v[52:53], v12 offset:61440
v_mfma_f32_16x16x32_bf16 v[36:39], v[60:63], v[188:191], v[36:39]
ds_read_b64_tr_b16 v[54:55], v12 offset:62464
s_waitcnt lgkmcnt(10)
v_mfma_f32_16x16x32_bf16 v[24:27], v[64:67], v[176:179], v[24:27]
ds_read_b64_tr_b16 v[56:57], v13 offset:57344
s_waitcnt lgkmcnt(9)
v_mfma_f32_16x16x32_bf16 v[24:27], v[68:71], v[184:187], v[24:27]
ds_read_b64_tr_b16 v[58:59], v13 offset:58368
v_mfma_f32_16x16x32_bf16 v[40:43], v[64:67], v[180:183], v[40:43]
ds_read_b64_tr_b16 v[60:61], v13 offset:61440
v_mfma_f32_16x16x32_bf16 v[40:43], v[68:71], v[188:191], v[40:43]
ds_read_b64_tr_b16 v[62:63], v13 offset:62464
s_waitcnt lgkmcnt(10)
v_mfma_f32_16x16x32_bf16 v[28:31], v[72:75], v[176:179], v[28:31]
ds_read_b64_tr_b16 v[64:65], v14 offset:57344
s_waitcnt lgkmcnt(9)
v_mfma_f32_16x16x32_bf16 v[28:31], v[76:79], v[184:187], v[28:31]
ds_read_b64_tr_b16 v[66:67], v14 offset:58368
v_mfma_f32_16x16x32_bf16 v[44:47], v[72:75], v[180:183], v[44:47]
ds_read_b64_tr_b16 v[68:69], v14 offset:61440
v_mfma_f32_16x16x32_bf16 v[44:47], v[76:79], v[188:191], v[44:47]
ds_read_b64_tr_b16 v[70:71], v14 offset:62464
s_waitcnt vmcnt(3) lgkmcnt(10)
v_mfma_f32_16x16x32_bf16 v[16:19], v[48:51], v[192:195], v[16:19]
ds_read_b64_tr_b16 v[72:73], v15 offset:57344
s_waitcnt vmcnt(2) lgkmcnt(9)
v_mfma_f32_16x16x32_bf16 v[16:19], v[52:55], v[200:203], v[16:19]
ds_read_b64_tr_b16 v[74:75], v15 offset:58368
s_waitcnt vmcnt(1)
v_mfma_f32_16x16x32_bf16 v[32:35], v[48:51], v[196:199], v[32:35]
ds_read_b64_tr_b16 v[76:77], v15 offset:61440
s_waitcnt vmcnt(0)
v_mfma_f32_16x16x32_bf16 v[32:35], v[52:55], v[204:207], v[32:35]
ds_read_b64_tr_b16 v[78:79], v15 offset:62464
s_waitcnt lgkmcnt(10)
v_mfma_f32_16x16x32_bf16 v[20:23], v[56:59], v[192:195], v[20:23]
v_add_u32 v5, s34, 22
s_mov_b64 exec, 1
ds_write_b32 v3, v5
s_mov_b64 exec, -1
s_waitcnt lgkmcnt(9)
v_mfma_f32_16x16x32_bf16 v[20:23], v[60:63], v[200:203], v[20:23]
v_mfma_f32_16x16x32_bf16 v[36:39], v[56:59], v[196:199], v[36:39]
v_mfma_f32_16x16x32_bf16 v[36:39], v[60:63], v[204:207], v[36:39]
s_waitcnt lgkmcnt(7)
v_mfma_f32_16x16x32_bf16 v[24:27], v[64:67], v[192:195], v[24:27]
s_waitcnt lgkmcnt(5)
v_mfma_f32_16x16x32_bf16 v[24:27], v[68:71], v[200:203], v[24:27]
v_mfma_f32_16x16x32_bf16 v[40:43], v[64:67], v[196:199], v[40:43]
v_mfma_f32_16x16x32_bf16 v[40:43], v[68:71], v[204:207], v[40:43]
s_waitcnt lgkmcnt(3)
v_mfma_f32_16x16x32_bf16 v[28:31], v[72:75], v[192:195], v[28:31]
s_waitcnt lgkmcnt(1)
v_mfma_f32_16x16x32_bf16 v[28:31], v[76:79], v[200:203], v[28:31]
v_mfma_f32_16x16x32_bf16 v[44:47], v[72:75], v[196:199], v[44:47]
v_mfma_f32_16x16x32_bf16 v[44:47], v[76:79], v[204:207], v[44:47]
s_lshl2_add_u32 s73, s61, s58
s_lshl4_add_u32 s66, s61, s62
s_lshl2_add_u32 s68, s66, s58
s_lshl_b32 s68, s68, 12
s_add_u32 s68, s68, 26214400
s_lshl_b32 s66, s66, 7
s_add_u32 s66, s66, 2883584
s_lshl_b32 s74, s73, 13
s_add_u32 s74, s74, 393216
s_lshl_b32 s67, s62, 9
s_add_u32 s67, s67, s74
v_lshlrev_b32 v6, 4, v0
s_mov_b32 s69, 0x3f803f80
v_mov_b32 v8, 0
v_mov_b32 v9, 0
v_mov_b32 v10, 0
v_mov_b32 v11, 0
v_mov_b32 v12, 0
v_mov_b32 v13, 0
v_mov_b32 v14, 0
v_dot2c_f32_bf16 v11, s69, v232
v_dot2c_f32_bf16 v11, s69, v233
v_dot2c_f32_bf16 v11, s69, v234
v_dot2c_f32_bf16 v11, s69, v235
v_dot2c_f32_bf16 v11, s69, v236
v_dot2c_f32_bf16 v11, s69, v237
v_dot2c_f32_bf16 v11, s69, v238
v_dot2c_f32_bf16 v11, s69, v239
s_cmp_eq_u32 s63, 0
v_cvt_pk_bf16_f32 v240, v16, v17
v_cvt_pk_bf16_f32 v241, v18, v19
v_cvt_pk_bf16_f32 v242, v20, v21
v_cvt_pk_bf16_f32 v243, v22, v23
v_cvt_pk_bf16_f32 v244, v24, v25
v_cvt_pk_bf16_f32 v245, v26, v27
v_cvt_pk_bf16_f32 v246, v28, v29
v_cvt_pk_bf16_f32 v247, v30, v31
v_cvt_pk_bf16_f32 v248, v32, v33
v_cvt_pk_bf16_f32 v249, v34, v35
v_cvt_pk_bf16_f32 v250, v36, v37
v_cvt_pk_bf16_f32 v251, v38, v39
v_cvt_pk_bf16_f32 v252, v40, v41
v_cvt_pk_bf16_f32 v253, v42, v43
v_cvt_pk_bf16_f32 v254, v44, v45
v_cvt_pk_bf16_f32 v255, v46, v47
s_cselect_b64 exec, -1, 0
buffer_store_dwordx4 v[240:243], v6, s[20:23], s68 offen offset:0 sc1
buffer_store_dwordx4 v[244:247], v6, s[20:23], s68 offen offset:1024 sc1
buffer_store_dwordx4 v[248:251], v6, s[20:23], s68 offen offset:2048 sc1
buffer_store_dwordx4 v[252:255], v6, s[20:23], s68 offen offset:3072 sc1
s_mov_b64 exec, -1
v_dot2c_f32_bf16 v8, s69, v240
v_dot2c_f32_bf16 v9, v240, v240
v_dot2c_f32_bf16 v10, v232, v240
v_dot2c_f32_bf16 v12, s69, v248
v_dot2c_f32_bf16 v13, v248, v248
v_dot2c_f32_bf16 v14, v232, v248
v_dot2c_f32_bf16 v8, s69, v241
v_dot2c_f32_bf16 v9, v241, v241
v_dot2c_f32_bf16 v10, v233, v241
v_dot2c_f32_bf16 v12, s69, v249
v_dot2c_f32_bf16 v13, v249, v249
v_dot2c_f32_bf16 v14, v233, v249
v_dot2c_f32_bf16 v8, s69, v242
v_dot2c_f32_bf16 v9, v242, v242
v_dot2c_f32_bf16 v10, v234, v242
v_dot2c_f32_bf16 v12, s69, v250
v_dot2c_f32_bf16 v13, v250, v250
v_dot2c_f32_bf16 v14, v234, v250
v_dot2c_f32_bf16 v8, s69, v243
v_dot2c_f32_bf16 v9, v243, v243
v_dot2c_f32_bf16 v10, v235, v243
v_dot2c_f32_bf16 v12, s69, v251
v_dot2c_f32_bf16 v13, v251, v251
v_dot2c_f32_bf16 v14, v235, v251
v_dot2c_f32_bf16 v8, s69, v244
v_dot2c_f32_bf16 v9, v244, v244
v_dot2c_f32_bf16 v10, v236, v244
v_dot2c_f32_bf16 v12, s69, v252
v_dot2c_f32_bf16 v13, v252, v252
v_dot2c_f32_bf16 v14, v236, v252
v_dot2c_f32_bf16 v8, s69, v245
v_dot2c_f32_bf16 v9, v245, v245
v_dot2c_f32_bf16 v10, v237, v245
v_dot2c_f32_bf16 v12, s69, v253
v_dot2c_f32_bf16 v13, v253, v253
v_dot2c_f32_bf16 v14, v237, v253
v_dot2c_f32_bf16 v8, s69, v246
v_dot2c_f32_bf16 v9, v246, v246
v_dot2c_f32_bf16 v10, v238, v246
v_dot2c_f32_bf16 v12, s69, v254
v_dot2c_f32_bf16 v13, v254, v254
v_dot2c_f32_bf16 v14, v238, v254
v_dot2c_f32_bf16 v8, s69, v247
v_dot2c_f32_bf16 v9, v247, v247
v_dot2c_f32_bf16 v10, v239, v247
v_dot2c_f32_bf16 v12, s69, v255
v_dot2c_f32_bf16 v13, v255, v255
v_dot2c_f32_bf16 v14, v239, v255
v_mov_b32 v15, v11
v_lshrrev_b32 v7, 5, v0
v_mul_u32_u24 v7, 3584, v7
v_permlane16_swap_b32 v8, v12
v_permlane16_swap_b32 v9, v13
v_permlane16_swap_b32 v10, v14
v_permlane16_swap_b32 v11, v15
v_pk_add_f32 v[8:9], v[8:9], v[12:13]
v_pk_add_f32 v[10:11], v[10:11], v[14:15]
v_mov_b32 v12, v8
v_mov_b32 v13, v9
v_mov_b32 v14, v10
v_mov_b32 v15, v11
v_permlane32_swap_b32 v12, v8
v_permlane32_swap_b32 v13, v9
v_permlane32_swap_b32 v14, v10
v_permlane32_swap_b32 v15, v11
v_pk_add_f32 v[8:9], v[8:9], v[12:13]
v_pk_add_f32 v[10:11], v[10:11], v[14:15]
v_add_u32 v7, v6, v7
v_max_u32 v8, 1, v8
v_max_u32 v9, 1, v9
v_max_u32 v10, 1, v10
v_max_u32 v11, 1, v11
s_mov_b32 exec_hi, 0
buffer_store_dwordx4 v[8:11], v6, s[24:27], s67 offen sc1
s_mov_b32 exec_hi, -1
v_lshlrev_b32 v16, 16, v240
v_and_b32 v17, 0xffff0000, v240
v_lshlrev_b32 v18, 16, v241
v_and_b32 v19, 0xffff0000, v241
v_lshlrev_b32 v20, 16, v242
v_and_b32 v21, 0xffff0000, v242
v_lshlrev_b32 v22, 16, v243
v_and_b32 v23, 0xffff0000, v243
v_lshlrev_b32 v24, 16, v244
v_and_b32 v25, 0xffff0000, v244
v_lshlrev_b32 v26, 16, v245
v_and_b32 v27, 0xffff0000, v245
v_lshlrev_b32 v28, 16, v246
v_and_b32 v29, 0xffff0000, v246
v_lshlrev_b32 v30, 16, v247
v_and_b32 v31, 0xffff0000, v247
v_lshlrev_b32 v32, 16, v248
v_and_b32 v33, 0xffff0000, v248
v_lshlrev_b32 v34, 16, v249
v_and_b32 v35, 0xffff0000, v249
v_lshlrev_b32 v36, 16, v250
v_and_b32 v37, 0xffff0000, v250
v_lshlrev_b32 v38, 16, v251
v_and_b32 v39, 0xffff0000, v251
v_lshlrev_b32 v40, 16, v252
v_and_b32 v41, 0xffff0000, v252
v_lshlrev_b32 v42, 16, v253
v_and_b32 v43, 0xffff0000, v253
v_lshlrev_b32 v44, 16, v254
v_and_b32 v45, 0xffff0000, v254
v_lshlrev_b32 v46, 16, v255
v_and_b32 v47, 0xffff0000, v255
v_and_b32 v14, 15, v0
v_lshlrev_b32 v14, 11, v14
v_bfe_u32 v15, v0, 4, 1
v_lshl_add_u32 v14, v15, 5, v14
v_lshrrev_b32 v15, 5, v0
v_lshl_add_u32 v14, v15, 4, v14
s_lshl2_add_u32 s70, s61, s58
s_lshl_b32 s70, s70, 16
s_lshl_b32 s71, s62, 7
s_add_u32 s70, s70, s71
s_add_u32 s71, s70, 0x8000
s_lshl4_add_u32 s68, s61, s62
s_lshl_b32 s68, s68, 8
s_add_u32 s69, s68, 2818048
s_add_u32 s68, s68, 2752512
s_lshl_b32 s75, s73, 5
s_add_u32 s75, s75, 1
v_and_b32 v15, 48, v0
v_add_u32 v13, s75, v0
s_mov_b64 exec, 1
s_waitcnt vmcnt(1)
buffer_store_dword v212, v3, s[24:27], s66 offen sc1
s_mov_b64 exec, -1
v_add_u32 v5, s34, 23
s_mov_b64 exec, 1
ds_write_b32 v3, v5
s_mov_b64 exec, -1
s_waitcnt vmcnt(1)
poll_119:
buffer_load_dwordx4 v[80:83], v7, s[24:27], s74 offen offset:0 sc1
buffer_load_dwordx4 v[84:87], v7, s[24:27], s74 offen offset:512 sc1
buffer_load_dwordx4 v[88:91], v7, s[24:27], s74 offen offset:1024 sc1
buffer_load_dwordx4 v[92:95], v7, s[24:27], s74 offen offset:1536 sc1
buffer_load_dwordx4 v[96:99], v7, s[24:27], s74 offen offset:2048 sc1
buffer_load_dwordx4 v[100:103], v7, s[24:27], s74 offen offset:2560 sc1
buffer_load_dwordx4 v[104:107], v7, s[24:27], s74 offen offset:3072 sc1
buffer_load_dwordx4 v[108:111], v7, s[24:27], s74 offen offset:3584 sc1
pchk_120:
s_waitcnt vmcnt(7)
v_min3_u32 v8, v80, v81, v82
s_waitcnt vmcnt(6)
v_min3_u32 v8, v8, v83, v84
v_min3_u32 v8, v8, v85, v86
s_waitcnt vmcnt(5)
v_min3_u32 v8, v8, v87, v88
v_min3_u32 v8, v8, v89, v90
s_waitcnt vmcnt(4)
v_min3_u32 v8, v8, v91, v92
v_min3_u32 v8, v8, v93, v94
s_waitcnt vmcnt(3)
v_min3_u32 v8, v8, v95, v96
v_min3_u32 v8, v8, v97, v98
s_waitcnt vmcnt(2)
v_min3_u32 v8, v8, v99, v100
v_min3_u32 v8, v8, v101, v102
s_waitcnt vmcnt(1)
v_min3_u32 v8, v8, v103, v104
v_min3_u32 v8, v8, v105, v106
s_waitcnt vmcnt(0)
v_min3_u32 v8, v8, v107, v108
v_min3_u32 v8, v8, v109, v110
v_min_u32 v8, v8, v111
v_cmp_eq_u32 vcc, 0, v8
s_cbranch_vccz pdone_121
s_sub_u32 s32, s32, 1
s_cmp_gt_i32 s32, 0
s_cbranch_scc1 poll_119
pdone_121:
v_pk_add_f32 v[80:81], v[80:81], v[96:97]
v_pk_add_f32 v[82:83], v[82:83], v[98:99]
v_pk_add_f32 v[84:85], v[84:85], v[100:101]
v_pk_add_f32 v[86:87], v[86:87], v[102:103]
v_pk_add_f32 v[88:89], v[88:89], v[104:105]
v_pk_add_f32 v[90:91], v[90:91], v[106:107]
v_pk_add_f32 v[92:93], v[92:93], v[108:109]
v_pk_add_f32 v[94:95], v[94:95], v[110:111]
v_pk_add_f32 v[80:81], v[80:81], v[88:89]
v_pk_add_f32 v[82:83], v[82:83], v[90:91]
v_pk_add_f32 v[84:85], v[84:85], v[92:93]
v_pk_add_f32 v[86:87], v[86:87], v[94:95]
v_pk_add_f32 v[80:81], v[80:81], v[84:85]
v_pk_add_f32 v[82:83], v[82:83], v[86:87]
v_mov_b32 v8, v80
v_mov_b32 v9, v81
v_mov_b32 v10, v82
v_mov_b32 v11, v83
v_permlane32_swap_b32 v8, v80
v_permlane32_swap_b32 v9, v81
v_permlane32_swap_b32 v10, v82
v_permlane32_swap_b32 v11, v83
v_pk_add_f32 v[8:9], v[8:9], v[80:81]
v_pk_add_f32 v[10:11], v[10:11], v[82:83]
v_mul_f32 v8, 0xba800000, v8
v_mul_f32 v9, 0x3a800000, v9
v_fma_f32 v9, -v8, v8, v9
v_max_f32 v9, 0, v9
v_add_f32 v12, 0x3727c5ac, v9
v_rsq_f32 v80, v12
v_fma_f32 v10, v8, v11, v10
v_mul_f32 v12, v80, v10
v_max_u32 v12, 1, v12
v_add_u32 v7, s34, v3
v_mov_b32 v6, v12
s_nop 1
v_max_f32_dpp v6, v6, v6 row_ror:1 row_mask:0xf bank_mask:0xf
s_nop 1
v_max_f32_dpp v6, v6, v6 row_ror:2 row_mask:0xf bank_mask:0xf
s_nop 1
v_max_f32_dpp v6, v6, v6 row_ror:4 row_mask:0xf bank_mask:0xf
s_nop 1
v_max_f32_dpp v6, v6, v6 row_ror:8 row_mask:0xf bank_mask:0xf
v_mov_b32 v11, v6
s_nop 1
v_permlane16_swap_b32 v11, v6
v_max_f32 v6, v6, v11
v_cmp_eq_f32 vcc, v6, v12
s_ff1_i32_b64 s66, vcc
s_and_b32 s66, s66, 31
s_mov_b64 exec, 1
ds_write_b32 v7, v6 offset:256
s_mov_b64 exec, -1
v_add_u32 v7, s34, v1
v_mul_f32 v81, v8, v80
v_add_f32 v10, 1.0, v80
v_mov_b32 v82, v80
v_mov_b32 v83, v81
s_and_b32 s67, s66, 15
s_lshl_b32 s67, 0x10001, s67
s_bitcmp0_b32 s66, 4
v_permlane16_swap_b32 v80, v82
v_permlane16_swap_b32 v81, v83
s_cselect_b32 s76, s67, 0
s_cselect_b32 s78, 0, s67
s_cselect_b32 s77, s67, 0
s_cselect_b32 s79, 0, s67
s_add_u32 s75, s75, s66
v_pk_fma_f32 v[48:49], v[16:17], v[80:81], v[80:81] op_sel:[0,0,1] op_sel_hi:[1,0,1]
v_pk_fma_f32 v[50:51], v[18:19], v[80:81], v[80:81] op_sel:[0,0,1] op_sel_hi:[1,0,1]
v_pk_fma_f32 v[52:53], v[20:21], v[80:81], v[80:81] op_sel:[0,0,1] op_sel_hi:[1,0,1]
v_pk_fma_f32 v[54:55], v[22:23], v[80:81], v[80:81] op_sel:[0,0,1] op_sel_hi:[1,0,1]
v_pk_fma_f32 v[56:57], v[24:25], v[80:81], v[80:81] op_sel:[0,0,1] op_sel_hi:[1,0,1]
v_pk_fma_f32 v[58:59], v[26:27], v[80:81], v[80:81] op_sel:[0,0,1] op_sel_hi:[1,0,1]
v_pk_fma_f32 v[60:61], v[28:29], v[80:81], v[80:81] op_sel:[0,0,1] op_sel_hi:[1,0,1]
v_pk_fma_f32 v[62:63], v[30:31], v[80:81], v[80:81] op_sel:[0,0,1] op_sel_hi:[1,0,1]
v_pk_fma_f32 v[64:65], v[32:33], v[82:83], v[82:83] op_sel:[0,0,1] op_sel_hi:[1,0,1]
v_pk_fma_f32 v[66:67], v[34:35], v[82:83], v[82:83] op_sel:[0,0,1] op_sel_hi:[1,0,1]
v_pk_fma_f32 v[68:69], v[36:37], v[82:83], v[82:83] op_sel:[0,0,1] op_sel_hi:[1,0,1]
v_pk_fma_f32 v[70:71], v[38:39], v[82:83], v[82:83] op_sel:[0,0,1] op_sel_hi:[1,0,1]
v_pk_fma_f32 v[72:73], v[40:41], v[82:83], v[82:83] op_sel:[0,0,1] op_sel_hi:[1,0,1]
v_pk_fma_f32 v[74:75], v[42:43], v[82:83], v[82:83] op_sel:[0,0,1] op_sel_hi:[1,0,1]
v_pk_fma_f32 v[76:77], v[44:45], v[82:83], v[82:83] op_sel:[0,0,1] op_sel_hi:[1,0,1]
v_pk_fma_f32 v[78:79], v[46:47], v[82:83], v[82:83] op_sel:[0,0,1] op_sel_hi:[1,0,1]
v_cvt_pk_bf16_f32 v84, v48, v49
v_cvt_pk_bf16_f32 v85, v50, v51
v_cvt_pk_bf16_f32 v86, v52, v53
v_cvt_pk_bf16_f32 v87, v54, v55
v_cvt_pk_bf16_f32 v88, v56, v57
v_cvt_pk_bf16_f32 v89, v58, v59
v_cvt_pk_bf16_f32 v90, v60, v61
v_cvt_pk_bf16_f32 v91, v62, v63
v_cvt_pk_bf16_f32 v92, v64, v65
v_cvt_pk_bf16_f32 v93, v66, v67
v_cvt_pk_bf16_f32 v94, v68, v69
v_cvt_pk_bf16_f32 v95, v70, v71
v_cvt_pk_bf16_f32 v96, v72, v73
v_cvt_pk_bf16_f32 v97, v74, v75
v_cvt_pk_bf16_f32 v98, v76, v77
v_cvt_pk_bf16_f32 v99, v78, v79
ds_read_b32 v11, v7 offset:256
v_max_u32 v84, 1, v84
v_max_u32 v85, 1, v85
v_max_u32 v86, 1, v86
v_max_u32 v87, 1, v87
v_max_u32 v88, 1, v88
v_max_u32 v89, 1, v89
v_max_u32 v90, 1, v90
v_max_u32 v91, 1, v91
v_max_u32 v92, 1, v92
v_max_u32 v93, 1, v93
v_max_u32 v94, 1, v94
v_max_u32 v95, 1, v95
v_max_u32 v96, 1, v96
v_max_u32 v97, 1, v97
v_max_u32 v98, 1, v98
v_max_u32 v99, 1, v99
s_branch pchk_123
poll_122:
ds_read_b32 v11, v7 offset:256
pchk_123:
s_waitcnt lgkmcnt(0)
v_cmp_eq_u32 vcc, 0, v11
s_cbranch_vccz pdone_124
s_sub_u32 s32, s32, 1
s_cmp_gt_i32 s32, 0
s_cbranch_scc1 poll_122
pdone_124:
v_cmp_eq_f32 vcc, v11, v6
s_bfm_b32 s67, s58, 0
s_and_b32 s67, s67, vcc_lo
v_cmp_gt_f32 vcc, v11, v6
s_lshl_b32 s66, 1, s66
s_or_b32 s67, s67, vcc_lo
s_cselect_b64 s[76:77], 0, s[76:77]
s_cselect_b64 s[78:79], 0, s[78:79]
s_cselect_b64 exec, 0, s[66:67]
buffer_store_dwordx2 v[12:13], off, s[24:27], s68 offset:64 sc1
buffer_store_dwordx2 v[12:13], off, s[24:27], s68 offset:192 sc1
s_mov_b64 exec, s[76:77]
buffer_store_dwordx4 v[84:87], v15, s[24:27], s68 offen offset:0 sc1
buffer_store_dwordx4 v[88:91], v15, s[24:27], s68 offen offset:128 sc1
s_mov_b64 exec, s[78:79]
buffer_store_dwordx4 v[92:95], v15, s[24:27], s68 offen offset:0 sc1
buffer_store_dwordx4 v[96:99], v15, s[24:27], s68 offen offset:128 sc1
s_mov_b64 exec, -1
v_add_u32 v5, s34, 24
s_mov_b64 exec, 1
ds_write_b32 v3, v5
s_mov_b64 exec, -1
v_pk_add_f32 v[16:17], v[16:17], v[48:49]
v_pk_add_f32 v[18:19], v[18:19], v[50:51]
v_pk_add_f32 v[20:21], v[20:21], v[52:53]
v_pk_add_f32 v[22:23], v[22:23], v[54:55]
v_pk_add_f32 v[24:25], v[24:25], v[56:57]
v_pk_add_f32 v[26:27], v[26:27], v[58:59]
v_pk_add_f32 v[28:29], v[28:29], v[60:61]
v_pk_add_f32 v[30:31], v[30:31], v[62:63]
v_pk_add_f32 v[32:33], v[32:33], v[64:65]
v_pk_add_f32 v[34:35], v[34:35], v[66:67]
v_pk_add_f32 v[36:37], v[36:37], v[68:69]
v_pk_add_f32 v[38:39], v[38:39], v[70:71]
v_pk_add_f32 v[40:41], v[40:41], v[72:73]
v_pk_add_f32 v[42:43], v[42:43], v[74:75]
v_pk_add_f32 v[44:45], v[44:45], v[76:77]
v_pk_add_f32 v[46:47], v[46:47], v[78:79]
v_cvt_pk_bf16_f32 v240, v16, v17
v_cvt_pk_bf16_f32 v241, v18, v19
v_cvt_pk_bf16_f32 v242, v20, v21
v_cvt_pk_bf16_f32 v243, v22, v23
v_cvt_pk_bf16_f32 v244, v24, v25
v_cvt_pk_bf16_f32 v245, v26, v27
v_cvt_pk_bf16_f32 v246, v28, v29
v_cvt_pk_bf16_f32 v247, v30, v31
v_cvt_pk_bf16_f32 v248, v32, v33
v_cvt_pk_bf16_f32 v249, v34, v35
v_cvt_pk_bf16_f32 v250, v36, v37
v_cvt_pk_bf16_f32 v251, v38, v39
v_cvt_pk_bf16_f32 v252, v40, v41
v_cvt_pk_bf16_f32 v253, v42, v43
v_cvt_pk_bf16_f32 v254, v44, v45
v_cvt_pk_bf16_f32 v255, v46, v47
v_max_u32 v16, 1, v16
v_max_u32 v17, 1, v17
v_max_u32 v18, 1, v18
v_max_u32 v19, 1, v19
v_max_u32 v20, 1, v20
v_max_u32 v21, 1, v21
v_max_u32 v22, 1, v22
v_max_u32 v23, 1, v23
v_max_u32 v24, 1, v24
v_max_u32 v25, 1, v25
v_max_u32 v26, 1, v26
v_max_u32 v27, 1, v27
v_max_u32 v28, 1, v28
v_max_u32 v29, 1, v29
v_max_u32 v30, 1, v30
v_max_u32 v31, 1, v31
v_max_u32 v32, 1, v32
v_max_u32 v33, 1, v33
v_max_u32 v34, 1, v34
v_max_u32 v35, 1, v35
v_max_u32 v36, 1, v36
v_max_u32 v37, 1, v37
v_max_u32 v38, 1, v38
v_max_u32 v39, 1, v39
v_max_u32 v40, 1, v40
v_max_u32 v41, 1, v41
v_max_u32 v42, 1, v42
v_max_u32 v43, 1, v43
v_max_u32 v44, 1, v44
v_max_u32 v45, 1, v45
v_max_u32 v46, 1, v46
v_max_u32 v47, 1, v47
s_mov_b64 exec, s[76:77]
buffer_store_dwordx4 v[16:19], v15, s[24:27], s69 offen offset:0 sc1
buffer_store_dwordx4 v[20:23], v15, s[24:27], s69 offen offset:64 sc1
buffer_store_dwordx4 v[24:27], v15, s[24:27], s69 offen offset:128 sc1
buffer_store_dwordx4 v[28:31], v15, s[24:27], s69 offen offset:192 sc1
s_mov_b64 exec, s[78:79]
buffer_store_dwordx4 v[32:35], v15, s[24:27], s69 offen offset:0 sc1
buffer_store_dwordx4 v[36:39], v15, s[24:27], s69 offen offset:64 sc1
buffer_store_dwordx4 v[40:43], v15, s[24:27], s69 offen offset:128 sc1
buffer_store_dwordx4 v[44:47], v15, s[24:27], s69 offen offset:192 sc1
s_mov_b64 exec, -1
s_cmp_eq_u32 s63, 0
s_cbranch_scc0 mout_125
v_mul_f32 v11, v10, v10
v_mov_b32 v12, 0x3727c5ac
v_fma_f32 v11, v11, v9, v12
v_rsq_f32 v11, v11
v_lshrrev_b32 v12, 3, v0
v_lshlrev_b32 v12, 6, v12
v_lshl_add_u32 v12, v0, 3, v12
v_mul_f32 v10, v10, v11
v_mul_f32 v11, v8, v10
s_lshl_b32 s66, s73, 9
s_add_u32 s66, s66, 3211264
v_max_u32 v11, 1, v11
s_cmp_eq_u32 s62, 8
s_cselect_b32 exec_lo, -1, 0
s_mov_b32 exec_hi, 0
buffer_store_dwordx2 v[10:11], v12, s[24:27], s66 offen sc1
s_mov_b64 exec, -1
s_mov_b32 s63, 1
s_mov_b32 s34, 32
s_add_u32 s24, s24, 2949120
s_addc_u32 s25, s25, 0
s_mov_b32 s26, 2949120
s_branch L_mtop
mout_125:
v_permlane16_swap_b32 v240, v242
v_permlane16_swap_b32 v241, v243
v_permlane16_swap_b32 v244, v246
v_permlane16_swap_b32 v245, v247
v_permlane16_swap_b32 v248, v250
v_permlane16_swap_b32 v249, v251
v_permlane16_swap_b32 v252, v254
v_permlane16_swap_b32 v253, v255
s_not_b64 exec, s[76:77]
buffer_store_dwordx4 v[240:243], v14, s[28:31], s70 offen offset:0
buffer_store_dwordx4 v[244:247], v14, s[28:31], s70 offen offset:64
s_not_b64 exec, s[78:79]
buffer_store_dwordx4 v[248:251], v14, s[28:31], s71 offen offset:0
buffer_store_dwordx4 v[252:255], v14, s[28:31], s71 offen offset:64
s_mov_b64 exec, -1
s_or_b32 s66, s76, s78
s_cbranch_scc0 L_end
v_mov_b32 v11, 0
s_add_u32 s35, s34, 3
lw_126:
ds_read_b32 v5, v2 offset:24
s_waitcnt lgkmcnt(0)
v_cmp_gt_i32 vcc, s35, v5
s_cbranch_vccz lwd_127
s_sleep 2
s_sub_u32 s32, s32, 1
s_cmp_gt_i32 s32, 0
s_cbranch_scc1 lw_126
lwd_127:
ds_read_b32 v11, v11 offset:32
s_waitcnt lgkmcnt(0)
v_cmp_eq_u32 vcc, s75, v11
s_cbranch_vccnz L_end
s_mov_b64 exec, s[76:77]
buffer_store_dwordx4 v[240:243], v14, s[28:31], s70 offen offset:0
buffer_store_dwordx4 v[244:247], v14, s[28:31], s70 offen offset:64
s_mov_b64 exec, s[78:79]
buffer_store_dwordx4 v[248:251], v14, s[28:31], s71 offen offset:0
buffer_store_dwordx4 v[252:255], v14, s[28:31], s71 offen offset:64
s_mov_b64 exec, -1
s_branch L_end
mspin_94:
s_cmp_eq_u32 s66, 1
s_cbranch_scc1 mback_95
msp_128:
ds_read_b32 v5, v2 offset:16
s_waitcnt lgkmcnt(0)
v_cmp_ge_u32 vcc, v4, v5
s_cbranch_vccz mback_95
s_sub_u32 s32, s32, 1
s_cmp_gt_i32 s32, 0
s_cbranch_scc1 msp_128
s_branch mback_95
patch_98:
s_bfe_u32 s66, s33, 0x20005
s_lshr_b32 s67, s66, 1
s_xor_b32 s66, s66, s67
s_and_b32 s66, s66, 1
s_cmp_eq_u32 s66, s65
s_cbranch_scc0 pback_99
s_lshl_b32 s67, s67, 5
s_and_b32 s66, s33, 31
s_add_u32 s66, s66, s67
v_and_b32 v10, 15, v0
v_sub_u32 v10, s66, v10
v_lshrrev_b32 v11, 4, v0
v_lshlrev_b32 v11, 2, v11
v_sub_u32 v11, s66, v11
v_cmp_eq_u32 vcc, 0, v10
s_mov_b64 exec, vcc
ds_read_b128 v[16:19], v9 offset:3456
ds_read_b128 v[20:23], v9 offset:3520
ds_read_b128 v[80:83], v9 offset:3328
ds_read_b128 v[84:87], v9 offset:3392
s_mov_b64 exec, -1
v_cmp_eq_u32 vcc, 0, v11
s_mov_b64 exec, vcc
ds_read_b32 v48, v8 offset:3584
ds_read_b32 v52, v8 offset:3648
s_mov_b64 exec, -1
v_cmp_eq_u32 vcc, 1, v11
s_mov_b64 exec, vcc
ds_read_b32 v49, v8 offset:3584
ds_read_b32 v53, v8 offset:3648
s_mov_b64 exec, -1
v_cmp_eq_u32 vcc, 2, v11
s_mov_b64 exec, vcc
ds_read_b32 v50, v8 offset:3584
ds_read_b32 v54, v8 offset:3648
s_mov_b64 exec, -1
v_cmp_eq_u32 vcc, 3, v11
s_mov_b64 exec, vcc
ds_read_b32 v51, v8 offset:3584
ds_read_b32 v55, v8 offset:3648
s_mov_b64 exec, -1
s_waitcnt lgkmcnt(0)
v_cmp_eq_u32 vcc, 16, v10
s_mov_b64 exec, vcc
ds_read_b128 v[24:27], v9 offset:3456
ds_read_b128 v[28:31], v9 offset:3520
ds_read_b128 v[88:91], v9 offset:3328
ds_read_b128 v[92:95], v9 offset:3392
s_mov_b64 exec, -1
v_cmp_eq_u32 vcc, 16, v11
s_mov_b64 exec, vcc
ds_read_b32 v56, v8 offset:3584
ds_read_b32 v60, v8 offset:3648
s_mov_b64 exec, -1
v_cmp_eq_u32 vcc, 17, v11
s_mov_b64 exec, vcc
ds_read_b32 v57, v8 offset:3584
ds_read_b32 v61, v8 offset:3648
s_mov_b64 exec, -1
v_cmp_eq_u32 vcc, 18, v11
s_mov_b64 exec, vcc
ds_read_b32 v58, v8 offset:3584
ds_read_b32 v62, v8 offset:3648
s_mov_b64 exec, -1
v_cmp_eq_u32 vcc, 19, v11
s_mov_b64 exec, vcc
ds_read_b32 v59, v8 offset:3584
ds_read_b32 v63, v8 offset:3648
s_mov_b64 exec, -1
s_waitcnt lgkmcnt(0)
v_cmp_eq_u32 vcc, 32, v10
s_mov_b64 exec, vcc
ds_read_b128 v[32:35], v9 offset:3456
ds_read_b128 v[36:39], v9 offset:3520
ds_read_b128 v[96:99], v9 offset:3328
ds_read_b128 v[100:103], v9 offset:3392
s_mov_b64 exec, -1
v_cmp_eq_u32 vcc, 32, v11
s_mov_b64 exec, vcc
ds_read_b32 v64, v8 offset:3584
ds_read_b32 v68, v8 offset:3648
s_mov_b64 exec, -1
v_cmp_eq_u32 vcc, 33, v11
s_mov_b64 exec, vcc
ds_read_b32 v65, v8 offset:3584
ds_read_b32 v69, v8 offset:3648
s_mov_b64 exec, -1
v_cmp_eq_u32 vcc, 34, v11
s_mov_b64 exec, vcc
ds_read_b32 v66, v8 offset:3584
ds_read_b32 v70, v8 offset:3648
s_mov_b64 exec, -1
v_cmp_eq_u32 vcc, 35, v11
s_mov_b64 exec, vcc
ds_read_b32 v67, v8 offset:3584
ds_read_b32 v71, v8 offset:3648
s_mov_b64 exec, -1
s_waitcnt lgkmcnt(0)
v_cmp_eq_u32 vcc, 48, v10
s_mov_b64 exec, vcc
ds_read_b128 v[40:43], v9 offset:3456
ds_read_b128 v[44:47], v9 offset:3520
ds_read_b128 v[104:107], v9 offset:3328
ds_read_b128 v[108:111], v9 offset:3392
s_mov_b64 exec, -1
v_cmp_eq_u32 vcc, 48, v11
s_mov_b64 exec, vcc
ds_read_b32 v72, v8 offset:3584
ds_read_b32 v76, v8 offset:3648
s_mov_b64 exec, -1
v_cmp_eq_u32 vcc, 49, v11
s_mov_b64 exec, vcc
ds_read_b32 v73, v8 offset:3584
ds_read_b32 v77, v8 offset:3648
s_mov_b64 exec, -1
v_cmp_eq_u32 vcc, 50, v11
s_mov_b64 exec, vcc
ds_read_b32 v74, v8 offset:3584
ds_read_b32 v78, v8 offset:3648
s_mov_b64 exec, -1
v_cmp_eq_u32 vcc, 51, v11
s_mov_b64 exec, vcc
ds_read_b32 v75, v8 offset:3584
ds_read_b32 v79, v8 offset:3648
s_mov_b64 exec, -1
s_waitcnt lgkmcnt(0)
s_branch pback_99
cross_109:
s_cmp_eq_u32 s67, 122880
s_cbranch_scc0 cr2_129
v_add_u32 v5, s34, 18
s_mov_b64 exec, 1
ds_write_b32 v3, v5
s_mov_b64 exec, -1
s_add_u32 s70, s72, 360448
s_mov_b64 exec, 1
s_waitcnt vmcnt(0)
buffer_store_dword v5, v3, s[24:27], s70 offen sc1
s_mov_b64 exec, -1
v_mov_b32 v9, 0xf149f2ca
v_xor_b32 v216, v9, v216
v_xor_b32 v217, v9, v217
v_xor_b32 v218, v9, v218
v_xor_b32 v219, v9, v219
v_xor_b32 v220, v9, v220
v_xor_b32 v221, v9, v221
v_xor_b32 v222, v9, v222
v_xor_b32 v223, v9, v223
v_xor_b32 v224, v9, v224
v_xor_b32 v225, v9, v225
v_xor_b32 v226, v9, v226
v_xor_b32 v227, v9, v227
v_xor_b32 v228, v9, v228
v_xor_b32 v229, v9, v229
v_xor_b32 v230, v9, v230
v_xor_b32 v231, v9, v231
s_mov_b32 s67, 90112
s_cmp_eq_u32 s63, 0
s_cbranch_scc0 cr3_130
v_and_b32 v9, 15, v0
v_lshlrev_b32 v9, 11, v9
v_bfe_u32 v10, v0, 4, 1
v_lshl_add_u32 v9, v10, 5, v9
v_lshrrev_b32 v10, 5, v0
v_lshl_add_u32 v9, v10, 4, v9
s_lshl2_add_u32 s70, s61, s58
s_lshl_b32 s70, s70, 16
s_lshl_b32 s71, s62, 7
s_add_u32 s70, s70, s71
s_add_u32 s71, s70, 0x8000
buffer_load_dwordx4 v[240:243], v9, s[8:11], s70 offen offset:0
buffer_load_dwordx4 v[244:247], v9, s[8:11], s70 offen offset:64
buffer_load_dwordx4 v[248:251], v9, s[8:11], s71 offen offset:0
buffer_load_dwordx4 v[252:255], v9, s[8:11], s71 offen offset:64
cr3_130:
s_cmp_eq_u32 s59, 0
s_cbranch_scc1 cback_110
v_mov_b32 v9, 0
s_add_u32 s35, s34, 17
lw_131:
ds_read_b32 v5, v9 offset:16
s_waitcnt lgkmcnt(0)
v_cmp_gt_i32 vcc, s35, v5
s_cbranch_vccz lwd_132
s_sub_u32 s32, s32, 1
s_cmp_gt_i32 s32, 0
s_cbranch_scc1 lw_131
lwd_132:
s_branch cback_110
cr2_129:
v_add_u32 v5, s34, 19
s_mov_b64 exec, 1
ds_write_b32 v3, v5
s_mov_b64 exec, -1
s_mov_b32 s66, 28672
s_cmp_lt_u32 s59, 2
s_cbranch_scc1 cback_110
s_add_u32 s35, s34, 17
lw_133:
ds_read_b32 v5, v2 offset:16
s_waitcnt lgkmcnt(0)
v_cmp_gt_i32 vcc, s35, v5
s_cbranch_vccz lwd_134
s_sub_u32 s32, s32, 1
s_cmp_gt_i32 s32, 0
s_cbranch_scc1 lw_133
lwd_134:
s_branch cback_110
cross_111:
s_cmp_eq_u32 s67, 122880
s_cbranch_scc0 cr2_135
v_add_u32 v5, s34, 18
s_mov_b64 exec, 1
ds_write_b32 v3, v5
s_mov_b64 exec, -1
s_add_u32 s70, s72, 360448
s_mov_b64 exec, 1
s_waitcnt vmcnt(0)
buffer_store_dword v5, v3, s[24:27], s70 offen sc1
s_mov_b64 exec, -1
v_mov_b32 v9, 0xf149f2ca
v_xor_b32 v216, v9, v216
v_xor_b32 v217, v9, v217
v_xor_b32 v218, v9, v218
v_xor_b32 v219, v9, v219
v_xor_b32 v220, v9, v220
v_xor_b32 v221, v9, v221
v_xor_b32 v222, v9, v222
v_xor_b32 v223, v9, v223
v_xor_b32 v224, v9, v224
v_xor_b32 v225, v9, v225
v_xor_b32 v226, v9, v226
v_xor_b32 v227, v9, v227
v_xor_b32 v228, v9, v228
v_xor_b32 v229, v9, v229
v_xor_b32 v230, v9, v230
v_xor_b32 v231, v9, v231
s_mov_b32 s67, 90112
s_cmp_eq_u32 s63, 0
s_cbranch_scc0 cr3_136
v_and_b32 v9, 15, v0
v_lshlrev_b32 v9, 11, v9
v_bfe_u32 v10, v0, 4, 1
v_lshl_add_u32 v9, v10, 5, v9
v_lshrrev_b32 v10, 5, v0
v_lshl_add_u32 v9, v10, 4, v9
s_lshl2_add_u32 s70, s61, s58
s_lshl_b32 s70, s70, 16
s_lshl_b32 s71, s62, 7
s_add_u32 s70, s70, s71
s_add_u32 s71, s70, 0x8000
buffer_load_dwordx4 v[240:243], v9, s[8:11], s70 offen offset:0
buffer_load_dwordx4 v[244:247], v9, s[8:11], s70 offen offset:64
buffer_load_dwordx4 v[248:251], v9, s[8:11], s71 offen offset:0
buffer_load_dwordx4 v[252:255], v9, s[8:11], s71 offen offset:64
cr3_136:
s_cmp_eq_u32 s59, 0
s_cbranch_scc1 cback_112
v_mov_b32 v9, 0
s_add_u32 s35, s34, 17
lw_137:
ds_read_b32 v5, v9 offset:16
s_waitcnt lgkmcnt(0)
v_cmp_gt_i32 vcc, s35, v5
s_cbranch_vccz lwd_138
s_sub_u32 s32, s32, 1
s_cmp_gt_i32 s32, 0
s_cbranch_scc1 lw_137
lwd_138:
s_branch cback_112
cr2_135:
v_add_u32 v5, s34, 19
s_mov_b64 exec, 1
ds_write_b32 v3, v5
s_mov_b64 exec, -1
s_mov_b32 s66, 28672
s_cmp_lt_u32 s59, 2
s_cbranch_scc1 cback_112
s_add_u32 s35, s34, 17
lw_139:
ds_read_b32 v5, v2 offset:16
s_waitcnt lgkmcnt(0)
v_cmp_gt_i32 vcc, s35, v5
s_cbranch_vccz lwd_140
s_sub_u32 s32, s32, 1
s_cmp_gt_i32 s32, 0
s_cbranch_scc1 lw_139
lwd_140:
s_branch cback_112
slow_113:
s_add_u32 s70, s72, 360448
poll_141:
buffer_load_dword v10, v1, s[24:27], s70 offen sc1
pchk_142:
s_waitcnt vmcnt(0)
v_cmp_eq_u32 vcc, 0, v10
s_cbranch_vccz pdone_143
s_sub_u32 s32, s32, 1
s_cmp_gt_i32 s32, 0
s_cbranch_scc1 poll_141
pdone_143:
s_lshl_b32 s73, s60, 15
s_lshl_b32 s74, s63, 23
s_add_u32 s73, s73, s74
s_add_u32 s73, s73, 1048576
v_mov_b32 v10, 0xf149f2ca
v_mov_b32 v11, 0
v_mov_b32 v192, 0
v_mov_b32 v193, 0
v_mov_b32 v194, 0
v_mov_b32 v195, 0
v_mov_b32 v196, 0
v_mov_b32 v197, 0
v_mov_b32 v198, 0
v_mov_b32 v199, 0
v_mov_b32 v200, 0
v_mov_b32 v201, 0
v_mov_b32 v202, 0
v_mov_b32 v203, 0
v_mov_b32 v204, 0
v_mov_b32 v205, 0
v_mov_b32 v206, 0
v_mov_b32 v207, 0
v_mov_b32 v208, 0
v_mov_b32 v209, 0
v_mov_b32 v210, 0
v_mov_b32 v211, 0
s_lshl2_add_u32 s74, s59, s65
s_mov_b32 s75, 0
sl_144:
s_lshr_b32 s76, s74, 2
s_lshl_b32 s76, s76, 19
s_and_b32 s77, s74, 3
s_lshl_b32 s77, s77, 13
s_add_u32 s76, s76, s77
s_add_u32 s76, s76, s73
buffer_load_dwordx4 v[152:155], v6, s[20:23], s76 offen offset:0 sc1
buffer_load_dwordx4 v[156:159], v6, s[20:23], s76 offen offset:1024 sc1
s_cmp_eq_u32 s75, 0
s_cselect_b32 s76, 0xf149f2ca, 0
s_and_b32 s77, s75, 7
s_cselect_b32 s77, 0, -1
v_xor_b32 v112, s76, v216
v_and_b32 v112, s77, v112
v_xor_b32 v113, s76, v217
v_and_b32 v113, s77, v113
v_xor_b32 v114, s76, v218
v_and_b32 v114, s77, v114
v_xor_b32 v115, s76, v219
v_and_b32 v115, s77, v115
v_xor_b32 v116, s76, v220
v_and_b32 v116, s77, v116
v_xor_b32 v117, s76, v221
v_and_b32 v117, s77, v117
v_xor_b32 v118, s76, v222
v_and_b32 v118, s77, v118
v_xor_b32 v119, s76, v223
v_and_b32 v119, s77, v119
v_xor_b32 v120, s76, v224
v_and_b32 v120, s77, v120
v_xor_b32 v121, s76, v225
v_and_b32 v121, s77, v121
v_xor_b32 v122, s76, v226
v_and_b32 v122, s77, v122
v_xor_b32 v123, s76, v227
v_and_b32 v123, s77, v123
v_xor_b32 v124, s76, v228
v_and_b32 v124, s77, v124
v_xor_b32 v125, s76, v229
v_and_b32 v125, s77, v125
v_xor_b32 v126, s76, v230
v_and_b32 v126, s77, v126
v_xor_b32 v127, s76, v231
v_and_b32 v127, s77, v127
s_waitcnt vmcnt(1)
s_nop 0
v_mfma_f32_32x32x16_bf16 v[112:127], v[152:155], v[80:83], v[112:127]
s_waitcnt vmcnt(0)
v_mfma_f32_32x32x16_bf16 v[112:127], v[156:159], v[88:91], v[112:127]
s_nop 11
v_max3_f32 v10, v10, v112, v113
v_max3_f32 v10, v10, v114, v115
v_max3_f32 v10, v10, v116, v117
v_max3_f32 v10, v10, v118, v119
v_max3_f32 v10, v10, v120, v121
v_max3_f32 v10, v10, v122, v123
v_max3_f32 v10, v10, v124, v125
v_max3_f32 v10, v10, v126, v127
s_add_u32 s75, s75, 1
s_sub_u32 s74, s74, 1
s_cselect_b32 s75, 9, s75
s_cmp_lt_u32 s75, 9
s_cbranch_scc1 sl_144
v_mov_b32 v11, v10
s_nop 1
v_permlane32_swap_b32 v11, v10
v_max_f32 v10, v10, v11
s_lshl2_add_u32 s74, s59, s65
s_mov_b32 s75, 0
sl_145:
s_lshr_b32 s76, s74, 2
s_lshl_b32 s76, s76, 19
s_and_b32 s77, s74, 3
s_lshl_b32 s77, s77, 13
s_add_u32 s76, s76, s77
s_add_u32 s76, s76, s73
buffer_load_dwordx4 v[152:155], v6, s[20:23], s76 offen offset:0 sc1
buffer_load_dwordx4 v[156:159], v6, s[20:23], s76 offen offset:1024 sc1
buffer_load_dwordx4 v[160:163], v6, s[20:23], s76 offen offset:2048 sc1
buffer_load_dwordx4 v[164:167], v6, s[20:23], s76 offen offset:3072 sc1
s_cmp_eq_u32 s75, 0
s_cselect_b32 s76, 0xf149f2ca, 0
s_and_b32 s77, s75, 7
s_cselect_b32 s77, 0, -1
v_xor_b32 v112, s76, v216
v_and_b32 v112, s77, v112
v_sub_f32 v112, v112, v10
v_xor_b32 v113, s76, v217
v_and_b32 v113, s77, v113
v_sub_f32 v113, v113, v10
v_xor_b32 v114, s76, v218
v_and_b32 v114, s77, v114
v_sub_f32 v114, v114, v10
v_xor_b32 v115, s76, v219
v_and_b32 v115, s77, v115
v_sub_f32 v115, v115, v10
v_xor_b32 v116, s76, v220
v_and_b32 v116, s77, v116
v_sub_f32 v116, v116, v10
v_xor_b32 v117, s76, v221
v_and_b32 v117, s77, v117
v_sub_f32 v117, v117, v10
v_xor_b32 v118, s76, v222
v_and_b32 v118, s77, v118
v_sub_f32 v118, v118, v10
v_xor_b32 v119, s76, v223
v_and_b32 v119, s77, v119
v_sub_f32 v119, v119, v10
v_xor_b32 v120, s76, v224
v_and_b32 v120, s77, v120
v_sub_f32 v120, v120, v10
v_xor_b32 v121, s76, v225
v_and_b32 v121, s77, v121
v_sub_f32 v121, v121, v10
v_xor_b32 v122, s76, v226
v_and_b32 v122, s77, v122
v_sub_f32 v122, v122, v10
v_xor_b32 v123, s76, v227
v_and_b32 v123, s77, v123
v_sub_f32 v123, v123, v10
v_xor_b32 v124, s76, v228
v_and_b32 v124, s77, v124
v_sub_f32 v124, v124, v10
v_xor_b32 v125, s76, v229
v_and_b32 v125, s77, v125
v_sub_f32 v125, v125, v10
v_xor_b32 v126, s76, v230
v_and_b32 v126, s77, v126
v_sub_f32 v126, v126, v10
v_xor_b32 v127, s76, v231
v_and_b32 v127, s77, v127
v_sub_f32 v127, v127, v10
s_waitcnt vmcnt(3)
s_nop 0
v_mfma_f32_32x32x16_bf16 v[112:127], v[152:155], v[80:83], v[112:127]
s_waitcnt vmcnt(2)
v_mfma_f32_32x32x16_bf16 v[112:127], v[156:159], v[88:91], v[112:127]
s_nop 11
v_exp_f32 v112, v112
v_exp_f32 v113, v113
v_exp_f32 v114, v114
v_exp_f32 v115, v115
v_exp_f32 v116, v116
v_exp_f32 v117, v117
v_exp_f32 v118, v118
v_exp_f32 v119, v119
v_exp_f32 v120, v120
v_exp_f32 v121, v121
v_exp_f32 v122, v122
v_exp_f32 v123, v123
v_exp_f32 v124, v124
v_exp_f32 v125, v125
v_exp_f32 v126, v126
v_exp_f32 v127, v127
v_cvt_pk_bf16_f32 v144, v112, v113
v_cvt_pk_bf16_f32 v145, v114, v115
v_cvt_pk_bf16_f32 v146, v116, v117
v_cvt_pk_bf16_f32 v147, v118, v119
v_cvt_pk_bf16_f32 v148, v120, v121
v_cvt_pk_bf16_f32 v149, v122, v123
v_cvt_pk_bf16_f32 v150, v124, v125
v_cvt_pk_bf16_f32 v151, v126, v127
s_waitcnt vmcnt(1)
v_mfma_f32_32x32x16_bf16 v[192:207], v[160:163], v[144:147], v[192:207]
v_mfma_f32_16x16x32_bf16 v[208:211], v[212:215], v[144:147], v[208:211]
s_waitcnt vmcnt(0)
v_mfma_f32_32x32x16_bf16 v[192:207], v[164:167], v[148:151], v[192:207]
v_mfma_f32_16x16x32_bf16 v[208:211], v[212:215], v[148:151], v[208:211]
s_add_u32 s75, s75, 1
s_sub_u32 s74, s74, 1
s_cselect_b32 s75, 9, s75
s_cmp_lt_u32 s75, 9
s_cbranch_scc1 sl_145
v_mov_b32 v10, 0xf149f2ca
v_mov_b32 v11, 0
v_mov_b32 v16, 0
v_mov_b32 v17, 0
v_mov_b32 v18, 0
v_mov_b32 v19, 0
v_mov_b32 v20, 0
v_mov_b32 v21, 0
v_mov_b32 v22, 0
v_mov_b32 v23, 0
v_mov_b32 v24, 0
v_mov_b32 v25, 0
v_mov_b32 v26, 0
v_mov_b32 v27, 0
v_mov_b32 v28, 0
v_mov_b32 v29, 0
v_mov_b32 v30, 0
v_mov_b32 v31, 0
v_mov_b32 v32, 0
v_mov_b32 v33, 0
v_mov_b32 v34, 0
v_mov_b32 v35, 0
s_sub_u32 s74, 3, s65
s_lshl2_add_u32 s74, s59, s74
s_mov_b32 s75, 0
sl_146:
s_lshr_b32 s76, s74, 2
s_lshl_b32 s76, s76, 19
s_and_b32 s77, s74, 3
s_lshl_b32 s77, s77, 13
s_add_u32 s76, s76, s77
s_add_u32 s76, s76, s73
buffer_load_dwordx4 v[152:155], v6, s[20:23], s76 offen offset:0 sc1
buffer_load_dwordx4 v[156:159], v6, s[20:23], s76 offen offset:1024 sc1
s_cmp_eq_u32 s75, 0
s_cselect_b32 s76, 0xf149f2ca, 0
s_and_b32 s77, s75, 7
s_cselect_b32 s77, 0, -1
v_xor_b32 v112, s76, v216
v_and_b32 v112, s77, v112
v_xor_b32 v113, s76, v217
v_and_b32 v113, s77, v113
v_xor_b32 v114, s76, v218
v_and_b32 v114, s77, v114
v_xor_b32 v115, s76, v219
v_and_b32 v115, s77, v115
v_xor_b32 v116, s76, v220
v_and_b32 v116, s77, v116
v_xor_b32 v117, s76, v221
v_and_b32 v117, s77, v117
v_xor_b32 v118, s76, v222
v_and_b32 v118, s77, v118
v_xor_b32 v119, s76, v223
v_and_b32 v119, s77, v119
v_xor_b32 v120, s76, v224
v_and_b32 v120, s77, v120
v_xor_b32 v121, s76, v225
v_and_b32 v121, s77, v121
v_xor_b32 v122, s76, v226
v_and_b32 v122, s77, v122
v_xor_b32 v123, s76, v227
v_and_b32 v123, s77, v123
v_xor_b32 v124, s76, v228
v_and_b32 v124, s77, v124
v_xor_b32 v125, s76, v229
v_and_b32 v125, s77, v125
v_xor_b32 v126, s76, v230
v_and_b32 v126, s77, v126
v_xor_b32 v127, s76, v231
v_and_b32 v127, s77, v127
s_waitcnt vmcnt(1)
s_nop 0
v_mfma_f32_32x32x16_bf16 v[112:127], v[152:155], v[96:99], v[112:127]
s_waitcnt vmcnt(0)
v_mfma_f32_32x32x16_bf16 v[112:127], v[156:159], v[104:107], v[112:127]
s_nop 11
v_max3_f32 v10, v10, v112, v113
v_max3_f32 v10, v10, v114, v115
v_max3_f32 v10, v10, v116, v117
v_max3_f32 v10, v10, v118, v119
v_max3_f32 v10, v10, v120, v121
v_max3_f32 v10, v10, v122, v123
v_max3_f32 v10, v10, v124, v125
v_max3_f32 v10, v10, v126, v127
s_add_u32 s75, s75, 1
s_sub_u32 s74, s74, 1
s_cselect_b32 s75, 9, s75
s_cmp_lt_u32 s75, 9
s_cbranch_scc1 sl_146
v_mov_b32 v11, v10
s_nop 1
v_permlane32_swap_b32 v11, v10
v_max_f32 v10, v10, v11
s_sub_u32 s74, 3, s65
s_lshl2_add_u32 s74, s59, s74
s_mov_b32 s75, 0
sl_147:
s_lshr_b32 s76, s74, 2
s_lshl_b32 s76, s76, 19
s_and_b32 s77, s74, 3
s_lshl_b32 s77, s77, 13
s_add_u32 s76, s76, s77
s_add_u32 s76, s76, s73
buffer_load_dwordx4 v[152:155], v6, s[20:23], s76 offen offset:0 sc1
buffer_load_dwordx4 v[156:159], v6, s[20:23], s76 offen offset:1024 sc1
buffer_load_dwordx4 v[160:163], v6, s[20:23], s76 offen offset:2048 sc1
buffer_load_dwordx4 v[164:167], v6, s[20:23], s76 offen offset:3072 sc1
s_cmp_eq_u32 s75, 0
s_cselect_b32 s76, 0xf149f2ca, 0
s_and_b32 s77, s75, 7
s_cselect_b32 s77, 0, -1
v_xor_b32 v112, s76, v216
v_and_b32 v112, s77, v112
v_sub_f32 v112, v112, v10
v_xor_b32 v113, s76, v217
v_and_b32 v113, s77, v113
v_sub_f32 v113, v113, v10
v_xor_b32 v114, s76, v218
v_and_b32 v114, s77, v114
v_sub_f32 v114, v114, v10
v_xor_b32 v115, s76, v219
v_and_b32 v115, s77, v115
v_sub_f32 v115, v115, v10
v_xor_b32 v116, s76, v220
v_and_b32 v116, s77, v116
v_sub_f32 v116, v116, v10
v_xor_b32 v117, s76, v221
v_and_b32 v117, s77, v117
v_sub_f32 v117, v117, v10
v_xor_b32 v118, s76, v222
v_and_b32 v118, s77, v118
v_sub_f32 v118, v118, v10
v_xor_b32 v119, s76, v223
v_and_b32 v119, s77, v119
v_sub_f32 v119, v119, v10
v_xor_b32 v120, s76, v224
v_and_b32 v120, s77, v120
v_sub_f32 v120, v120, v10
v_xor_b32 v121, s76, v225
v_and_b32 v121, s77, v121
v_sub_f32 v121, v121, v10
v_xor_b32 v122, s76, v226
v_and_b32 v122, s77, v122
v_sub_f32 v122, v122, v10
v_xor_b32 v123, s76, v227
v_and_b32 v123, s77, v123
v_sub_f32 v123, v123, v10
v_xor_b32 v124, s76, v228
v_and_b32 v124, s77, v124
v_sub_f32 v124, v124, v10
v_xor_b32 v125, s76, v229
v_and_b32 v125, s77, v125
v_sub_f32 v125, v125, v10
v_xor_b32 v126, s76, v230
v_and_b32 v126, s77, v126
v_sub_f32 v126, v126, v10
v_xor_b32 v127, s76, v231
v_and_b32 v127, s77, v127
v_sub_f32 v127, v127, v10
s_waitcnt vmcnt(3)
s_nop 0
v_mfma_f32_32x32x16_bf16 v[112:127], v[152:155], v[96:99], v[112:127]
s_waitcnt vmcnt(2)
v_mfma_f32_32x32x16_bf16 v[112:127], v[156:159], v[104:107], v[112:127]
s_nop 11
v_exp_f32 v112, v112
v_exp_f32 v113, v113
v_exp_f32 v114, v114
v_exp_f32 v115, v115
v_exp_f32 v116, v116
v_exp_f32 v117, v117
v_exp_f32 v118, v118
v_exp_f32 v119, v119
v_exp_f32 v120, v120
v_exp_f32 v121, v121
v_exp_f32 v122, v122
v_exp_f32 v123, v123
v_exp_f32 v124, v124
v_exp_f32 v125, v125
v_exp_f32 v126, v126
v_exp_f32 v127, v127
v_cvt_pk_bf16_f32 v144, v112, v113
v_cvt_pk_bf16_f32 v145, v114, v115
v_cvt_pk_bf16_f32 v146, v116, v117
v_cvt_pk_bf16_f32 v147, v118, v119
v_cvt_pk_bf16_f32 v148, v120, v121
v_cvt_pk_bf16_f32 v149, v122, v123
v_cvt_pk_bf16_f32 v150, v124, v125
v_cvt_pk_bf16_f32 v151, v126, v127
s_waitcnt vmcnt(1)
v_mfma_f32_32x32x16_bf16 v[16:31], v[160:163], v[144:147], v[16:31]
v_mfma_f32_16x16x32_bf16 v[32:35], v[212:215], v[144:147], v[32:35]
s_waitcnt vmcnt(0)
v_mfma_f32_32x32x16_bf16 v[16:31], v[164:167], v[148:151], v[16:31]
v_mfma_f32_16x16x32_bf16 v[32:35], v[212:215], v[148:151], v[32:35]
s_add_u32 s75, s75, 1
s_sub_u32 s74, s74, 1
s_cselect_b32 s75, 9, s75
s_cmp_lt_u32 s75, 9
s_cbranch_scc1 sl_147
s_branch sback_114
mo_115:
s_lshr_b32 s67, s33, 5
s_cmp_eq_u32 s67, s66
s_cbranch_scc0 mo_116
s_and_b32 s67, s33, 31
v_sub_u32 v48, s67, v48
v_lshlrev_b32 v49, 7, v49
s_lshl_b32 s67, s62, 11
s_add_u32 s67, s67, 33325056
poll_148:
buffer_load_dwordx2 v[56:57], v49, s[20:23], s67 offen offset:0 sc1
buffer_load_dwordx2 v[58:59], v49, s[20:23], s67 offen offset:512 sc1
buffer_load_dwordx2 v[60:61], v49, s[20:23], s67 offen offset:1024 sc1
buffer_load_dwordx2 v[62:63], v49, s[20:23], s67 offen offset:1536 sc1
pchk_149:
s_waitcnt vmcnt(2)
v_min3_u32 v50, v56, v57, v58
s_waitcnt vmcnt(1)
v_min3_u32 v50, v50, v59, v60
s_waitcnt vmcnt(0)
v_min3_u32 v50, v50, v61, v62
v_min_u32 v50, v50, v63
v_cmp_eq_u32 vcc, 0, v50
s_cbranch_vccz pdone_150
s_sub_u32 s32, s32, 1
s_cmp_gt_i32 s32, 0
s_cbranch_scc1 poll_148
pdone_150:
v_cmp_eq_u32 vcc, 0, v48
s_nop 1
v_cndmask_b32 v240, v240, v56, vcc
v_cndmask_b32 v241, v241, v57, vcc
v_cndmask_b32 v242, v242, v58, vcc
v_cndmask_b32 v243, v243, v59, vcc
v_cndmask_b32 v244, v244, v60, vcc
v_cndmask_b32 v245, v245, v61, vcc
v_cndmask_b32 v246, v246, v62, vcc
v_cndmask_b32 v247, v247, v63, vcc
v_cmp_eq_u32 vcc, 16, v48
s_nop 1
v_cndmask_b32 v248, v248, v56, vcc
v_cndmask_b32 v249, v249, v57, vcc
v_cndmask_b32 v250, v250, v58, vcc
v_cndmask_b32 v251, v251, v59, vcc
v_cndmask_b32 v252, v252, v60, vcc
v_cndmask_b32 v253, v253, v61, vcc
v_cndmask_b32 v254, v254, v62, vcc
v_cndmask_b32 v255, v255, v63, vcc
s_branch mo_116
L_end:
L_fin:
s_endpgm
.section .rodata,"a"
.p2align 6
.amdhsa_kernel interleave_layers__sliding_block__moe_arch_mod__prompt_kernel
  .amdhsa_next_free_vgpr 256
  .amdhsa_next_free_sgpr 102
  .amdhsa_accum_offset 256
  .amdhsa_group_segment_fixed_size 0
  .amdhsa_kernarg_size 88
  .amdhsa_user_sgpr_count 2
  .amdhsa_user_sgpr_kernarg_segment_ptr 1
  .amdhsa_system_sgpr_workgroup_id_x 1
  .amdhsa_float_denorm_mode_32 3
.end_amdhsa_kernel
```

```asm
; @launch grid=(256,1,1) block=(512,1,1) lds=163840
.amdgcn_target "amdgcn-amd-amdhsa--gfx950"
.text
.globl interleave_layers__sliding_block__moe_arch_mod__prompt_kernel
.p2align 8
.type interleave_layers__sliding_block__moe_arch_mod__prompt_kernel,@function
interleave_layers__sliding_block__moe_arch_mod__prompt_kernel:
s_cmp_ge_u32 s2, 256
s_cbranch_scc1 L_fin
s_load_dwordx16 s[36:51], s[0:1], 0
s_load_dwordx4 s[52:55], s[0:1], 64
s_load_dwordx2 s[56:57], s[0:1], 80
v_lshrrev_b32 v1, 6, v0
v_and_b32 v0, 63, v0
s_and_b32 s64, s2, 7
v_readfirstlane_b32 s3, v1
s_lshr_b32 s65, s2, 3
s_and_b32 s66, s65, 7
s_and_b32 s67, s64, 1
s_lshl3_add_u32 s59, s67, s66
s_lshr_b32 s66, s65, 3
s_lshr_b32 s67, s64, 1
s_lshl2_add_u32 s60, s67, s66
s_and_b32 s66, s65, 1
s_lshl1_add_u32 s61, s64, s66
s_lshr_b32 s62, s65, 1
s_mov_b32 s63, 0
s_mov_b32 s34, 0
s_mov_b32 s32, 200000
s_mov_b32 s33, -1
s_cmp_ge_u32 s3, 4
s_cselect_b32 s66, 3, 1
s_and_b32 s58, s3, s66
s_waitcnt lgkmcnt(0)
s_mov_b32 s8, s36
s_mov_b32 s9, s37
s_mov_b32 s10, 0x400000
s_mov_b32 s11, 0x00020000
s_mov_b32 s12, s38
s_mov_b32 s13, s39
s_mov_b32 s14, 0x600000
s_mov_b32 s15, 0x00020000
s_mov_b32 s16, s40
s_mov_b32 s17, s41
s_mov_b32 s18, 0x200000
s_mov_b32 s19, 0x00020000
s_mov_b32 s20, s56
s_mov_b32 s21, s57
s_mov_b32 s22, 0x2500000
s_mov_b32 s23, 0x00020000
s_add_u32 s24, s56, 30408704
s_addc_u32 s25, s57, 0
s_mov_b32 s26, 2818048
s_mov_b32 s27, 0x00020000
s_mov_b32 s28, s52
s_mov_b32 s29, s53
s_mov_b32 s30, 0x400000
s_mov_b32 s31, 0x00020000
s_cmp_ge_u32 s3, 4
s_cbranch_scc1 L_m
s_cmp_ge_u32 s3, 2
s_cbranch_scc1 L_f
s_setprio 1
v_and_b32 v22, 7, v0
v_lshrrev_b32 v23, 4, v0
v_lshrrev_b32 v6, 3, v0
v_xor_b32 v7, v22, v23
v_lshlrev_b32 v7, 4, v7
v_lshl_add_u32 v8, v6, 11, v7
v_xor_b32 v7, 64, v8
v_add_u32 v9, 15360, v7
v_add_u32 v10, 30720, v8
v_add_u32 v11, 46080, v7
s_lshl_b32 s70, s59, 18
s_lshl_b32 s71, s58, 16
s_add_u32 s68, s70, s71
s_sub_u32 s69, s70, s71
s_add_u32 s69, s69, 196608
s_mov_b32 s67, 128
s_lshl_b32 s75, s58, 13
s_mov_b32 s65, 86016
s_lshr_b32 s70, s59, 3
s_lshl1_add_u32 s70, s59, s70
s_lshr_b32 s71, s60, 2
s_lshl2_add_u32 s71, s60, s71
s_add_u32 s70, s70, s71
s_and_b32 s64, s70, 15
s_mul_i32 s70, s64, s67
s_add_u32 m0, s65, s75
s_add_u32 s71, s70, s68
buffer_load_dwordx4 v8, s[8:11], s71 offen offset:0 lds
buffer_load_dwordx4 v9, s[8:11], s71 offen offset:1024 lds
buffer_load_dwordx4 v10, s[8:11], s71 offen offset:2048 lds
buffer_load_dwordx4 v11, s[8:11], s71 offen offset:3072 lds
s_add_u32 m0, m0, 4096
s_add_u32 s71, s70, s69
buffer_load_dwordx4 v8, s[8:11], s71 offen offset:0 lds
buffer_load_dwordx4 v9, s[8:11], s71 offen offset:1024 lds
buffer_load_dwordx4 v10, s[8:11], s71 offen offset:2048 lds
buffer_load_dwordx4 v11, s[8:11], s71 offen offset:3072 lds
v_and_b32 v7, 2, v6
v_xor_b32 v7, v7, v22
v_mul_u32_u24 v6, 6144, v6
v_lshl_add_u32 v12, v7, 4, v6
v_xor_b32 v6, 64, v12
v_add_u32 v13, 48128, v6
v_add_u32 v14, 96256, v12
v_add_u32 v15, 144384, v6
s_mul_i32 s76, s58, 12288
s_add_u32 s76, s76, 16384
s_lshl_b32 s70, s60, 7
s_cmp_eq_u32 s58, 0
s_mov_b32 s71, 198656
s_cselect_b32 s72, 0, s71
s_mov_b32 s71, 4096
s_cselect_b32 s73, 196608, s71
s_mov_b32 s71, 200704
s_cselect_b32 s74, 2048, s71
s_add_u32 s72, s72, s70
s_add_u32 s73, s73, s70
s_add_u32 s74, s74, s70
s_mul_i32 s70, s64, 393216
s_add_u32 m0, s65, s76
s_add_u32 s71, s70, s72
buffer_load_dwordx4 v12, s[12:15], s71 offen offset:0 lds
buffer_load_dwordx4 v13, s[12:15], s71 offen offset:1024 lds
buffer_load_dwordx4 v14, s[12:15], s71 offen offset:2048 lds
buffer_load_dwordx4 v15, s[12:15], s71 offen offset:3072 lds
s_add_u32 m0, m0, 4096
s_add_u32 s71, s70, s73
buffer_load_dwordx4 v12, s[12:15], s71 offen offset:0 lds
buffer_load_dwordx4 v13, s[12:15], s71 offen offset:1024 lds
buffer_load_dwordx4 v14, s[12:15], s71 offen offset:2048 lds
buffer_load_dwordx4 v15, s[12:15], s71 offen offset:3072 lds
s_add_u32 m0, m0, 4096
s_add_u32 s71, s70, s74
buffer_load_dwordx4 v12, s[12:15], s71 offen offset:0 lds
buffer_load_dwordx4 v13, s[12:15], s71 offen offset:1024 lds
buffer_load_dwordx4 v14, s[12:15], s71 offen offset:2048 lds
buffer_load_dwordx4 v15, s[12:15], s71 offen offset:3072 lds
s_add_u32 s64, s64, 1
s_and_b32 s64, s64, 15
s_sub_u32 s65, s65, 40960
s_cselect_b32 s65, 86016, s65
v_and_b32 v1, 3, v0
v_lshlrev_b32 v1, 2, v1
v_and_b32 v2, 4, v1
s_lshl2_add_u32 s35, s58, 16
v_mov_b32 v3, s35
v_lshlrev_b32 v20, 4, v0
v_lshrrev_b32 v6, 2, v0
v_lshl_add_u32 v21, v6, 7, v1
v_lshrrev_b32 v6, 3, v0
v_lshlrev_b32 v23, 1, v23
v_xor_b32 v23, v23, v22
v_lshlrev_b32 v23, 4, v23
v_lshl_add_u32 v23, v6, 11, v23
s_lshl_b32 s70, s62, 7
s_lshl_b32 s71, s58, 16
s_add_u32 s70, s70, s71
v_add_u32 v16, s70, v23
v_add_u32 v17, 15360, v16
v_add_u32 v18, 30720, v16
v_add_u32 v19, 46080, v16
s_add_u32 s77, s61, s62
s_lshl_b32 s77, s77, 17
s_lshl_b32 s78, s58, 12
s_mov_b32 s66, -2
s_barrier
.p2align 4
lq_1:
s_add_u32 s35, s66, 1
lw_4:
ds_read_b32 v5, v1 offset:0
s_waitcnt lgkmcnt(0)
v_cmp_gt_i32 vcc, s35, v5
s_cbranch_vccz lwd_5
s_sub_u32 s32, s32, 1
s_cmp_gt_i32 s32, 0
s_cbranch_scc1 lw_4
lwd_5:
s_cmp_eq_u32 s66, 0
s_cbranch_scc1 lcs_2
lcb_3:
s_mul_i32 s70, s64, s67
s_add_u32 m0, s65, s75
s_add_u32 s71, s70, s68
buffer_load_dwordx4 v8, s[8:11], s71 offen offset:0 sc1 lds
buffer_load_dwordx4 v9, s[8:11], s71 offen offset:1024 sc1 lds
buffer_load_dwordx4 v10, s[8:11], s71 offen offset:2048 sc1 lds
buffer_load_dwordx4 v11, s[8:11], s71 offen offset:3072 sc1 lds
buffer_load_dword v30, off, s[12:15], 0
s_add_u32 m0, m0, 4096
s_add_u32 s71, s70, s69
buffer_load_dwordx4 v8, s[8:11], s71 offen offset:0 sc1 lds
buffer_load_dwordx4 v9, s[8:11], s71 offen offset:1024 sc1 lds
buffer_load_dwordx4 v10, s[8:11], s71 offen offset:2048 sc1 lds
buffer_load_dwordx4 v11, s[8:11], s71 offen offset:3072 sc1 lds
buffer_load_dword v30, off, s[12:15], 0
s_mul_i32 s70, s64, 393216
s_add_u32 m0, s65, s76
s_add_u32 s71, s70, s72
buffer_load_dwordx4 v12, s[12:15], s71 offen offset:0 lds
buffer_load_dwordx4 v13, s[12:15], s71 offen offset:1024 lds
buffer_load_dwordx4 v14, s[12:15], s71 offen offset:2048 lds
buffer_load_dwordx4 v15, s[12:15], s71 offen offset:3072 lds
buffer_load_dword v30, off, s[12:15], 0
v_add_u32 v5, s66, 3
s_mov_b64 exec, 1
s_waitcnt vmcnt(15)
ds_write_b32 v3, v5
s_mov_b64 exec, -1
s_mul_i32 s70, s64, 393216
s_add_u32 m0, m0, 4096
s_add_u32 s71, s70, s73
buffer_load_dwordx4 v12, s[12:15], s71 offen offset:0 lds
buffer_load_dwordx4 v13, s[12:15], s71 offen offset:1024 lds
buffer_load_dwordx4 v14, s[12:15], s71 offen offset:2048 lds
buffer_load_dwordx4 v15, s[12:15], s71 offen offset:3072 lds
buffer_load_dword v30, off, s[12:15], 0
s_mul_i32 s70, s64, 393216
s_add_u32 m0, m0, 4096
s_add_u32 s71, s70, s74
buffer_load_dwordx4 v12, s[12:15], s71 offen offset:0 lds
buffer_load_dwordx4 v13, s[12:15], s71 offen offset:1024 lds
buffer_load_dwordx4 v14, s[12:15], s71 offen offset:2048 lds
buffer_load_dwordx4 v15, s[12:15], s71 offen offset:3072 lds
buffer_load_dword v30, off, s[12:15], 0
s_add_u32 s64, s64, 1
s_and_b32 s64, s64, 15
s_sub_u32 s65, s65, 40960
s_cselect_b32 s65, 86016, s65
s_add_u32 s66, s66, 1
s_and_b32 s70, s66, 31
s_cmp_eq_u32 s70, 13
s_cbranch_scc0 lq_1
s_waitcnt vmcnt(0)
v_add_u32 v5, s34, 16
s_mov_b64 exec, 1
ds_write_b32 v3, v5
s_mov_b64 exec, -1
s_add_u32 s35, s34, 14
lw_6:
ds_read_b32 v5, v1 offset:0
s_waitcnt lgkmcnt(0)
v_cmp_gt_i32 vcc, s35, v5
s_cbranch_vccz lwd_7
s_sleep 1
s_sub_u32 s32, s32, 1
s_cmp_gt_i32 s32, 0
s_cbranch_scc1 lw_6
lwd_7:
s_add_u32 s70, s77, 262144
s_add_u32 m0, s78, 49152
s_and_b32 s70, s70, 0x1fffff
buffer_load_dwordx4 v16, s[16:19], s70 offen offset:0 lds
buffer_load_dwordx4 v17, s[16:19], s70 offen offset:1024 lds
buffer_load_dwordx4 v18, s[16:19], s70 offen offset:2048 lds
buffer_load_dwordx4 v19, s[16:19], s70 offen offset:3072 lds
buffer_load_dword v30, off, s[12:15], 0
s_add_u32 s70, s77, 393216
s_add_u32 m0, s78, 57344
s_and_b32 s70, s70, 0x1fffff
buffer_load_dwordx4 v16, s[16:19], s70 offen offset:0 lds
buffer_load_dwordx4 v17, s[16:19], s70 offen offset:1024 lds
buffer_load_dwordx4 v18, s[16:19], s70 offen offset:2048 lds
buffer_load_dwordx4 v19, s[16:19], s70 offen offset:3072 lds
buffer_load_dword v30, off, s[12:15], 0
s_add_u32 s70, s77, 524288
s_add_u32 m0, s78, 65536
s_and_b32 s70, s70, 0x1fffff
buffer_load_dwordx4 v16, s[16:19], s70 offen offset:0 lds
buffer_load_dwordx4 v17, s[16:19], s70 offen offset:1024 lds
buffer_load_dwordx4 v18, s[16:19], s70 offen offset:2048 lds
buffer_load_dwordx4 v19, s[16:19], s70 offen offset:3072 lds
buffer_load_dword v30, off, s[12:15], 0
s_add_u32 s70, s77, 655360
s_add_u32 m0, s78, 73728
s_and_b32 s70, s70, 0x1fffff
buffer_load_dwordx4 v16, s[16:19], s70 offen offset:0 lds
buffer_load_dwordx4 v17, s[16:19], s70 offen offset:1024 lds
buffer_load_dwordx4 v18, s[16:19], s70 offen offset:2048 lds
buffer_load_dwordx4 v19, s[16:19], s70 offen offset:3072 lds
buffer_load_dword v30, off, s[12:15], 0
s_sub_u32 s70, s59, s58
s_lshl_b32 s71, s70, 7
s_add_u32 s71, s71, s60
s_lshl4_add_u32 s70, s70, s60
s_sub_u32 s70, s70, 16
s_lshl_b32 s66, s71, 7
s_add_u32 s66, s66, 253952
s_lshl_b32 s70, s70, 15
s_lshl_b32 s71, s63, 23
s_add_u32 s70, s70, s71
s_add_u32 s64, s70, 1077248
s_mul_i32 s65, s58, -94208
s_add_u32 s35, s34, 16
lw_8:
ds_read_b32 v5, v1 offset:0
s_waitcnt lgkmcnt(0)
v_cmp_gt_i32 vcc, s35, v5
s_cbranch_vccz lwd_9
s_sleep 1
s_sub_u32 s32, s32, 1
s_cmp_gt_i32 s32, 0
s_cbranch_scc1 lw_8
lwd_9:
s_add_u32 s70, s77, 131072
s_add_u32 m0, s78, 40960
s_and_b32 s70, s70, 0x1fffff
buffer_load_dwordx4 v16, s[16:19], s70 offen offset:0 lds
buffer_load_dwordx4 v17, s[16:19], s70 offen offset:1024 lds
buffer_load_dwordx4 v18, s[16:19], s70 offen offset:2048 lds
buffer_load_dwordx4 v19, s[16:19], s70 offen offset:3072 lds
buffer_load_dword v30, off, s[12:15], 0
s_add_u32 s70, s77, 786432
s_add_u32 m0, s78, 81920
s_and_b32 s70, s70, 0x1fffff
buffer_load_dwordx4 v16, s[16:19], s70 offen offset:0 lds
buffer_load_dwordx4 v17, s[16:19], s70 offen offset:1024 lds
buffer_load_dwordx4 v18, s[16:19], s70 offen offset:2048 lds
buffer_load_dwordx4 v19, s[16:19], s70 offen offset:3072 lds
buffer_load_dword v30, off, s[12:15], 0
s_add_u32 s70, s77, 917504
s_add_u32 m0, s78, 90112
s_and_b32 s70, s70, 0x1fffff
buffer_load_dwordx4 v16, s[16:19], s70 offen offset:0 lds
buffer_load_dwordx4 v17, s[16:19], s70 offen offset:1024 lds
buffer_load_dwordx4 v18, s[16:19], s70 offen offset:2048 lds
buffer_load_dwordx4 v19, s[16:19], s70 offen offset:3072 lds
buffer_load_dword v30, off, s[12:15], 0
s_add_u32 s35, s34, 17
lw_11:
ds_read_b32 v5, v1 offset:0
s_waitcnt lgkmcnt(0)
v_cmp_gt_i32 vcc, s35, v5
s_cbranch_vccz lwd_12
s_sleep 1
s_sub_u32 s32, s32, 1
s_cmp_gt_i32 s32, 0
s_cbranch_scc1 lw_11
lwd_12:
s_cmp_gt_u32 s59, s58
s_cbranch_scc0 nokv_10
poll_13:
buffer_load_dword v6, v1, s[24:27], s66 offen sc1
pchk_14:
s_waitcnt vmcnt(0)
v_cmp_eq_u32 vcc, 0, v6
s_cbranch_vccz pdone_15
s_sub_u32 s32, s32, 1
s_cmp_gt_i32 s32, 0
s_cbranch_scc1 poll_13
pdone_15:
s_add_u32 m0, s65, 126976
s_nop 0
buffer_load_dwordx4 v20, s[20:23], s64 offen offset:0 sc1 lds
buffer_load_dwordx4 v20, s[20:23], s64 offen offset:1024 sc1 lds
buffer_load_dwordx4 v20, s[20:23], s64 offen offset:2048 sc1 lds
buffer_load_dwordx4 v20, s[20:23], s64 offen offset:3072 sc1 lds
buffer_load_dword v30, off, s[12:15], 0
s_add_u32 m0, s65, 122880
s_sub_u32 s64, s64, 4096
buffer_load_dwordx4 v20, s[20:23], s64 offen offset:0 sc1 lds
buffer_load_dwordx4 v20, s[20:23], s64 offen offset:1024 sc1 lds
buffer_load_dwordx4 v20, s[20:23], s64 offen offset:2048 sc1 lds
buffer_load_dwordx4 v20, s[20:23], s64 offen offset:3072 sc1 lds
buffer_load_dword v30, off, s[12:15], 0
s_add_u32 m0, s65, 118784
s_sub_u32 s64, s64, 4096
buffer_load_dwordx4 v20, s[20:23], s64 offen offset:0 sc1 lds
buffer_load_dwordx4 v20, s[20:23], s64 offen offset:1024 sc1 lds
buffer_load_dwordx4 v20, s[20:23], s64 offen offset:2048 sc1 lds
buffer_load_dwordx4 v20, s[20:23], s64 offen offset:3072 sc1 lds
buffer_load_dword v30, off, s[12:15], 0
s_add_u32 m0, s65, 114688
s_sub_u32 s64, s64, 4096
buffer_load_dwordx4 v20, s[20:23], s64 offen offset:0 sc1 lds
buffer_load_dwordx4 v20, s[20:23], s64 offen offset:1024 sc1 lds
buffer_load_dwordx4 v20, s[20:23], s64 offen offset:2048 sc1 lds
buffer_load_dwordx4 v20, s[20:23], s64 offen offset:3072 sc1 lds
buffer_load_dword v30, off, s[12:15], 0
s_add_u32 m0, s65, 110592
s_sub_u32 s64, s64, 4096
buffer_load_dwordx4 v20, s[20:23], s64 offen offset:0 sc1 lds
buffer_load_dwordx4 v20, s[20:23], s64 offen offset:1024 sc1 lds
buffer_load_dwordx4 v20, s[20:23], s64 offen offset:2048 sc1 lds
buffer_load_dwordx4 v20, s[20:23], s64 offen offset:3072 sc1 lds
buffer_load_dword v30, off, s[12:15], 0
s_add_u32 m0, s65, 106496
s_sub_u32 s64, s64, 4096
buffer_load_dwordx4 v20, s[20:23], s64 offen offset:0 sc1 lds
buffer_load_dwordx4 v20, s[20:23], s64 offen offset:1024 sc1 lds
buffer_load_dwordx4 v20, s[20:23], s64 offen offset:2048 sc1 lds
buffer_load_dwordx4 v20, s[20:23], s64 offen offset:3072 sc1 lds
buffer_load_dword v30, off, s[12:15], 0
s_add_u32 m0, s65, 102400
s_sub_u32 s64, s64, 4096
buffer_load_dwordx4 v20, s[20:23], s64 offen offset:0 sc1 lds
buffer_load_dwordx4 v20, s[20:23], s64 offen offset:1024 sc1 lds
buffer_load_dwordx4 v20, s[20:23], s64 offen offset:2048 sc1 lds
buffer_load_dwordx4 v20, s[20:23], s64 offen offset:3072 sc1 lds
buffer_load_dword v30, off, s[12:15], 0
s_add_u32 m0, s65, 98304
s_sub_u32 s64, s64, 4096
buffer_load_dwordx4 v20, s[20:23], s64 offen offset:0 sc1 lds
buffer_load_dwordx4 v20, s[20:23], s64 offen offset:1024 sc1 lds
buffer_load_dwordx4 v20, s[20:23], s64 offen offset:2048 sc1 lds
buffer_load_dwordx4 v20, s[20:23], s64 offen offset:3072 sc1 lds
buffer_load_dword v30, off, s[12:15], 0
nokv_10:
s_waitcnt vmcnt(0)
v_add_u32 v5, s34, 17
s_mov_b64 exec, 1
ds_write_b32 v3, v5
s_mov_b64 exec, -1
s_add_u32 s35, s34, 18
lw_16:
ds_read_b32 v5, v1 offset:0
s_waitcnt lgkmcnt(0)
v_cmp_gt_i32 vcc, s35, v5
s_cbranch_vccz lwd_17
s_sleep 1
s_sub_u32 s32, s32, 1
s_cmp_gt_i32 s32, 0
s_cbranch_scc1 lw_16
lwd_17:
s_add_u32 s70, s77, 1572864
s_add_u32 m0, s78, 131072
s_and_b32 s70, s70, 0x1fffff
buffer_load_dwordx4 v16, s[16:19], s70 offen offset:0 lds
buffer_load_dwordx4 v17, s[16:19], s70 offen offset:1024 lds
buffer_load_dwordx4 v18, s[16:19], s70 offen offset:2048 lds
buffer_load_dwordx4 v19, s[16:19], s70 offen offset:3072 lds
buffer_load_dword v30, off, s[12:15], 0
s_add_u32 s70, s77, 1703936
s_add_u32 m0, s78, 139264
s_and_b32 s70, s70, 0x1fffff
buffer_load_dwordx4 v16, s[16:19], s70 offen offset:0 lds
buffer_load_dwordx4 v17, s[16:19], s70 offen offset:1024 lds
buffer_load_dwordx4 v18, s[16:19], s70 offen offset:2048 lds
buffer_load_dwordx4 v19, s[16:19], s70 offen offset:3072 lds
buffer_load_dword v30, off, s[12:15], 0
s_add_u32 s70, s77, 1835008
s_add_u32 m0, s78, 147456
s_and_b32 s70, s70, 0x1fffff
buffer_load_dwordx4 v16, s[16:19], s70 offen offset:0 lds
buffer_load_dwordx4 v17, s[16:19], s70 offen offset:1024 lds
buffer_load_dwordx4 v18, s[16:19], s70 offen offset:2048 lds
buffer_load_dwordx4 v19, s[16:19], s70 offen offset:3072 lds
buffer_load_dword v30, off, s[12:15], 0
s_add_u32 s70, s77, 1966080
s_add_u32 m0, s78, 155648
s_and_b32 s70, s70, 0x1fffff
buffer_load_dwordx4 v16, s[16:19], s70 offen offset:0 lds
buffer_load_dwordx4 v17, s[16:19], s70 offen offset:1024 lds
buffer_load_dwordx4 v18, s[16:19], s70 offen offset:2048 lds
buffer_load_dwordx4 v19, s[16:19], s70 offen offset:3072 lds
buffer_load_dword v30, off, s[12:15], 0
s_add_u32 s35, s34, 19
lw_18:
ds_read_b32 v5, v1 offset:0
s_waitcnt lgkmcnt(0)
v_cmp_gt_i32 vcc, s35, v5
s_cbranch_vccz lwd_19
s_sleep 2
s_sub_u32 s32, s32, 1
s_cmp_gt_i32 s32, 0
s_cbranch_scc1 lw_18
lwd_19:
s_add_u32 s70, s77, 1048576
s_add_u32 m0, s78, 98304
s_and_b32 s70, s70, 0x1fffff
buffer_load_dwordx4 v16, s[16:19], s70 offen offset:0 lds
buffer_load_dwordx4 v17, s[16:19], s70 offen offset:1024 lds
buffer_load_dwordx4 v18, s[16:19], s70 offen offset:2048 lds
buffer_load_dwordx4 v19, s[16:19], s70 offen offset:3072 lds
buffer_load_dword v30, off, s[12:15], 0
s_add_u32 s70, s77, 1179648
s_add_u32 m0, s78, 106496
s_and_b32 s70, s70, 0x1fffff
buffer_load_dwordx4 v16, s[16:19], s70 offen offset:0 lds
buffer_load_dwordx4 v17, s[16:19], s70 offen offset:1024 lds
buffer_load_dwordx4 v18, s[16:19], s70 offen offset:2048 lds
buffer_load_dwordx4 v19, s[16:19], s70 offen offset:3072 lds
buffer_load_dword v30, off, s[12:15], 0
s_add_u32 s70, s77, 1310720
s_add_u32 m0, s78, 114688
s_and_b32 s70, s70, 0x1fffff
buffer_load_dwordx4 v16, s[16:19], s70 offen offset:0 lds
buffer_load_dwordx4 v17, s[16:19], s70 offen offset:1024 lds
buffer_load_dwordx4 v18, s[16:19], s70 offen offset:2048 lds
buffer_load_dwordx4 v19, s[16:19], s70 offen offset:3072 lds
buffer_load_dword v30, off, s[12:15], 0
s_add_u32 s70, s77, 1441792
s_add_u32 m0, s78, 122880
s_and_b32 s70, s70, 0x1fffff
buffer_load_dwordx4 v16, s[16:19], s70 offen offset:0 lds
buffer_load_dwordx4 v17, s[16:19], s70 offen offset:1024 lds
buffer_load_dwordx4 v18, s[16:19], s70 offen offset:2048 lds
buffer_load_dwordx4 v19, s[16:19], s70 offen offset:3072 lds
buffer_load_dword v30, off, s[12:15], 0
s_add_u32 s35, s34, 20
lw_20:
ds_read_b32 v5, v1 offset:0
s_waitcnt lgkmcnt(0)
v_cmp_gt_i32 vcc, s35, v5
s_cbranch_vccz lwd_21
s_sleep 2
s_sub_u32 s32, s32, 1
s_cmp_gt_i32 s32, 0
s_cbranch_scc1 lw_20
lwd_21:
s_add_u32 s70, s77, 0
s_add_u32 m0, s78, 32768
s_and_b32 s70, s70, 0x1fffff
buffer_load_dwordx4 v16, s[16:19], s70 offen offset:0 lds
buffer_load_dwordx4 v17, s[16:19], s70 offen offset:1024 lds
buffer_load_dwordx4 v18, s[16:19], s70 offen offset:2048 lds
buffer_load_dwordx4 v19, s[16:19], s70 offen offset:3072 lds
buffer_load_dword v30, off, s[12:15], 0
s_lshl_b32 s66, s61, 14
s_add_u32 s66, s66, 268288
s_cmp_eq_u32 s58, 0
s_cbranch_scc0 nofo_22
s_add_u32 s35, s34, 21
lw_23:
ds_read_b32 v5, v1 offset:0
s_waitcnt lgkmcnt(0)
v_cmp_gt_i32 vcc, s35, v5
s_cbranch_vccz lwd_24
s_sleep 1
s_sub_u32 s32, s32, 1
s_cmp_gt_i32 s32, 0
s_cbranch_scc1 lw_23
lwd_24:
poll_25:
buffer_load_dword v6, v21, s[24:27], s66 offen sc1
pchk_26:
s_waitcnt vmcnt(0)
v_cmp_eq_u32 vcc, 0, v6
s_cbranch_vccz pdone_27
s_sub_u32 s32, s32, 1
s_cmp_gt_i32 s32, 0
s_cbranch_scc1 poll_25
pdone_27:
nofo_22:
s_waitcnt vmcnt(0)
v_add_u32 v5, s34, 18
s_mov_b64 exec, 1
ds_write_b32 v3, v5
s_mov_b64 exec, -1
s_cmp_eq_u32 s63, 0
s_cbranch_scc0 L_end
v_bfe_u32 v6, v0, 3, 2
v_and_b32 v7, 2, v6
v_xor_b32 v7, v7, v22
v_lshrrev_b32 v23, 5, v0
v_lshl_add_u32 v6, v23, 4, v6
v_mul_u32_u24 v6, 6144, v6
v_lshl_add_u32 v12, v7, 4, v6
v_xor_b32 v6, 64, v12
v_add_u32 v13, 23552, v6
v_add_u32 v14, 47104, v12
v_add_u32 v15, 70656, v6
v_mov_b32 v8, v20
v_mov_b32 v9, v20
v_mov_b32 v10, v20
v_mov_b32 v11, v20
s_mov_b32 s8, s56
s_mov_b32 s9, s57
s_mov_b32 s10, 0x2500000
s_mov_b32 s11, 0x00020000
s_lshl_b32 s70, s59, 18
s_add_u32 s70, s70, 26214400
s_add_u32 s68, s70, s78
s_sub_u32 s69, s70, s78
s_add_u32 s69, s69, 12288
s_mov_b32 s67, 16384
s_lshl_b32 s66, s59, 14
s_add_u32 s66, s66, 274432
s_and_b32 s64, s61, 14
s_mov_b32 s65, 86016
s_add_u32 s35, s34, 22
lw_28:
ds_read_b32 v5, v1 offset:0
s_waitcnt lgkmcnt(0)
v_cmp_gt_i32 vcc, s35, v5
s_cbranch_vccz lwd_29
s_sleep 2
s_sub_u32 s32, s32, 1
s_cmp_gt_i32 s32, 0
s_cbranch_scc1 lw_28
lwd_29:
s_mul_i32 s70, s64, 393216
s_add_u32 m0, s65, s76
s_add_u32 s71, s70, s72
buffer_load_dwordx4 v12, s[12:15], s71 offen offset:0 lds
buffer_load_dwordx4 v13, s[12:15], s71 offen offset:1024 lds
buffer_load_dwordx4 v14, s[12:15], s71 offen offset:2048 lds
buffer_load_dwordx4 v15, s[12:15], s71 offen offset:3072 lds
buffer_load_dword v30, off, s[12:15], 0
s_add_u32 m0, m0, 4096
s_add_u32 s71, s70, s73
buffer_load_dwordx4 v12, s[12:15], s71 offen offset:0 lds
buffer_load_dwordx4 v13, s[12:15], s71 offen offset:1024 lds
buffer_load_dwordx4 v14, s[12:15], s71 offen offset:2048 lds
buffer_load_dwordx4 v15, s[12:15], s71 offen offset:3072 lds
buffer_load_dword v30, off, s[12:15], 0
s_add_u32 m0, m0, 4096
s_add_u32 s71, s70, s74
buffer_load_dwordx4 v12, s[12:15], s71 offen offset:0 lds
buffer_load_dwordx4 v13, s[12:15], s71 offen offset:1024 lds
buffer_load_dwordx4 v14, s[12:15], s71 offen offset:2048 lds
buffer_load_dwordx4 v15, s[12:15], s71 offen offset:3072 lds
buffer_load_dword v30, off, s[12:15], 0
s_add_u32 s64, s64, 1
s_and_b32 s64, s64, 15
s_sub_u32 s65, s65, 40960
s_cselect_b32 s65, 86016, s65
s_mul_i32 s70, s64, 393216
s_add_u32 m0, s65, s76
s_add_u32 s71, s70, s72
buffer_load_dwordx4 v12, s[12:15], s71 offen offset:0 lds
buffer_load_dwordx4 v13, s[12:15], s71 offen offset:1024 lds
buffer_load_dwordx4 v14, s[12:15], s71 offen offset:2048 lds
buffer_load_dwordx4 v15, s[12:15], s71 offen offset:3072 lds
buffer_load_dword v30, off, s[12:15], 0
s_add_u32 m0, m0, 4096
s_add_u32 s71, s70, s73
buffer_load_dwordx4 v12, s[12:15], s71 offen offset:0 lds
buffer_load_dwordx4 v13, s[12:15], s71 offen offset:1024 lds
buffer_load_dwordx4 v14, s[12:15], s71 offen offset:2048 lds
buffer_load_dwordx4 v15, s[12:15], s71 offen offset:3072 lds
buffer_load_dword v30, off, s[12:15], 0
s_add_u32 m0, m0, 4096
s_add_u32 s71, s70, s74
buffer_load_dwordx4 v12, s[12:15], s71 offen offset:0 lds
buffer_load_dwordx4 v13, s[12:15], s71 offen offset:1024 lds
buffer_load_dwordx4 v14, s[12:15], s71 offen offset:2048 lds
buffer_load_dwordx4 v15, s[12:15], s71 offen offset:3072 lds
buffer_load_dword v30, off, s[12:15], 0
s_add_u32 s64, s64, 1
s_and_b32 s64, s64, 15
s_sub_u32 s65, s65, 40960
s_cselect_b32 s65, 86016, s65
s_mul_i32 s70, s64, 393216
s_add_u32 m0, s65, s76
s_add_u32 s71, s70, s72
buffer_load_dwordx4 v12, s[12:15], s71 offen offset:0 lds
buffer_load_dwordx4 v13, s[12:15], s71 offen offset:1024 lds
buffer_load_dwordx4 v14, s[12:15], s71 offen offset:2048 lds
buffer_load_dwordx4 v15, s[12:15], s71 offen offset:3072 lds
buffer_load_dword v30, off, s[12:15], 0
s_add_u32 m0, m0, 4096
s_add_u32 s71, s70, s73
buffer_load_dwordx4 v12, s[12:15], s71 offen offset:0 lds
buffer_load_dwordx4 v13, s[12:15], s71 offen offset:1024 lds
buffer_load_dwordx4 v14, s[12:15], s71 offen offset:2048 lds
buffer_load_dwordx4 v15, s[12:15], s71 offen offset:3072 lds
buffer_load_dword v30, off, s[12:15], 0
s_add_u32 m0, m0, 4096
s_add_u32 s71, s70, s74
buffer_load_dwordx4 v12, s[12:15], s71 offen offset:0 lds
buffer_load_dwordx4 v13, s[12:15], s71 offen offset:1024 lds
buffer_load_dwordx4 v14, s[12:15], s71 offen offset:2048 lds
buffer_load_dwordx4 v15, s[12:15], s71 offen offset:3072 lds
buffer_load_dword v30, off, s[12:15], 0
s_add_u32 s64, s64, 1
s_and_b32 s64, s64, 15
s_sub_u32 s65, s65, 40960
s_cselect_b32 s65, 86016, s65
s_mov_b32 s36, s64
s_mov_b32 s37, s65
s_mov_b32 s64, s59
s_mov_b32 s65, 114688
s_mul_i32 s70, s64, 393216
s_add_u32 m0, s65, s76
s_add_u32 s71, s70, s72
buffer_load_dwordx4 v12, s[12:15], s71 offen offset:0 lds
buffer_load_dwordx4 v13, s[12:15], s71 offen offset:1024 lds
buffer_load_dwordx4 v14, s[12:15], s71 offen offset:2048 lds
buffer_load_dwordx4 v15, s[12:15], s71 offen offset:3072 lds
buffer_load_dword v30, off, s[12:15], 0
s_add_u32 m0, m0, 4096
s_add_u32 s71, s70, s73
buffer_load_dwordx4 v12, s[12:15], s71 offen offset:0 lds
buffer_load_dwordx4 v13, s[12:15], s71 offen offset:1024 lds
buffer_load_dwordx4 v14, s[12:15], s71 offen offset:2048 lds
buffer_load_dwordx4 v15, s[12:15], s71 offen offset:3072 lds
buffer_load_dword v30, off, s[12:15], 0
s_add_u32 m0, m0, 4096
s_add_u32 s71, s70, s74
buffer_load_dwordx4 v12, s[12:15], s71 offen offset:0 lds
buffer_load_dwordx4 v13, s[12:15], s71 offen offset:1024 lds
buffer_load_dwordx4 v14, s[12:15], s71 offen offset:2048 lds
buffer_load_dwordx4 v15, s[12:15], s71 offen offset:3072 lds
buffer_load_dword v30, off, s[12:15], 0
s_mov_b32 s64, s36
s_mov_b32 s65, s37
s_and_b32 s64, s61, 14
s_mov_b32 s65, 86016
s_add_u32 s35, s34, 23
lw_30:
ds_read_b32 v5, v1 offset:0
s_waitcnt lgkmcnt(0)
v_cmp_gt_i32 vcc, s35, v5
s_cbranch_vccz lwd_31
s_sleep 1
s_sub_u32 s32, s32, 1
s_cmp_gt_i32 s32, 0
s_cbranch_scc1 lw_30
lwd_31:
poll_32:
buffer_load_dword v6, v21, s[24:27], s66 offen sc1
pchk_33:
s_waitcnt vmcnt(0)
v_cmp_eq_u32 vcc, 0, v6
s_cbranch_vccz pdone_34
s_sub_u32 s32, s32, 1
s_cmp_gt_i32 s32, 0
s_cbranch_scc1 poll_32
pdone_34:
s_mul_i32 s70, s64, s67
s_add_u32 m0, s65, s75
s_add_u32 s71, s70, s68
buffer_load_dwordx4 v8, s[8:11], s71 offen offset:0 sc1 lds
buffer_load_dwordx4 v9, s[8:11], s71 offen offset:1024 sc1 lds
buffer_load_dwordx4 v10, s[8:11], s71 offen offset:2048 sc1 lds
buffer_load_dwordx4 v11, s[8:11], s71 offen offset:3072 sc1 lds
buffer_load_dword v30, off, s[12:15], 0
s_add_u32 m0, m0, 4096
s_add_u32 s71, s70, s69
buffer_load_dwordx4 v8, s[8:11], s71 offen offset:0 sc1 lds
buffer_load_dwordx4 v9, s[8:11], s71 offen offset:1024 sc1 lds
buffer_load_dwordx4 v10, s[8:11], s71 offen offset:2048 sc1 lds
buffer_load_dwordx4 v11, s[8:11], s71 offen offset:3072 sc1 lds
buffer_load_dword v30, off, s[12:15], 0
s_add_u32 s64, s64, 1
s_and_b32 s64, s64, 15
s_sub_u32 s65, s65, 40960
s_cselect_b32 s65, 86016, s65
s_mul_i32 s70, s64, s67
s_add_u32 m0, s65, s75
s_add_u32 s71, s70, s68
buffer_load_dwordx4 v8, s[8:11], s71 offen offset:0 sc1 lds
buffer_load_dwordx4 v9, s[8:11], s71 offen offset:1024 sc1 lds
buffer_load_dwordx4 v10, s[8:11], s71 offen offset:2048 sc1 lds
buffer_load_dwordx4 v11, s[8:11], s71 offen offset:3072 sc1 lds
buffer_load_dword v30, off, s[12:15], 0
s_add_u32 m0, m0, 4096
s_add_u32 s71, s70, s69
buffer_load_dwordx4 v8, s[8:11], s71 offen offset:0 sc1 lds
buffer_load_dwordx4 v9, s[8:11], s71 offen offset:1024 sc1 lds
buffer_load_dwordx4 v10, s[8:11], s71 offen offset:2048 sc1 lds
buffer_load_dwordx4 v11, s[8:11], s71 offen offset:3072 sc1 lds
buffer_load_dword v30, off, s[12:15], 0
s_add_u32 s64, s64, 1
s_and_b32 s64, s64, 15
s_sub_u32 s65, s65, 40960
s_cselect_b32 s65, 86016, s65
s_mul_i32 s70, s64, s67
s_add_u32 m0, s65, s75
s_add_u32 s71, s70, s68
buffer_load_dwordx4 v8, s[8:11], s71 offen offset:0 sc1 lds
buffer_load_dwordx4 v9, s[8:11], s71 offen offset:1024 sc1 lds
buffer_load_dwordx4 v10, s[8:11], s71 offen offset:2048 sc1 lds
buffer_load_dwordx4 v11, s[8:11], s71 offen offset:3072 sc1 lds
buffer_load_dword v30, off, s[12:15], 0
s_add_u32 m0, m0, 4096
s_add_u32 s71, s70, s69
buffer_load_dwordx4 v8, s[8:11], s71 offen offset:0 sc1 lds
buffer_load_dwordx4 v9, s[8:11], s71 offen offset:1024 sc1 lds
buffer_load_dwordx4 v10, s[8:11], s71 offen offset:2048 sc1 lds
buffer_load_dwordx4 v11, s[8:11], s71 offen offset:3072 sc1 lds
buffer_load_dword v30, off, s[12:15], 0
s_add_u32 s64, s64, 1
s_and_b32 s64, s64, 15
s_sub_u32 s65, s65, 40960
s_cselect_b32 s65, 86016, s65
s_waitcnt vmcnt(20)
v_add_u32 v5, s34, 33
s_mov_b64 exec, 1
ds_write_b32 v3, v5
s_mov_b64 exec, -1
s_waitcnt vmcnt(10)
v_add_u32 v5, s34, 34
s_mov_b64 exec, 1
ds_write_b32 v3, v5
s_mov_b64 exec, -1
s_mov_b32 s63, 1
s_mov_b32 s34, 32
s_add_u32 s24, s24, 1409024
s_addc_u32 s25, s25, 0
s_mov_b32 s26, 1409024
s_mov_b32 s66, 32
s_branch lq_1
lcs_2:
s_add_u32 s35, s34, 1
lw_35:
ds_read_b32 v5, v2 offset:24
s_waitcnt lgkmcnt(0)
v_cmp_gt_i32 vcc, s35, v5
s_cbranch_vccz lwd_36
s_sub_u32 s32, s32, 1
s_cmp_gt_i32 s32, 0
s_cbranch_scc1 lw_35
lwd_36:
s_branch lcb_3
L_f:
v_lshlrev_b32 v4, 4, v0
s_lshl4_add_u32 s78, s59, s60
v_mov_b32 v252, 0
v_mov_b32 v253, 0
v_mov_b32 v254, 0
v_mov_b32 v255, 0
s_lshl_b32 s35, s78, 10
s_cmp_eq_u32 s58, 0
s_cselect_b64 exec, -1, 0
buffer_store_dwordx4 v[252:255], v4, s[24:27], s35 offen offset:0 sc1
s_add_u32 s35, s35, 262144
buffer_store_dwordx4 v[252:255], v4, s[24:27], s35 offen offset:0 sc1
s_mov_b64 exec, -1
s_setprio 3
v_and_b32 v1, 3, v0
v_lshlrev_b32 v1, 2, v1
v_and_b32 v2, 4, v1
s_lshl2_add_u32 s35, s58, 24
v_mov_b32 v3, s35
s_mov_b32 s4, s54
s_mov_b32 s5, s55
s_mov_b32 s6, 0x100
s_mov_b32 s7, 0x00020000
s_add_u32 s70, s60, 4
s_lshr_b32 s70, s70, 3
s_sub_u32 s70, s60, s70
s_lshl4_add_u32 s64, s70, s59
s_and_b32 s70, s60, 7
s_cmp_eq_u32 s70, 3
s_cselect_b32 s65, 1, 0
s_mov_b32 s69, 0x3f803f80
s_barrier
s_cmp_eq_u32 s58, 0
s_cselect_b32 s16, s46, s48
s_cselect_b32 s17, s47, s49
s_mov_b32 s12, s50
s_mov_b32 s13, s51
s_mov_b32 s14, 0x0
s_mov_b32 s15, 0x00020000
s_cmp_eq_u32 s65, 0
s_cselect_b32 s18, 7340032, 0
s_mov_b32 s14, s18
s_lshr_b32 s70, s64, 3
s_and_b32 s71, s64, 7
s_lshl_b32 s66, s70, 10
s_add_u32 s66, s66, s71
s_lshl1_add_u32 s66, s66, s58
s_lshl_b32 s66, s66, 7
s_mul_i32 s71, s71, 917504
s_lshl_b32 s70, s70, 8
s_add_u32 s77, s71, s70
s_and_b32 s73, s2, 3
s_lshl_b32 s73, s73, 6
v_mov_b32 v14, 1
s_sub_u32 exec_lo, 1, s58
s_mov_b32 exec_hi, 0
s_waitcnt vmcnt(0)
buffer_atomic_add v14, off, s[4:7], s73 sc1
s_mov_b64 exec, -1
v_mov_b32 v8, s69
v_mov_b32 v9, s69
v_mov_b32 v10, s69
v_mov_b32 v11, s69
v_mov_b32 v12, s69
v_mov_b32 v13, s69
v_mov_b32 v14, s69
v_mov_b32 v15, s69
s_mov_b32 s70, 102400
ftop_37:
v_lshrrev_b32 v6, 4, v0
v_bfe_u32 v7, v0, 2, 2
v_lshl_add_u32 v6, v6, 3, v7
v_bfe_u32 v7, v0, 3, 2
s_lshl_b32 s71, s58, 1
v_xor_b32 v7, s71, v7
v_lshl_add_u32 v7, v7, 5, s70
v_lshl_add_u32 v6, v6, 7, v7
v_lshl_add_u32 v6, v1, 1, v6
v_xor_b32 v7, 32, v6
s_lshl1_add_u32 s71, s63, s34
s_add_u32 s35, s71, 1
lw_38:
ds_read_b32 v5, v2 offset:16
s_waitcnt lgkmcnt(0)
v_cmp_gt_i32 vcc, s35, v5
s_cbranch_vccz lwd_39
s_sleep 1
s_sub_u32 s32, s32, 1
s_cmp_gt_i32 s32, 0
s_cbranch_scc1 lw_38
lwd_39:
ds_read_b64_tr_b16 v[24:25], v6 offset:0
ds_read_b64_tr_b16 v[26:27], v6 offset:512
ds_read_b64_tr_b16 v[28:29], v6 offset:4096
ds_read_b64_tr_b16 v[30:31], v6 offset:4608
ds_read_b64_tr_b16 v[32:33], v7 offset:0
ds_read_b64_tr_b16 v[34:35], v7 offset:512
ds_read_b64_tr_b16 v[36:37], v7 offset:4096
ds_read_b64_tr_b16 v[38:39], v7 offset:4608
ds_read_b64_tr_b16 v[40:41], v6 offset:8192
ds_read_b64_tr_b16 v[42:43], v6 offset:8704
ds_read_b64_tr_b16 v[44:45], v6 offset:12288
ds_read_b64_tr_b16 v[46:47], v6 offset:12800
ds_read_b64_tr_b16 v[48:49], v7 offset:8192
ds_read_b64_tr_b16 v[50:51], v7 offset:8704
ds_read_b64_tr_b16 v[52:53], v7 offset:12288
ds_read_b64_tr_b16 v[54:55], v7 offset:12800
s_lshl_b32 s72, s60, 14
s_lshl_b32 s70, s58, 9
s_add_u32 s72, s72, s70
s_lshl_b32 s70, s59, 10
s_add_u32 s71, s72, s70
s_lshl_b32 s76, s59, 14
s_add_u32 s73, s76, 30686208
s_add_u32 s76, s76, 266240
s_waitcnt lgkmcnt(14)
v_mfma_f32_16x16x32_bf16 v[248:251], v[8:11], v[24:27], 0
s_waitcnt lgkmcnt(10)
v_mfma_f32_16x16x32_bf16 v[252:255], v[8:11], v[32:35], 0
v_mfma_f32_16x16x32_bf16 v[248:251], v[12:15], v[28:31], v[248:251]
s_waitcnt lgkmcnt(8)
v_mfma_f32_16x16x32_bf16 v[252:255], v[12:15], v[36:39], v[252:255]
ds_read_b64_tr_b16 v[24:25], v6 offset:16384
ds_read_b64_tr_b16 v[26:27], v6 offset:16896
ds_read_b64_tr_b16 v[28:29], v6 offset:20480
ds_read_b64_tr_b16 v[30:31], v6 offset:20992
ds_read_b64_tr_b16 v[32:33], v7 offset:16384
ds_read_b64_tr_b16 v[34:35], v7 offset:16896
ds_read_b64_tr_b16 v[36:37], v7 offset:20480
ds_read_b64_tr_b16 v[38:39], v7 offset:20992
v_add_u32 v5, s34, 1
s_mov_b64 exec, 1
ds_write_b32 v3, v5
s_mov_b64 exec, -1
s_waitcnt lgkmcnt(14)
v_mfma_f32_16x16x32_bf16 v[16:19], v[8:11], v[40:43], 0
s_waitcnt lgkmcnt(11)
v_mfma_f32_16x16x32_bf16 v[20:23], v[8:11], v[48:51], 0
v_mfma_f32_16x16x32_bf16 v[16:19], v[12:15], v[44:47], v[16:19]
s_waitcnt lgkmcnt(9)
v_mfma_f32_16x16x32_bf16 v[20:23], v[12:15], v[52:55], v[20:23]
v_mov_b32 v249, v252
v_mov_b32 v252, s69
v_mov_b32 v253, s69
v_mov_b32 v254, s69
v_mov_b32 v255, s69
v_mfma_f32_16x16x32_bf16 v[52:55], v[8:11], v[8:11], 0
s_nop 0
v_mfma_f32_16x16x32_bf16 v[48:51], v[8:11], v[252:255], 0
v_mfma_f32_16x16x32_bf16 v[52:55], v[12:15], v[12:15], v[52:55]
v_mfma_f32_16x16x32_bf16 v[48:51], v[12:15], v[252:255], v[48:51]
s_waitcnt lgkmcnt(7)
v_mfma_f32_16x16x32_bf16 v[40:43], v[8:11], v[24:27], 0
s_waitcnt lgkmcnt(3)
v_mfma_f32_16x16x32_bf16 v[44:47], v[8:11], v[32:35], 0
v_mfma_f32_16x16x32_bf16 v[40:43], v[12:15], v[28:31], v[40:43]
s_waitcnt lgkmcnt(1)
v_mfma_f32_16x16x32_bf16 v[44:47], v[12:15], v[36:39], v[44:47]
v_lshlrev_b32 v6, 3, v0
v_and_b32 v7, 48, v0
v_mov_b32_dpp v248, v16 quad_perm:[0,1,2,3] row_mask:0x2 bank_mask:0xf
v_mov_b32_dpp v249, v20 quad_perm:[0,1,2,3] row_mask:0x2 bank_mask:0xf
s_nop 0
v_mov_b32_dpp v248, v48 quad_perm:[0,1,2,3] row_mask:0x8 bank_mask:0xf
v_mov_b32_dpp v249, v52 quad_perm:[0,1,2,3] row_mask:0x8 bank_mask:0xf
s_nop 0
v_mov_b32_dpp v248, v40 quad_perm:[0,1,2,3] row_mask:0x4 bank_mask:0xf
v_mov_b32_dpp v249, v44 quad_perm:[0,1,2,3] row_mask:0x4 bank_mask:0xf
v_max_u32 v248, 1, v248
v_max_u32 v249, 1, v249
s_cmp_eq_u32 s63, 0
s_cbranch_scc1 fst_40
fsb_41:
buffer_store_dwordx2 v[248:249], v6, s[24:27], s71 offen sc1
s_lshl4_add_u32 s70, s58, s60
s_add_u32 s70, s70, s34
s_cmp_eq_u32 s70, 51
s_cbranch_scc1 fxt_42
fxb_43:
s_add_u32 s73, s72, 4096
s_add_u32 s74, s72, 8192
s_add_u32 s75, s72, 12288
v_lshrrev_b32 v7, 2, v0
v_lshlrev_b32 v7, 7, v7
v_lshl_add_u32 v7, v1, 2, v7
v_lshrrev_b32 v8, 5, v0
v_lshrrev_b32 v9, 4, v0
v_xor_b32 v10, v8, v9
v_and_b32 v10, 1, v10
v_lshl_add_u32 v8, v10, 1, v8
v_and_b32 v10, 15, v0
v_lshlrev_b32 v8, 7, v8
v_lshl_add_u32 v8, v10, 3, v8
v_add_u32 v8, 1280, v8
s_mul_i32 s70, s58, 384
s_lshl_b32 s71, s63, 10
s_add_u32 s70, s70, s71
s_add_u32 s70, s70, 2304
v_lshl_add_u32 v9, v9, 7, s70
v_lshl_add_u32 v9, v10, 2, v9
s_cmp_eq_u32 s63, 0
s_cbranch_scc1 fg_44
fg_45:
poll_46:
buffer_load_dwordx4 v[12:15], v7, s[24:27], s76 offen sc1
pchk_47:
s_waitcnt vmcnt(0)
v_min3_u32 v10, v12, v13, v14
v_min_u32 v10, v10, v15
v_cmp_eq_u32 vcc, 0, v10
s_cbranch_vccz pdone_48
s_sub_u32 s32, s32, 1
s_cmp_gt_i32 s32, 0
s_cbranch_scc1 poll_46
pdone_48:
s_lshr_b32 s70, s33, 7
s_sub_u32 s70, s70, s59
s_mul_i32 s70, s70, s63
s_cmp_eq_u32 s70, 0
s_cbranch_scc0 fng_49
poll_50:
buffer_load_dwordx2 v[24:25], v6, s[24:27], s72 offen offset:0 sc1
buffer_load_dwordx2 v[26:27], v6, s[24:27], s72 offen offset:1024 sc1
buffer_load_dwordx2 v[28:29], v6, s[24:27], s72 offen offset:2048 sc1
buffer_load_dwordx2 v[30:31], v6, s[24:27], s72 offen offset:3072 sc1
buffer_load_dwordx2 v[32:33], v6, s[24:27], s73 offen offset:0 sc1
buffer_load_dwordx2 v[34:35], v6, s[24:27], s73 offen offset:1024 sc1
buffer_load_dwordx2 v[36:37], v6, s[24:27], s73 offen offset:2048 sc1
buffer_load_dwordx2 v[38:39], v6, s[24:27], s73 offen offset:3072 sc1
buffer_load_dwordx2 v[40:41], v6, s[24:27], s74 offen offset:0 sc1
buffer_load_dwordx2 v[42:43], v6, s[24:27], s74 offen offset:1024 sc1
buffer_load_dwordx2 v[44:45], v6, s[24:27], s74 offen offset:2048 sc1
buffer_load_dwordx2 v[46:47], v6, s[24:27], s74 offen offset:3072 sc1
buffer_load_dwordx2 v[48:49], v6, s[24:27], s75 offen offset:0 sc1
buffer_load_dwordx2 v[50:51], v6, s[24:27], s75 offen offset:1024 sc1
buffer_load_dwordx2 v[52:53], v6, s[24:27], s75 offen offset:2048 sc1
buffer_load_dwordx2 v[54:55], v6, s[24:27], s75 offen offset:3072 sc1
pchk_51:
s_waitcnt vmcnt(14)
v_min3_u32 v10, v24, v25, v26
s_waitcnt vmcnt(13)
v_min3_u32 v10, v10, v27, v28
s_waitcnt vmcnt(12)
v_min3_u32 v10, v10, v29, v30
s_waitcnt vmcnt(11)
v_min3_u32 v10, v10, v31, v32
s_waitcnt vmcnt(10)
v_min3_u32 v10, v10, v33, v34
s_waitcnt vmcnt(9)
v_min3_u32 v10, v10, v35, v36
s_waitcnt vmcnt(8)
v_min3_u32 v10, v10, v37, v38
s_waitcnt vmcnt(7)
v_min3_u32 v10, v10, v39, v40
s_waitcnt vmcnt(6)
v_min3_u32 v10, v10, v41, v42
s_waitcnt vmcnt(5)
v_min3_u32 v10, v10, v43, v44
s_waitcnt vmcnt(4)
v_min3_u32 v10, v10, v45, v46
s_waitcnt vmcnt(3)
v_min3_u32 v10, v10, v47, v48
s_waitcnt vmcnt(2)
v_min3_u32 v10, v10, v49, v50
s_waitcnt vmcnt(1)
v_min3_u32 v10, v10, v51, v52
s_waitcnt vmcnt(0)
v_min3_u32 v10, v10, v53, v54
v_min_u32 v10, v10, v55
v_cmp_eq_u32 vcc, 0, v10
s_cbranch_vccz pdone_52
s_sub_u32 s32, s32, 1
s_cmp_gt_i32 s32, 0
s_cbranch_scc1 poll_50
pdone_52:
v_add_f32 v24, v24, v40
v_add_f32 v25, v25, v41
v_add_f32 v26, v26, v42
v_add_f32 v27, v27, v43
v_add_f32 v28, v28, v44
v_add_f32 v29, v29, v45
v_add_f32 v30, v30, v46
v_add_f32 v31, v31, v47
v_add_f32 v32, v32, v48
v_add_f32 v33, v33, v49
v_add_f32 v34, v34, v50
v_add_f32 v35, v35, v51
v_add_f32 v36, v36, v52
v_add_f32 v37, v37, v53
v_add_f32 v38, v38, v54
v_add_f32 v39, v39, v55
v_add_f32 v24, v24, v32
v_add_f32 v25, v25, v33
v_add_f32 v26, v26, v34
v_add_f32 v27, v27, v35
v_add_f32 v28, v28, v36
v_add_f32 v29, v29, v37
v_add_f32 v30, v30, v38
v_add_f32 v31, v31, v39
v_add_f32 v24, v24, v28
v_add_f32 v25, v25, v29
v_add_f32 v26, v26, v30
v_add_f32 v27, v27, v31
v_add_f32 v24, v24, v26
v_add_f32 v25, v25, v27
s_mov_b32 exec_hi, 0xffff
ds_write2_b32 v9, v24, v25 offset1:16
s_mov_b32 exec_hi, -1
v_mul_f32 v5, 0xba800000, v24
v_mul_f32 v25, 0x3a800000, v25
v_fma_f32 v25, -v5, v5, v25
v_max_f32 v25, 0, v25
v_add_f32 v25, 0x3727c5ac, v25
v_rsq_f32 v24, v25
s_nop 0
v_mul_f32 v25, v5, v24
s_lshl_b32 s70, s59, 7
s_sub_u32 s70, s33, s70
v_lshlrev_b32 v10, 1, v0
v_sub_u32 v10, s70, v10
v_readlane_b32 s70, v24, 48
v_readlane_b32 s71, v25, 48
v_cmp_eq_u32 vcc, 0, v10
s_mov_b64 exec, vcc
v_mov_b32 v12, s70
v_mov_b32 v13, s71
s_mov_b64 exec, -1
v_cmp_eq_u32 vcc, 1, v10
s_mov_b64 exec, vcc
v_mov_b32 v14, s70
v_mov_b32 v15, s71
s_mov_b64 exec, -1
fng_49:
ds_write2_b32 v8, v12, v14 offset1:1
ds_write2_b32 v8, v13, v15 offset0:128 offset1:129
s_add_u32 s71, s34, s63
v_add_u32 v5, s71, 2
s_mov_b64 exec, 1
ds_write_b32 v3, v5
s_mov_b64 exec, -1
s_setprio 0
s_cmp_eq_u32 s63, 0
s_cbranch_scc1 fnw_53
fnw_54:
s_and_b32 s70, s64, 7
s_lshl_b32 s70, s70, 7
s_add_u32 s73, s70, 276480
s_lshl1_add_u32 s72, s70, 272384
s_lshr_b32 s71, s64, 3
s_lshl_b32 s76, s71, 13
s_add_u32 s76, s76, 1048576
s_lshl2_add_u32 s74, s70, s76
s_lshl_b32 s70, s58, 8
s_add_u32 s74, s74, s70
s_add_u32 s75, s74, 4096
s_lshl4_add_u32 s76, s70, s76
v_and_b32 v251, 15, v0
v_lshlrev_b32 v6, 14, v251
v_lshrrev_b32 v252, 4, v0
v_lshl_add_u32 v7, v252, 5, v6
v_lshlrev_b32 v251, 4, v251
s_lshl_b32 s70, s58, 3
v_lshl_add_u32 v253, v252, 1, s70
v_add_u32 v253, v253, v251
v_lshlrev_b32 v254, 5, v252
v_lshl_add_u32 v254, v2, 2, v254
v_and_b32 v255, 7, v0
v_lshl_add_u32 v255, v255, 2, v252
v_lshlrev_b32 v255, 3, v255
s_add_u32 s35, s34, 22
lw_55:
ds_read_b32 v5, v1 offset:0
s_waitcnt lgkmcnt(0)
v_cmp_gt_i32 vcc, s35, v5
s_cbranch_vccz lwd_56
s_sleep 4
s_sub_u32 s32, s32, 1
s_cmp_gt_i32 s32, 0
s_cbranch_scc1 lw_55
lwd_56:
s_setprio 3
s_add_u32 s35, s34, 24
lw_57:
ds_read_b32 v5, v1 offset:0
s_waitcnt lgkmcnt(0)
v_cmp_gt_i32 vcc, s35, v5
s_cbranch_vccz lwd_58
s_sleep 2
s_sub_u32 s32, s32, 1
s_cmp_gt_i32 s32, 0
s_cbranch_scc1 lw_57
lwd_58:
s_cmp_eq_u32 s65, 0
s_cbranch_scc0 fnd_60
poll_61:
buffer_load_dwordx2 v[248:249], v6, s[24:27], s73 offen sc1
buffer_load_dwordx4 v[8:11], v7, s[24:27], s72 offen offset:0 sc1
buffer_load_dwordx4 v[12:15], v7, s[24:27], s72 offen offset:16 sc1
buffer_load_dwordx4 v[16:19], v7, s[24:27], s72 offen offset:128 sc1
buffer_load_dwordx4 v[20:23], v7, s[24:27], s72 offen offset:144 sc1
pchk_62:
s_waitcnt vmcnt(3)
v_min3_u32 v5, v248, v249, v8
v_min3_u32 v5, v5, v9, v10
s_waitcnt vmcnt(2)
v_min3_u32 v5, v5, v11, v12
v_min3_u32 v5, v5, v13, v14
s_waitcnt vmcnt(1)
v_min3_u32 v5, v5, v15, v16
v_min3_u32 v5, v5, v17, v18
s_waitcnt vmcnt(0)
v_min3_u32 v5, v5, v19, v20
v_min3_u32 v5, v5, v21, v22
v_min_u32 v5, v5, v23
v_cmp_eq_u32 vcc, 0, v5
s_cbranch_vccz pdone_63
s_sub_u32 s32, s32, 1
s_cmp_gt_i32 s32, 0
s_cbranch_scc1 poll_61
pdone_63:
v_mfma_f32_16x16x32_bf16 v[24:27], v[8:11], v[56:59], 0
v_mov_b32 v250, v248
v_mfma_f32_16x16x32_bf16 v[28:31], v[8:11], v[60:63], 0
s_nop 0
v_max_f32_dpp v250, v250, v250 row_ror:1 row_mask:0xf bank_mask:0xf
v_mfma_f32_16x16x32_bf16 v[32:35], v[8:11], v[64:67], 0
s_nop 0
v_max_f32_dpp v250, v250, v250 row_ror:2 row_mask:0xf bank_mask:0xf
v_mfma_f32_16x16x32_bf16 v[36:39], v[8:11], v[68:71], 0
s_nop 0
v_max_f32_dpp v250, v250, v250 row_ror:4 row_mask:0xf bank_mask:0xf
v_mfma_f32_16x16x32_bf16 v[40:43], v[8:11], v[72:75], 0
s_nop 0
v_max_f32_dpp v250, v250, v250 row_ror:8 row_mask:0xf bank_mask:0xf
v_mfma_f32_16x16x32_bf16 v[44:47], v[8:11], v[76:79], 0
v_cmp_eq_f32 vcc, v250, v248
v_mfma_f32_16x16x32_bf16 v[48:51], v[8:11], v[80:83], 0
s_ff1_i32_b64 s68, vcc
v_mfma_f32_16x16x32_bf16 v[52:55], v[8:11], v[84:87], 0
s_and_b32 s68, s68, 15
v_mfma_f32_16x16x32_bf16 v[24:27], v[12:15], v[88:91], v[24:27]
v_readlane_b32 s33, v249, s68
v_mfma_f32_16x16x32_bf16 v[28:31], v[12:15], v[92:95], v[28:31]
v_readlane_b32 s67, v248, s68
v_mfma_f32_16x16x32_bf16 v[32:35], v[12:15], v[96:99], v[32:35]
v_add_u32 v5, s34, 4
v_mfma_f32_16x16x32_bf16 v[36:39], v[12:15], v[100:103], v[36:39]
v_mov_b32 v250, s33
v_mfma_f32_16x16x32_bf16 v[40:43], v[12:15], v[104:107], v[40:43]
s_mov_b64 exec, 1
ds_write2_b32 v3, v5, v250 offset1:2
s_mov_b64 exec, -1
v_mfma_f32_16x16x32_bf16 v[44:47], v[12:15], v[108:111], v[44:47]
s_sub_u32 s33, s33, 1
v_mfma_f32_16x16x32_bf16 v[48:51], v[12:15], v[112:115], v[48:51]
s_and_b32 s33, s33, 2047
v_mfma_f32_16x16x32_bf16 v[52:55], v[12:15], v[116:119], v[52:55]
v_mfma_f32_16x16x32_bf16 v[24:27], v[16:19], v[120:123], v[24:27]
v_mfma_f32_16x16x32_bf16 v[28:31], v[16:19], v[124:127], v[28:31]
v_mfma_f32_16x16x32_bf16 v[32:35], v[16:19], v[128:131], v[32:35]
v_mfma_f32_16x16x32_bf16 v[36:39], v[16:19], v[132:135], v[36:39]
v_mfma_f32_16x16x32_bf16 v[40:43], v[16:19], v[136:139], v[40:43]
v_mfma_f32_16x16x32_bf16 v[44:47], v[16:19], v[140:143], v[44:47]
v_mfma_f32_16x16x32_bf16 v[48:51], v[16:19], v[144:147], v[48:51]
v_mfma_f32_16x16x32_bf16 v[52:55], v[16:19], v[148:151], v[52:55]
v_mfma_f32_16x16x32_bf16 v[24:27], v[20:23], v[152:155], v[24:27]
s_and_b32 s70, s68, 12
s_lshl_b32 s70, s70, 2
s_bitcmp1_b32 s68, 1
v_mfma_f32_16x16x32_bf16 v[28:31], v[20:23], v[156:159], v[28:31]
v_mfma_f32_16x16x32_bf16 v[32:35], v[20:23], v[160:163], v[32:35]
v_mfma_f32_16x16x32_bf16 v[36:39], v[20:23], v[164:167], v[36:39]
v_mfma_f32_16x16x32_bf16 v[40:43], v[20:23], v[168:171], v[40:43]
v_mfma_f32_16x16x32_bf16 v[44:47], v[20:23], v[172:175], v[44:47]
v_mfma_f32_16x16x32_bf16 v[48:51], v[20:23], v[176:179], v[48:51]
v_mfma_f32_16x16x32_bf16 v[52:55], v[20:23], v[180:183], v[52:55]
s_cbranch_scc1 fsel_66
fsel_64:
s_bitcmp1_b32 s68, 0
s_cbranch_scc1 fsel_65
v_max_u32 v8, 1, v24
v_max_u32 v9, 1, v28
v_max_u32 v10, 1, v32
v_max_u32 v11, 1, v36
v_max_u32 v12, 1, v40
v_max_u32 v13, 1, v44
v_max_u32 v14, 1, v48
v_max_u32 v15, 1, v52
s_branch fsel_68
fsel_65:
v_max_u32 v8, 1, v25
v_max_u32 v9, 1, v29
v_max_u32 v10, 1, v33
v_max_u32 v11, 1, v37
v_max_u32 v12, 1, v41
v_max_u32 v13, 1, v45
v_max_u32 v14, 1, v49
v_max_u32 v15, 1, v53
s_branch fsel_68
fsel_66:
s_bitcmp1_b32 s68, 0
s_cbranch_scc1 fsel_67
v_max_u32 v8, 1, v26
v_max_u32 v9, 1, v30
v_max_u32 v10, 1, v34
v_max_u32 v11, 1, v38
v_max_u32 v12, 1, v42
v_max_u32 v13, 1, v46
v_max_u32 v14, 1, v50
v_max_u32 v15, 1, v54
s_branch fsel_68
fsel_67:
v_max_u32 v8, 1, v27
v_max_u32 v9, 1, v31
v_max_u32 v10, 1, v35
v_max_u32 v11, 1, v39
v_max_u32 v12, 1, v43
v_max_u32 v13, 1, v47
v_max_u32 v14, 1, v51
v_max_u32 v15, 1, v55
fsel_68:
s_bfm_b64 exec, 16, s70
buffer_store_dwordx4 v[8:11], v251, s[24:27], s74 offen sc1
buffer_store_dwordx4 v[12:15], v251, s[24:27], s75 offen sc1
s_mov_b64 exec, -1
s_and_b32 s70, s64, 7
s_lshl1_add_u32 s70, s70, s58
s_mul_i32 s70, s70, 28
s_add_u32 s70, s70, s71
s_lshl_b32 s70, s70, 8
s_add_u32 s70, s70, 1277952
s_waitcnt vmcnt(0)
poll_69:
buffer_load_dwordx4 v[24:27], v4, s[24:27], s76 offen offset:0 sc1
buffer_load_dwordx4 v[28:31], v4, s[24:27], s76 offen offset:1024 sc1
buffer_load_dwordx4 v[32:35], v4, s[24:27], s76 offen offset:2048 sc1
buffer_load_dwordx4 v[36:39], v4, s[24:27], s76 offen offset:3072 sc1
pchk_70:
s_waitcnt vmcnt(3)
v_min3_u32 v5, v24, v25, v26
s_waitcnt vmcnt(2)
v_min3_u32 v5, v5, v27, v28
v_min3_u32 v5, v5, v29, v30
s_waitcnt vmcnt(1)
v_min3_u32 v5, v5, v31, v32
v_min3_u32 v5, v5, v33, v34
s_waitcnt vmcnt(0)
v_min3_u32 v5, v5, v35, v36
v_min3_u32 v5, v5, v37, v38
v_min_u32 v5, v5, v39
v_cmp_eq_u32 vcc, 0, v5
s_cbranch_vccz pdone_71
s_sub_u32 s32, s32, 1
s_cmp_gt_i32 s32, 0
s_cbranch_scc1 poll_69
pdone_71:
v_add_f32 v24, v24, v32
v_add_f32 v25, v25, v33
v_add_f32 v26, v26, v34
v_add_f32 v27, v27, v35
v_add_f32 v28, v28, v36
v_add_f32 v29, v29, v37
v_add_f32 v30, v30, v38
v_add_f32 v31, v31, v39
v_add_f32 v24, v24, v28
v_add_f32 v25, v25, v29
v_add_f32 v26, v26, v30
v_add_f32 v27, v27, v31
s_nop 0
v_permlane32_swap_b32 v24, v26
v_permlane32_swap_b32 v25, v27
v_add_f32 v24, v24, v26
v_add_f32 v25, v25, v27
s_nop 1
v_permlane16_swap_b32 v24, v25
v_mul_f32 v26, 0xbfb8aa3b, v24
v_exp_f32 v26, v26
v_mul_f32 v24, v24, v25
v_add_f32 v26, 1.0, v26
v_rcp_f32 v26, v26
v_add_u32 v5, s34, 5
v_mul_f32 v24, v24, v26
v_cvt_pk_bf16_f32 v24, v24, v24
ds_write_b16 v253, v24 offset:512
s_mov_b64 exec, 1
ds_write_b32 v3, v5
s_mov_b64 exec, -1
s_add_u32 s35, s34, 5
poll_72:
ds_read_b32 v5, v2 offset:24
ds_read_b128 v[8:11], v254 offset:512
ds_read_b128 v[12:15], v254 offset:640
pchk_73:
s_waitcnt lgkmcnt(2)
v_cmp_gt_i32 vcc, s35, v5
s_cbranch_vccz pdone_74
s_sleep 1
s_sub_u32 s32, s32, 1
s_cmp_gt_i32 s32, 0
s_cbranch_scc1 poll_72
pdone_74:
s_waitcnt lgkmcnt(1)
v_mfma_f32_16x16x32_bf16 v[24:27], v[8:11], v[184:187], 0
v_mfma_f32_16x16x32_bf16 v[28:31], v[8:11], v[188:191], 0
v_mfma_f32_16x16x32_bf16 v[32:35], v[8:11], v[192:195], 0
v_mfma_f32_16x16x32_bf16 v[36:39], v[8:11], v[196:199], 0
v_mfma_f32_16x16x32_bf16 v[40:43], v[8:11], v[200:203], 0
v_mfma_f32_16x16x32_bf16 v[44:47], v[8:11], v[204:207], 0
v_mfma_f32_16x16x32_bf16 v[48:51], v[8:11], v[208:211], 0
v_mfma_f32_16x16x32_bf16 v[52:55], v[8:11], v[212:215], 0
s_waitcnt lgkmcnt(0)
v_mfma_f32_16x16x32_bf16 v[24:27], v[12:15], v[216:219], v[24:27]
v_mfma_f32_16x16x32_bf16 v[28:31], v[12:15], v[220:223], v[28:31]
v_mfma_f32_16x16x32_bf16 v[32:35], v[12:15], v[224:227], v[32:35]
v_mfma_f32_16x16x32_bf16 v[36:39], v[12:15], v[228:231], v[36:39]
v_mfma_f32_16x16x32_bf16 v[40:43], v[12:15], v[232:235], v[40:43]
v_mfma_f32_16x16x32_bf16 v[44:47], v[12:15], v[236:239], v[44:47]
v_mfma_f32_16x16x32_bf16 v[48:51], v[12:15], v[240:243], v[48:51]
v_mfma_f32_16x16x32_bf16 v[52:55], v[12:15], v[244:247], v[52:55]
s_nop 0
v_add_f32_dpp v16, v25, v24 row_ror:8 row_mask:0x1 bank_mask:0xf
v_add_f32_dpp v17, v29, v28 row_ror:8 row_mask:0x1 bank_mask:0xf
s_nop 0
v_add_f32_dpp v16, v33, v32 row_ror:8 row_mask:0x2 bank_mask:0xf
v_add_f32_dpp v17, v37, v36 row_ror:8 row_mask:0x2 bank_mask:0xf
s_nop 0
v_add_f32_dpp v16, v41, v40 row_ror:8 row_mask:0x4 bank_mask:0xf
v_add_f32_dpp v17, v45, v44 row_ror:8 row_mask:0x4 bank_mask:0xf
s_nop 0
v_add_f32_dpp v16, v49, v48 row_ror:8 row_mask:0x8 bank_mask:0xf
v_add_f32_dpp v17, v53, v52 row_ror:8 row_mask:0x8 bank_mask:0xf
v_max_u32 v16, 1, v16
v_max_u32 v17, 1, v17
s_mov_b32 exec_lo, 0x00ff00ff
s_mov_b32 exec_hi, 0x00ff00ff
buffer_store_dwordx2 v[16:17], v255, s[24:27], s70 offen sc1
s_mov_b64 exec, -1
fnd_59:
s_sub_u32 s70, s60, 3
s_mul_i32 s70, s70, s63
s_or_b32 s70, s70, s58
s_cbranch_scc1 fnr_75
s_mul_i32 s72, s59, 7168
s_add_u32 s72, s72, 1277952
s_add_u32 s73, s72, 4096
s_lshl_b32 s70, s68, 6
s_add_u32 s70, s70, s59
s_lshl_b32 s70, s70, 8
s_add_u32 s76, s70, 262144
v_mov_b32 v12, s67
v_mul_f32 v12, 0xbfb8aa3b, v12
v_exp_f32 v12, v12
v_lshl_add_u32 v6, v252, 2, v251
v_add_f32 v12, 1.0, v12
v_rcp_f32 v12, v12
v_lshrrev_b32 v7, 1, v6
s_lshl4_add_u32 s70, s33, s59
s_lshl_b32 s70, s70, 7
v_and_b32 v8, 0x46, v7
v_lshl_add_u32 v8, v1, 2, v8
v_and_b32 v9, 4, v0
v_lshl_add_u32 v8, v9, 1, v8
s_waitcnt vmcnt(0)
s_cmp_gt_u32 s65, s63
s_cbranch_scc1 fpre_77
fpre_78:
poll_79:
buffer_load_dword v52, v6, s[24:27], s76 offen sc1
buffer_load_dwordx4 v[24:27], v4, s[24:27], s72 offen offset:0 sc1
buffer_load_dwordx4 v[28:31], v4, s[24:27], s72 offen offset:1024 sc1
buffer_load_dwordx4 v[32:35], v4, s[24:27], s72 offen offset:2048 sc1
buffer_load_dwordx4 v[36:39], v4, s[24:27], s72 offen offset:3072 sc1
buffer_load_dwordx4 v[40:43], v4, s[24:27], s73 offen offset:0 sc1
buffer_load_dwordx4 v[44:47], v4, s[24:27], s73 offen offset:1024 sc1
buffer_load_dwordx4 v[48:51], v4, s[24:27], s73 offen offset:2048 sc1
pchk_80:
s_waitcnt vmcnt(6)
v_min3_u32 v5, v24, v25, v26
s_waitcnt vmcnt(5)
v_min3_u32 v5, v5, v27, v28
v_min3_u32 v5, v5, v29, v30
s_waitcnt vmcnt(4)
v_min3_u32 v5, v5, v31, v32
v_min3_u32 v5, v5, v33, v34
s_waitcnt vmcnt(3)
v_min3_u32 v5, v5, v35, v36
v_min3_u32 v5, v5, v37, v38
s_waitcnt vmcnt(2)
v_min3_u32 v5, v5, v39, v40
v_min3_u32 v5, v5, v41, v42
s_waitcnt vmcnt(1)
v_min3_u32 v5, v5, v43, v44
v_min3_u32 v5, v5, v45, v46
s_waitcnt vmcnt(0)
v_min3_u32 v5, v5, v47, v48
v_min3_u32 v5, v5, v49, v50
v_min3_u32 v5, v5, v51, v52
v_cmp_eq_u32 vcc, 0, v5
s_cbranch_vccz pdone_81
s_sub_u32 s32, s32, 1
s_cmp_gt_i32 s32, 0
s_cbranch_scc1 poll_79
pdone_81:
v_add_f32 v24, v24, v40
v_add_f32 v25, v25, v41
v_add_f32 v26, v26, v42
v_add_f32 v27, v27, v43
v_add_f32 v28, v28, v44
v_add_f32 v29, v29, v45
v_add_f32 v30, v30, v46
v_add_f32 v31, v31, v47
v_add_f32 v32, v32, v48
v_add_f32 v33, v33, v49
v_add_f32 v34, v34, v50
v_add_f32 v35, v35, v51
v_add_f32 v24, v24, v32
v_add_f32 v25, v25, v33
v_add_f32 v26, v26, v34
v_add_f32 v27, v27, v35
v_add_f32 v28, v28, v36
v_add_f32 v29, v29, v37
v_add_f32 v30, v30, v38
v_add_f32 v31, v31, v39
v_add_f32 v24, v24, v28
v_add_f32 v25, v25, v29
v_add_f32 v26, v26, v30
v_add_f32 v27, v27, v31
s_nop 0
v_permlane32_swap_b32 v24, v26
v_permlane32_swap_b32 v25, v27
v_add_f32 v24, v24, v26
v_add_f32 v25, v25, v27
s_nop 1
v_permlane16_swap_b32 v24, v25
v_add_f32 v24, v24, v25
v_fma_f32 v24, v24, v12, v52
v_cvt_pk_bf16_f32 v24, v24, v24
s_cmp_eq_u32 s63, 0
s_cbranch_scc1 fl0_76
buffer_store_short v24, v7, s[28:31], s70 offen
s_branch L_end
fl0_76:
ds_write_b16 v8, v24 offset:384
fnr_75:
s_cmp_eq_u32 s63, 0
s_cbranch_scc0 L_end
v_add_u32 v5, s34, 6
s_mov_b64 exec, 1
ds_write_b32 v3, v5
s_mov_b64 exec, -1
v_and_b32 v6, 48, v0
s_add_u32 s35, s34, 6
poll_82:
ds_read_b32 v5, v2 offset:24
ds_read_b128 v[8:11], v6 offset:384
ds_read_b128 v[12:15], v6 offset:448
pchk_83:
s_waitcnt lgkmcnt(2)
v_cmp_gt_i32 vcc, s35, v5
s_cbranch_vccz pdone_84
s_sleep 1
s_sub_u32 s32, s32, 1
s_cmp_gt_i32 s32, 0
s_cbranch_scc1 poll_82
pdone_84:
s_mov_b32 s63, 1
s_mov_b32 s34, 32
s_add_u32 s24, s24, 1409024
s_addc_u32 s25, s25, 0
s_mov_b32 s26, 1409024
s_mov_b32 s70, 131072
s_branch ftop_37
fxt_42:
v_max_u32 v8, 1, v8
v_max_u32 v9, 1, v9
v_max_u32 v10, 1, v10
v_max_u32 v11, 1, v11
v_max_u32 v12, 1, v12
v_max_u32 v13, 1, v13
v_max_u32 v14, 1, v14
v_max_u32 v15, 1, v15
s_mov_b32 exec_lo, 0x10001
s_mov_b32 exec_hi, 0x10001
buffer_store_dwordx4 v[8:11], v7, s[20:23], s73 offen offset:0 sc1
buffer_store_dwordx4 v[12:15], v7, s[20:23], s73 offen offset:64 sc1
s_mov_b64 exec, -1
s_branch fxb_43
fst_40:
s_lshl1_add_u32 s70, s78, s58
s_lshl_b32 s70, s70, 13
v_bfe_u32 v8, v0, 2, 2
v_lshl_add_u32 v8, v8, 9, v7
v_add_u32 v8, v8, v1
v_lshlrev_b32 v8, 2, v8
buffer_load_dwordx4 v[24:27], v8, s[8:11], s70 offen offset:0
buffer_load_dwordx4 v[28:31], v8, s[8:11], s70 offen offset:256
buffer_load_dwordx4 v[32:35], v8, s[8:11], s70 offen offset:512
buffer_load_dwordx4 v[36:39], v8, s[8:11], s70 offen offset:768
buffer_load_dwordx4 v[40:43], v8, s[8:11], s70 offen offset:1024
buffer_load_dwordx4 v[44:47], v8, s[8:11], s70 offen offset:1280
buffer_load_dwordx4 v[48:51], v8, s[8:11], s70 offen offset:1536
buffer_load_dwordx4 v[52:55], v8, s[8:11], s70 offen offset:1792
v_lshlrev_b32 v9, 4, v1
s_waitcnt vmcnt(7)
v_mfma_f32_16x16x32_bf16 v[16:19], v[24:27], v[252:255], 0
v_mfma_f32_16x16x32_bf16 v[20:23], v[24:27], v[24:27], 0
s_waitcnt vmcnt(6)
v_mfma_f32_16x16x32_bf16 v[16:19], v[28:31], v[252:255], v[16:19]
v_mfma_f32_16x16x32_bf16 v[20:23], v[28:31], v[28:31], v[20:23]
s_waitcnt vmcnt(5)
v_mfma_f32_16x16x32_bf16 v[16:19], v[32:35], v[252:255], v[16:19]
v_mfma_f32_16x16x32_bf16 v[20:23], v[32:35], v[32:35], v[20:23]
s_waitcnt vmcnt(4)
v_mfma_f32_16x16x32_bf16 v[16:19], v[36:39], v[252:255], v[16:19]
v_mfma_f32_16x16x32_bf16 v[20:23], v[36:39], v[36:39], v[20:23]
s_waitcnt vmcnt(3)
v_mfma_f32_16x16x32_bf16 v[16:19], v[40:43], v[252:255], v[16:19]
v_mfma_f32_16x16x32_bf16 v[20:23], v[40:43], v[40:43], v[20:23]
s_waitcnt vmcnt(2)
v_mfma_f32_16x16x32_bf16 v[16:19], v[44:47], v[252:255], v[16:19]
v_mfma_f32_16x16x32_bf16 v[20:23], v[44:47], v[44:47], v[20:23]
s_waitcnt vmcnt(1)
v_mfma_f32_16x16x32_bf16 v[16:19], v[48:51], v[252:255], v[16:19]
v_mfma_f32_16x16x32_bf16 v[20:23], v[48:51], v[48:51], v[20:23]
s_waitcnt vmcnt(0)
v_mfma_f32_16x16x32_bf16 v[16:19], v[52:55], v[252:255], v[16:19]
v_mfma_f32_16x16x32_bf16 v[20:23], v[52:55], v[52:55], v[20:23]
s_nop 6
v_add_f32 v16, v16, v18
v_add_f32 v17, v17, v19
v_add_f32 v16, v16, v17
s_nop 0
v_mov_b32_dpp v17, v20 quad_perm:[0,0,0,0] row_mask:0xf bank_mask:0xf
s_nop 1
v_add_f32_dpp v17, v21, v17 quad_perm:[1,1,1,1] row_mask:0xf bank_mask:0xf
s_nop 1
v_add_f32_dpp v17, v22, v17 quad_perm:[2,2,2,2] row_mask:0xf bank_mask:0xf
s_nop 1
v_add_f32_dpp v17, v23, v17 quad_perm:[3,3,3,3] row_mask:0xf bank_mask:0xf
v_mul_f32 v5, 0xba800000, v16
v_mul_f32 v17, 0x3a800000, v17
v_fma_f32 v17, -v5, v5, v17
v_max_f32 v17, 0, v17
v_add_f32 v17, 0x3727c5ac, v17
v_rsq_f32 v16, v17
s_nop 0
v_mul_f32 v17, v5, v16
v_max_u32 v17, 1, v17
s_lshl_b32 s70, s60, 7
s_add_u32 s70, s70, s76
s_lshl_b32 s73, s58, 5
s_add_u32 s70, s70, s73
v_lshrrev_b32 v7, 1, v7
s_add_u32 s35, s34, 5
lw_85:
ds_read_b32 v5, v2 offset:16
s_waitcnt lgkmcnt(0)
v_cmp_gt_i32 vcc, s35, v5
s_cbranch_vccz lwd_86
s_sleep 4
s_sub_u32 s32, s32, 1
s_cmp_gt_i32 s32, 0
s_cbranch_scc1 lw_85
lwd_86:
poll_87:
buffer_load_dword v12, v9, s[4:7], 0 offen sc1
pchk_88:
s_waitcnt vmcnt(0)
v_cmp_gt_u32 vcc, 64, v12
s_cbranch_vccz pdone_89
s_sleep 16
s_sub_u32 s32, s32, 1
s_cmp_gt_i32 s32, 0
s_cbranch_scc1 poll_87
pdone_89:
s_mov_b32 exec_lo, 0x00100001
s_mov_b32 exec_hi, 0x10000100
buffer_store_dwordx2 v[16:17], v7, s[24:27], s70 offen sc1
s_mov_b64 exec, -1
s_branch fsb_41
fg_44:
s_lshl1_add_u32 s35, s2, s58
s_lshl_b32 s35, s35, 12
s_add_u32 s44, s40, s35
s_addc_u32 s45, s41, 0
s_mov_b32 s35, 4
ft_90:
s_load_dwordx2 s[42:43], s[44:45], 60
s_load_dwordx2 s[42:43], s[44:45], 188
s_load_dwordx2 s[42:43], s[44:45], 316
s_load_dwordx2 s[42:43], s[44:45], 444
s_load_dwordx2 s[42:43], s[44:45], 572
s_load_dwordx2 s[42:43], s[44:45], 700
s_load_dwordx2 s[42:43], s[44:45], 828
s_load_dwordx2 s[42:43], s[44:45], 956
s_add_u32 s44, s44, 1024
s_addc_u32 s45, s45, 0
s_sub_u32 s35, s35, 1
s_cmp_eq_u32 s35, 0
s_cbranch_scc0 ft_90
v_lshrrev_b32 v250, 3, v0
v_mul_u32_u24 v250, 16256, v250
v_add_u32 v250, v250, v4
s_add_u32 s35, s66, 131072
buffer_load_dwordx4 v[184:187], v250, s[12:15], s35 offen nt
s_add_u32 s35, s66, 133120
buffer_load_dwordx4 v[188:191], v250, s[12:15], s35 offen nt
s_add_u32 s35, s66, 135168
buffer_load_dwordx4 v[192:195], v250, s[12:15], s35 offen nt
s_add_u32 s35, s66, 137216
buffer_load_dwordx4 v[196:199], v250, s[12:15], s35 offen nt
s_add_u32 s35, s66, 139264
buffer_load_dwordx4 v[200:203], v250, s[12:15], s35 offen nt
s_add_u32 s35, s66, 141312
buffer_load_dwordx4 v[204:207], v250, s[12:15], s35 offen nt
s_add_u32 s35, s66, 143360
buffer_load_dwordx4 v[208:211], v250, s[12:15], s35 offen nt
s_add_u32 s35, s66, 145408
buffer_load_dwordx4 v[212:215], v250, s[12:15], s35 offen nt
v_lshrrev_b32 v250, 3, v0
v_mul_u32_u24 v250, 16256, v250
v_add_u32 v250, v250, v4
s_add_u32 s35, s66, 0
buffer_load_dwordx4 v[152:155], v250, s[12:15], s35 offen nt
s_add_u32 s35, s66, 2048
buffer_load_dwordx4 v[156:159], v250, s[12:15], s35 offen nt
s_add_u32 s35, s66, 4096
buffer_load_dwordx4 v[160:163], v250, s[12:15], s35 offen nt
s_add_u32 s35, s66, 6144
buffer_load_dwordx4 v[164:167], v250, s[12:15], s35 offen nt
s_add_u32 s35, s66, 8192
buffer_load_dwordx4 v[168:171], v250, s[12:15], s35 offen nt
s_add_u32 s35, s66, 10240
buffer_load_dwordx4 v[172:175], v250, s[12:15], s35 offen nt
s_add_u32 s35, s66, 12288
buffer_load_dwordx4 v[176:179], v250, s[12:15], s35 offen nt
s_add_u32 s35, s66, 14336
buffer_load_dwordx4 v[180:183], v250, s[12:15], s35 offen nt
s_add_u32 s35, s34, 10
lw_91:
ds_read_b32 v5, v2 offset:16
s_waitcnt lgkmcnt(0)
v_cmp_gt_i32 vcc, s35, v5
s_cbranch_vccz lwd_92
s_sleep 4
s_sub_u32 s32, s32, 1
s_cmp_gt_i32 s32, 0
s_cbranch_scc1 lw_91
lwd_92:
s_branch fg_45
fnw_53:
v_mov_b32 v252, 0
v_mov_b32 v253, 0
v_mov_b32 v254, 0
v_mov_b32 v255, 0
s_mul_i32 s42, s58, 1409024
s_mul_i32 s35, s78, 2048
s_add_u32 s35, s35, s42
s_add_u32 s35, s35, 524288
buffer_store_dwordx4 v[252:255], v4, s[24:27], s35 offen offset:0 sc1
buffer_store_dwordx4 v[252:255], v4, s[24:27], s35 offen offset:1024 sc1
s_mul_i32 s35, s78, 1408
s_add_u32 s35, s35, s42
s_add_u32 s35, s35, 1048576
buffer_store_dwordx4 v[252:255], v4, s[24:27], s35 offen offset:0 sc1
buffer_store_dwordx4 v[252:255], v4, s[24:27], s35 offen offset:384 sc1
s_lshl_b32 s35, s78, 10
s_add_u32 s35, s35, 1409024
s_cmp_eq_u32 s58, 1
s_cselect_b64 exec, -1, 0
buffer_store_dwordx4 v[252:255], v4, s[24:27], s35 offen offset:0 sc1
s_add_u32 s35, s35, 262144
buffer_store_dwordx4 v[252:255], v4, s[24:27], s35 offen offset:0 sc1
s_mov_b64 exec, -1
s_waitcnt vmcnt(0)
v_add_u32 v5, s34, 3
s_mov_b64 exec, 1
ds_write_b32 v3, v5
s_mov_b64 exec, -1
s_add_u32 s35, s34, 17
lw_93:
ds_read_b32 v5, v2 offset:16
s_waitcnt lgkmcnt(0)
v_cmp_gt_i32 vcc, s35, v5
s_cbranch_vccz lwd_94
s_sleep 4
s_sub_u32 s32, s32, 1
s_cmp_gt_i32 s32, 0
s_cbranch_scc1 lw_93
lwd_94:
v_lshrrev_b32 v250, 4, v0
v_mul_u32_u24 v250, 28416, v250
v_add_u32 v250, v250, v4
s_add_u32 s35, s77, 688128
buffer_load_dwordx4 v[120:123], v250, s[16:19], s35 offen nt
s_add_u32 s35, s77, 695296
buffer_load_dwordx4 v[124:127], v250, s[16:19], s35 offen nt
s_add_u32 s35, s77, 702464
buffer_load_dwordx4 v[128:131], v250, s[16:19], s35 offen nt
s_add_u32 s35, s77, 709632
buffer_load_dwordx4 v[132:135], v250, s[16:19], s35 offen nt
s_add_u32 s35, s77, 802816
buffer_load_dwordx4 v[136:139], v250, s[16:19], s35 offen nt
s_add_u32 s35, s77, 809984
buffer_load_dwordx4 v[140:143], v250, s[16:19], s35 offen nt
s_add_u32 s35, s77, 817152
buffer_load_dwordx4 v[144:147], v250, s[16:19], s35 offen nt
s_add_u32 s35, s77, 824320
buffer_load_dwordx4 v[148:151], v250, s[16:19], s35 offen nt
v_lshrrev_b32 v250, 4, v0
v_mul_u32_u24 v250, 28416, v250
v_add_u32 v250, v250, v4
s_add_u32 s35, s77, 458752
buffer_load_dwordx4 v[88:91], v250, s[16:19], s35 offen nt
s_add_u32 s35, s77, 465920
buffer_load_dwordx4 v[92:95], v250, s[16:19], s35 offen nt
s_add_u32 s35, s77, 473088
buffer_load_dwordx4 v[96:99], v250, s[16:19], s35 offen nt
s_add_u32 s35, s77, 480256
buffer_load_dwordx4 v[100:103], v250, s[16:19], s35 offen nt
s_add_u32 s35, s77, 573440
buffer_load_dwordx4 v[104:107], v250, s[16:19], s35 offen nt
s_add_u32 s35, s77, 580608
buffer_load_dwordx4 v[108:111], v250, s[16:19], s35 offen nt
s_add_u32 s35, s77, 587776
buffer_load_dwordx4 v[112:115], v250, s[16:19], s35 offen nt
s_add_u32 s35, s77, 594944
buffer_load_dwordx4 v[116:119], v250, s[16:19], s35 offen nt
v_lshrrev_b32 v250, 4, v0
v_mul_u32_u24 v250, 28416, v250
v_add_u32 v250, v250, v4
s_add_u32 s35, s77, 229376
buffer_load_dwordx4 v[56:59], v250, s[16:19], s35 offen nt
s_add_u32 s35, s77, 236544
buffer_load_dwordx4 v[60:63], v250, s[16:19], s35 offen nt
s_add_u32 s35, s77, 243712
buffer_load_dwordx4 v[64:67], v250, s[16:19], s35 offen nt
s_add_u32 s35, s77, 250880
buffer_load_dwordx4 v[68:71], v250, s[16:19], s35 offen nt
s_add_u32 s35, s77, 344064
buffer_load_dwordx4 v[72:75], v250, s[16:19], s35 offen nt
s_add_u32 s35, s77, 351232
buffer_load_dwordx4 v[76:79], v250, s[16:19], s35 offen nt
s_add_u32 s35, s77, 358400
buffer_load_dwordx4 v[80:83], v250, s[16:19], s35 offen nt
s_add_u32 s35, s77, 365568
buffer_load_dwordx4 v[84:87], v250, s[16:19], s35 offen nt
v_lshrrev_b32 v250, 4, v0
v_mul_u32_u24 v250, 28416, v250
v_add_u32 v250, v250, v4
s_add_u32 s35, s77, 0
buffer_load_dwordx4 v[24:27], v250, s[16:19], s35 offen nt
s_add_u32 s35, s77, 7168
buffer_load_dwordx4 v[28:31], v250, s[16:19], s35 offen nt
s_add_u32 s35, s77, 14336
buffer_load_dwordx4 v[32:35], v250, s[16:19], s35 offen nt
s_add_u32 s35, s77, 21504
buffer_load_dwordx4 v[36:39], v250, s[16:19], s35 offen nt
s_add_u32 s35, s77, 114688
buffer_load_dwordx4 v[40:43], v250, s[16:19], s35 offen nt
s_add_u32 s35, s77, 121856
buffer_load_dwordx4 v[44:47], v250, s[16:19], s35 offen nt
s_add_u32 s35, s77, 129024
buffer_load_dwordx4 v[48:51], v250, s[16:19], s35 offen nt
s_add_u32 s35, s77, 136192
buffer_load_dwordx4 v[52:55], v250, s[16:19], s35 offen nt
s_mov_b32 s42, 0x05040100
s_mov_b32 s43, 0x07060302
s_cmp_eq_u32 s65, 0
s_cbranch_scc0 fq_95
v_perm_b32 v216, v188, v184, s42
v_perm_b32 v220, v188, v184, s43
v_perm_b32 v224, v189, v185, s42
v_perm_b32 v228, v189, v185, s43
v_perm_b32 v232, v190, v186, s42
v_perm_b32 v236, v190, v186, s43
v_perm_b32 v240, v191, v187, s42
v_perm_b32 v244, v191, v187, s43
v_perm_b32 v217, v196, v192, s42
v_perm_b32 v221, v196, v192, s43
v_perm_b32 v225, v197, v193, s42
v_perm_b32 v229, v197, v193, s43
v_perm_b32 v233, v198, v194, s42
v_perm_b32 v237, v198, v194, s43
v_perm_b32 v241, v199, v195, s42
v_perm_b32 v245, v199, v195, s43
v_perm_b32 v218, v204, v200, s42
v_perm_b32 v222, v204, v200, s43
v_perm_b32 v226, v205, v201, s42
v_perm_b32 v230, v205, v201, s43
v_perm_b32 v234, v206, v202, s42
v_perm_b32 v238, v206, v202, s43
v_perm_b32 v242, v207, v203, s42
v_perm_b32 v246, v207, v203, s43
v_perm_b32 v219, v212, v208, s42
v_perm_b32 v223, v212, v208, s43
v_perm_b32 v227, v213, v209, s42
v_perm_b32 v231, v213, v209, s43
v_perm_b32 v235, v214, v210, s42
v_perm_b32 v239, v214, v210, s43
v_perm_b32 v243, v215, v211, s42
v_perm_b32 v247, v215, v211, s43
v_perm_b32 v184, v156, v152, s42
v_perm_b32 v188, v156, v152, s43
v_perm_b32 v192, v157, v153, s42
v_perm_b32 v196, v157, v153, s43
v_perm_b32 v200, v158, v154, s42
v_perm_b32 v204, v158, v154, s43
v_perm_b32 v208, v159, v155, s42
v_perm_b32 v212, v159, v155, s43
v_perm_b32 v185, v164, v160, s42
v_perm_b32 v189, v164, v160, s43
v_perm_b32 v193, v165, v161, s42
v_perm_b32 v197, v165, v161, s43
v_perm_b32 v201, v166, v162, s42
v_perm_b32 v205, v166, v162, s43
v_perm_b32 v209, v167, v163, s42
v_perm_b32 v213, v167, v163, s43
v_perm_b32 v186, v172, v168, s42
v_perm_b32 v190, v172, v168, s43
v_perm_b32 v194, v173, v169, s42
v_perm_b32 v198, v173, v169, s43
v_perm_b32 v202, v174, v170, s42
v_perm_b32 v206, v174, v170, s43
v_perm_b32 v210, v175, v171, s42
v_perm_b32 v214, v175, v171, s43
v_perm_b32 v187, v180, v176, s42
v_perm_b32 v191, v180, v176, s43
v_perm_b32 v195, v181, v177, s42
v_perm_b32 v199, v181, v177, s43
v_perm_b32 v203, v182, v178, s42
v_perm_b32 v207, v182, v178, s43
v_perm_b32 v211, v183, v179, s42
v_perm_b32 v215, v183, v179, s43
s_waitcnt vmcnt(30)
v_perm_b32 v152, v124, v120, s42
v_perm_b32 v156, v124, v120, s43
v_perm_b32 v160, v125, v121, s42
v_perm_b32 v164, v125, v121, s43
v_perm_b32 v168, v126, v122, s42
v_perm_b32 v172, v126, v122, s43
v_perm_b32 v176, v127, v123, s42
v_perm_b32 v180, v127, v123, s43
s_waitcnt vmcnt(28)
v_perm_b32 v153, v132, v128, s42
v_perm_b32 v157, v132, v128, s43
v_perm_b32 v161, v133, v129, s42
v_perm_b32 v165, v133, v129, s43
v_perm_b32 v169, v134, v130, s42
v_perm_b32 v173, v134, v130, s43
v_perm_b32 v177, v135, v131, s42
v_perm_b32 v181, v135, v131, s43
s_waitcnt vmcnt(26)
v_perm_b32 v154, v140, v136, s42
v_perm_b32 v158, v140, v136, s43
v_perm_b32 v162, v141, v137, s42
v_perm_b32 v166, v141, v137, s43
v_perm_b32 v170, v142, v138, s42
v_perm_b32 v174, v142, v138, s43
v_perm_b32 v178, v143, v139, s42
v_perm_b32 v182, v143, v139, s43
s_waitcnt vmcnt(24)
v_perm_b32 v155, v148, v144, s42
v_perm_b32 v159, v148, v144, s43
v_perm_b32 v163, v149, v145, s42
v_perm_b32 v167, v149, v145, s43
v_perm_b32 v171, v150, v146, s42
v_perm_b32 v175, v150, v146, s43
v_perm_b32 v179, v151, v147, s42
v_perm_b32 v183, v151, v147, s43
s_waitcnt vmcnt(22)
v_perm_b32 v120, v92, v88, s42
v_perm_b32 v124, v92, v88, s43
v_perm_b32 v128, v93, v89, s42
v_perm_b32 v132, v93, v89, s43
v_perm_b32 v136, v94, v90, s42
v_perm_b32 v140, v94, v90, s43
v_perm_b32 v144, v95, v91, s42
v_perm_b32 v148, v95, v91, s43
s_waitcnt vmcnt(20)
v_perm_b32 v121, v100, v96, s42
v_perm_b32 v125, v100, v96, s43
v_perm_b32 v129, v101, v97, s42
v_perm_b32 v133, v101, v97, s43
v_perm_b32 v137, v102, v98, s42
v_perm_b32 v141, v102, v98, s43
v_perm_b32 v145, v103, v99, s42
v_perm_b32 v149, v103, v99, s43
s_waitcnt vmcnt(18)
v_perm_b32 v122, v108, v104, s42
v_perm_b32 v126, v108, v104, s43
v_perm_b32 v130, v109, v105, s42
v_perm_b32 v134, v109, v105, s43
v_perm_b32 v138, v110, v106, s42
v_perm_b32 v142, v110, v106, s43
v_perm_b32 v146, v111, v107, s42
v_perm_b32 v150, v111, v107, s43
s_waitcnt vmcnt(16)
v_perm_b32 v123, v116, v112, s42
v_perm_b32 v127, v116, v112, s43
v_perm_b32 v131, v117, v113, s42
v_perm_b32 v135, v117, v113, s43
v_perm_b32 v139, v118, v114, s42
v_perm_b32 v143, v118, v114, s43
v_perm_b32 v147, v119, v115, s42
v_perm_b32 v151, v119, v115, s43
s_waitcnt vmcnt(14)
v_perm_b32 v88, v60, v56, s42
v_perm_b32 v92, v60, v56, s43
v_perm_b32 v96, v61, v57, s42
v_perm_b32 v100, v61, v57, s43
v_perm_b32 v104, v62, v58, s42
v_perm_b32 v108, v62, v58, s43
v_perm_b32 v112, v63, v59, s42
v_perm_b32 v116, v63, v59, s43
s_waitcnt vmcnt(12)
v_perm_b32 v89, v68, v64, s42
v_perm_b32 v93, v68, v64, s43
v_perm_b32 v97, v69, v65, s42
v_perm_b32 v101, v69, v65, s43
v_perm_b32 v105, v70, v66, s42
v_perm_b32 v109, v70, v66, s43
v_perm_b32 v113, v71, v67, s42
v_perm_b32 v117, v71, v67, s43
s_waitcnt vmcnt(10)
v_perm_b32 v90, v76, v72, s42
v_perm_b32 v94, v76, v72, s43
v_perm_b32 v98, v77, v73, s42
v_perm_b32 v102, v77, v73, s43
v_perm_b32 v106, v78, v74, s42
v_perm_b32 v110, v78, v74, s43
v_perm_b32 v114, v79, v75, s42
v_perm_b32 v118, v79, v75, s43
s_waitcnt vmcnt(8)
v_perm_b32 v91, v84, v80, s42
v_perm_b32 v95, v84, v80, s43
v_perm_b32 v99, v85, v81, s42
v_perm_b32 v103, v85, v81, s43
v_perm_b32 v107, v86, v82, s42
v_perm_b32 v111, v86, v82, s43
v_perm_b32 v115, v87, v83, s42
v_perm_b32 v119, v87, v83, s43
s_waitcnt vmcnt(6)
v_perm_b32 v56, v28, v24, s42
v_perm_b32 v60, v28, v24, s43
v_perm_b32 v64, v29, v25, s42
v_perm_b32 v68, v29, v25, s43
v_perm_b32 v72, v30, v26, s42
v_perm_b32 v76, v30, v26, s43
v_perm_b32 v80, v31, v27, s42
v_perm_b32 v84, v31, v27, s43
s_waitcnt vmcnt(4)
v_perm_b32 v57, v36, v32, s42
v_perm_b32 v61, v36, v32, s43
v_perm_b32 v65, v37, v33, s42
v_perm_b32 v69, v37, v33, s43
v_perm_b32 v73, v38, v34, s42
v_perm_b32 v77, v38, v34, s43
v_perm_b32 v81, v39, v35, s42
v_perm_b32 v85, v39, v35, s43
s_waitcnt vmcnt(2)
v_perm_b32 v58, v44, v40, s42
v_perm_b32 v62, v44, v40, s43
v_perm_b32 v66, v45, v41, s42
v_perm_b32 v70, v45, v41, s43
v_perm_b32 v74, v46, v42, s42
v_perm_b32 v78, v46, v42, s43
v_perm_b32 v82, v47, v43, s42
v_perm_b32 v86, v47, v43, s43
s_waitcnt vmcnt(0)
v_perm_b32 v59, v52, v48, s42
v_perm_b32 v63, v52, v48, s43
v_perm_b32 v67, v53, v49, s42
v_perm_b32 v71, v53, v49, s43
v_perm_b32 v75, v54, v50, s42
v_perm_b32 v79, v54, v50, s43
v_perm_b32 v83, v55, v51, s42
v_perm_b32 v87, v55, v51, s43
fq_95:
s_branch fnw_54
fnd_60:
poll_96:
buffer_load_dwordx2 v[248:249], v6, s[24:27], s73 offen sc1
pchk_97:
s_waitcnt vmcnt(0)
v_min_u32 v5, v248, v249
v_cmp_eq_u32 vcc, 0, v5
s_cbranch_vccz pdone_98
s_sleep 1
s_sub_u32 s32, s32, 1
s_cmp_gt_i32 s32, 0
s_cbranch_scc1 poll_96
pdone_98:
v_mov_b32 v250, v248
s_nop 1
v_max_f32_dpp v250, v250, v250 row_ror:1 row_mask:0xf bank_mask:0xf
s_nop 1
v_max_f32_dpp v250, v250, v250 row_ror:2 row_mask:0xf bank_mask:0xf
s_nop 1
v_max_f32_dpp v250, v250, v250 row_ror:4 row_mask:0xf bank_mask:0xf
s_nop 1
v_max_f32_dpp v250, v250, v250 row_ror:8 row_mask:0xf bank_mask:0xf
v_cmp_eq_f32 vcc, v250, v248
s_ff1_i32_b64 s68, vcc
s_and_b32 s68, s68, 15
v_readlane_b32 s33, v249, s68
v_readlane_b32 s67, v248, s68
v_add_u32 v5, s34, 4
v_mov_b32 v250, s33
s_mov_b64 exec, 1
ds_write2_b32 v3, v5, v250 offset1:2
s_mov_b64 exec, -1
s_sub_u32 s33, s33, 1
s_and_b32 s33, s33, 2047
s_branch fnd_59
fpre_77:
poll_99:
buffer_load_dwordx4 v[24:27], v4, s[24:27], s72 offen offset:0 sc1
pchk_100:
s_waitcnt vmcnt(0)
v_min3_u32 v5, v24, v25, v26
v_min_u32 v5, v5, v27
v_cmp_eq_u32 vcc, 0, v5
s_cbranch_vccz pdone_101
s_sleep 8
s_sub_u32 s32, s32, 1
s_cmp_gt_i32 s32, 0
s_cbranch_scc1 poll_99
pdone_101:
s_branch fpre_78
L_m:
s_setprio 2
v_mov_b32 v6, 0
v_mov_b32 v7, 0
v_lshlrev_b32 v8, 3, v0
ds_write_b64 v8, v[6:7]
s_waitcnt lgkmcnt(0)
s_barrier
s_lshr_b32 s64, s58, 1
s_and_b32 s65, s58, 1
v_and_b32 v1, 3, v0
v_lshlrev_b32 v1, 2, v1
v_and_b32 v2, 4, v1
s_lshl2_add_u32 s35, s58, 0
v_mov_b32 v3, s35
s_mov_b32 s4, s44
s_mov_b32 s5, s45
s_mov_b32 s6, 0x800
s_mov_b32 s7, 0x00020000
v_lshrrev_b32 v6, 4, v0
v_lshlrev_b32 v6, 3, v6
s_lshl_b32 s66, s62, 7
buffer_load_dwordx2 v[232:233], v6, s[4:7], s66 offen offset:0
buffer_load_dwordx2 v[234:235], v6, s[4:7], s66 offen offset:32
buffer_load_dwordx2 v[236:237], v6, s[4:7], s66 offen offset:64
buffer_load_dwordx2 v[238:239], v6, s[4:7], s66 offen offset:96
v_and_b32 v6, 31, v0
v_lshrrev_b32 v7, 5, v0
v_lshlrev_b32 v7, 3, v7
v_sub_u32 v6, v6, v7
v_mov_b32 v7, 0xf149f2ca
v_cmp_le_i32 vcc, 0, v6
s_nop 1
v_cndmask_b32 v216, 0, v7, vcc
v_cmp_le_i32 vcc, 1, v6
s_nop 1
v_cndmask_b32 v217, 0, v7, vcc
v_cmp_le_i32 vcc, 2, v6
s_nop 1
v_cndmask_b32 v218, 0, v7, vcc
v_cmp_le_i32 vcc, 3, v6
s_nop 1
v_cndmask_b32 v219, 0, v7, vcc
v_cmp_le_i32 vcc, 16, v6
s_nop 1
v_cndmask_b32 v220, 0, v7, vcc
v_cmp_le_i32 vcc, 17, v6
s_nop 1
v_cndmask_b32 v221, 0, v7, vcc
v_cmp_le_i32 vcc, 18, v6
s_nop 1
v_cndmask_b32 v222, 0, v7, vcc
v_cmp_le_i32 vcc, 19, v6
s_nop 1
v_cndmask_b32 v223, 0, v7, vcc
v_cmp_le_i32 vcc, 4, v6
s_nop 1
v_cndmask_b32 v224, 0, v7, vcc
v_cmp_le_i32 vcc, 5, v6
s_nop 1
v_cndmask_b32 v225, 0, v7, vcc
v_cmp_le_i32 vcc, 6, v6
s_nop 1
v_cndmask_b32 v226, 0, v7, vcc
v_cmp_le_i32 vcc, 7, v6
s_nop 1
v_cndmask_b32 v227, 0, v7, vcc
v_cmp_le_i32 vcc, 20, v6
s_nop 1
v_cndmask_b32 v228, 0, v7, vcc
v_cmp_le_i32 vcc, 21, v6
s_nop 1
v_cndmask_b32 v229, 0, v7, vcc
v_cmp_le_i32 vcc, 22, v6
s_nop 1
v_cndmask_b32 v230, 0, v7, vcc
v_cmp_le_i32 vcc, 23, v6
s_nop 1
v_cndmask_b32 v231, 0, v7, vcc
v_lshrrev_b32 v6, 2, v0
v_xor_b32 v6, v6, v0
v_and_b32 v6, 4, v6
v_mov_b32 v7, 0x3f803f80
v_cmp_eq_u32 vcc, 0, v6
s_nop 1
v_cndmask_b32 v212, 0, v7, vcc
v_cndmask_b32 v213, 0, v7, vcc
v_cndmask_b32 v214, 0, v7, vcc
v_cndmask_b32 v215, 0, v7, vcc
L_mtop:
v_lshrrev_b32 v10, 4, v0
s_cmp_eq_u32 s63, 0
s_cbranch_scc0 mq_102
v_bfe_u32 v11, v0, 1, 3
v_xor_b32 v11, v11, v10
v_lshlrev_b32 v11, 4, v11
v_and_b32 v12, 15, v0
v_lshl_add_u32 v6, v12, 7, v11
v_xor_b32 v7, 64, v6
s_branch mq_103
mq_102:
v_lshlrev_b32 v6, 4, v0
v_add_u32 v7, 1024, v6
mq_103:
s_lshl_b32 s66, s65, 13
s_add_u32 s66, s66, 86016
v_add_u32 v6, s66, v6
v_add_u32 v7, s66, v7
v_bfe_u32 v11, v0, 2, 2
v_lshl_add_u32 v11, v10, 3, v11
v_bfe_u32 v12, v0, 3, 2
s_lshl_b32 s66, s64, 1
v_xor_b32 v12, s66, v12
v_lshlrev_b32 v12, 5, v12
v_lshl_add_u32 v11, v11, 7, v12
v_and_b32 v12, 3, v0
v_lshl_add_u32 v11, v12, 3, v11
v_add_u32 v8, 102400, v11
v_xor_b32 v9, 32, v8
v_mov_b32 v11, 0xf149f2ca
v_xor_b32 v216, v11, v216
v_xor_b32 v217, v11, v217
v_xor_b32 v218, v11, v218
v_xor_b32 v219, v11, v219
v_xor_b32 v220, v11, v220
v_xor_b32 v221, v11, v221
v_xor_b32 v222, v11, v222
v_xor_b32 v223, v11, v223
v_xor_b32 v224, v11, v224
v_xor_b32 v225, v11, v225
v_xor_b32 v226, v11, v226
v_xor_b32 v227, v11, v227
v_xor_b32 v228, v11, v228
v_xor_b32 v229, v11, v229
v_xor_b32 v230, v11, v230
v_xor_b32 v231, v11, v231
v_mov_b32 v16, 0
v_mov_b32 v17, 0
v_mov_b32 v18, 0
v_mov_b32 v19, 0
v_mov_b32 v20, 0
v_mov_b32 v21, 0
v_mov_b32 v22, 0
v_mov_b32 v23, 0
v_mov_b32 v24, 0
v_mov_b32 v25, 0
v_mov_b32 v26, 0
v_mov_b32 v27, 0
v_mov_b32 v28, 0
v_mov_b32 v29, 0
v_mov_b32 v30, 0
v_mov_b32 v31, 0
v_mov_b32 v32, 0
v_mov_b32 v33, 0
v_mov_b32 v34, 0
v_mov_b32 v35, 0
v_mov_b32 v36, 0
v_mov_b32 v37, 0
v_mov_b32 v38, 0
v_mov_b32 v39, 0
v_mov_b32 v40, 0
v_mov_b32 v41, 0
v_mov_b32 v42, 0
v_mov_b32 v43, 0
v_mov_b32 v44, 0
v_mov_b32 v45, 0
v_mov_b32 v46, 0
v_mov_b32 v47, 0
v_mov_b32 v48, 0
v_mov_b32 v49, 0
v_mov_b32 v50, 0
v_mov_b32 v51, 0
v_mov_b32 v52, 0
v_mov_b32 v53, 0
v_mov_b32 v54, 0
v_mov_b32 v55, 0
v_mov_b32 v56, 0
v_mov_b32 v57, 0
v_mov_b32 v58, 0
v_mov_b32 v59, 0
v_mov_b32 v60, 0
v_mov_b32 v61, 0
v_mov_b32 v62, 0
v_mov_b32 v63, 0
v_mov_b32 v64, 0
v_mov_b32 v65, 0
v_mov_b32 v66, 0
v_mov_b32 v67, 0
v_mov_b32 v68, 0
v_mov_b32 v69, 0
v_mov_b32 v70, 0
v_mov_b32 v71, 0
v_mov_b32 v72, 0
v_mov_b32 v73, 0
v_mov_b32 v74, 0
v_mov_b32 v75, 0
v_mov_b32 v76, 0
v_mov_b32 v77, 0
v_mov_b32 v78, 0
v_mov_b32 v79, 0
v_mov_b32 v80, 0
v_mov_b32 v81, 0
v_mov_b32 v82, 0
v_mov_b32 v83, 0
v_mov_b32 v84, 0
v_mov_b32 v85, 0
v_mov_b32 v86, 0
v_mov_b32 v87, 0
v_mov_b32 v88, 0
v_mov_b32 v89, 0
v_mov_b32 v90, 0
v_mov_b32 v91, 0
v_mov_b32 v92, 0
v_mov_b32 v93, 0
v_mov_b32 v94, 0
v_mov_b32 v95, 0
v_mov_b32 v96, 0
v_mov_b32 v97, 0
v_mov_b32 v98, 0
v_mov_b32 v99, 0
v_mov_b32 v100, 0
v_mov_b32 v101, 0
v_mov_b32 v102, 0
v_mov_b32 v103, 0
v_mov_b32 v104, 0
v_mov_b32 v105, 0
v_mov_b32 v106, 0
v_mov_b32 v107, 0
v_mov_b32 v108, 0
v_mov_b32 v109, 0
v_mov_b32 v110, 0
v_mov_b32 v111, 0
v_mov_b32 v192, 0
v_mov_b32 v193, 0
v_mov_b32 v194, 0
v_mov_b32 v195, 0
v_mov_b32 v196, 0
v_mov_b32 v197, 0
v_mov_b32 v198, 0
v_mov_b32 v199, 0
v_mov_b32 v200, 0
v_mov_b32 v201, 0
v_mov_b32 v202, 0
v_mov_b32 v203, 0
v_mov_b32 v204, 0
v_mov_b32 v205, 0
v_mov_b32 v206, 0
v_mov_b32 v207, 0
v_mov_b32 v208, 0
v_mov_b32 v209, 0
v_mov_b32 v210, 0
v_mov_b32 v211, 0
v_add_u32 v4, s34, 1
s_mov_b32 s66, 16
s_mov_b32 s67, -40960
s_mov_b32 s68, -40960
s_mov_b32 s69, 81920
s_add_u32 s35, s34, 1
lw_104:
ds_read_b32 v5, v2 offset:16
s_waitcnt lgkmcnt(0)
v_cmp_gt_i32 vcc, s35, v5
s_cbranch_vccz lwd_105
s_sub_u32 s32, s32, 1
s_cmp_gt_i32 s32, 0
s_cbranch_scc1 lw_104
lwd_105:
ds_read_b64_tr_b16 v[144:145], v8 offset:8192
ds_read_b64_tr_b16 v[146:147], v8 offset:8704
ds_read_b64_tr_b16 v[148:149], v8 offset:12288
ds_read_b64_tr_b16 v[150:151], v8 offset:12800
ds_read_b128 v[112:115], v6 offset:0
ds_read_b128 v[116:119], v7 offset:0
ds_read_b64_tr_b16 v[152:153], v9 offset:8192
ds_read_b64_tr_b16 v[154:155], v9 offset:8704
ds_read_b64_tr_b16 v[156:157], v9 offset:12288
ds_read_b64_tr_b16 v[158:159], v9 offset:12800
ds_read_b128 v[120:123], v6 offset:2048
ds_read_b128 v[124:127], v7 offset:2048
ds_read_b128 v[128:131], v6 offset:4096
ds_read_b128 v[132:135], v7 offset:4096
ds_read_b128 v[136:139], v6 offset:6144
ds_read_b128 v[140:143], v7 offset:6144
.p2align 6
mqkv_106:
s_waitcnt lgkmcnt(7)
v_mfma_f32_16x16x32_bf16 v[16:19], v[144:147], v[112:115], v[16:19]
ds_read_b64_tr_b16 v[160:161], v8 offset:16384
s_waitcnt lgkmcnt(7)
v_mfma_f32_16x16x32_bf16 v[16:19], v[148:151], v[116:119], v[16:19]
ds_read_b64_tr_b16 v[162:163], v8 offset:16896
v_mfma_f32_16x16x32_bf16 v[20:23], v[152:155], v[112:115], v[20:23]
ds_read_b64_tr_b16 v[164:165], v8 offset:20480
v_mfma_f32_16x16x32_bf16 v[20:23], v[156:159], v[116:119], v[20:23]
ds_read_b64_tr_b16 v[166:167], v8 offset:20992
s_waitcnt lgkmcnt(9)
v_mfma_f32_16x16x32_bf16 v[24:27], v[144:147], v[120:123], v[24:27]
ds_read_b64_tr_b16 v[168:169], v9 offset:16384
s_waitcnt lgkmcnt(9)
v_mfma_f32_16x16x32_bf16 v[24:27], v[148:151], v[124:127], v[24:27]
ds_read_b64_tr_b16 v[170:171], v9 offset:16896
v_mfma_f32_16x16x32_bf16 v[28:31], v[152:155], v[120:123], v[28:31]
ds_read_b64_tr_b16 v[172:173], v9 offset:20480
v_mfma_f32_16x16x32_bf16 v[28:31], v[156:159], v[124:127], v[28:31]
ds_read_b64_tr_b16 v[174:175], v9 offset:20992
s_waitcnt lgkmcnt(11)
v_mfma_f32_16x16x32_bf16 v[32:35], v[144:147], v[128:131], v[32:35]
ds_read_b64_tr_b16 v[176:177], v8 offset:0
s_waitcnt lgkmcnt(11)
v_mfma_f32_16x16x32_bf16 v[32:35], v[148:151], v[132:135], v[32:35]
ds_read_b64_tr_b16 v[178:179], v8 offset:512
v_mfma_f32_16x16x32_bf16 v[36:39], v[152:155], v[128:131], v[36:39]
ds_read_b64_tr_b16 v[180:181], v8 offset:4096
v_mfma_f32_16x16x32_bf16 v[36:39], v[156:159], v[132:135], v[36:39]
ds_read_b64_tr_b16 v[182:183], v8 offset:4608
s_waitcnt lgkmcnt(13)
v_mfma_f32_16x16x32_bf16 v[40:43], v[144:147], v[136:139], v[40:43]
ds_read_b64_tr_b16 v[184:185], v9 offset:0
s_waitcnt lgkmcnt(13)
v_mfma_f32_16x16x32_bf16 v[40:43], v[148:151], v[140:143], v[40:43]
ds_read_b64_tr_b16 v[186:187], v9 offset:512
v_mfma_f32_16x16x32_bf16 v[44:47], v[152:155], v[136:139], v[44:47]
ds_read_b64_tr_b16 v[188:189], v9 offset:4096
v_mfma_f32_16x16x32_bf16 v[44:47], v[156:159], v[140:143], v[44:47]
ds_read_b64_tr_b16 v[190:191], v9 offset:4608
s_waitcnt lgkmcnt(14)
v_mfma_f32_16x16x32_bf16 v[48:51], v[112:115], v[160:163], v[48:51]
s_mov_b64 exec, 1
ds_write_b32 v3, v4
s_mov_b64 exec, -1
s_waitcnt lgkmcnt(13)
v_mfma_f32_16x16x32_bf16 v[48:51], v[116:119], v[164:167], v[48:51]
v_add_u32 v8, s67, v8
v_add_u32 v9, s67, v9
s_waitcnt lgkmcnt(11)
v_mfma_f32_16x16x32_bf16 v[52:55], v[112:115], v[168:171], v[52:55]
v_add_u32 v6, s67, v6
v_add_u32 v7, s67, v7
s_waitcnt lgkmcnt(9)
v_mfma_f32_16x16x32_bf16 v[52:55], v[116:119], v[172:175], v[52:55]
s_mov_b32 s70, s67
s_mov_b32 s67, s68
s_mov_b32 s68, s69
s_mov_b32 s69, s70
v_mfma_f32_16x16x32_bf16 v[56:59], v[120:123], v[160:163], v[56:59]
ds_read_b32 v5, v2 offset:16
v_mfma_f32_16x16x32_bf16 v[56:59], v[124:127], v[164:167], v[56:59]
v_mfma_f32_16x16x32_bf16 v[60:63], v[120:123], v[168:171], v[60:63]
v_mfma_f32_16x16x32_bf16 v[60:63], v[124:127], v[172:175], v[60:63]
v_mfma_f32_16x16x32_bf16 v[64:67], v[128:131], v[160:163], v[64:67]
s_waitcnt lgkmcnt(0)
v_cmp_ge_u32 vcc, v4, v5
s_cbranch_vccnz mspin_107
mback_108:
v_add_u32 v4, 1, v4
v_mfma_f32_16x16x32_bf16 v[64:67], v[132:135], v[164:167], v[64:67]
ds_read_b64_tr_b16 v[144:145], v8 offset:8192
v_mfma_f32_16x16x32_bf16 v[68:71], v[128:131], v[168:171], v[68:71]
ds_read_b64_tr_b16 v[146:147], v8 offset:8704
v_mfma_f32_16x16x32_bf16 v[68:71], v[132:135], v[172:175], v[68:71]
ds_read_b64_tr_b16 v[148:149], v8 offset:12288
v_mfma_f32_16x16x32_bf16 v[72:75], v[136:139], v[160:163], v[72:75]
ds_read_b64_tr_b16 v[150:151], v8 offset:12800
v_mfma_f32_16x16x32_bf16 v[72:75], v[140:143], v[164:167], v[72:75]
ds_read_b64_tr_b16 v[152:153], v9 offset:8192
v_mfma_f32_16x16x32_bf16 v[76:79], v[136:139], v[168:171], v[76:79]
ds_read_b64_tr_b16 v[154:155], v9 offset:8704
v_mfma_f32_16x16x32_bf16 v[76:79], v[140:143], v[172:175], v[76:79]
ds_read_b64_tr_b16 v[156:157], v9 offset:12288
v_mfma_f32_16x16x32_bf16 v[80:83], v[176:179], v[112:115], v[80:83]
ds_read_b64_tr_b16 v[158:159], v9 offset:12800
v_mfma_f32_16x16x32_bf16 v[80:83], v[180:183], v[116:119], v[80:83]
v_mfma_f32_16x16x32_bf16 v[84:87], v[184:187], v[112:115], v[84:87]
v_mfma_f32_16x16x32_bf16 v[84:87], v[188:191], v[116:119], v[84:87]
ds_read_b128 v[112:115], v6 offset:0
ds_read_b128 v[116:119], v7 offset:0
v_mfma_f32_16x16x32_bf16 v[88:91], v[176:179], v[120:123], v[88:91]
v_mfma_f32_16x16x32_bf16 v[88:91], v[180:183], v[124:127], v[88:91]
v_mfma_f32_16x16x32_bf16 v[92:95], v[184:187], v[120:123], v[92:95]
v_mfma_f32_16x16x32_bf16 v[92:95], v[188:191], v[124:127], v[92:95]
ds_read_b128 v[120:123], v6 offset:2048
ds_read_b128 v[124:127], v7 offset:2048
v_mfma_f32_16x16x32_bf16 v[96:99], v[176:179], v[128:131], v[96:99]
v_mfma_f32_16x16x32_bf16 v[96:99], v[180:183], v[132:135], v[96:99]
v_mfma_f32_16x16x32_bf16 v[100:103], v[184:187], v[128:131], v[100:103]
v_mfma_f32_16x16x32_bf16 v[100:103], v[188:191], v[132:135], v[100:103]
ds_read_b128 v[128:131], v6 offset:4096
ds_read_b128 v[132:135], v7 offset:4096
v_mfma_f32_16x16x32_bf16 v[104:107], v[176:179], v[136:139], v[104:107]
v_mfma_f32_16x16x32_bf16 v[104:107], v[180:183], v[140:143], v[104:107]
s_sub_u32 s66, s66, 1
s_cmp_eq_u32 s66, 0
v_mfma_f32_16x16x32_bf16 v[108:111], v[184:187], v[136:139], v[108:111]
v_mfma_f32_16x16x32_bf16 v[108:111], v[188:191], v[140:143], v[108:111]
ds_read_b128 v[136:139], v6 offset:6144
ds_read_b128 v[140:143], v7 offset:6144
s_cbranch_scc0 mqkv_106
v_and_b32 v10, 15, v0
v_lshrrev_b32 v11, 4, v0
s_lshl_b32 s66, s65, 8
s_add_u32 s66, s66, 1280
s_mul_i32 s67, s64, 384
v_lshl_add_u32 v6, v10, 2, s66
v_lshl_add_u32 v7, v11, 4, s66
v_lshl_add_u32 v8, v10, 2, s67
v_lshl_add_u32 v9, v11, 4, s67
v_and_b32 v12, 1, v11
v_lshrrev_b32 v11, 1, v11
v_lshlrev_b32 v11, 9, v11
v_lshl_add_u32 v11, v12, 10, v11
s_lshl_b32 s66, s64, 12
s_lshl_b32 s67, s65, 13
s_add_u32 s66, s66, 131072
s_add_u32 s68, s66, 24576
s_sub_u32 s68, s68, s67
s_add_u32 s67, s66, s67
v_lshl_add_u32 v14, v10, 4, v11
v_and_b32 v12, 3, v0
v_lshl_add_u32 v11, v12, 4, v11
v_bfe_u32 v12, v0, 3, 1
v_lshl_add_u32 v11, v12, 6, v11
v_bfe_u32 v12, v0, 2, 1
v_lshl_add_u32 v12, v12, 8, v11
v_add_u32 v13, s68, v12
v_add_u32 v12, s67, v12
v_add_u32 v15, s68, v14
v_add_u32 v14, s67, v14
s_lshl_b32 s66, s59, 4
s_add_u32 s66, s66, s60
s_lshl_b32 s72, s59, 7
s_add_u32 s72, s72, s60
s_lshl_b32 s72, s72, 7
s_lshl_b32 s66, s66, 15
s_lshl_b32 s67, s63, 23
s_add_u32 s66, s66, s67
s_add_u32 s71, s66, 917504
s_add_u32 s35, s34, 2
lw_109:
ds_read_b32 v5, v2 offset:24
s_waitcnt lgkmcnt(0)
v_cmp_gt_i32 vcc, s35, v5
s_cbranch_vccz lwd_110
s_sub_u32 s32, s32, 1
s_cmp_gt_i32 s32, 0
s_cbranch_scc1 lw_109
lwd_110:
v_mov_b32 v10, 0
ds_read_b32 v10, v10 offset:32
ds_read2_b32 v[144:145], v6 offset0:0 offset1:128
ds_read2_b32 v[146:147], v6 offset0:16 offset1:144
ds_read2_b32 v[148:149], v6 offset0:32 offset1:160
ds_read2_b32 v[150:151], v6 offset0:48 offset1:176
ds_read_b128 v[152:155], v9 offset:2432
ds_read_b128 v[156:159], v9 offset:2496
ds_read_b32 v168, v8 offset:2560
ds_read_b32 v169, v8 offset:2624
ds_read_b128 v[112:115], v7 offset:0
ds_read_b128 v[128:131], v7 offset:512
ds_read_b128 v[116:119], v7 offset:64
ds_read_b128 v[132:135], v7 offset:576
s_waitcnt lgkmcnt(12)
v_readfirstlane_b32 s33, v10
s_sub_u32 s33, s33, 1
s_lshr_b32 s66, s33, 7
s_cmp_eq_u32 s66, s59
s_cbranch_scc1 patch_111
pback_112:
s_waitcnt lgkmcnt(11)
v_pk_mul_f32 v[16:17], v[16:17], v[144:145] op_sel:[0,0] op_sel_hi:[1,0]
v_pk_mul_f32 v[18:19], v[18:19], v[144:145] op_sel:[0,0] op_sel_hi:[1,0]
v_pk_mul_f32 v[20:21], v[20:21], v[144:145] op_sel:[0,0] op_sel_hi:[1,0]
v_pk_mul_f32 v[22:23], v[22:23], v[144:145] op_sel:[0,0] op_sel_hi:[1,0]
s_waitcnt lgkmcnt(7)
v_pk_fma_f32 v[16:17], v[152:153], v[144:145], v[16:17] op_sel:[0,1,0] op_sel_hi:[1,1,1]
v_pk_fma_f32 v[18:19], v[154:155], v[144:145], v[18:19] op_sel:[0,1,0] op_sel_hi:[1,1,1]
s_waitcnt lgkmcnt(6)
v_pk_fma_f32 v[20:21], v[156:157], v[144:145], v[20:21] op_sel:[0,1,0] op_sel_hi:[1,1,1]
v_pk_fma_f32 v[22:23], v[158:159], v[144:145], v[22:23] op_sel:[0,1,0] op_sel_hi:[1,1,1]
v_cvt_pk_bf16_f32 v16, v16, v17
v_cvt_pk_bf16_f32 v17, v18, v19
v_cvt_pk_bf16_f32 v18, v20, v21
v_cvt_pk_bf16_f32 v19, v22, v23
buffer_store_dwordx4 v[16:19], v12, s[20:23], s71 offen offset:0 sc1
ds_write_b128 v12, v[16:19] offset:0
ds_read_b128 v[120:123], v7 offset:128
ds_read_b128 v[136:139], v7 offset:640
ds_read_b128 v[124:127], v7 offset:192
ds_read_b128 v[140:143], v7 offset:704
ds_read_b128 v[160:163], v9 offset:2304
ds_read_b128 v[164:167], v9 offset:2368
v_pk_mul_f32 v[24:25], v[24:25], v[146:147] op_sel:[0,0] op_sel_hi:[1,0]
v_pk_mul_f32 v[26:27], v[26:27], v[146:147] op_sel:[0,0] op_sel_hi:[1,0]
v_pk_mul_f32 v[28:29], v[28:29], v[146:147] op_sel:[0,0] op_sel_hi:[1,0]
v_pk_mul_f32 v[30:31], v[30:31], v[146:147] op_sel:[0,0] op_sel_hi:[1,0]
v_pk_fma_f32 v[24:25], v[152:153], v[146:147], v[24:25] op_sel:[0,1,0] op_sel_hi:[1,1,1]
v_pk_fma_f32 v[26:27], v[154:155], v[146:147], v[26:27] op_sel:[0,1,0] op_sel_hi:[1,1,1]
v_pk_fma_f32 v[28:29], v[156:157], v[146:147], v[28:29] op_sel:[0,1,0] op_sel_hi:[1,1,1]
v_pk_fma_f32 v[30:31], v[158:159], v[146:147], v[30:31] op_sel:[0,1,0] op_sel_hi:[1,1,1]
v_cvt_pk_bf16_f32 v24, v24, v25
v_cvt_pk_bf16_f32 v25, v26, v27
v_cvt_pk_bf16_f32 v26, v28, v29
v_cvt_pk_bf16_f32 v27, v30, v31
buffer_store_dwordx4 v[24:27], v12, s[20:23], s71 offen offset:128 sc1
ds_write_b128 v12, v[24:27] offset:128
v_pk_mul_f32 v[32:33], v[32:33], v[148:149] op_sel:[0,0] op_sel_hi:[1,0]
v_pk_mul_f32 v[34:35], v[34:35], v[148:149] op_sel:[0,0] op_sel_hi:[1,0]
v_pk_mul_f32 v[36:37], v[36:37], v[148:149] op_sel:[0,0] op_sel_hi:[1,0]
v_pk_mul_f32 v[38:39], v[38:39], v[148:149] op_sel:[0,0] op_sel_hi:[1,0]
v_pk_fma_f32 v[32:33], v[152:153], v[148:149], v[32:33] op_sel:[0,1,0] op_sel_hi:[1,1,1]
v_pk_fma_f32 v[34:35], v[154:155], v[148:149], v[34:35] op_sel:[0,1,0] op_sel_hi:[1,1,1]
v_pk_fma_f32 v[36:37], v[156:157], v[148:149], v[36:37] op_sel:[0,1,0] op_sel_hi:[1,1,1]
v_pk_fma_f32 v[38:39], v[158:159], v[148:149], v[38:39] op_sel:[0,1,0] op_sel_hi:[1,1,1]
v_cvt_pk_bf16_f32 v32, v32, v33
v_cvt_pk_bf16_f32 v33, v34, v35
v_cvt_pk_bf16_f32 v34, v36, v37
v_cvt_pk_bf16_f32 v35, v38, v39
buffer_store_dwordx4 v[32:35], v13, s[20:23], s71 offen offset:0 sc1
ds_write_b128 v13, v[32:35] offset:0
v_pk_mul_f32 v[40:41], v[40:41], v[150:151] op_sel:[0,0] op_sel_hi:[1,0]
v_pk_mul_f32 v[42:43], v[42:43], v[150:151] op_sel:[0,0] op_sel_hi:[1,0]
v_pk_mul_f32 v[44:45], v[44:45], v[150:151] op_sel:[0,0] op_sel_hi:[1,0]
v_pk_mul_f32 v[46:47], v[46:47], v[150:151] op_sel:[0,0] op_sel_hi:[1,0]
v_pk_fma_f32 v[40:41], v[152:153], v[150:151], v[40:41] op_sel:[0,1,0] op_sel_hi:[1,1,1]
v_pk_fma_f32 v[42:43], v[154:155], v[150:151], v[42:43] op_sel:[0,1,0] op_sel_hi:[1,1,1]
v_pk_fma_f32 v[44:45], v[156:157], v[150:151], v[44:45] op_sel:[0,1,0] op_sel_hi:[1,1,1]
v_pk_fma_f32 v[46:47], v[158:159], v[150:151], v[46:47] op_sel:[0,1,0] op_sel_hi:[1,1,1]
v_cvt_pk_bf16_f32 v40, v40, v41
v_cvt_pk_bf16_f32 v41, v42, v43
v_cvt_pk_bf16_f32 v42, v44, v45
v_cvt_pk_bf16_f32 v43, v46, v47
buffer_store_dwordx4 v[40:43], v13, s[20:23], s71 offen offset:128 sc1
ds_write_b128 v13, v[40:43] offset:128
s_waitcnt lgkmcnt(13)
v_pk_mul_f32 v[48:49], v[48:49], v[112:113]
v_pk_mul_f32 v[50:51], v[50:51], v[114:115]
s_waitcnt lgkmcnt(12)
v_pk_fma_f32 v[48:49], v[128:129], v[168:169], v[48:49] op_sel:[0,0,0] op_sel_hi:[1,0,1]
v_pk_fma_f32 v[50:51], v[130:131], v[168:169], v[50:51] op_sel:[0,0,0] op_sel_hi:[1,0,1]
s_waitcnt lgkmcnt(11)
v_pk_mul_f32 v[56:57], v[56:57], v[116:117]
v_pk_mul_f32 v[58:59], v[58:59], v[118:119]
s_waitcnt lgkmcnt(10)
v_pk_fma_f32 v[56:57], v[132:133], v[168:169], v[56:57] op_sel:[0,0,0] op_sel_hi:[1,0,1]
v_pk_fma_f32 v[58:59], v[134:135], v[168:169], v[58:59] op_sel:[0,0,0] op_sel_hi:[1,0,1]
v_cvt_pk_bf16_f32 v48, v48, v49
v_cvt_pk_bf16_f32 v49, v50, v51
v_cvt_pk_bf16_f32 v50, v56, v57
v_cvt_pk_bf16_f32 v51, v58, v59
buffer_store_dwordx4 v[48:51], v14, s[20:23], s71 offen offset:2048 sc1
ds_write_b128 v14, v[48:51] offset:2048
v_pk_mul_f32 v[52:53], v[52:53], v[112:113]
v_pk_mul_f32 v[54:55], v[54:55], v[114:115]
v_pk_fma_f32 v[52:53], v[128:129], v[168:169], v[52:53] op_sel:[0,1,0] op_sel_hi:[1,1,1]
v_pk_fma_f32 v[54:55], v[130:131], v[168:169], v[54:55] op_sel:[0,1,0] op_sel_hi:[1,1,1]
v_pk_mul_f32 v[60:61], v[60:61], v[116:117]
v_pk_mul_f32 v[62:63], v[62:63], v[118:119]
v_pk_fma_f32 v[60:61], v[132:133], v[168:169], v[60:61] op_sel:[0,1,0] op_sel_hi:[1,1,1]
v_pk_fma_f32 v[62:63], v[134:135], v[168:169], v[62:63] op_sel:[0,1,0] op_sel_hi:[1,1,1]
v_cvt_pk_bf16_f32 v52, v52, v53
v_cvt_pk_bf16_f32 v53, v54, v55
v_cvt_pk_bf16_f32 v54, v60, v61
v_cvt_pk_bf16_f32 v55, v62, v63
buffer_store_dwordx4 v[52:55], v14, s[20:23], s71 offen offset:2304 sc1
ds_write_b128 v14, v[52:55] offset:2304
s_waitcnt lgkmcnt(10)
v_pk_mul_f32 v[64:65], v[64:65], v[120:121]
v_pk_mul_f32 v[66:67], v[66:67], v[122:123]
s_waitcnt lgkmcnt(9)
v_pk_fma_f32 v[64:65], v[136:137], v[168:169], v[64:65] op_sel:[0,0,0] op_sel_hi:[1,0,1]
v_pk_fma_f32 v[66:67], v[138:139], v[168:169], v[66:67] op_sel:[0,0,0] op_sel_hi:[1,0,1]
s_waitcnt lgkmcnt(8)
v_pk_mul_f32 v[72:73], v[72:73], v[124:125]
v_pk_mul_f32 v[74:75], v[74:75], v[126:127]
s_waitcnt lgkmcnt(7)
v_pk_fma_f32 v[72:73], v[140:141], v[168:169], v[72:73] op_sel:[0,0,0] op_sel_hi:[1,0,1]
v_pk_fma_f32 v[74:75], v[142:143], v[168:169], v[74:75] op_sel:[0,0,0] op_sel_hi:[1,0,1]
v_cvt_pk_bf16_f32 v64, v64, v65
v_cvt_pk_bf16_f32 v65, v66, v67
v_cvt_pk_bf16_f32 v66, v72, v73
v_cvt_pk_bf16_f32 v67, v74, v75
buffer_store_dwordx4 v[64:67], v15, s[20:23], s71 offen offset:2048 sc1
ds_write_b128 v15, v[64:67] offset:2048
v_pk_mul_f32 v[68:69], v[68:69], v[120:121]
v_pk_mul_f32 v[70:71], v[70:71], v[122:123]
v_pk_fma_f32 v[68:69], v[136:137], v[168:169], v[68:69] op_sel:[0,1,0] op_sel_hi:[1,1,1]
v_pk_fma_f32 v[70:71], v[138:139], v[168:169], v[70:71] op_sel:[0,1,0] op_sel_hi:[1,1,1]
v_pk_mul_f32 v[76:77], v[76:77], v[124:125]
v_pk_mul_f32 v[78:79], v[78:79], v[126:127]
v_pk_fma_f32 v[76:77], v[140:141], v[168:169], v[76:77] op_sel:[0,1,0] op_sel_hi:[1,1,1]
v_pk_fma_f32 v[78:79], v[142:143], v[168:169], v[78:79] op_sel:[0,1,0] op_sel_hi:[1,1,1]
v_cvt_pk_bf16_f32 v68, v68, v69
v_cvt_pk_bf16_f32 v69, v70, v71
v_cvt_pk_bf16_f32 v70, v76, v77
v_cvt_pk_bf16_f32 v71, v78, v79
buffer_store_dwordx4 v[68:71], v15, s[20:23], s71 offen offset:2304 sc1
ds_write_b128 v15, v[68:71] offset:2304
v_add_u32 v5, s34, 17
s_mov_b64 exec, 1
ds_write_b32 v3, v5
s_mov_b64 exec, -1
s_mov_b32 s66, 0x3e8293ee
v_mul_f32 v144, s66, v144
v_mul_f32 v145, s66, v145
v_mul_f32 v146, s66, v146
v_mul_f32 v147, s66, v147
v_mul_f32 v148, s66, v148
v_mul_f32 v149, s66, v149
v_mul_f32 v150, s66, v150
v_mul_f32 v151, s66, v151
v_pk_mul_f32 v[96:97], v[96:97], v[148:149] op_sel:[0,0] op_sel_hi:[1,0]
v_pk_mul_f32 v[98:99], v[98:99], v[148:149] op_sel:[0,0] op_sel_hi:[1,0]
v_pk_mul_f32 v[100:101], v[100:101], v[148:149] op_sel:[0,0] op_sel_hi:[1,0]
v_pk_mul_f32 v[102:103], v[102:103], v[148:149] op_sel:[0,0] op_sel_hi:[1,0]
s_waitcnt lgkmcnt(9)
v_pk_fma_f32 v[96:97], v[160:161], v[148:149], v[96:97] op_sel:[0,1,0] op_sel_hi:[1,1,1]
v_pk_fma_f32 v[98:99], v[162:163], v[148:149], v[98:99] op_sel:[0,1,0] op_sel_hi:[1,1,1]
s_waitcnt lgkmcnt(8)
v_pk_fma_f32 v[100:101], v[164:165], v[148:149], v[100:101] op_sel:[0,1,0] op_sel_hi:[1,1,1]
v_pk_fma_f32 v[102:103], v[166:167], v[148:149], v[102:103] op_sel:[0,1,0] op_sel_hi:[1,1,1]
v_cvt_pk_bf16_f32 v96, v96, v97
v_cvt_pk_bf16_f32 v97, v98, v99
v_cvt_pk_bf16_f32 v98, v100, v101
v_cvt_pk_bf16_f32 v99, v102, v103
v_pk_mul_f32 v[104:105], v[104:105], v[150:151] op_sel:[0,0] op_sel_hi:[1,0]
v_pk_mul_f32 v[106:107], v[106:107], v[150:151] op_sel:[0,0] op_sel_hi:[1,0]
v_pk_mul_f32 v[108:109], v[108:109], v[150:151] op_sel:[0,0] op_sel_hi:[1,0]
v_pk_mul_f32 v[110:111], v[110:111], v[150:151] op_sel:[0,0] op_sel_hi:[1,0]
v_pk_fma_f32 v[104:105], v[160:161], v[150:151], v[104:105] op_sel:[0,1,0] op_sel_hi:[1,1,1]
v_pk_fma_f32 v[106:107], v[162:163], v[150:151], v[106:107] op_sel:[0,1,0] op_sel_hi:[1,1,1]
v_pk_fma_f32 v[108:109], v[164:165], v[150:151], v[108:109] op_sel:[0,1,0] op_sel_hi:[1,1,1]
v_pk_fma_f32 v[110:111], v[166:167], v[150:151], v[110:111] op_sel:[0,1,0] op_sel_hi:[1,1,1]
v_cvt_pk_bf16_f32 v104, v104, v105
v_cvt_pk_bf16_f32 v105, v106, v107
v_cvt_pk_bf16_f32 v106, v108, v109
v_cvt_pk_bf16_f32 v107, v110, v111
v_pk_mul_f32 v[80:81], v[80:81], v[144:145] op_sel:[0,0] op_sel_hi:[1,0]
v_pk_mul_f32 v[82:83], v[82:83], v[144:145] op_sel:[0,0] op_sel_hi:[1,0]
v_pk_mul_f32 v[84:85], v[84:85], v[144:145] op_sel:[0,0] op_sel_hi:[1,0]
v_pk_mul_f32 v[86:87], v[86:87], v[144:145] op_sel:[0,0] op_sel_hi:[1,0]
v_pk_fma_f32 v[80:81], v[160:161], v[144:145], v[80:81] op_sel:[0,1,0] op_sel_hi:[1,1,1]
v_pk_fma_f32 v[82:83], v[162:163], v[144:145], v[82:83] op_sel:[0,1,0] op_sel_hi:[1,1,1]
v_pk_fma_f32 v[84:85], v[164:165], v[144:145], v[84:85] op_sel:[0,1,0] op_sel_hi:[1,1,1]
v_pk_fma_f32 v[86:87], v[166:167], v[144:145], v[86:87] op_sel:[0,1,0] op_sel_hi:[1,1,1]
v_cvt_pk_bf16_f32 v80, v80, v81
v_cvt_pk_bf16_f32 v81, v82, v83
v_cvt_pk_bf16_f32 v82, v84, v85
v_cvt_pk_bf16_f32 v83, v86, v87
v_pk_mul_f32 v[88:89], v[88:89], v[146:147] op_sel:[0,0] op_sel_hi:[1,0]
v_pk_mul_f32 v[90:91], v[90:91], v[146:147] op_sel:[0,0] op_sel_hi:[1,0]
v_pk_mul_f32 v[92:93], v[92:93], v[146:147] op_sel:[0,0] op_sel_hi:[1,0]
v_pk_mul_f32 v[94:95], v[94:95], v[146:147] op_sel:[0,0] op_sel_hi:[1,0]
v_pk_fma_f32 v[88:89], v[160:161], v[146:147], v[88:89] op_sel:[0,1,0] op_sel_hi:[1,1,1]
v_pk_fma_f32 v[90:91], v[162:163], v[146:147], v[90:91] op_sel:[0,1,0] op_sel_hi:[1,1,1]
v_pk_fma_f32 v[92:93], v[164:165], v[146:147], v[92:93] op_sel:[0,1,0] op_sel_hi:[1,1,1]
v_pk_fma_f32 v[94:95], v[166:167], v[146:147], v[94:95] op_sel:[0,1,0] op_sel_hi:[1,1,1]
v_cvt_pk_bf16_f32 v88, v88, v89
v_cvt_pk_bf16_f32 v89, v90, v91
v_cvt_pk_bf16_f32 v90, v92, v93
v_cvt_pk_bf16_f32 v91, v94, v95
v_permlane16_swap_b32 v96, v104
v_permlane16_swap_b32 v97, v105
v_permlane16_swap_b32 v98, v106
v_permlane16_swap_b32 v99, v107
v_permlane16_swap_b32 v80, v88
v_permlane16_swap_b32 v81, v89
v_permlane16_swap_b32 v82, v90
v_permlane16_swap_b32 v83, v91
s_lshl_b32 s69, s64, 12
v_lshl_add_u32 v6, v0, 4, s69
v_add_u32 v7, 131072, v6
s_lshl_b32 s69, s65, 13
s_add_u32 s66, s69, 131072
s_sub_u32 s69, 147456, s69
v_add_u32 v8, s69, v6
ds_read_b128 v[152:155], v8 offset:8192
ds_read_b128 v[156:159], v8 offset:9216
s_mov_b32 s67, 122880
s_min_u32 s69, s59, 1
s_lshl2_add_u32 s68, s69, s65
s_cmp_ge_u32 s59, 2
s_cselect_b32 s69, s65, 0
s_add_u32 s68, s68, s69
ds_read_b128 v[160:163], v8 offset:10240
ds_read_b128 v[164:167], v8 offset:11264
s_waitcnt lgkmcnt(3)
v_mfma_f32_32x32x16_bf16 v[112:127], v[152:155], v[96:99], v[216:231]
s_waitcnt lgkmcnt(2)
v_mfma_f32_32x32x16_bf16 v[112:127], v[156:159], v[104:107], v[112:127]
s_add_u32 s35, s34, 17
lw_113:
ds_read_b32 v5, v1 offset:0
s_waitcnt lgkmcnt(0)
v_cmp_gt_i32 vcc, s35, v5
s_cbranch_vccz lwd_114
s_sub_u32 s32, s32, 1
s_cmp_gt_i32 s32, 0
s_cbranch_scc1 lw_113
lwd_114:
ds_read_b128 v[152:155], v8 offset:0
ds_read_b128 v[156:159], v8 offset:1024
.p2align 3
s_nop 4
v_exp_f32 v112, v112
v_exp_f32 v113, v113
v_exp_f32 v114, v114
v_exp_f32 v115, v115
v_exp_f32 v116, v116
v_exp_f32 v117, v117
s_waitcnt lgkmcnt(1)
v_mfma_f32_32x32x16_bf16 v[128:143], v[152:155], v[96:99], 0
v_exp_f32 v118, v118
v_exp_f32 v119, v119
v_cvt_pk_bf16_f32 v144, v112, v113
v_cvt_pk_bf16_f32 v145, v114, v115
s_waitcnt lgkmcnt(0)
v_mfma_f32_32x32x16_bf16 v[128:143], v[156:159], v[104:107], v[128:143]
ds_read_b128 v[152:155], v7 offset:8192
ds_read_b128 v[156:159], v7 offset:9216
v_cvt_pk_bf16_f32 v146, v116, v117
v_cvt_pk_bf16_f32 v147, v118, v119
v_exp_f32 v120, v120
v_exp_f32 v121, v121
v_mfma_f32_32x32x16_bf16 v[16:31], v[160:163], v[144:147], 0
ds_read_b128 v[160:163], v8 offset:2048
v_exp_f32 v122, v122
v_exp_f32 v123, v123
v_exp_f32 v124, v124
v_mfma_f32_16x16x32_bf16 v[32:35], v[212:215], v[144:147], 0
s_cmp_eq_u32 s65, 1
v_exp_f32 v125, v125
v_exp_f32 v126, v126
v_exp_f32 v127, v127
v_cvt_pk_bf16_f32 v148, v120, v121
v_cvt_pk_bf16_f32 v149, v122, v123
v_cvt_pk_bf16_f32 v150, v124, v125
v_cvt_pk_bf16_f32 v151, v126, v127
s_cbranch_scc1 at_115
v_exp_f32 v128, v128
v_exp_f32 v129, v129
v_mfma_f32_32x32x16_bf16 v[16:31], v[164:167], v[148:151], v[16:31]
ds_read_b128 v[164:167], v8 offset:3072
v_exp_f32 v130, v130
v_exp_f32 v131, v131
v_exp_f32 v132, v132
v_mfma_f32_16x16x32_bf16 v[32:35], v[212:215], v[148:151], v[32:35]
v_exp_f32 v133, v133
s_waitcnt lgkmcnt(3)
v_mfma_f32_32x32x16_bf16 v[112:127], v[152:155], v[96:99], 0
v_exp_f32 v134, v134
v_exp_f32 v135, v135
v_cvt_pk_bf16_f32 v144, v128, v129
v_cvt_pk_bf16_f32 v145, v130, v131
s_waitcnt lgkmcnt(2)
v_mfma_f32_32x32x16_bf16 v[112:127], v[156:159], v[104:107], v[112:127]
ds_read_b128 v[152:155], v7 offset:0
ds_read_b128 v[156:159], v7 offset:1024
v_cvt_pk_bf16_f32 v146, v132, v133
v_cvt_pk_bf16_f32 v147, v134, v135
v_exp_f32 v136, v136
v_exp_f32 v137, v137
s_waitcnt lgkmcnt(3)
v_mfma_f32_32x32x16_bf16 v[16:31], v[160:163], v[144:147], v[16:31]
ds_read_b128 v[160:163], v7 offset:10240
v_exp_f32 v138, v138
v_exp_f32 v139, v139
v_exp_f32 v140, v140
v_mfma_f32_16x16x32_bf16 v[32:35], v[212:215], v[144:147], v[32:35]
v_exp_f32 v141, v141
v_exp_f32 v142, v142
v_exp_f32 v143, v143
v_cvt_pk_bf16_f32 v148, v136, v137
v_cvt_pk_bf16_f32 v149, v138, v139
v_cvt_pk_bf16_f32 v150, v140, v141
v_cvt_pk_bf16_f32 v151, v142, v143
v_exp_f32 v112, v112
v_exp_f32 v113, v113
s_waitcnt lgkmcnt(3)
v_mfma_f32_32x32x16_bf16 v[16:31], v[164:167], v[148:151], v[16:31]
ds_read_b128 v[164:167], v7 offset:11264
v_exp_f32 v114, v114
v_exp_f32 v115, v115
v_exp_f32 v116, v116
v_mfma_f32_16x16x32_bf16 v[32:35], v[212:215], v[148:151], v[32:35]
v_exp_f32 v117, v117
s_waitcnt lgkmcnt(3)
v_mfma_f32_32x32x16_bf16 v[128:143], v[152:155], v[96:99], 0
v_exp_f32 v118, v118
v_exp_f32 v119, v119
v_cvt_pk_bf16_f32 v144, v112, v113
v_cvt_pk_bf16_f32 v145, v114, v115
s_waitcnt lgkmcnt(2)
v_mfma_f32_32x32x16_bf16 v[128:143], v[156:159], v[104:107], v[128:143]
v_cvt_pk_bf16_f32 v146, v116, v117
v_cvt_pk_bf16_f32 v147, v118, v119
v_exp_f32 v120, v120
v_exp_f32 v121, v121
s_waitcnt lgkmcnt(1)
v_mfma_f32_32x32x16_bf16 v[16:31], v[160:163], v[144:147], v[16:31]
ds_read_b128 v[160:163], v7 offset:2048
v_exp_f32 v122, v122
v_exp_f32 v123, v123
v_exp_f32 v124, v124
v_mfma_f32_16x16x32_bf16 v[32:35], v[212:215], v[144:147], v[32:35]
v_mov_b32 v8, v7
v_exp_f32 v125, v125
v_exp_f32 v126, v126
v_exp_f32 v127, v127
v_cvt_pk_bf16_f32 v148, v120, v121
v_cvt_pk_bf16_f32 v149, v122, v123
v_cvt_pk_bf16_f32 v150, v124, v125
v_cvt_pk_bf16_f32 v151, v126, v127
.p2align 3
at_115:
v_exp_f32 v128, v128
v_exp_f32 v129, v129
s_waitcnt lgkmcnt(1)
v_mfma_f32_32x32x16_bf16 v[16:31], v[164:167], v[148:151], v[16:31]
ds_read_b128 v[164:167], v8 offset:3072
v_exp_f32 v130, v130
v_exp_f32 v131, v131
v_exp_f32 v132, v132
v_mfma_f32_16x16x32_bf16 v[32:35], v[212:215], v[148:151], v[32:35]
v_exp_f32 v133, v133
v_mfma_f32_32x32x16_bf16 v[112:127], v[152:155], v[80:83], v[216:231]
v_exp_f32 v134, v134
v_exp_f32 v135, v135
v_cvt_pk_bf16_f32 v144, v128, v129
v_cvt_pk_bf16_f32 v145, v130, v131
v_mfma_f32_32x32x16_bf16 v[112:127], v[156:159], v[88:91], v[112:127]
s_sub_u32 s66, s66, 8192
s_cmp_eq_u32 s66, s67
s_cbranch_scc1 cross_122
cback_123:
v_add_u32 v8, s66, v6
ds_read_b128 v[152:155], v8 offset:0
ds_read_b128 v[156:159], v8 offset:1024
v_cvt_pk_bf16_f32 v146, v132, v133
v_cvt_pk_bf16_f32 v147, v134, v135
v_exp_f32 v136, v136
v_exp_f32 v137, v137
s_waitcnt lgkmcnt(3)
v_mfma_f32_32x32x16_bf16 v[16:31], v[160:163], v[144:147], v[16:31]
v_exp_f32 v138, v138
v_exp_f32 v139, v139
v_exp_f32 v140, v140
v_mfma_f32_16x16x32_bf16 v[32:35], v[212:215], v[144:147], v[32:35]
s_cmp_eq_u32 s68, 0
v_exp_f32 v141, v141
v_exp_f32 v142, v142
v_exp_f32 v143, v143
v_cvt_pk_bf16_f32 v148, v136, v137
v_cvt_pk_bf16_f32 v149, v138, v139
v_cvt_pk_bf16_f32 v150, v140, v141
v_cvt_pk_bf16_f32 v151, v142, v143
s_cbranch_scc1 at_119
.p2align 3
at_116:
v_exp_f32 v112, v112
v_exp_f32 v113, v113
s_waitcnt lgkmcnt(2)
v_mfma_f32_32x32x16_bf16 v[16:31], v[164:167], v[148:151], v[16:31]
v_exp_f32 v114, v114
v_exp_f32 v115, v115
v_exp_f32 v116, v116
v_mfma_f32_16x16x32_bf16 v[32:35], v[212:215], v[148:151], v[32:35]
v_exp_f32 v117, v117
s_waitcnt lgkmcnt(1)
v_mfma_f32_32x32x16_bf16 v[128:143], v[152:155], v[96:99], 0
v_exp_f32 v118, v118
v_exp_f32 v119, v119
v_cvt_pk_bf16_f32 v144, v112, v113
v_cvt_pk_bf16_f32 v145, v114, v115
s_waitcnt lgkmcnt(0)
v_mfma_f32_32x32x16_bf16 v[128:143], v[156:159], v[104:107], v[128:143]
v_cvt_pk_bf16_f32 v146, v116, v117
v_cvt_pk_bf16_f32 v147, v118, v119
v_exp_f32 v120, v120
v_exp_f32 v121, v121
v_mfma_f32_32x32x16_bf16 v[192:207], v[160:163], v[144:147], v[192:207]
ds_read_b128 v[160:163], v8 offset:2048
v_exp_f32 v122, v122
v_exp_f32 v123, v123
v_exp_f32 v124, v124
v_mfma_f32_16x16x32_bf16 v[208:211], v[212:215], v[144:147], v[208:211]
v_exp_f32 v125, v125
v_exp_f32 v126, v126
v_exp_f32 v127, v127
v_cvt_pk_bf16_f32 v148, v120, v121
v_cvt_pk_bf16_f32 v149, v122, v123
v_cvt_pk_bf16_f32 v150, v124, v125
v_cvt_pk_bf16_f32 v151, v126, v127
v_exp_f32 v128, v128
v_exp_f32 v129, v129
v_mfma_f32_32x32x16_bf16 v[192:207], v[164:167], v[148:151], v[192:207]
ds_read_b128 v[164:167], v8 offset:3072
v_exp_f32 v130, v130
v_exp_f32 v131, v131
v_exp_f32 v132, v132
v_mfma_f32_16x16x32_bf16 v[208:211], v[212:215], v[148:151], v[208:211]
v_exp_f32 v133, v133
v_mfma_f32_32x32x16_bf16 v[112:127], v[152:155], v[80:83], 0
v_exp_f32 v134, v134
v_exp_f32 v135, v135
v_cvt_pk_bf16_f32 v144, v128, v129
v_cvt_pk_bf16_f32 v145, v130, v131
v_mfma_f32_32x32x16_bf16 v[112:127], v[156:159], v[88:91], v[112:127]
s_sub_u32 s66, s66, 8192
s_cmp_eq_u32 s66, s67
s_cbranch_scc1 cross_124
cback_125:
v_add_u32 v8, s66, v6
ds_read_b128 v[152:155], v8 offset:0
ds_read_b128 v[156:159], v8 offset:1024
v_cvt_pk_bf16_f32 v146, v132, v133
v_cvt_pk_bf16_f32 v147, v134, v135
v_exp_f32 v136, v136
v_exp_f32 v137, v137
s_waitcnt lgkmcnt(3)
v_mfma_f32_32x32x16_bf16 v[16:31], v[160:163], v[144:147], v[16:31]
v_exp_f32 v138, v138
v_exp_f32 v139, v139
v_exp_f32 v140, v140
v_mfma_f32_16x16x32_bf16 v[32:35], v[212:215], v[144:147], v[32:35]
s_sub_u32 s68, s68, 1
s_cmp_eq_u32 s68, 0
v_exp_f32 v141, v141
v_exp_f32 v142, v142
v_exp_f32 v143, v143
v_cvt_pk_bf16_f32 v148, v136, v137
v_cvt_pk_bf16_f32 v149, v138, v139
v_cvt_pk_bf16_f32 v150, v140, v141
v_cvt_pk_bf16_f32 v151, v142, v143
s_cbranch_scc0 at_116
s_cmp_lt_u32 s59, 2
s_cbranch_scc1 at_119
.p2align 3
v_exp_f32 v112, v112
v_exp_f32 v113, v113
s_waitcnt lgkmcnt(2)
v_mfma_f32_32x32x16_bf16 v[16:31], v[164:167], v[148:151], v[16:31]
v_exp_f32 v114, v114
v_exp_f32 v115, v115
v_exp_f32 v116, v116
v_mfma_f32_16x16x32_bf16 v[32:35], v[212:215], v[148:151], v[32:35]
v_exp_f32 v117, v117
s_waitcnt lgkmcnt(1)
v_mfma_f32_32x32x16_bf16 v[128:143], v[152:155], v[96:99], v[216:231]
v_exp_f32 v118, v118
v_exp_f32 v119, v119
v_cvt_pk_bf16_f32 v144, v112, v113
v_cvt_pk_bf16_f32 v145, v114, v115
s_waitcnt lgkmcnt(0)
v_mfma_f32_32x32x16_bf16 v[128:143], v[156:159], v[104:107], v[128:143]
v_cvt_pk_bf16_f32 v146, v116, v117
v_cvt_pk_bf16_f32 v147, v118, v119
v_exp_f32 v120, v120
v_exp_f32 v121, v121
v_mfma_f32_32x32x16_bf16 v[192:207], v[160:163], v[144:147], v[192:207]
ds_read_b128 v[160:163], v8 offset:2048
v_exp_f32 v122, v122
v_exp_f32 v123, v123
v_exp_f32 v124, v124
v_mfma_f32_16x16x32_bf16 v[208:211], v[212:215], v[144:147], v[208:211]
v_exp_f32 v125, v125
v_exp_f32 v126, v126
v_exp_f32 v127, v127
v_cvt_pk_bf16_f32 v148, v120, v121
v_cvt_pk_bf16_f32 v149, v122, v123
v_cvt_pk_bf16_f32 v150, v124, v125
v_cvt_pk_bf16_f32 v151, v126, v127
v_exp_f32 v128, v128
v_exp_f32 v129, v129
v_mfma_f32_32x32x16_bf16 v[192:207], v[164:167], v[148:151], v[192:207]
ds_read_b128 v[164:167], v8 offset:3072
v_exp_f32 v130, v130
v_exp_f32 v131, v131
v_exp_f32 v132, v132
v_mfma_f32_16x16x32_bf16 v[208:211], v[212:215], v[148:151], v[208:211]
v_exp_f32 v133, v133
v_mfma_f32_32x32x16_bf16 v[112:127], v[152:155], v[80:83], 0
v_exp_f32 v134, v134
v_exp_f32 v135, v135
v_cvt_pk_bf16_f32 v144, v128, v129
v_cvt_pk_bf16_f32 v145, v130, v131
v_mfma_f32_32x32x16_bf16 v[112:127], v[156:159], v[88:91], v[112:127]
v_subrev_u32 v8, 8192, v8
ds_read_b128 v[152:155], v8 offset:0
ds_read_b128 v[156:159], v8 offset:1024
v_cvt_pk_bf16_f32 v146, v132, v133
v_cvt_pk_bf16_f32 v147, v134, v135
v_exp_f32 v136, v136
v_exp_f32 v137, v137
s_waitcnt lgkmcnt(3)
v_mfma_f32_32x32x16_bf16 v[16:31], v[160:163], v[144:147], v[16:31]
v_exp_f32 v138, v138
v_exp_f32 v139, v139
v_exp_f32 v140, v140
v_mfma_f32_16x16x32_bf16 v[32:35], v[212:215], v[144:147], v[32:35]
s_cmp_eq_u32 s65, 1
v_exp_f32 v141, v141
v_exp_f32 v142, v142
v_exp_f32 v143, v143
v_cvt_pk_bf16_f32 v148, v136, v137
v_cvt_pk_bf16_f32 v149, v138, v139
v_cvt_pk_bf16_f32 v150, v140, v141
v_cvt_pk_bf16_f32 v151, v142, v143
s_cbranch_scc1 at_118
.p2align 3
v_exp_f32 v112, v112
v_exp_f32 v113, v113
s_waitcnt lgkmcnt(2)
v_mfma_f32_32x32x16_bf16 v[16:31], v[164:167], v[148:151], v[16:31]
v_exp_f32 v114, v114
v_exp_f32 v115, v115
v_exp_f32 v116, v116
v_mfma_f32_16x16x32_bf16 v[32:35], v[212:215], v[148:151], v[32:35]
v_exp_f32 v117, v117
s_waitcnt lgkmcnt(1)
v_mfma_f32_32x32x16_bf16 v[128:143], v[152:155], v[80:83], 0
v_exp_f32 v118, v118
v_exp_f32 v119, v119
v_cvt_pk_bf16_f32 v144, v112, v113
v_cvt_pk_bf16_f32 v145, v114, v115
s_waitcnt lgkmcnt(0)
v_mfma_f32_32x32x16_bf16 v[128:143], v[156:159], v[88:91], v[128:143]
v_subrev_u32 v8, 8192, v8
ds_read_b128 v[152:155], v8 offset:0
ds_read_b128 v[156:159], v8 offset:1024
v_cvt_pk_bf16_f32 v146, v116, v117
v_cvt_pk_bf16_f32 v147, v118, v119
v_exp_f32 v120, v120
v_exp_f32 v121, v121
v_mfma_f32_32x32x16_bf16 v[192:207], v[160:163], v[144:147], v[192:207]
ds_read_b128 v[160:163], v8 offset:10240
v_exp_f32 v122, v122
v_exp_f32 v123, v123
v_exp_f32 v124, v124
v_mfma_f32_16x16x32_bf16 v[208:211], v[212:215], v[144:147], v[208:211]
v_exp_f32 v125, v125
v_exp_f32 v126, v126
v_exp_f32 v127, v127
v_cvt_pk_bf16_f32 v148, v120, v121
v_cvt_pk_bf16_f32 v149, v122, v123
v_cvt_pk_bf16_f32 v150, v124, v125
v_cvt_pk_bf16_f32 v151, v126, v127
v_exp_f32 v128, v128
v_exp_f32 v129, v129
v_mfma_f32_32x32x16_bf16 v[192:207], v[164:167], v[148:151], v[192:207]
ds_read_b128 v[164:167], v8 offset:11264
v_exp_f32 v130, v130
v_exp_f32 v131, v131
v_exp_f32 v132, v132
v_mfma_f32_16x16x32_bf16 v[208:211], v[212:215], v[148:151], v[208:211]
v_exp_f32 v133, v133
s_waitcnt lgkmcnt(3)
v_mfma_f32_32x32x16_bf16 v[112:127], v[152:155], v[80:83], 0
v_exp_f32 v134, v134
v_exp_f32 v135, v135
v_cvt_pk_bf16_f32 v144, v128, v129
v_cvt_pk_bf16_f32 v145, v130, v131
s_waitcnt lgkmcnt(2)
v_mfma_f32_32x32x16_bf16 v[112:127], v[156:159], v[88:91], v[112:127]
v_subrev_u32 v8, 8192, v8
ds_read_b128 v[152:155], v8 offset:0
ds_read_b128 v[156:159], v8 offset:1024
v_cvt_pk_bf16_f32 v146, v132, v133
v_cvt_pk_bf16_f32 v147, v134, v135
v_exp_f32 v136, v136
v_exp_f32 v137, v137
s_waitcnt lgkmcnt(3)
v_mfma_f32_32x32x16_bf16 v[192:207], v[160:163], v[144:147], v[192:207]
ds_read_b128 v[160:163], v8 offset:10240
v_exp_f32 v138, v138
v_exp_f32 v139, v139
v_exp_f32 v140, v140
v_mfma_f32_16x16x32_bf16 v[208:211], v[212:215], v[144:147], v[208:211]
v_exp_f32 v141, v141
v_exp_f32 v142, v142
v_exp_f32 v143, v143
v_cvt_pk_bf16_f32 v148, v136, v137
v_cvt_pk_bf16_f32 v149, v138, v139
v_cvt_pk_bf16_f32 v150, v140, v141
v_cvt_pk_bf16_f32 v151, v142, v143
v_exp_f32 v112, v112
v_exp_f32 v113, v113
s_waitcnt lgkmcnt(3)
v_mfma_f32_32x32x16_bf16 v[192:207], v[164:167], v[148:151], v[192:207]
ds_read_b128 v[164:167], v8 offset:11264
v_exp_f32 v114, v114
v_exp_f32 v115, v115
v_exp_f32 v116, v116
v_mfma_f32_16x16x32_bf16 v[208:211], v[212:215], v[148:151], v[208:211]
v_exp_f32 v117, v117
s_waitcnt lgkmcnt(3)
v_mfma_f32_32x32x16_bf16 v[128:143], v[152:155], v[80:83], v[216:231]
v_exp_f32 v118, v118
v_exp_f32 v119, v119
v_cvt_pk_bf16_f32 v144, v112, v113
v_cvt_pk_bf16_f32 v145, v114, v115
s_waitcnt lgkmcnt(2)
v_mfma_f32_32x32x16_bf16 v[128:143], v[156:159], v[88:91], v[128:143]
v_cvt_pk_bf16_f32 v146, v116, v117
v_cvt_pk_bf16_f32 v147, v118, v119
v_exp_f32 v120, v120
v_exp_f32 v121, v121
s_waitcnt lgkmcnt(1)
v_mfma_f32_32x32x16_bf16 v[192:207], v[160:163], v[144:147], v[192:207]
ds_read_b128 v[160:163], v8 offset:2048
v_exp_f32 v122, v122
v_exp_f32 v123, v123
v_exp_f32 v124, v124
v_mfma_f32_16x16x32_bf16 v[208:211], v[212:215], v[144:147], v[208:211]
v_exp_f32 v125, v125
v_exp_f32 v126, v126
v_exp_f32 v127, v127
v_cvt_pk_bf16_f32 v148, v120, v121
v_cvt_pk_bf16_f32 v149, v122, v123
v_cvt_pk_bf16_f32 v150, v124, v125
v_cvt_pk_bf16_f32 v151, v126, v127
s_branch at_120
.p2align 3
at_119:
v_add_u32 v5, s34, 20
s_mov_b64 exec, 1
ds_write_b32 v3, v5
s_mov_b64 exec, -1
v_exp_f32 v112, v112
v_exp_f32 v113, v113
s_waitcnt lgkmcnt(3)
v_mfma_f32_32x32x16_bf16 v[16:31], v[164:167], v[148:151], v[16:31]
v_exp_f32 v114, v114
v_exp_f32 v115, v115
v_exp_f32 v116, v116
v_mfma_f32_16x16x32_bf16 v[32:35], v[212:215], v[148:151], v[32:35]
v_exp_f32 v117, v117
v_exp_f32 v118, v118
v_exp_f32 v119, v119
v_cvt_pk_bf16_f32 v144, v112, v113
v_cvt_pk_bf16_f32 v145, v114, v115
v_cvt_pk_bf16_f32 v146, v116, v117
v_cvt_pk_bf16_f32 v147, v118, v119
v_exp_f32 v120, v120
v_exp_f32 v121, v121
v_mfma_f32_32x32x16_bf16 v[192:207], v[160:163], v[144:147], v[192:207]
v_exp_f32 v122, v122
v_exp_f32 v123, v123
v_exp_f32 v124, v124
v_mfma_f32_16x16x32_bf16 v[208:211], v[212:215], v[144:147], v[208:211]
v_exp_f32 v125, v125
v_exp_f32 v126, v126
v_exp_f32 v127, v127
v_cvt_pk_bf16_f32 v148, v120, v121
v_cvt_pk_bf16_f32 v149, v122, v123
v_cvt_pk_bf16_f32 v150, v124, v125
v_cvt_pk_bf16_f32 v151, v126, v127
s_branch at_121
.p2align 3
at_118:
v_exp_f32 v112, v112
v_exp_f32 v113, v113
s_waitcnt lgkmcnt(2)
v_mfma_f32_32x32x16_bf16 v[16:31], v[164:167], v[148:151], v[16:31]
v_exp_f32 v114, v114
v_exp_f32 v115, v115
v_exp_f32 v116, v116
v_mfma_f32_16x16x32_bf16 v[32:35], v[212:215], v[148:151], v[32:35]
v_exp_f32 v117, v117
s_waitcnt lgkmcnt(1)
v_mfma_f32_32x32x16_bf16 v[128:143], v[152:155], v[80:83], v[216:231]
v_exp_f32 v118, v118
v_exp_f32 v119, v119
v_cvt_pk_bf16_f32 v144, v112, v113
v_cvt_pk_bf16_f32 v145, v114, v115
s_waitcnt lgkmcnt(0)
v_mfma_f32_32x32x16_bf16 v[128:143], v[156:159], v[88:91], v[128:143]
v_cvt_pk_bf16_f32 v146, v116, v117
v_cvt_pk_bf16_f32 v147, v118, v119
v_exp_f32 v120, v120
v_exp_f32 v121, v121
v_mfma_f32_32x32x16_bf16 v[192:207], v[160:163], v[144:147], v[192:207]
ds_read_b128 v[160:163], v8 offset:2048
v_exp_f32 v122, v122
v_exp_f32 v123, v123
v_exp_f32 v124, v124
v_mfma_f32_16x16x32_bf16 v[208:211], v[212:215], v[144:147], v[208:211]
v_exp_f32 v125, v125
v_exp_f32 v126, v126
v_exp_f32 v127, v127
v_cvt_pk_bf16_f32 v148, v120, v121
v_cvt_pk_bf16_f32 v149, v122, v123
v_cvt_pk_bf16_f32 v150, v124, v125
v_cvt_pk_bf16_f32 v151, v126, v127
.p2align 3
at_120:
v_exp_f32 v128, v128
v_exp_f32 v129, v129
s_waitcnt lgkmcnt(1)
v_mfma_f32_32x32x16_bf16 v[192:207], v[164:167], v[148:151], v[192:207]
ds_read_b128 v[164:167], v8 offset:3072
v_exp_f32 v130, v130
v_exp_f32 v131, v131
v_exp_f32 v132, v132
v_mfma_f32_16x16x32_bf16 v[208:211], v[212:215], v[148:151], v[208:211]
v_exp_f32 v133, v133
v_exp_f32 v134, v134
v_exp_f32 v135, v135
v_cvt_pk_bf16_f32 v144, v128, v129
v_cvt_pk_bf16_f32 v145, v130, v131
v_add_u32 v5, s34, 20
s_mov_b64 exec, 1
ds_write_b32 v3, v5
s_mov_b64 exec, -1
v_cvt_pk_bf16_f32 v146, v132, v133
v_cvt_pk_bf16_f32 v147, v134, v135
v_exp_f32 v136, v136
v_exp_f32 v137, v137
s_waitcnt lgkmcnt(2)
v_mfma_f32_32x32x16_bf16 v[192:207], v[160:163], v[144:147], v[192:207]
v_exp_f32 v138, v138
v_exp_f32 v139, v139
v_exp_f32 v140, v140
v_mfma_f32_16x16x32_bf16 v[208:211], v[212:215], v[144:147], v[208:211]
v_exp_f32 v141, v141
v_exp_f32 v142, v142
v_exp_f32 v143, v143
v_cvt_pk_bf16_f32 v148, v136, v137
v_cvt_pk_bf16_f32 v149, v138, v139
v_cvt_pk_bf16_f32 v150, v140, v141
v_cvt_pk_bf16_f32 v151, v142, v143
at_121:
s_lshl_b32 s66, s59, 18
s_lshl_b32 s67, s63, 22
v_mfma_f32_16x16x32_bf16 v[208:211], v[212:215], v[148:151], v[208:211]
s_add_u32 s66, s66, s67
s_lshl1_add_u32 s67, s60, s64
s_waitcnt lgkmcnt(1)
v_mfma_f32_32x32x16_bf16 v[192:207], v[164:167], v[148:151], v[192:207]
s_lshl_b32 s67, s67, 11
s_add_u32 s66, s66, s67
s_lshl_b32 s68, s65, 16
s_add_u32 s67, s66, 18022400
s_sub_u32 s67, s67, s68
s_add_u32 s66, s66, s68
s_add_u32 s66, s66, 17825792
v_lshlrev_b32 v9, 4, v0
v_subrev_u32 v10, 0x2f800000, v32
v_subrev_u32 v11, 0x2f800000, v208
v_max_u32 v10, v10, v11
v_cmp_lt_u32 vcc, 0x20000000, v10
s_cbranch_vccnz slow_126
sback_127:
s_nop 1
v_rcp_f32 v12, v32
s_nop 1
v_pk_mul_f32 v[16:17], v[16:17], v[12:13] op_sel:[0,0] op_sel_hi:[1,0]
v_pk_mul_f32 v[18:19], v[18:19], v[12:13] op_sel:[0,0] op_sel_hi:[1,0]
v_pk_mul_f32 v[20:21], v[20:21], v[12:13] op_sel:[0,0] op_sel_hi:[1,0]
v_pk_mul_f32 v[22:23], v[22:23], v[12:13] op_sel:[0,0] op_sel_hi:[1,0]
v_pk_mul_f32 v[24:25], v[24:25], v[12:13] op_sel:[0,0] op_sel_hi:[1,0]
v_pk_mul_f32 v[26:27], v[26:27], v[12:13] op_sel:[0,0] op_sel_hi:[1,0]
v_pk_mul_f32 v[28:29], v[28:29], v[12:13] op_sel:[0,0] op_sel_hi:[1,0]
v_pk_mul_f32 v[30:31], v[30:31], v[12:13] op_sel:[0,0] op_sel_hi:[1,0]
v_cvt_pk_bf16_f32 v16, v16, v17
v_cvt_pk_bf16_f32 v17, v18, v19
v_cvt_pk_bf16_f32 v18, v20, v21
v_cvt_pk_bf16_f32 v19, v22, v23
v_cvt_pk_bf16_f32 v20, v24, v25
v_cvt_pk_bf16_f32 v21, v26, v27
v_cvt_pk_bf16_f32 v22, v28, v29
v_cvt_pk_bf16_f32 v23, v30, v31
buffer_store_dwordx4 v[16:19], v9, s[20:23], s67 offen offset:0 sc1
buffer_store_dwordx4 v[20:23], v9, s[20:23], s67 offen offset:1024 sc1
v_rcp_f32 v12, v208
s_nop 0
v_pk_mul_f32 v[192:193], v[192:193], v[12:13] op_sel:[0,0] op_sel_hi:[1,0]
v_pk_mul_f32 v[194:195], v[194:195], v[12:13] op_sel:[0,0] op_sel_hi:[1,0]
v_pk_mul_f32 v[196:197], v[196:197], v[12:13] op_sel:[0,0] op_sel_hi:[1,0]
v_pk_mul_f32 v[198:199], v[198:199], v[12:13] op_sel:[0,0] op_sel_hi:[1,0]
v_pk_mul_f32 v[200:201], v[200:201], v[12:13] op_sel:[0,0] op_sel_hi:[1,0]
v_pk_mul_f32 v[202:203], v[202:203], v[12:13] op_sel:[0,0] op_sel_hi:[1,0]
v_pk_mul_f32 v[204:205], v[204:205], v[12:13] op_sel:[0,0] op_sel_hi:[1,0]
v_pk_mul_f32 v[206:207], v[206:207], v[12:13] op_sel:[0,0] op_sel_hi:[1,0]
v_cvt_pk_bf16_f32 v192, v192, v193
v_cvt_pk_bf16_f32 v193, v194, v195
v_cvt_pk_bf16_f32 v194, v196, v197
v_cvt_pk_bf16_f32 v195, v198, v199
v_cvt_pk_bf16_f32 v196, v200, v201
v_cvt_pk_bf16_f32 v197, v202, v203
v_cvt_pk_bf16_f32 v198, v204, v205
v_cvt_pk_bf16_f32 v199, v206, v207
buffer_store_dwordx4 v[192:195], v9, s[20:23], s66 offen offset:0 sc1
buffer_store_dwordx4 v[196:199], v9, s[20:23], s66 offen offset:1024 sc1
v_bfe_u32 v48, v0, 2, 3
v_lshrrev_b32 v49, 5, v0
v_lshl_add_u32 v48, v49, 4, v48
v_lshlrev_b32 v48, 7, v48
v_bfe_u32 v49, v0, 3, 2
v_lshl_add_u32 v48, v49, 5, v48
v_and_b32 v49, 3, v0
v_lshl_add_u32 v48, v49, 3, v48
v_add_u32 v8, 32768, v48
v_xor_b32 v9, 32, v8
v_xor_b32 v10, 64, v8
v_xor_b32 v11, 96, v8
v_add_u32 v12, 0x10000, v8
v_add_u32 v13, 0x10000, v9
v_add_u32 v14, 0x10000, v10
v_add_u32 v15, 0x10000, v11
v_and_b32 v48, 15, v0
v_lshrrev_b32 v49, 4, v0
s_lshl2_add_u32 s66, s61, s58
s_lshl_b32 s67, s66, 16
s_lshl_b32 s68, s63, 22
s_add_u32 s67, s67, s68
s_add_u32 s67, s67, 17825792
v_lshl_add_u32 v6, v48, 4, s67
v_lshl_add_u32 v6, v49, 9, v6
s_add_u32 s70, s72, 268288
s_add_u32 s35, s34, 3
lw_128:
ds_read_b32 v5, v2 offset:24
s_waitcnt lgkmcnt(0)
v_cmp_gt_i32 vcc, s35, v5
s_cbranch_vccz lwd_129
s_sub_u32 s32, s32, 1
s_cmp_gt_i32 s32, 0
s_cbranch_scc1 lw_128
lwd_129:
s_mov_b64 exec, 1
s_waitcnt vmcnt(0)
buffer_store_dword v212, v3, s[24:27], s70 offen sc1
s_mov_b64 exec, -1
v_add_u32 v5, s34, 21
s_mov_b64 exec, 1
ds_write_b32 v3, v5
s_mov_b64 exec, -1
s_cmp_eq_u32 s63, 0
s_cbranch_scc0 mo_130
v_permlane16_swap_b32 v240, v242
v_permlane16_swap_b32 v241, v243
v_permlane16_swap_b32 v244, v246
v_permlane16_swap_b32 v245, v247
v_permlane16_swap_b32 v248, v250
v_permlane16_swap_b32 v249, v251
v_permlane16_swap_b32 v252, v254
v_permlane16_swap_b32 v253, v255
mo_131:
v_lshlrev_b32 v16, 16, v240
v_and_b32 v17, 0xffff0000, v240
v_lshlrev_b32 v18, 16, v241
v_and_b32 v19, 0xffff0000, v241
v_lshlrev_b32 v20, 16, v242
v_and_b32 v21, 0xffff0000, v242
v_lshlrev_b32 v22, 16, v243
v_and_b32 v23, 0xffff0000, v243
v_lshlrev_b32 v24, 16, v244
v_and_b32 v25, 0xffff0000, v244
v_lshlrev_b32 v26, 16, v245
v_and_b32 v27, 0xffff0000, v245
v_lshlrev_b32 v28, 16, v246
v_and_b32 v29, 0xffff0000, v246
v_lshlrev_b32 v30, 16, v247
v_and_b32 v31, 0xffff0000, v247
v_lshlrev_b32 v32, 16, v248
v_and_b32 v33, 0xffff0000, v248
v_lshlrev_b32 v34, 16, v249
v_and_b32 v35, 0xffff0000, v249
v_lshlrev_b32 v36, 16, v250
v_and_b32 v37, 0xffff0000, v250
v_lshlrev_b32 v38, 16, v251
v_and_b32 v39, 0xffff0000, v251
v_lshlrev_b32 v40, 16, v252
v_and_b32 v41, 0xffff0000, v252
v_lshlrev_b32 v42, 16, v253
v_and_b32 v43, 0xffff0000, v253
v_lshlrev_b32 v44, 16, v254
v_and_b32 v45, 0xffff0000, v254
v_lshlrev_b32 v46, 16, v255
v_and_b32 v47, 0xffff0000, v255
s_add_u32 s66, s61, s62
s_and_b32 s66, s66, 15
s_lshl_b32 s66, s66, 12
s_add_u32 s35, s34, 18
lw_132:
ds_read_b32 v5, v2 offset:16
s_waitcnt lgkmcnt(0)
v_cmp_gt_i32 vcc, s35, v5
s_cbranch_vccz lwd_133
s_sub_u32 s32, s32, 1
s_cmp_gt_i32 s32, 0
s_cbranch_scc1 lw_132
lwd_133:
buffer_load_dwordx4 v[80:83], v6, s[20:23], s66 offen offset:0 sc1
buffer_load_dwordx4 v[88:91], v6, s[20:23], s66 offen offset:2048 sc1
buffer_load_dwordx4 v[84:87], v6, s[20:23], s66 offen offset:256 sc1
buffer_load_dwordx4 v[92:95], v6, s[20:23], s66 offen offset:2304 sc1
s_add_u32 s66, s66, 4096
s_and_b32 s66, s66, 0xffff
ds_read_b64_tr_b16 v[48:49], v8 offset:0
ds_read_b64_tr_b16 v[50:51], v8 offset:1024
ds_read_b64_tr_b16 v[52:53], v8 offset:4096
ds_read_b64_tr_b16 v[54:55], v8 offset:5120
buffer_load_dwordx4 v[96:99], v6, s[20:23], s66 offen offset:0 sc1
buffer_load_dwordx4 v[104:107], v6, s[20:23], s66 offen offset:2048 sc1
buffer_load_dwordx4 v[100:103], v6, s[20:23], s66 offen offset:256 sc1
buffer_load_dwordx4 v[108:111], v6, s[20:23], s66 offen offset:2304 sc1
s_add_u32 s66, s66, 4096
s_and_b32 s66, s66, 0xffff
ds_read_b64_tr_b16 v[56:57], v9 offset:0
ds_read_b64_tr_b16 v[58:59], v9 offset:1024
ds_read_b64_tr_b16 v[60:61], v9 offset:4096
ds_read_b64_tr_b16 v[62:63], v9 offset:5120
buffer_load_dwordx4 v[112:115], v6, s[20:23], s66 offen offset:0 sc1
buffer_load_dwordx4 v[120:123], v6, s[20:23], s66 offen offset:2048 sc1
buffer_load_dwordx4 v[116:119], v6, s[20:23], s66 offen offset:256 sc1
buffer_load_dwordx4 v[124:127], v6, s[20:23], s66 offen offset:2304 sc1
s_add_u32 s66, s66, 4096
s_and_b32 s66, s66, 0xffff
ds_read_b64_tr_b16 v[64:65], v10 offset:0
ds_read_b64_tr_b16 v[66:67], v10 offset:1024
ds_read_b64_tr_b16 v[68:69], v10 offset:4096
ds_read_b64_tr_b16 v[70:71], v10 offset:5120
buffer_load_dwordx4 v[128:131], v6, s[20:23], s66 offen offset:0 sc1
buffer_load_dwordx4 v[136:139], v6, s[20:23], s66 offen offset:2048 sc1
buffer_load_dwordx4 v[132:135], v6, s[20:23], s66 offen offset:256 sc1
buffer_load_dwordx4 v[140:143], v6, s[20:23], s66 offen offset:2304 sc1
s_add_u32 s66, s66, 4096
s_and_b32 s66, s66, 0xffff
buffer_load_dwordx4 v[144:147], v6, s[20:23], s66 offen offset:0 sc1
buffer_load_dwordx4 v[152:155], v6, s[20:23], s66 offen offset:2048 sc1
buffer_load_dwordx4 v[148:151], v6, s[20:23], s66 offen offset:256 sc1
buffer_load_dwordx4 v[156:159], v6, s[20:23], s66 offen offset:2304 sc1
s_add_u32 s66, s66, 4096
s_and_b32 s66, s66, 0xffff
buffer_load_dwordx4 v[160:163], v6, s[20:23], s66 offen offset:0 sc1
buffer_load_dwordx4 v[168:171], v6, s[20:23], s66 offen offset:2048 sc1
buffer_load_dwordx4 v[164:167], v6, s[20:23], s66 offen offset:256 sc1
buffer_load_dwordx4 v[172:175], v6, s[20:23], s66 offen offset:2304 sc1
s_add_u32 s66, s66, 4096
s_and_b32 s66, s66, 0xffff
buffer_load_dwordx4 v[176:179], v6, s[20:23], s66 offen offset:0 sc1
buffer_load_dwordx4 v[184:187], v6, s[20:23], s66 offen offset:2048 sc1
buffer_load_dwordx4 v[180:183], v6, s[20:23], s66 offen offset:256 sc1
buffer_load_dwordx4 v[188:191], v6, s[20:23], s66 offen offset:2304 sc1
s_add_u32 s66, s66, 4096
s_and_b32 s66, s66, 0xffff
buffer_load_dwordx4 v[192:195], v6, s[20:23], s66 offen offset:0 sc1
buffer_load_dwordx4 v[200:203], v6, s[20:23], s66 offen offset:2048 sc1
buffer_load_dwordx4 v[196:199], v6, s[20:23], s66 offen offset:256 sc1
buffer_load_dwordx4 v[204:207], v6, s[20:23], s66 offen offset:2304 sc1
s_add_u32 s66, s66, 4096
s_and_b32 s66, s66, 0xffff
.p2align 3
s_waitcnt vmcnt(31) lgkmcnt(10)
v_mfma_f32_16x16x32_bf16 v[16:19], v[48:51], v[80:83], v[16:19]
ds_read_b64_tr_b16 v[72:73], v11 offset:0
s_waitcnt vmcnt(30) lgkmcnt(9)
v_mfma_f32_16x16x32_bf16 v[16:19], v[52:55], v[88:91], v[16:19]
ds_read_b64_tr_b16 v[74:75], v11 offset:1024
s_waitcnt vmcnt(29)
v_mfma_f32_16x16x32_bf16 v[32:35], v[48:51], v[84:87], v[32:35]
ds_read_b64_tr_b16 v[76:77], v11 offset:4096
s_waitcnt vmcnt(28)
v_mfma_f32_16x16x32_bf16 v[32:35], v[52:55], v[92:95], v[32:35]
ds_read_b64_tr_b16 v[78:79], v11 offset:5120
s_waitcnt lgkmcnt(10)
v_mfma_f32_16x16x32_bf16 v[20:23], v[56:59], v[80:83], v[20:23]
ds_read_b64_tr_b16 v[48:49], v8 offset:8192
s_waitcnt lgkmcnt(9)
v_mfma_f32_16x16x32_bf16 v[20:23], v[60:63], v[88:91], v[20:23]
ds_read_b64_tr_b16 v[50:51], v8 offset:9216
v_mfma_f32_16x16x32_bf16 v[36:39], v[56:59], v[84:87], v[36:39]
ds_read_b64_tr_b16 v[52:53], v8 offset:12288
v_mfma_f32_16x16x32_bf16 v[36:39], v[60:63], v[92:95], v[36:39]
ds_read_b64_tr_b16 v[54:55], v8 offset:13312
s_waitcnt lgkmcnt(10)
v_mfma_f32_16x16x32_bf16 v[24:27], v[64:67], v[80:83], v[24:27]
ds_read_b64_tr_b16 v[56:57], v9 offset:8192
s_waitcnt lgkmcnt(9)
v_mfma_f32_16x16x32_bf16 v[24:27], v[68:71], v[88:91], v[24:27]
ds_read_b64_tr_b16 v[58:59], v9 offset:9216
v_mfma_f32_16x16x32_bf16 v[40:43], v[64:67], v[84:87], v[40:43]
ds_read_b64_tr_b16 v[60:61], v9 offset:12288
v_mfma_f32_16x16x32_bf16 v[40:43], v[68:71], v[92:95], v[40:43]
ds_read_b64_tr_b16 v[62:63], v9 offset:13312
s_waitcnt lgkmcnt(10)
v_mfma_f32_16x16x32_bf16 v[28:31], v[72:75], v[80:83], v[28:31]
ds_read_b64_tr_b16 v[64:65], v10 offset:8192
s_waitcnt lgkmcnt(9)
v_mfma_f32_16x16x32_bf16 v[28:31], v[76:79], v[88:91], v[28:31]
ds_read_b64_tr_b16 v[66:67], v10 offset:9216
v_mfma_f32_16x16x32_bf16 v[44:47], v[72:75], v[84:87], v[44:47]
ds_read_b64_tr_b16 v[68:69], v10 offset:12288
v_mfma_f32_16x16x32_bf16 v[44:47], v[76:79], v[92:95], v[44:47]
ds_read_b64_tr_b16 v[70:71], v10 offset:13312
s_waitcnt vmcnt(27) lgkmcnt(10)
v_mfma_f32_16x16x32_bf16 v[16:19], v[48:51], v[96:99], v[16:19]
ds_read_b64_tr_b16 v[72:73], v11 offset:8192
buffer_load_dwordx4 v[80:83], v6, s[20:23], s66 offen offset:0 sc1
s_waitcnt vmcnt(27) lgkmcnt(9)
v_mfma_f32_16x16x32_bf16 v[16:19], v[52:55], v[104:107], v[16:19]
ds_read_b64_tr_b16 v[74:75], v11 offset:9216
buffer_load_dwordx4 v[88:91], v6, s[20:23], s66 offen offset:2048 sc1
s_waitcnt vmcnt(27)
v_mfma_f32_16x16x32_bf16 v[32:35], v[48:51], v[100:103], v[32:35]
ds_read_b64_tr_b16 v[76:77], v11 offset:12288
buffer_load_dwordx4 v[84:87], v6, s[20:23], s66 offen offset:256 sc1
s_waitcnt vmcnt(27)
v_mfma_f32_16x16x32_bf16 v[32:35], v[52:55], v[108:111], v[32:35]
ds_read_b64_tr_b16 v[78:79], v11 offset:13312
buffer_load_dwordx4 v[92:95], v6, s[20:23], s66 offen offset:2304 sc1
s_waitcnt lgkmcnt(10)
v_mfma_f32_16x16x32_bf16 v[20:23], v[56:59], v[96:99], v[20:23]
ds_read_b64_tr_b16 v[48:49], v8 offset:16384
s_add_u32 s66, s66, 4096
s_and_b32 s66, s66, 0xffff
s_waitcnt lgkmcnt(9)
v_mfma_f32_16x16x32_bf16 v[20:23], v[60:63], v[104:107], v[20:23]
ds_read_b64_tr_b16 v[50:51], v8 offset:17408
v_mfma_f32_16x16x32_bf16 v[36:39], v[56:59], v[100:103], v[36:39]
ds_read_b64_tr_b16 v[52:53], v8 offset:20480
v_mfma_f32_16x16x32_bf16 v[36:39], v[60:63], v[108:111], v[36:39]
ds_read_b64_tr_b16 v[54:55], v8 offset:21504
s_waitcnt lgkmcnt(10)
v_mfma_f32_16x16x32_bf16 v[24:27], v[64:67], v[96:99], v[24:27]
ds_read_b64_tr_b16 v[56:57], v9 offset:16384
s_waitcnt lgkmcnt(9)
v_mfma_f32_16x16x32_bf16 v[24:27], v[68:71], v[104:107], v[24:27]
ds_read_b64_tr_b16 v[58:59], v9 offset:17408
v_mfma_f32_16x16x32_bf16 v[40:43], v[64:67], v[100:103], v[40:43]
ds_read_b64_tr_b16 v[60:61], v9 offset:20480
v_mfma_f32_16x16x32_bf16 v[40:43], v[68:71], v[108:111], v[40:43]
ds_read_b64_tr_b16 v[62:63], v9 offset:21504
s_waitcnt lgkmcnt(10)
v_mfma_f32_16x16x32_bf16 v[28:31], v[72:75], v[96:99], v[28:31]
ds_read_b64_tr_b16 v[64:65], v10 offset:16384
s_waitcnt lgkmcnt(9)
v_mfma_f32_16x16x32_bf16 v[28:31], v[76:79], v[104:107], v[28:31]
ds_read_b64_tr_b16 v[66:67], v10 offset:17408
v_mfma_f32_16x16x32_bf16 v[44:47], v[72:75], v[100:103], v[44:47]
ds_read_b64_tr_b16 v[68:69], v10 offset:20480
v_mfma_f32_16x16x32_bf16 v[44:47], v[76:79], v[108:111], v[44:47]
ds_read_b64_tr_b16 v[70:71], v10 offset:21504
s_waitcnt vmcnt(27) lgkmcnt(10)
v_mfma_f32_16x16x32_bf16 v[16:19], v[48:51], v[112:115], v[16:19]
ds_read_b64_tr_b16 v[72:73], v11 offset:16384
buffer_load_dwordx4 v[96:99], v6, s[20:23], s66 offen offset:0 sc1
s_waitcnt vmcnt(27) lgkmcnt(9)
v_mfma_f32_16x16x32_bf16 v[16:19], v[52:55], v[120:123], v[16:19]
ds_read_b64_tr_b16 v[74:75], v11 offset:17408
buffer_load_dwordx4 v[104:107], v6, s[20:23], s66 offen offset:2048 sc1
s_waitcnt vmcnt(27)
v_mfma_f32_16x16x32_bf16 v[32:35], v[48:51], v[116:119], v[32:35]
ds_read_b64_tr_b16 v[76:77], v11 offset:20480
buffer_load_dwordx4 v[100:103], v6, s[20:23], s66 offen offset:256 sc1
s_waitcnt vmcnt(27)
v_mfma_f32_16x16x32_bf16 v[32:35], v[52:55], v[124:127], v[32:35]
ds_read_b64_tr_b16 v[78:79], v11 offset:21504
buffer_load_dwordx4 v[108:111], v6, s[20:23], s66 offen offset:2304 sc1
s_waitcnt lgkmcnt(10)
v_mfma_f32_16x16x32_bf16 v[20:23], v[56:59], v[112:115], v[20:23]
ds_read_b64_tr_b16 v[48:49], v8 offset:24576
s_add_u32 s66, s66, 4096
s_and_b32 s66, s66, 0xffff
s_waitcnt lgkmcnt(9)
v_mfma_f32_16x16x32_bf16 v[20:23], v[60:63], v[120:123], v[20:23]
ds_read_b64_tr_b16 v[50:51], v8 offset:25600
v_mfma_f32_16x16x32_bf16 v[36:39], v[56:59], v[116:119], v[36:39]
ds_read_b64_tr_b16 v[52:53], v8 offset:28672
v_mfma_f32_16x16x32_bf16 v[36:39], v[60:63], v[124:127], v[36:39]
ds_read_b64_tr_b16 v[54:55], v8 offset:29696
s_waitcnt lgkmcnt(10)
v_mfma_f32_16x16x32_bf16 v[24:27], v[64:67], v[112:115], v[24:27]
ds_read_b64_tr_b16 v[56:57], v9 offset:24576
s_waitcnt lgkmcnt(9)
v_mfma_f32_16x16x32_bf16 v[24:27], v[68:71], v[120:123], v[24:27]
ds_read_b64_tr_b16 v[58:59], v9 offset:25600
v_mfma_f32_16x16x32_bf16 v[40:43], v[64:67], v[116:119], v[40:43]
ds_read_b64_tr_b16 v[60:61], v9 offset:28672
v_mfma_f32_16x16x32_bf16 v[40:43], v[68:71], v[124:127], v[40:43]
ds_read_b64_tr_b16 v[62:63], v9 offset:29696
s_waitcnt lgkmcnt(10)
v_mfma_f32_16x16x32_bf16 v[28:31], v[72:75], v[112:115], v[28:31]
ds_read_b64_tr_b16 v[64:65], v10 offset:24576
s_waitcnt lgkmcnt(9)
v_mfma_f32_16x16x32_bf16 v[28:31], v[76:79], v[120:123], v[28:31]
ds_read_b64_tr_b16 v[66:67], v10 offset:25600
v_mfma_f32_16x16x32_bf16 v[44:47], v[72:75], v[116:119], v[44:47]
ds_read_b64_tr_b16 v[68:69], v10 offset:28672
v_mfma_f32_16x16x32_bf16 v[44:47], v[76:79], v[124:127], v[44:47]
ds_read_b64_tr_b16 v[70:71], v10 offset:29696
s_waitcnt vmcnt(27) lgkmcnt(10)
v_mfma_f32_16x16x32_bf16 v[16:19], v[48:51], v[128:131], v[16:19]
ds_read_b64_tr_b16 v[72:73], v11 offset:24576
buffer_load_dwordx4 v[112:115], v6, s[20:23], s66 offen offset:0 sc1
s_waitcnt vmcnt(27) lgkmcnt(9)
v_mfma_f32_16x16x32_bf16 v[16:19], v[52:55], v[136:139], v[16:19]
ds_read_b64_tr_b16 v[74:75], v11 offset:25600
buffer_load_dwordx4 v[120:123], v6, s[20:23], s66 offen offset:2048 sc1
s_waitcnt vmcnt(27)
v_mfma_f32_16x16x32_bf16 v[32:35], v[48:51], v[132:135], v[32:35]
ds_read_b64_tr_b16 v[76:77], v11 offset:28672
buffer_load_dwordx4 v[116:119], v6, s[20:23], s66 offen offset:256 sc1
s_waitcnt vmcnt(27)
v_mfma_f32_16x16x32_bf16 v[32:35], v[52:55], v[140:143], v[32:35]
ds_read_b64_tr_b16 v[78:79], v11 offset:29696
buffer_load_dwordx4 v[124:127], v6, s[20:23], s66 offen offset:2304 sc1
s_waitcnt lgkmcnt(10)
v_mfma_f32_16x16x32_bf16 v[20:23], v[56:59], v[128:131], v[20:23]
ds_read_b64_tr_b16 v[48:49], v8 offset:32768
s_add_u32 s66, s66, 4096
s_and_b32 s66, s66, 0xffff
s_waitcnt lgkmcnt(9)
v_mfma_f32_16x16x32_bf16 v[20:23], v[60:63], v[136:139], v[20:23]
ds_read_b64_tr_b16 v[50:51], v8 offset:33792
v_mfma_f32_16x16x32_bf16 v[36:39], v[56:59], v[132:135], v[36:39]
ds_read_b64_tr_b16 v[52:53], v8 offset:36864
v_mfma_f32_16x16x32_bf16 v[36:39], v[60:63], v[140:143], v[36:39]
ds_read_b64_tr_b16 v[54:55], v8 offset:37888
s_waitcnt lgkmcnt(10)
v_mfma_f32_16x16x32_bf16 v[24:27], v[64:67], v[128:131], v[24:27]
ds_read_b64_tr_b16 v[56:57], v9 offset:32768
s_waitcnt lgkmcnt(9)
v_mfma_f32_16x16x32_bf16 v[24:27], v[68:71], v[136:139], v[24:27]
ds_read_b64_tr_b16 v[58:59], v9 offset:33792
v_mfma_f32_16x16x32_bf16 v[40:43], v[64:67], v[132:135], v[40:43]
ds_read_b64_tr_b16 v[60:61], v9 offset:36864
v_mfma_f32_16x16x32_bf16 v[40:43], v[68:71], v[140:143], v[40:43]
ds_read_b64_tr_b16 v[62:63], v9 offset:37888
s_waitcnt lgkmcnt(10)
v_mfma_f32_16x16x32_bf16 v[28:31], v[72:75], v[128:131], v[28:31]
ds_read_b64_tr_b16 v[64:65], v10 offset:32768
s_waitcnt lgkmcnt(9)
v_mfma_f32_16x16x32_bf16 v[28:31], v[76:79], v[136:139], v[28:31]
ds_read_b64_tr_b16 v[66:67], v10 offset:33792
v_mfma_f32_16x16x32_bf16 v[44:47], v[72:75], v[132:135], v[44:47]
ds_read_b64_tr_b16 v[68:69], v10 offset:36864
v_mfma_f32_16x16x32_bf16 v[44:47], v[76:79], v[140:143], v[44:47]
ds_read_b64_tr_b16 v[70:71], v10 offset:37888
s_waitcnt vmcnt(27) lgkmcnt(10)
v_mfma_f32_16x16x32_bf16 v[16:19], v[48:51], v[144:147], v[16:19]
ds_read_b64_tr_b16 v[72:73], v11 offset:32768
buffer_load_dwordx4 v[128:131], v6, s[20:23], s66 offen offset:0 sc1
s_waitcnt vmcnt(27) lgkmcnt(9)
v_mfma_f32_16x16x32_bf16 v[16:19], v[52:55], v[152:155], v[16:19]
ds_read_b64_tr_b16 v[74:75], v11 offset:33792
buffer_load_dwordx4 v[136:139], v6, s[20:23], s66 offen offset:2048 sc1
s_waitcnt vmcnt(27)
v_mfma_f32_16x16x32_bf16 v[32:35], v[48:51], v[148:151], v[32:35]
ds_read_b64_tr_b16 v[76:77], v11 offset:36864
buffer_load_dwordx4 v[132:135], v6, s[20:23], s66 offen offset:256 sc1
s_waitcnt vmcnt(27)
v_mfma_f32_16x16x32_bf16 v[32:35], v[52:55], v[156:159], v[32:35]
ds_read_b64_tr_b16 v[78:79], v11 offset:37888
buffer_load_dwordx4 v[140:143], v6, s[20:23], s66 offen offset:2304 sc1
s_waitcnt lgkmcnt(10)
v_mfma_f32_16x16x32_bf16 v[20:23], v[56:59], v[144:147], v[20:23]
ds_read_b64_tr_b16 v[48:49], v8 offset:40960
s_add_u32 s66, s66, 4096
s_and_b32 s66, s66, 0xffff
s_waitcnt lgkmcnt(9)
v_mfma_f32_16x16x32_bf16 v[20:23], v[60:63], v[152:155], v[20:23]
ds_read_b64_tr_b16 v[50:51], v8 offset:41984
v_mfma_f32_16x16x32_bf16 v[36:39], v[56:59], v[148:151], v[36:39]
ds_read_b64_tr_b16 v[52:53], v8 offset:45056
v_mfma_f32_16x16x32_bf16 v[36:39], v[60:63], v[156:159], v[36:39]
ds_read_b64_tr_b16 v[54:55], v8 offset:46080
s_waitcnt lgkmcnt(10)
v_mfma_f32_16x16x32_bf16 v[24:27], v[64:67], v[144:147], v[24:27]
ds_read_b64_tr_b16 v[56:57], v9 offset:40960
s_waitcnt lgkmcnt(9)
v_mfma_f32_16x16x32_bf16 v[24:27], v[68:71], v[152:155], v[24:27]
ds_read_b64_tr_b16 v[58:59], v9 offset:41984
v_mfma_f32_16x16x32_bf16 v[40:43], v[64:67], v[148:151], v[40:43]
ds_read_b64_tr_b16 v[60:61], v9 offset:45056
v_mfma_f32_16x16x32_bf16 v[40:43], v[68:71], v[156:159], v[40:43]
ds_read_b64_tr_b16 v[62:63], v9 offset:46080
s_waitcnt lgkmcnt(10)
v_mfma_f32_16x16x32_bf16 v[28:31], v[72:75], v[144:147], v[28:31]
ds_read_b64_tr_b16 v[64:65], v10 offset:40960
s_waitcnt lgkmcnt(9)
v_mfma_f32_16x16x32_bf16 v[28:31], v[76:79], v[152:155], v[28:31]
ds_read_b64_tr_b16 v[66:67], v10 offset:41984
v_mfma_f32_16x16x32_bf16 v[44:47], v[72:75], v[148:151], v[44:47]
ds_read_b64_tr_b16 v[68:69], v10 offset:45056
v_mfma_f32_16x16x32_bf16 v[44:47], v[76:79], v[156:159], v[44:47]
ds_read_b64_tr_b16 v[70:71], v10 offset:46080
s_waitcnt vmcnt(27) lgkmcnt(10)
v_mfma_f32_16x16x32_bf16 v[16:19], v[48:51], v[160:163], v[16:19]
ds_read_b64_tr_b16 v[72:73], v11 offset:40960
buffer_load_dwordx4 v[144:147], v6, s[20:23], s66 offen offset:0 sc1
s_waitcnt vmcnt(27) lgkmcnt(9)
v_mfma_f32_16x16x32_bf16 v[16:19], v[52:55], v[168:171], v[16:19]
ds_read_b64_tr_b16 v[74:75], v11 offset:41984
buffer_load_dwordx4 v[152:155], v6, s[20:23], s66 offen offset:2048 sc1
s_waitcnt vmcnt(27)
v_mfma_f32_16x16x32_bf16 v[32:35], v[48:51], v[164:167], v[32:35]
ds_read_b64_tr_b16 v[76:77], v11 offset:45056
buffer_load_dwordx4 v[148:151], v6, s[20:23], s66 offen offset:256 sc1
s_waitcnt vmcnt(27)
v_mfma_f32_16x16x32_bf16 v[32:35], v[52:55], v[172:175], v[32:35]
ds_read_b64_tr_b16 v[78:79], v11 offset:46080
buffer_load_dwordx4 v[156:159], v6, s[20:23], s66 offen offset:2304 sc1
s_waitcnt lgkmcnt(10)
v_mfma_f32_16x16x32_bf16 v[20:23], v[56:59], v[160:163], v[20:23]
ds_read_b64_tr_b16 v[48:49], v8 offset:49152
s_add_u32 s66, s66, 4096
s_and_b32 s66, s66, 0xffff
s_waitcnt lgkmcnt(9)
v_mfma_f32_16x16x32_bf16 v[20:23], v[60:63], v[168:171], v[20:23]
ds_read_b64_tr_b16 v[50:51], v8 offset:50176
v_mfma_f32_16x16x32_bf16 v[36:39], v[56:59], v[164:167], v[36:39]
ds_read_b64_tr_b16 v[52:53], v8 offset:53248
v_mfma_f32_16x16x32_bf16 v[36:39], v[60:63], v[172:175], v[36:39]
ds_read_b64_tr_b16 v[54:55], v8 offset:54272
s_waitcnt lgkmcnt(10)
v_mfma_f32_16x16x32_bf16 v[24:27], v[64:67], v[160:163], v[24:27]
ds_read_b64_tr_b16 v[56:57], v9 offset:49152
s_waitcnt lgkmcnt(9)
v_mfma_f32_16x16x32_bf16 v[24:27], v[68:71], v[168:171], v[24:27]
ds_read_b64_tr_b16 v[58:59], v9 offset:50176
v_mfma_f32_16x16x32_bf16 v[40:43], v[64:67], v[164:167], v[40:43]
ds_read_b64_tr_b16 v[60:61], v9 offset:53248
v_mfma_f32_16x16x32_bf16 v[40:43], v[68:71], v[172:175], v[40:43]
ds_read_b64_tr_b16 v[62:63], v9 offset:54272
s_waitcnt lgkmcnt(10)
v_mfma_f32_16x16x32_bf16 v[28:31], v[72:75], v[160:163], v[28:31]
ds_read_b64_tr_b16 v[64:65], v10 offset:49152
s_waitcnt lgkmcnt(9)
v_mfma_f32_16x16x32_bf16 v[28:31], v[76:79], v[168:171], v[28:31]
ds_read_b64_tr_b16 v[66:67], v10 offset:50176
v_mfma_f32_16x16x32_bf16 v[44:47], v[72:75], v[164:167], v[44:47]
ds_read_b64_tr_b16 v[68:69], v10 offset:53248
v_mfma_f32_16x16x32_bf16 v[44:47], v[76:79], v[172:175], v[44:47]
ds_read_b64_tr_b16 v[70:71], v10 offset:54272
s_waitcnt vmcnt(27) lgkmcnt(10)
v_mfma_f32_16x16x32_bf16 v[16:19], v[48:51], v[176:179], v[16:19]
ds_read_b64_tr_b16 v[72:73], v11 offset:49152
buffer_load_dwordx4 v[160:163], v6, s[20:23], s66 offen offset:0 sc1
s_waitcnt vmcnt(27) lgkmcnt(9)
v_mfma_f32_16x16x32_bf16 v[16:19], v[52:55], v[184:187], v[16:19]
ds_read_b64_tr_b16 v[74:75], v11 offset:50176
buffer_load_dwordx4 v[168:171], v6, s[20:23], s66 offen offset:2048 sc1
s_waitcnt vmcnt(27)
v_mfma_f32_16x16x32_bf16 v[32:35], v[48:51], v[180:183], v[32:35]
ds_read_b64_tr_b16 v[76:77], v11 offset:53248
buffer_load_dwordx4 v[164:167], v6, s[20:23], s66 offen offset:256 sc1
s_waitcnt vmcnt(27)
v_mfma_f32_16x16x32_bf16 v[32:35], v[52:55], v[188:191], v[32:35]
ds_read_b64_tr_b16 v[78:79], v11 offset:54272
buffer_load_dwordx4 v[172:175], v6, s[20:23], s66 offen offset:2304 sc1
s_waitcnt lgkmcnt(10)
v_mfma_f32_16x16x32_bf16 v[20:23], v[56:59], v[176:179], v[20:23]
ds_read_b64_tr_b16 v[48:49], v8 offset:57344
s_add_u32 s66, s66, 4096
s_and_b32 s66, s66, 0xffff
s_waitcnt lgkmcnt(9)
v_mfma_f32_16x16x32_bf16 v[20:23], v[60:63], v[184:187], v[20:23]
ds_read_b64_tr_b16 v[50:51], v8 offset:58368
v_mfma_f32_16x16x32_bf16 v[36:39], v[56:59], v[180:183], v[36:39]
ds_read_b64_tr_b16 v[52:53], v8 offset:61440
v_mfma_f32_16x16x32_bf16 v[36:39], v[60:63], v[188:191], v[36:39]
ds_read_b64_tr_b16 v[54:55], v8 offset:62464
s_waitcnt lgkmcnt(10)
v_mfma_f32_16x16x32_bf16 v[24:27], v[64:67], v[176:179], v[24:27]
ds_read_b64_tr_b16 v[56:57], v9 offset:57344
s_waitcnt lgkmcnt(9)
v_mfma_f32_16x16x32_bf16 v[24:27], v[68:71], v[184:187], v[24:27]
ds_read_b64_tr_b16 v[58:59], v9 offset:58368
v_mfma_f32_16x16x32_bf16 v[40:43], v[64:67], v[180:183], v[40:43]
ds_read_b64_tr_b16 v[60:61], v9 offset:61440
v_mfma_f32_16x16x32_bf16 v[40:43], v[68:71], v[188:191], v[40:43]
ds_read_b64_tr_b16 v[62:63], v9 offset:62464
s_waitcnt lgkmcnt(10)
v_mfma_f32_16x16x32_bf16 v[28:31], v[72:75], v[176:179], v[28:31]
ds_read_b64_tr_b16 v[64:65], v10 offset:57344
s_waitcnt lgkmcnt(9)
v_mfma_f32_16x16x32_bf16 v[28:31], v[76:79], v[184:187], v[28:31]
ds_read_b64_tr_b16 v[66:67], v10 offset:58368
v_mfma_f32_16x16x32_bf16 v[44:47], v[72:75], v[180:183], v[44:47]
ds_read_b64_tr_b16 v[68:69], v10 offset:61440
v_mfma_f32_16x16x32_bf16 v[44:47], v[76:79], v[188:191], v[44:47]
ds_read_b64_tr_b16 v[70:71], v10 offset:62464
s_waitcnt vmcnt(27) lgkmcnt(10)
v_mfma_f32_16x16x32_bf16 v[16:19], v[48:51], v[192:195], v[16:19]
ds_read_b64_tr_b16 v[72:73], v11 offset:57344
buffer_load_dwordx4 v[176:179], v6, s[20:23], s66 offen offset:0 sc1
s_waitcnt vmcnt(27) lgkmcnt(9)
v_mfma_f32_16x16x32_bf16 v[16:19], v[52:55], v[200:203], v[16:19]
ds_read_b64_tr_b16 v[74:75], v11 offset:58368
buffer_load_dwordx4 v[184:187], v6, s[20:23], s66 offen offset:2048 sc1
s_waitcnt vmcnt(27)
v_mfma_f32_16x16x32_bf16 v[32:35], v[48:51], v[196:199], v[32:35]
ds_read_b64_tr_b16 v[76:77], v11 offset:61440
buffer_load_dwordx4 v[180:183], v6, s[20:23], s66 offen offset:256 sc1
s_waitcnt vmcnt(27)
v_mfma_f32_16x16x32_bf16 v[32:35], v[52:55], v[204:207], v[32:35]
ds_read_b64_tr_b16 v[78:79], v11 offset:62464
buffer_load_dwordx4 v[188:191], v6, s[20:23], s66 offen offset:2304 sc1
s_waitcnt lgkmcnt(10)
v_mfma_f32_16x16x32_bf16 v[20:23], v[56:59], v[192:195], v[20:23]
ds_read_b64_tr_b16 v[48:49], v12 offset:0
s_add_u32 s66, s66, 4096
s_and_b32 s66, s66, 0xffff
s_waitcnt lgkmcnt(9)
v_mfma_f32_16x16x32_bf16 v[20:23], v[60:63], v[200:203], v[20:23]
ds_read_b64_tr_b16 v[50:51], v12 offset:1024
v_mfma_f32_16x16x32_bf16 v[36:39], v[56:59], v[196:199], v[36:39]
ds_read_b64_tr_b16 v[52:53], v12 offset:4096
v_mfma_f32_16x16x32_bf16 v[36:39], v[60:63], v[204:207], v[36:39]
ds_read_b64_tr_b16 v[54:55], v12 offset:5120
s_waitcnt lgkmcnt(10)
v_mfma_f32_16x16x32_bf16 v[24:27], v[64:67], v[192:195], v[24:27]
ds_read_b64_tr_b16 v[56:57], v13 offset:0
s_waitcnt lgkmcnt(9)
v_mfma_f32_16x16x32_bf16 v[24:27], v[68:71], v[200:203], v[24:27]
ds_read_b64_tr_b16 v[58:59], v13 offset:1024
v_mfma_f32_16x16x32_bf16 v[40:43], v[64:67], v[196:199], v[40:43]
ds_read_b64_tr_b16 v[60:61], v13 offset:4096
v_mfma_f32_16x16x32_bf16 v[40:43], v[68:71], v[204:207], v[40:43]
ds_read_b64_tr_b16 v[62:63], v13 offset:5120
s_waitcnt lgkmcnt(10)
v_mfma_f32_16x16x32_bf16 v[28:31], v[72:75], v[192:195], v[28:31]
ds_read_b64_tr_b16 v[64:65], v14 offset:0
s_waitcnt lgkmcnt(9)
v_mfma_f32_16x16x32_bf16 v[28:31], v[76:79], v[200:203], v[28:31]
ds_read_b64_tr_b16 v[66:67], v14 offset:1024
v_mfma_f32_16x16x32_bf16 v[44:47], v[72:75], v[196:199], v[44:47]
ds_read_b64_tr_b16 v[68:69], v14 offset:4096
v_mfma_f32_16x16x32_bf16 v[44:47], v[76:79], v[204:207], v[44:47]
ds_read_b64_tr_b16 v[70:71], v14 offset:5120
s_waitcnt vmcnt(27) lgkmcnt(10)
v_mfma_f32_16x16x32_bf16 v[16:19], v[48:51], v[80:83], v[16:19]
ds_read_b64_tr_b16 v[72:73], v15 offset:0
buffer_load_dwordx4 v[192:195], v6, s[20:23], s66 offen offset:0 sc1
s_waitcnt vmcnt(27) lgkmcnt(9)
v_mfma_f32_16x16x32_bf16 v[16:19], v[52:55], v[88:91], v[16:19]
ds_read_b64_tr_b16 v[74:75], v15 offset:1024
buffer_load_dwordx4 v[200:203], v6, s[20:23], s66 offen offset:2048 sc1
s_waitcnt vmcnt(27)
v_mfma_f32_16x16x32_bf16 v[32:35], v[48:51], v[84:87], v[32:35]
ds_read_b64_tr_b16 v[76:77], v15 offset:4096
buffer_load_dwordx4 v[196:199], v6, s[20:23], s66 offen offset:256 sc1
s_waitcnt vmcnt(27)
v_mfma_f32_16x16x32_bf16 v[32:35], v[52:55], v[92:95], v[32:35]
ds_read_b64_tr_b16 v[78:79], v15 offset:5120
buffer_load_dwordx4 v[204:207], v6, s[20:23], s66 offen offset:2304 sc1
s_waitcnt lgkmcnt(10)
v_mfma_f32_16x16x32_bf16 v[20:23], v[56:59], v[80:83], v[20:23]
ds_read_b64_tr_b16 v[48:49], v12 offset:8192
s_add_u32 s66, s66, 4096
s_and_b32 s66, s66, 0xffff
s_waitcnt lgkmcnt(9)
v_mfma_f32_16x16x32_bf16 v[20:23], v[60:63], v[88:91], v[20:23]
ds_read_b64_tr_b16 v[50:51], v12 offset:9216
v_mfma_f32_16x16x32_bf16 v[36:39], v[56:59], v[84:87], v[36:39]
ds_read_b64_tr_b16 v[52:53], v12 offset:12288
v_mfma_f32_16x16x32_bf16 v[36:39], v[60:63], v[92:95], v[36:39]
ds_read_b64_tr_b16 v[54:55], v12 offset:13312
s_waitcnt lgkmcnt(10)
v_mfma_f32_16x16x32_bf16 v[24:27], v[64:67], v[80:83], v[24:27]
ds_read_b64_tr_b16 v[56:57], v13 offset:8192
s_waitcnt lgkmcnt(9)
v_mfma_f32_16x16x32_bf16 v[24:27], v[68:71], v[88:91], v[24:27]
ds_read_b64_tr_b16 v[58:59], v13 offset:9216
v_mfma_f32_16x16x32_bf16 v[40:43], v[64:67], v[84:87], v[40:43]
ds_read_b64_tr_b16 v[60:61], v13 offset:12288
v_mfma_f32_16x16x32_bf16 v[40:43], v[68:71], v[92:95], v[40:43]
ds_read_b64_tr_b16 v[62:63], v13 offset:13312
s_waitcnt lgkmcnt(10)
v_mfma_f32_16x16x32_bf16 v[28:31], v[72:75], v[80:83], v[28:31]
ds_read_b64_tr_b16 v[64:65], v14 offset:8192
s_waitcnt lgkmcnt(9)
v_mfma_f32_16x16x32_bf16 v[28:31], v[76:79], v[88:91], v[28:31]
ds_read_b64_tr_b16 v[66:67], v14 offset:9216
v_mfma_f32_16x16x32_bf16 v[44:47], v[72:75], v[84:87], v[44:47]
ds_read_b64_tr_b16 v[68:69], v14 offset:12288
v_mfma_f32_16x16x32_bf16 v[44:47], v[76:79], v[92:95], v[44:47]
ds_read_b64_tr_b16 v[70:71], v14 offset:13312
s_waitcnt vmcnt(27) lgkmcnt(10)
v_mfma_f32_16x16x32_bf16 v[16:19], v[48:51], v[96:99], v[16:19]
ds_read_b64_tr_b16 v[72:73], v15 offset:8192
s_waitcnt vmcnt(26) lgkmcnt(9)
v_mfma_f32_16x16x32_bf16 v[16:19], v[52:55], v[104:107], v[16:19]
ds_read_b64_tr_b16 v[74:75], v15 offset:9216
s_waitcnt vmcnt(25)
v_mfma_f32_16x16x32_bf16 v[32:35], v[48:51], v[100:103], v[32:35]
ds_read_b64_tr_b16 v[76:77], v15 offset:12288
s_waitcnt vmcnt(24)
v_mfma_f32_16x16x32_bf16 v[32:35], v[52:55], v[108:111], v[32:35]
ds_read_b64_tr_b16 v[78:79], v15 offset:13312
s_waitcnt lgkmcnt(10)
v_mfma_f32_16x16x32_bf16 v[20:23], v[56:59], v[96:99], v[20:23]
ds_read_b64_tr_b16 v[48:49], v12 offset:16384
s_waitcnt lgkmcnt(9)
v_mfma_f32_16x16x32_bf16 v[20:23], v[60:63], v[104:107], v[20:23]
ds_read_b64_tr_b16 v[50:51], v12 offset:17408
v_mfma_f32_16x16x32_bf16 v[36:39], v[56:59], v[100:103], v[36:39]
ds_read_b64_tr_b16 v[52:53], v12 offset:20480
v_mfma_f32_16x16x32_bf16 v[36:39], v[60:63], v[108:111], v[36:39]
ds_read_b64_tr_b16 v[54:55], v12 offset:21504
s_waitcnt lgkmcnt(10)
v_mfma_f32_16x16x32_bf16 v[24:27], v[64:67], v[96:99], v[24:27]
ds_read_b64_tr_b16 v[56:57], v13 offset:16384
s_waitcnt lgkmcnt(9)
v_mfma_f32_16x16x32_bf16 v[24:27], v[68:71], v[104:107], v[24:27]
ds_read_b64_tr_b16 v[58:59], v13 offset:17408
v_mfma_f32_16x16x32_bf16 v[40:43], v[64:67], v[100:103], v[40:43]
ds_read_b64_tr_b16 v[60:61], v13 offset:20480
v_mfma_f32_16x16x32_bf16 v[40:43], v[68:71], v[108:111], v[40:43]
ds_read_b64_tr_b16 v[62:63], v13 offset:21504
s_waitcnt lgkmcnt(10)
v_mfma_f32_16x16x32_bf16 v[28:31], v[72:75], v[96:99], v[28:31]
ds_read_b64_tr_b16 v[64:65], v14 offset:16384
s_waitcnt lgkmcnt(9)
v_mfma_f32_16x16x32_bf16 v[28:31], v[76:79], v[104:107], v[28:31]
ds_read_b64_tr_b16 v[66:67], v14 offset:17408
v_mfma_f32_16x16x32_bf16 v[44:47], v[72:75], v[100:103], v[44:47]
ds_read_b64_tr_b16 v[68:69], v14 offset:20480
v_mfma_f32_16x16x32_bf16 v[44:47], v[76:79], v[108:111], v[44:47]
ds_read_b64_tr_b16 v[70:71], v14 offset:21504
s_waitcnt vmcnt(23) lgkmcnt(10)
v_mfma_f32_16x16x32_bf16 v[16:19], v[48:51], v[112:115], v[16:19]
ds_read_b64_tr_b16 v[72:73], v15 offset:16384
s_waitcnt vmcnt(22) lgkmcnt(9)
v_mfma_f32_16x16x32_bf16 v[16:19], v[52:55], v[120:123], v[16:19]
ds_read_b64_tr_b16 v[74:75], v15 offset:17408
s_waitcnt vmcnt(21)
v_mfma_f32_16x16x32_bf16 v[32:35], v[48:51], v[116:119], v[32:35]
ds_read_b64_tr_b16 v[76:77], v15 offset:20480
s_waitcnt vmcnt(20)
v_mfma_f32_16x16x32_bf16 v[32:35], v[52:55], v[124:127], v[32:35]
ds_read_b64_tr_b16 v[78:79], v15 offset:21504
s_waitcnt lgkmcnt(10)
v_mfma_f32_16x16x32_bf16 v[20:23], v[56:59], v[112:115], v[20:23]
ds_read_b64_tr_b16 v[48:49], v12 offset:24576
s_waitcnt lgkmcnt(9)
v_mfma_f32_16x16x32_bf16 v[20:23], v[60:63], v[120:123], v[20:23]
ds_read_b64_tr_b16 v[50:51], v12 offset:25600
v_mfma_f32_16x16x32_bf16 v[36:39], v[56:59], v[116:119], v[36:39]
ds_read_b64_tr_b16 v[52:53], v12 offset:28672
v_mfma_f32_16x16x32_bf16 v[36:39], v[60:63], v[124:127], v[36:39]
ds_read_b64_tr_b16 v[54:55], v12 offset:29696
s_waitcnt lgkmcnt(10)
v_mfma_f32_16x16x32_bf16 v[24:27], v[64:67], v[112:115], v[24:27]
ds_read_b64_tr_b16 v[56:57], v13 offset:24576
s_waitcnt lgkmcnt(9)
v_mfma_f32_16x16x32_bf16 v[24:27], v[68:71], v[120:123], v[24:27]
ds_read_b64_tr_b16 v[58:59], v13 offset:25600
v_mfma_f32_16x16x32_bf16 v[40:43], v[64:67], v[116:119], v[40:43]
ds_read_b64_tr_b16 v[60:61], v13 offset:28672
v_mfma_f32_16x16x32_bf16 v[40:43], v[68:71], v[124:127], v[40:43]
ds_read_b64_tr_b16 v[62:63], v13 offset:29696
s_waitcnt lgkmcnt(10)
v_mfma_f32_16x16x32_bf16 v[28:31], v[72:75], v[112:115], v[28:31]
ds_read_b64_tr_b16 v[64:65], v14 offset:24576
s_waitcnt lgkmcnt(9)
v_mfma_f32_16x16x32_bf16 v[28:31], v[76:79], v[120:123], v[28:31]
ds_read_b64_tr_b16 v[66:67], v14 offset:25600
v_mfma_f32_16x16x32_bf16 v[44:47], v[72:75], v[116:119], v[44:47]
ds_read_b64_tr_b16 v[68:69], v14 offset:28672
v_mfma_f32_16x16x32_bf16 v[44:47], v[76:79], v[124:127], v[44:47]
ds_read_b64_tr_b16 v[70:71], v14 offset:29696
s_waitcnt vmcnt(19) lgkmcnt(10)
v_mfma_f32_16x16x32_bf16 v[16:19], v[48:51], v[128:131], v[16:19]
ds_read_b64_tr_b16 v[72:73], v15 offset:24576
s_waitcnt vmcnt(18) lgkmcnt(9)
v_mfma_f32_16x16x32_bf16 v[16:19], v[52:55], v[136:139], v[16:19]
ds_read_b64_tr_b16 v[74:75], v15 offset:25600
s_waitcnt vmcnt(17)
v_mfma_f32_16x16x32_bf16 v[32:35], v[48:51], v[132:135], v[32:35]
ds_read_b64_tr_b16 v[76:77], v15 offset:28672
s_waitcnt vmcnt(16)
v_mfma_f32_16x16x32_bf16 v[32:35], v[52:55], v[140:143], v[32:35]
ds_read_b64_tr_b16 v[78:79], v15 offset:29696
s_waitcnt lgkmcnt(10)
v_mfma_f32_16x16x32_bf16 v[20:23], v[56:59], v[128:131], v[20:23]
ds_read_b64_tr_b16 v[48:49], v12 offset:32768
s_waitcnt lgkmcnt(9)
v_mfma_f32_16x16x32_bf16 v[20:23], v[60:63], v[136:139], v[20:23]
ds_read_b64_tr_b16 v[50:51], v12 offset:33792
v_mfma_f32_16x16x32_bf16 v[36:39], v[56:59], v[132:135], v[36:39]
ds_read_b64_tr_b16 v[52:53], v12 offset:36864
v_mfma_f32_16x16x32_bf16 v[36:39], v[60:63], v[140:143], v[36:39]
ds_read_b64_tr_b16 v[54:55], v12 offset:37888
s_waitcnt lgkmcnt(10)
v_mfma_f32_16x16x32_bf16 v[24:27], v[64:67], v[128:131], v[24:27]
ds_read_b64_tr_b16 v[56:57], v13 offset:32768
s_waitcnt lgkmcnt(9)
v_mfma_f32_16x16x32_bf16 v[24:27], v[68:71], v[136:139], v[24:27]
ds_read_b64_tr_b16 v[58:59], v13 offset:33792
v_mfma_f32_16x16x32_bf16 v[40:43], v[64:67], v[132:135], v[40:43]
ds_read_b64_tr_b16 v[60:61], v13 offset:36864
v_mfma_f32_16x16x32_bf16 v[40:43], v[68:71], v[140:143], v[40:43]
ds_read_b64_tr_b16 v[62:63], v13 offset:37888
s_waitcnt lgkmcnt(10)
v_mfma_f32_16x16x32_bf16 v[28:31], v[72:75], v[128:131], v[28:31]
ds_read_b64_tr_b16 v[64:65], v14 offset:32768
s_waitcnt lgkmcnt(9)
v_mfma_f32_16x16x32_bf16 v[28:31], v[76:79], v[136:139], v[28:31]
ds_read_b64_tr_b16 v[66:67], v14 offset:33792
v_mfma_f32_16x16x32_bf16 v[44:47], v[72:75], v[132:135], v[44:47]
ds_read_b64_tr_b16 v[68:69], v14 offset:36864
v_mfma_f32_16x16x32_bf16 v[44:47], v[76:79], v[140:143], v[44:47]
ds_read_b64_tr_b16 v[70:71], v14 offset:37888
s_waitcnt vmcnt(15) lgkmcnt(10)
v_mfma_f32_16x16x32_bf16 v[16:19], v[48:51], v[144:147], v[16:19]
ds_read_b64_tr_b16 v[72:73], v15 offset:32768
s_waitcnt vmcnt(14) lgkmcnt(9)
v_mfma_f32_16x16x32_bf16 v[16:19], v[52:55], v[152:155], v[16:19]
ds_read_b64_tr_b16 v[74:75], v15 offset:33792
s_waitcnt vmcnt(13)
v_mfma_f32_16x16x32_bf16 v[32:35], v[48:51], v[148:151], v[32:35]
ds_read_b64_tr_b16 v[76:77], v15 offset:36864
s_waitcnt vmcnt(12)
v_mfma_f32_16x16x32_bf16 v[32:35], v[52:55], v[156:159], v[32:35]
ds_read_b64_tr_b16 v[78:79], v15 offset:37888
s_waitcnt lgkmcnt(10)
v_mfma_f32_16x16x32_bf16 v[20:23], v[56:59], v[144:147], v[20:23]
ds_read_b64_tr_b16 v[48:49], v12 offset:40960
s_waitcnt lgkmcnt(9)
v_mfma_f32_16x16x32_bf16 v[20:23], v[60:63], v[152:155], v[20:23]
ds_read_b64_tr_b16 v[50:51], v12 offset:41984
v_mfma_f32_16x16x32_bf16 v[36:39], v[56:59], v[148:151], v[36:39]
ds_read_b64_tr_b16 v[52:53], v12 offset:45056
v_mfma_f32_16x16x32_bf16 v[36:39], v[60:63], v[156:159], v[36:39]
ds_read_b64_tr_b16 v[54:55], v12 offset:46080
s_waitcnt lgkmcnt(10)
v_mfma_f32_16x16x32_bf16 v[24:27], v[64:67], v[144:147], v[24:27]
ds_read_b64_tr_b16 v[56:57], v13 offset:40960
s_waitcnt lgkmcnt(9)
v_mfma_f32_16x16x32_bf16 v[24:27], v[68:71], v[152:155], v[24:27]
ds_read_b64_tr_b16 v[58:59], v13 offset:41984
v_mfma_f32_16x16x32_bf16 v[40:43], v[64:67], v[148:151], v[40:43]
ds_read_b64_tr_b16 v[60:61], v13 offset:45056
v_mfma_f32_16x16x32_bf16 v[40:43], v[68:71], v[156:159], v[40:43]
ds_read_b64_tr_b16 v[62:63], v13 offset:46080
s_waitcnt lgkmcnt(10)
v_mfma_f32_16x16x32_bf16 v[28:31], v[72:75], v[144:147], v[28:31]
ds_read_b64_tr_b16 v[64:65], v14 offset:40960
s_waitcnt lgkmcnt(9)
v_mfma_f32_16x16x32_bf16 v[28:31], v[76:79], v[152:155], v[28:31]
ds_read_b64_tr_b16 v[66:67], v14 offset:41984
v_mfma_f32_16x16x32_bf16 v[44:47], v[72:75], v[148:151], v[44:47]
ds_read_b64_tr_b16 v[68:69], v14 offset:45056
v_mfma_f32_16x16x32_bf16 v[44:47], v[76:79], v[156:159], v[44:47]
ds_read_b64_tr_b16 v[70:71], v14 offset:46080
s_waitcnt vmcnt(11) lgkmcnt(10)
v_mfma_f32_16x16x32_bf16 v[16:19], v[48:51], v[160:163], v[16:19]
ds_read_b64_tr_b16 v[72:73], v15 offset:40960
s_waitcnt vmcnt(10) lgkmcnt(9)
v_mfma_f32_16x16x32_bf16 v[16:19], v[52:55], v[168:171], v[16:19]
ds_read_b64_tr_b16 v[74:75], v15 offset:41984
s_waitcnt vmcnt(9)
v_mfma_f32_16x16x32_bf16 v[32:35], v[48:51], v[164:167], v[32:35]
ds_read_b64_tr_b16 v[76:77], v15 offset:45056
s_waitcnt vmcnt(8)
v_mfma_f32_16x16x32_bf16 v[32:35], v[52:55], v[172:175], v[32:35]
ds_read_b64_tr_b16 v[78:79], v15 offset:46080
s_waitcnt lgkmcnt(10)
v_mfma_f32_16x16x32_bf16 v[20:23], v[56:59], v[160:163], v[20:23]
ds_read_b64_tr_b16 v[48:49], v12 offset:49152
s_waitcnt lgkmcnt(9)
v_mfma_f32_16x16x32_bf16 v[20:23], v[60:63], v[168:171], v[20:23]
ds_read_b64_tr_b16 v[50:51], v12 offset:50176
v_mfma_f32_16x16x32_bf16 v[36:39], v[56:59], v[164:167], v[36:39]
ds_read_b64_tr_b16 v[52:53], v12 offset:53248
v_mfma_f32_16x16x32_bf16 v[36:39], v[60:63], v[172:175], v[36:39]
ds_read_b64_tr_b16 v[54:55], v12 offset:54272
s_waitcnt lgkmcnt(10)
v_mfma_f32_16x16x32_bf16 v[24:27], v[64:67], v[160:163], v[24:27]
ds_read_b64_tr_b16 v[56:57], v13 offset:49152
s_waitcnt lgkmcnt(9)
v_mfma_f32_16x16x32_bf16 v[24:27], v[68:71], v[168:171], v[24:27]
ds_read_b64_tr_b16 v[58:59], v13 offset:50176
v_mfma_f32_16x16x32_bf16 v[40:43], v[64:67], v[164:167], v[40:43]
ds_read_b64_tr_b16 v[60:61], v13 offset:53248
v_mfma_f32_16x16x32_bf16 v[40:43], v[68:71], v[172:175], v[40:43]
ds_read_b64_tr_b16 v[62:63], v13 offset:54272
s_waitcnt lgkmcnt(10)
v_mfma_f32_16x16x32_bf16 v[28:31], v[72:75], v[160:163], v[28:31]
ds_read_b64_tr_b16 v[64:65], v14 offset:49152
s_waitcnt lgkmcnt(9)
v_mfma_f32_16x16x32_bf16 v[28:31], v[76:79], v[168:171], v[28:31]
ds_read_b64_tr_b16 v[66:67], v14 offset:50176
v_mfma_f32_16x16x32_bf16 v[44:47], v[72:75], v[164:167], v[44:47]
ds_read_b64_tr_b16 v[68:69], v14 offset:53248
v_mfma_f32_16x16x32_bf16 v[44:47], v[76:79], v[172:175], v[44:47]
ds_read_b64_tr_b16 v[70:71], v14 offset:54272
s_waitcnt vmcnt(7) lgkmcnt(10)
v_mfma_f32_16x16x32_bf16 v[16:19], v[48:51], v[176:179], v[16:19]
ds_read_b64_tr_b16 v[72:73], v15 offset:49152
s_waitcnt vmcnt(6) lgkmcnt(9)
v_mfma_f32_16x16x32_bf16 v[16:19], v[52:55], v[184:187], v[16:19]
ds_read_b64_tr_b16 v[74:75], v15 offset:50176
s_waitcnt vmcnt(5)
v_mfma_f32_16x16x32_bf16 v[32:35], v[48:51], v[180:183], v[32:35]
ds_read_b64_tr_b16 v[76:77], v15 offset:53248
s_waitcnt vmcnt(4)
v_mfma_f32_16x16x32_bf16 v[32:35], v[52:55], v[188:191], v[32:35]
ds_read_b64_tr_b16 v[78:79], v15 offset:54272
s_waitcnt lgkmcnt(10)
v_mfma_f32_16x16x32_bf16 v[20:23], v[56:59], v[176:179], v[20:23]
ds_read_b64_tr_b16 v[48:49], v12 offset:57344
s_waitcnt lgkmcnt(9)
v_mfma_f32_16x16x32_bf16 v[20:23], v[60:63], v[184:187], v[20:23]
ds_read_b64_tr_b16 v[50:51], v12 offset:58368
v_mfma_f32_16x16x32_bf16 v[36:39], v[56:59], v[180:183], v[36:39]
ds_read_b64_tr_b16 v[52:53], v12 offset:61440
v_mfma_f32_16x16x32_bf16 v[36:39], v[60:63], v[188:191], v[36:39]
ds_read_b64_tr_b16 v[54:55], v12 offset:62464
s_waitcnt lgkmcnt(10)
v_mfma_f32_16x16x32_bf16 v[24:27], v[64:67], v[176:179], v[24:27]
ds_read_b64_tr_b16 v[56:57], v13 offset:57344
s_waitcnt lgkmcnt(9)
v_mfma_f32_16x16x32_bf16 v[24:27], v[68:71], v[184:187], v[24:27]
ds_read_b64_tr_b16 v[58:59], v13 offset:58368
v_mfma_f32_16x16x32_bf16 v[40:43], v[64:67], v[180:183], v[40:43]
ds_read_b64_tr_b16 v[60:61], v13 offset:61440
v_mfma_f32_16x16x32_bf16 v[40:43], v[68:71], v[188:191], v[40:43]
ds_read_b64_tr_b16 v[62:63], v13 offset:62464
s_waitcnt lgkmcnt(10)
v_mfma_f32_16x16x32_bf16 v[28:31], v[72:75], v[176:179], v[28:31]
ds_read_b64_tr_b16 v[64:65], v14 offset:57344
s_waitcnt lgkmcnt(9)
v_mfma_f32_16x16x32_bf16 v[28:31], v[76:79], v[184:187], v[28:31]
ds_read_b64_tr_b16 v[66:67], v14 offset:58368
v_mfma_f32_16x16x32_bf16 v[44:47], v[72:75], v[180:183], v[44:47]
ds_read_b64_tr_b16 v[68:69], v14 offset:61440
v_mfma_f32_16x16x32_bf16 v[44:47], v[76:79], v[188:191], v[44:47]
ds_read_b64_tr_b16 v[70:71], v14 offset:62464
s_waitcnt vmcnt(3) lgkmcnt(10)
v_mfma_f32_16x16x32_bf16 v[16:19], v[48:51], v[192:195], v[16:19]
ds_read_b64_tr_b16 v[72:73], v15 offset:57344
s_waitcnt vmcnt(2) lgkmcnt(9)
v_mfma_f32_16x16x32_bf16 v[16:19], v[52:55], v[200:203], v[16:19]
ds_read_b64_tr_b16 v[74:75], v15 offset:58368
s_waitcnt vmcnt(1)
v_mfma_f32_16x16x32_bf16 v[32:35], v[48:51], v[196:199], v[32:35]
ds_read_b64_tr_b16 v[76:77], v15 offset:61440
s_waitcnt vmcnt(0)
v_mfma_f32_16x16x32_bf16 v[32:35], v[52:55], v[204:207], v[32:35]
ds_read_b64_tr_b16 v[78:79], v15 offset:62464
s_waitcnt lgkmcnt(10)
v_mfma_f32_16x16x32_bf16 v[20:23], v[56:59], v[192:195], v[20:23]
v_add_u32 v5, s34, 22
s_mov_b64 exec, 1
ds_write_b32 v3, v5
s_mov_b64 exec, -1
s_waitcnt lgkmcnt(9)
v_mfma_f32_16x16x32_bf16 v[20:23], v[60:63], v[200:203], v[20:23]
v_mfma_f32_16x16x32_bf16 v[36:39], v[56:59], v[196:199], v[36:39]
v_mfma_f32_16x16x32_bf16 v[36:39], v[60:63], v[204:207], v[36:39]
s_waitcnt lgkmcnt(7)
v_mfma_f32_16x16x32_bf16 v[24:27], v[64:67], v[192:195], v[24:27]
s_waitcnt lgkmcnt(5)
v_mfma_f32_16x16x32_bf16 v[24:27], v[68:71], v[200:203], v[24:27]
v_mfma_f32_16x16x32_bf16 v[40:43], v[64:67], v[196:199], v[40:43]
v_mfma_f32_16x16x32_bf16 v[40:43], v[68:71], v[204:207], v[40:43]
s_waitcnt lgkmcnt(3)
v_mfma_f32_16x16x32_bf16 v[28:31], v[72:75], v[192:195], v[28:31]
s_waitcnt lgkmcnt(1)
v_mfma_f32_16x16x32_bf16 v[28:31], v[76:79], v[200:203], v[28:31]
v_mfma_f32_16x16x32_bf16 v[44:47], v[72:75], v[196:199], v[44:47]
v_mfma_f32_16x16x32_bf16 v[44:47], v[76:79], v[204:207], v[44:47]
s_lshl2_add_u32 s73, s61, s58
s_lshl4_add_u32 s66, s61, s62
s_lshl2_add_u32 s68, s66, s58
s_lshl_b32 s68, s68, 12
s_add_u32 s68, s68, 26214400
s_lshl_b32 s66, s61, 7
s_add_u32 s66, s66, s62
s_lshl_b32 s66, s66, 7
s_add_u32 s66, s66, 274432
s_lshl_b32 s74, s73, 13
s_add_u32 s74, s74, 524288
s_lshl_b32 s67, s62, 9
s_add_u32 s67, s67, s74
v_lshlrev_b32 v6, 4, v0
s_mov_b32 s69, 0x3f803f80
v_mov_b32 v8, 0
v_mov_b32 v9, 0
v_mov_b32 v10, 0
v_mov_b32 v11, 0
v_mov_b32 v12, 0
v_mov_b32 v13, 0
v_mov_b32 v14, 0
v_dot2c_f32_bf16 v11, s69, v232
v_dot2c_f32_bf16 v11, s69, v233
v_dot2c_f32_bf16 v11, s69, v234
v_dot2c_f32_bf16 v11, s69, v235
v_dot2c_f32_bf16 v11, s69, v236
v_dot2c_f32_bf16 v11, s69, v237
v_dot2c_f32_bf16 v11, s69, v238
v_dot2c_f32_bf16 v11, s69, v239
s_cmp_eq_u32 s63, 0
v_cvt_pk_bf16_f32 v240, v16, v17
v_cvt_pk_bf16_f32 v241, v18, v19
v_cvt_pk_bf16_f32 v242, v20, v21
v_cvt_pk_bf16_f32 v243, v22, v23
v_cvt_pk_bf16_f32 v244, v24, v25
v_cvt_pk_bf16_f32 v245, v26, v27
v_cvt_pk_bf16_f32 v246, v28, v29
v_cvt_pk_bf16_f32 v247, v30, v31
v_cvt_pk_bf16_f32 v248, v32, v33
v_cvt_pk_bf16_f32 v249, v34, v35
v_cvt_pk_bf16_f32 v250, v36, v37
v_cvt_pk_bf16_f32 v251, v38, v39
v_cvt_pk_bf16_f32 v252, v40, v41
v_cvt_pk_bf16_f32 v253, v42, v43
v_cvt_pk_bf16_f32 v254, v44, v45
v_cvt_pk_bf16_f32 v255, v46, v47
s_cselect_b64 exec, -1, 0
buffer_store_dwordx4 v[240:243], v6, s[20:23], s68 offen offset:0 sc1
buffer_store_dwordx4 v[244:247], v6, s[20:23], s68 offen offset:1024 sc1
buffer_store_dwordx4 v[248:251], v6, s[20:23], s68 offen offset:2048 sc1
buffer_store_dwordx4 v[252:255], v6, s[20:23], s68 offen offset:3072 sc1
s_mov_b64 exec, -1
v_dot2c_f32_bf16 v8, s69, v240
v_dot2c_f32_bf16 v9, v240, v240
v_dot2c_f32_bf16 v10, v232, v240
v_dot2c_f32_bf16 v12, s69, v248
v_dot2c_f32_bf16 v13, v248, v248
v_dot2c_f32_bf16 v14, v232, v248
v_dot2c_f32_bf16 v8, s69, v241
v_dot2c_f32_bf16 v9, v241, v241
v_dot2c_f32_bf16 v10, v233, v241
v_dot2c_f32_bf16 v12, s69, v249
v_dot2c_f32_bf16 v13, v249, v249
v_dot2c_f32_bf16 v14, v233, v249
v_dot2c_f32_bf16 v8, s69, v242
v_dot2c_f32_bf16 v9, v242, v242
v_dot2c_f32_bf16 v10, v234, v242
v_dot2c_f32_bf16 v12, s69, v250
v_dot2c_f32_bf16 v13, v250, v250
v_dot2c_f32_bf16 v14, v234, v250
v_dot2c_f32_bf16 v8, s69, v243
v_dot2c_f32_bf16 v9, v243, v243
v_dot2c_f32_bf16 v10, v235, v243
v_dot2c_f32_bf16 v12, s69, v251
v_dot2c_f32_bf16 v13, v251, v251
v_dot2c_f32_bf16 v14, v235, v251
v_dot2c_f32_bf16 v8, s69, v244
v_dot2c_f32_bf16 v9, v244, v244
v_dot2c_f32_bf16 v10, v236, v244
v_dot2c_f32_bf16 v12, s69, v252
v_dot2c_f32_bf16 v13, v252, v252
v_dot2c_f32_bf16 v14, v236, v252
v_dot2c_f32_bf16 v8, s69, v245
v_dot2c_f32_bf16 v9, v245, v245
v_dot2c_f32_bf16 v10, v237, v245
v_dot2c_f32_bf16 v12, s69, v253
v_dot2c_f32_bf16 v13, v253, v253
v_dot2c_f32_bf16 v14, v237, v253
v_dot2c_f32_bf16 v8, s69, v246
v_dot2c_f32_bf16 v9, v246, v246
v_dot2c_f32_bf16 v10, v238, v246
v_dot2c_f32_bf16 v12, s69, v254
v_dot2c_f32_bf16 v13, v254, v254
v_dot2c_f32_bf16 v14, v238, v254
v_dot2c_f32_bf16 v8, s69, v247
v_dot2c_f32_bf16 v9, v247, v247
v_dot2c_f32_bf16 v10, v239, v247
v_dot2c_f32_bf16 v12, s69, v255
v_dot2c_f32_bf16 v13, v255, v255
v_dot2c_f32_bf16 v14, v239, v255
v_mov_b32 v15, v11
v_lshrrev_b32 v7, 5, v0
v_mul_u32_u24 v7, 3584, v7
v_permlane16_swap_b32 v8, v12
v_permlane16_swap_b32 v9, v13
v_permlane16_swap_b32 v10, v14
v_permlane16_swap_b32 v11, v15
v_pk_add_f32 v[8:9], v[8:9], v[12:13]
v_pk_add_f32 v[10:11], v[10:11], v[14:15]
v_mov_b32 v12, v8
v_mov_b32 v13, v9
v_mov_b32 v14, v10
v_mov_b32 v15, v11
v_permlane32_swap_b32 v12, v8
v_permlane32_swap_b32 v13, v9
v_permlane32_swap_b32 v14, v10
v_permlane32_swap_b32 v15, v11
v_pk_add_f32 v[8:9], v[8:9], v[12:13]
v_pk_add_f32 v[10:11], v[10:11], v[14:15]
v_add_u32 v7, v6, v7
v_max_u32 v8, 1, v8
v_max_u32 v9, 1, v9
v_max_u32 v10, 1, v10
v_max_u32 v11, 1, v11
s_mov_b32 exec_hi, 0
buffer_store_dwordx4 v[8:11], v6, s[24:27], s67 offen sc1
s_mov_b32 exec_hi, -1
v_lshlrev_b32 v16, 16, v240
v_and_b32 v17, 0xffff0000, v240
v_lshlrev_b32 v18, 16, v241
v_and_b32 v19, 0xffff0000, v241
v_lshlrev_b32 v20, 16, v242
v_and_b32 v21, 0xffff0000, v242
v_lshlrev_b32 v22, 16, v243
v_and_b32 v23, 0xffff0000, v243
v_lshlrev_b32 v24, 16, v244
v_and_b32 v25, 0xffff0000, v244
v_lshlrev_b32 v26, 16, v245
v_and_b32 v27, 0xffff0000, v245
v_lshlrev_b32 v28, 16, v246
v_and_b32 v29, 0xffff0000, v246
v_lshlrev_b32 v30, 16, v247
v_and_b32 v31, 0xffff0000, v247
v_lshlrev_b32 v32, 16, v248
v_and_b32 v33, 0xffff0000, v248
v_lshlrev_b32 v34, 16, v249
v_and_b32 v35, 0xffff0000, v249
v_lshlrev_b32 v36, 16, v250
v_and_b32 v37, 0xffff0000, v250
v_lshlrev_b32 v38, 16, v251
v_and_b32 v39, 0xffff0000, v251
v_lshlrev_b32 v40, 16, v252
v_and_b32 v41, 0xffff0000, v252
v_lshlrev_b32 v42, 16, v253
v_and_b32 v43, 0xffff0000, v253
v_lshlrev_b32 v44, 16, v254
v_and_b32 v45, 0xffff0000, v254
v_lshlrev_b32 v46, 16, v255
v_and_b32 v47, 0xffff0000, v255
v_and_b32 v14, 15, v0
v_lshlrev_b32 v14, 11, v14
v_bfe_u32 v15, v0, 4, 1
v_lshl_add_u32 v14, v15, 5, v14
v_lshrrev_b32 v15, 5, v0
v_lshl_add_u32 v14, v15, 4, v14
s_lshl2_add_u32 s70, s61, s58
s_lshl_b32 s70, s70, 16
s_lshl_b32 s71, s62, 7
s_add_u32 s70, s70, s71
s_add_u32 s71, s70, 0x8000
s_lshl_b32 s67, s62, 6
s_sub_u32 s68, s66, 2048
s_lshl1_add_u32 s69, s67, s68
s_sub_u32 s69, s69, 10240
s_sub_u32 s72, s68, s67
s_add_u32 s72, s72, 4096
s_lshl_b32 s75, s73, 5
s_add_u32 s75, s75, 1
v_and_b32 v15, 48, v0
v_add_u32 v13, s75, v0
v_lshlrev_b32 v4, 1, v15
s_mov_b64 exec, 1
s_waitcnt vmcnt(1)
buffer_store_dword v212, v3, s[24:27], s66 offen sc1
s_mov_b64 exec, -1
v_add_u32 v5, s34, 23
s_mov_b64 exec, 1
ds_write_b32 v3, v5
s_mov_b64 exec, -1
s_waitcnt vmcnt(1)
poll_134:
buffer_load_dwordx4 v[80:83], v7, s[24:27], s74 offen offset:0 sc1
buffer_load_dwordx4 v[84:87], v7, s[24:27], s74 offen offset:512 sc1
buffer_load_dwordx4 v[88:91], v7, s[24:27], s74 offen offset:1024 sc1
buffer_load_dwordx4 v[92:95], v7, s[24:27], s74 offen offset:1536 sc1
buffer_load_dwordx4 v[96:99], v7, s[24:27], s74 offen offset:2048 sc1
buffer_load_dwordx4 v[100:103], v7, s[24:27], s74 offen offset:2560 sc1
buffer_load_dwordx4 v[104:107], v7, s[24:27], s74 offen offset:3072 sc1
buffer_load_dwordx4 v[108:111], v7, s[24:27], s74 offen offset:3584 sc1
pchk_135:
s_waitcnt vmcnt(7)
v_min3_u32 v8, v80, v81, v82
s_waitcnt vmcnt(6)
v_min3_u32 v8, v8, v83, v84
v_min3_u32 v8, v8, v85, v86
s_waitcnt vmcnt(5)
v_min3_u32 v8, v8, v87, v88
v_min3_u32 v8, v8, v89, v90
s_waitcnt vmcnt(4)
v_min3_u32 v8, v8, v91, v92
v_min3_u32 v8, v8, v93, v94
s_waitcnt vmcnt(3)
v_min3_u32 v8, v8, v95, v96
v_min3_u32 v8, v8, v97, v98
s_waitcnt vmcnt(2)
v_min3_u32 v8, v8, v99, v100
v_min3_u32 v8, v8, v101, v102
s_waitcnt vmcnt(1)
v_min3_u32 v8, v8, v103, v104
v_min3_u32 v8, v8, v105, v106
s_waitcnt vmcnt(0)
v_min3_u32 v8, v8, v107, v108
v_min3_u32 v8, v8, v109, v110
v_min_u32 v8, v8, v111
v_cmp_eq_u32 vcc, 0, v8
s_cbranch_vccz pdone_136
s_sub_u32 s32, s32, 1
s_cmp_gt_i32 s32, 0
s_cbranch_scc1 poll_134
pdone_136:
v_pk_add_f32 v[80:81], v[80:81], v[96:97]
v_pk_add_f32 v[82:83], v[82:83], v[98:99]
v_pk_add_f32 v[84:85], v[84:85], v[100:101]
v_pk_add_f32 v[86:87], v[86:87], v[102:103]
v_pk_add_f32 v[88:89], v[88:89], v[104:105]
v_pk_add_f32 v[90:91], v[90:91], v[106:107]
v_pk_add_f32 v[92:93], v[92:93], v[108:109]
v_pk_add_f32 v[94:95], v[94:95], v[110:111]
v_pk_add_f32 v[80:81], v[80:81], v[88:89]
v_pk_add_f32 v[82:83], v[82:83], v[90:91]
v_pk_add_f32 v[84:85], v[84:85], v[92:93]
v_pk_add_f32 v[86:87], v[86:87], v[94:95]
v_pk_add_f32 v[80:81], v[80:81], v[84:85]
v_pk_add_f32 v[82:83], v[82:83], v[86:87]
v_mov_b32 v8, v80
v_mov_b32 v9, v81
v_mov_b32 v10, v82
v_mov_b32 v11, v83
v_permlane32_swap_b32 v8, v80
v_permlane32_swap_b32 v9, v81
v_permlane32_swap_b32 v10, v82
v_permlane32_swap_b32 v11, v83
v_pk_add_f32 v[8:9], v[8:9], v[80:81]
v_pk_add_f32 v[10:11], v[10:11], v[82:83]
v_mul_f32 v8, 0xba800000, v8
v_mul_f32 v9, 0x3a800000, v9
v_fma_f32 v9, -v8, v8, v9
v_max_f32 v9, 0, v9
v_add_f32 v12, 0x3727c5ac, v9
v_rsq_f32 v80, v12
v_fma_f32 v10, v8, v11, v10
v_mul_f32 v12, v80, v10
v_max_u32 v12, 1, v12
v_add_u32 v7, s34, v3
v_mov_b32 v6, v12
s_nop 1
v_max_f32_dpp v6, v6, v6 row_ror:1 row_mask:0xf bank_mask:0xf
s_nop 1
v_max_f32_dpp v6, v6, v6 row_ror:2 row_mask:0xf bank_mask:0xf
s_nop 1
v_max_f32_dpp v6, v6, v6 row_ror:4 row_mask:0xf bank_mask:0xf
s_nop 1
v_max_f32_dpp v6, v6, v6 row_ror:8 row_mask:0xf bank_mask:0xf
v_mov_b32 v11, v6
s_nop 1
v_permlane16_swap_b32 v11, v6
v_max_f32 v6, v6, v11
v_cmp_eq_f32 vcc, v6, v12
s_ff1_i32_b64 s66, vcc
s_and_b32 s66, s66, 31
s_mov_b64 exec, 1
ds_write_b32 v7, v6 offset:256
s_mov_b64 exec, -1
v_add_u32 v7, s34, v1
v_mul_f32 v81, v8, v80
v_add_f32 v10, 1.0, v80
v_mov_b32 v82, v80
v_mov_b32 v83, v81
s_and_b32 s67, s66, 15
s_lshl_b32 s67, 0x10001, s67
s_bitcmp0_b32 s66, 4
v_permlane16_swap_b32 v80, v82
v_permlane16_swap_b32 v81, v83
s_cselect_b32 s76, s67, 0
s_cselect_b32 s78, 0, s67
s_cselect_b32 s77, s67, 0
s_cselect_b32 s79, 0, s67
s_add_u32 s75, s75, s66
v_pk_fma_f32 v[48:49], v[16:17], v[80:81], v[80:81] op_sel:[0,0,1] op_sel_hi:[1,0,1]
v_pk_fma_f32 v[50:51], v[18:19], v[80:81], v[80:81] op_sel:[0,0,1] op_sel_hi:[1,0,1]
v_pk_fma_f32 v[52:53], v[20:21], v[80:81], v[80:81] op_sel:[0,0,1] op_sel_hi:[1,0,1]
v_pk_fma_f32 v[54:55], v[22:23], v[80:81], v[80:81] op_sel:[0,0,1] op_sel_hi:[1,0,1]
v_pk_fma_f32 v[56:57], v[24:25], v[80:81], v[80:81] op_sel:[0,0,1] op_sel_hi:[1,0,1]
v_pk_fma_f32 v[58:59], v[26:27], v[80:81], v[80:81] op_sel:[0,0,1] op_sel_hi:[1,0,1]
v_pk_fma_f32 v[60:61], v[28:29], v[80:81], v[80:81] op_sel:[0,0,1] op_sel_hi:[1,0,1]
v_pk_fma_f32 v[62:63], v[30:31], v[80:81], v[80:81] op_sel:[0,0,1] op_sel_hi:[1,0,1]
v_pk_fma_f32 v[64:65], v[32:33], v[82:83], v[82:83] op_sel:[0,0,1] op_sel_hi:[1,0,1]
v_pk_fma_f32 v[66:67], v[34:35], v[82:83], v[82:83] op_sel:[0,0,1] op_sel_hi:[1,0,1]
v_pk_fma_f32 v[68:69], v[36:37], v[82:83], v[82:83] op_sel:[0,0,1] op_sel_hi:[1,0,1]
v_pk_fma_f32 v[70:71], v[38:39], v[82:83], v[82:83] op_sel:[0,0,1] op_sel_hi:[1,0,1]
v_pk_fma_f32 v[72:73], v[40:41], v[82:83], v[82:83] op_sel:[0,0,1] op_sel_hi:[1,0,1]
v_pk_fma_f32 v[74:75], v[42:43], v[82:83], v[82:83] op_sel:[0,0,1] op_sel_hi:[1,0,1]
v_pk_fma_f32 v[76:77], v[44:45], v[82:83], v[82:83] op_sel:[0,0,1] op_sel_hi:[1,0,1]
v_pk_fma_f32 v[78:79], v[46:47], v[82:83], v[82:83] op_sel:[0,0,1] op_sel_hi:[1,0,1]
v_cvt_pk_bf16_f32 v84, v48, v49
v_cvt_pk_bf16_f32 v85, v50, v51
v_cvt_pk_bf16_f32 v86, v52, v53
v_cvt_pk_bf16_f32 v87, v54, v55
v_cvt_pk_bf16_f32 v88, v56, v57
v_cvt_pk_bf16_f32 v89, v58, v59
v_cvt_pk_bf16_f32 v90, v60, v61
v_cvt_pk_bf16_f32 v91, v62, v63
v_cvt_pk_bf16_f32 v92, v64, v65
v_cvt_pk_bf16_f32 v93, v66, v67
v_cvt_pk_bf16_f32 v94, v68, v69
v_cvt_pk_bf16_f32 v95, v70, v71
v_cvt_pk_bf16_f32 v96, v72, v73
v_cvt_pk_bf16_f32 v97, v74, v75
v_cvt_pk_bf16_f32 v98, v76, v77
v_cvt_pk_bf16_f32 v99, v78, v79
ds_read_b32 v11, v7 offset:256
v_max_u32 v84, 1, v84
v_max_u32 v85, 1, v85
v_max_u32 v86, 1, v86
v_max_u32 v87, 1, v87
v_max_u32 v88, 1, v88
v_max_u32 v89, 1, v89
v_max_u32 v90, 1, v90
v_max_u32 v91, 1, v91
v_max_u32 v92, 1, v92
v_max_u32 v93, 1, v93
v_max_u32 v94, 1, v94
v_max_u32 v95, 1, v95
v_max_u32 v96, 1, v96
v_max_u32 v97, 1, v97
v_max_u32 v98, 1, v98
v_max_u32 v99, 1, v99
s_branch pchk_138
poll_137:
ds_read_b32 v11, v7 offset:256
pchk_138:
s_waitcnt lgkmcnt(0)
v_cmp_eq_u32 vcc, 0, v11
s_cbranch_vccz pdone_139
s_sub_u32 s32, s32, 1
s_cmp_gt_i32 s32, 0
s_cbranch_scc1 poll_137
pdone_139:
v_cmp_eq_f32 vcc, v11, v6
s_bfm_b32 s67, s58, 0
s_and_b32 s67, s67, vcc_lo
v_cmp_gt_f32 vcc, v11, v6
s_lshl_b32 s66, 1, s66
s_or_b32 s67, s67, vcc_lo
s_cselect_b64 s[76:77], 0, s[76:77]
s_cselect_b64 s[78:79], 0, s[78:79]
s_cselect_b64 exec, 0, s[66:67]
s_bitcmp0_b32 s62, 0
s_cselect_b64 exec, exec, 0
buffer_store_dwordx2 v[12:13], off, s[24:27], s72 sc1
s_mov_b64 exec, s[76:77]
buffer_store_dwordx4 v[84:87], v4, s[24:27], s68 offen offset:0 sc1
buffer_store_dwordx4 v[88:91], v4, s[24:27], s68 offen offset:16 sc1
s_mov_b64 exec, s[78:79]
buffer_store_dwordx4 v[92:95], v4, s[24:27], s68 offen offset:0 sc1
buffer_store_dwordx4 v[96:99], v4, s[24:27], s68 offen offset:16 sc1
s_mov_b64 exec, -1
v_add_u32 v5, s34, 24
s_mov_b64 exec, 1
ds_write_b32 v3, v5
s_mov_b64 exec, -1
v_pk_add_f32 v[16:17], v[16:17], v[48:49]
v_pk_add_f32 v[18:19], v[18:19], v[50:51]
v_pk_add_f32 v[20:21], v[20:21], v[52:53]
v_pk_add_f32 v[22:23], v[22:23], v[54:55]
v_pk_add_f32 v[24:25], v[24:25], v[56:57]
v_pk_add_f32 v[26:27], v[26:27], v[58:59]
v_pk_add_f32 v[28:29], v[28:29], v[60:61]
v_pk_add_f32 v[30:31], v[30:31], v[62:63]
v_pk_add_f32 v[32:33], v[32:33], v[64:65]
v_pk_add_f32 v[34:35], v[34:35], v[66:67]
v_pk_add_f32 v[36:37], v[36:37], v[68:69]
v_pk_add_f32 v[38:39], v[38:39], v[70:71]
v_pk_add_f32 v[40:41], v[40:41], v[72:73]
v_pk_add_f32 v[42:43], v[42:43], v[74:75]
v_pk_add_f32 v[44:45], v[44:45], v[76:77]
v_pk_add_f32 v[46:47], v[46:47], v[78:79]
v_cvt_pk_bf16_f32 v240, v16, v17
v_cvt_pk_bf16_f32 v241, v18, v19
v_cvt_pk_bf16_f32 v242, v20, v21
v_cvt_pk_bf16_f32 v243, v22, v23
v_cvt_pk_bf16_f32 v244, v24, v25
v_cvt_pk_bf16_f32 v245, v26, v27
v_cvt_pk_bf16_f32 v246, v28, v29
v_cvt_pk_bf16_f32 v247, v30, v31
v_cvt_pk_bf16_f32 v248, v32, v33
v_cvt_pk_bf16_f32 v249, v34, v35
v_cvt_pk_bf16_f32 v250, v36, v37
v_cvt_pk_bf16_f32 v251, v38, v39
v_cvt_pk_bf16_f32 v252, v40, v41
v_cvt_pk_bf16_f32 v253, v42, v43
v_cvt_pk_bf16_f32 v254, v44, v45
v_cvt_pk_bf16_f32 v255, v46, v47
v_max_u32 v16, 1, v16
v_max_u32 v17, 1, v17
v_max_u32 v18, 1, v18
v_max_u32 v19, 1, v19
v_max_u32 v20, 1, v20
v_max_u32 v21, 1, v21
v_max_u32 v22, 1, v22
v_max_u32 v23, 1, v23
v_max_u32 v24, 1, v24
v_max_u32 v25, 1, v25
v_max_u32 v26, 1, v26
v_max_u32 v27, 1, v27
v_max_u32 v28, 1, v28
v_max_u32 v29, 1, v29
v_max_u32 v30, 1, v30
v_max_u32 v31, 1, v31
v_max_u32 v32, 1, v32
v_max_u32 v33, 1, v33
v_max_u32 v34, 1, v34
v_max_u32 v35, 1, v35
v_max_u32 v36, 1, v36
v_max_u32 v37, 1, v37
v_max_u32 v38, 1, v38
v_max_u32 v39, 1, v39
v_max_u32 v40, 1, v40
v_max_u32 v41, 1, v41
v_max_u32 v42, 1, v42
v_max_u32 v43, 1, v43
v_max_u32 v44, 1, v44
v_max_u32 v45, 1, v45
v_max_u32 v46, 1, v46
v_max_u32 v47, 1, v47
s_mov_b64 exec, s[76:77]
buffer_store_dwordx4 v[16:19], v15, s[24:27], s69 offen offset:0 sc1
buffer_store_dwordx4 v[20:23], v15, s[24:27], s69 offen offset:64 sc1
buffer_store_dwordx4 v[24:27], v15, s[24:27], s69 offen offset:128 sc1
buffer_store_dwordx4 v[28:31], v15, s[24:27], s69 offen offset:192 sc1
s_mov_b64 exec, s[78:79]
buffer_store_dwordx4 v[32:35], v15, s[24:27], s69 offen offset:0 sc1
buffer_store_dwordx4 v[36:39], v15, s[24:27], s69 offen offset:64 sc1
buffer_store_dwordx4 v[40:43], v15, s[24:27], s69 offen offset:128 sc1
buffer_store_dwordx4 v[44:47], v15, s[24:27], s69 offen offset:192 sc1
s_mov_b64 exec, -1
s_cmp_eq_u32 s63, 0
s_cbranch_scc0 mout_140
v_mul_f32 v11, v10, v10
v_mov_b32 v12, 0x3727c5ac
v_fma_f32 v11, v11, v9, v12
v_rsq_f32 v11, v11
v_lshrrev_b32 v12, 3, v0
v_lshlrev_b32 v12, 6, v12
v_lshl_add_u32 v12, v0, 3, v12
v_mul_f32 v10, v10, v11
v_mul_f32 v11, v8, v10
s_lshl_b32 s66, s61, 5
s_add_u32 s66, s66, s58
s_lshl_b32 s66, s66, 9
s_add_u32 s66, s66, 1675264
v_max_u32 v11, 1, v11
s_cmp_eq_u32 s62, 8
s_cselect_b32 exec_lo, -1, 0
s_mov_b32 exec_hi, 0
buffer_store_dwordx2 v[10:11], v12, s[24:27], s66 offen sc1
s_mov_b64 exec, -1
s_mov_b32 s63, 1
s_mov_b32 s34, 32
s_add_u32 s24, s24, 1409024
s_addc_u32 s25, s25, 0
s_mov_b32 s26, 1409024
s_branch L_mtop
mout_140:
v_permlane16_swap_b32 v240, v242
v_permlane16_swap_b32 v241, v243
v_permlane16_swap_b32 v244, v246
v_permlane16_swap_b32 v245, v247
v_permlane16_swap_b32 v248, v250
v_permlane16_swap_b32 v249, v251
v_permlane16_swap_b32 v252, v254
v_permlane16_swap_b32 v253, v255
s_not_b64 exec, s[76:77]
buffer_store_dwordx4 v[240:243], v14, s[28:31], s70 offen offset:0
buffer_store_dwordx4 v[244:247], v14, s[28:31], s70 offen offset:64
s_not_b64 exec, s[78:79]
buffer_store_dwordx4 v[248:251], v14, s[28:31], s71 offen offset:0
buffer_store_dwordx4 v[252:255], v14, s[28:31], s71 offen offset:64
s_mov_b64 exec, -1
s_or_b32 s66, s76, s78
s_cbranch_scc0 L_end
v_mov_b32 v11, 0
s_add_u32 s35, s34, 4
lw_141:
ds_read_b32 v5, v2 offset:24
s_waitcnt lgkmcnt(0)
v_cmp_gt_i32 vcc, s35, v5
s_cbranch_vccz lwd_142
s_sleep 2
s_sub_u32 s32, s32, 1
s_cmp_gt_i32 s32, 0
s_cbranch_scc1 lw_141
lwd_142:
ds_read_b32 v11, v11 offset:32
s_waitcnt lgkmcnt(0)
v_cmp_eq_u32 vcc, s75, v11
s_cbranch_vccnz L_end
s_mov_b64 exec, s[76:77]
buffer_store_dwordx4 v[240:243], v14, s[28:31], s70 offen offset:0
buffer_store_dwordx4 v[244:247], v14, s[28:31], s70 offen offset:64
s_mov_b64 exec, s[78:79]
buffer_store_dwordx4 v[248:251], v14, s[28:31], s71 offen offset:0
buffer_store_dwordx4 v[252:255], v14, s[28:31], s71 offen offset:64
s_mov_b64 exec, -1
s_branch L_end
mspin_107:
s_cmp_eq_u32 s66, 1
s_cbranch_scc1 mback_108
msp_143:
ds_read_b32 v5, v2 offset:16
s_waitcnt lgkmcnt(0)
v_cmp_ge_u32 vcc, v4, v5
s_cbranch_vccz mback_108
s_sub_u32 s32, s32, 1
s_cmp_gt_i32 s32, 0
s_cbranch_scc1 msp_143
s_branch mback_108
patch_111:
s_bfe_u32 s66, s33, 0x20005
s_lshr_b32 s67, s66, 1
s_xor_b32 s66, s66, s67
s_and_b32 s66, s66, 1
s_cmp_eq_u32 s66, s65
s_cbranch_scc0 pback_112
s_lshl_b32 s67, s67, 5
s_and_b32 s66, s33, 31
s_add_u32 s66, s66, s67
v_and_b32 v10, 15, v0
v_sub_u32 v10, s66, v10
v_lshrrev_b32 v11, 4, v0
v_lshlrev_b32 v11, 2, v11
v_sub_u32 v11, s66, v11
v_cmp_eq_u32 vcc, 0, v10
s_mov_b64 exec, vcc
ds_read_b128 v[16:19], v9 offset:3456
ds_read_b128 v[20:23], v9 offset:3520
ds_read_b128 v[80:83], v9 offset:3328
ds_read_b128 v[84:87], v9 offset:3392
s_mov_b64 exec, -1
v_cmp_eq_u32 vcc, 0, v11
s_mov_b64 exec, vcc
ds_read_b32 v48, v8 offset:3584
ds_read_b32 v52, v8 offset:3648
s_mov_b64 exec, -1
v_cmp_eq_u32 vcc, 1, v11
s_mov_b64 exec, vcc
ds_read_b32 v49, v8 offset:3584
ds_read_b32 v53, v8 offset:3648
s_mov_b64 exec, -1
v_cmp_eq_u32 vcc, 2, v11
s_mov_b64 exec, vcc
ds_read_b32 v50, v8 offset:3584
ds_read_b32 v54, v8 offset:3648
s_mov_b64 exec, -1
v_cmp_eq_u32 vcc, 3, v11
s_mov_b64 exec, vcc
ds_read_b32 v51, v8 offset:3584
ds_read_b32 v55, v8 offset:3648
s_mov_b64 exec, -1
s_waitcnt lgkmcnt(0)
v_cmp_eq_u32 vcc, 16, v10
s_mov_b64 exec, vcc
ds_read_b128 v[24:27], v9 offset:3456
ds_read_b128 v[28:31], v9 offset:3520
ds_read_b128 v[88:91], v9 offset:3328
ds_read_b128 v[92:95], v9 offset:3392
s_mov_b64 exec, -1
v_cmp_eq_u32 vcc, 16, v11
s_mov_b64 exec, vcc
ds_read_b32 v56, v8 offset:3584
ds_read_b32 v60, v8 offset:3648
s_mov_b64 exec, -1
v_cmp_eq_u32 vcc, 17, v11
s_mov_b64 exec, vcc
ds_read_b32 v57, v8 offset:3584
ds_read_b32 v61, v8 offset:3648
s_mov_b64 exec, -1
v_cmp_eq_u32 vcc, 18, v11
s_mov_b64 exec, vcc
ds_read_b32 v58, v8 offset:3584
ds_read_b32 v62, v8 offset:3648
s_mov_b64 exec, -1
v_cmp_eq_u32 vcc, 19, v11
s_mov_b64 exec, vcc
ds_read_b32 v59, v8 offset:3584
ds_read_b32 v63, v8 offset:3648
s_mov_b64 exec, -1
s_waitcnt lgkmcnt(0)
v_cmp_eq_u32 vcc, 32, v10
s_mov_b64 exec, vcc
ds_read_b128 v[32:35], v9 offset:3456
ds_read_b128 v[36:39], v9 offset:3520
ds_read_b128 v[96:99], v9 offset:3328
ds_read_b128 v[100:103], v9 offset:3392
s_mov_b64 exec, -1
v_cmp_eq_u32 vcc, 32, v11
s_mov_b64 exec, vcc
ds_read_b32 v64, v8 offset:3584
ds_read_b32 v68, v8 offset:3648
s_mov_b64 exec, -1
v_cmp_eq_u32 vcc, 33, v11
s_mov_b64 exec, vcc
ds_read_b32 v65, v8 offset:3584
ds_read_b32 v69, v8 offset:3648
s_mov_b64 exec, -1
v_cmp_eq_u32 vcc, 34, v11
s_mov_b64 exec, vcc
ds_read_b32 v66, v8 offset:3584
ds_read_b32 v70, v8 offset:3648
s_mov_b64 exec, -1
v_cmp_eq_u32 vcc, 35, v11
s_mov_b64 exec, vcc
ds_read_b32 v67, v8 offset:3584
ds_read_b32 v71, v8 offset:3648
s_mov_b64 exec, -1
s_waitcnt lgkmcnt(0)
v_cmp_eq_u32 vcc, 48, v10
s_mov_b64 exec, vcc
ds_read_b128 v[40:43], v9 offset:3456
ds_read_b128 v[44:47], v9 offset:3520
ds_read_b128 v[104:107], v9 offset:3328
ds_read_b128 v[108:111], v9 offset:3392
s_mov_b64 exec, -1
v_cmp_eq_u32 vcc, 48, v11
s_mov_b64 exec, vcc
ds_read_b32 v72, v8 offset:3584
ds_read_b32 v76, v8 offset:3648
s_mov_b64 exec, -1
v_cmp_eq_u32 vcc, 49, v11
s_mov_b64 exec, vcc
ds_read_b32 v73, v8 offset:3584
ds_read_b32 v77, v8 offset:3648
s_mov_b64 exec, -1
v_cmp_eq_u32 vcc, 50, v11
s_mov_b64 exec, vcc
ds_read_b32 v74, v8 offset:3584
ds_read_b32 v78, v8 offset:3648
s_mov_b64 exec, -1
v_cmp_eq_u32 vcc, 51, v11
s_mov_b64 exec, vcc
ds_read_b32 v75, v8 offset:3584
ds_read_b32 v79, v8 offset:3648
s_mov_b64 exec, -1
s_waitcnt lgkmcnt(0)
s_branch pback_112
cross_122:
s_cmp_eq_u32 s67, 122880
s_cbranch_scc0 cr2_144
v_add_u32 v5, s34, 18
s_mov_b64 exec, 1
ds_write_b32 v3, v5
s_mov_b64 exec, -1
s_add_u32 s70, s72, 270336
s_mov_b64 exec, 1
s_waitcnt vmcnt(0)
buffer_store_dword v5, v3, s[24:27], s70 offen sc1
s_mov_b64 exec, -1
v_mov_b32 v9, 0xf149f2ca
v_xor_b32 v216, v9, v216
v_xor_b32 v217, v9, v217
v_xor_b32 v218, v9, v218
v_xor_b32 v219, v9, v219
v_xor_b32 v220, v9, v220
v_xor_b32 v221, v9, v221
v_xor_b32 v222, v9, v222
v_xor_b32 v223, v9, v223
v_xor_b32 v224, v9, v224
v_xor_b32 v225, v9, v225
v_xor_b32 v226, v9, v226
v_xor_b32 v227, v9, v227
v_xor_b32 v228, v9, v228
v_xor_b32 v229, v9, v229
v_xor_b32 v230, v9, v230
v_xor_b32 v231, v9, v231
s_mov_b32 s67, 90112
s_cmp_eq_u32 s63, 0
s_cbranch_scc0 cr3_145
v_and_b32 v9, 15, v0
v_lshlrev_b32 v9, 11, v9
v_bfe_u32 v10, v0, 4, 1
v_lshl_add_u32 v9, v10, 5, v9
v_lshrrev_b32 v10, 5, v0
v_lshl_add_u32 v9, v10, 4, v9
s_lshl2_add_u32 s70, s61, s58
s_lshl_b32 s70, s70, 16
s_lshl_b32 s71, s62, 7
s_add_u32 s70, s70, s71
s_add_u32 s71, s70, 0x8000
buffer_load_dwordx4 v[240:243], v9, s[8:11], s70 offen offset:0
buffer_load_dwordx4 v[244:247], v9, s[8:11], s70 offen offset:64
buffer_load_dwordx4 v[248:251], v9, s[8:11], s71 offen offset:0
buffer_load_dwordx4 v[252:255], v9, s[8:11], s71 offen offset:64
cr3_145:
s_cmp_eq_u32 s59, 0
s_cbranch_scc1 cback_123
v_mov_b32 v9, 0
s_add_u32 s35, s34, 17
lw_146:
ds_read_b32 v5, v9 offset:16
s_waitcnt lgkmcnt(0)
v_cmp_gt_i32 vcc, s35, v5
s_cbranch_vccz lwd_147
s_sub_u32 s32, s32, 1
s_cmp_gt_i32 s32, 0
s_cbranch_scc1 lw_146
lwd_147:
s_branch cback_123
cr2_144:
v_add_u32 v5, s34, 19
s_mov_b64 exec, 1
ds_write_b32 v3, v5
s_mov_b64 exec, -1
s_mov_b32 s66, 28672
s_cmp_lt_u32 s59, 2
s_cbranch_scc1 cback_123
s_add_u32 s35, s34, 17
lw_148:
ds_read_b32 v5, v2 offset:16
s_waitcnt lgkmcnt(0)
v_cmp_gt_i32 vcc, s35, v5
s_cbranch_vccz lwd_149
s_sub_u32 s32, s32, 1
s_cmp_gt_i32 s32, 0
s_cbranch_scc1 lw_148
lwd_149:
s_branch cback_123
cross_124:
s_cmp_eq_u32 s67, 122880
s_cbranch_scc0 cr2_150
v_add_u32 v5, s34, 18
s_mov_b64 exec, 1
ds_write_b32 v3, v5
s_mov_b64 exec, -1
s_add_u32 s70, s72, 270336
s_mov_b64 exec, 1
s_waitcnt vmcnt(0)
buffer_store_dword v5, v3, s[24:27], s70 offen sc1
s_mov_b64 exec, -1
v_mov_b32 v9, 0xf149f2ca
v_xor_b32 v216, v9, v216
v_xor_b32 v217, v9, v217
v_xor_b32 v218, v9, v218
v_xor_b32 v219, v9, v219
v_xor_b32 v220, v9, v220
v_xor_b32 v221, v9, v221
v_xor_b32 v222, v9, v222
v_xor_b32 v223, v9, v223
v_xor_b32 v224, v9, v224
v_xor_b32 v225, v9, v225
v_xor_b32 v226, v9, v226
v_xor_b32 v227, v9, v227
v_xor_b32 v228, v9, v228
v_xor_b32 v229, v9, v229
v_xor_b32 v230, v9, v230
v_xor_b32 v231, v9, v231
s_mov_b32 s67, 90112
s_cmp_eq_u32 s63, 0
s_cbranch_scc0 cr3_151
v_and_b32 v9, 15, v0
v_lshlrev_b32 v9, 11, v9
v_bfe_u32 v10, v0, 4, 1
v_lshl_add_u32 v9, v10, 5, v9
v_lshrrev_b32 v10, 5, v0
v_lshl_add_u32 v9, v10, 4, v9
s_lshl2_add_u32 s70, s61, s58
s_lshl_b32 s70, s70, 16
s_lshl_b32 s71, s62, 7
s_add_u32 s70, s70, s71
s_add_u32 s71, s70, 0x8000
buffer_load_dwordx4 v[240:243], v9, s[8:11], s70 offen offset:0
buffer_load_dwordx4 v[244:247], v9, s[8:11], s70 offen offset:64
buffer_load_dwordx4 v[248:251], v9, s[8:11], s71 offen offset:0
buffer_load_dwordx4 v[252:255], v9, s[8:11], s71 offen offset:64
cr3_151:
s_cmp_eq_u32 s59, 0
s_cbranch_scc1 cback_125
v_mov_b32 v9, 0
s_add_u32 s35, s34, 17
lw_152:
ds_read_b32 v5, v9 offset:16
s_waitcnt lgkmcnt(0)
v_cmp_gt_i32 vcc, s35, v5
s_cbranch_vccz lwd_153
s_sub_u32 s32, s32, 1
s_cmp_gt_i32 s32, 0
s_cbranch_scc1 lw_152
lwd_153:
s_branch cback_125
cr2_150:
v_add_u32 v5, s34, 19
s_mov_b64 exec, 1
ds_write_b32 v3, v5
s_mov_b64 exec, -1
s_mov_b32 s66, 28672
s_cmp_lt_u32 s59, 2
s_cbranch_scc1 cback_125
s_add_u32 s35, s34, 17
lw_154:
ds_read_b32 v5, v2 offset:16
s_waitcnt lgkmcnt(0)
v_cmp_gt_i32 vcc, s35, v5
s_cbranch_vccz lwd_155
s_sub_u32 s32, s32, 1
s_cmp_gt_i32 s32, 0
s_cbranch_scc1 lw_154
lwd_155:
s_branch cback_125
slow_126:
s_add_u32 s70, s72, 270336
poll_156:
buffer_load_dword v10, v1, s[24:27], s70 offen sc1
pchk_157:
s_waitcnt vmcnt(0)
v_cmp_eq_u32 vcc, 0, v10
s_cbranch_vccz pdone_158
s_sub_u32 s32, s32, 1
s_cmp_gt_i32 s32, 0
s_cbranch_scc1 poll_156
pdone_158:
s_lshl_b32 s73, s60, 15
s_lshl_b32 s74, s63, 23
s_add_u32 s73, s73, s74
s_add_u32 s73, s73, 1048576
v_mov_b32 v10, 0xf149f2ca
v_mov_b32 v11, 0
v_mov_b32 v192, 0
v_mov_b32 v193, 0
v_mov_b32 v194, 0
v_mov_b32 v195, 0
v_mov_b32 v196, 0
v_mov_b32 v197, 0
v_mov_b32 v198, 0
v_mov_b32 v199, 0
v_mov_b32 v200, 0
v_mov_b32 v201, 0
v_mov_b32 v202, 0
v_mov_b32 v203, 0
v_mov_b32 v204, 0
v_mov_b32 v205, 0
v_mov_b32 v206, 0
v_mov_b32 v207, 0
v_mov_b32 v208, 0
v_mov_b32 v209, 0
v_mov_b32 v210, 0
v_mov_b32 v211, 0
s_lshl2_add_u32 s74, s59, s65
s_mov_b32 s75, 0
sl_159:
s_lshr_b32 s76, s74, 2
s_lshl_b32 s76, s76, 19
s_and_b32 s77, s74, 3
s_lshl_b32 s77, s77, 13
s_add_u32 s76, s76, s77
s_add_u32 s76, s76, s73
buffer_load_dwordx4 v[152:155], v6, s[20:23], s76 offen offset:0 sc1
buffer_load_dwordx4 v[156:159], v6, s[20:23], s76 offen offset:1024 sc1
s_cmp_eq_u32 s75, 0
s_cselect_b32 s76, 0xf149f2ca, 0
s_and_b32 s77, s75, 7
s_cselect_b32 s77, 0, -1
v_xor_b32 v112, s76, v216
v_and_b32 v112, s77, v112
v_xor_b32 v113, s76, v217
v_and_b32 v113, s77, v113
v_xor_b32 v114, s76, v218
v_and_b32 v114, s77, v114
v_xor_b32 v115, s76, v219
v_and_b32 v115, s77, v115
v_xor_b32 v116, s76, v220
v_and_b32 v116, s77, v116
v_xor_b32 v117, s76, v221
v_and_b32 v117, s77, v117
v_xor_b32 v118, s76, v222
v_and_b32 v118, s77, v118
v_xor_b32 v119, s76, v223
v_and_b32 v119, s77, v119
v_xor_b32 v120, s76, v224
v_and_b32 v120, s77, v120
v_xor_b32 v121, s76, v225
v_and_b32 v121, s77, v121
v_xor_b32 v122, s76, v226
v_and_b32 v122, s77, v122
v_xor_b32 v123, s76, v227
v_and_b32 v123, s77, v123
v_xor_b32 v124, s76, v228
v_and_b32 v124, s77, v124
v_xor_b32 v125, s76, v229
v_and_b32 v125, s77, v125
v_xor_b32 v126, s76, v230
v_and_b32 v126, s77, v126
v_xor_b32 v127, s76, v231
v_and_b32 v127, s77, v127
s_waitcnt vmcnt(1)
s_nop 0
v_mfma_f32_32x32x16_bf16 v[112:127], v[152:155], v[80:83], v[112:127]
s_waitcnt vmcnt(0)
v_mfma_f32_32x32x16_bf16 v[112:127], v[156:159], v[88:91], v[112:127]
s_nop 11
v_max3_f32 v10, v10, v112, v113
v_max3_f32 v10, v10, v114, v115
v_max3_f32 v10, v10, v116, v117
v_max3_f32 v10, v10, v118, v119
v_max3_f32 v10, v10, v120, v121
v_max3_f32 v10, v10, v122, v123
v_max3_f32 v10, v10, v124, v125
v_max3_f32 v10, v10, v126, v127
s_add_u32 s75, s75, 1
s_sub_u32 s74, s74, 1
s_cselect_b32 s75, 9, s75
s_cmp_lt_u32 s75, 9
s_cbranch_scc1 sl_159
v_mov_b32 v11, v10
s_nop 1
v_permlane32_swap_b32 v11, v10
v_max_f32 v10, v10, v11
s_lshl2_add_u32 s74, s59, s65
s_mov_b32 s75, 0
sl_160:
s_lshr_b32 s76, s74, 2
s_lshl_b32 s76, s76, 19
s_and_b32 s77, s74, 3
s_lshl_b32 s77, s77, 13
s_add_u32 s76, s76, s77
s_add_u32 s76, s76, s73
buffer_load_dwordx4 v[152:155], v6, s[20:23], s76 offen offset:0 sc1
buffer_load_dwordx4 v[156:159], v6, s[20:23], s76 offen offset:1024 sc1
buffer_load_dwordx4 v[160:163], v6, s[20:23], s76 offen offset:2048 sc1
buffer_load_dwordx4 v[164:167], v6, s[20:23], s76 offen offset:3072 sc1
s_cmp_eq_u32 s75, 0
s_cselect_b32 s76, 0xf149f2ca, 0
s_and_b32 s77, s75, 7
s_cselect_b32 s77, 0, -1
v_xor_b32 v112, s76, v216
v_and_b32 v112, s77, v112
v_sub_f32 v112, v112, v10
v_xor_b32 v113, s76, v217
v_and_b32 v113, s77, v113
v_sub_f32 v113, v113, v10
v_xor_b32 v114, s76, v218
v_and_b32 v114, s77, v114
v_sub_f32 v114, v114, v10
v_xor_b32 v115, s76, v219
v_and_b32 v115, s77, v115
v_sub_f32 v115, v115, v10
v_xor_b32 v116, s76, v220
v_and_b32 v116, s77, v116
v_sub_f32 v116, v116, v10
v_xor_b32 v117, s76, v221
v_and_b32 v117, s77, v117
v_sub_f32 v117, v117, v10
v_xor_b32 v118, s76, v222
v_and_b32 v118, s77, v118
v_sub_f32 v118, v118, v10
v_xor_b32 v119, s76, v223
v_and_b32 v119, s77, v119
v_sub_f32 v119, v119, v10
v_xor_b32 v120, s76, v224
v_and_b32 v120, s77, v120
v_sub_f32 v120, v120, v10
v_xor_b32 v121, s76, v225
v_and_b32 v121, s77, v121
v_sub_f32 v121, v121, v10
v_xor_b32 v122, s76, v226
v_and_b32 v122, s77, v122
v_sub_f32 v122, v122, v10
v_xor_b32 v123, s76, v227
v_and_b32 v123, s77, v123
v_sub_f32 v123, v123, v10
v_xor_b32 v124, s76, v228
v_and_b32 v124, s77, v124
v_sub_f32 v124, v124, v10
v_xor_b32 v125, s76, v229
v_and_b32 v125, s77, v125
v_sub_f32 v125, v125, v10
v_xor_b32 v126, s76, v230
v_and_b32 v126, s77, v126
v_sub_f32 v126, v126, v10
v_xor_b32 v127, s76, v231
v_and_b32 v127, s77, v127
v_sub_f32 v127, v127, v10
s_waitcnt vmcnt(3)
s_nop 0
v_mfma_f32_32x32x16_bf16 v[112:127], v[152:155], v[80:83], v[112:127]
s_waitcnt vmcnt(2)
v_mfma_f32_32x32x16_bf16 v[112:127], v[156:159], v[88:91], v[112:127]
s_nop 11
v_exp_f32 v112, v112
v_exp_f32 v113, v113
v_exp_f32 v114, v114
v_exp_f32 v115, v115
v_exp_f32 v116, v116
v_exp_f32 v117, v117
v_exp_f32 v118, v118
v_exp_f32 v119, v119
v_exp_f32 v120, v120
v_exp_f32 v121, v121
v_exp_f32 v122, v122
v_exp_f32 v123, v123
v_exp_f32 v124, v124
v_exp_f32 v125, v125
v_exp_f32 v126, v126
v_exp_f32 v127, v127
v_cvt_pk_bf16_f32 v144, v112, v113
v_cvt_pk_bf16_f32 v145, v114, v115
v_cvt_pk_bf16_f32 v146, v116, v117
v_cvt_pk_bf16_f32 v147, v118, v119
v_cvt_pk_bf16_f32 v148, v120, v121
v_cvt_pk_bf16_f32 v149, v122, v123
v_cvt_pk_bf16_f32 v150, v124, v125
v_cvt_pk_bf16_f32 v151, v126, v127
s_waitcnt vmcnt(1)
v_mfma_f32_32x32x16_bf16 v[192:207], v[160:163], v[144:147], v[192:207]
v_mfma_f32_16x16x32_bf16 v[208:211], v[212:215], v[144:147], v[208:211]
s_waitcnt vmcnt(0)
v_mfma_f32_32x32x16_bf16 v[192:207], v[164:167], v[148:151], v[192:207]
v_mfma_f32_16x16x32_bf16 v[208:211], v[212:215], v[148:151], v[208:211]
s_add_u32 s75, s75, 1
s_sub_u32 s74, s74, 1
s_cselect_b32 s75, 9, s75
s_cmp_lt_u32 s75, 9
s_cbranch_scc1 sl_160
v_mov_b32 v10, 0xf149f2ca
v_mov_b32 v11, 0
v_mov_b32 v16, 0
v_mov_b32 v17, 0
v_mov_b32 v18, 0
v_mov_b32 v19, 0
v_mov_b32 v20, 0
v_mov_b32 v21, 0
v_mov_b32 v22, 0
v_mov_b32 v23, 0
v_mov_b32 v24, 0
v_mov_b32 v25, 0
v_mov_b32 v26, 0
v_mov_b32 v27, 0
v_mov_b32 v28, 0
v_mov_b32 v29, 0
v_mov_b32 v30, 0
v_mov_b32 v31, 0
v_mov_b32 v32, 0
v_mov_b32 v33, 0
v_mov_b32 v34, 0
v_mov_b32 v35, 0
s_sub_u32 s74, 3, s65
s_lshl2_add_u32 s74, s59, s74
s_mov_b32 s75, 0
sl_161:
s_lshr_b32 s76, s74, 2
s_lshl_b32 s76, s76, 19
s_and_b32 s77, s74, 3
s_lshl_b32 s77, s77, 13
s_add_u32 s76, s76, s77
s_add_u32 s76, s76, s73
buffer_load_dwordx4 v[152:155], v6, s[20:23], s76 offen offset:0 sc1
buffer_load_dwordx4 v[156:159], v6, s[20:23], s76 offen offset:1024 sc1
s_cmp_eq_u32 s75, 0
s_cselect_b32 s76, 0xf149f2ca, 0
s_and_b32 s77, s75, 7
s_cselect_b32 s77, 0, -1
v_xor_b32 v112, s76, v216
v_and_b32 v112, s77, v112
v_xor_b32 v113, s76, v217
v_and_b32 v113, s77, v113
v_xor_b32 v114, s76, v218
v_and_b32 v114, s77, v114
v_xor_b32 v115, s76, v219
v_and_b32 v115, s77, v115
v_xor_b32 v116, s76, v220
v_and_b32 v116, s77, v116
v_xor_b32 v117, s76, v221
v_and_b32 v117, s77, v117
v_xor_b32 v118, s76, v222
v_and_b32 v118, s77, v118
v_xor_b32 v119, s76, v223
v_and_b32 v119, s77, v119
v_xor_b32 v120, s76, v224
v_and_b32 v120, s77, v120
v_xor_b32 v121, s76, v225
v_and_b32 v121, s77, v121
v_xor_b32 v122, s76, v226
v_and_b32 v122, s77, v122
v_xor_b32 v123, s76, v227
v_and_b32 v123, s77, v123
v_xor_b32 v124, s76, v228
v_and_b32 v124, s77, v124
v_xor_b32 v125, s76, v229
v_and_b32 v125, s77, v125
v_xor_b32 v126, s76, v230
v_and_b32 v126, s77, v126
v_xor_b32 v127, s76, v231
v_and_b32 v127, s77, v127
s_waitcnt vmcnt(1)
s_nop 0
v_mfma_f32_32x32x16_bf16 v[112:127], v[152:155], v[96:99], v[112:127]
s_waitcnt vmcnt(0)
v_mfma_f32_32x32x16_bf16 v[112:127], v[156:159], v[104:107], v[112:127]
s_nop 11
v_max3_f32 v10, v10, v112, v113
v_max3_f32 v10, v10, v114, v115
v_max3_f32 v10, v10, v116, v117
v_max3_f32 v10, v10, v118, v119
v_max3_f32 v10, v10, v120, v121
v_max3_f32 v10, v10, v122, v123
v_max3_f32 v10, v10, v124, v125
v_max3_f32 v10, v10, v126, v127
s_add_u32 s75, s75, 1
s_sub_u32 s74, s74, 1
s_cselect_b32 s75, 9, s75
s_cmp_lt_u32 s75, 9
s_cbranch_scc1 sl_161
v_mov_b32 v11, v10
s_nop 1
v_permlane32_swap_b32 v11, v10
v_max_f32 v10, v10, v11
s_sub_u32 s74, 3, s65
s_lshl2_add_u32 s74, s59, s74
s_mov_b32 s75, 0
sl_162:
s_lshr_b32 s76, s74, 2
s_lshl_b32 s76, s76, 19
s_and_b32 s77, s74, 3
s_lshl_b32 s77, s77, 13
s_add_u32 s76, s76, s77
s_add_u32 s76, s76, s73
buffer_load_dwordx4 v[152:155], v6, s[20:23], s76 offen offset:0 sc1
buffer_load_dwordx4 v[156:159], v6, s[20:23], s76 offen offset:1024 sc1
buffer_load_dwordx4 v[160:163], v6, s[20:23], s76 offen offset:2048 sc1
buffer_load_dwordx4 v[164:167], v6, s[20:23], s76 offen offset:3072 sc1
s_cmp_eq_u32 s75, 0
s_cselect_b32 s76, 0xf149f2ca, 0
s_and_b32 s77, s75, 7
s_cselect_b32 s77, 0, -1
v_xor_b32 v112, s76, v216
v_and_b32 v112, s77, v112
v_sub_f32 v112, v112, v10
v_xor_b32 v113, s76, v217
v_and_b32 v113, s77, v113
v_sub_f32 v113, v113, v10
v_xor_b32 v114, s76, v218
v_and_b32 v114, s77, v114
v_sub_f32 v114, v114, v10
v_xor_b32 v115, s76, v219
v_and_b32 v115, s77, v115
v_sub_f32 v115, v115, v10
v_xor_b32 v116, s76, v220
v_and_b32 v116, s77, v116
v_sub_f32 v116, v116, v10
v_xor_b32 v117, s76, v221
v_and_b32 v117, s77, v117
v_sub_f32 v117, v117, v10
v_xor_b32 v118, s76, v222
v_and_b32 v118, s77, v118
v_sub_f32 v118, v118, v10
v_xor_b32 v119, s76, v223
v_and_b32 v119, s77, v119
v_sub_f32 v119, v119, v10
v_xor_b32 v120, s76, v224
v_and_b32 v120, s77, v120
v_sub_f32 v120, v120, v10
v_xor_b32 v121, s76, v225
v_and_b32 v121, s77, v121
v_sub_f32 v121, v121, v10
v_xor_b32 v122, s76, v226
v_and_b32 v122, s77, v122
v_sub_f32 v122, v122, v10
v_xor_b32 v123, s76, v227
v_and_b32 v123, s77, v123
v_sub_f32 v123, v123, v10
v_xor_b32 v124, s76, v228
v_and_b32 v124, s77, v124
v_sub_f32 v124, v124, v10
v_xor_b32 v125, s76, v229
v_and_b32 v125, s77, v125
v_sub_f32 v125, v125, v10
v_xor_b32 v126, s76, v230
v_and_b32 v126, s77, v126
v_sub_f32 v126, v126, v10
v_xor_b32 v127, s76, v231
v_and_b32 v127, s77, v127
v_sub_f32 v127, v127, v10
s_waitcnt vmcnt(3)
s_nop 0
v_mfma_f32_32x32x16_bf16 v[112:127], v[152:155], v[96:99], v[112:127]
s_waitcnt vmcnt(2)
v_mfma_f32_32x32x16_bf16 v[112:127], v[156:159], v[104:107], v[112:127]
s_nop 11
v_exp_f32 v112, v112
v_exp_f32 v113, v113
v_exp_f32 v114, v114
v_exp_f32 v115, v115
v_exp_f32 v116, v116
v_exp_f32 v117, v117
v_exp_f32 v118, v118
v_exp_f32 v119, v119
v_exp_f32 v120, v120
v_exp_f32 v121, v121
v_exp_f32 v122, v122
v_exp_f32 v123, v123
v_exp_f32 v124, v124
v_exp_f32 v125, v125
v_exp_f32 v126, v126
v_exp_f32 v127, v127
v_cvt_pk_bf16_f32 v144, v112, v113
v_cvt_pk_bf16_f32 v145, v114, v115
v_cvt_pk_bf16_f32 v146, v116, v117
v_cvt_pk_bf16_f32 v147, v118, v119
v_cvt_pk_bf16_f32 v148, v120, v121
v_cvt_pk_bf16_f32 v149, v122, v123
v_cvt_pk_bf16_f32 v150, v124, v125
v_cvt_pk_bf16_f32 v151, v126, v127
s_waitcnt vmcnt(1)
v_mfma_f32_32x32x16_bf16 v[16:31], v[160:163], v[144:147], v[16:31]
v_mfma_f32_16x16x32_bf16 v[32:35], v[212:215], v[144:147], v[32:35]
s_waitcnt vmcnt(0)
v_mfma_f32_32x32x16_bf16 v[16:31], v[164:167], v[148:151], v[16:31]
v_mfma_f32_16x16x32_bf16 v[32:35], v[212:215], v[148:151], v[32:35]
s_add_u32 s75, s75, 1
s_sub_u32 s74, s74, 1
s_cselect_b32 s75, 9, s75
s_cmp_lt_u32 s75, 9
s_cbranch_scc1 sl_162
s_branch sback_127
mo_130:
s_lshr_b32 s67, s33, 5
s_cmp_eq_u32 s67, s66
s_cbranch_scc0 mo_131
s_and_b32 s67, s33, 31
v_sub_u32 v48, s67, v48
v_lshlrev_b32 v49, 4, v49
s_lshl_b32 s67, s62, 14
s_add_u32 s67, s67, 30686208
poll_163:
buffer_load_dwordx4 v[56:59], v49, s[20:23], s67 offen offset:0 sc1
buffer_load_dwordx4 v[60:63], v49, s[20:23], s67 offen offset:64 sc1
pchk_164:
s_waitcnt vmcnt(1)
v_min3_u32 v50, v56, v57, v58
s_waitcnt vmcnt(0)
v_min3_u32 v50, v50, v59, v60
v_min3_u32 v50, v50, v61, v62
v_min_u32 v50, v50, v63
v_cmp_eq_u32 vcc, 0, v50
s_cbranch_vccz pdone_165
s_sub_u32 s32, s32, 1
s_cmp_gt_i32 s32, 0
s_cbranch_scc1 poll_163
pdone_165:
v_cmp_eq_u32 vcc, 0, v48
s_nop 1
v_cndmask_b32 v240, v240, v56, vcc
v_cndmask_b32 v241, v241, v57, vcc
v_cndmask_b32 v242, v242, v58, vcc
v_cndmask_b32 v243, v243, v59, vcc
v_cndmask_b32 v244, v244, v60, vcc
v_cndmask_b32 v245, v245, v61, vcc
v_cndmask_b32 v246, v246, v62, vcc
v_cndmask_b32 v247, v247, v63, vcc
v_cmp_eq_u32 vcc, 16, v48
s_nop 1
v_cndmask_b32 v248, v248, v56, vcc
v_cndmask_b32 v249, v249, v57, vcc
v_cndmask_b32 v250, v250, v58, vcc
v_cndmask_b32 v251, v251, v59, vcc
v_cndmask_b32 v252, v252, v60, vcc
v_cndmask_b32 v253, v253, v61, vcc
v_cndmask_b32 v254, v254, v62, vcc
v_cndmask_b32 v255, v255, v63, vcc
s_branch mo_131
L_end:
L_fin:
s_endpgm
.section .rodata,"a"
.p2align 6
.amdhsa_kernel interleave_layers__sliding_block__moe_arch_mod__prompt_kernel
  .amdhsa_next_free_vgpr 256
  .amdhsa_next_free_sgpr 102
  .amdhsa_accum_offset 256
  .amdhsa_group_segment_fixed_size 0
  .amdhsa_kernarg_size 88
  .amdhsa_user_sgpr_count 2
  .amdhsa_user_sgpr_kernarg_segment_ptr 1
  .amdhsa_system_sgpr_workgroup_id_x 1
  .amdhsa_float_denorm_mode_32 3
.end_amdhsa_kernel
```

```asm
; @launch grid=(256,1,1) block=(512,1,1) lds=163840
.amdgcn_target "amdgcn-amd-amdhsa--gfx950"
.text
.globl interleave_layers__sliding_block__moe_arch_mod__prompt_kernel
.p2align 8
.type interleave_layers__sliding_block__moe_arch_mod__prompt_kernel,@function
interleave_layers__sliding_block__moe_arch_mod__prompt_kernel:
s_cmp_ge_u32 s2, 256
s_cbranch_scc1 L_fin
s_load_dwordx16 s[36:51], s[0:1], 0
s_load_dwordx4 s[52:55], s[0:1], 64
s_load_dwordx2 s[56:57], s[0:1], 80
v_lshrrev_b32 v1, 6, v0
v_and_b32 v0, 63, v0
s_and_b32 s64, s2, 7
v_readfirstlane_b32 s3, v1
s_lshr_b32 s65, s2, 3
s_and_b32 s66, s65, 7
s_and_b32 s67, s64, 1
s_lshl3_add_u32 s59, s67, s66
s_lshr_b32 s66, s65, 3
s_lshr_b32 s67, s64, 1
s_lshl2_add_u32 s60, s67, s66
s_and_b32 s66, s65, 1
s_lshl1_add_u32 s61, s64, s66
s_lshr_b32 s62, s65, 1
s_mov_b32 s63, 0
s_mov_b32 s34, 0
s_mov_b32 s32, 200000
s_mov_b32 s33, -1
s_cmp_ge_u32 s3, 4
s_cselect_b32 s66, 3, 1
s_and_b32 s58, s3, s66
s_waitcnt lgkmcnt(0)
s_mov_b32 s8, s36
s_mov_b32 s9, s37
s_mov_b32 s10, 0x400000
s_mov_b32 s11, 0x00020000
s_mov_b32 s12, s38
s_mov_b32 s13, s39
s_mov_b32 s14, 0x600000
s_mov_b32 s15, 0x00020000
s_mov_b32 s16, s40
s_mov_b32 s17, s41
s_mov_b32 s18, 0x200000
s_mov_b32 s19, 0x00020000
s_mov_b32 s20, s56
s_mov_b32 s21, s57
s_mov_b32 s22, 0x2500000
s_mov_b32 s23, 0x00020000
s_add_u32 s24, s56, 30408704
s_addc_u32 s25, s57, 0
s_mov_b32 s26, 2818048
s_mov_b32 s27, 0x00020000
s_mov_b32 s28, s52
s_mov_b32 s29, s53
s_mov_b32 s30, 0x400000
s_mov_b32 s31, 0x00020000
s_cmp_ge_u32 s3, 4
s_cbranch_scc1 L_m
s_cmp_ge_u32 s3, 2
s_cbranch_scc1 L_f
s_setprio 1
v_and_b32 v22, 7, v0
v_lshrrev_b32 v23, 4, v0
v_lshrrev_b32 v6, 3, v0
v_xor_b32 v7, v22, v23
v_lshlrev_b32 v7, 4, v7
v_lshl_add_u32 v8, v6, 11, v7
v_xor_b32 v7, 64, v8
v_add_u32 v9, 15360, v7
v_add_u32 v10, 30720, v8
v_add_u32 v11, 46080, v7
s_lshl_b32 s70, s59, 18
s_lshl_b32 s71, s58, 16
s_add_u32 s68, s70, s71
s_sub_u32 s69, s70, s71
s_add_u32 s69, s69, 196608
s_mov_b32 s67, 128
s_lshl_b32 s75, s58, 13
s_mov_b32 s65, 86016
s_lshr_b32 s70, s59, 3
s_lshl1_add_u32 s70, s59, s70
s_lshr_b32 s71, s60, 2
s_lshl2_add_u32 s71, s60, s71
s_add_u32 s70, s70, s71
s_and_b32 s64, s70, 15
s_mul_i32 s70, s64, s67
s_add_u32 m0, s65, s75
s_add_u32 s71, s70, s68
buffer_load_dwordx4 v8, s[8:11], s71 offen offset:0 lds
buffer_load_dwordx4 v9, s[8:11], s71 offen offset:1024 lds
buffer_load_dwordx4 v10, s[8:11], s71 offen offset:2048 lds
buffer_load_dwordx4 v11, s[8:11], s71 offen offset:3072 lds
s_add_u32 m0, m0, 4096
s_add_u32 s71, s70, s69
buffer_load_dwordx4 v8, s[8:11], s71 offen offset:0 lds
buffer_load_dwordx4 v9, s[8:11], s71 offen offset:1024 lds
buffer_load_dwordx4 v10, s[8:11], s71 offen offset:2048 lds
buffer_load_dwordx4 v11, s[8:11], s71 offen offset:3072 lds
v_and_b32 v7, 2, v6
v_xor_b32 v7, v7, v22
v_mul_u32_u24 v6, 6144, v6
v_lshl_add_u32 v12, v7, 4, v6
v_xor_b32 v6, 64, v12
v_add_u32 v13, 48128, v6
v_add_u32 v14, 96256, v12
v_add_u32 v15, 144384, v6
s_mul_i32 s76, s58, 12288
s_add_u32 s76, s76, 16384
s_lshl_b32 s70, s60, 7
s_cmp_eq_u32 s58, 0
s_mov_b32 s71, 198656
s_cselect_b32 s72, 0, s71
s_mov_b32 s71, 4096
s_cselect_b32 s73, 196608, s71
s_mov_b32 s71, 200704
s_cselect_b32 s74, 2048, s71
s_add_u32 s72, s72, s70
s_add_u32 s73, s73, s70
s_add_u32 s74, s74, s70
s_mul_i32 s70, s64, 393216
s_add_u32 m0, s65, s76
s_add_u32 s71, s70, s72
buffer_load_dwordx4 v12, s[12:15], s71 offen offset:0 lds
buffer_load_dwordx4 v13, s[12:15], s71 offen offset:1024 lds
buffer_load_dwordx4 v14, s[12:15], s71 offen offset:2048 lds
buffer_load_dwordx4 v15, s[12:15], s71 offen offset:3072 lds
s_add_u32 m0, m0, 4096
s_add_u32 s71, s70, s73
buffer_load_dwordx4 v12, s[12:15], s71 offen offset:0 lds
buffer_load_dwordx4 v13, s[12:15], s71 offen offset:1024 lds
buffer_load_dwordx4 v14, s[12:15], s71 offen offset:2048 lds
buffer_load_dwordx4 v15, s[12:15], s71 offen offset:3072 lds
s_add_u32 m0, m0, 4096
s_add_u32 s71, s70, s74
buffer_load_dwordx4 v12, s[12:15], s71 offen offset:0 lds
buffer_load_dwordx4 v13, s[12:15], s71 offen offset:1024 lds
buffer_load_dwordx4 v14, s[12:15], s71 offen offset:2048 lds
buffer_load_dwordx4 v15, s[12:15], s71 offen offset:3072 lds
s_add_u32 s64, s64, 1
s_and_b32 s64, s64, 15
s_sub_u32 s65, s65, 40960
s_cselect_b32 s65, 86016, s65
v_and_b32 v1, 3, v0
v_lshlrev_b32 v1, 2, v1
v_and_b32 v2, 4, v1
s_lshl2_add_u32 s35, s58, 16
v_mov_b32 v3, s35
v_lshlrev_b32 v20, 4, v0
v_lshrrev_b32 v6, 2, v0
v_lshl_add_u32 v21, v6, 7, v1
v_lshrrev_b32 v6, 3, v0
v_lshlrev_b32 v23, 1, v23
v_xor_b32 v23, v23, v22
v_lshlrev_b32 v23, 4, v23
v_lshl_add_u32 v23, v6, 11, v23
s_lshl_b32 s70, s62, 7
s_lshl_b32 s71, s58, 16
s_add_u32 s70, s70, s71
v_add_u32 v16, s70, v23
v_add_u32 v17, 15360, v16
v_add_u32 v18, 30720, v16
v_add_u32 v19, 46080, v16
s_add_u32 s77, s61, s62
s_lshl_b32 s77, s77, 17
s_lshl_b32 s78, s58, 12
s_mov_b32 s66, -2
s_barrier
.p2align 4
lq_1:
s_add_u32 s35, s66, 1
lw_4:
ds_read_b32 v5, v1 offset:0
s_waitcnt lgkmcnt(0)
v_cmp_gt_i32 vcc, s35, v5
s_cbranch_vccz lwd_5
s_sub_u32 s32, s32, 1
s_cmp_gt_i32 s32, 0
s_cbranch_scc1 lw_4
lwd_5:
s_cmp_eq_u32 s66, 0
s_cbranch_scc1 lcs_2
lcb_3:
s_mul_i32 s70, s64, s67
s_add_u32 m0, s65, s75
s_add_u32 s71, s70, s68
buffer_load_dwordx4 v8, s[8:11], s71 offen offset:0 sc1 lds
buffer_load_dwordx4 v9, s[8:11], s71 offen offset:1024 sc1 lds
buffer_load_dwordx4 v10, s[8:11], s71 offen offset:2048 sc1 lds
buffer_load_dwordx4 v11, s[8:11], s71 offen offset:3072 sc1 lds
buffer_load_dword v30, off, s[12:15], 0
s_add_u32 m0, m0, 4096
s_add_u32 s71, s70, s69
buffer_load_dwordx4 v8, s[8:11], s71 offen offset:0 sc1 lds
buffer_load_dwordx4 v9, s[8:11], s71 offen offset:1024 sc1 lds
buffer_load_dwordx4 v10, s[8:11], s71 offen offset:2048 sc1 lds
buffer_load_dwordx4 v11, s[8:11], s71 offen offset:3072 sc1 lds
buffer_load_dword v30, off, s[12:15], 0
s_mul_i32 s70, s64, 393216
s_add_u32 m0, s65, s76
s_add_u32 s71, s70, s72
buffer_load_dwordx4 v12, s[12:15], s71 offen offset:0 lds
buffer_load_dwordx4 v13, s[12:15], s71 offen offset:1024 lds
buffer_load_dwordx4 v14, s[12:15], s71 offen offset:2048 lds
buffer_load_dwordx4 v15, s[12:15], s71 offen offset:3072 lds
buffer_load_dword v30, off, s[12:15], 0
v_add_u32 v5, s66, 3
s_mov_b64 exec, 1
s_waitcnt vmcnt(15)
ds_write_b32 v3, v5
s_mov_b64 exec, -1
s_mul_i32 s70, s64, 393216
s_add_u32 m0, m0, 4096
s_add_u32 s71, s70, s73
buffer_load_dwordx4 v12, s[12:15], s71 offen offset:0 lds
buffer_load_dwordx4 v13, s[12:15], s71 offen offset:1024 lds
buffer_load_dwordx4 v14, s[12:15], s71 offen offset:2048 lds
buffer_load_dwordx4 v15, s[12:15], s71 offen offset:3072 lds
buffer_load_dword v30, off, s[12:15], 0
s_mul_i32 s70, s64, 393216
s_add_u32 m0, m0, 4096
s_add_u32 s71, s70, s74
buffer_load_dwordx4 v12, s[12:15], s71 offen offset:0 lds
buffer_load_dwordx4 v13, s[12:15], s71 offen offset:1024 lds
buffer_load_dwordx4 v14, s[12:15], s71 offen offset:2048 lds
buffer_load_dwordx4 v15, s[12:15], s71 offen offset:3072 lds
buffer_load_dword v30, off, s[12:15], 0
s_add_u32 s64, s64, 1
s_and_b32 s64, s64, 15
s_sub_u32 s65, s65, 40960
s_cselect_b32 s65, 86016, s65
s_add_u32 s66, s66, 1
s_and_b32 s70, s66, 31
s_cmp_eq_u32 s70, 13
s_cbranch_scc0 lq_1
s_waitcnt vmcnt(0)
v_add_u32 v5, s34, 16
s_mov_b64 exec, 1
ds_write_b32 v3, v5
s_mov_b64 exec, -1
s_add_u32 s35, s34, 14
lw_6:
ds_read_b32 v5, v1 offset:0
s_waitcnt lgkmcnt(0)
v_cmp_gt_i32 vcc, s35, v5
s_cbranch_vccz lwd_7
s_sleep 1
s_sub_u32 s32, s32, 1
s_cmp_gt_i32 s32, 0
s_cbranch_scc1 lw_6
lwd_7:
s_add_u32 s70, s77, 262144
s_add_u32 m0, s78, 49152
s_and_b32 s70, s70, 0x1fffff
buffer_load_dwordx4 v16, s[16:19], s70 offen offset:0 lds
buffer_load_dwordx4 v17, s[16:19], s70 offen offset:1024 lds
buffer_load_dwordx4 v18, s[16:19], s70 offen offset:2048 lds
buffer_load_dwordx4 v19, s[16:19], s70 offen offset:3072 lds
buffer_load_dword v30, off, s[12:15], 0
s_add_u32 s70, s77, 393216
s_add_u32 m0, s78, 57344
s_and_b32 s70, s70, 0x1fffff
buffer_load_dwordx4 v16, s[16:19], s70 offen offset:0 lds
buffer_load_dwordx4 v17, s[16:19], s70 offen offset:1024 lds
buffer_load_dwordx4 v18, s[16:19], s70 offen offset:2048 lds
buffer_load_dwordx4 v19, s[16:19], s70 offen offset:3072 lds
buffer_load_dword v30, off, s[12:15], 0
s_add_u32 s70, s77, 524288
s_add_u32 m0, s78, 65536
s_and_b32 s70, s70, 0x1fffff
buffer_load_dwordx4 v16, s[16:19], s70 offen offset:0 lds
buffer_load_dwordx4 v17, s[16:19], s70 offen offset:1024 lds
buffer_load_dwordx4 v18, s[16:19], s70 offen offset:2048 lds
buffer_load_dwordx4 v19, s[16:19], s70 offen offset:3072 lds
buffer_load_dword v30, off, s[12:15], 0
s_add_u32 s70, s77, 655360
s_add_u32 m0, s78, 73728
s_and_b32 s70, s70, 0x1fffff
buffer_load_dwordx4 v16, s[16:19], s70 offen offset:0 lds
buffer_load_dwordx4 v17, s[16:19], s70 offen offset:1024 lds
buffer_load_dwordx4 v18, s[16:19], s70 offen offset:2048 lds
buffer_load_dwordx4 v19, s[16:19], s70 offen offset:3072 lds
buffer_load_dword v30, off, s[12:15], 0
s_sub_u32 s70, s59, s58
s_lshl_b32 s71, s70, 7
s_add_u32 s71, s71, s60
s_lshl4_add_u32 s70, s70, s60
s_sub_u32 s70, s70, 16
s_lshl_b32 s66, s71, 7
s_add_u32 s66, s66, 253952
s_lshl_b32 s70, s70, 15
s_lshl_b32 s71, s63, 23
s_add_u32 s70, s70, s71
s_add_u32 s64, s70, 1077248
s_mul_i32 s65, s58, -94208
s_add_u32 s35, s34, 16
lw_8:
ds_read_b32 v5, v1 offset:0
s_waitcnt lgkmcnt(0)
v_cmp_gt_i32 vcc, s35, v5
s_cbranch_vccz lwd_9
s_sleep 1
s_sub_u32 s32, s32, 1
s_cmp_gt_i32 s32, 0
s_cbranch_scc1 lw_8
lwd_9:
s_add_u32 s70, s77, 131072
s_add_u32 m0, s78, 40960
s_and_b32 s70, s70, 0x1fffff
buffer_load_dwordx4 v16, s[16:19], s70 offen offset:0 lds
buffer_load_dwordx4 v17, s[16:19], s70 offen offset:1024 lds
buffer_load_dwordx4 v18, s[16:19], s70 offen offset:2048 lds
buffer_load_dwordx4 v19, s[16:19], s70 offen offset:3072 lds
buffer_load_dword v30, off, s[12:15], 0
s_add_u32 s70, s77, 786432
s_add_u32 m0, s78, 81920
s_and_b32 s70, s70, 0x1fffff
buffer_load_dwordx4 v16, s[16:19], s70 offen offset:0 lds
buffer_load_dwordx4 v17, s[16:19], s70 offen offset:1024 lds
buffer_load_dwordx4 v18, s[16:19], s70 offen offset:2048 lds
buffer_load_dwordx4 v19, s[16:19], s70 offen offset:3072 lds
buffer_load_dword v30, off, s[12:15], 0
s_add_u32 s70, s77, 917504
s_add_u32 m0, s78, 90112
s_and_b32 s70, s70, 0x1fffff
buffer_load_dwordx4 v16, s[16:19], s70 offen offset:0 lds
buffer_load_dwordx4 v17, s[16:19], s70 offen offset:1024 lds
buffer_load_dwordx4 v18, s[16:19], s70 offen offset:2048 lds
buffer_load_dwordx4 v19, s[16:19], s70 offen offset:3072 lds
buffer_load_dword v30, off, s[12:15], 0
s_add_u32 s35, s34, 17
lw_11:
ds_read_b32 v5, v1 offset:0
s_waitcnt lgkmcnt(0)
v_cmp_gt_i32 vcc, s35, v5
s_cbranch_vccz lwd_12
s_sleep 1
s_sub_u32 s32, s32, 1
s_cmp_gt_i32 s32, 0
s_cbranch_scc1 lw_11
lwd_12:
s_cmp_gt_u32 s59, s58
s_cbranch_scc0 nokv_10
poll_13:
buffer_load_dword v6, v1, s[24:27], s66 offen sc1
pchk_14:
s_waitcnt vmcnt(0)
v_cmp_eq_u32 vcc, 0, v6
s_cbranch_vccz pdone_15
s_sub_u32 s32, s32, 1
s_cmp_gt_i32 s32, 0
s_cbranch_scc1 poll_13
pdone_15:
s_add_u32 m0, s65, 126976
s_nop 0
buffer_load_dwordx4 v20, s[20:23], s64 offen offset:0 sc1 lds
buffer_load_dwordx4 v20, s[20:23], s64 offen offset:1024 sc1 lds
buffer_load_dwordx4 v20, s[20:23], s64 offen offset:2048 sc1 lds
buffer_load_dwordx4 v20, s[20:23], s64 offen offset:3072 sc1 lds
buffer_load_dword v30, off, s[12:15], 0
s_add_u32 m0, s65, 122880
s_sub_u32 s64, s64, 4096
buffer_load_dwordx4 v20, s[20:23], s64 offen offset:0 sc1 lds
buffer_load_dwordx4 v20, s[20:23], s64 offen offset:1024 sc1 lds
buffer_load_dwordx4 v20, s[20:23], s64 offen offset:2048 sc1 lds
buffer_load_dwordx4 v20, s[20:23], s64 offen offset:3072 sc1 lds
buffer_load_dword v30, off, s[12:15], 0
s_add_u32 m0, s65, 118784
s_sub_u32 s64, s64, 4096
buffer_load_dwordx4 v20, s[20:23], s64 offen offset:0 sc1 lds
buffer_load_dwordx4 v20, s[20:23], s64 offen offset:1024 sc1 lds
buffer_load_dwordx4 v20, s[20:23], s64 offen offset:2048 sc1 lds
buffer_load_dwordx4 v20, s[20:23], s64 offen offset:3072 sc1 lds
buffer_load_dword v30, off, s[12:15], 0
s_add_u32 m0, s65, 114688
s_sub_u32 s64, s64, 4096
buffer_load_dwordx4 v20, s[20:23], s64 offen offset:0 sc1 lds
buffer_load_dwordx4 v20, s[20:23], s64 offen offset:1024 sc1 lds
buffer_load_dwordx4 v20, s[20:23], s64 offen offset:2048 sc1 lds
buffer_load_dwordx4 v20, s[20:23], s64 offen offset:3072 sc1 lds
buffer_load_dword v30, off, s[12:15], 0
s_add_u32 m0, s65, 110592
s_sub_u32 s64, s64, 4096
buffer_load_dwordx4 v20, s[20:23], s64 offen offset:0 sc1 lds
buffer_load_dwordx4 v20, s[20:23], s64 offen offset:1024 sc1 lds
buffer_load_dwordx4 v20, s[20:23], s64 offen offset:2048 sc1 lds
buffer_load_dwordx4 v20, s[20:23], s64 offen offset:3072 sc1 lds
buffer_load_dword v30, off, s[12:15], 0
s_add_u32 m0, s65, 106496
s_sub_u32 s64, s64, 4096
buffer_load_dwordx4 v20, s[20:23], s64 offen offset:0 sc1 lds
buffer_load_dwordx4 v20, s[20:23], s64 offen offset:1024 sc1 lds
buffer_load_dwordx4 v20, s[20:23], s64 offen offset:2048 sc1 lds
buffer_load_dwordx4 v20, s[20:23], s64 offen offset:3072 sc1 lds
buffer_load_dword v30, off, s[12:15], 0
s_add_u32 m0, s65, 102400
s_sub_u32 s64, s64, 4096
buffer_load_dwordx4 v20, s[20:23], s64 offen offset:0 sc1 lds
buffer_load_dwordx4 v20, s[20:23], s64 offen offset:1024 sc1 lds
buffer_load_dwordx4 v20, s[20:23], s64 offen offset:2048 sc1 lds
buffer_load_dwordx4 v20, s[20:23], s64 offen offset:3072 sc1 lds
buffer_load_dword v30, off, s[12:15], 0
s_add_u32 m0, s65, 98304
s_sub_u32 s64, s64, 4096
buffer_load_dwordx4 v20, s[20:23], s64 offen offset:0 sc1 lds
buffer_load_dwordx4 v20, s[20:23], s64 offen offset:1024 sc1 lds
buffer_load_dwordx4 v20, s[20:23], s64 offen offset:2048 sc1 lds
buffer_load_dwordx4 v20, s[20:23], s64 offen offset:3072 sc1 lds
buffer_load_dword v30, off, s[12:15], 0
nokv_10:
s_waitcnt vmcnt(0)
v_add_u32 v5, s34, 17
s_mov_b64 exec, 1
ds_write_b32 v3, v5
s_mov_b64 exec, -1
s_add_u32 s35, s34, 18
lw_16:
ds_read_b32 v5, v1 offset:0
s_waitcnt lgkmcnt(0)
v_cmp_gt_i32 vcc, s35, v5
s_cbranch_vccz lwd_17
s_sleep 1
s_sub_u32 s32, s32, 1
s_cmp_gt_i32 s32, 0
s_cbranch_scc1 lw_16
lwd_17:
s_add_u32 s70, s77, 1572864
s_add_u32 m0, s78, 131072
s_and_b32 s70, s70, 0x1fffff
buffer_load_dwordx4 v16, s[16:19], s70 offen offset:0 lds
buffer_load_dwordx4 v17, s[16:19], s70 offen offset:1024 lds
buffer_load_dwordx4 v18, s[16:19], s70 offen offset:2048 lds
buffer_load_dwordx4 v19, s[16:19], s70 offen offset:3072 lds
buffer_load_dword v30, off, s[12:15], 0
s_add_u32 s70, s77, 1703936
s_add_u32 m0, s78, 139264
s_and_b32 s70, s70, 0x1fffff
buffer_load_dwordx4 v16, s[16:19], s70 offen offset:0 lds
buffer_load_dwordx4 v17, s[16:19], s70 offen offset:1024 lds
buffer_load_dwordx4 v18, s[16:19], s70 offen offset:2048 lds
buffer_load_dwordx4 v19, s[16:19], s70 offen offset:3072 lds
buffer_load_dword v30, off, s[12:15], 0
s_add_u32 s70, s77, 1835008
s_add_u32 m0, s78, 147456
s_and_b32 s70, s70, 0x1fffff
buffer_load_dwordx4 v16, s[16:19], s70 offen offset:0 lds
buffer_load_dwordx4 v17, s[16:19], s70 offen offset:1024 lds
buffer_load_dwordx4 v18, s[16:19], s70 offen offset:2048 lds
buffer_load_dwordx4 v19, s[16:19], s70 offen offset:3072 lds
buffer_load_dword v30, off, s[12:15], 0
s_add_u32 s70, s77, 1966080
s_add_u32 m0, s78, 155648
s_and_b32 s70, s70, 0x1fffff
buffer_load_dwordx4 v16, s[16:19], s70 offen offset:0 lds
buffer_load_dwordx4 v17, s[16:19], s70 offen offset:1024 lds
buffer_load_dwordx4 v18, s[16:19], s70 offen offset:2048 lds
buffer_load_dwordx4 v19, s[16:19], s70 offen offset:3072 lds
buffer_load_dword v30, off, s[12:15], 0
s_add_u32 s35, s34, 19
lw_18:
ds_read_b32 v5, v1 offset:0
s_waitcnt lgkmcnt(0)
v_cmp_gt_i32 vcc, s35, v5
s_cbranch_vccz lwd_19
s_sleep 2
s_sub_u32 s32, s32, 1
s_cmp_gt_i32 s32, 0
s_cbranch_scc1 lw_18
lwd_19:
s_add_u32 s70, s77, 1048576
s_add_u32 m0, s78, 98304
s_and_b32 s70, s70, 0x1fffff
buffer_load_dwordx4 v16, s[16:19], s70 offen offset:0 lds
buffer_load_dwordx4 v17, s[16:19], s70 offen offset:1024 lds
buffer_load_dwordx4 v18, s[16:19], s70 offen offset:2048 lds
buffer_load_dwordx4 v19, s[16:19], s70 offen offset:3072 lds
buffer_load_dword v30, off, s[12:15], 0
s_add_u32 s70, s77, 1179648
s_add_u32 m0, s78, 106496
s_and_b32 s70, s70, 0x1fffff
buffer_load_dwordx4 v16, s[16:19], s70 offen offset:0 lds
buffer_load_dwordx4 v17, s[16:19], s70 offen offset:1024 lds
buffer_load_dwordx4 v18, s[16:19], s70 offen offset:2048 lds
buffer_load_dwordx4 v19, s[16:19], s70 offen offset:3072 lds
buffer_load_dword v30, off, s[12:15], 0
s_add_u32 s70, s77, 1310720
s_add_u32 m0, s78, 114688
s_and_b32 s70, s70, 0x1fffff
buffer_load_dwordx4 v16, s[16:19], s70 offen offset:0 lds
buffer_load_dwordx4 v17, s[16:19], s70 offen offset:1024 lds
buffer_load_dwordx4 v18, s[16:19], s70 offen offset:2048 lds
buffer_load_dwordx4 v19, s[16:19], s70 offen offset:3072 lds
buffer_load_dword v30, off, s[12:15], 0
s_add_u32 s70, s77, 1441792
s_add_u32 m0, s78, 122880
s_and_b32 s70, s70, 0x1fffff
buffer_load_dwordx4 v16, s[16:19], s70 offen offset:0 lds
buffer_load_dwordx4 v17, s[16:19], s70 offen offset:1024 lds
buffer_load_dwordx4 v18, s[16:19], s70 offen offset:2048 lds
buffer_load_dwordx4 v19, s[16:19], s70 offen offset:3072 lds
buffer_load_dword v30, off, s[12:15], 0
s_add_u32 s35, s34, 20
lw_20:
ds_read_b32 v5, v1 offset:0
s_waitcnt lgkmcnt(0)
v_cmp_gt_i32 vcc, s35, v5
s_cbranch_vccz lwd_21
s_sleep 2
s_sub_u32 s32, s32, 1
s_cmp_gt_i32 s32, 0
s_cbranch_scc1 lw_20
lwd_21:
s_add_u32 s70, s77, 0
s_add_u32 m0, s78, 32768
s_and_b32 s70, s70, 0x1fffff
buffer_load_dwordx4 v16, s[16:19], s70 offen offset:0 lds
buffer_load_dwordx4 v17, s[16:19], s70 offen offset:1024 lds
buffer_load_dwordx4 v18, s[16:19], s70 offen offset:2048 lds
buffer_load_dwordx4 v19, s[16:19], s70 offen offset:3072 lds
buffer_load_dword v30, off, s[12:15], 0
s_lshl_b32 s66, s61, 14
s_add_u32 s66, s66, 268288
s_cmp_eq_u32 s58, 0
s_cbranch_scc0 nofo_22
s_add_u32 s35, s34, 21
lw_23:
ds_read_b32 v5, v1 offset:0
s_waitcnt lgkmcnt(0)
v_cmp_gt_i32 vcc, s35, v5
s_cbranch_vccz lwd_24
s_sleep 1
s_sub_u32 s32, s32, 1
s_cmp_gt_i32 s32, 0
s_cbranch_scc1 lw_23
lwd_24:
poll_25:
buffer_load_dword v6, v21, s[24:27], s66 offen sc1
pchk_26:
s_waitcnt vmcnt(0)
v_cmp_eq_u32 vcc, 0, v6
s_cbranch_vccz pdone_27
s_sub_u32 s32, s32, 1
s_cmp_gt_i32 s32, 0
s_cbranch_scc1 poll_25
pdone_27:
nofo_22:
s_waitcnt vmcnt(0)
v_add_u32 v5, s34, 18
s_mov_b64 exec, 1
ds_write_b32 v3, v5
s_mov_b64 exec, -1
s_cmp_eq_u32 s63, 0
s_cbranch_scc0 L_end
v_bfe_u32 v6, v0, 3, 2
v_and_b32 v7, 2, v6
v_xor_b32 v7, v7, v22
v_lshrrev_b32 v23, 5, v0
v_lshl_add_u32 v6, v23, 4, v6
v_mul_u32_u24 v6, 6144, v6
v_lshl_add_u32 v12, v7, 4, v6
v_xor_b32 v6, 64, v12
v_add_u32 v13, 23552, v6
v_add_u32 v14, 47104, v12
v_add_u32 v15, 70656, v6
v_mov_b32 v8, v20
v_mov_b32 v9, v20
v_mov_b32 v10, v20
v_mov_b32 v11, v20
s_mov_b32 s8, s56
s_mov_b32 s9, s57
s_mov_b32 s10, 0x2500000
s_mov_b32 s11, 0x00020000
s_lshl_b32 s70, s59, 18
s_add_u32 s70, s70, 26214400
s_add_u32 s68, s70, s78
s_sub_u32 s69, s70, s78
s_add_u32 s69, s69, 12288
s_mov_b32 s67, 16384
s_lshl_b32 s66, s59, 14
s_add_u32 s66, s66, 274432
s_and_b32 s64, s61, 14
s_mov_b32 s65, 86016
s_add_u32 s35, s34, 22
lw_28:
ds_read_b32 v5, v1 offset:0
s_waitcnt lgkmcnt(0)
v_cmp_gt_i32 vcc, s35, v5
s_cbranch_vccz lwd_29
s_sleep 2
s_sub_u32 s32, s32, 1
s_cmp_gt_i32 s32, 0
s_cbranch_scc1 lw_28
lwd_29:
s_mul_i32 s70, s64, 393216
s_add_u32 m0, s65, s76
s_add_u32 s71, s70, s72
buffer_load_dwordx4 v12, s[12:15], s71 offen offset:0 lds
buffer_load_dwordx4 v13, s[12:15], s71 offen offset:1024 lds
buffer_load_dwordx4 v14, s[12:15], s71 offen offset:2048 lds
buffer_load_dwordx4 v15, s[12:15], s71 offen offset:3072 lds
buffer_load_dword v30, off, s[12:15], 0
s_add_u32 m0, m0, 4096
s_add_u32 s71, s70, s73
buffer_load_dwordx4 v12, s[12:15], s71 offen offset:0 lds
buffer_load_dwordx4 v13, s[12:15], s71 offen offset:1024 lds
buffer_load_dwordx4 v14, s[12:15], s71 offen offset:2048 lds
buffer_load_dwordx4 v15, s[12:15], s71 offen offset:3072 lds
buffer_load_dword v30, off, s[12:15], 0
s_add_u32 m0, m0, 4096
s_add_u32 s71, s70, s74
buffer_load_dwordx4 v12, s[12:15], s71 offen offset:0 lds
buffer_load_dwordx4 v13, s[12:15], s71 offen offset:1024 lds
buffer_load_dwordx4 v14, s[12:15], s71 offen offset:2048 lds
buffer_load_dwordx4 v15, s[12:15], s71 offen offset:3072 lds
buffer_load_dword v30, off, s[12:15], 0
s_add_u32 s64, s64, 1
s_and_b32 s64, s64, 15
s_sub_u32 s65, s65, 40960
s_cselect_b32 s65, 86016, s65
s_mul_i32 s70, s64, 393216
s_add_u32 m0, s65, s76
s_add_u32 s71, s70, s72
buffer_load_dwordx4 v12, s[12:15], s71 offen offset:0 lds
buffer_load_dwordx4 v13, s[12:15], s71 offen offset:1024 lds
buffer_load_dwordx4 v14, s[12:15], s71 offen offset:2048 lds
buffer_load_dwordx4 v15, s[12:15], s71 offen offset:3072 lds
buffer_load_dword v30, off, s[12:15], 0
s_add_u32 m0, m0, 4096
s_add_u32 s71, s70, s73
buffer_load_dwordx4 v12, s[12:15], s71 offen offset:0 lds
buffer_load_dwordx4 v13, s[12:15], s71 offen offset:1024 lds
buffer_load_dwordx4 v14, s[12:15], s71 offen offset:2048 lds
buffer_load_dwordx4 v15, s[12:15], s71 offen offset:3072 lds
buffer_load_dword v30, off, s[12:15], 0
s_add_u32 m0, m0, 4096
s_add_u32 s71, s70, s74
buffer_load_dwordx4 v12, s[12:15], s71 offen offset:0 lds
buffer_load_dwordx4 v13, s[12:15], s71 offen offset:1024 lds
buffer_load_dwordx4 v14, s[12:15], s71 offen offset:2048 lds
buffer_load_dwordx4 v15, s[12:15], s71 offen offset:3072 lds
buffer_load_dword v30, off, s[12:15], 0
s_add_u32 s64, s64, 1
s_and_b32 s64, s64, 15
s_sub_u32 s65, s65, 40960
s_cselect_b32 s65, 86016, s65
s_mul_i32 s70, s64, 393216
s_add_u32 m0, s65, s76
s_add_u32 s71, s70, s72
buffer_load_dwordx4 v12, s[12:15], s71 offen offset:0 lds
buffer_load_dwordx4 v13, s[12:15], s71 offen offset:1024 lds
buffer_load_dwordx4 v14, s[12:15], s71 offen offset:2048 lds
buffer_load_dwordx4 v15, s[12:15], s71 offen offset:3072 lds
buffer_load_dword v30, off, s[12:15], 0
s_add_u32 m0, m0, 4096
s_add_u32 s71, s70, s73
buffer_load_dwordx4 v12, s[12:15], s71 offen offset:0 lds
buffer_load_dwordx4 v13, s[12:15], s71 offen offset:1024 lds
buffer_load_dwordx4 v14, s[12:15], s71 offen offset:2048 lds
buffer_load_dwordx4 v15, s[12:15], s71 offen offset:3072 lds
buffer_load_dword v30, off, s[12:15], 0
s_add_u32 m0, m0, 4096
s_add_u32 s71, s70, s74
buffer_load_dwordx4 v12, s[12:15], s71 offen offset:0 lds
buffer_load_dwordx4 v13, s[12:15], s71 offen offset:1024 lds
buffer_load_dwordx4 v14, s[12:15], s71 offen offset:2048 lds
buffer_load_dwordx4 v15, s[12:15], s71 offen offset:3072 lds
buffer_load_dword v30, off, s[12:15], 0
s_add_u32 s64, s64, 1
s_and_b32 s64, s64, 15
s_sub_u32 s65, s65, 40960
s_cselect_b32 s65, 86016, s65
s_mov_b32 s36, s64
s_mov_b32 s37, s65
s_mov_b32 s64, s59
s_mov_b32 s65, 114688
s_mul_i32 s70, s64, 393216
s_add_u32 m0, s65, s76
s_add_u32 s71, s70, s72
buffer_load_dwordx4 v12, s[12:15], s71 offen offset:0 lds
buffer_load_dwordx4 v13, s[12:15], s71 offen offset:1024 lds
buffer_load_dwordx4 v14, s[12:15], s71 offen offset:2048 lds
buffer_load_dwordx4 v15, s[12:15], s71 offen offset:3072 lds
buffer_load_dword v30, off, s[12:15], 0
s_add_u32 m0, m0, 4096
s_add_u32 s71, s70, s73
buffer_load_dwordx4 v12, s[12:15], s71 offen offset:0 lds
buffer_load_dwordx4 v13, s[12:15], s71 offen offset:1024 lds
buffer_load_dwordx4 v14, s[12:15], s71 offen offset:2048 lds
buffer_load_dwordx4 v15, s[12:15], s71 offen offset:3072 lds
buffer_load_dword v30, off, s[12:15], 0
s_add_u32 m0, m0, 4096
s_add_u32 s71, s70, s74
buffer_load_dwordx4 v12, s[12:15], s71 offen offset:0 lds
buffer_load_dwordx4 v13, s[12:15], s71 offen offset:1024 lds
buffer_load_dwordx4 v14, s[12:15], s71 offen offset:2048 lds
buffer_load_dwordx4 v15, s[12:15], s71 offen offset:3072 lds
buffer_load_dword v30, off, s[12:15], 0
s_mov_b32 s64, s36
s_mov_b32 s65, s37
s_and_b32 s64, s61, 14
s_mov_b32 s65, 86016
s_add_u32 s35, s34, 23
lw_30:
ds_read_b32 v5, v1 offset:0
s_waitcnt lgkmcnt(0)
v_cmp_gt_i32 vcc, s35, v5
s_cbranch_vccz lwd_31
s_sleep 1
s_sub_u32 s32, s32, 1
s_cmp_gt_i32 s32, 0
s_cbranch_scc1 lw_30
lwd_31:
poll_32:
buffer_load_dword v6, v21, s[24:27], s66 offen sc1
pchk_33:
s_waitcnt vmcnt(0)
v_cmp_eq_u32 vcc, 0, v6
s_cbranch_vccz pdone_34
s_sub_u32 s32, s32, 1
s_cmp_gt_i32 s32, 0
s_cbranch_scc1 poll_32
pdone_34:
s_mul_i32 s70, s64, s67
s_add_u32 m0, s65, s75
s_add_u32 s71, s70, s68
buffer_load_dwordx4 v8, s[8:11], s71 offen offset:0 sc1 lds
buffer_load_dwordx4 v9, s[8:11], s71 offen offset:1024 sc1 lds
buffer_load_dwordx4 v10, s[8:11], s71 offen offset:2048 sc1 lds
buffer_load_dwordx4 v11, s[8:11], s71 offen offset:3072 sc1 lds
buffer_load_dword v30, off, s[12:15], 0
s_add_u32 m0, m0, 4096
s_add_u32 s71, s70, s69
buffer_load_dwordx4 v8, s[8:11], s71 offen offset:0 sc1 lds
buffer_load_dwordx4 v9, s[8:11], s71 offen offset:1024 sc1 lds
buffer_load_dwordx4 v10, s[8:11], s71 offen offset:2048 sc1 lds
buffer_load_dwordx4 v11, s[8:11], s71 offen offset:3072 sc1 lds
buffer_load_dword v30, off, s[12:15], 0
s_add_u32 s64, s64, 1
s_and_b32 s64, s64, 15
s_sub_u32 s65, s65, 40960
s_cselect_b32 s65, 86016, s65
s_mul_i32 s70, s64, s67
s_add_u32 m0, s65, s75
s_add_u32 s71, s70, s68
buffer_load_dwordx4 v8, s[8:11], s71 offen offset:0 sc1 lds
buffer_load_dwordx4 v9, s[8:11], s71 offen offset:1024 sc1 lds
buffer_load_dwordx4 v10, s[8:11], s71 offen offset:2048 sc1 lds
buffer_load_dwordx4 v11, s[8:11], s71 offen offset:3072 sc1 lds
buffer_load_dword v30, off, s[12:15], 0
s_add_u32 m0, m0, 4096
s_add_u32 s71, s70, s69
buffer_load_dwordx4 v8, s[8:11], s71 offen offset:0 sc1 lds
buffer_load_dwordx4 v9, s[8:11], s71 offen offset:1024 sc1 lds
buffer_load_dwordx4 v10, s[8:11], s71 offen offset:2048 sc1 lds
buffer_load_dwordx4 v11, s[8:11], s71 offen offset:3072 sc1 lds
buffer_load_dword v30, off, s[12:15], 0
s_add_u32 s64, s64, 1
s_and_b32 s64, s64, 15
s_sub_u32 s65, s65, 40960
s_cselect_b32 s65, 86016, s65
s_mul_i32 s70, s64, s67
s_add_u32 m0, s65, s75
s_add_u32 s71, s70, s68
buffer_load_dwordx4 v8, s[8:11], s71 offen offset:0 sc1 lds
buffer_load_dwordx4 v9, s[8:11], s71 offen offset:1024 sc1 lds
buffer_load_dwordx4 v10, s[8:11], s71 offen offset:2048 sc1 lds
buffer_load_dwordx4 v11, s[8:11], s71 offen offset:3072 sc1 lds
buffer_load_dword v30, off, s[12:15], 0
s_add_u32 m0, m0, 4096
s_add_u32 s71, s70, s69
buffer_load_dwordx4 v8, s[8:11], s71 offen offset:0 sc1 lds
buffer_load_dwordx4 v9, s[8:11], s71 offen offset:1024 sc1 lds
buffer_load_dwordx4 v10, s[8:11], s71 offen offset:2048 sc1 lds
buffer_load_dwordx4 v11, s[8:11], s71 offen offset:3072 sc1 lds
buffer_load_dword v30, off, s[12:15], 0
s_add_u32 s64, s64, 1
s_and_b32 s64, s64, 15
s_sub_u32 s65, s65, 40960
s_cselect_b32 s65, 86016, s65
s_waitcnt vmcnt(20)
v_add_u32 v5, s34, 33
s_mov_b64 exec, 1
ds_write_b32 v3, v5
s_mov_b64 exec, -1
s_waitcnt vmcnt(10)
v_add_u32 v5, s34, 34
s_mov_b64 exec, 1
ds_write_b32 v3, v5
s_mov_b64 exec, -1
s_mov_b32 s63, 1
s_mov_b32 s34, 32
s_add_u32 s24, s24, 1409024
s_addc_u32 s25, s25, 0
s_mov_b32 s26, 1409024
s_mov_b32 s66, 32
s_branch lq_1
lcs_2:
s_add_u32 s35, s34, 1
lw_35:
ds_read_b32 v5, v2 offset:24
s_waitcnt lgkmcnt(0)
v_cmp_gt_i32 vcc, s35, v5
s_cbranch_vccz lwd_36
s_sub_u32 s32, s32, 1
s_cmp_gt_i32 s32, 0
s_cbranch_scc1 lw_35
lwd_36:
s_branch lcb_3
L_f:
v_lshlrev_b32 v4, 4, v0
s_lshl4_add_u32 s78, s59, s60
v_mov_b32 v252, 0
v_mov_b32 v253, 0
v_mov_b32 v254, 0
v_mov_b32 v255, 0
s_lshl_b32 s35, s78, 10
s_cmp_eq_u32 s58, 0
s_cselect_b64 exec, -1, 0
buffer_store_dwordx4 v[252:255], v4, s[24:27], s35 offen offset:0 sc1
s_add_u32 s35, s35, 262144
buffer_store_dwordx4 v[252:255], v4, s[24:27], s35 offen offset:0 sc1
s_mov_b64 exec, -1
s_setprio 3
v_and_b32 v1, 3, v0
v_lshlrev_b32 v1, 2, v1
v_and_b32 v2, 4, v1
s_lshl2_add_u32 s35, s58, 24
v_mov_b32 v3, s35
s_mov_b32 s4, s54
s_mov_b32 s5, s55
s_mov_b32 s6, 0x100
s_mov_b32 s7, 0x00020000
s_add_u32 s70, s60, 4
s_lshr_b32 s70, s70, 3
s_sub_u32 s70, s60, s70
s_lshl4_add_u32 s64, s70, s59
s_and_b32 s70, s60, 7
s_cmp_eq_u32 s70, 3
s_cselect_b32 s65, 1, 0
s_mov_b32 s69, 0x3f803f80
s_barrier
s_cmp_eq_u32 s58, 0
s_cselect_b32 s16, s46, s48
s_cselect_b32 s17, s47, s49
s_mov_b32 s12, s50
s_mov_b32 s13, s51
s_mov_b32 s14, 0x0
s_mov_b32 s15, 0x00020000
s_cmp_eq_u32 s65, 0
s_cselect_b32 s18, 7340032, 0
s_mov_b32 s14, s18
s_lshr_b32 s70, s64, 3
s_and_b32 s71, s64, 7
s_lshl_b32 s66, s70, 10
s_add_u32 s66, s66, s71
s_lshl1_add_u32 s66, s66, s58
s_lshl_b32 s66, s66, 7
s_mul_i32 s71, s71, 917504
s_lshl_b32 s70, s70, 8
s_add_u32 s77, s71, s70
s_and_b32 s73, s2, 3
s_lshl_b32 s73, s73, 6
v_mov_b32 v14, 1
s_sub_u32 exec_lo, 1, s58
s_mov_b32 exec_hi, 0
s_waitcnt vmcnt(0)
buffer_atomic_add v14, off, s[4:7], s73 sc1
s_mov_b64 exec, -1
v_mov_b32 v8, s69
v_mov_b32 v9, s69
v_mov_b32 v10, s69
v_mov_b32 v11, s69
v_mov_b32 v12, s69
v_mov_b32 v13, s69
v_mov_b32 v14, s69
v_mov_b32 v15, s69
s_mov_b32 s70, 102400
ftop_37:
v_lshrrev_b32 v6, 4, v0
v_bfe_u32 v7, v0, 2, 2
v_lshl_add_u32 v6, v6, 3, v7
v_bfe_u32 v7, v0, 3, 2
s_lshl_b32 s71, s58, 1
v_xor_b32 v7, s71, v7
v_lshl_add_u32 v7, v7, 5, s70
v_lshl_add_u32 v6, v6, 7, v7
v_lshl_add_u32 v6, v1, 1, v6
v_xor_b32 v7, 32, v6
s_lshl1_add_u32 s71, s63, s34
s_add_u32 s35, s71, 1
lw_38:
ds_read_b32 v5, v2 offset:16
s_waitcnt lgkmcnt(0)
v_cmp_gt_i32 vcc, s35, v5
s_cbranch_vccz lwd_39
s_sleep 1
s_sub_u32 s32, s32, 1
s_cmp_gt_i32 s32, 0
s_cbranch_scc1 lw_38
lwd_39:
ds_read_b64_tr_b16 v[24:25], v6 offset:0
ds_read_b64_tr_b16 v[26:27], v6 offset:512
ds_read_b64_tr_b16 v[28:29], v6 offset:4096
ds_read_b64_tr_b16 v[30:31], v6 offset:4608
ds_read_b64_tr_b16 v[32:33], v7 offset:0
ds_read_b64_tr_b16 v[34:35], v7 offset:512
ds_read_b64_tr_b16 v[36:37], v7 offset:4096
ds_read_b64_tr_b16 v[38:39], v7 offset:4608
ds_read_b64_tr_b16 v[40:41], v6 offset:8192
ds_read_b64_tr_b16 v[42:43], v6 offset:8704
ds_read_b64_tr_b16 v[44:45], v6 offset:12288
ds_read_b64_tr_b16 v[46:47], v6 offset:12800
ds_read_b64_tr_b16 v[48:49], v7 offset:8192
ds_read_b64_tr_b16 v[50:51], v7 offset:8704
ds_read_b64_tr_b16 v[52:53], v7 offset:12288
ds_read_b64_tr_b16 v[54:55], v7 offset:12800
s_lshl_b32 s72, s60, 14
s_lshl_b32 s70, s58, 9
s_add_u32 s72, s72, s70
s_lshl_b32 s70, s59, 10
s_add_u32 s71, s72, s70
s_lshl_b32 s76, s59, 14
s_add_u32 s73, s76, 30686208
s_add_u32 s76, s76, 266240
s_waitcnt lgkmcnt(14)
v_mfma_f32_16x16x32_bf16 v[248:251], v[8:11], v[24:27], 0
s_waitcnt lgkmcnt(10)
v_mfma_f32_16x16x32_bf16 v[252:255], v[8:11], v[32:35], 0
v_mfma_f32_16x16x32_bf16 v[248:251], v[12:15], v[28:31], v[248:251]
s_waitcnt lgkmcnt(8)
v_mfma_f32_16x16x32_bf16 v[252:255], v[12:15], v[36:39], v[252:255]
ds_read_b64_tr_b16 v[24:25], v6 offset:16384
ds_read_b64_tr_b16 v[26:27], v6 offset:16896
ds_read_b64_tr_b16 v[28:29], v6 offset:20480
ds_read_b64_tr_b16 v[30:31], v6 offset:20992
ds_read_b64_tr_b16 v[32:33], v7 offset:16384
ds_read_b64_tr_b16 v[34:35], v7 offset:16896
ds_read_b64_tr_b16 v[36:37], v7 offset:20480
ds_read_b64_tr_b16 v[38:39], v7 offset:20992
v_add_u32 v5, s34, 1
s_mov_b64 exec, 1
ds_write_b32 v3, v5
s_mov_b64 exec, -1
s_waitcnt lgkmcnt(14)
v_mfma_f32_16x16x32_bf16 v[16:19], v[8:11], v[40:43], 0
s_waitcnt lgkmcnt(11)
v_mfma_f32_16x16x32_bf16 v[20:23], v[8:11], v[48:51], 0
v_mfma_f32_16x16x32_bf16 v[16:19], v[12:15], v[44:47], v[16:19]
s_waitcnt lgkmcnt(9)
v_mfma_f32_16x16x32_bf16 v[20:23], v[12:15], v[52:55], v[20:23]
v_mov_b32 v249, v252
v_mov_b32 v252, s69
v_mov_b32 v253, s69
v_mov_b32 v254, s69
v_mov_b32 v255, s69
v_mfma_f32_16x16x32_bf16 v[52:55], v[8:11], v[8:11], 0
s_nop 0
v_mfma_f32_16x16x32_bf16 v[48:51], v[8:11], v[252:255], 0
v_mfma_f32_16x16x32_bf16 v[52:55], v[12:15], v[12:15], v[52:55]
v_mfma_f32_16x16x32_bf16 v[48:51], v[12:15], v[252:255], v[48:51]
s_waitcnt lgkmcnt(7)
v_mfma_f32_16x16x32_bf16 v[40:43], v[8:11], v[24:27], 0
s_waitcnt lgkmcnt(3)
v_mfma_f32_16x16x32_bf16 v[44:47], v[8:11], v[32:35], 0
v_mfma_f32_16x16x32_bf16 v[40:43], v[12:15], v[28:31], v[40:43]
s_waitcnt lgkmcnt(1)
v_mfma_f32_16x16x32_bf16 v[44:47], v[12:15], v[36:39], v[44:47]
v_lshlrev_b32 v6, 3, v0
v_and_b32 v7, 48, v0
v_mov_b32_dpp v248, v16 quad_perm:[0,1,2,3] row_mask:0x2 bank_mask:0xf
v_mov_b32_dpp v249, v20 quad_perm:[0,1,2,3] row_mask:0x2 bank_mask:0xf
s_nop 0
v_mov_b32_dpp v248, v48 quad_perm:[0,1,2,3] row_mask:0x8 bank_mask:0xf
v_mov_b32_dpp v249, v52 quad_perm:[0,1,2,3] row_mask:0x8 bank_mask:0xf
s_nop 0
v_mov_b32_dpp v248, v40 quad_perm:[0,1,2,3] row_mask:0x4 bank_mask:0xf
v_mov_b32_dpp v249, v44 quad_perm:[0,1,2,3] row_mask:0x4 bank_mask:0xf
v_max_u32 v248, 1, v248
v_max_u32 v249, 1, v249
s_cmp_eq_u32 s63, 0
s_cbranch_scc1 fst_40
fsb_41:
buffer_store_dwordx2 v[248:249], v6, s[24:27], s71 offen sc1
s_lshl4_add_u32 s70, s58, s60
s_add_u32 s70, s70, s34
s_cmp_eq_u32 s70, 51
s_cbranch_scc1 fxt_42
fxb_43:
s_add_u32 s73, s72, 4096
s_add_u32 s74, s72, 8192
s_add_u32 s75, s72, 12288
v_lshrrev_b32 v7, 2, v0
v_lshlrev_b32 v7, 7, v7
v_lshl_add_u32 v7, v1, 2, v7
v_lshrrev_b32 v8, 5, v0
v_lshrrev_b32 v9, 4, v0
v_xor_b32 v10, v8, v9
v_and_b32 v10, 1, v10
v_lshl_add_u32 v8, v10, 1, v8
v_and_b32 v10, 15, v0
v_lshlrev_b32 v8, 7, v8
v_lshl_add_u32 v8, v10, 3, v8
v_add_u32 v8, 1280, v8
s_mul_i32 s70, s58, 384
s_lshl_b32 s71, s63, 10
s_add_u32 s70, s70, s71
s_add_u32 s70, s70, 2304
v_lshl_add_u32 v9, v9, 7, s70
v_lshl_add_u32 v9, v10, 2, v9
s_cmp_eq_u32 s63, 0
s_cbranch_scc1 fg_44
fg_45:
poll_46:
buffer_load_dwordx4 v[12:15], v7, s[24:27], s76 offen sc1
pchk_47:
s_waitcnt vmcnt(0)
v_min3_u32 v10, v12, v13, v14
v_min_u32 v10, v10, v15
v_cmp_eq_u32 vcc, 0, v10
s_cbranch_vccz pdone_48
s_sub_u32 s32, s32, 1
s_cmp_gt_i32 s32, 0
s_cbranch_scc1 poll_46
pdone_48:
s_lshr_b32 s70, s33, 7
s_sub_u32 s70, s70, s59
s_mul_i32 s70, s70, s63
s_cmp_eq_u32 s70, 0
s_cbranch_scc0 fng_49
poll_50:
buffer_load_dwordx2 v[24:25], v6, s[24:27], s72 offen offset:0 sc1
buffer_load_dwordx2 v[26:27], v6, s[24:27], s72 offen offset:1024 sc1
buffer_load_dwordx2 v[28:29], v6, s[24:27], s72 offen offset:2048 sc1
buffer_load_dwordx2 v[30:31], v6, s[24:27], s72 offen offset:3072 sc1
buffer_load_dwordx2 v[32:33], v6, s[24:27], s73 offen offset:0 sc1
buffer_load_dwordx2 v[34:35], v6, s[24:27], s73 offen offset:1024 sc1
buffer_load_dwordx2 v[36:37], v6, s[24:27], s73 offen offset:2048 sc1
buffer_load_dwordx2 v[38:39], v6, s[24:27], s73 offen offset:3072 sc1
buffer_load_dwordx2 v[40:41], v6, s[24:27], s74 offen offset:0 sc1
buffer_load_dwordx2 v[42:43], v6, s[24:27], s74 offen offset:1024 sc1
buffer_load_dwordx2 v[44:45], v6, s[24:27], s74 offen offset:2048 sc1
buffer_load_dwordx2 v[46:47], v6, s[24:27], s74 offen offset:3072 sc1
buffer_load_dwordx2 v[48:49], v6, s[24:27], s75 offen offset:0 sc1
buffer_load_dwordx2 v[50:51], v6, s[24:27], s75 offen offset:1024 sc1
buffer_load_dwordx2 v[52:53], v6, s[24:27], s75 offen offset:2048 sc1
buffer_load_dwordx2 v[54:55], v6, s[24:27], s75 offen offset:3072 sc1
pchk_51:
s_waitcnt vmcnt(14)
v_min3_u32 v10, v24, v25, v26
s_waitcnt vmcnt(13)
v_min3_u32 v10, v10, v27, v28
s_waitcnt vmcnt(12)
v_min3_u32 v10, v10, v29, v30
s_waitcnt vmcnt(11)
v_min3_u32 v10, v10, v31, v32
s_waitcnt vmcnt(10)
v_min3_u32 v10, v10, v33, v34
s_waitcnt vmcnt(9)
v_min3_u32 v10, v10, v35, v36
s_waitcnt vmcnt(8)
v_min3_u32 v10, v10, v37, v38
s_waitcnt vmcnt(7)
v_min3_u32 v10, v10, v39, v40
s_waitcnt vmcnt(6)
v_min3_u32 v10, v10, v41, v42
s_waitcnt vmcnt(5)
v_min3_u32 v10, v10, v43, v44
s_waitcnt vmcnt(4)
v_min3_u32 v10, v10, v45, v46
s_waitcnt vmcnt(3)
v_min3_u32 v10, v10, v47, v48
s_waitcnt vmcnt(2)
v_min3_u32 v10, v10, v49, v50
s_waitcnt vmcnt(1)
v_min3_u32 v10, v10, v51, v52
s_waitcnt vmcnt(0)
v_min3_u32 v10, v10, v53, v54
v_min_u32 v10, v10, v55
v_cmp_eq_u32 vcc, 0, v10
s_cbranch_vccz pdone_52
s_sub_u32 s32, s32, 1
s_cmp_gt_i32 s32, 0
s_cbranch_scc1 poll_50
pdone_52:
v_add_f32 v24, v24, v40
v_add_f32 v25, v25, v41
v_add_f32 v26, v26, v42
v_add_f32 v27, v27, v43
v_add_f32 v28, v28, v44
v_add_f32 v29, v29, v45
v_add_f32 v30, v30, v46
v_add_f32 v31, v31, v47
v_add_f32 v32, v32, v48
v_add_f32 v33, v33, v49
v_add_f32 v34, v34, v50
v_add_f32 v35, v35, v51
v_add_f32 v36, v36, v52
v_add_f32 v37, v37, v53
v_add_f32 v38, v38, v54
v_add_f32 v39, v39, v55
v_add_f32 v24, v24, v32
v_add_f32 v25, v25, v33
v_add_f32 v26, v26, v34
v_add_f32 v27, v27, v35
v_add_f32 v28, v28, v36
v_add_f32 v29, v29, v37
v_add_f32 v30, v30, v38
v_add_f32 v31, v31, v39
v_add_f32 v24, v24, v28
v_add_f32 v25, v25, v29
v_add_f32 v26, v26, v30
v_add_f32 v27, v27, v31
v_add_f32 v24, v24, v26
v_add_f32 v25, v25, v27
s_mov_b32 exec_hi, 0xffff
ds_write2_b32 v9, v24, v25 offset1:16
s_mov_b32 exec_hi, -1
v_mul_f32 v5, 0xba800000, v24
v_mul_f32 v25, 0x3a800000, v25
v_fma_f32 v25, -v5, v5, v25
v_max_f32 v25, 0, v25
v_add_f32 v25, 0x3727c5ac, v25
v_rsq_f32 v24, v25
s_nop 0
v_mul_f32 v25, v5, v24
s_lshl_b32 s70, s59, 7
s_sub_u32 s70, s33, s70
v_lshlrev_b32 v10, 1, v0
v_sub_u32 v10, s70, v10
v_readlane_b32 s70, v24, 48
v_readlane_b32 s71, v25, 48
v_cmp_eq_u32 vcc, 0, v10
s_mov_b64 exec, vcc
v_mov_b32 v12, s70
v_mov_b32 v13, s71
s_mov_b64 exec, -1
v_cmp_eq_u32 vcc, 1, v10
s_mov_b64 exec, vcc
v_mov_b32 v14, s70
v_mov_b32 v15, s71
s_mov_b64 exec, -1
fng_49:
ds_write2_b32 v8, v12, v14 offset1:1
ds_write2_b32 v8, v13, v15 offset0:128 offset1:129
s_add_u32 s71, s34, s63
v_add_u32 v5, s71, 2
s_mov_b64 exec, 1
ds_write_b32 v3, v5
s_mov_b64 exec, -1
s_setprio 0
s_cmp_eq_u32 s63, 0
s_cbranch_scc1 fnw_53
fnw_54:
s_and_b32 s70, s64, 7
s_lshl_b32 s70, s70, 7
s_add_u32 s73, s70, 276480
s_lshl1_add_u32 s72, s70, 272384
s_lshr_b32 s71, s64, 3
s_lshl_b32 s76, s71, 13
s_add_u32 s76, s76, 1048576
s_lshl2_add_u32 s74, s70, s76
s_lshl_b32 s70, s58, 8
s_add_u32 s74, s74, s70
s_add_u32 s75, s74, 4096
s_lshl4_add_u32 s76, s70, s76
v_and_b32 v251, 15, v0
v_lshlrev_b32 v6, 14, v251
v_lshrrev_b32 v252, 4, v0
v_lshl_add_u32 v7, v252, 5, v6
v_lshlrev_b32 v251, 4, v251
s_lshl_b32 s70, s58, 3
v_lshl_add_u32 v253, v252, 1, s70
v_add_u32 v253, v253, v251
v_lshlrev_b32 v254, 5, v252
v_lshl_add_u32 v254, v2, 2, v254
v_and_b32 v255, 7, v0
v_lshl_add_u32 v255, v255, 2, v252
v_lshlrev_b32 v255, 3, v255
s_add_u32 s35, s34, 22
lw_55:
ds_read_b32 v5, v1 offset:0
s_waitcnt lgkmcnt(0)
v_cmp_gt_i32 vcc, s35, v5
s_cbranch_vccz lwd_56
s_sleep 4
s_sub_u32 s32, s32, 1
s_cmp_gt_i32 s32, 0
s_cbranch_scc1 lw_55
lwd_56:
s_setprio 3
s_add_u32 s35, s34, 24
lw_57:
ds_read_b32 v5, v1 offset:0
s_waitcnt lgkmcnt(0)
v_cmp_gt_i32 vcc, s35, v5
s_cbranch_vccz lwd_58
s_sleep 2
s_sub_u32 s32, s32, 1
s_cmp_gt_i32 s32, 0
s_cbranch_scc1 lw_57
lwd_58:
s_mul_i32 s79, s63, 64
s_sub_u32 s79, 32, s79
s_add_u32 s35, s79, 3
lw_59:
ds_read_b32 v5, v2 offset:16
s_waitcnt lgkmcnt(0)
v_cmp_gt_i32 vcc, s35, v5
s_cbranch_vccz lwd_60
s_sleep 4
s_sub_u32 s32, s32, 1
s_cmp_gt_i32 s32, 0
s_cbranch_scc1 lw_59
lwd_60:
s_cmp_eq_u32 s65, 0
s_cbranch_scc0 fnd_62
poll_63:
buffer_load_dwordx2 v[248:249], v6, s[24:27], s73 offen sc1
buffer_load_dwordx4 v[8:11], v7, s[24:27], s72 offen offset:0 sc1
buffer_load_dwordx4 v[12:15], v7, s[24:27], s72 offen offset:16 sc1
buffer_load_dwordx4 v[16:19], v7, s[24:27], s72 offen offset:128 sc1
buffer_load_dwordx4 v[20:23], v7, s[24:27], s72 offen offset:144 sc1
pchk_64:
s_waitcnt vmcnt(3)
v_min3_u32 v5, v248, v249, v8
v_min3_u32 v5, v5, v9, v10
s_waitcnt vmcnt(2)
v_min3_u32 v5, v5, v11, v12
v_min3_u32 v5, v5, v13, v14
s_waitcnt vmcnt(1)
v_min3_u32 v5, v5, v15, v16
v_min3_u32 v5, v5, v17, v18
s_waitcnt vmcnt(0)
v_min3_u32 v5, v5, v19, v20
v_min3_u32 v5, v5, v21, v22
v_min_u32 v5, v5, v23
v_cmp_eq_u32 vcc, 0, v5
s_cbranch_vccz pdone_65
s_sub_u32 s32, s32, 1
s_cmp_gt_i32 s32, 0
s_cbranch_scc1 poll_63
pdone_65:
v_mfma_f32_16x16x32_bf16 v[24:27], v[8:11], v[56:59], 0
v_mov_b32 v250, v248
v_mfma_f32_16x16x32_bf16 v[28:31], v[8:11], v[60:63], 0
s_nop 0
v_max_f32_dpp v250, v250, v250 row_ror:1 row_mask:0xf bank_mask:0xf
v_mfma_f32_16x16x32_bf16 v[32:35], v[8:11], v[64:67], 0
s_nop 0
v_max_f32_dpp v250, v250, v250 row_ror:2 row_mask:0xf bank_mask:0xf
v_mfma_f32_16x16x32_bf16 v[36:39], v[8:11], v[68:71], 0
s_nop 0
v_max_f32_dpp v250, v250, v250 row_ror:4 row_mask:0xf bank_mask:0xf
v_mfma_f32_16x16x32_bf16 v[40:43], v[8:11], v[72:75], 0
s_nop 0
v_max_f32_dpp v250, v250, v250 row_ror:8 row_mask:0xf bank_mask:0xf
v_mfma_f32_16x16x32_bf16 v[44:47], v[8:11], v[76:79], 0
v_cmp_eq_f32 vcc, v250, v248
v_mfma_f32_16x16x32_bf16 v[48:51], v[8:11], v[80:83], 0
s_ff1_i32_b64 s68, vcc
v_mfma_f32_16x16x32_bf16 v[52:55], v[8:11], v[84:87], 0
s_and_b32 s68, s68, 15
v_mfma_f32_16x16x32_bf16 v[24:27], v[12:15], v[88:91], v[24:27]
v_readlane_b32 s33, v249, s68
v_mfma_f32_16x16x32_bf16 v[28:31], v[12:15], v[92:95], v[28:31]
v_readlane_b32 s67, v248, s68
v_mfma_f32_16x16x32_bf16 v[32:35], v[12:15], v[96:99], v[32:35]
v_add_u32 v5, s34, 4
v_mfma_f32_16x16x32_bf16 v[36:39], v[12:15], v[100:103], v[36:39]
v_mov_b32 v250, s33
v_mfma_f32_16x16x32_bf16 v[40:43], v[12:15], v[104:107], v[40:43]
s_mov_b64 exec, 1
ds_write2_b32 v3, v5, v250 offset1:2
s_mov_b64 exec, -1
v_mfma_f32_16x16x32_bf16 v[44:47], v[12:15], v[108:111], v[44:47]
s_sub_u32 s33, s33, 1
v_mfma_f32_16x16x32_bf16 v[48:51], v[12:15], v[112:115], v[48:51]
s_and_b32 s33, s33, 2047
v_mfma_f32_16x16x32_bf16 v[52:55], v[12:15], v[116:119], v[52:55]
v_mfma_f32_16x16x32_bf16 v[24:27], v[16:19], v[120:123], v[24:27]
v_mfma_f32_16x16x32_bf16 v[28:31], v[16:19], v[124:127], v[28:31]
v_mfma_f32_16x16x32_bf16 v[32:35], v[16:19], v[128:131], v[32:35]
v_mfma_f32_16x16x32_bf16 v[36:39], v[16:19], v[132:135], v[36:39]
v_mfma_f32_16x16x32_bf16 v[40:43], v[16:19], v[136:139], v[40:43]
v_mfma_f32_16x16x32_bf16 v[44:47], v[16:19], v[140:143], v[44:47]
v_mfma_f32_16x16x32_bf16 v[48:51], v[16:19], v[144:147], v[48:51]
v_mfma_f32_16x16x32_bf16 v[52:55], v[16:19], v[148:151], v[52:55]
v_mfma_f32_16x16x32_bf16 v[24:27], v[20:23], v[152:155], v[24:27]
s_and_b32 s70, s68, 12
s_lshl_b32 s70, s70, 2
s_bitcmp1_b32 s68, 1
v_mfma_f32_16x16x32_bf16 v[28:31], v[20:23], v[156:159], v[28:31]
v_mfma_f32_16x16x32_bf16 v[32:35], v[20:23], v[160:163], v[32:35]
v_mfma_f32_16x16x32_bf16 v[36:39], v[20:23], v[164:167], v[36:39]
v_mfma_f32_16x16x32_bf16 v[40:43], v[20:23], v[168:171], v[40:43]
v_mfma_f32_16x16x32_bf16 v[44:47], v[20:23], v[172:175], v[44:47]
v_mfma_f32_16x16x32_bf16 v[48:51], v[20:23], v[176:179], v[48:51]
v_mfma_f32_16x16x32_bf16 v[52:55], v[20:23], v[180:183], v[52:55]
s_cbranch_scc1 fsel_68
fsel_66:
s_bitcmp1_b32 s68, 0
s_cbranch_scc1 fsel_67
v_max_u32 v8, 1, v24
v_max_u32 v9, 1, v28
v_max_u32 v10, 1, v32
v_max_u32 v11, 1, v36
v_max_u32 v12, 1, v40
v_max_u32 v13, 1, v44
v_max_u32 v14, 1, v48
v_max_u32 v15, 1, v52
s_branch fsel_70
fsel_67:
v_max_u32 v8, 1, v25
v_max_u32 v9, 1, v29
v_max_u32 v10, 1, v33
v_max_u32 v11, 1, v37
v_max_u32 v12, 1, v41
v_max_u32 v13, 1, v45
v_max_u32 v14, 1, v49
v_max_u32 v15, 1, v53
s_branch fsel_70
fsel_68:
s_bitcmp1_b32 s68, 0
s_cbranch_scc1 fsel_69
v_max_u32 v8, 1, v26
v_max_u32 v9, 1, v30
v_max_u32 v10, 1, v34
v_max_u32 v11, 1, v38
v_max_u32 v12, 1, v42
v_max_u32 v13, 1, v46
v_max_u32 v14, 1, v50
v_max_u32 v15, 1, v54
s_branch fsel_70
fsel_69:
v_max_u32 v8, 1, v27
v_max_u32 v9, 1, v31
v_max_u32 v10, 1, v35
v_max_u32 v11, 1, v39
v_max_u32 v12, 1, v43
v_max_u32 v13, 1, v47
v_max_u32 v14, 1, v51
v_max_u32 v15, 1, v55
fsel_70:
s_bfm_b64 exec, 16, s70
buffer_store_dwordx4 v[8:11], v251, s[24:27], s74 offen sc1
buffer_store_dwordx4 v[12:15], v251, s[24:27], s75 offen sc1
s_mov_b64 exec, -1
s_and_b32 s70, s64, 7
s_lshl1_add_u32 s70, s70, s58
s_mul_i32 s70, s70, 28
s_add_u32 s70, s70, s71
s_lshl_b32 s70, s70, 8
s_add_u32 s70, s70, 1277952
s_waitcnt vmcnt(0)
s_mul_i32 s79, s63, 64
s_sub_u32 s79, 32, s79
s_add_u32 s35, s79, 7
lw_71:
ds_read_b32 v5, v2 offset:16
s_waitcnt lgkmcnt(0)
v_cmp_gt_i32 vcc, s35, v5
s_cbranch_vccz lwd_72
s_sleep 4
s_sub_u32 s32, s32, 1
s_cmp_gt_i32 s32, 0
s_cbranch_scc1 lw_71
lwd_72:
poll_73:
buffer_load_dwordx4 v[24:27], v4, s[24:27], s76 offen offset:0 sc1
buffer_load_dwordx4 v[28:31], v4, s[24:27], s76 offen offset:1024 sc1
buffer_load_dwordx4 v[32:35], v4, s[24:27], s76 offen offset:2048 sc1
buffer_load_dwordx4 v[36:39], v4, s[24:27], s76 offen offset:3072 sc1
pchk_74:
s_waitcnt vmcnt(3)
v_min3_u32 v5, v24, v25, v26
s_waitcnt vmcnt(2)
v_min3_u32 v5, v5, v27, v28
v_min3_u32 v5, v5, v29, v30
s_waitcnt vmcnt(1)
v_min3_u32 v5, v5, v31, v32
v_min3_u32 v5, v5, v33, v34
s_waitcnt vmcnt(0)
v_min3_u32 v5, v5, v35, v36
v_min3_u32 v5, v5, v37, v38
v_min_u32 v5, v5, v39
v_cmp_eq_u32 vcc, 0, v5
s_cbranch_vccz pdone_75
s_sub_u32 s32, s32, 1
s_cmp_gt_i32 s32, 0
s_cbranch_scc1 poll_73
pdone_75:
v_add_f32 v24, v24, v32
v_add_f32 v25, v25, v33
v_add_f32 v26, v26, v34
v_add_f32 v27, v27, v35
v_add_f32 v28, v28, v36
v_add_f32 v29, v29, v37
v_add_f32 v30, v30, v38
v_add_f32 v31, v31, v39
v_add_f32 v24, v24, v28
v_add_f32 v25, v25, v29
v_add_f32 v26, v26, v30
v_add_f32 v27, v27, v31
s_nop 0
v_permlane32_swap_b32 v24, v26
v_permlane32_swap_b32 v25, v27
v_add_f32 v24, v24, v26
v_add_f32 v25, v25, v27
s_nop 1
v_permlane16_swap_b32 v24, v25
v_mul_f32 v26, 0xbfb8aa3b, v24
v_exp_f32 v26, v26
v_mul_f32 v24, v24, v25
v_add_f32 v26, 1.0, v26
v_rcp_f32 v26, v26
v_add_u32 v5, s34, 5
v_mul_f32 v24, v24, v26
v_cvt_pk_bf16_f32 v24, v24, v24
ds_write_b16 v253, v24 offset:512
s_mov_b64 exec, 1
ds_write_b32 v3, v5
s_mov_b64 exec, -1
s_add_u32 s35, s34, 5
poll_76:
ds_read_b32 v5, v2 offset:24
ds_read_b128 v[8:11], v254 offset:512
ds_read_b128 v[12:15], v254 offset:640
pchk_77:
s_waitcnt lgkmcnt(2)
v_cmp_gt_i32 vcc, s35, v5
s_cbranch_vccz pdone_78
s_sleep 1
s_sub_u32 s32, s32, 1
s_cmp_gt_i32 s32, 0
s_cbranch_scc1 poll_76
pdone_78:
s_waitcnt lgkmcnt(1)
v_mfma_f32_16x16x32_bf16 v[24:27], v[8:11], v[184:187], 0
v_mfma_f32_16x16x32_bf16 v[28:31], v[8:11], v[188:191], 0
v_mfma_f32_16x16x32_bf16 v[32:35], v[8:11], v[192:195], 0
v_mfma_f32_16x16x32_bf16 v[36:39], v[8:11], v[196:199], 0
v_mfma_f32_16x16x32_bf16 v[40:43], v[8:11], v[200:203], 0
v_mfma_f32_16x16x32_bf16 v[44:47], v[8:11], v[204:207], 0
v_mfma_f32_16x16x32_bf16 v[48:51], v[8:11], v[208:211], 0
v_mfma_f32_16x16x32_bf16 v[52:55], v[8:11], v[212:215], 0
s_waitcnt lgkmcnt(0)
v_mfma_f32_16x16x32_bf16 v[24:27], v[12:15], v[216:219], v[24:27]
v_mfma_f32_16x16x32_bf16 v[28:31], v[12:15], v[220:223], v[28:31]
v_mfma_f32_16x16x32_bf16 v[32:35], v[12:15], v[224:227], v[32:35]
v_mfma_f32_16x16x32_bf16 v[36:39], v[12:15], v[228:231], v[36:39]
v_mfma_f32_16x16x32_bf16 v[40:43], v[12:15], v[232:235], v[40:43]
v_mfma_f32_16x16x32_bf16 v[44:47], v[12:15], v[236:239], v[44:47]
v_mfma_f32_16x16x32_bf16 v[48:51], v[12:15], v[240:243], v[48:51]
v_mfma_f32_16x16x32_bf16 v[52:55], v[12:15], v[244:247], v[52:55]
s_nop 0
v_add_f32_dpp v16, v25, v24 row_ror:8 row_mask:0x1 bank_mask:0xf
v_add_f32_dpp v17, v29, v28 row_ror:8 row_mask:0x1 bank_mask:0xf
s_nop 0
v_add_f32_dpp v16, v33, v32 row_ror:8 row_mask:0x2 bank_mask:0xf
v_add_f32_dpp v17, v37, v36 row_ror:8 row_mask:0x2 bank_mask:0xf
s_nop 0
v_add_f32_dpp v16, v41, v40 row_ror:8 row_mask:0x4 bank_mask:0xf
v_add_f32_dpp v17, v45, v44 row_ror:8 row_mask:0x4 bank_mask:0xf
s_nop 0
v_add_f32_dpp v16, v49, v48 row_ror:8 row_mask:0x8 bank_mask:0xf
v_add_f32_dpp v17, v53, v52 row_ror:8 row_mask:0x8 bank_mask:0xf
v_max_u32 v16, 1, v16
v_max_u32 v17, 1, v17
s_mov_b32 exec_lo, 0x00ff00ff
s_mov_b32 exec_hi, 0x00ff00ff
buffer_store_dwordx2 v[16:17], v255, s[24:27], s70 offen sc1
s_mov_b64 exec, -1
fnd_61:
s_sub_u32 s70, s60, 3
s_mul_i32 s70, s70, s63
s_or_b32 s70, s70, s58
s_cbranch_scc1 fnr_79
s_mul_i32 s72, s59, 7168
s_add_u32 s72, s72, 1277952
s_add_u32 s73, s72, 4096
s_lshl_b32 s70, s68, 6
s_add_u32 s70, s70, s59
s_lshl_b32 s70, s70, 8
s_add_u32 s76, s70, 262144
v_mov_b32 v12, s67
v_mul_f32 v12, 0xbfb8aa3b, v12
v_exp_f32 v12, v12
v_lshl_add_u32 v6, v252, 2, v251
v_add_f32 v12, 1.0, v12
v_rcp_f32 v12, v12
v_lshrrev_b32 v7, 1, v6
s_lshl4_add_u32 s70, s33, s59
s_lshl_b32 s70, s70, 7
v_and_b32 v8, 0x46, v7
v_lshl_add_u32 v8, v1, 2, v8
v_and_b32 v9, 4, v0
v_lshl_add_u32 v8, v9, 1, v8
s_waitcnt vmcnt(0)
s_cmp_gt_u32 s65, s63
s_cbranch_scc1 fpre_81
fpre_82:
s_mul_i32 s79, s63, 64
s_sub_u32 s79, 32, s79
s_add_u32 s35, s79, 11
lw_83:
ds_read_b32 v5, v2 offset:16
s_waitcnt lgkmcnt(0)
v_cmp_gt_i32 vcc, s35, v5
s_cbranch_vccz lwd_84
s_sleep 4
s_sub_u32 s32, s32, 1
s_cmp_gt_i32 s32, 0
s_cbranch_scc1 lw_83
lwd_84:
poll_85:
buffer_load_dword v52, v6, s[24:27], s76 offen sc1
buffer_load_dwordx4 v[24:27], v4, s[24:27], s72 offen offset:0 sc1
buffer_load_dwordx4 v[28:31], v4, s[24:27], s72 offen offset:1024 sc1
buffer_load_dwordx4 v[32:35], v4, s[24:27], s72 offen offset:2048 sc1
buffer_load_dwordx4 v[36:39], v4, s[24:27], s72 offen offset:3072 sc1
buffer_load_dwordx4 v[40:43], v4, s[24:27], s73 offen offset:0 sc1
buffer_load_dwordx4 v[44:47], v4, s[24:27], s73 offen offset:1024 sc1
buffer_load_dwordx4 v[48:51], v4, s[24:27], s73 offen offset:2048 sc1
pchk_86:
s_waitcnt vmcnt(6)
v_min3_u32 v5, v24, v25, v26
s_waitcnt vmcnt(5)
v_min3_u32 v5, v5, v27, v28
v_min3_u32 v5, v5, v29, v30
s_waitcnt vmcnt(4)
v_min3_u32 v5, v5, v31, v32
v_min3_u32 v5, v5, v33, v34
s_waitcnt vmcnt(3)
v_min3_u32 v5, v5, v35, v36
v_min3_u32 v5, v5, v37, v38
s_waitcnt vmcnt(2)
v_min3_u32 v5, v5, v39, v40
v_min3_u32 v5, v5, v41, v42
s_waitcnt vmcnt(1)
v_min3_u32 v5, v5, v43, v44
v_min3_u32 v5, v5, v45, v46
s_waitcnt vmcnt(0)
v_min3_u32 v5, v5, v47, v48
v_min3_u32 v5, v5, v49, v50
v_min3_u32 v5, v5, v51, v52
v_cmp_eq_u32 vcc, 0, v5
s_cbranch_vccz pdone_87
s_sub_u32 s32, s32, 1
s_cmp_gt_i32 s32, 0
s_cbranch_scc1 poll_85
pdone_87:
v_add_f32 v24, v24, v40
v_add_f32 v25, v25, v41
v_add_f32 v26, v26, v42
v_add_f32 v27, v27, v43
v_add_f32 v28, v28, v44
v_add_f32 v29, v29, v45
v_add_f32 v30, v30, v46
v_add_f32 v31, v31, v47
v_add_f32 v32, v32, v48
v_add_f32 v33, v33, v49
v_add_f32 v34, v34, v50
v_add_f32 v35, v35, v51
v_add_f32 v24, v24, v32
v_add_f32 v25, v25, v33
v_add_f32 v26, v26, v34
v_add_f32 v27, v27, v35
v_add_f32 v28, v28, v36
v_add_f32 v29, v29, v37
v_add_f32 v30, v30, v38
v_add_f32 v31, v31, v39
v_add_f32 v24, v24, v28
v_add_f32 v25, v25, v29
v_add_f32 v26, v26, v30
v_add_f32 v27, v27, v31
s_nop 0
v_permlane32_swap_b32 v24, v26
v_permlane32_swap_b32 v25, v27
v_add_f32 v24, v24, v26
v_add_f32 v25, v25, v27
s_nop 1
v_permlane16_swap_b32 v24, v25
v_add_f32 v24, v24, v25
v_fma_f32 v24, v24, v12, v52
v_cvt_pk_bf16_f32 v24, v24, v24
s_cmp_eq_u32 s63, 0
s_cbranch_scc1 fl0_80
buffer_store_short v24, v7, s[28:31], s70 offen
s_branch L_end
fl0_80:
ds_write_b16 v8, v24 offset:384
fnr_79:
s_cmp_eq_u32 s63, 0
s_cbranch_scc0 L_end
v_add_u32 v5, s34, 6
s_mov_b64 exec, 1
ds_write_b32 v3, v5
s_mov_b64 exec, -1
v_and_b32 v6, 48, v0
s_add_u32 s35, s34, 6
poll_88:
ds_read_b32 v5, v2 offset:24
ds_read_b128 v[8:11], v6 offset:384
ds_read_b128 v[12:15], v6 offset:448
pchk_89:
s_waitcnt lgkmcnt(2)
v_cmp_gt_i32 vcc, s35, v5
s_cbranch_vccz pdone_90
s_sleep 1
s_sub_u32 s32, s32, 1
s_cmp_gt_i32 s32, 0
s_cbranch_scc1 poll_88
pdone_90:
s_mov_b32 s63, 1
s_mov_b32 s34, 32
s_add_u32 s24, s24, 1409024
s_addc_u32 s25, s25, 0
s_mov_b32 s26, 1409024
s_mov_b32 s70, 131072
s_branch ftop_37
fxt_42:
v_max_u32 v8, 1, v8
v_max_u32 v9, 1, v9
v_max_u32 v10, 1, v10
v_max_u32 v11, 1, v11
v_max_u32 v12, 1, v12
v_max_u32 v13, 1, v13
v_max_u32 v14, 1, v14
v_max_u32 v15, 1, v15
s_mov_b32 exec_lo, 0x10001
s_mov_b32 exec_hi, 0x10001
buffer_store_dwordx4 v[8:11], v7, s[20:23], s73 offen offset:0 sc1
buffer_store_dwordx4 v[12:15], v7, s[20:23], s73 offen offset:64 sc1
s_mov_b64 exec, -1
s_branch fxb_43
fst_40:
s_lshl1_add_u32 s70, s78, s58
s_lshl_b32 s70, s70, 13
v_bfe_u32 v8, v0, 2, 2
v_lshl_add_u32 v8, v8, 9, v7
v_add_u32 v8, v8, v1
v_lshlrev_b32 v8, 2, v8
buffer_load_dwordx4 v[24:27], v8, s[8:11], s70 offen offset:0
buffer_load_dwordx4 v[28:31], v8, s[8:11], s70 offen offset:256
buffer_load_dwordx4 v[32:35], v8, s[8:11], s70 offen offset:512
buffer_load_dwordx4 v[36:39], v8, s[8:11], s70 offen offset:768
buffer_load_dwordx4 v[40:43], v8, s[8:11], s70 offen offset:1024
buffer_load_dwordx4 v[44:47], v8, s[8:11], s70 offen offset:1280
buffer_load_dwordx4 v[48:51], v8, s[8:11], s70 offen offset:1536
buffer_load_dwordx4 v[52:55], v8, s[8:11], s70 offen offset:1792
v_lshlrev_b32 v9, 4, v1
s_waitcnt vmcnt(7)
v_mfma_f32_16x16x32_bf16 v[16:19], v[24:27], v[252:255], 0
v_mfma_f32_16x16x32_bf16 v[20:23], v[24:27], v[24:27], 0
s_waitcnt vmcnt(6)
v_mfma_f32_16x16x32_bf16 v[16:19], v[28:31], v[252:255], v[16:19]
v_mfma_f32_16x16x32_bf16 v[20:23], v[28:31], v[28:31], v[20:23]
s_waitcnt vmcnt(5)
v_mfma_f32_16x16x32_bf16 v[16:19], v[32:35], v[252:255], v[16:19]
v_mfma_f32_16x16x32_bf16 v[20:23], v[32:35], v[32:35], v[20:23]
s_waitcnt vmcnt(4)
v_mfma_f32_16x16x32_bf16 v[16:19], v[36:39], v[252:255], v[16:19]
v_mfma_f32_16x16x32_bf16 v[20:23], v[36:39], v[36:39], v[20:23]
s_waitcnt vmcnt(3)
v_mfma_f32_16x16x32_bf16 v[16:19], v[40:43], v[252:255], v[16:19]
v_mfma_f32_16x16x32_bf16 v[20:23], v[40:43], v[40:43], v[20:23]
s_waitcnt vmcnt(2)
v_mfma_f32_16x16x32_bf16 v[16:19], v[44:47], v[252:255], v[16:19]
v_mfma_f32_16x16x32_bf16 v[20:23], v[44:47], v[44:47], v[20:23]
s_waitcnt vmcnt(1)
v_mfma_f32_16x16x32_bf16 v[16:19], v[48:51], v[252:255], v[16:19]
v_mfma_f32_16x16x32_bf16 v[20:23], v[48:51], v[48:51], v[20:23]
s_waitcnt vmcnt(0)
v_mfma_f32_16x16x32_bf16 v[16:19], v[52:55], v[252:255], v[16:19]
v_mfma_f32_16x16x32_bf16 v[20:23], v[52:55], v[52:55], v[20:23]
s_nop 6
v_add_f32 v16, v16, v18
v_add_f32 v17, v17, v19
v_add_f32 v16, v16, v17
s_nop 0
v_mov_b32_dpp v17, v20 quad_perm:[0,0,0,0] row_mask:0xf bank_mask:0xf
s_nop 1
v_add_f32_dpp v17, v21, v17 quad_perm:[1,1,1,1] row_mask:0xf bank_mask:0xf
s_nop 1
v_add_f32_dpp v17, v22, v17 quad_perm:[2,2,2,2] row_mask:0xf bank_mask:0xf
s_nop 1
v_add_f32_dpp v17, v23, v17 quad_perm:[3,3,3,3] row_mask:0xf bank_mask:0xf
v_mul_f32 v5, 0xba800000, v16
v_mul_f32 v17, 0x3a800000, v17
v_fma_f32 v17, -v5, v5, v17
v_max_f32 v17, 0, v17
v_add_f32 v17, 0x3727c5ac, v17
v_rsq_f32 v16, v17
s_nop 0
v_mul_f32 v17, v5, v16
v_max_u32 v17, 1, v17
s_lshl_b32 s70, s60, 7
s_add_u32 s70, s70, s76
s_lshl_b32 s73, s58, 5
s_add_u32 s70, s70, s73
v_lshrrev_b32 v7, 1, v7
s_add_u32 s35, s34, 5
lw_91:
ds_read_b32 v5, v2 offset:16
s_waitcnt lgkmcnt(0)
v_cmp_gt_i32 vcc, s35, v5
s_cbranch_vccz lwd_92
s_sleep 4
s_sub_u32 s32, s32, 1
s_cmp_gt_i32 s32, 0
s_cbranch_scc1 lw_91
lwd_92:
poll_93:
buffer_load_dword v12, v9, s[4:7], 0 offen sc1
pchk_94:
s_waitcnt vmcnt(0)
v_cmp_gt_u32 vcc, 64, v12
s_cbranch_vccz pdone_95
s_sleep 16
s_sub_u32 s32, s32, 1
s_cmp_gt_i32 s32, 0
s_cbranch_scc1 poll_93
pdone_95:
s_mov_b32 exec_lo, 0x00100001
s_mov_b32 exec_hi, 0x10000100
buffer_store_dwordx2 v[16:17], v7, s[24:27], s70 offen sc1
s_mov_b64 exec, -1
s_branch fsb_41
fg_44:
s_lshl1_add_u32 s35, s2, s58
s_lshl_b32 s35, s35, 12
s_add_u32 s44, s40, s35
s_addc_u32 s45, s41, 0
s_mov_b32 s35, 4
ft_96:
s_load_dwordx2 s[42:43], s[44:45], 60
s_load_dwordx2 s[42:43], s[44:45], 188
s_load_dwordx2 s[42:43], s[44:45], 316
s_load_dwordx2 s[42:43], s[44:45], 444
s_load_dwordx2 s[42:43], s[44:45], 572
s_load_dwordx2 s[42:43], s[44:45], 700
s_load_dwordx2 s[42:43], s[44:45], 828
s_load_dwordx2 s[42:43], s[44:45], 956
s_add_u32 s44, s44, 1024
s_addc_u32 s45, s45, 0
s_sub_u32 s35, s35, 1
s_cmp_eq_u32 s35, 0
s_cbranch_scc0 ft_96
v_lshrrev_b32 v250, 3, v0
v_mul_u32_u24 v250, 16256, v250
v_add_u32 v250, v250, v4
s_add_u32 s35, s66, 131072
buffer_load_dwordx4 v[184:187], v250, s[12:15], s35 offen nt
s_add_u32 s35, s66, 133120
buffer_load_dwordx4 v[188:191], v250, s[12:15], s35 offen nt
s_add_u32 s35, s66, 135168
buffer_load_dwordx4 v[192:195], v250, s[12:15], s35 offen nt
s_add_u32 s35, s66, 137216
buffer_load_dwordx4 v[196:199], v250, s[12:15], s35 offen nt
s_add_u32 s35, s66, 139264
buffer_load_dwordx4 v[200:203], v250, s[12:15], s35 offen nt
s_add_u32 s35, s66, 141312
buffer_load_dwordx4 v[204:207], v250, s[12:15], s35 offen nt
s_add_u32 s35, s66, 143360
buffer_load_dwordx4 v[208:211], v250, s[12:15], s35 offen nt
s_add_u32 s35, s66, 145408
buffer_load_dwordx4 v[212:215], v250, s[12:15], s35 offen nt
v_lshrrev_b32 v250, 3, v0
v_mul_u32_u24 v250, 16256, v250
v_add_u32 v250, v250, v4
s_add_u32 s35, s66, 0
buffer_load_dwordx4 v[152:155], v250, s[12:15], s35 offen nt
s_add_u32 s35, s66, 2048
buffer_load_dwordx4 v[156:159], v250, s[12:15], s35 offen nt
s_add_u32 s35, s66, 4096
buffer_load_dwordx4 v[160:163], v250, s[12:15], s35 offen nt
s_add_u32 s35, s66, 6144
buffer_load_dwordx4 v[164:167], v250, s[12:15], s35 offen nt
s_add_u32 s35, s66, 8192
buffer_load_dwordx4 v[168:171], v250, s[12:15], s35 offen nt
s_add_u32 s35, s66, 10240
buffer_load_dwordx4 v[172:175], v250, s[12:15], s35 offen nt
s_add_u32 s35, s66, 12288
buffer_load_dwordx4 v[176:179], v250, s[12:15], s35 offen nt
s_add_u32 s35, s66, 14336
buffer_load_dwordx4 v[180:183], v250, s[12:15], s35 offen nt
s_add_u32 s35, s34, 10
lw_97:
ds_read_b32 v5, v2 offset:16
s_waitcnt lgkmcnt(0)
v_cmp_gt_i32 vcc, s35, v5
s_cbranch_vccz lwd_98
s_sleep 4
s_sub_u32 s32, s32, 1
s_cmp_gt_i32 s32, 0
s_cbranch_scc1 lw_97
lwd_98:
s_branch fg_45
fnw_53:
v_mov_b32 v252, 0
v_mov_b32 v253, 0
v_mov_b32 v254, 0
v_mov_b32 v255, 0
s_mul_i32 s42, s58, 1409024
s_mul_i32 s35, s78, 2048
s_add_u32 s35, s35, s42
s_add_u32 s35, s35, 524288
buffer_store_dwordx4 v[252:255], v4, s[24:27], s35 offen offset:0 sc1
buffer_store_dwordx4 v[252:255], v4, s[24:27], s35 offen offset:1024 sc1
s_mul_i32 s35, s78, 1408
s_add_u32 s35, s35, s42
s_add_u32 s35, s35, 1048576
buffer_store_dwordx4 v[252:255], v4, s[24:27], s35 offen offset:0 sc1
buffer_store_dwordx4 v[252:255], v4, s[24:27], s35 offen offset:384 sc1
s_lshl_b32 s35, s78, 10
s_add_u32 s35, s35, 1409024
s_cmp_eq_u32 s58, 1
s_cselect_b64 exec, -1, 0
buffer_store_dwordx4 v[252:255], v4, s[24:27], s35 offen offset:0 sc1
s_add_u32 s35, s35, 262144
buffer_store_dwordx4 v[252:255], v4, s[24:27], s35 offen offset:0 sc1
s_mov_b64 exec, -1
s_waitcnt vmcnt(0)
v_add_u32 v5, s34, 3
s_mov_b64 exec, 1
ds_write_b32 v3, v5
s_mov_b64 exec, -1
s_add_u32 s35, s34, 17
lw_99:
ds_read_b32 v5, v2 offset:16
s_waitcnt lgkmcnt(0)
v_cmp_gt_i32 vcc, s35, v5
s_cbranch_vccz lwd_100
s_sleep 4
s_sub_u32 s32, s32, 1
s_cmp_gt_i32 s32, 0
s_cbranch_scc1 lw_99
lwd_100:
v_lshrrev_b32 v250, 4, v0
v_mul_u32_u24 v250, 28416, v250
v_add_u32 v250, v250, v4
s_add_u32 s35, s77, 688128
buffer_load_dwordx4 v[120:123], v250, s[16:19], s35 offen nt
s_add_u32 s35, s77, 695296
buffer_load_dwordx4 v[124:127], v250, s[16:19], s35 offen nt
s_add_u32 s35, s77, 702464
buffer_load_dwordx4 v[128:131], v250, s[16:19], s35 offen nt
s_add_u32 s35, s77, 709632
buffer_load_dwordx4 v[132:135], v250, s[16:19], s35 offen nt
s_add_u32 s35, s77, 802816
buffer_load_dwordx4 v[136:139], v250, s[16:19], s35 offen nt
s_add_u32 s35, s77, 809984
buffer_load_dwordx4 v[140:143], v250, s[16:19], s35 offen nt
s_add_u32 s35, s77, 817152
buffer_load_dwordx4 v[144:147], v250, s[16:19], s35 offen nt
s_add_u32 s35, s77, 824320
buffer_load_dwordx4 v[148:151], v250, s[16:19], s35 offen nt
v_lshrrev_b32 v250, 4, v0
v_mul_u32_u24 v250, 28416, v250
v_add_u32 v250, v250, v4
s_add_u32 s35, s77, 458752
buffer_load_dwordx4 v[88:91], v250, s[16:19], s35 offen nt
s_add_u32 s35, s77, 465920
buffer_load_dwordx4 v[92:95], v250, s[16:19], s35 offen nt
s_add_u32 s35, s77, 473088
buffer_load_dwordx4 v[96:99], v250, s[16:19], s35 offen nt
s_add_u32 s35, s77, 480256
buffer_load_dwordx4 v[100:103], v250, s[16:19], s35 offen nt
s_add_u32 s35, s77, 573440
buffer_load_dwordx4 v[104:107], v250, s[16:19], s35 offen nt
s_add_u32 s35, s77, 580608
buffer_load_dwordx4 v[108:111], v250, s[16:19], s35 offen nt
s_add_u32 s35, s77, 587776
buffer_load_dwordx4 v[112:115], v250, s[16:19], s35 offen nt
s_add_u32 s35, s77, 594944
buffer_load_dwordx4 v[116:119], v250, s[16:19], s35 offen nt
v_lshrrev_b32 v250, 4, v0
v_mul_u32_u24 v250, 28416, v250
v_add_u32 v250, v250, v4
s_add_u32 s35, s77, 229376
buffer_load_dwordx4 v[56:59], v250, s[16:19], s35 offen nt
s_add_u32 s35, s77, 236544
buffer_load_dwordx4 v[60:63], v250, s[16:19], s35 offen nt
s_add_u32 s35, s77, 243712
buffer_load_dwordx4 v[64:67], v250, s[16:19], s35 offen nt
s_add_u32 s35, s77, 250880
buffer_load_dwordx4 v[68:71], v250, s[16:19], s35 offen nt
s_add_u32 s35, s77, 344064
buffer_load_dwordx4 v[72:75], v250, s[16:19], s35 offen nt
s_add_u32 s35, s77, 351232
buffer_load_dwordx4 v[76:79], v250, s[16:19], s35 offen nt
s_add_u32 s35, s77, 358400
buffer_load_dwordx4 v[80:83], v250, s[16:19], s35 offen nt
s_add_u32 s35, s77, 365568
buffer_load_dwordx4 v[84:87], v250, s[16:19], s35 offen nt
v_lshrrev_b32 v250, 4, v0
v_mul_u32_u24 v250, 28416, v250
v_add_u32 v250, v250, v4
s_add_u32 s35, s77, 0
buffer_load_dwordx4 v[24:27], v250, s[16:19], s35 offen nt
s_add_u32 s35, s77, 7168
buffer_load_dwordx4 v[28:31], v250, s[16:19], s35 offen nt
s_add_u32 s35, s77, 14336
buffer_load_dwordx4 v[32:35], v250, s[16:19], s35 offen nt
s_add_u32 s35, s77, 21504
buffer_load_dwordx4 v[36:39], v250, s[16:19], s35 offen nt
s_add_u32 s35, s77, 114688
buffer_load_dwordx4 v[40:43], v250, s[16:19], s35 offen nt
s_add_u32 s35, s77, 121856
buffer_load_dwordx4 v[44:47], v250, s[16:19], s35 offen nt
s_add_u32 s35, s77, 129024
buffer_load_dwordx4 v[48:51], v250, s[16:19], s35 offen nt
s_add_u32 s35, s77, 136192
buffer_load_dwordx4 v[52:55], v250, s[16:19], s35 offen nt
s_mov_b32 s42, 0x05040100
s_mov_b32 s43, 0x07060302
s_cmp_eq_u32 s65, 0
s_cbranch_scc0 fq_101
v_perm_b32 v216, v188, v184, s42
v_perm_b32 v220, v188, v184, s43
v_perm_b32 v224, v189, v185, s42
v_perm_b32 v228, v189, v185, s43
v_perm_b32 v232, v190, v186, s42
v_perm_b32 v236, v190, v186, s43
v_perm_b32 v240, v191, v187, s42
v_perm_b32 v244, v191, v187, s43
v_perm_b32 v217, v196, v192, s42
v_perm_b32 v221, v196, v192, s43
v_perm_b32 v225, v197, v193, s42
v_perm_b32 v229, v197, v193, s43
v_perm_b32 v233, v198, v194, s42
v_perm_b32 v237, v198, v194, s43
v_perm_b32 v241, v199, v195, s42
v_perm_b32 v245, v199, v195, s43
v_perm_b32 v218, v204, v200, s42
v_perm_b32 v222, v204, v200, s43
v_perm_b32 v226, v205, v201, s42
v_perm_b32 v230, v205, v201, s43
v_perm_b32 v234, v206, v202, s42
v_perm_b32 v238, v206, v202, s43
v_perm_b32 v242, v207, v203, s42
v_perm_b32 v246, v207, v203, s43
v_perm_b32 v219, v212, v208, s42
v_perm_b32 v223, v212, v208, s43
v_perm_b32 v227, v213, v209, s42
v_perm_b32 v231, v213, v209, s43
v_perm_b32 v235, v214, v210, s42
v_perm_b32 v239, v214, v210, s43
v_perm_b32 v243, v215, v211, s42
v_perm_b32 v247, v215, v211, s43
v_perm_b32 v184, v156, v152, s42
v_perm_b32 v188, v156, v152, s43
v_perm_b32 v192, v157, v153, s42
v_perm_b32 v196, v157, v153, s43
v_perm_b32 v200, v158, v154, s42
v_perm_b32 v204, v158, v154, s43
v_perm_b32 v208, v159, v155, s42
v_perm_b32 v212, v159, v155, s43
v_perm_b32 v185, v164, v160, s42
v_perm_b32 v189, v164, v160, s43
v_perm_b32 v193, v165, v161, s42
v_perm_b32 v197, v165, v161, s43
v_perm_b32 v201, v166, v162, s42
v_perm_b32 v205, v166, v162, s43
v_perm_b32 v209, v167, v163, s42
v_perm_b32 v213, v167, v163, s43
v_perm_b32 v186, v172, v168, s42
v_perm_b32 v190, v172, v168, s43
v_perm_b32 v194, v173, v169, s42
v_perm_b32 v198, v173, v169, s43
v_perm_b32 v202, v174, v170, s42
v_perm_b32 v206, v174, v170, s43
v_perm_b32 v210, v175, v171, s42
v_perm_b32 v214, v175, v171, s43
v_perm_b32 v187, v180, v176, s42
v_perm_b32 v191, v180, v176, s43
v_perm_b32 v195, v181, v177, s42
v_perm_b32 v199, v181, v177, s43
v_perm_b32 v203, v182, v178, s42
v_perm_b32 v207, v182, v178, s43
v_perm_b32 v211, v183, v179, s42
v_perm_b32 v215, v183, v179, s43
s_waitcnt vmcnt(30)
v_perm_b32 v152, v124, v120, s42
v_perm_b32 v156, v124, v120, s43
v_perm_b32 v160, v125, v121, s42
v_perm_b32 v164, v125, v121, s43
v_perm_b32 v168, v126, v122, s42
v_perm_b32 v172, v126, v122, s43
v_perm_b32 v176, v127, v123, s42
v_perm_b32 v180, v127, v123, s43
s_waitcnt vmcnt(28)
v_perm_b32 v153, v132, v128, s42
v_perm_b32 v157, v132, v128, s43
v_perm_b32 v161, v133, v129, s42
v_perm_b32 v165, v133, v129, s43
v_perm_b32 v169, v134, v130, s42
v_perm_b32 v173, v134, v130, s43
v_perm_b32 v177, v135, v131, s42
v_perm_b32 v181, v135, v131, s43
s_waitcnt vmcnt(26)
v_perm_b32 v154, v140, v136, s42
v_perm_b32 v158, v140, v136, s43
v_perm_b32 v162, v141, v137, s42
v_perm_b32 v166, v141, v137, s43
v_perm_b32 v170, v142, v138, s42
v_perm_b32 v174, v142, v138, s43
v_perm_b32 v178, v143, v139, s42
v_perm_b32 v182, v143, v139, s43
s_waitcnt vmcnt(24)
v_perm_b32 v155, v148, v144, s42
v_perm_b32 v159, v148, v144, s43
v_perm_b32 v163, v149, v145, s42
v_perm_b32 v167, v149, v145, s43
v_perm_b32 v171, v150, v146, s42
v_perm_b32 v175, v150, v146, s43
v_perm_b32 v179, v151, v147, s42
v_perm_b32 v183, v151, v147, s43
s_waitcnt vmcnt(22)
v_perm_b32 v120, v92, v88, s42
v_perm_b32 v124, v92, v88, s43
v_perm_b32 v128, v93, v89, s42
v_perm_b32 v132, v93, v89, s43
v_perm_b32 v136, v94, v90, s42
v_perm_b32 v140, v94, v90, s43
v_perm_b32 v144, v95, v91, s42
v_perm_b32 v148, v95, v91, s43
s_waitcnt vmcnt(20)
v_perm_b32 v121, v100, v96, s42
v_perm_b32 v125, v100, v96, s43
v_perm_b32 v129, v101, v97, s42
v_perm_b32 v133, v101, v97, s43
v_perm_b32 v137, v102, v98, s42
v_perm_b32 v141, v102, v98, s43
v_perm_b32 v145, v103, v99, s42
v_perm_b32 v149, v103, v99, s43
s_waitcnt vmcnt(18)
v_perm_b32 v122, v108, v104, s42
v_perm_b32 v126, v108, v104, s43
v_perm_b32 v130, v109, v105, s42
v_perm_b32 v134, v109, v105, s43
v_perm_b32 v138, v110, v106, s42
v_perm_b32 v142, v110, v106, s43
v_perm_b32 v146, v111, v107, s42
v_perm_b32 v150, v111, v107, s43
s_waitcnt vmcnt(16)
v_perm_b32 v123, v116, v112, s42
v_perm_b32 v127, v116, v112, s43
v_perm_b32 v131, v117, v113, s42
v_perm_b32 v135, v117, v113, s43
v_perm_b32 v139, v118, v114, s42
v_perm_b32 v143, v118, v114, s43
v_perm_b32 v147, v119, v115, s42
v_perm_b32 v151, v119, v115, s43
s_waitcnt vmcnt(14)
v_perm_b32 v88, v60, v56, s42
v_perm_b32 v92, v60, v56, s43
v_perm_b32 v96, v61, v57, s42
v_perm_b32 v100, v61, v57, s43
v_perm_b32 v104, v62, v58, s42
v_perm_b32 v108, v62, v58, s43
v_perm_b32 v112, v63, v59, s42
v_perm_b32 v116, v63, v59, s43
s_waitcnt vmcnt(12)
v_perm_b32 v89, v68, v64, s42
v_perm_b32 v93, v68, v64, s43
v_perm_b32 v97, v69, v65, s42
v_perm_b32 v101, v69, v65, s43
v_perm_b32 v105, v70, v66, s42
v_perm_b32 v109, v70, v66, s43
v_perm_b32 v113, v71, v67, s42
v_perm_b32 v117, v71, v67, s43
s_waitcnt vmcnt(10)
v_perm_b32 v90, v76, v72, s42
v_perm_b32 v94, v76, v72, s43
v_perm_b32 v98, v77, v73, s42
v_perm_b32 v102, v77, v73, s43
v_perm_b32 v106, v78, v74, s42
v_perm_b32 v110, v78, v74, s43
v_perm_b32 v114, v79, v75, s42
v_perm_b32 v118, v79, v75, s43
s_waitcnt vmcnt(8)
v_perm_b32 v91, v84, v80, s42
v_perm_b32 v95, v84, v80, s43
v_perm_b32 v99, v85, v81, s42
v_perm_b32 v103, v85, v81, s43
v_perm_b32 v107, v86, v82, s42
v_perm_b32 v111, v86, v82, s43
v_perm_b32 v115, v87, v83, s42
v_perm_b32 v119, v87, v83, s43
s_waitcnt vmcnt(6)
v_perm_b32 v56, v28, v24, s42
v_perm_b32 v60, v28, v24, s43
v_perm_b32 v64, v29, v25, s42
v_perm_b32 v68, v29, v25, s43
v_perm_b32 v72, v30, v26, s42
v_perm_b32 v76, v30, v26, s43
v_perm_b32 v80, v31, v27, s42
v_perm_b32 v84, v31, v27, s43
s_waitcnt vmcnt(4)
v_perm_b32 v57, v36, v32, s42
v_perm_b32 v61, v36, v32, s43
v_perm_b32 v65, v37, v33, s42
v_perm_b32 v69, v37, v33, s43
v_perm_b32 v73, v38, v34, s42
v_perm_b32 v77, v38, v34, s43
v_perm_b32 v81, v39, v35, s42
v_perm_b32 v85, v39, v35, s43
s_waitcnt vmcnt(2)
v_perm_b32 v58, v44, v40, s42
v_perm_b32 v62, v44, v40, s43
v_perm_b32 v66, v45, v41, s42
v_perm_b32 v70, v45, v41, s43
v_perm_b32 v74, v46, v42, s42
v_perm_b32 v78, v46, v42, s43
v_perm_b32 v82, v47, v43, s42
v_perm_b32 v86, v47, v43, s43
s_waitcnt vmcnt(0)
v_perm_b32 v59, v52, v48, s42
v_perm_b32 v63, v52, v48, s43
v_perm_b32 v67, v53, v49, s42
v_perm_b32 v71, v53, v49, s43
v_perm_b32 v75, v54, v50, s42
v_perm_b32 v79, v54, v50, s43
v_perm_b32 v83, v55, v51, s42
v_perm_b32 v87, v55, v51, s43
fq_101:
s_branch fnw_54
fnd_62:
poll_102:
buffer_load_dwordx2 v[248:249], v6, s[24:27], s73 offen sc1
pchk_103:
s_waitcnt vmcnt(0)
v_min_u32 v5, v248, v249
v_cmp_eq_u32 vcc, 0, v5
s_cbranch_vccz pdone_104
s_sleep 1
s_sub_u32 s32, s32, 1
s_cmp_gt_i32 s32, 0
s_cbranch_scc1 poll_102
pdone_104:
v_mov_b32 v250, v248
s_nop 1
v_max_f32_dpp v250, v250, v250 row_ror:1 row_mask:0xf bank_mask:0xf
s_nop 1
v_max_f32_dpp v250, v250, v250 row_ror:2 row_mask:0xf bank_mask:0xf
s_nop 1
v_max_f32_dpp v250, v250, v250 row_ror:4 row_mask:0xf bank_mask:0xf
s_nop 1
v_max_f32_dpp v250, v250, v250 row_ror:8 row_mask:0xf bank_mask:0xf
v_cmp_eq_f32 vcc, v250, v248
s_ff1_i32_b64 s68, vcc
s_and_b32 s68, s68, 15
v_readlane_b32 s33, v249, s68
v_readlane_b32 s67, v248, s68
v_add_u32 v5, s34, 4
v_mov_b32 v250, s33
s_mov_b64 exec, 1
ds_write2_b32 v3, v5, v250 offset1:2
s_mov_b64 exec, -1
s_sub_u32 s33, s33, 1
s_and_b32 s33, s33, 2047
s_branch fnd_61
fpre_81:
poll_105:
buffer_load_dwordx4 v[24:27], v4, s[24:27], s72 offen offset:0 sc1
pchk_106:
s_waitcnt vmcnt(0)
v_min3_u32 v5, v24, v25, v26
v_min_u32 v5, v5, v27
v_cmp_eq_u32 vcc, 0, v5
s_cbranch_vccz pdone_107
s_sleep 8
s_sub_u32 s32, s32, 1
s_cmp_gt_i32 s32, 0
s_cbranch_scc1 poll_105
pdone_107:
s_branch fpre_82
L_m:
s_setprio 2
v_mov_b32 v6, 0
v_mov_b32 v7, 0
v_lshlrev_b32 v8, 3, v0
ds_write_b64 v8, v[6:7]
s_waitcnt lgkmcnt(0)
s_barrier
s_lshr_b32 s64, s58, 1
s_and_b32 s65, s58, 1
v_and_b32 v1, 3, v0
v_lshlrev_b32 v1, 2, v1
v_and_b32 v2, 4, v1
s_lshl2_add_u32 s35, s58, 0
v_mov_b32 v3, s35
s_mov_b32 s4, s44
s_mov_b32 s5, s45
s_mov_b32 s6, 0x800
s_mov_b32 s7, 0x00020000
v_lshrrev_b32 v6, 4, v0
v_lshlrev_b32 v6, 3, v6
s_lshl_b32 s66, s62, 7
buffer_load_dwordx2 v[232:233], v6, s[4:7], s66 offen offset:0
buffer_load_dwordx2 v[234:235], v6, s[4:7], s66 offen offset:32
buffer_load_dwordx2 v[236:237], v6, s[4:7], s66 offen offset:64
buffer_load_dwordx2 v[238:239], v6, s[4:7], s66 offen offset:96
v_and_b32 v6, 31, v0
v_lshrrev_b32 v7, 5, v0
v_lshlrev_b32 v7, 3, v7
v_sub_u32 v6, v6, v7
v_mov_b32 v7, 0xf149f2ca
v_cmp_le_i32 vcc, 0, v6
s_nop 1
v_cndmask_b32 v216, 0, v7, vcc
v_cmp_le_i32 vcc, 1, v6
s_nop 1
v_cndmask_b32 v217, 0, v7, vcc
v_cmp_le_i32 vcc, 2, v6
s_nop 1
v_cndmask_b32 v218, 0, v7, vcc
v_cmp_le_i32 vcc, 3, v6
s_nop 1
v_cndmask_b32 v219, 0, v7, vcc
v_cmp_le_i32 vcc, 16, v6
s_nop 1
v_cndmask_b32 v220, 0, v7, vcc
v_cmp_le_i32 vcc, 17, v6
s_nop 1
v_cndmask_b32 v221, 0, v7, vcc
v_cmp_le_i32 vcc, 18, v6
s_nop 1
v_cndmask_b32 v222, 0, v7, vcc
v_cmp_le_i32 vcc, 19, v6
s_nop 1
v_cndmask_b32 v223, 0, v7, vcc
v_cmp_le_i32 vcc, 4, v6
s_nop 1
v_cndmask_b32 v224, 0, v7, vcc
v_cmp_le_i32 vcc, 5, v6
s_nop 1
v_cndmask_b32 v225, 0, v7, vcc
v_cmp_le_i32 vcc, 6, v6
s_nop 1
v_cndmask_b32 v226, 0, v7, vcc
v_cmp_le_i32 vcc, 7, v6
s_nop 1
v_cndmask_b32 v227, 0, v7, vcc
v_cmp_le_i32 vcc, 20, v6
s_nop 1
v_cndmask_b32 v228, 0, v7, vcc
v_cmp_le_i32 vcc, 21, v6
s_nop 1
v_cndmask_b32 v229, 0, v7, vcc
v_cmp_le_i32 vcc, 22, v6
s_nop 1
v_cndmask_b32 v230, 0, v7, vcc
v_cmp_le_i32 vcc, 23, v6
s_nop 1
v_cndmask_b32 v231, 0, v7, vcc
v_lshrrev_b32 v6, 2, v0
v_xor_b32 v6, v6, v0
v_and_b32 v6, 4, v6
v_mov_b32 v7, 0x3f803f80
v_cmp_eq_u32 vcc, 0, v6
s_nop 1
v_cndmask_b32 v212, 0, v7, vcc
v_cndmask_b32 v213, 0, v7, vcc
v_cndmask_b32 v214, 0, v7, vcc
v_cndmask_b32 v215, 0, v7, vcc
L_mtop:
v_lshrrev_b32 v10, 4, v0
s_cmp_eq_u32 s63, 0
s_cbranch_scc0 mq_108
v_bfe_u32 v11, v0, 1, 3
v_xor_b32 v11, v11, v10
v_lshlrev_b32 v11, 4, v11
v_and_b32 v12, 15, v0
v_lshl_add_u32 v6, v12, 7, v11
v_xor_b32 v7, 64, v6
s_branch mq_109
mq_108:
v_lshlrev_b32 v6, 4, v0
v_add_u32 v7, 1024, v6
mq_109:
s_lshl_b32 s66, s65, 13
s_add_u32 s66, s66, 86016
v_add_u32 v6, s66, v6
v_add_u32 v7, s66, v7
v_bfe_u32 v11, v0, 2, 2
v_lshl_add_u32 v11, v10, 3, v11
v_bfe_u32 v12, v0, 3, 2
s_lshl_b32 s66, s64, 1
v_xor_b32 v12, s66, v12
v_lshlrev_b32 v12, 5, v12
v_lshl_add_u32 v11, v11, 7, v12
v_and_b32 v12, 3, v0
v_lshl_add_u32 v11, v12, 3, v11
v_add_u32 v8, 102400, v11
v_xor_b32 v9, 32, v8
v_mov_b32 v11, 0xf149f2ca
v_xor_b32 v216, v11, v216
v_xor_b32 v217, v11, v217
v_xor_b32 v218, v11, v218
v_xor_b32 v219, v11, v219
v_xor_b32 v220, v11, v220
v_xor_b32 v221, v11, v221
v_xor_b32 v222, v11, v222
v_xor_b32 v223, v11, v223
v_xor_b32 v224, v11, v224
v_xor_b32 v225, v11, v225
v_xor_b32 v226, v11, v226
v_xor_b32 v227, v11, v227
v_xor_b32 v228, v11, v228
v_xor_b32 v229, v11, v229
v_xor_b32 v230, v11, v230
v_xor_b32 v231, v11, v231
v_mov_b32 v16, 0
v_mov_b32 v17, 0
v_mov_b32 v18, 0
v_mov_b32 v19, 0
v_mov_b32 v20, 0
v_mov_b32 v21, 0
v_mov_b32 v22, 0
v_mov_b32 v23, 0
v_mov_b32 v24, 0
v_mov_b32 v25, 0
v_mov_b32 v26, 0
v_mov_b32 v27, 0
v_mov_b32 v28, 0
v_mov_b32 v29, 0
v_mov_b32 v30, 0
v_mov_b32 v31, 0
v_mov_b32 v32, 0
v_mov_b32 v33, 0
v_mov_b32 v34, 0
v_mov_b32 v35, 0
v_mov_b32 v36, 0
v_mov_b32 v37, 0
v_mov_b32 v38, 0
v_mov_b32 v39, 0
v_mov_b32 v40, 0
v_mov_b32 v41, 0
v_mov_b32 v42, 0
v_mov_b32 v43, 0
v_mov_b32 v44, 0
v_mov_b32 v45, 0
v_mov_b32 v46, 0
v_mov_b32 v47, 0
v_mov_b32 v48, 0
v_mov_b32 v49, 0
v_mov_b32 v50, 0
v_mov_b32 v51, 0
v_mov_b32 v52, 0
v_mov_b32 v53, 0
v_mov_b32 v54, 0
v_mov_b32 v55, 0
v_mov_b32 v56, 0
v_mov_b32 v57, 0
v_mov_b32 v58, 0
v_mov_b32 v59, 0
v_mov_b32 v60, 0
v_mov_b32 v61, 0
v_mov_b32 v62, 0
v_mov_b32 v63, 0
v_mov_b32 v64, 0
v_mov_b32 v65, 0
v_mov_b32 v66, 0
v_mov_b32 v67, 0
v_mov_b32 v68, 0
v_mov_b32 v69, 0
v_mov_b32 v70, 0
v_mov_b32 v71, 0
v_mov_b32 v72, 0
v_mov_b32 v73, 0
v_mov_b32 v74, 0
v_mov_b32 v75, 0
v_mov_b32 v76, 0
v_mov_b32 v77, 0
v_mov_b32 v78, 0
v_mov_b32 v79, 0
v_mov_b32 v80, 0
v_mov_b32 v81, 0
v_mov_b32 v82, 0
v_mov_b32 v83, 0
v_mov_b32 v84, 0
v_mov_b32 v85, 0
v_mov_b32 v86, 0
v_mov_b32 v87, 0
v_mov_b32 v88, 0
v_mov_b32 v89, 0
v_mov_b32 v90, 0
v_mov_b32 v91, 0
v_mov_b32 v92, 0
v_mov_b32 v93, 0
v_mov_b32 v94, 0
v_mov_b32 v95, 0
v_mov_b32 v96, 0
v_mov_b32 v97, 0
v_mov_b32 v98, 0
v_mov_b32 v99, 0
v_mov_b32 v100, 0
v_mov_b32 v101, 0
v_mov_b32 v102, 0
v_mov_b32 v103, 0
v_mov_b32 v104, 0
v_mov_b32 v105, 0
v_mov_b32 v106, 0
v_mov_b32 v107, 0
v_mov_b32 v108, 0
v_mov_b32 v109, 0
v_mov_b32 v110, 0
v_mov_b32 v111, 0
v_mov_b32 v192, 0
v_mov_b32 v193, 0
v_mov_b32 v194, 0
v_mov_b32 v195, 0
v_mov_b32 v196, 0
v_mov_b32 v197, 0
v_mov_b32 v198, 0
v_mov_b32 v199, 0
v_mov_b32 v200, 0
v_mov_b32 v201, 0
v_mov_b32 v202, 0
v_mov_b32 v203, 0
v_mov_b32 v204, 0
v_mov_b32 v205, 0
v_mov_b32 v206, 0
v_mov_b32 v207, 0
v_mov_b32 v208, 0
v_mov_b32 v209, 0
v_mov_b32 v210, 0
v_mov_b32 v211, 0
v_add_u32 v4, s34, 1
s_mov_b32 s66, 16
s_mov_b32 s67, -40960
s_mov_b32 s68, -40960
s_mov_b32 s69, 81920
s_add_u32 s35, s34, 1
lw_110:
ds_read_b32 v5, v2 offset:16
s_waitcnt lgkmcnt(0)
v_cmp_gt_i32 vcc, s35, v5
s_cbranch_vccz lwd_111
s_sub_u32 s32, s32, 1
s_cmp_gt_i32 s32, 0
s_cbranch_scc1 lw_110
lwd_111:
ds_read_b64_tr_b16 v[144:145], v8 offset:8192
ds_read_b64_tr_b16 v[146:147], v8 offset:8704
ds_read_b64_tr_b16 v[148:149], v8 offset:12288
ds_read_b64_tr_b16 v[150:151], v8 offset:12800
ds_read_b128 v[112:115], v6 offset:0
ds_read_b128 v[116:119], v7 offset:0
ds_read_b64_tr_b16 v[152:153], v9 offset:8192
ds_read_b64_tr_b16 v[154:155], v9 offset:8704
ds_read_b64_tr_b16 v[156:157], v9 offset:12288
ds_read_b64_tr_b16 v[158:159], v9 offset:12800
ds_read_b128 v[120:123], v6 offset:2048
ds_read_b128 v[124:127], v7 offset:2048
ds_read_b128 v[128:131], v6 offset:4096
ds_read_b128 v[132:135], v7 offset:4096
ds_read_b128 v[136:139], v6 offset:6144
ds_read_b128 v[140:143], v7 offset:6144
.p2align 6
mqkv_112:
s_waitcnt lgkmcnt(7)
v_mfma_f32_16x16x32_bf16 v[16:19], v[144:147], v[112:115], v[16:19]
ds_read_b64_tr_b16 v[160:161], v8 offset:16384
s_waitcnt lgkmcnt(7)
v_mfma_f32_16x16x32_bf16 v[16:19], v[148:151], v[116:119], v[16:19]
ds_read_b64_tr_b16 v[162:163], v8 offset:16896
v_mfma_f32_16x16x32_bf16 v[20:23], v[152:155], v[112:115], v[20:23]
ds_read_b64_tr_b16 v[164:165], v8 offset:20480
v_mfma_f32_16x16x32_bf16 v[20:23], v[156:159], v[116:119], v[20:23]
ds_read_b64_tr_b16 v[166:167], v8 offset:20992
s_waitcnt lgkmcnt(9)
v_mfma_f32_16x16x32_bf16 v[24:27], v[144:147], v[120:123], v[24:27]
ds_read_b64_tr_b16 v[168:169], v9 offset:16384
s_waitcnt lgkmcnt(9)
v_mfma_f32_16x16x32_bf16 v[24:27], v[148:151], v[124:127], v[24:27]
ds_read_b64_tr_b16 v[170:171], v9 offset:16896
v_mfma_f32_16x16x32_bf16 v[28:31], v[152:155], v[120:123], v[28:31]
ds_read_b64_tr_b16 v[172:173], v9 offset:20480
v_mfma_f32_16x16x32_bf16 v[28:31], v[156:159], v[124:127], v[28:31]
ds_read_b64_tr_b16 v[174:175], v9 offset:20992
s_waitcnt lgkmcnt(11)
v_mfma_f32_16x16x32_bf16 v[32:35], v[144:147], v[128:131], v[32:35]
ds_read_b64_tr_b16 v[176:177], v8 offset:0
s_waitcnt lgkmcnt(11)
v_mfma_f32_16x16x32_bf16 v[32:35], v[148:151], v[132:135], v[32:35]
ds_read_b64_tr_b16 v[178:179], v8 offset:512
v_mfma_f32_16x16x32_bf16 v[36:39], v[152:155], v[128:131], v[36:39]
ds_read_b64_tr_b16 v[180:181], v8 offset:4096
v_mfma_f32_16x16x32_bf16 v[36:39], v[156:159], v[132:135], v[36:39]
ds_read_b64_tr_b16 v[182:183], v8 offset:4608
s_waitcnt lgkmcnt(13)
v_mfma_f32_16x16x32_bf16 v[40:43], v[144:147], v[136:139], v[40:43]
ds_read_b64_tr_b16 v[184:185], v9 offset:0
s_waitcnt lgkmcnt(13)
v_mfma_f32_16x16x32_bf16 v[40:43], v[148:151], v[140:143], v[40:43]
ds_read_b64_tr_b16 v[186:187], v9 offset:512
v_mfma_f32_16x16x32_bf16 v[44:47], v[152:155], v[136:139], v[44:47]
ds_read_b64_tr_b16 v[188:189], v9 offset:4096
v_mfma_f32_16x16x32_bf16 v[44:47], v[156:159], v[140:143], v[44:47]
ds_read_b64_tr_b16 v[190:191], v9 offset:4608
s_waitcnt lgkmcnt(14)
v_mfma_f32_16x16x32_bf16 v[48:51], v[112:115], v[160:163], v[48:51]
s_mov_b64 exec, 1
ds_write_b32 v3, v4
s_mov_b64 exec, -1
s_waitcnt lgkmcnt(13)
v_mfma_f32_16x16x32_bf16 v[48:51], v[116:119], v[164:167], v[48:51]
v_add_u32 v8, s67, v8
v_add_u32 v9, s67, v9
s_waitcnt lgkmcnt(11)
v_mfma_f32_16x16x32_bf16 v[52:55], v[112:115], v[168:171], v[52:55]
v_add_u32 v6, s67, v6
v_add_u32 v7, s67, v7
s_waitcnt lgkmcnt(9)
v_mfma_f32_16x16x32_bf16 v[52:55], v[116:119], v[172:175], v[52:55]
s_mov_b32 s70, s67
s_mov_b32 s67, s68
s_mov_b32 s68, s69
s_mov_b32 s69, s70
v_mfma_f32_16x16x32_bf16 v[56:59], v[120:123], v[160:163], v[56:59]
ds_read_b32 v5, v2 offset:16
v_mfma_f32_16x16x32_bf16 v[56:59], v[124:127], v[164:167], v[56:59]
v_mfma_f32_16x16x32_bf16 v[60:63], v[120:123], v[168:171], v[60:63]
v_mfma_f32_16x16x32_bf16 v[60:63], v[124:127], v[172:175], v[60:63]
v_mfma_f32_16x16x32_bf16 v[64:67], v[128:131], v[160:163], v[64:67]
s_waitcnt lgkmcnt(0)
v_cmp_ge_u32 vcc, v4, v5
s_cbranch_vccnz mspin_113
mback_114:
v_add_u32 v4, 1, v4
v_mfma_f32_16x16x32_bf16 v[64:67], v[132:135], v[164:167], v[64:67]
ds_read_b64_tr_b16 v[144:145], v8 offset:8192
v_mfma_f32_16x16x32_bf16 v[68:71], v[128:131], v[168:171], v[68:71]
ds_read_b64_tr_b16 v[146:147], v8 offset:8704
v_mfma_f32_16x16x32_bf16 v[68:71], v[132:135], v[172:175], v[68:71]
ds_read_b64_tr_b16 v[148:149], v8 offset:12288
v_mfma_f32_16x16x32_bf16 v[72:75], v[136:139], v[160:163], v[72:75]
ds_read_b64_tr_b16 v[150:151], v8 offset:12800
v_mfma_f32_16x16x32_bf16 v[72:75], v[140:143], v[164:167], v[72:75]
ds_read_b64_tr_b16 v[152:153], v9 offset:8192
v_mfma_f32_16x16x32_bf16 v[76:79], v[136:139], v[168:171], v[76:79]
ds_read_b64_tr_b16 v[154:155], v9 offset:8704
v_mfma_f32_16x16x32_bf16 v[76:79], v[140:143], v[172:175], v[76:79]
ds_read_b64_tr_b16 v[156:157], v9 offset:12288
v_mfma_f32_16x16x32_bf16 v[80:83], v[176:179], v[112:115], v[80:83]
ds_read_b64_tr_b16 v[158:159], v9 offset:12800
v_mfma_f32_16x16x32_bf16 v[80:83], v[180:183], v[116:119], v[80:83]
v_mfma_f32_16x16x32_bf16 v[84:87], v[184:187], v[112:115], v[84:87]
v_mfma_f32_16x16x32_bf16 v[84:87], v[188:191], v[116:119], v[84:87]
ds_read_b128 v[112:115], v6 offset:0
ds_read_b128 v[116:119], v7 offset:0
v_mfma_f32_16x16x32_bf16 v[88:91], v[176:179], v[120:123], v[88:91]
v_mfma_f32_16x16x32_bf16 v[88:91], v[180:183], v[124:127], v[88:91]
v_mfma_f32_16x16x32_bf16 v[92:95], v[184:187], v[120:123], v[92:95]
v_mfma_f32_16x16x32_bf16 v[92:95], v[188:191], v[124:127], v[92:95]
ds_read_b128 v[120:123], v6 offset:2048
ds_read_b128 v[124:127], v7 offset:2048
v_mfma_f32_16x16x32_bf16 v[96:99], v[176:179], v[128:131], v[96:99]
v_mfma_f32_16x16x32_bf16 v[96:99], v[180:183], v[132:135], v[96:99]
v_mfma_f32_16x16x32_bf16 v[100:103], v[184:187], v[128:131], v[100:103]
v_mfma_f32_16x16x32_bf16 v[100:103], v[188:191], v[132:135], v[100:103]
ds_read_b128 v[128:131], v6 offset:4096
ds_read_b128 v[132:135], v7 offset:4096
v_mfma_f32_16x16x32_bf16 v[104:107], v[176:179], v[136:139], v[104:107]
v_mfma_f32_16x16x32_bf16 v[104:107], v[180:183], v[140:143], v[104:107]
s_sub_u32 s66, s66, 1
s_cmp_eq_u32 s66, 0
v_mfma_f32_16x16x32_bf16 v[108:111], v[184:187], v[136:139], v[108:111]
v_mfma_f32_16x16x32_bf16 v[108:111], v[188:191], v[140:143], v[108:111]
ds_read_b128 v[136:139], v6 offset:6144
ds_read_b128 v[140:143], v7 offset:6144
s_cbranch_scc0 mqkv_112
v_and_b32 v10, 15, v0
v_lshrrev_b32 v11, 4, v0
s_lshl_b32 s66, s65, 8
s_add_u32 s66, s66, 1280
s_mul_i32 s67, s64, 384
v_lshl_add_u32 v6, v10, 2, s66
v_lshl_add_u32 v7, v11, 4, s66
v_lshl_add_u32 v8, v10, 2, s67
v_lshl_add_u32 v9, v11, 4, s67
v_and_b32 v12, 1, v11
v_lshrrev_b32 v11, 1, v11
v_lshlrev_b32 v11, 9, v11
v_lshl_add_u32 v11, v12, 10, v11
s_lshl_b32 s66, s64, 12
s_lshl_b32 s67, s65, 13
s_add_u32 s66, s66, 131072
s_add_u32 s68, s66, 24576
s_sub_u32 s68, s68, s67
s_add_u32 s67, s66, s67
v_lshl_add_u32 v14, v10, 4, v11
v_and_b32 v12, 3, v0
v_lshl_add_u32 v11, v12, 4, v11
v_bfe_u32 v12, v0, 3, 1
v_lshl_add_u32 v11, v12, 6, v11
v_bfe_u32 v12, v0, 2, 1
v_lshl_add_u32 v12, v12, 8, v11
v_add_u32 v13, s68, v12
v_add_u32 v12, s67, v12
v_add_u32 v15, s68, v14
v_add_u32 v14, s67, v14
s_lshl_b32 s66, s59, 4
s_add_u32 s66, s66, s60
s_lshl_b32 s72, s59, 7
s_add_u32 s72, s72, s60
s_lshl_b32 s72, s72, 7
s_lshl_b32 s66, s66, 15
s_lshl_b32 s67, s63, 23
s_add_u32 s66, s66, s67
s_add_u32 s71, s66, 917504
s_add_u32 s35, s34, 2
lw_115:
ds_read_b32 v5, v2 offset:24
s_waitcnt lgkmcnt(0)
v_cmp_gt_i32 vcc, s35, v5
s_cbranch_vccz lwd_116
s_sub_u32 s32, s32, 1
s_cmp_gt_i32 s32, 0
s_cbranch_scc1 lw_115
lwd_116:
v_mov_b32 v10, 0
ds_read_b32 v10, v10 offset:32
ds_read2_b32 v[144:145], v6 offset0:0 offset1:128
ds_read2_b32 v[146:147], v6 offset0:16 offset1:144
ds_read2_b32 v[148:149], v6 offset0:32 offset1:160
ds_read2_b32 v[150:151], v6 offset0:48 offset1:176
ds_read_b128 v[152:155], v9 offset:2432
ds_read_b128 v[156:159], v9 offset:2496
ds_read_b32 v168, v8 offset:2560
ds_read_b32 v169, v8 offset:2624
ds_read_b128 v[112:115], v7 offset:0
ds_read_b128 v[128:131], v7 offset:512
ds_read_b128 v[116:119], v7 offset:64
ds_read_b128 v[132:135], v7 offset:576
s_waitcnt lgkmcnt(12)
v_readfirstlane_b32 s33, v10
s_sub_u32 s33, s33, 1
s_lshr_b32 s66, s33, 7
s_cmp_eq_u32 s66, s59
s_cbranch_scc1 patch_117
pback_118:
s_waitcnt lgkmcnt(11)
v_pk_mul_f32 v[16:17], v[16:17], v[144:145] op_sel:[0,0] op_sel_hi:[1,0]
v_pk_mul_f32 v[18:19], v[18:19], v[144:145] op_sel:[0,0] op_sel_hi:[1,0]
v_pk_mul_f32 v[20:21], v[20:21], v[144:145] op_sel:[0,0] op_sel_hi:[1,0]
v_pk_mul_f32 v[22:23], v[22:23], v[144:145] op_sel:[0,0] op_sel_hi:[1,0]
s_waitcnt lgkmcnt(7)
v_pk_fma_f32 v[16:17], v[152:153], v[144:145], v[16:17] op_sel:[0,1,0] op_sel_hi:[1,1,1]
v_pk_fma_f32 v[18:19], v[154:155], v[144:145], v[18:19] op_sel:[0,1,0] op_sel_hi:[1,1,1]
s_waitcnt lgkmcnt(6)
v_pk_fma_f32 v[20:21], v[156:157], v[144:145], v[20:21] op_sel:[0,1,0] op_sel_hi:[1,1,1]
v_pk_fma_f32 v[22:23], v[158:159], v[144:145], v[22:23] op_sel:[0,1,0] op_sel_hi:[1,1,1]
v_cvt_pk_bf16_f32 v16, v16, v17
v_cvt_pk_bf16_f32 v17, v18, v19
v_cvt_pk_bf16_f32 v18, v20, v21
v_cvt_pk_bf16_f32 v19, v22, v23
buffer_store_dwordx4 v[16:19], v12, s[20:23], s71 offen offset:0 sc1
ds_write_b128 v12, v[16:19] offset:0
ds_read_b128 v[120:123], v7 offset:128
ds_read_b128 v[136:139], v7 offset:640
ds_read_b128 v[124:127], v7 offset:192
ds_read_b128 v[140:143], v7 offset:704
ds_read_b128 v[160:163], v9 offset:2304
ds_read_b128 v[164:167], v9 offset:2368
v_pk_mul_f32 v[24:25], v[24:25], v[146:147] op_sel:[0,0] op_sel_hi:[1,0]
v_pk_mul_f32 v[26:27], v[26:27], v[146:147] op_sel:[0,0] op_sel_hi:[1,0]
v_pk_mul_f32 v[28:29], v[28:29], v[146:147] op_sel:[0,0] op_sel_hi:[1,0]
v_pk_mul_f32 v[30:31], v[30:31], v[146:147] op_sel:[0,0] op_sel_hi:[1,0]
v_pk_fma_f32 v[24:25], v[152:153], v[146:147], v[24:25] op_sel:[0,1,0] op_sel_hi:[1,1,1]
v_pk_fma_f32 v[26:27], v[154:155], v[146:147], v[26:27] op_sel:[0,1,0] op_sel_hi:[1,1,1]
v_pk_fma_f32 v[28:29], v[156:157], v[146:147], v[28:29] op_sel:[0,1,0] op_sel_hi:[1,1,1]
v_pk_fma_f32 v[30:31], v[158:159], v[146:147], v[30:31] op_sel:[0,1,0] op_sel_hi:[1,1,1]
v_cvt_pk_bf16_f32 v24, v24, v25
v_cvt_pk_bf16_f32 v25, v26, v27
v_cvt_pk_bf16_f32 v26, v28, v29
v_cvt_pk_bf16_f32 v27, v30, v31
buffer_store_dwordx4 v[24:27], v12, s[20:23], s71 offen offset:128 sc1
ds_write_b128 v12, v[24:27] offset:128
v_pk_mul_f32 v[32:33], v[32:33], v[148:149] op_sel:[0,0] op_sel_hi:[1,0]
v_pk_mul_f32 v[34:35], v[34:35], v[148:149] op_sel:[0,0] op_sel_hi:[1,0]
v_pk_mul_f32 v[36:37], v[36:37], v[148:149] op_sel:[0,0] op_sel_hi:[1,0]
v_pk_mul_f32 v[38:39], v[38:39], v[148:149] op_sel:[0,0] op_sel_hi:[1,0]
v_pk_fma_f32 v[32:33], v[152:153], v[148:149], v[32:33] op_sel:[0,1,0] op_sel_hi:[1,1,1]
v_pk_fma_f32 v[34:35], v[154:155], v[148:149], v[34:35] op_sel:[0,1,0] op_sel_hi:[1,1,1]
v_pk_fma_f32 v[36:37], v[156:157], v[148:149], v[36:37] op_sel:[0,1,0] op_sel_hi:[1,1,1]
v_pk_fma_f32 v[38:39], v[158:159], v[148:149], v[38:39] op_sel:[0,1,0] op_sel_hi:[1,1,1]
v_cvt_pk_bf16_f32 v32, v32, v33
v_cvt_pk_bf16_f32 v33, v34, v35
v_cvt_pk_bf16_f32 v34, v36, v37
v_cvt_pk_bf16_f32 v35, v38, v39
buffer_store_dwordx4 v[32:35], v13, s[20:23], s71 offen offset:0 sc1
ds_write_b128 v13, v[32:35] offset:0
v_pk_mul_f32 v[40:41], v[40:41], v[150:151] op_sel:[0,0] op_sel_hi:[1,0]
v_pk_mul_f32 v[42:43], v[42:43], v[150:151] op_sel:[0,0] op_sel_hi:[1,0]
v_pk_mul_f32 v[44:45], v[44:45], v[150:151] op_sel:[0,0] op_sel_hi:[1,0]
v_pk_mul_f32 v[46:47], v[46:47], v[150:151] op_sel:[0,0] op_sel_hi:[1,0]
v_pk_fma_f32 v[40:41], v[152:153], v[150:151], v[40:41] op_sel:[0,1,0] op_sel_hi:[1,1,1]
v_pk_fma_f32 v[42:43], v[154:155], v[150:151], v[42:43] op_sel:[0,1,0] op_sel_hi:[1,1,1]
v_pk_fma_f32 v[44:45], v[156:157], v[150:151], v[44:45] op_sel:[0,1,0] op_sel_hi:[1,1,1]
v_pk_fma_f32 v[46:47], v[158:159], v[150:151], v[46:47] op_sel:[0,1,0] op_sel_hi:[1,1,1]
v_cvt_pk_bf16_f32 v40, v40, v41
v_cvt_pk_bf16_f32 v41, v42, v43
v_cvt_pk_bf16_f32 v42, v44, v45
v_cvt_pk_bf16_f32 v43, v46, v47
buffer_store_dwordx4 v[40:43], v13, s[20:23], s71 offen offset:128 sc1
ds_write_b128 v13, v[40:43] offset:128
s_waitcnt lgkmcnt(13)
v_pk_mul_f32 v[48:49], v[48:49], v[112:113]
v_pk_mul_f32 v[50:51], v[50:51], v[114:115]
s_waitcnt lgkmcnt(12)
v_pk_fma_f32 v[48:49], v[128:129], v[168:169], v[48:49] op_sel:[0,0,0] op_sel_hi:[1,0,1]
v_pk_fma_f32 v[50:51], v[130:131], v[168:169], v[50:51] op_sel:[0,0,0] op_sel_hi:[1,0,1]
s_waitcnt lgkmcnt(11)
v_pk_mul_f32 v[56:57], v[56:57], v[116:117]
v_pk_mul_f32 v[58:59], v[58:59], v[118:119]
s_waitcnt lgkmcnt(10)
v_pk_fma_f32 v[56:57], v[132:133], v[168:169], v[56:57] op_sel:[0,0,0] op_sel_hi:[1,0,1]
v_pk_fma_f32 v[58:59], v[134:135], v[168:169], v[58:59] op_sel:[0,0,0] op_sel_hi:[1,0,1]
v_cvt_pk_bf16_f32 v48, v48, v49
v_cvt_pk_bf16_f32 v49, v50, v51
v_cvt_pk_bf16_f32 v50, v56, v57
v_cvt_pk_bf16_f32 v51, v58, v59
buffer_store_dwordx4 v[48:51], v14, s[20:23], s71 offen offset:2048 sc1
ds_write_b128 v14, v[48:51] offset:2048
v_pk_mul_f32 v[52:53], v[52:53], v[112:113]
v_pk_mul_f32 v[54:55], v[54:55], v[114:115]
v_pk_fma_f32 v[52:53], v[128:129], v[168:169], v[52:53] op_sel:[0,1,0] op_sel_hi:[1,1,1]
v_pk_fma_f32 v[54:55], v[130:131], v[168:169], v[54:55] op_sel:[0,1,0] op_sel_hi:[1,1,1]
v_pk_mul_f32 v[60:61], v[60:61], v[116:117]
v_pk_mul_f32 v[62:63], v[62:63], v[118:119]
v_pk_fma_f32 v[60:61], v[132:133], v[168:169], v[60:61] op_sel:[0,1,0] op_sel_hi:[1,1,1]
v_pk_fma_f32 v[62:63], v[134:135], v[168:169], v[62:63] op_sel:[0,1,0] op_sel_hi:[1,1,1]
v_cvt_pk_bf16_f32 v52, v52, v53
v_cvt_pk_bf16_f32 v53, v54, v55
v_cvt_pk_bf16_f32 v54, v60, v61
v_cvt_pk_bf16_f32 v55, v62, v63
buffer_store_dwordx4 v[52:55], v14, s[20:23], s71 offen offset:2304 sc1
ds_write_b128 v14, v[52:55] offset:2304
s_waitcnt lgkmcnt(10)
v_pk_mul_f32 v[64:65], v[64:65], v[120:121]
v_pk_mul_f32 v[66:67], v[66:67], v[122:123]
s_waitcnt lgkmcnt(9)
v_pk_fma_f32 v[64:65], v[136:137], v[168:169], v[64:65] op_sel:[0,0,0] op_sel_hi:[1,0,1]
v_pk_fma_f32 v[66:67], v[138:139], v[168:169], v[66:67] op_sel:[0,0,0] op_sel_hi:[1,0,1]
s_waitcnt lgkmcnt(8)
v_pk_mul_f32 v[72:73], v[72:73], v[124:125]
v_pk_mul_f32 v[74:75], v[74:75], v[126:127]
s_waitcnt lgkmcnt(7)
v_pk_fma_f32 v[72:73], v[140:141], v[168:169], v[72:73] op_sel:[0,0,0] op_sel_hi:[1,0,1]
v_pk_fma_f32 v[74:75], v[142:143], v[168:169], v[74:75] op_sel:[0,0,0] op_sel_hi:[1,0,1]
v_cvt_pk_bf16_f32 v64, v64, v65
v_cvt_pk_bf16_f32 v65, v66, v67
v_cvt_pk_bf16_f32 v66, v72, v73
v_cvt_pk_bf16_f32 v67, v74, v75
buffer_store_dwordx4 v[64:67], v15, s[20:23], s71 offen offset:2048 sc1
ds_write_b128 v15, v[64:67] offset:2048
v_pk_mul_f32 v[68:69], v[68:69], v[120:121]
v_pk_mul_f32 v[70:71], v[70:71], v[122:123]
v_pk_fma_f32 v[68:69], v[136:137], v[168:169], v[68:69] op_sel:[0,1,0] op_sel_hi:[1,1,1]
v_pk_fma_f32 v[70:71], v[138:139], v[168:169], v[70:71] op_sel:[0,1,0] op_sel_hi:[1,1,1]
v_pk_mul_f32 v[76:77], v[76:77], v[124:125]
v_pk_mul_f32 v[78:79], v[78:79], v[126:127]
v_pk_fma_f32 v[76:77], v[140:141], v[168:169], v[76:77] op_sel:[0,1,0] op_sel_hi:[1,1,1]
v_pk_fma_f32 v[78:79], v[142:143], v[168:169], v[78:79] op_sel:[0,1,0] op_sel_hi:[1,1,1]
v_cvt_pk_bf16_f32 v68, v68, v69
v_cvt_pk_bf16_f32 v69, v70, v71
v_cvt_pk_bf16_f32 v70, v76, v77
v_cvt_pk_bf16_f32 v71, v78, v79
buffer_store_dwordx4 v[68:71], v15, s[20:23], s71 offen offset:2304 sc1
ds_write_b128 v15, v[68:71] offset:2304
v_add_u32 v5, s34, 17
s_mov_b64 exec, 1
ds_write_b32 v3, v5
s_mov_b64 exec, -1
s_mov_b32 s66, 0x3e8293ee
v_mul_f32 v144, s66, v144
v_mul_f32 v145, s66, v145
v_mul_f32 v146, s66, v146
v_mul_f32 v147, s66, v147
v_mul_f32 v148, s66, v148
v_mul_f32 v149, s66, v149
v_mul_f32 v150, s66, v150
v_mul_f32 v151, s66, v151
v_pk_mul_f32 v[96:97], v[96:97], v[148:149] op_sel:[0,0] op_sel_hi:[1,0]
v_pk_mul_f32 v[98:99], v[98:99], v[148:149] op_sel:[0,0] op_sel_hi:[1,0]
v_pk_mul_f32 v[100:101], v[100:101], v[148:149] op_sel:[0,0] op_sel_hi:[1,0]
v_pk_mul_f32 v[102:103], v[102:103], v[148:149] op_sel:[0,0] op_sel_hi:[1,0]
s_waitcnt lgkmcnt(9)
v_pk_fma_f32 v[96:97], v[160:161], v[148:149], v[96:97] op_sel:[0,1,0] op_sel_hi:[1,1,1]
v_pk_fma_f32 v[98:99], v[162:163], v[148:149], v[98:99] op_sel:[0,1,0] op_sel_hi:[1,1,1]
s_waitcnt lgkmcnt(8)
v_pk_fma_f32 v[100:101], v[164:165], v[148:149], v[100:101] op_sel:[0,1,0] op_sel_hi:[1,1,1]
v_pk_fma_f32 v[102:103], v[166:167], v[148:149], v[102:103] op_sel:[0,1,0] op_sel_hi:[1,1,1]
v_cvt_pk_bf16_f32 v96, v96, v97
v_cvt_pk_bf16_f32 v97, v98, v99
v_cvt_pk_bf16_f32 v98, v100, v101
v_cvt_pk_bf16_f32 v99, v102, v103
v_pk_mul_f32 v[104:105], v[104:105], v[150:151] op_sel:[0,0] op_sel_hi:[1,0]
v_pk_mul_f32 v[106:107], v[106:107], v[150:151] op_sel:[0,0] op_sel_hi:[1,0]
v_pk_mul_f32 v[108:109], v[108:109], v[150:151] op_sel:[0,0] op_sel_hi:[1,0]
v_pk_mul_f32 v[110:111], v[110:111], v[150:151] op_sel:[0,0] op_sel_hi:[1,0]
v_pk_fma_f32 v[104:105], v[160:161], v[150:151], v[104:105] op_sel:[0,1,0] op_sel_hi:[1,1,1]
v_pk_fma_f32 v[106:107], v[162:163], v[150:151], v[106:107] op_sel:[0,1,0] op_sel_hi:[1,1,1]
v_pk_fma_f32 v[108:109], v[164:165], v[150:151], v[108:109] op_sel:[0,1,0] op_sel_hi:[1,1,1]
v_pk_fma_f32 v[110:111], v[166:167], v[150:151], v[110:111] op_sel:[0,1,0] op_sel_hi:[1,1,1]
v_cvt_pk_bf16_f32 v104, v104, v105
v_cvt_pk_bf16_f32 v105, v106, v107
v_cvt_pk_bf16_f32 v106, v108, v109
v_cvt_pk_bf16_f32 v107, v110, v111
v_pk_mul_f32 v[80:81], v[80:81], v[144:145] op_sel:[0,0] op_sel_hi:[1,0]
v_pk_mul_f32 v[82:83], v[82:83], v[144:145] op_sel:[0,0] op_sel_hi:[1,0]
v_pk_mul_f32 v[84:85], v[84:85], v[144:145] op_sel:[0,0] op_sel_hi:[1,0]
v_pk_mul_f32 v[86:87], v[86:87], v[144:145] op_sel:[0,0] op_sel_hi:[1,0]
v_pk_fma_f32 v[80:81], v[160:161], v[144:145], v[80:81] op_sel:[0,1,0] op_sel_hi:[1,1,1]
v_pk_fma_f32 v[82:83], v[162:163], v[144:145], v[82:83] op_sel:[0,1,0] op_sel_hi:[1,1,1]
v_pk_fma_f32 v[84:85], v[164:165], v[144:145], v[84:85] op_sel:[0,1,0] op_sel_hi:[1,1,1]
v_pk_fma_f32 v[86:87], v[166:167], v[144:145], v[86:87] op_sel:[0,1,0] op_sel_hi:[1,1,1]
v_cvt_pk_bf16_f32 v80, v80, v81
v_cvt_pk_bf16_f32 v81, v82, v83
v_cvt_pk_bf16_f32 v82, v84, v85
v_cvt_pk_bf16_f32 v83, v86, v87
v_pk_mul_f32 v[88:89], v[88:89], v[146:147] op_sel:[0,0] op_sel_hi:[1,0]
v_pk_mul_f32 v[90:91], v[90:91], v[146:147] op_sel:[0,0] op_sel_hi:[1,0]
v_pk_mul_f32 v[92:93], v[92:93], v[146:147] op_sel:[0,0] op_sel_hi:[1,0]
v_pk_mul_f32 v[94:95], v[94:95], v[146:147] op_sel:[0,0] op_sel_hi:[1,0]
v_pk_fma_f32 v[88:89], v[160:161], v[146:147], v[88:89] op_sel:[0,1,0] op_sel_hi:[1,1,1]
v_pk_fma_f32 v[90:91], v[162:163], v[146:147], v[90:91] op_sel:[0,1,0] op_sel_hi:[1,1,1]
v_pk_fma_f32 v[92:93], v[164:165], v[146:147], v[92:93] op_sel:[0,1,0] op_sel_hi:[1,1,1]
v_pk_fma_f32 v[94:95], v[166:167], v[146:147], v[94:95] op_sel:[0,1,0] op_sel_hi:[1,1,1]
v_cvt_pk_bf16_f32 v88, v88, v89
v_cvt_pk_bf16_f32 v89, v90, v91
v_cvt_pk_bf16_f32 v90, v92, v93
v_cvt_pk_bf16_f32 v91, v94, v95
v_permlane16_swap_b32 v96, v104
v_permlane16_swap_b32 v97, v105
v_permlane16_swap_b32 v98, v106
v_permlane16_swap_b32 v99, v107
v_permlane16_swap_b32 v80, v88
v_permlane16_swap_b32 v81, v89
v_permlane16_swap_b32 v82, v90
v_permlane16_swap_b32 v83, v91
s_lshl_b32 s69, s64, 12
v_lshl_add_u32 v6, v0, 4, s69
v_add_u32 v7, 131072, v6
s_lshl_b32 s69, s65, 13
s_add_u32 s66, s69, 131072
s_sub_u32 s69, 147456, s69
v_add_u32 v8, s69, v6
ds_read_b128 v[152:155], v8 offset:8192
ds_read_b128 v[156:159], v8 offset:9216
s_mov_b32 s67, 122880
s_min_u32 s69, s59, 1
s_lshl2_add_u32 s68, s69, s65
s_cmp_ge_u32 s59, 2
s_cselect_b32 s69, s65, 0
s_add_u32 s68, s68, s69
ds_read_b128 v[160:163], v8 offset:10240
ds_read_b128 v[164:167], v8 offset:11264
s_waitcnt lgkmcnt(3)
v_mfma_f32_32x32x16_bf16 v[112:127], v[152:155], v[96:99], v[216:231]
s_waitcnt lgkmcnt(2)
v_mfma_f32_32x32x16_bf16 v[112:127], v[156:159], v[104:107], v[112:127]
s_add_u32 s35, s34, 17
lw_119:
ds_read_b32 v5, v1 offset:0
s_waitcnt lgkmcnt(0)
v_cmp_gt_i32 vcc, s35, v5
s_cbranch_vccz lwd_120
s_sub_u32 s32, s32, 1
s_cmp_gt_i32 s32, 0
s_cbranch_scc1 lw_119
lwd_120:
ds_read_b128 v[152:155], v8 offset:0
ds_read_b128 v[156:159], v8 offset:1024
.p2align 3
s_nop 4
v_exp_f32 v112, v112
v_exp_f32 v113, v113
v_exp_f32 v114, v114
v_exp_f32 v115, v115
v_exp_f32 v116, v116
v_exp_f32 v117, v117
s_waitcnt lgkmcnt(1)
v_mfma_f32_32x32x16_bf16 v[128:143], v[152:155], v[96:99], 0
v_exp_f32 v118, v118
v_exp_f32 v119, v119
v_cvt_pk_bf16_f32 v144, v112, v113
v_cvt_pk_bf16_f32 v145, v114, v115
s_waitcnt lgkmcnt(0)
v_mfma_f32_32x32x16_bf16 v[128:143], v[156:159], v[104:107], v[128:143]
ds_read_b128 v[152:155], v7 offset:8192
ds_read_b128 v[156:159], v7 offset:9216
v_cvt_pk_bf16_f32 v146, v116, v117
v_cvt_pk_bf16_f32 v147, v118, v119
v_exp_f32 v120, v120
v_exp_f32 v121, v121
v_mfma_f32_32x32x16_bf16 v[16:31], v[160:163], v[144:147], 0
ds_read_b128 v[160:163], v8 offset:2048
v_exp_f32 v122, v122
v_exp_f32 v123, v123
v_exp_f32 v124, v124
v_mfma_f32_16x16x32_bf16 v[32:35], v[212:215], v[144:147], 0
s_cmp_eq_u32 s65, 1
v_exp_f32 v125, v125
v_exp_f32 v126, v126
v_exp_f32 v127, v127
v_cvt_pk_bf16_f32 v148, v120, v121
v_cvt_pk_bf16_f32 v149, v122, v123
v_cvt_pk_bf16_f32 v150, v124, v125
v_cvt_pk_bf16_f32 v151, v126, v127
s_cbranch_scc1 at_121
v_exp_f32 v128, v128
v_exp_f32 v129, v129
v_mfma_f32_32x32x16_bf16 v[16:31], v[164:167], v[148:151], v[16:31]
ds_read_b128 v[164:167], v8 offset:3072
v_exp_f32 v130, v130
v_exp_f32 v131, v131
v_exp_f32 v132, v132
v_mfma_f32_16x16x32_bf16 v[32:35], v[212:215], v[148:151], v[32:35]
v_exp_f32 v133, v133
s_waitcnt lgkmcnt(3)
v_mfma_f32_32x32x16_bf16 v[112:127], v[152:155], v[96:99], 0
v_exp_f32 v134, v134
v_exp_f32 v135, v135
v_cvt_pk_bf16_f32 v144, v128, v129
v_cvt_pk_bf16_f32 v145, v130, v131
s_waitcnt lgkmcnt(2)
v_mfma_f32_32x32x16_bf16 v[112:127], v[156:159], v[104:107], v[112:127]
ds_read_b128 v[152:155], v7 offset:0
ds_read_b128 v[156:159], v7 offset:1024
v_cvt_pk_bf16_f32 v146, v132, v133
v_cvt_pk_bf16_f32 v147, v134, v135
v_exp_f32 v136, v136
v_exp_f32 v137, v137
s_waitcnt lgkmcnt(3)
v_mfma_f32_32x32x16_bf16 v[16:31], v[160:163], v[144:147], v[16:31]
ds_read_b128 v[160:163], v7 offset:10240
v_exp_f32 v138, v138
v_exp_f32 v139, v139
v_exp_f32 v140, v140
v_mfma_f32_16x16x32_bf16 v[32:35], v[212:215], v[144:147], v[32:35]
v_exp_f32 v141, v141
v_exp_f32 v142, v142
v_exp_f32 v143, v143
v_cvt_pk_bf16_f32 v148, v136, v137
v_cvt_pk_bf16_f32 v149, v138, v139
v_cvt_pk_bf16_f32 v150, v140, v141
v_cvt_pk_bf16_f32 v151, v142, v143
v_exp_f32 v112, v112
v_exp_f32 v113, v113
s_waitcnt lgkmcnt(3)
v_mfma_f32_32x32x16_bf16 v[16:31], v[164:167], v[148:151], v[16:31]
ds_read_b128 v[164:167], v7 offset:11264
v_exp_f32 v114, v114
v_exp_f32 v115, v115
v_exp_f32 v116, v116
v_mfma_f32_16x16x32_bf16 v[32:35], v[212:215], v[148:151], v[32:35]
v_exp_f32 v117, v117
s_waitcnt lgkmcnt(3)
v_mfma_f32_32x32x16_bf16 v[128:143], v[152:155], v[96:99], 0
v_exp_f32 v118, v118
v_exp_f32 v119, v119
v_cvt_pk_bf16_f32 v144, v112, v113
v_cvt_pk_bf16_f32 v145, v114, v115
s_waitcnt lgkmcnt(2)
v_mfma_f32_32x32x16_bf16 v[128:143], v[156:159], v[104:107], v[128:143]
v_cvt_pk_bf16_f32 v146, v116, v117
v_cvt_pk_bf16_f32 v147, v118, v119
v_exp_f32 v120, v120
v_exp_f32 v121, v121
s_waitcnt lgkmcnt(1)
v_mfma_f32_32x32x16_bf16 v[16:31], v[160:163], v[144:147], v[16:31]
ds_read_b128 v[160:163], v7 offset:2048
v_exp_f32 v122, v122
v_exp_f32 v123, v123
v_exp_f32 v124, v124
v_mfma_f32_16x16x32_bf16 v[32:35], v[212:215], v[144:147], v[32:35]
v_mov_b32 v8, v7
v_exp_f32 v125, v125
v_exp_f32 v126, v126
v_exp_f32 v127, v127
v_cvt_pk_bf16_f32 v148, v120, v121
v_cvt_pk_bf16_f32 v149, v122, v123
v_cvt_pk_bf16_f32 v150, v124, v125
v_cvt_pk_bf16_f32 v151, v126, v127
.p2align 3
at_121:
v_exp_f32 v128, v128
v_exp_f32 v129, v129
s_waitcnt lgkmcnt(1)
v_mfma_f32_32x32x16_bf16 v[16:31], v[164:167], v[148:151], v[16:31]
ds_read_b128 v[164:167], v8 offset:3072
v_exp_f32 v130, v130
v_exp_f32 v131, v131
v_exp_f32 v132, v132
v_mfma_f32_16x16x32_bf16 v[32:35], v[212:215], v[148:151], v[32:35]
v_exp_f32 v133, v133
v_mfma_f32_32x32x16_bf16 v[112:127], v[152:155], v[80:83], v[216:231]
v_exp_f32 v134, v134
v_exp_f32 v135, v135
v_cvt_pk_bf16_f32 v144, v128, v129
v_cvt_pk_bf16_f32 v145, v130, v131
v_mfma_f32_32x32x16_bf16 v[112:127], v[156:159], v[88:91], v[112:127]
s_sub_u32 s66, s66, 8192
s_cmp_eq_u32 s66, s67
s_cbranch_scc1 cross_128
cback_129:
v_add_u32 v8, s66, v6
ds_read_b128 v[152:155], v8 offset:0
ds_read_b128 v[156:159], v8 offset:1024
v_cvt_pk_bf16_f32 v146, v132, v133
v_cvt_pk_bf16_f32 v147, v134, v135
v_exp_f32 v136, v136
v_exp_f32 v137, v137
s_waitcnt lgkmcnt(3)
v_mfma_f32_32x32x16_bf16 v[16:31], v[160:163], v[144:147], v[16:31]
v_exp_f32 v138, v138
v_exp_f32 v139, v139
v_exp_f32 v140, v140
v_mfma_f32_16x16x32_bf16 v[32:35], v[212:215], v[144:147], v[32:35]
s_cmp_eq_u32 s68, 0
v_exp_f32 v141, v141
v_exp_f32 v142, v142
v_exp_f32 v143, v143
v_cvt_pk_bf16_f32 v148, v136, v137
v_cvt_pk_bf16_f32 v149, v138, v139
v_cvt_pk_bf16_f32 v150, v140, v141
v_cvt_pk_bf16_f32 v151, v142, v143
s_cbranch_scc1 at_125
.p2align 3
at_122:
v_exp_f32 v112, v112
v_exp_f32 v113, v113
s_waitcnt lgkmcnt(2)
v_mfma_f32_32x32x16_bf16 v[16:31], v[164:167], v[148:151], v[16:31]
v_exp_f32 v114, v114
v_exp_f32 v115, v115
v_exp_f32 v116, v116
v_mfma_f32_16x16x32_bf16 v[32:35], v[212:215], v[148:151], v[32:35]
v_exp_f32 v117, v117
s_waitcnt lgkmcnt(1)
v_mfma_f32_32x32x16_bf16 v[128:143], v[152:155], v[96:99], 0
v_exp_f32 v118, v118
v_exp_f32 v119, v119
v_cvt_pk_bf16_f32 v144, v112, v113
v_cvt_pk_bf16_f32 v145, v114, v115
s_waitcnt lgkmcnt(0)
v_mfma_f32_32x32x16_bf16 v[128:143], v[156:159], v[104:107], v[128:143]
v_cvt_pk_bf16_f32 v146, v116, v117
v_cvt_pk_bf16_f32 v147, v118, v119
v_exp_f32 v120, v120
v_exp_f32 v121, v121
v_mfma_f32_32x32x16_bf16 v[192:207], v[160:163], v[144:147], v[192:207]
ds_read_b128 v[160:163], v8 offset:2048
v_exp_f32 v122, v122
v_exp_f32 v123, v123
v_exp_f32 v124, v124
v_mfma_f32_16x16x32_bf16 v[208:211], v[212:215], v[144:147], v[208:211]
v_exp_f32 v125, v125
v_exp_f32 v126, v126
v_exp_f32 v127, v127
v_cvt_pk_bf16_f32 v148, v120, v121
v_cvt_pk_bf16_f32 v149, v122, v123
v_cvt_pk_bf16_f32 v150, v124, v125
v_cvt_pk_bf16_f32 v151, v126, v127
v_exp_f32 v128, v128
v_exp_f32 v129, v129
v_mfma_f32_32x32x16_bf16 v[192:207], v[164:167], v[148:151], v[192:207]
ds_read_b128 v[164:167], v8 offset:3072
v_exp_f32 v130, v130
v_exp_f32 v131, v131
v_exp_f32 v132, v132
v_mfma_f32_16x16x32_bf16 v[208:211], v[212:215], v[148:151], v[208:211]
v_exp_f32 v133, v133
v_mfma_f32_32x32x16_bf16 v[112:127], v[152:155], v[80:83], 0
v_exp_f32 v134, v134
v_exp_f32 v135, v135
v_cvt_pk_bf16_f32 v144, v128, v129
v_cvt_pk_bf16_f32 v145, v130, v131
v_mfma_f32_32x32x16_bf16 v[112:127], v[156:159], v[88:91], v[112:127]
s_sub_u32 s66, s66, 8192
s_cmp_eq_u32 s66, s67
s_cbranch_scc1 cross_130
cback_131:
v_add_u32 v8, s66, v6
ds_read_b128 v[152:155], v8 offset:0
ds_read_b128 v[156:159], v8 offset:1024
v_cvt_pk_bf16_f32 v146, v132, v133
v_cvt_pk_bf16_f32 v147, v134, v135
v_exp_f32 v136, v136
v_exp_f32 v137, v137
s_waitcnt lgkmcnt(3)
v_mfma_f32_32x32x16_bf16 v[16:31], v[160:163], v[144:147], v[16:31]
v_exp_f32 v138, v138
v_exp_f32 v139, v139
v_exp_f32 v140, v140
v_mfma_f32_16x16x32_bf16 v[32:35], v[212:215], v[144:147], v[32:35]
s_sub_u32 s68, s68, 1
s_cmp_eq_u32 s68, 0
v_exp_f32 v141, v141
v_exp_f32 v142, v142
v_exp_f32 v143, v143
v_cvt_pk_bf16_f32 v148, v136, v137
v_cvt_pk_bf16_f32 v149, v138, v139
v_cvt_pk_bf16_f32 v150, v140, v141
v_cvt_pk_bf16_f32 v151, v142, v143
s_cbranch_scc0 at_122
s_cmp_lt_u32 s59, 2
s_cbranch_scc1 at_125
.p2align 3
v_exp_f32 v112, v112
v_exp_f32 v113, v113
s_waitcnt lgkmcnt(2)
v_mfma_f32_32x32x16_bf16 v[16:31], v[164:167], v[148:151], v[16:31]
v_exp_f32 v114, v114
v_exp_f32 v115, v115
v_exp_f32 v116, v116
v_mfma_f32_16x16x32_bf16 v[32:35], v[212:215], v[148:151], v[32:35]
v_exp_f32 v117, v117
s_waitcnt lgkmcnt(1)
v_mfma_f32_32x32x16_bf16 v[128:143], v[152:155], v[96:99], v[216:231]
v_exp_f32 v118, v118
v_exp_f32 v119, v119
v_cvt_pk_bf16_f32 v144, v112, v113
v_cvt_pk_bf16_f32 v145, v114, v115
s_waitcnt lgkmcnt(0)
v_mfma_f32_32x32x16_bf16 v[128:143], v[156:159], v[104:107], v[128:143]
v_cvt_pk_bf16_f32 v146, v116, v117
v_cvt_pk_bf16_f32 v147, v118, v119
v_exp_f32 v120, v120
v_exp_f32 v121, v121
v_mfma_f32_32x32x16_bf16 v[192:207], v[160:163], v[144:147], v[192:207]
ds_read_b128 v[160:163], v8 offset:2048
v_exp_f32 v122, v122
v_exp_f32 v123, v123
v_exp_f32 v124, v124
v_mfma_f32_16x16x32_bf16 v[208:211], v[212:215], v[144:147], v[208:211]
v_exp_f32 v125, v125
v_exp_f32 v126, v126
v_exp_f32 v127, v127
v_cvt_pk_bf16_f32 v148, v120, v121
v_cvt_pk_bf16_f32 v149, v122, v123
v_cvt_pk_bf16_f32 v150, v124, v125
v_cvt_pk_bf16_f32 v151, v126, v127
v_exp_f32 v128, v128
v_exp_f32 v129, v129
v_mfma_f32_32x32x16_bf16 v[192:207], v[164:167], v[148:151], v[192:207]
ds_read_b128 v[164:167], v8 offset:3072
v_exp_f32 v130, v130
v_exp_f32 v131, v131
v_exp_f32 v132, v132
v_mfma_f32_16x16x32_bf16 v[208:211], v[212:215], v[148:151], v[208:211]
v_exp_f32 v133, v133
v_mfma_f32_32x32x16_bf16 v[112:127], v[152:155], v[80:83], 0
v_exp_f32 v134, v134
v_exp_f32 v135, v135
v_cvt_pk_bf16_f32 v144, v128, v129
v_cvt_pk_bf16_f32 v145, v130, v131
v_mfma_f32_32x32x16_bf16 v[112:127], v[156:159], v[88:91], v[112:127]
v_subrev_u32 v8, 8192, v8
ds_read_b128 v[152:155], v8 offset:0
ds_read_b128 v[156:159], v8 offset:1024
v_cvt_pk_bf16_f32 v146, v132, v133
v_cvt_pk_bf16_f32 v147, v134, v135
v_exp_f32 v136, v136
v_exp_f32 v137, v137
s_waitcnt lgkmcnt(3)
v_mfma_f32_32x32x16_bf16 v[16:31], v[160:163], v[144:147], v[16:31]
v_exp_f32 v138, v138
v_exp_f32 v139, v139
v_exp_f32 v140, v140
v_mfma_f32_16x16x32_bf16 v[32:35], v[212:215], v[144:147], v[32:35]
s_cmp_eq_u32 s65, 1
v_exp_f32 v141, v141
v_exp_f32 v142, v142
v_exp_f32 v143, v143
v_cvt_pk_bf16_f32 v148, v136, v137
v_cvt_pk_bf16_f32 v149, v138, v139
v_cvt_pk_bf16_f32 v150, v140, v141
v_cvt_pk_bf16_f32 v151, v142, v143
s_cbranch_scc1 at_124
.p2align 3
v_exp_f32 v112, v112
v_exp_f32 v113, v113
s_waitcnt lgkmcnt(2)
v_mfma_f32_32x32x16_bf16 v[16:31], v[164:167], v[148:151], v[16:31]
v_exp_f32 v114, v114
v_exp_f32 v115, v115
v_exp_f32 v116, v116
v_mfma_f32_16x16x32_bf16 v[32:35], v[212:215], v[148:151], v[32:35]
v_exp_f32 v117, v117
s_waitcnt lgkmcnt(1)
v_mfma_f32_32x32x16_bf16 v[128:143], v[152:155], v[80:83], 0
v_exp_f32 v118, v118
v_exp_f32 v119, v119
v_cvt_pk_bf16_f32 v144, v112, v113
v_cvt_pk_bf16_f32 v145, v114, v115
s_waitcnt lgkmcnt(0)
v_mfma_f32_32x32x16_bf16 v[128:143], v[156:159], v[88:91], v[128:143]
v_subrev_u32 v8, 8192, v8
ds_read_b128 v[152:155], v8 offset:0
ds_read_b128 v[156:159], v8 offset:1024
v_cvt_pk_bf16_f32 v146, v116, v117
v_cvt_pk_bf16_f32 v147, v118, v119
v_exp_f32 v120, v120
v_exp_f32 v121, v121
v_mfma_f32_32x32x16_bf16 v[192:207], v[160:163], v[144:147], v[192:207]
ds_read_b128 v[160:163], v8 offset:10240
v_exp_f32 v122, v122
v_exp_f32 v123, v123
v_exp_f32 v124, v124
v_mfma_f32_16x16x32_bf16 v[208:211], v[212:215], v[144:147], v[208:211]
v_exp_f32 v125, v125
v_exp_f32 v126, v126
v_exp_f32 v127, v127
v_cvt_pk_bf16_f32 v148, v120, v121
v_cvt_pk_bf16_f32 v149, v122, v123
v_cvt_pk_bf16_f32 v150, v124, v125
v_cvt_pk_bf16_f32 v151, v126, v127
v_exp_f32 v128, v128
v_exp_f32 v129, v129
v_mfma_f32_32x32x16_bf16 v[192:207], v[164:167], v[148:151], v[192:207]
ds_read_b128 v[164:167], v8 offset:11264
v_exp_f32 v130, v130
v_exp_f32 v131, v131
v_exp_f32 v132, v132
v_mfma_f32_16x16x32_bf16 v[208:211], v[212:215], v[148:151], v[208:211]
v_exp_f32 v133, v133
s_waitcnt lgkmcnt(3)
v_mfma_f32_32x32x16_bf16 v[112:127], v[152:155], v[80:83], 0
v_exp_f32 v134, v134
v_exp_f32 v135, v135
v_cvt_pk_bf16_f32 v144, v128, v129
v_cvt_pk_bf16_f32 v145, v130, v131
s_waitcnt lgkmcnt(2)
v_mfma_f32_32x32x16_bf16 v[112:127], v[156:159], v[88:91], v[112:127]
v_subrev_u32 v8, 8192, v8
ds_read_b128 v[152:155], v8 offset:0
ds_read_b128 v[156:159], v8 offset:1024
v_cvt_pk_bf16_f32 v146, v132, v133
v_cvt_pk_bf16_f32 v147, v134, v135
v_exp_f32 v136, v136
v_exp_f32 v137, v137
s_waitcnt lgkmcnt(3)
v_mfma_f32_32x32x16_bf16 v[192:207], v[160:163], v[144:147], v[192:207]
ds_read_b128 v[160:163], v8 offset:10240
v_exp_f32 v138, v138
v_exp_f32 v139, v139
v_exp_f32 v140, v140
v_mfma_f32_16x16x32_bf16 v[208:211], v[212:215], v[144:147], v[208:211]
v_exp_f32 v141, v141
v_exp_f32 v142, v142
v_exp_f32 v143, v143
v_cvt_pk_bf16_f32 v148, v136, v137
v_cvt_pk_bf16_f32 v149, v138, v139
v_cvt_pk_bf16_f32 v150, v140, v141
v_cvt_pk_bf16_f32 v151, v142, v143
v_exp_f32 v112, v112
v_exp_f32 v113, v113
s_waitcnt lgkmcnt(3)
v_mfma_f32_32x32x16_bf16 v[192:207], v[164:167], v[148:151], v[192:207]
ds_read_b128 v[164:167], v8 offset:11264
v_exp_f32 v114, v114
v_exp_f32 v115, v115
v_exp_f32 v116, v116
v_mfma_f32_16x16x32_bf16 v[208:211], v[212:215], v[148:151], v[208:211]
v_exp_f32 v117, v117
s_waitcnt lgkmcnt(3)
v_mfma_f32_32x32x16_bf16 v[128:143], v[152:155], v[80:83], v[216:231]
v_exp_f32 v118, v118
v_exp_f32 v119, v119
v_cvt_pk_bf16_f32 v144, v112, v113
v_cvt_pk_bf16_f32 v145, v114, v115
s_waitcnt lgkmcnt(2)
v_mfma_f32_32x32x16_bf16 v[128:143], v[156:159], v[88:91], v[128:143]
v_cvt_pk_bf16_f32 v146, v116, v117
v_cvt_pk_bf16_f32 v147, v118, v119
v_exp_f32 v120, v120
v_exp_f32 v121, v121
s_waitcnt lgkmcnt(1)
v_mfma_f32_32x32x16_bf16 v[192:207], v[160:163], v[144:147], v[192:207]
ds_read_b128 v[160:163], v8 offset:2048
v_exp_f32 v122, v122
v_exp_f32 v123, v123
v_exp_f32 v124, v124
v_mfma_f32_16x16x32_bf16 v[208:211], v[212:215], v[144:147], v[208:211]
v_exp_f32 v125, v125
v_exp_f32 v126, v126
v_exp_f32 v127, v127
v_cvt_pk_bf16_f32 v148, v120, v121
v_cvt_pk_bf16_f32 v149, v122, v123
v_cvt_pk_bf16_f32 v150, v124, v125
v_cvt_pk_bf16_f32 v151, v126, v127
s_branch at_126
.p2align 3
at_125:
v_add_u32 v5, s34, 20
s_mov_b64 exec, 1
ds_write_b32 v3, v5
s_mov_b64 exec, -1
v_exp_f32 v112, v112
v_exp_f32 v113, v113
s_waitcnt lgkmcnt(3)
v_mfma_f32_32x32x16_bf16 v[16:31], v[164:167], v[148:151], v[16:31]
v_exp_f32 v114, v114
v_exp_f32 v115, v115
v_exp_f32 v116, v116
v_mfma_f32_16x16x32_bf16 v[32:35], v[212:215], v[148:151], v[32:35]
v_exp_f32 v117, v117
v_exp_f32 v118, v118
v_exp_f32 v119, v119
v_cvt_pk_bf16_f32 v144, v112, v113
v_cvt_pk_bf16_f32 v145, v114, v115
v_cvt_pk_bf16_f32 v146, v116, v117
v_cvt_pk_bf16_f32 v147, v118, v119
v_exp_f32 v120, v120
v_exp_f32 v121, v121
v_mfma_f32_32x32x16_bf16 v[192:207], v[160:163], v[144:147], v[192:207]
v_exp_f32 v122, v122
v_exp_f32 v123, v123
v_exp_f32 v124, v124
v_mfma_f32_16x16x32_bf16 v[208:211], v[212:215], v[144:147], v[208:211]
v_exp_f32 v125, v125
v_exp_f32 v126, v126
v_exp_f32 v127, v127
v_cvt_pk_bf16_f32 v148, v120, v121
v_cvt_pk_bf16_f32 v149, v122, v123
v_cvt_pk_bf16_f32 v150, v124, v125
v_cvt_pk_bf16_f32 v151, v126, v127
s_branch at_127
.p2align 3
at_124:
v_exp_f32 v112, v112
v_exp_f32 v113, v113
s_waitcnt lgkmcnt(2)
v_mfma_f32_32x32x16_bf16 v[16:31], v[164:167], v[148:151], v[16:31]
v_exp_f32 v114, v114
v_exp_f32 v115, v115
v_exp_f32 v116, v116
v_mfma_f32_16x16x32_bf16 v[32:35], v[212:215], v[148:151], v[32:35]
v_exp_f32 v117, v117
s_waitcnt lgkmcnt(1)
v_mfma_f32_32x32x16_bf16 v[128:143], v[152:155], v[80:83], v[216:231]
v_exp_f32 v118, v118
v_exp_f32 v119, v119
v_cvt_pk_bf16_f32 v144, v112, v113
v_cvt_pk_bf16_f32 v145, v114, v115
s_waitcnt lgkmcnt(0)
v_mfma_f32_32x32x16_bf16 v[128:143], v[156:159], v[88:91], v[128:143]
v_cvt_pk_bf16_f32 v146, v116, v117
v_cvt_pk_bf16_f32 v147, v118, v119
v_exp_f32 v120, v120
v_exp_f32 v121, v121
v_mfma_f32_32x32x16_bf16 v[192:207], v[160:163], v[144:147], v[192:207]
ds_read_b128 v[160:163], v8 offset:2048
v_exp_f32 v122, v122
v_exp_f32 v123, v123
v_exp_f32 v124, v124
v_mfma_f32_16x16x32_bf16 v[208:211], v[212:215], v[144:147], v[208:211]
v_exp_f32 v125, v125
v_exp_f32 v126, v126
v_exp_f32 v127, v127
v_cvt_pk_bf16_f32 v148, v120, v121
v_cvt_pk_bf16_f32 v149, v122, v123
v_cvt_pk_bf16_f32 v150, v124, v125
v_cvt_pk_bf16_f32 v151, v126, v127
.p2align 3
at_126:
v_exp_f32 v128, v128
v_exp_f32 v129, v129
s_waitcnt lgkmcnt(1)
v_mfma_f32_32x32x16_bf16 v[192:207], v[164:167], v[148:151], v[192:207]
ds_read_b128 v[164:167], v8 offset:3072
v_exp_f32 v130, v130
v_exp_f32 v131, v131
v_exp_f32 v132, v132
v_mfma_f32_16x16x32_bf16 v[208:211], v[212:215], v[148:151], v[208:211]
v_exp_f32 v133, v133
v_exp_f32 v134, v134
v_exp_f32 v135, v135
v_cvt_pk_bf16_f32 v144, v128, v129
v_cvt_pk_bf16_f32 v145, v130, v131
v_add_u32 v5, s34, 20
s_mov_b64 exec, 1
ds_write_b32 v3, v5
s_mov_b64 exec, -1
v_cvt_pk_bf16_f32 v146, v132, v133
v_cvt_pk_bf16_f32 v147, v134, v135
v_exp_f32 v136, v136
v_exp_f32 v137, v137
s_waitcnt lgkmcnt(2)
v_mfma_f32_32x32x16_bf16 v[192:207], v[160:163], v[144:147], v[192:207]
v_exp_f32 v138, v138
v_exp_f32 v139, v139
v_exp_f32 v140, v140
v_mfma_f32_16x16x32_bf16 v[208:211], v[212:215], v[144:147], v[208:211]
v_exp_f32 v141, v141
v_exp_f32 v142, v142
v_exp_f32 v143, v143
v_cvt_pk_bf16_f32 v148, v136, v137
v_cvt_pk_bf16_f32 v149, v138, v139
v_cvt_pk_bf16_f32 v150, v140, v141
v_cvt_pk_bf16_f32 v151, v142, v143
at_127:
s_lshl_b32 s66, s59, 18
s_lshl_b32 s67, s63, 22
v_mfma_f32_16x16x32_bf16 v[208:211], v[212:215], v[148:151], v[208:211]
s_add_u32 s66, s66, s67
s_lshl1_add_u32 s67, s60, s64
s_waitcnt lgkmcnt(1)
v_mfma_f32_32x32x16_bf16 v[192:207], v[164:167], v[148:151], v[192:207]
s_lshl_b32 s67, s67, 11
s_add_u32 s66, s66, s67
s_lshl_b32 s68, s65, 16
s_add_u32 s67, s66, 18022400
s_sub_u32 s67, s67, s68
s_add_u32 s66, s66, s68
s_add_u32 s66, s66, 17825792
v_lshlrev_b32 v9, 4, v0
v_subrev_u32 v10, 0x2f800000, v32
v_subrev_u32 v11, 0x2f800000, v208
v_max_u32 v10, v10, v11
v_cmp_lt_u32 vcc, 0x20000000, v10
s_cbranch_vccnz slow_132
sback_133:
s_nop 1
v_rcp_f32 v12, v32
s_nop 1
v_pk_mul_f32 v[16:17], v[16:17], v[12:13] op_sel:[0,0] op_sel_hi:[1,0]
v_pk_mul_f32 v[18:19], v[18:19], v[12:13] op_sel:[0,0] op_sel_hi:[1,0]
v_pk_mul_f32 v[20:21], v[20:21], v[12:13] op_sel:[0,0] op_sel_hi:[1,0]
v_pk_mul_f32 v[22:23], v[22:23], v[12:13] op_sel:[0,0] op_sel_hi:[1,0]
v_pk_mul_f32 v[24:25], v[24:25], v[12:13] op_sel:[0,0] op_sel_hi:[1,0]
v_pk_mul_f32 v[26:27], v[26:27], v[12:13] op_sel:[0,0] op_sel_hi:[1,0]
v_pk_mul_f32 v[28:29], v[28:29], v[12:13] op_sel:[0,0] op_sel_hi:[1,0]
v_pk_mul_f32 v[30:31], v[30:31], v[12:13] op_sel:[0,0] op_sel_hi:[1,0]
v_cvt_pk_bf16_f32 v16, v16, v17
v_cvt_pk_bf16_f32 v17, v18, v19
v_cvt_pk_bf16_f32 v18, v20, v21
v_cvt_pk_bf16_f32 v19, v22, v23
v_cvt_pk_bf16_f32 v20, v24, v25
v_cvt_pk_bf16_f32 v21, v26, v27
v_cvt_pk_bf16_f32 v22, v28, v29
v_cvt_pk_bf16_f32 v23, v30, v31
buffer_store_dwordx4 v[16:19], v9, s[20:23], s67 offen offset:0 sc1
buffer_store_dwordx4 v[20:23], v9, s[20:23], s67 offen offset:1024 sc1
v_rcp_f32 v12, v208
s_nop 0
v_pk_mul_f32 v[192:193], v[192:193], v[12:13] op_sel:[0,0] op_sel_hi:[1,0]
v_pk_mul_f32 v[194:195], v[194:195], v[12:13] op_sel:[0,0] op_sel_hi:[1,0]
v_pk_mul_f32 v[196:197], v[196:197], v[12:13] op_sel:[0,0] op_sel_hi:[1,0]
v_pk_mul_f32 v[198:199], v[198:199], v[12:13] op_sel:[0,0] op_sel_hi:[1,0]
v_pk_mul_f32 v[200:201], v[200:201], v[12:13] op_sel:[0,0] op_sel_hi:[1,0]
v_pk_mul_f32 v[202:203], v[202:203], v[12:13] op_sel:[0,0] op_sel_hi:[1,0]
v_pk_mul_f32 v[204:205], v[204:205], v[12:13] op_sel:[0,0] op_sel_hi:[1,0]
v_pk_mul_f32 v[206:207], v[206:207], v[12:13] op_sel:[0,0] op_sel_hi:[1,0]
v_cvt_pk_bf16_f32 v192, v192, v193
v_cvt_pk_bf16_f32 v193, v194, v195
v_cvt_pk_bf16_f32 v194, v196, v197
v_cvt_pk_bf16_f32 v195, v198, v199
v_cvt_pk_bf16_f32 v196, v200, v201
v_cvt_pk_bf16_f32 v197, v202, v203
v_cvt_pk_bf16_f32 v198, v204, v205
v_cvt_pk_bf16_f32 v199, v206, v207
buffer_store_dwordx4 v[192:195], v9, s[20:23], s66 offen offset:0 sc1
buffer_store_dwordx4 v[196:199], v9, s[20:23], s66 offen offset:1024 sc1
v_bfe_u32 v48, v0, 2, 3
v_lshrrev_b32 v49, 5, v0
v_lshl_add_u32 v48, v49, 4, v48
v_lshlrev_b32 v48, 7, v48
v_bfe_u32 v49, v0, 3, 2
v_lshl_add_u32 v48, v49, 5, v48
v_and_b32 v49, 3, v0
v_lshl_add_u32 v48, v49, 3, v48
v_add_u32 v8, 32768, v48
v_xor_b32 v9, 32, v8
v_xor_b32 v10, 64, v8
v_xor_b32 v11, 96, v8
v_add_u32 v12, 0x10000, v8
v_add_u32 v13, 0x10000, v9
v_add_u32 v14, 0x10000, v10
v_add_u32 v15, 0x10000, v11
v_and_b32 v48, 15, v0
v_lshrrev_b32 v49, 4, v0
s_lshl2_add_u32 s66, s61, s58
s_lshl_b32 s67, s66, 16
s_lshl_b32 s68, s63, 22
s_add_u32 s67, s67, s68
s_add_u32 s67, s67, 17825792
v_lshl_add_u32 v6, v48, 4, s67
v_lshl_add_u32 v6, v49, 9, v6
s_add_u32 s70, s72, 268288
s_add_u32 s35, s34, 3
lw_134:
ds_read_b32 v5, v2 offset:24
s_waitcnt lgkmcnt(0)
v_cmp_gt_i32 vcc, s35, v5
s_cbranch_vccz lwd_135
s_sub_u32 s32, s32, 1
s_cmp_gt_i32 s32, 0
s_cbranch_scc1 lw_134
lwd_135:
s_mov_b64 exec, 1
s_waitcnt vmcnt(0)
buffer_store_dword v212, v3, s[24:27], s70 offen sc1
s_mov_b64 exec, -1
v_add_u32 v5, s34, 21
s_mov_b64 exec, 1
ds_write_b32 v3, v5
s_mov_b64 exec, -1
s_cmp_eq_u32 s63, 0
s_cbranch_scc0 mo_136
v_permlane16_swap_b32 v240, v242
v_permlane16_swap_b32 v241, v243
v_permlane16_swap_b32 v244, v246
v_permlane16_swap_b32 v245, v247
v_permlane16_swap_b32 v248, v250
v_permlane16_swap_b32 v249, v251
v_permlane16_swap_b32 v252, v254
v_permlane16_swap_b32 v253, v255
mo_137:
v_lshlrev_b32 v16, 16, v240
v_and_b32 v17, 0xffff0000, v240
v_lshlrev_b32 v18, 16, v241
v_and_b32 v19, 0xffff0000, v241
v_lshlrev_b32 v20, 16, v242
v_and_b32 v21, 0xffff0000, v242
v_lshlrev_b32 v22, 16, v243
v_and_b32 v23, 0xffff0000, v243
v_lshlrev_b32 v24, 16, v244
v_and_b32 v25, 0xffff0000, v244
v_lshlrev_b32 v26, 16, v245
v_and_b32 v27, 0xffff0000, v245
v_lshlrev_b32 v28, 16, v246
v_and_b32 v29, 0xffff0000, v246
v_lshlrev_b32 v30, 16, v247
v_and_b32 v31, 0xffff0000, v247
v_lshlrev_b32 v32, 16, v248
v_and_b32 v33, 0xffff0000, v248
v_lshlrev_b32 v34, 16, v249
v_and_b32 v35, 0xffff0000, v249
v_lshlrev_b32 v36, 16, v250
v_and_b32 v37, 0xffff0000, v250
v_lshlrev_b32 v38, 16, v251
v_and_b32 v39, 0xffff0000, v251
v_lshlrev_b32 v40, 16, v252
v_and_b32 v41, 0xffff0000, v252
v_lshlrev_b32 v42, 16, v253
v_and_b32 v43, 0xffff0000, v253
v_lshlrev_b32 v44, 16, v254
v_and_b32 v45, 0xffff0000, v254
v_lshlrev_b32 v46, 16, v255
v_and_b32 v47, 0xffff0000, v255
s_add_u32 s66, s61, s62
s_and_b32 s66, s66, 15
s_lshl_b32 s66, s66, 12
s_add_u32 s35, s34, 18
lw_138:
ds_read_b32 v5, v2 offset:16
s_waitcnt lgkmcnt(0)
v_cmp_gt_i32 vcc, s35, v5
s_cbranch_vccz lwd_139
s_sub_u32 s32, s32, 1
s_cmp_gt_i32 s32, 0
s_cbranch_scc1 lw_138
lwd_139:
buffer_load_dwordx4 v[80:83], v6, s[20:23], s66 offen offset:0 sc1
buffer_load_dwordx4 v[88:91], v6, s[20:23], s66 offen offset:2048 sc1
buffer_load_dwordx4 v[84:87], v6, s[20:23], s66 offen offset:256 sc1
buffer_load_dwordx4 v[92:95], v6, s[20:23], s66 offen offset:2304 sc1
s_add_u32 s66, s66, 4096
s_and_b32 s66, s66, 0xffff
ds_read_b64_tr_b16 v[48:49], v8 offset:0
ds_read_b64_tr_b16 v[50:51], v8 offset:1024
ds_read_b64_tr_b16 v[52:53], v8 offset:4096
ds_read_b64_tr_b16 v[54:55], v8 offset:5120
buffer_load_dwordx4 v[96:99], v6, s[20:23], s66 offen offset:0 sc1
buffer_load_dwordx4 v[104:107], v6, s[20:23], s66 offen offset:2048 sc1
buffer_load_dwordx4 v[100:103], v6, s[20:23], s66 offen offset:256 sc1
buffer_load_dwordx4 v[108:111], v6, s[20:23], s66 offen offset:2304 sc1
s_add_u32 s66, s66, 4096
s_and_b32 s66, s66, 0xffff
ds_read_b64_tr_b16 v[56:57], v9 offset:0
ds_read_b64_tr_b16 v[58:59], v9 offset:1024
ds_read_b64_tr_b16 v[60:61], v9 offset:4096
ds_read_b64_tr_b16 v[62:63], v9 offset:5120
buffer_load_dwordx4 v[112:115], v6, s[20:23], s66 offen offset:0 sc1
buffer_load_dwordx4 v[120:123], v6, s[20:23], s66 offen offset:2048 sc1
buffer_load_dwordx4 v[116:119], v6, s[20:23], s66 offen offset:256 sc1
buffer_load_dwordx4 v[124:127], v6, s[20:23], s66 offen offset:2304 sc1
s_add_u32 s66, s66, 4096
s_and_b32 s66, s66, 0xffff
ds_read_b64_tr_b16 v[64:65], v10 offset:0
ds_read_b64_tr_b16 v[66:67], v10 offset:1024
ds_read_b64_tr_b16 v[68:69], v10 offset:4096
ds_read_b64_tr_b16 v[70:71], v10 offset:5120
buffer_load_dwordx4 v[128:131], v6, s[20:23], s66 offen offset:0 sc1
buffer_load_dwordx4 v[136:139], v6, s[20:23], s66 offen offset:2048 sc1
buffer_load_dwordx4 v[132:135], v6, s[20:23], s66 offen offset:256 sc1
buffer_load_dwordx4 v[140:143], v6, s[20:23], s66 offen offset:2304 sc1
s_add_u32 s66, s66, 4096
s_and_b32 s66, s66, 0xffff
buffer_load_dwordx4 v[144:147], v6, s[20:23], s66 offen offset:0 sc1
buffer_load_dwordx4 v[152:155], v6, s[20:23], s66 offen offset:2048 sc1
buffer_load_dwordx4 v[148:151], v6, s[20:23], s66 offen offset:256 sc1
buffer_load_dwordx4 v[156:159], v6, s[20:23], s66 offen offset:2304 sc1
s_add_u32 s66, s66, 4096
s_and_b32 s66, s66, 0xffff
buffer_load_dwordx4 v[160:163], v6, s[20:23], s66 offen offset:0 sc1
buffer_load_dwordx4 v[168:171], v6, s[20:23], s66 offen offset:2048 sc1
buffer_load_dwordx4 v[164:167], v6, s[20:23], s66 offen offset:256 sc1
buffer_load_dwordx4 v[172:175], v6, s[20:23], s66 offen offset:2304 sc1
s_add_u32 s66, s66, 4096
s_and_b32 s66, s66, 0xffff
buffer_load_dwordx4 v[176:179], v6, s[20:23], s66 offen offset:0 sc1
buffer_load_dwordx4 v[184:187], v6, s[20:23], s66 offen offset:2048 sc1
buffer_load_dwordx4 v[180:183], v6, s[20:23], s66 offen offset:256 sc1
buffer_load_dwordx4 v[188:191], v6, s[20:23], s66 offen offset:2304 sc1
s_add_u32 s66, s66, 4096
s_and_b32 s66, s66, 0xffff
buffer_load_dwordx4 v[192:195], v6, s[20:23], s66 offen offset:0 sc1
buffer_load_dwordx4 v[200:203], v6, s[20:23], s66 offen offset:2048 sc1
buffer_load_dwordx4 v[196:199], v6, s[20:23], s66 offen offset:256 sc1
buffer_load_dwordx4 v[204:207], v6, s[20:23], s66 offen offset:2304 sc1
s_add_u32 s66, s66, 4096
s_and_b32 s66, s66, 0xffff
.p2align 3
s_waitcnt vmcnt(31) lgkmcnt(10)
v_mfma_f32_16x16x32_bf16 v[16:19], v[48:51], v[80:83], v[16:19]
ds_read_b64_tr_b16 v[72:73], v11 offset:0
s_waitcnt vmcnt(30) lgkmcnt(9)
v_mfma_f32_16x16x32_bf16 v[16:19], v[52:55], v[88:91], v[16:19]
ds_read_b64_tr_b16 v[74:75], v11 offset:1024
s_waitcnt vmcnt(29)
v_mfma_f32_16x16x32_bf16 v[32:35], v[48:51], v[84:87], v[32:35]
ds_read_b64_tr_b16 v[76:77], v11 offset:4096
s_waitcnt vmcnt(28)
v_mfma_f32_16x16x32_bf16 v[32:35], v[52:55], v[92:95], v[32:35]
ds_read_b64_tr_b16 v[78:79], v11 offset:5120
s_waitcnt lgkmcnt(10)
v_mfma_f32_16x16x32_bf16 v[20:23], v[56:59], v[80:83], v[20:23]
ds_read_b64_tr_b16 v[48:49], v8 offset:8192
s_waitcnt lgkmcnt(9)
v_mfma_f32_16x16x32_bf16 v[20:23], v[60:63], v[88:91], v[20:23]
ds_read_b64_tr_b16 v[50:51], v8 offset:9216
v_mfma_f32_16x16x32_bf16 v[36:39], v[56:59], v[84:87], v[36:39]
ds_read_b64_tr_b16 v[52:53], v8 offset:12288
v_mfma_f32_16x16x32_bf16 v[36:39], v[60:63], v[92:95], v[36:39]
ds_read_b64_tr_b16 v[54:55], v8 offset:13312
s_waitcnt lgkmcnt(10)
v_mfma_f32_16x16x32_bf16 v[24:27], v[64:67], v[80:83], v[24:27]
ds_read_b64_tr_b16 v[56:57], v9 offset:8192
s_waitcnt lgkmcnt(9)
v_mfma_f32_16x16x32_bf16 v[24:27], v[68:71], v[88:91], v[24:27]
ds_read_b64_tr_b16 v[58:59], v9 offset:9216
v_mfma_f32_16x16x32_bf16 v[40:43], v[64:67], v[84:87], v[40:43]
ds_read_b64_tr_b16 v[60:61], v9 offset:12288
v_mfma_f32_16x16x32_bf16 v[40:43], v[68:71], v[92:95], v[40:43]
ds_read_b64_tr_b16 v[62:63], v9 offset:13312
s_waitcnt lgkmcnt(10)
v_mfma_f32_16x16x32_bf16 v[28:31], v[72:75], v[80:83], v[28:31]
ds_read_b64_tr_b16 v[64:65], v10 offset:8192
s_waitcnt lgkmcnt(9)
v_mfma_f32_16x16x32_bf16 v[28:31], v[76:79], v[88:91], v[28:31]
ds_read_b64_tr_b16 v[66:67], v10 offset:9216
v_mfma_f32_16x16x32_bf16 v[44:47], v[72:75], v[84:87], v[44:47]
ds_read_b64_tr_b16 v[68:69], v10 offset:12288
v_mfma_f32_16x16x32_bf16 v[44:47], v[76:79], v[92:95], v[44:47]
ds_read_b64_tr_b16 v[70:71], v10 offset:13312
s_waitcnt vmcnt(27) lgkmcnt(10)
v_mfma_f32_16x16x32_bf16 v[16:19], v[48:51], v[96:99], v[16:19]
ds_read_b64_tr_b16 v[72:73], v11 offset:8192
buffer_load_dwordx4 v[80:83], v6, s[20:23], s66 offen offset:0 sc1
s_waitcnt vmcnt(27) lgkmcnt(9)
v_mfma_f32_16x16x32_bf16 v[16:19], v[52:55], v[104:107], v[16:19]
ds_read_b64_tr_b16 v[74:75], v11 offset:9216
buffer_load_dwordx4 v[88:91], v6, s[20:23], s66 offen offset:2048 sc1
s_waitcnt vmcnt(27)
v_mfma_f32_16x16x32_bf16 v[32:35], v[48:51], v[100:103], v[32:35]
ds_read_b64_tr_b16 v[76:77], v11 offset:12288
buffer_load_dwordx4 v[84:87], v6, s[20:23], s66 offen offset:256 sc1
s_waitcnt vmcnt(27)
v_mfma_f32_16x16x32_bf16 v[32:35], v[52:55], v[108:111], v[32:35]
ds_read_b64_tr_b16 v[78:79], v11 offset:13312
buffer_load_dwordx4 v[92:95], v6, s[20:23], s66 offen offset:2304 sc1
s_waitcnt lgkmcnt(10)
v_mfma_f32_16x16x32_bf16 v[20:23], v[56:59], v[96:99], v[20:23]
ds_read_b64_tr_b16 v[48:49], v8 offset:16384
s_add_u32 s66, s66, 4096
s_and_b32 s66, s66, 0xffff
s_waitcnt lgkmcnt(9)
v_mfma_f32_16x16x32_bf16 v[20:23], v[60:63], v[104:107], v[20:23]
ds_read_b64_tr_b16 v[50:51], v8 offset:17408
v_mfma_f32_16x16x32_bf16 v[36:39], v[56:59], v[100:103], v[36:39]
ds_read_b64_tr_b16 v[52:53], v8 offset:20480
v_mfma_f32_16x16x32_bf16 v[36:39], v[60:63], v[108:111], v[36:39]
ds_read_b64_tr_b16 v[54:55], v8 offset:21504
s_waitcnt lgkmcnt(10)
v_mfma_f32_16x16x32_bf16 v[24:27], v[64:67], v[96:99], v[24:27]
ds_read_b64_tr_b16 v[56:57], v9 offset:16384
s_waitcnt lgkmcnt(9)
v_mfma_f32_16x16x32_bf16 v[24:27], v[68:71], v[104:107], v[24:27]
ds_read_b64_tr_b16 v[58:59], v9 offset:17408
v_mfma_f32_16x16x32_bf16 v[40:43], v[64:67], v[100:103], v[40:43]
ds_read_b64_tr_b16 v[60:61], v9 offset:20480
v_mfma_f32_16x16x32_bf16 v[40:43], v[68:71], v[108:111], v[40:43]
ds_read_b64_tr_b16 v[62:63], v9 offset:21504
s_waitcnt lgkmcnt(10)
v_mfma_f32_16x16x32_bf16 v[28:31], v[72:75], v[96:99], v[28:31]
ds_read_b64_tr_b16 v[64:65], v10 offset:16384
s_waitcnt lgkmcnt(9)
v_mfma_f32_16x16x32_bf16 v[28:31], v[76:79], v[104:107], v[28:31]
ds_read_b64_tr_b16 v[66:67], v10 offset:17408
v_mfma_f32_16x16x32_bf16 v[44:47], v[72:75], v[100:103], v[44:47]
ds_read_b64_tr_b16 v[68:69], v10 offset:20480
v_mfma_f32_16x16x32_bf16 v[44:47], v[76:79], v[108:111], v[44:47]
ds_read_b64_tr_b16 v[70:71], v10 offset:21504
s_waitcnt vmcnt(27) lgkmcnt(10)
v_mfma_f32_16x16x32_bf16 v[16:19], v[48:51], v[112:115], v[16:19]
ds_read_b64_tr_b16 v[72:73], v11 offset:16384
buffer_load_dwordx4 v[96:99], v6, s[20:23], s66 offen offset:0 sc1
s_waitcnt vmcnt(27) lgkmcnt(9)
v_mfma_f32_16x16x32_bf16 v[16:19], v[52:55], v[120:123], v[16:19]
ds_read_b64_tr_b16 v[74:75], v11 offset:17408
buffer_load_dwordx4 v[104:107], v6, s[20:23], s66 offen offset:2048 sc1
s_waitcnt vmcnt(27)
v_mfma_f32_16x16x32_bf16 v[32:35], v[48:51], v[116:119], v[32:35]
ds_read_b64_tr_b16 v[76:77], v11 offset:20480
buffer_load_dwordx4 v[100:103], v6, s[20:23], s66 offen offset:256 sc1
s_waitcnt vmcnt(27)
v_mfma_f32_16x16x32_bf16 v[32:35], v[52:55], v[124:127], v[32:35]
ds_read_b64_tr_b16 v[78:79], v11 offset:21504
buffer_load_dwordx4 v[108:111], v6, s[20:23], s66 offen offset:2304 sc1
s_waitcnt lgkmcnt(10)
v_mfma_f32_16x16x32_bf16 v[20:23], v[56:59], v[112:115], v[20:23]
ds_read_b64_tr_b16 v[48:49], v8 offset:24576
s_add_u32 s66, s66, 4096
s_and_b32 s66, s66, 0xffff
s_waitcnt lgkmcnt(9)
v_mfma_f32_16x16x32_bf16 v[20:23], v[60:63], v[120:123], v[20:23]
ds_read_b64_tr_b16 v[50:51], v8 offset:25600
v_mfma_f32_16x16x32_bf16 v[36:39], v[56:59], v[116:119], v[36:39]
ds_read_b64_tr_b16 v[52:53], v8 offset:28672
v_mfma_f32_16x16x32_bf16 v[36:39], v[60:63], v[124:127], v[36:39]
ds_read_b64_tr_b16 v[54:55], v8 offset:29696
s_waitcnt lgkmcnt(10)
v_mfma_f32_16x16x32_bf16 v[24:27], v[64:67], v[112:115], v[24:27]
ds_read_b64_tr_b16 v[56:57], v9 offset:24576
s_waitcnt lgkmcnt(9)
v_mfma_f32_16x16x32_bf16 v[24:27], v[68:71], v[120:123], v[24:27]
ds_read_b64_tr_b16 v[58:59], v9 offset:25600
v_mfma_f32_16x16x32_bf16 v[40:43], v[64:67], v[116:119], v[40:43]
ds_read_b64_tr_b16 v[60:61], v9 offset:28672
v_mfma_f32_16x16x32_bf16 v[40:43], v[68:71], v[124:127], v[40:43]
ds_read_b64_tr_b16 v[62:63], v9 offset:29696
s_waitcnt lgkmcnt(10)
v_mfma_f32_16x16x32_bf16 v[28:31], v[72:75], v[112:115], v[28:31]
ds_read_b64_tr_b16 v[64:65], v10 offset:24576
s_waitcnt lgkmcnt(9)
v_mfma_f32_16x16x32_bf16 v[28:31], v[76:79], v[120:123], v[28:31]
ds_read_b64_tr_b16 v[66:67], v10 offset:25600
v_mfma_f32_16x16x32_bf16 v[44:47], v[72:75], v[116:119], v[44:47]
ds_read_b64_tr_b16 v[68:69], v10 offset:28672
v_mfma_f32_16x16x32_bf16 v[44:47], v[76:79], v[124:127], v[44:47]
ds_read_b64_tr_b16 v[70:71], v10 offset:29696
s_waitcnt vmcnt(27) lgkmcnt(10)
v_mfma_f32_16x16x32_bf16 v[16:19], v[48:51], v[128:131], v[16:19]
ds_read_b64_tr_b16 v[72:73], v11 offset:24576
buffer_load_dwordx4 v[112:115], v6, s[20:23], s66 offen offset:0 sc1
s_waitcnt vmcnt(27) lgkmcnt(9)
v_mfma_f32_16x16x32_bf16 v[16:19], v[52:55], v[136:139], v[16:19]
ds_read_b64_tr_b16 v[74:75], v11 offset:25600
buffer_load_dwordx4 v[120:123], v6, s[20:23], s66 offen offset:2048 sc1
s_waitcnt vmcnt(27)
v_mfma_f32_16x16x32_bf16 v[32:35], v[48:51], v[132:135], v[32:35]
ds_read_b64_tr_b16 v[76:77], v11 offset:28672
buffer_load_dwordx4 v[116:119], v6, s[20:23], s66 offen offset:256 sc1
s_waitcnt vmcnt(27)
v_mfma_f32_16x16x32_bf16 v[32:35], v[52:55], v[140:143], v[32:35]
ds_read_b64_tr_b16 v[78:79], v11 offset:29696
buffer_load_dwordx4 v[124:127], v6, s[20:23], s66 offen offset:2304 sc1
s_waitcnt lgkmcnt(10)
v_mfma_f32_16x16x32_bf16 v[20:23], v[56:59], v[128:131], v[20:23]
ds_read_b64_tr_b16 v[48:49], v8 offset:32768
s_add_u32 s66, s66, 4096
s_and_b32 s66, s66, 0xffff
s_waitcnt lgkmcnt(9)
v_mfma_f32_16x16x32_bf16 v[20:23], v[60:63], v[136:139], v[20:23]
ds_read_b64_tr_b16 v[50:51], v8 offset:33792
v_mfma_f32_16x16x32_bf16 v[36:39], v[56:59], v[132:135], v[36:39]
ds_read_b64_tr_b16 v[52:53], v8 offset:36864
v_mfma_f32_16x16x32_bf16 v[36:39], v[60:63], v[140:143], v[36:39]
ds_read_b64_tr_b16 v[54:55], v8 offset:37888
s_waitcnt lgkmcnt(10)
v_mfma_f32_16x16x32_bf16 v[24:27], v[64:67], v[128:131], v[24:27]
ds_read_b64_tr_b16 v[56:57], v9 offset:32768
s_waitcnt lgkmcnt(9)
v_mfma_f32_16x16x32_bf16 v[24:27], v[68:71], v[136:139], v[24:27]
ds_read_b64_tr_b16 v[58:59], v9 offset:33792
v_mfma_f32_16x16x32_bf16 v[40:43], v[64:67], v[132:135], v[40:43]
ds_read_b64_tr_b16 v[60:61], v9 offset:36864
v_mfma_f32_16x16x32_bf16 v[40:43], v[68:71], v[140:143], v[40:43]
ds_read_b64_tr_b16 v[62:63], v9 offset:37888
s_waitcnt lgkmcnt(10)
v_mfma_f32_16x16x32_bf16 v[28:31], v[72:75], v[128:131], v[28:31]
ds_read_b64_tr_b16 v[64:65], v10 offset:32768
s_waitcnt lgkmcnt(9)
v_mfma_f32_16x16x32_bf16 v[28:31], v[76:79], v[136:139], v[28:31]
ds_read_b64_tr_b16 v[66:67], v10 offset:33792
v_mfma_f32_16x16x32_bf16 v[44:47], v[72:75], v[132:135], v[44:47]
ds_read_b64_tr_b16 v[68:69], v10 offset:36864
v_mfma_f32_16x16x32_bf16 v[44:47], v[76:79], v[140:143], v[44:47]
ds_read_b64_tr_b16 v[70:71], v10 offset:37888
s_waitcnt vmcnt(27) lgkmcnt(10)
v_mfma_f32_16x16x32_bf16 v[16:19], v[48:51], v[144:147], v[16:19]
ds_read_b64_tr_b16 v[72:73], v11 offset:32768
buffer_load_dwordx4 v[128:131], v6, s[20:23], s66 offen offset:0 sc1
s_waitcnt vmcnt(27) lgkmcnt(9)
v_mfma_f32_16x16x32_bf16 v[16:19], v[52:55], v[152:155], v[16:19]
ds_read_b64_tr_b16 v[74:75], v11 offset:33792
buffer_load_dwordx4 v[136:139], v6, s[20:23], s66 offen offset:2048 sc1
s_waitcnt vmcnt(27)
v_mfma_f32_16x16x32_bf16 v[32:35], v[48:51], v[148:151], v[32:35]
ds_read_b64_tr_b16 v[76:77], v11 offset:36864
buffer_load_dwordx4 v[132:135], v6, s[20:23], s66 offen offset:256 sc1
s_waitcnt vmcnt(27)
v_mfma_f32_16x16x32_bf16 v[32:35], v[52:55], v[156:159], v[32:35]
ds_read_b64_tr_b16 v[78:79], v11 offset:37888
buffer_load_dwordx4 v[140:143], v6, s[20:23], s66 offen offset:2304 sc1
s_waitcnt lgkmcnt(10)
v_mfma_f32_16x16x32_bf16 v[20:23], v[56:59], v[144:147], v[20:23]
ds_read_b64_tr_b16 v[48:49], v8 offset:40960
s_add_u32 s66, s66, 4096
s_and_b32 s66, s66, 0xffff
s_waitcnt lgkmcnt(9)
v_mfma_f32_16x16x32_bf16 v[20:23], v[60:63], v[152:155], v[20:23]
ds_read_b64_tr_b16 v[50:51], v8 offset:41984
v_mfma_f32_16x16x32_bf16 v[36:39], v[56:59], v[148:151], v[36:39]
ds_read_b64_tr_b16 v[52:53], v8 offset:45056
v_mfma_f32_16x16x32_bf16 v[36:39], v[60:63], v[156:159], v[36:39]
ds_read_b64_tr_b16 v[54:55], v8 offset:46080
s_waitcnt lgkmcnt(10)
v_mfma_f32_16x16x32_bf16 v[24:27], v[64:67], v[144:147], v[24:27]
ds_read_b64_tr_b16 v[56:57], v9 offset:40960
s_waitcnt lgkmcnt(9)
v_mfma_f32_16x16x32_bf16 v[24:27], v[68:71], v[152:155], v[24:27]
ds_read_b64_tr_b16 v[58:59], v9 offset:41984
v_mfma_f32_16x16x32_bf16 v[40:43], v[64:67], v[148:151], v[40:43]
ds_read_b64_tr_b16 v[60:61], v9 offset:45056
v_mfma_f32_16x16x32_bf16 v[40:43], v[68:71], v[156:159], v[40:43]
ds_read_b64_tr_b16 v[62:63], v9 offset:46080
s_waitcnt lgkmcnt(10)
v_mfma_f32_16x16x32_bf16 v[28:31], v[72:75], v[144:147], v[28:31]
ds_read_b64_tr_b16 v[64:65], v10 offset:40960
s_waitcnt lgkmcnt(9)
v_mfma_f32_16x16x32_bf16 v[28:31], v[76:79], v[152:155], v[28:31]
ds_read_b64_tr_b16 v[66:67], v10 offset:41984
v_mfma_f32_16x16x32_bf16 v[44:47], v[72:75], v[148:151], v[44:47]
ds_read_b64_tr_b16 v[68:69], v10 offset:45056
v_mfma_f32_16x16x32_bf16 v[44:47], v[76:79], v[156:159], v[44:47]
ds_read_b64_tr_b16 v[70:71], v10 offset:46080
s_waitcnt vmcnt(27) lgkmcnt(10)
v_mfma_f32_16x16x32_bf16 v[16:19], v[48:51], v[160:163], v[16:19]
ds_read_b64_tr_b16 v[72:73], v11 offset:40960
buffer_load_dwordx4 v[144:147], v6, s[20:23], s66 offen offset:0 sc1
s_waitcnt vmcnt(27) lgkmcnt(9)
v_mfma_f32_16x16x32_bf16 v[16:19], v[52:55], v[168:171], v[16:19]
ds_read_b64_tr_b16 v[74:75], v11 offset:41984
buffer_load_dwordx4 v[152:155], v6, s[20:23], s66 offen offset:2048 sc1
s_waitcnt vmcnt(27)
v_mfma_f32_16x16x32_bf16 v[32:35], v[48:51], v[164:167], v[32:35]
ds_read_b64_tr_b16 v[76:77], v11 offset:45056
buffer_load_dwordx4 v[148:151], v6, s[20:23], s66 offen offset:256 sc1
s_waitcnt vmcnt(27)
v_mfma_f32_16x16x32_bf16 v[32:35], v[52:55], v[172:175], v[32:35]
ds_read_b64_tr_b16 v[78:79], v11 offset:46080
buffer_load_dwordx4 v[156:159], v6, s[20:23], s66 offen offset:2304 sc1
s_waitcnt lgkmcnt(10)
v_mfma_f32_16x16x32_bf16 v[20:23], v[56:59], v[160:163], v[20:23]
ds_read_b64_tr_b16 v[48:49], v8 offset:49152
s_add_u32 s66, s66, 4096
s_and_b32 s66, s66, 0xffff
s_waitcnt lgkmcnt(9)
v_mfma_f32_16x16x32_bf16 v[20:23], v[60:63], v[168:171], v[20:23]
ds_read_b64_tr_b16 v[50:51], v8 offset:50176
v_mfma_f32_16x16x32_bf16 v[36:39], v[56:59], v[164:167], v[36:39]
ds_read_b64_tr_b16 v[52:53], v8 offset:53248
v_mfma_f32_16x16x32_bf16 v[36:39], v[60:63], v[172:175], v[36:39]
ds_read_b64_tr_b16 v[54:55], v8 offset:54272
s_waitcnt lgkmcnt(10)
v_mfma_f32_16x16x32_bf16 v[24:27], v[64:67], v[160:163], v[24:27]
ds_read_b64_tr_b16 v[56:57], v9 offset:49152
s_waitcnt lgkmcnt(9)
v_mfma_f32_16x16x32_bf16 v[24:27], v[68:71], v[168:171], v[24:27]
ds_read_b64_tr_b16 v[58:59], v9 offset:50176
v_mfma_f32_16x16x32_bf16 v[40:43], v[64:67], v[164:167], v[40:43]
ds_read_b64_tr_b16 v[60:61], v9 offset:53248
v_mfma_f32_16x16x32_bf16 v[40:43], v[68:71], v[172:175], v[40:43]
ds_read_b64_tr_b16 v[62:63], v9 offset:54272
s_waitcnt lgkmcnt(10)
v_mfma_f32_16x16x32_bf16 v[28:31], v[72:75], v[160:163], v[28:31]
ds_read_b64_tr_b16 v[64:65], v10 offset:49152
s_waitcnt lgkmcnt(9)
v_mfma_f32_16x16x32_bf16 v[28:31], v[76:79], v[168:171], v[28:31]
ds_read_b64_tr_b16 v[66:67], v10 offset:50176
v_mfma_f32_16x16x32_bf16 v[44:47], v[72:75], v[164:167], v[44:47]
ds_read_b64_tr_b16 v[68:69], v10 offset:53248
v_mfma_f32_16x16x32_bf16 v[44:47], v[76:79], v[172:175], v[44:47]
ds_read_b64_tr_b16 v[70:71], v10 offset:54272
s_waitcnt vmcnt(27) lgkmcnt(10)
v_mfma_f32_16x16x32_bf16 v[16:19], v[48:51], v[176:179], v[16:19]
ds_read_b64_tr_b16 v[72:73], v11 offset:49152
buffer_load_dwordx4 v[160:163], v6, s[20:23], s66 offen offset:0 sc1
s_waitcnt vmcnt(27) lgkmcnt(9)
v_mfma_f32_16x16x32_bf16 v[16:19], v[52:55], v[184:187], v[16:19]
ds_read_b64_tr_b16 v[74:75], v11 offset:50176
buffer_load_dwordx4 v[168:171], v6, s[20:23], s66 offen offset:2048 sc1
s_waitcnt vmcnt(27)
v_mfma_f32_16x16x32_bf16 v[32:35], v[48:51], v[180:183], v[32:35]
ds_read_b64_tr_b16 v[76:77], v11 offset:53248
buffer_load_dwordx4 v[164:167], v6, s[20:23], s66 offen offset:256 sc1
s_waitcnt vmcnt(27)
v_mfma_f32_16x16x32_bf16 v[32:35], v[52:55], v[188:191], v[32:35]
ds_read_b64_tr_b16 v[78:79], v11 offset:54272
buffer_load_dwordx4 v[172:175], v6, s[20:23], s66 offen offset:2304 sc1
s_waitcnt lgkmcnt(10)
v_mfma_f32_16x16x32_bf16 v[20:23], v[56:59], v[176:179], v[20:23]
ds_read_b64_tr_b16 v[48:49], v8 offset:57344
s_add_u32 s66, s66, 4096
s_and_b32 s66, s66, 0xffff
s_waitcnt lgkmcnt(9)
v_mfma_f32_16x16x32_bf16 v[20:23], v[60:63], v[184:187], v[20:23]
ds_read_b64_tr_b16 v[50:51], v8 offset:58368
v_mfma_f32_16x16x32_bf16 v[36:39], v[56:59], v[180:183], v[36:39]
ds_read_b64_tr_b16 v[52:53], v8 offset:61440
v_mfma_f32_16x16x32_bf16 v[36:39], v[60:63], v[188:191], v[36:39]
ds_read_b64_tr_b16 v[54:55], v8 offset:62464
s_waitcnt lgkmcnt(10)
v_mfma_f32_16x16x32_bf16 v[24:27], v[64:67], v[176:179], v[24:27]
ds_read_b64_tr_b16 v[56:57], v9 offset:57344
s_waitcnt lgkmcnt(9)
v_mfma_f32_16x16x32_bf16 v[24:27], v[68:71], v[184:187], v[24:27]
ds_read_b64_tr_b16 v[58:59], v9 offset:58368
v_mfma_f32_16x16x32_bf16 v[40:43], v[64:67], v[180:183], v[40:43]
ds_read_b64_tr_b16 v[60:61], v9 offset:61440
v_mfma_f32_16x16x32_bf16 v[40:43], v[68:71], v[188:191], v[40:43]
ds_read_b64_tr_b16 v[62:63], v9 offset:62464
s_waitcnt lgkmcnt(10)
v_mfma_f32_16x16x32_bf16 v[28:31], v[72:75], v[176:179], v[28:31]
ds_read_b64_tr_b16 v[64:65], v10 offset:57344
s_waitcnt lgkmcnt(9)
v_mfma_f32_16x16x32_bf16 v[28:31], v[76:79], v[184:187], v[28:31]
ds_read_b64_tr_b16 v[66:67], v10 offset:58368
v_mfma_f32_16x16x32_bf16 v[44:47], v[72:75], v[180:183], v[44:47]
ds_read_b64_tr_b16 v[68:69], v10 offset:61440
v_mfma_f32_16x16x32_bf16 v[44:47], v[76:79], v[188:191], v[44:47]
ds_read_b64_tr_b16 v[70:71], v10 offset:62464
s_waitcnt vmcnt(27) lgkmcnt(10)
v_mfma_f32_16x16x32_bf16 v[16:19], v[48:51], v[192:195], v[16:19]
ds_read_b64_tr_b16 v[72:73], v11 offset:57344
buffer_load_dwordx4 v[176:179], v6, s[20:23], s66 offen offset:0 sc1
s_waitcnt vmcnt(27) lgkmcnt(9)
v_mfma_f32_16x16x32_bf16 v[16:19], v[52:55], v[200:203], v[16:19]
ds_read_b64_tr_b16 v[74:75], v11 offset:58368
buffer_load_dwordx4 v[184:187], v6, s[20:23], s66 offen offset:2048 sc1
s_waitcnt vmcnt(27)
v_mfma_f32_16x16x32_bf16 v[32:35], v[48:51], v[196:199], v[32:35]
ds_read_b64_tr_b16 v[76:77], v11 offset:61440
buffer_load_dwordx4 v[180:183], v6, s[20:23], s66 offen offset:256 sc1
s_waitcnt vmcnt(27)
v_mfma_f32_16x16x32_bf16 v[32:35], v[52:55], v[204:207], v[32:35]
ds_read_b64_tr_b16 v[78:79], v11 offset:62464
buffer_load_dwordx4 v[188:191], v6, s[20:23], s66 offen offset:2304 sc1
s_waitcnt lgkmcnt(10)
v_mfma_f32_16x16x32_bf16 v[20:23], v[56:59], v[192:195], v[20:23]
ds_read_b64_tr_b16 v[48:49], v12 offset:0
s_add_u32 s66, s66, 4096
s_and_b32 s66, s66, 0xffff
s_waitcnt lgkmcnt(9)
v_mfma_f32_16x16x32_bf16 v[20:23], v[60:63], v[200:203], v[20:23]
ds_read_b64_tr_b16 v[50:51], v12 offset:1024
v_mfma_f32_16x16x32_bf16 v[36:39], v[56:59], v[196:199], v[36:39]
ds_read_b64_tr_b16 v[52:53], v12 offset:4096
v_mfma_f32_16x16x32_bf16 v[36:39], v[60:63], v[204:207], v[36:39]
ds_read_b64_tr_b16 v[54:55], v12 offset:5120
s_waitcnt lgkmcnt(10)
v_mfma_f32_16x16x32_bf16 v[24:27], v[64:67], v[192:195], v[24:27]
ds_read_b64_tr_b16 v[56:57], v13 offset:0
s_waitcnt lgkmcnt(9)
v_mfma_f32_16x16x32_bf16 v[24:27], v[68:71], v[200:203], v[24:27]
ds_read_b64_tr_b16 v[58:59], v13 offset:1024
v_mfma_f32_16x16x32_bf16 v[40:43], v[64:67], v[196:199], v[40:43]
ds_read_b64_tr_b16 v[60:61], v13 offset:4096
v_mfma_f32_16x16x32_bf16 v[40:43], v[68:71], v[204:207], v[40:43]
ds_read_b64_tr_b16 v[62:63], v13 offset:5120
s_waitcnt lgkmcnt(10)
v_mfma_f32_16x16x32_bf16 v[28:31], v[72:75], v[192:195], v[28:31]
ds_read_b64_tr_b16 v[64:65], v14 offset:0
s_waitcnt lgkmcnt(9)
v_mfma_f32_16x16x32_bf16 v[28:31], v[76:79], v[200:203], v[28:31]
ds_read_b64_tr_b16 v[66:67], v14 offset:1024
v_mfma_f32_16x16x32_bf16 v[44:47], v[72:75], v[196:199], v[44:47]
ds_read_b64_tr_b16 v[68:69], v14 offset:4096
v_mfma_f32_16x16x32_bf16 v[44:47], v[76:79], v[204:207], v[44:47]
ds_read_b64_tr_b16 v[70:71], v14 offset:5120
s_waitcnt vmcnt(27) lgkmcnt(10)
v_mfma_f32_16x16x32_bf16 v[16:19], v[48:51], v[80:83], v[16:19]
ds_read_b64_tr_b16 v[72:73], v15 offset:0
buffer_load_dwordx4 v[192:195], v6, s[20:23], s66 offen offset:0 sc1
s_waitcnt vmcnt(27) lgkmcnt(9)
v_mfma_f32_16x16x32_bf16 v[16:19], v[52:55], v[88:91], v[16:19]
ds_read_b64_tr_b16 v[74:75], v15 offset:1024
buffer_load_dwordx4 v[200:203], v6, s[20:23], s66 offen offset:2048 sc1
s_waitcnt vmcnt(27)
v_mfma_f32_16x16x32_bf16 v[32:35], v[48:51], v[84:87], v[32:35]
ds_read_b64_tr_b16 v[76:77], v15 offset:4096
buffer_load_dwordx4 v[196:199], v6, s[20:23], s66 offen offset:256 sc1
s_waitcnt vmcnt(27)
v_mfma_f32_16x16x32_bf16 v[32:35], v[52:55], v[92:95], v[32:35]
ds_read_b64_tr_b16 v[78:79], v15 offset:5120
buffer_load_dwordx4 v[204:207], v6, s[20:23], s66 offen offset:2304 sc1
s_waitcnt lgkmcnt(10)
v_mfma_f32_16x16x32_bf16 v[20:23], v[56:59], v[80:83], v[20:23]
ds_read_b64_tr_b16 v[48:49], v12 offset:8192
s_add_u32 s66, s66, 4096
s_and_b32 s66, s66, 0xffff
s_waitcnt lgkmcnt(9)
v_mfma_f32_16x16x32_bf16 v[20:23], v[60:63], v[88:91], v[20:23]
ds_read_b64_tr_b16 v[50:51], v12 offset:9216
v_mfma_f32_16x16x32_bf16 v[36:39], v[56:59], v[84:87], v[36:39]
ds_read_b64_tr_b16 v[52:53], v12 offset:12288
v_mfma_f32_16x16x32_bf16 v[36:39], v[60:63], v[92:95], v[36:39]
ds_read_b64_tr_b16 v[54:55], v12 offset:13312
s_waitcnt lgkmcnt(10)
v_mfma_f32_16x16x32_bf16 v[24:27], v[64:67], v[80:83], v[24:27]
ds_read_b64_tr_b16 v[56:57], v13 offset:8192
s_waitcnt lgkmcnt(9)
v_mfma_f32_16x16x32_bf16 v[24:27], v[68:71], v[88:91], v[24:27]
ds_read_b64_tr_b16 v[58:59], v13 offset:9216
v_mfma_f32_16x16x32_bf16 v[40:43], v[64:67], v[84:87], v[40:43]
ds_read_b64_tr_b16 v[60:61], v13 offset:12288
v_mfma_f32_16x16x32_bf16 v[40:43], v[68:71], v[92:95], v[40:43]
ds_read_b64_tr_b16 v[62:63], v13 offset:13312
s_waitcnt lgkmcnt(10)
v_mfma_f32_16x16x32_bf16 v[28:31], v[72:75], v[80:83], v[28:31]
ds_read_b64_tr_b16 v[64:65], v14 offset:8192
s_waitcnt lgkmcnt(9)
v_mfma_f32_16x16x32_bf16 v[28:31], v[76:79], v[88:91], v[28:31]
ds_read_b64_tr_b16 v[66:67], v14 offset:9216
v_mfma_f32_16x16x32_bf16 v[44:47], v[72:75], v[84:87], v[44:47]
ds_read_b64_tr_b16 v[68:69], v14 offset:12288
v_mfma_f32_16x16x32_bf16 v[44:47], v[76:79], v[92:95], v[44:47]
ds_read_b64_tr_b16 v[70:71], v14 offset:13312
s_waitcnt vmcnt(27) lgkmcnt(10)
v_mfma_f32_16x16x32_bf16 v[16:19], v[48:51], v[96:99], v[16:19]
ds_read_b64_tr_b16 v[72:73], v15 offset:8192
s_waitcnt vmcnt(26) lgkmcnt(9)
v_mfma_f32_16x16x32_bf16 v[16:19], v[52:55], v[104:107], v[16:19]
ds_read_b64_tr_b16 v[74:75], v15 offset:9216
s_waitcnt vmcnt(25)
v_mfma_f32_16x16x32_bf16 v[32:35], v[48:51], v[100:103], v[32:35]
ds_read_b64_tr_b16 v[76:77], v15 offset:12288
s_waitcnt vmcnt(24)
v_mfma_f32_16x16x32_bf16 v[32:35], v[52:55], v[108:111], v[32:35]
ds_read_b64_tr_b16 v[78:79], v15 offset:13312
s_waitcnt lgkmcnt(10)
v_mfma_f32_16x16x32_bf16 v[20:23], v[56:59], v[96:99], v[20:23]
ds_read_b64_tr_b16 v[48:49], v12 offset:16384
s_waitcnt lgkmcnt(9)
v_mfma_f32_16x16x32_bf16 v[20:23], v[60:63], v[104:107], v[20:23]
ds_read_b64_tr_b16 v[50:51], v12 offset:17408
v_mfma_f32_16x16x32_bf16 v[36:39], v[56:59], v[100:103], v[36:39]
ds_read_b64_tr_b16 v[52:53], v12 offset:20480
v_mfma_f32_16x16x32_bf16 v[36:39], v[60:63], v[108:111], v[36:39]
ds_read_b64_tr_b16 v[54:55], v12 offset:21504
s_waitcnt lgkmcnt(10)
v_mfma_f32_16x16x32_bf16 v[24:27], v[64:67], v[96:99], v[24:27]
ds_read_b64_tr_b16 v[56:57], v13 offset:16384
s_waitcnt lgkmcnt(9)
v_mfma_f32_16x16x32_bf16 v[24:27], v[68:71], v[104:107], v[24:27]
ds_read_b64_tr_b16 v[58:59], v13 offset:17408
v_mfma_f32_16x16x32_bf16 v[40:43], v[64:67], v[100:103], v[40:43]
ds_read_b64_tr_b16 v[60:61], v13 offset:20480
v_mfma_f32_16x16x32_bf16 v[40:43], v[68:71], v[108:111], v[40:43]
ds_read_b64_tr_b16 v[62:63], v13 offset:21504
s_waitcnt lgkmcnt(10)
v_mfma_f32_16x16x32_bf16 v[28:31], v[72:75], v[96:99], v[28:31]
ds_read_b64_tr_b16 v[64:65], v14 offset:16384
s_waitcnt lgkmcnt(9)
v_mfma_f32_16x16x32_bf16 v[28:31], v[76:79], v[104:107], v[28:31]
ds_read_b64_tr_b16 v[66:67], v14 offset:17408
v_mfma_f32_16x16x32_bf16 v[44:47], v[72:75], v[100:103], v[44:47]
ds_read_b64_tr_b16 v[68:69], v14 offset:20480
v_mfma_f32_16x16x32_bf16 v[44:47], v[76:79], v[108:111], v[44:47]
ds_read_b64_tr_b16 v[70:71], v14 offset:21504
s_waitcnt vmcnt(23) lgkmcnt(10)
v_mfma_f32_16x16x32_bf16 v[16:19], v[48:51], v[112:115], v[16:19]
ds_read_b64_tr_b16 v[72:73], v15 offset:16384
s_waitcnt vmcnt(22) lgkmcnt(9)
v_mfma_f32_16x16x32_bf16 v[16:19], v[52:55], v[120:123], v[16:19]
ds_read_b64_tr_b16 v[74:75], v15 offset:17408
s_waitcnt vmcnt(21)
v_mfma_f32_16x16x32_bf16 v[32:35], v[48:51], v[116:119], v[32:35]
ds_read_b64_tr_b16 v[76:77], v15 offset:20480
s_waitcnt vmcnt(20)
v_mfma_f32_16x16x32_bf16 v[32:35], v[52:55], v[124:127], v[32:35]
ds_read_b64_tr_b16 v[78:79], v15 offset:21504
s_waitcnt lgkmcnt(10)
v_mfma_f32_16x16x32_bf16 v[20:23], v[56:59], v[112:115], v[20:23]
ds_read_b64_tr_b16 v[48:49], v12 offset:24576
s_waitcnt lgkmcnt(9)
v_mfma_f32_16x16x32_bf16 v[20:23], v[60:63], v[120:123], v[20:23]
ds_read_b64_tr_b16 v[50:51], v12 offset:25600
v_mfma_f32_16x16x32_bf16 v[36:39], v[56:59], v[116:119], v[36:39]
ds_read_b64_tr_b16 v[52:53], v12 offset:28672
v_mfma_f32_16x16x32_bf16 v[36:39], v[60:63], v[124:127], v[36:39]
ds_read_b64_tr_b16 v[54:55], v12 offset:29696
s_waitcnt lgkmcnt(10)
v_mfma_f32_16x16x32_bf16 v[24:27], v[64:67], v[112:115], v[24:27]
ds_read_b64_tr_b16 v[56:57], v13 offset:24576
s_waitcnt lgkmcnt(9)
v_mfma_f32_16x16x32_bf16 v[24:27], v[68:71], v[120:123], v[24:27]
ds_read_b64_tr_b16 v[58:59], v13 offset:25600
v_mfma_f32_16x16x32_bf16 v[40:43], v[64:67], v[116:119], v[40:43]
ds_read_b64_tr_b16 v[60:61], v13 offset:28672
v_mfma_f32_16x16x32_bf16 v[40:43], v[68:71], v[124:127], v[40:43]
ds_read_b64_tr_b16 v[62:63], v13 offset:29696
s_waitcnt lgkmcnt(10)
v_mfma_f32_16x16x32_bf16 v[28:31], v[72:75], v[112:115], v[28:31]
ds_read_b64_tr_b16 v[64:65], v14 offset:24576
s_waitcnt lgkmcnt(9)
v_mfma_f32_16x16x32_bf16 v[28:31], v[76:79], v[120:123], v[28:31]
ds_read_b64_tr_b16 v[66:67], v14 offset:25600
v_mfma_f32_16x16x32_bf16 v[44:47], v[72:75], v[116:119], v[44:47]
ds_read_b64_tr_b16 v[68:69], v14 offset:28672
v_mfma_f32_16x16x32_bf16 v[44:47], v[76:79], v[124:127], v[44:47]
ds_read_b64_tr_b16 v[70:71], v14 offset:29696
s_waitcnt vmcnt(19) lgkmcnt(10)
v_mfma_f32_16x16x32_bf16 v[16:19], v[48:51], v[128:131], v[16:19]
ds_read_b64_tr_b16 v[72:73], v15 offset:24576
s_waitcnt vmcnt(18) lgkmcnt(9)
v_mfma_f32_16x16x32_bf16 v[16:19], v[52:55], v[136:139], v[16:19]
ds_read_b64_tr_b16 v[74:75], v15 offset:25600
s_waitcnt vmcnt(17)
v_mfma_f32_16x16x32_bf16 v[32:35], v[48:51], v[132:135], v[32:35]
ds_read_b64_tr_b16 v[76:77], v15 offset:28672
s_waitcnt vmcnt(16)
v_mfma_f32_16x16x32_bf16 v[32:35], v[52:55], v[140:143], v[32:35]
ds_read_b64_tr_b16 v[78:79], v15 offset:29696
s_waitcnt lgkmcnt(10)
v_mfma_f32_16x16x32_bf16 v[20:23], v[56:59], v[128:131], v[20:23]
ds_read_b64_tr_b16 v[48:49], v12 offset:32768
s_waitcnt lgkmcnt(9)
v_mfma_f32_16x16x32_bf16 v[20:23], v[60:63], v[136:139], v[20:23]
ds_read_b64_tr_b16 v[50:51], v12 offset:33792
v_mfma_f32_16x16x32_bf16 v[36:39], v[56:59], v[132:135], v[36:39]
ds_read_b64_tr_b16 v[52:53], v12 offset:36864
v_mfma_f32_16x16x32_bf16 v[36:39], v[60:63], v[140:143], v[36:39]
ds_read_b64_tr_b16 v[54:55], v12 offset:37888
s_waitcnt lgkmcnt(10)
v_mfma_f32_16x16x32_bf16 v[24:27], v[64:67], v[128:131], v[24:27]
ds_read_b64_tr_b16 v[56:57], v13 offset:32768
s_waitcnt lgkmcnt(9)
v_mfma_f32_16x16x32_bf16 v[24:27], v[68:71], v[136:139], v[24:27]
ds_read_b64_tr_b16 v[58:59], v13 offset:33792
v_mfma_f32_16x16x32_bf16 v[40:43], v[64:67], v[132:135], v[40:43]
ds_read_b64_tr_b16 v[60:61], v13 offset:36864
v_mfma_f32_16x16x32_bf16 v[40:43], v[68:71], v[140:143], v[40:43]
ds_read_b64_tr_b16 v[62:63], v13 offset:37888
s_waitcnt lgkmcnt(10)
v_mfma_f32_16x16x32_bf16 v[28:31], v[72:75], v[128:131], v[28:31]
ds_read_b64_tr_b16 v[64:65], v14 offset:32768
s_waitcnt lgkmcnt(9)
v_mfma_f32_16x16x32_bf16 v[28:31], v[76:79], v[136:139], v[28:31]
ds_read_b64_tr_b16 v[66:67], v14 offset:33792
v_mfma_f32_16x16x32_bf16 v[44:47], v[72:75], v[132:135], v[44:47]
ds_read_b64_tr_b16 v[68:69], v14 offset:36864
v_mfma_f32_16x16x32_bf16 v[44:47], v[76:79], v[140:143], v[44:47]
ds_read_b64_tr_b16 v[70:71], v14 offset:37888
s_waitcnt vmcnt(15) lgkmcnt(10)
v_mfma_f32_16x16x32_bf16 v[16:19], v[48:51], v[144:147], v[16:19]
ds_read_b64_tr_b16 v[72:73], v15 offset:32768
s_waitcnt vmcnt(14) lgkmcnt(9)
v_mfma_f32_16x16x32_bf16 v[16:19], v[52:55], v[152:155], v[16:19]
ds_read_b64_tr_b16 v[74:75], v15 offset:33792
s_waitcnt vmcnt(13)
v_mfma_f32_16x16x32_bf16 v[32:35], v[48:51], v[148:151], v[32:35]
ds_read_b64_tr_b16 v[76:77], v15 offset:36864
s_waitcnt vmcnt(12)
v_mfma_f32_16x16x32_bf16 v[32:35], v[52:55], v[156:159], v[32:35]
ds_read_b64_tr_b16 v[78:79], v15 offset:37888
s_waitcnt lgkmcnt(10)
v_mfma_f32_16x16x32_bf16 v[20:23], v[56:59], v[144:147], v[20:23]
ds_read_b64_tr_b16 v[48:49], v12 offset:40960
s_waitcnt lgkmcnt(9)
v_mfma_f32_16x16x32_bf16 v[20:23], v[60:63], v[152:155], v[20:23]
ds_read_b64_tr_b16 v[50:51], v12 offset:41984
v_mfma_f32_16x16x32_bf16 v[36:39], v[56:59], v[148:151], v[36:39]
ds_read_b64_tr_b16 v[52:53], v12 offset:45056
v_mfma_f32_16x16x32_bf16 v[36:39], v[60:63], v[156:159], v[36:39]
ds_read_b64_tr_b16 v[54:55], v12 offset:46080
s_waitcnt lgkmcnt(10)
v_mfma_f32_16x16x32_bf16 v[24:27], v[64:67], v[144:147], v[24:27]
ds_read_b64_tr_b16 v[56:57], v13 offset:40960
s_waitcnt lgkmcnt(9)
v_mfma_f32_16x16x32_bf16 v[24:27], v[68:71], v[152:155], v[24:27]
ds_read_b64_tr_b16 v[58:59], v13 offset:41984
v_mfma_f32_16x16x32_bf16 v[40:43], v[64:67], v[148:151], v[40:43]
ds_read_b64_tr_b16 v[60:61], v13 offset:45056
v_mfma_f32_16x16x32_bf16 v[40:43], v[68:71], v[156:159], v[40:43]
ds_read_b64_tr_b16 v[62:63], v13 offset:46080
s_waitcnt lgkmcnt(10)
v_mfma_f32_16x16x32_bf16 v[28:31], v[72:75], v[144:147], v[28:31]
ds_read_b64_tr_b16 v[64:65], v14 offset:40960
s_waitcnt lgkmcnt(9)
v_mfma_f32_16x16x32_bf16 v[28:31], v[76:79], v[152:155], v[28:31]
ds_read_b64_tr_b16 v[66:67], v14 offset:41984
v_mfma_f32_16x16x32_bf16 v[44:47], v[72:75], v[148:151], v[44:47]
ds_read_b64_tr_b16 v[68:69], v14 offset:45056
v_mfma_f32_16x16x32_bf16 v[44:47], v[76:79], v[156:159], v[44:47]
ds_read_b64_tr_b16 v[70:71], v14 offset:46080
s_waitcnt vmcnt(11) lgkmcnt(10)
v_mfma_f32_16x16x32_bf16 v[16:19], v[48:51], v[160:163], v[16:19]
ds_read_b64_tr_b16 v[72:73], v15 offset:40960
s_waitcnt vmcnt(10) lgkmcnt(9)
v_mfma_f32_16x16x32_bf16 v[16:19], v[52:55], v[168:171], v[16:19]
ds_read_b64_tr_b16 v[74:75], v15 offset:41984
s_waitcnt vmcnt(9)
v_mfma_f32_16x16x32_bf16 v[32:35], v[48:51], v[164:167], v[32:35]
ds_read_b64_tr_b16 v[76:77], v15 offset:45056
s_waitcnt vmcnt(8)
v_mfma_f32_16x16x32_bf16 v[32:35], v[52:55], v[172:175], v[32:35]
ds_read_b64_tr_b16 v[78:79], v15 offset:46080
s_waitcnt lgkmcnt(10)
v_mfma_f32_16x16x32_bf16 v[20:23], v[56:59], v[160:163], v[20:23]
ds_read_b64_tr_b16 v[48:49], v12 offset:49152
s_waitcnt lgkmcnt(9)
v_mfma_f32_16x16x32_bf16 v[20:23], v[60:63], v[168:171], v[20:23]
ds_read_b64_tr_b16 v[50:51], v12 offset:50176
v_mfma_f32_16x16x32_bf16 v[36:39], v[56:59], v[164:167], v[36:39]
ds_read_b64_tr_b16 v[52:53], v12 offset:53248
v_mfma_f32_16x16x32_bf16 v[36:39], v[60:63], v[172:175], v[36:39]
ds_read_b64_tr_b16 v[54:55], v12 offset:54272
s_waitcnt lgkmcnt(10)
v_mfma_f32_16x16x32_bf16 v[24:27], v[64:67], v[160:163], v[24:27]
ds_read_b64_tr_b16 v[56:57], v13 offset:49152
s_waitcnt lgkmcnt(9)
v_mfma_f32_16x16x32_bf16 v[24:27], v[68:71], v[168:171], v[24:27]
ds_read_b64_tr_b16 v[58:59], v13 offset:50176
v_mfma_f32_16x16x32_bf16 v[40:43], v[64:67], v[164:167], v[40:43]
ds_read_b64_tr_b16 v[60:61], v13 offset:53248
v_mfma_f32_16x16x32_bf16 v[40:43], v[68:71], v[172:175], v[40:43]
ds_read_b64_tr_b16 v[62:63], v13 offset:54272
s_waitcnt lgkmcnt(10)
v_mfma_f32_16x16x32_bf16 v[28:31], v[72:75], v[160:163], v[28:31]
ds_read_b64_tr_b16 v[64:65], v14 offset:49152
s_waitcnt lgkmcnt(9)
v_mfma_f32_16x16x32_bf16 v[28:31], v[76:79], v[168:171], v[28:31]
ds_read_b64_tr_b16 v[66:67], v14 offset:50176
v_mfma_f32_16x16x32_bf16 v[44:47], v[72:75], v[164:167], v[44:47]
ds_read_b64_tr_b16 v[68:69], v14 offset:53248
v_mfma_f32_16x16x32_bf16 v[44:47], v[76:79], v[172:175], v[44:47]
ds_read_b64_tr_b16 v[70:71], v14 offset:54272
s_waitcnt vmcnt(7) lgkmcnt(10)
v_mfma_f32_16x16x32_bf16 v[16:19], v[48:51], v[176:179], v[16:19]
ds_read_b64_tr_b16 v[72:73], v15 offset:49152
s_waitcnt vmcnt(6) lgkmcnt(9)
v_mfma_f32_16x16x32_bf16 v[16:19], v[52:55], v[184:187], v[16:19]
ds_read_b64_tr_b16 v[74:75], v15 offset:50176
s_waitcnt vmcnt(5)
v_mfma_f32_16x16x32_bf16 v[32:35], v[48:51], v[180:183], v[32:35]
ds_read_b64_tr_b16 v[76:77], v15 offset:53248
s_waitcnt vmcnt(4)
v_mfma_f32_16x16x32_bf16 v[32:35], v[52:55], v[188:191], v[32:35]
ds_read_b64_tr_b16 v[78:79], v15 offset:54272
s_waitcnt lgkmcnt(10)
v_mfma_f32_16x16x32_bf16 v[20:23], v[56:59], v[176:179], v[20:23]
ds_read_b64_tr_b16 v[48:49], v12 offset:57344
s_waitcnt lgkmcnt(9)
v_mfma_f32_16x16x32_bf16 v[20:23], v[60:63], v[184:187], v[20:23]
ds_read_b64_tr_b16 v[50:51], v12 offset:58368
v_mfma_f32_16x16x32_bf16 v[36:39], v[56:59], v[180:183], v[36:39]
ds_read_b64_tr_b16 v[52:53], v12 offset:61440
v_mfma_f32_16x16x32_bf16 v[36:39], v[60:63], v[188:191], v[36:39]
ds_read_b64_tr_b16 v[54:55], v12 offset:62464
s_waitcnt lgkmcnt(10)
v_mfma_f32_16x16x32_bf16 v[24:27], v[64:67], v[176:179], v[24:27]
ds_read_b64_tr_b16 v[56:57], v13 offset:57344
s_waitcnt lgkmcnt(9)
v_mfma_f32_16x16x32_bf16 v[24:27], v[68:71], v[184:187], v[24:27]
ds_read_b64_tr_b16 v[58:59], v13 offset:58368
v_mfma_f32_16x16x32_bf16 v[40:43], v[64:67], v[180:183], v[40:43]
ds_read_b64_tr_b16 v[60:61], v13 offset:61440
v_mfma_f32_16x16x32_bf16 v[40:43], v[68:71], v[188:191], v[40:43]
ds_read_b64_tr_b16 v[62:63], v13 offset:62464
s_waitcnt lgkmcnt(10)
v_mfma_f32_16x16x32_bf16 v[28:31], v[72:75], v[176:179], v[28:31]
ds_read_b64_tr_b16 v[64:65], v14 offset:57344
s_waitcnt lgkmcnt(9)
v_mfma_f32_16x16x32_bf16 v[28:31], v[76:79], v[184:187], v[28:31]
ds_read_b64_tr_b16 v[66:67], v14 offset:58368
v_mfma_f32_16x16x32_bf16 v[44:47], v[72:75], v[180:183], v[44:47]
ds_read_b64_tr_b16 v[68:69], v14 offset:61440
v_mfma_f32_16x16x32_bf16 v[44:47], v[76:79], v[188:191], v[44:47]
ds_read_b64_tr_b16 v[70:71], v14 offset:62464
s_waitcnt vmcnt(3) lgkmcnt(10)
v_mfma_f32_16x16x32_bf16 v[16:19], v[48:51], v[192:195], v[16:19]
ds_read_b64_tr_b16 v[72:73], v15 offset:57344
s_waitcnt vmcnt(2) lgkmcnt(9)
v_mfma_f32_16x16x32_bf16 v[16:19], v[52:55], v[200:203], v[16:19]
ds_read_b64_tr_b16 v[74:75], v15 offset:58368
s_waitcnt vmcnt(1)
v_mfma_f32_16x16x32_bf16 v[32:35], v[48:51], v[196:199], v[32:35]
ds_read_b64_tr_b16 v[76:77], v15 offset:61440
s_waitcnt vmcnt(0)
v_mfma_f32_16x16x32_bf16 v[32:35], v[52:55], v[204:207], v[32:35]
ds_read_b64_tr_b16 v[78:79], v15 offset:62464
s_waitcnt lgkmcnt(10)
v_mfma_f32_16x16x32_bf16 v[20:23], v[56:59], v[192:195], v[20:23]
v_add_u32 v5, s34, 22
s_mov_b64 exec, 1
ds_write_b32 v3, v5
s_mov_b64 exec, -1
s_waitcnt lgkmcnt(9)
v_mfma_f32_16x16x32_bf16 v[20:23], v[60:63], v[200:203], v[20:23]
v_mfma_f32_16x16x32_bf16 v[36:39], v[56:59], v[196:199], v[36:39]
v_mfma_f32_16x16x32_bf16 v[36:39], v[60:63], v[204:207], v[36:39]
s_waitcnt lgkmcnt(7)
v_mfma_f32_16x16x32_bf16 v[24:27], v[64:67], v[192:195], v[24:27]
s_waitcnt lgkmcnt(5)
v_mfma_f32_16x16x32_bf16 v[24:27], v[68:71], v[200:203], v[24:27]
v_mfma_f32_16x16x32_bf16 v[40:43], v[64:67], v[196:199], v[40:43]
v_mfma_f32_16x16x32_bf16 v[40:43], v[68:71], v[204:207], v[40:43]
s_waitcnt lgkmcnt(3)
v_mfma_f32_16x16x32_bf16 v[28:31], v[72:75], v[192:195], v[28:31]
s_waitcnt lgkmcnt(1)
v_mfma_f32_16x16x32_bf16 v[28:31], v[76:79], v[200:203], v[28:31]
v_mfma_f32_16x16x32_bf16 v[44:47], v[72:75], v[196:199], v[44:47]
v_mfma_f32_16x16x32_bf16 v[44:47], v[76:79], v[204:207], v[44:47]
s_lshl2_add_u32 s73, s61, s58
s_lshl4_add_u32 s66, s61, s62
s_lshl2_add_u32 s68, s66, s58
s_lshl_b32 s68, s68, 12
s_add_u32 s68, s68, 26214400
s_lshl_b32 s66, s61, 7
s_add_u32 s66, s66, s62
s_lshl_b32 s66, s66, 7
s_add_u32 s66, s66, 274432
s_lshl_b32 s74, s73, 13
s_add_u32 s74, s74, 524288
s_lshl_b32 s67, s62, 9
s_add_u32 s67, s67, s74
v_lshlrev_b32 v6, 4, v0
s_mov_b32 s69, 0x3f803f80
v_mov_b32 v8, 0
v_mov_b32 v9, 0
v_mov_b32 v10, 0
v_mov_b32 v11, 0
v_mov_b32 v12, 0
v_mov_b32 v13, 0
v_mov_b32 v14, 0
v_dot2c_f32_bf16 v11, s69, v232
v_dot2c_f32_bf16 v11, s69, v233
v_dot2c_f32_bf16 v11, s69, v234
v_dot2c_f32_bf16 v11, s69, v235
v_dot2c_f32_bf16 v11, s69, v236
v_dot2c_f32_bf16 v11, s69, v237
v_dot2c_f32_bf16 v11, s69, v238
v_dot2c_f32_bf16 v11, s69, v239
s_cmp_eq_u32 s63, 0
v_cvt_pk_bf16_f32 v240, v16, v17
v_cvt_pk_bf16_f32 v241, v18, v19
v_cvt_pk_bf16_f32 v242, v20, v21
v_cvt_pk_bf16_f32 v243, v22, v23
v_cvt_pk_bf16_f32 v244, v24, v25
v_cvt_pk_bf16_f32 v245, v26, v27
v_cvt_pk_bf16_f32 v246, v28, v29
v_cvt_pk_bf16_f32 v247, v30, v31
v_cvt_pk_bf16_f32 v248, v32, v33
v_cvt_pk_bf16_f32 v249, v34, v35
v_cvt_pk_bf16_f32 v250, v36, v37
v_cvt_pk_bf16_f32 v251, v38, v39
v_cvt_pk_bf16_f32 v252, v40, v41
v_cvt_pk_bf16_f32 v253, v42, v43
v_cvt_pk_bf16_f32 v254, v44, v45
v_cvt_pk_bf16_f32 v255, v46, v47
s_cselect_b64 exec, -1, 0
buffer_store_dwordx4 v[240:243], v6, s[20:23], s68 offen offset:0 sc1
buffer_store_dwordx4 v[244:247], v6, s[20:23], s68 offen offset:1024 sc1
buffer_store_dwordx4 v[248:251], v6, s[20:23], s68 offen offset:2048 sc1
buffer_store_dwordx4 v[252:255], v6, s[20:23], s68 offen offset:3072 sc1
s_mov_b64 exec, -1
v_dot2c_f32_bf16 v8, s69, v240
v_dot2c_f32_bf16 v9, v240, v240
v_dot2c_f32_bf16 v10, v232, v240
v_dot2c_f32_bf16 v12, s69, v248
v_dot2c_f32_bf16 v13, v248, v248
v_dot2c_f32_bf16 v14, v232, v248
v_dot2c_f32_bf16 v8, s69, v241
v_dot2c_f32_bf16 v9, v241, v241
v_dot2c_f32_bf16 v10, v233, v241
v_dot2c_f32_bf16 v12, s69, v249
v_dot2c_f32_bf16 v13, v249, v249
v_dot2c_f32_bf16 v14, v233, v249
v_dot2c_f32_bf16 v8, s69, v242
v_dot2c_f32_bf16 v9, v242, v242
v_dot2c_f32_bf16 v10, v234, v242
v_dot2c_f32_bf16 v12, s69, v250
v_dot2c_f32_bf16 v13, v250, v250
v_dot2c_f32_bf16 v14, v234, v250
v_dot2c_f32_bf16 v8, s69, v243
v_dot2c_f32_bf16 v9, v243, v243
v_dot2c_f32_bf16 v10, v235, v243
v_dot2c_f32_bf16 v12, s69, v251
v_dot2c_f32_bf16 v13, v251, v251
v_dot2c_f32_bf16 v14, v235, v251
v_dot2c_f32_bf16 v8, s69, v244
v_dot2c_f32_bf16 v9, v244, v244
v_dot2c_f32_bf16 v10, v236, v244
v_dot2c_f32_bf16 v12, s69, v252
v_dot2c_f32_bf16 v13, v252, v252
v_dot2c_f32_bf16 v14, v236, v252
v_dot2c_f32_bf16 v8, s69, v245
v_dot2c_f32_bf16 v9, v245, v245
v_dot2c_f32_bf16 v10, v237, v245
v_dot2c_f32_bf16 v12, s69, v253
v_dot2c_f32_bf16 v13, v253, v253
v_dot2c_f32_bf16 v14, v237, v253
v_dot2c_f32_bf16 v8, s69, v246
v_dot2c_f32_bf16 v9, v246, v246
v_dot2c_f32_bf16 v10, v238, v246
v_dot2c_f32_bf16 v12, s69, v254
v_dot2c_f32_bf16 v13, v254, v254
v_dot2c_f32_bf16 v14, v238, v254
v_dot2c_f32_bf16 v8, s69, v247
v_dot2c_f32_bf16 v9, v247, v247
v_dot2c_f32_bf16 v10, v239, v247
v_dot2c_f32_bf16 v12, s69, v255
v_dot2c_f32_bf16 v13, v255, v255
v_dot2c_f32_bf16 v14, v239, v255
v_mov_b32 v15, v11
v_lshrrev_b32 v7, 5, v0
v_mul_u32_u24 v7, 3584, v7
v_permlane16_swap_b32 v8, v12
v_permlane16_swap_b32 v9, v13
v_permlane16_swap_b32 v10, v14
v_permlane16_swap_b32 v11, v15
v_pk_add_f32 v[8:9], v[8:9], v[12:13]
v_pk_add_f32 v[10:11], v[10:11], v[14:15]
v_mov_b32 v12, v8
v_mov_b32 v13, v9
v_mov_b32 v14, v10
v_mov_b32 v15, v11
v_permlane32_swap_b32 v12, v8
v_permlane32_swap_b32 v13, v9
v_permlane32_swap_b32 v14, v10
v_permlane32_swap_b32 v15, v11
v_pk_add_f32 v[8:9], v[8:9], v[12:13]
v_pk_add_f32 v[10:11], v[10:11], v[14:15]
v_add_u32 v7, v6, v7
v_max_u32 v8, 1, v8
v_max_u32 v9, 1, v9
v_max_u32 v10, 1, v10
v_max_u32 v11, 1, v11
s_mov_b32 exec_hi, 0
buffer_store_dwordx4 v[8:11], v6, s[24:27], s67 offen sc1
s_mov_b32 exec_hi, -1
v_lshlrev_b32 v16, 16, v240
v_and_b32 v17, 0xffff0000, v240
v_lshlrev_b32 v18, 16, v241
v_and_b32 v19, 0xffff0000, v241
v_lshlrev_b32 v20, 16, v242
v_and_b32 v21, 0xffff0000, v242
v_lshlrev_b32 v22, 16, v243
v_and_b32 v23, 0xffff0000, v243
v_lshlrev_b32 v24, 16, v244
v_and_b32 v25, 0xffff0000, v244
v_lshlrev_b32 v26, 16, v245
v_and_b32 v27, 0xffff0000, v245
v_lshlrev_b32 v28, 16, v246
v_and_b32 v29, 0xffff0000, v246
v_lshlrev_b32 v30, 16, v247
v_and_b32 v31, 0xffff0000, v247
v_lshlrev_b32 v32, 16, v248
v_and_b32 v33, 0xffff0000, v248
v_lshlrev_b32 v34, 16, v249
v_and_b32 v35, 0xffff0000, v249
v_lshlrev_b32 v36, 16, v250
v_and_b32 v37, 0xffff0000, v250
v_lshlrev_b32 v38, 16, v251
v_and_b32 v39, 0xffff0000, v251
v_lshlrev_b32 v40, 16, v252
v_and_b32 v41, 0xffff0000, v252
v_lshlrev_b32 v42, 16, v253
v_and_b32 v43, 0xffff0000, v253
v_lshlrev_b32 v44, 16, v254
v_and_b32 v45, 0xffff0000, v254
v_lshlrev_b32 v46, 16, v255
v_and_b32 v47, 0xffff0000, v255
v_and_b32 v14, 15, v0
v_lshlrev_b32 v14, 11, v14
v_bfe_u32 v15, v0, 4, 1
v_lshl_add_u32 v14, v15, 5, v14
v_lshrrev_b32 v15, 5, v0
v_lshl_add_u32 v14, v15, 4, v14
s_lshl2_add_u32 s70, s61, s58
s_lshl_b32 s70, s70, 16
s_lshl_b32 s71, s62, 7
s_add_u32 s70, s70, s71
s_add_u32 s71, s70, 0x8000
s_lshl_b32 s67, s62, 6
s_sub_u32 s68, s66, 2048
s_lshl1_add_u32 s69, s67, s68
s_sub_u32 s69, s69, 10240
s_sub_u32 s72, s68, s67
s_add_u32 s72, s72, 4096
s_lshl_b32 s75, s73, 5
s_add_u32 s75, s75, 1
v_and_b32 v15, 48, v0
v_add_u32 v13, s75, v0
v_lshlrev_b32 v4, 1, v15
s_mov_b64 exec, 1
s_waitcnt vmcnt(1)
buffer_store_dword v212, v3, s[24:27], s66 offen sc1
s_mov_b64 exec, -1
v_add_u32 v5, s34, 23
s_mov_b64 exec, 1
ds_write_b32 v3, v5
s_mov_b64 exec, -1
s_waitcnt vmcnt(1)
poll_140:
buffer_load_dwordx4 v[80:83], v7, s[24:27], s74 offen offset:0 sc1
buffer_load_dwordx4 v[84:87], v7, s[24:27], s74 offen offset:512 sc1
buffer_load_dwordx4 v[88:91], v7, s[24:27], s74 offen offset:1024 sc1
buffer_load_dwordx4 v[92:95], v7, s[24:27], s74 offen offset:1536 sc1
buffer_load_dwordx4 v[96:99], v7, s[24:27], s74 offen offset:2048 sc1
buffer_load_dwordx4 v[100:103], v7, s[24:27], s74 offen offset:2560 sc1
buffer_load_dwordx4 v[104:107], v7, s[24:27], s74 offen offset:3072 sc1
buffer_load_dwordx4 v[108:111], v7, s[24:27], s74 offen offset:3584 sc1
pchk_141:
s_waitcnt vmcnt(7)
v_min3_u32 v8, v80, v81, v82
s_waitcnt vmcnt(6)
v_min3_u32 v8, v8, v83, v84
v_min3_u32 v8, v8, v85, v86
s_waitcnt vmcnt(5)
v_min3_u32 v8, v8, v87, v88
v_min3_u32 v8, v8, v89, v90
s_waitcnt vmcnt(4)
v_min3_u32 v8, v8, v91, v92
v_min3_u32 v8, v8, v93, v94
s_waitcnt vmcnt(3)
v_min3_u32 v8, v8, v95, v96
v_min3_u32 v8, v8, v97, v98
s_waitcnt vmcnt(2)
v_min3_u32 v8, v8, v99, v100
v_min3_u32 v8, v8, v101, v102
s_waitcnt vmcnt(1)
v_min3_u32 v8, v8, v103, v104
v_min3_u32 v8, v8, v105, v106
s_waitcnt vmcnt(0)
v_min3_u32 v8, v8, v107, v108
v_min3_u32 v8, v8, v109, v110
v_min_u32 v8, v8, v111
v_cmp_eq_u32 vcc, 0, v8
s_cbranch_vccz pdone_142
s_sub_u32 s32, s32, 1
s_cmp_gt_i32 s32, 0
s_cbranch_scc1 poll_140
pdone_142:
v_pk_add_f32 v[80:81], v[80:81], v[96:97]
v_pk_add_f32 v[82:83], v[82:83], v[98:99]
v_pk_add_f32 v[84:85], v[84:85], v[100:101]
v_pk_add_f32 v[86:87], v[86:87], v[102:103]
v_pk_add_f32 v[88:89], v[88:89], v[104:105]
v_pk_add_f32 v[90:91], v[90:91], v[106:107]
v_pk_add_f32 v[92:93], v[92:93], v[108:109]
v_pk_add_f32 v[94:95], v[94:95], v[110:111]
v_pk_add_f32 v[80:81], v[80:81], v[88:89]
v_pk_add_f32 v[82:83], v[82:83], v[90:91]
v_pk_add_f32 v[84:85], v[84:85], v[92:93]
v_pk_add_f32 v[86:87], v[86:87], v[94:95]
v_pk_add_f32 v[80:81], v[80:81], v[84:85]
v_pk_add_f32 v[82:83], v[82:83], v[86:87]
v_mov_b32 v8, v80
v_mov_b32 v9, v81
v_mov_b32 v10, v82
v_mov_b32 v11, v83
v_permlane32_swap_b32 v8, v80
v_permlane32_swap_b32 v9, v81
v_permlane32_swap_b32 v10, v82
v_permlane32_swap_b32 v11, v83
v_pk_add_f32 v[8:9], v[8:9], v[80:81]
v_pk_add_f32 v[10:11], v[10:11], v[82:83]
v_mul_f32 v8, 0xba800000, v8
v_mul_f32 v9, 0x3a800000, v9
v_fma_f32 v9, -v8, v8, v9
v_max_f32 v9, 0, v9
v_add_f32 v12, 0x3727c5ac, v9
v_rsq_f32 v80, v12
v_fma_f32 v10, v8, v11, v10
v_mul_f32 v12, v80, v10
v_max_u32 v12, 1, v12
v_add_u32 v7, s34, v3
v_mov_b32 v6, v12
s_nop 1
v_max_f32_dpp v6, v6, v6 row_ror:1 row_mask:0xf bank_mask:0xf
s_nop 1
v_max_f32_dpp v6, v6, v6 row_ror:2 row_mask:0xf bank_mask:0xf
s_nop 1
v_max_f32_dpp v6, v6, v6 row_ror:4 row_mask:0xf bank_mask:0xf
s_nop 1
v_max_f32_dpp v6, v6, v6 row_ror:8 row_mask:0xf bank_mask:0xf
v_mov_b32 v11, v6
s_nop 1
v_permlane16_swap_b32 v11, v6
v_max_f32 v6, v6, v11
v_cmp_eq_f32 vcc, v6, v12
s_ff1_i32_b64 s66, vcc
s_and_b32 s66, s66, 31
s_mov_b64 exec, 1
ds_write_b32 v7, v6 offset:256
s_mov_b64 exec, -1
v_add_u32 v7, s34, v1
v_mul_f32 v81, v8, v80
v_add_f32 v10, 1.0, v80
v_mov_b32 v82, v80
v_mov_b32 v83, v81
s_and_b32 s67, s66, 15
s_lshl_b32 s67, 0x10001, s67
s_bitcmp0_b32 s66, 4
v_permlane16_swap_b32 v80, v82
v_permlane16_swap_b32 v81, v83
s_cselect_b32 s76, s67, 0
s_cselect_b32 s78, 0, s67
s_cselect_b32 s77, s67, 0
s_cselect_b32 s79, 0, s67
s_add_u32 s75, s75, s66
v_pk_fma_f32 v[48:49], v[16:17], v[80:81], v[80:81] op_sel:[0,0,1] op_sel_hi:[1,0,1]
v_pk_fma_f32 v[50:51], v[18:19], v[80:81], v[80:81] op_sel:[0,0,1] op_sel_hi:[1,0,1]
v_pk_fma_f32 v[52:53], v[20:21], v[80:81], v[80:81] op_sel:[0,0,1] op_sel_hi:[1,0,1]
v_pk_fma_f32 v[54:55], v[22:23], v[80:81], v[80:81] op_sel:[0,0,1] op_sel_hi:[1,0,1]
v_pk_fma_f32 v[56:57], v[24:25], v[80:81], v[80:81] op_sel:[0,0,1] op_sel_hi:[1,0,1]
v_pk_fma_f32 v[58:59], v[26:27], v[80:81], v[80:81] op_sel:[0,0,1] op_sel_hi:[1,0,1]
v_pk_fma_f32 v[60:61], v[28:29], v[80:81], v[80:81] op_sel:[0,0,1] op_sel_hi:[1,0,1]
v_pk_fma_f32 v[62:63], v[30:31], v[80:81], v[80:81] op_sel:[0,0,1] op_sel_hi:[1,0,1]
v_pk_fma_f32 v[64:65], v[32:33], v[82:83], v[82:83] op_sel:[0,0,1] op_sel_hi:[1,0,1]
v_pk_fma_f32 v[66:67], v[34:35], v[82:83], v[82:83] op_sel:[0,0,1] op_sel_hi:[1,0,1]
v_pk_fma_f32 v[68:69], v[36:37], v[82:83], v[82:83] op_sel:[0,0,1] op_sel_hi:[1,0,1]
v_pk_fma_f32 v[70:71], v[38:39], v[82:83], v[82:83] op_sel:[0,0,1] op_sel_hi:[1,0,1]
v_pk_fma_f32 v[72:73], v[40:41], v[82:83], v[82:83] op_sel:[0,0,1] op_sel_hi:[1,0,1]
v_pk_fma_f32 v[74:75], v[42:43], v[82:83], v[82:83] op_sel:[0,0,1] op_sel_hi:[1,0,1]
v_pk_fma_f32 v[76:77], v[44:45], v[82:83], v[82:83] op_sel:[0,0,1] op_sel_hi:[1,0,1]
v_pk_fma_f32 v[78:79], v[46:47], v[82:83], v[82:83] op_sel:[0,0,1] op_sel_hi:[1,0,1]
v_cvt_pk_bf16_f32 v84, v48, v49
v_cvt_pk_bf16_f32 v85, v50, v51
v_cvt_pk_bf16_f32 v86, v52, v53
v_cvt_pk_bf16_f32 v87, v54, v55
v_cvt_pk_bf16_f32 v88, v56, v57
v_cvt_pk_bf16_f32 v89, v58, v59
v_cvt_pk_bf16_f32 v90, v60, v61
v_cvt_pk_bf16_f32 v91, v62, v63
v_cvt_pk_bf16_f32 v92, v64, v65
v_cvt_pk_bf16_f32 v93, v66, v67
v_cvt_pk_bf16_f32 v94, v68, v69
v_cvt_pk_bf16_f32 v95, v70, v71
v_cvt_pk_bf16_f32 v96, v72, v73
v_cvt_pk_bf16_f32 v97, v74, v75
v_cvt_pk_bf16_f32 v98, v76, v77
v_cvt_pk_bf16_f32 v99, v78, v79
ds_read_b32 v11, v7 offset:256
v_max_u32 v84, 1, v84
v_max_u32 v85, 1, v85
v_max_u32 v86, 1, v86
v_max_u32 v87, 1, v87
v_max_u32 v88, 1, v88
v_max_u32 v89, 1, v89
v_max_u32 v90, 1, v90
v_max_u32 v91, 1, v91
v_max_u32 v92, 1, v92
v_max_u32 v93, 1, v93
v_max_u32 v94, 1, v94
v_max_u32 v95, 1, v95
v_max_u32 v96, 1, v96
v_max_u32 v97, 1, v97
v_max_u32 v98, 1, v98
v_max_u32 v99, 1, v99
s_branch pchk_144
poll_143:
ds_read_b32 v11, v7 offset:256
pchk_144:
s_waitcnt lgkmcnt(0)
v_cmp_eq_u32 vcc, 0, v11
s_cbranch_vccz pdone_145
s_sub_u32 s32, s32, 1
s_cmp_gt_i32 s32, 0
s_cbranch_scc1 poll_143
pdone_145:
v_cmp_eq_f32 vcc, v11, v6
s_bfm_b32 s67, s58, 0
s_and_b32 s67, s67, vcc_lo
v_cmp_gt_f32 vcc, v11, v6
s_lshl_b32 s66, 1, s66
s_or_b32 s67, s67, vcc_lo
s_cselect_b64 s[76:77], 0, s[76:77]
s_cselect_b64 s[78:79], 0, s[78:79]
s_cselect_b64 exec, 0, s[66:67]
s_bitcmp0_b32 s62, 0
s_cselect_b64 exec, exec, 0
buffer_store_dwordx2 v[12:13], off, s[24:27], s72 sc1
s_mov_b64 exec, s[76:77]
buffer_store_dwordx4 v[84:87], v4, s[24:27], s68 offen offset:0 sc1
buffer_store_dwordx4 v[88:91], v4, s[24:27], s68 offen offset:16 sc1
s_mov_b64 exec, s[78:79]
buffer_store_dwordx4 v[92:95], v4, s[24:27], s68 offen offset:0 sc1
buffer_store_dwordx4 v[96:99], v4, s[24:27], s68 offen offset:16 sc1
s_mov_b64 exec, -1
v_add_u32 v5, s34, 24
s_mov_b64 exec, 1
ds_write_b32 v3, v5
s_mov_b64 exec, -1
v_pk_add_f32 v[16:17], v[16:17], v[48:49]
v_pk_add_f32 v[18:19], v[18:19], v[50:51]
v_pk_add_f32 v[20:21], v[20:21], v[52:53]
v_pk_add_f32 v[22:23], v[22:23], v[54:55]
v_pk_add_f32 v[24:25], v[24:25], v[56:57]
v_pk_add_f32 v[26:27], v[26:27], v[58:59]
v_pk_add_f32 v[28:29], v[28:29], v[60:61]
v_pk_add_f32 v[30:31], v[30:31], v[62:63]
v_pk_add_f32 v[32:33], v[32:33], v[64:65]
v_pk_add_f32 v[34:35], v[34:35], v[66:67]
v_pk_add_f32 v[36:37], v[36:37], v[68:69]
v_pk_add_f32 v[38:39], v[38:39], v[70:71]
v_pk_add_f32 v[40:41], v[40:41], v[72:73]
v_pk_add_f32 v[42:43], v[42:43], v[74:75]
v_pk_add_f32 v[44:45], v[44:45], v[76:77]
v_pk_add_f32 v[46:47], v[46:47], v[78:79]
v_cvt_pk_bf16_f32 v240, v16, v17
v_cvt_pk_bf16_f32 v241, v18, v19
v_cvt_pk_bf16_f32 v242, v20, v21
v_cvt_pk_bf16_f32 v243, v22, v23
v_cvt_pk_bf16_f32 v244, v24, v25
v_cvt_pk_bf16_f32 v245, v26, v27
v_cvt_pk_bf16_f32 v246, v28, v29
v_cvt_pk_bf16_f32 v247, v30, v31
v_cvt_pk_bf16_f32 v248, v32, v33
v_cvt_pk_bf16_f32 v249, v34, v35
v_cvt_pk_bf16_f32 v250, v36, v37
v_cvt_pk_bf16_f32 v251, v38, v39
v_cvt_pk_bf16_f32 v252, v40, v41
v_cvt_pk_bf16_f32 v253, v42, v43
v_cvt_pk_bf16_f32 v254, v44, v45
v_cvt_pk_bf16_f32 v255, v46, v47
v_max_u32 v16, 1, v16
v_max_u32 v17, 1, v17
v_max_u32 v18, 1, v18
v_max_u32 v19, 1, v19
v_max_u32 v20, 1, v20
v_max_u32 v21, 1, v21
v_max_u32 v22, 1, v22
v_max_u32 v23, 1, v23
v_max_u32 v24, 1, v24
v_max_u32 v25, 1, v25
v_max_u32 v26, 1, v26
v_max_u32 v27, 1, v27
v_max_u32 v28, 1, v28
v_max_u32 v29, 1, v29
v_max_u32 v30, 1, v30
v_max_u32 v31, 1, v31
v_max_u32 v32, 1, v32
v_max_u32 v33, 1, v33
v_max_u32 v34, 1, v34
v_max_u32 v35, 1, v35
v_max_u32 v36, 1, v36
v_max_u32 v37, 1, v37
v_max_u32 v38, 1, v38
v_max_u32 v39, 1, v39
v_max_u32 v40, 1, v40
v_max_u32 v41, 1, v41
v_max_u32 v42, 1, v42
v_max_u32 v43, 1, v43
v_max_u32 v44, 1, v44
v_max_u32 v45, 1, v45
v_max_u32 v46, 1, v46
v_max_u32 v47, 1, v47
s_mov_b64 exec, s[76:77]
buffer_store_dwordx4 v[16:19], v15, s[24:27], s69 offen offset:0 sc1
buffer_store_dwordx4 v[20:23], v15, s[24:27], s69 offen offset:64 sc1
buffer_store_dwordx4 v[24:27], v15, s[24:27], s69 offen offset:128 sc1
buffer_store_dwordx4 v[28:31], v15, s[24:27], s69 offen offset:192 sc1
s_mov_b64 exec, s[78:79]
buffer_store_dwordx4 v[32:35], v15, s[24:27], s69 offen offset:0 sc1
buffer_store_dwordx4 v[36:39], v15, s[24:27], s69 offen offset:64 sc1
buffer_store_dwordx4 v[40:43], v15, s[24:27], s69 offen offset:128 sc1
buffer_store_dwordx4 v[44:47], v15, s[24:27], s69 offen offset:192 sc1
s_mov_b64 exec, -1
s_cmp_eq_u32 s63, 0
s_cbranch_scc0 mout_146
v_mul_f32 v11, v10, v10
v_mov_b32 v12, 0x3727c5ac
v_fma_f32 v11, v11, v9, v12
v_rsq_f32 v11, v11
v_lshrrev_b32 v12, 3, v0
v_lshlrev_b32 v12, 6, v12
v_lshl_add_u32 v12, v0, 3, v12
v_mul_f32 v10, v10, v11
v_mul_f32 v11, v8, v10
s_lshl_b32 s66, s61, 5
s_add_u32 s66, s66, s58
s_lshl_b32 s66, s66, 9
s_add_u32 s66, s66, 1675264
v_max_u32 v11, 1, v11
s_cmp_eq_u32 s62, 8
s_cselect_b32 exec_lo, -1, 0
s_mov_b32 exec_hi, 0
buffer_store_dwordx2 v[10:11], v12, s[24:27], s66 offen sc1
s_mov_b64 exec, -1
s_mov_b32 s63, 1
s_mov_b32 s34, 32
s_add_u32 s24, s24, 1409024
s_addc_u32 s25, s25, 0
s_mov_b32 s26, 1409024
s_branch L_mtop
mout_146:
v_permlane16_swap_b32 v240, v242
v_permlane16_swap_b32 v241, v243
v_permlane16_swap_b32 v244, v246
v_permlane16_swap_b32 v245, v247
v_permlane16_swap_b32 v248, v250
v_permlane16_swap_b32 v249, v251
v_permlane16_swap_b32 v252, v254
v_permlane16_swap_b32 v253, v255
s_not_b64 exec, s[76:77]
buffer_store_dwordx4 v[240:243], v14, s[28:31], s70 offen offset:0
buffer_store_dwordx4 v[244:247], v14, s[28:31], s70 offen offset:64
s_not_b64 exec, s[78:79]
buffer_store_dwordx4 v[248:251], v14, s[28:31], s71 offen offset:0
buffer_store_dwordx4 v[252:255], v14, s[28:31], s71 offen offset:64
s_mov_b64 exec, -1
s_or_b32 s66, s76, s78
s_cbranch_scc0 L_end
v_mov_b32 v11, 0
s_add_u32 s35, s34, 4
lw_147:
ds_read_b32 v5, v2 offset:24
s_waitcnt lgkmcnt(0)
v_cmp_gt_i32 vcc, s35, v5
s_cbranch_vccz lwd_148
s_sleep 2
s_sub_u32 s32, s32, 1
s_cmp_gt_i32 s32, 0
s_cbranch_scc1 lw_147
lwd_148:
ds_read_b32 v11, v11 offset:32
s_waitcnt lgkmcnt(0)
v_cmp_eq_u32 vcc, s75, v11
s_cbranch_vccnz L_end
s_mov_b64 exec, s[76:77]
buffer_store_dwordx4 v[240:243], v14, s[28:31], s70 offen offset:0
buffer_store_dwordx4 v[244:247], v14, s[28:31], s70 offen offset:64
s_mov_b64 exec, s[78:79]
buffer_store_dwordx4 v[248:251], v14, s[28:31], s71 offen offset:0
buffer_store_dwordx4 v[252:255], v14, s[28:31], s71 offen offset:64
s_mov_b64 exec, -1
s_branch L_end
mspin_113:
s_cmp_eq_u32 s66, 1
s_cbranch_scc1 mback_114
msp_149:
ds_read_b32 v5, v2 offset:16
s_waitcnt lgkmcnt(0)
v_cmp_ge_u32 vcc, v4, v5
s_cbranch_vccz mback_114
s_sub_u32 s32, s32, 1
s_cmp_gt_i32 s32, 0
s_cbranch_scc1 msp_149
s_branch mback_114
patch_117:
s_bfe_u32 s66, s33, 0x20005
s_lshr_b32 s67, s66, 1
s_xor_b32 s66, s66, s67
s_and_b32 s66, s66, 1
s_cmp_eq_u32 s66, s65
s_cbranch_scc0 pback_118
s_lshl_b32 s67, s67, 5
s_and_b32 s66, s33, 31
s_add_u32 s66, s66, s67
v_and_b32 v10, 15, v0
v_sub_u32 v10, s66, v10
v_lshrrev_b32 v11, 4, v0
v_lshlrev_b32 v11, 2, v11
v_sub_u32 v11, s66, v11
v_cmp_eq_u32 vcc, 0, v10
s_mov_b64 exec, vcc
ds_read_b128 v[16:19], v9 offset:3456
ds_read_b128 v[20:23], v9 offset:3520
ds_read_b128 v[80:83], v9 offset:3328
ds_read_b128 v[84:87], v9 offset:3392
s_mov_b64 exec, -1
v_cmp_eq_u32 vcc, 0, v11
s_mov_b64 exec, vcc
ds_read_b32 v48, v8 offset:3584
ds_read_b32 v52, v8 offset:3648
s_mov_b64 exec, -1
v_cmp_eq_u32 vcc, 1, v11
s_mov_b64 exec, vcc
ds_read_b32 v49, v8 offset:3584
ds_read_b32 v53, v8 offset:3648
s_mov_b64 exec, -1
v_cmp_eq_u32 vcc, 2, v11
s_mov_b64 exec, vcc
ds_read_b32 v50, v8 offset:3584
ds_read_b32 v54, v8 offset:3648
s_mov_b64 exec, -1
v_cmp_eq_u32 vcc, 3, v11
s_mov_b64 exec, vcc
ds_read_b32 v51, v8 offset:3584
ds_read_b32 v55, v8 offset:3648
s_mov_b64 exec, -1
s_waitcnt lgkmcnt(0)
v_cmp_eq_u32 vcc, 16, v10
s_mov_b64 exec, vcc
ds_read_b128 v[24:27], v9 offset:3456
ds_read_b128 v[28:31], v9 offset:3520
ds_read_b128 v[88:91], v9 offset:3328
ds_read_b128 v[92:95], v9 offset:3392
s_mov_b64 exec, -1
v_cmp_eq_u32 vcc, 16, v11
s_mov_b64 exec, vcc
ds_read_b32 v56, v8 offset:3584
ds_read_b32 v60, v8 offset:3648
s_mov_b64 exec, -1
v_cmp_eq_u32 vcc, 17, v11
s_mov_b64 exec, vcc
ds_read_b32 v57, v8 offset:3584
ds_read_b32 v61, v8 offset:3648
s_mov_b64 exec, -1
v_cmp_eq_u32 vcc, 18, v11
s_mov_b64 exec, vcc
ds_read_b32 v58, v8 offset:3584
ds_read_b32 v62, v8 offset:3648
s_mov_b64 exec, -1
v_cmp_eq_u32 vcc, 19, v11
s_mov_b64 exec, vcc
ds_read_b32 v59, v8 offset:3584
ds_read_b32 v63, v8 offset:3648
s_mov_b64 exec, -1
s_waitcnt lgkmcnt(0)
v_cmp_eq_u32 vcc, 32, v10
s_mov_b64 exec, vcc
ds_read_b128 v[32:35], v9 offset:3456
ds_read_b128 v[36:39], v9 offset:3520
ds_read_b128 v[96:99], v9 offset:3328
ds_read_b128 v[100:103], v9 offset:3392
s_mov_b64 exec, -1
v_cmp_eq_u32 vcc, 32, v11
s_mov_b64 exec, vcc
ds_read_b32 v64, v8 offset:3584
ds_read_b32 v68, v8 offset:3648
s_mov_b64 exec, -1
v_cmp_eq_u32 vcc, 33, v11
s_mov_b64 exec, vcc
ds_read_b32 v65, v8 offset:3584
ds_read_b32 v69, v8 offset:3648
s_mov_b64 exec, -1
v_cmp_eq_u32 vcc, 34, v11
s_mov_b64 exec, vcc
ds_read_b32 v66, v8 offset:3584
ds_read_b32 v70, v8 offset:3648
s_mov_b64 exec, -1
v_cmp_eq_u32 vcc, 35, v11
s_mov_b64 exec, vcc
ds_read_b32 v67, v8 offset:3584
ds_read_b32 v71, v8 offset:3648
s_mov_b64 exec, -1
s_waitcnt lgkmcnt(0)
v_cmp_eq_u32 vcc, 48, v10
s_mov_b64 exec, vcc
ds_read_b128 v[40:43], v9 offset:3456
ds_read_b128 v[44:47], v9 offset:3520
ds_read_b128 v[104:107], v9 offset:3328
ds_read_b128 v[108:111], v9 offset:3392
s_mov_b64 exec, -1
v_cmp_eq_u32 vcc, 48, v11
s_mov_b64 exec, vcc
ds_read_b32 v72, v8 offset:3584
ds_read_b32 v76, v8 offset:3648
s_mov_b64 exec, -1
v_cmp_eq_u32 vcc, 49, v11
s_mov_b64 exec, vcc
ds_read_b32 v73, v8 offset:3584
ds_read_b32 v77, v8 offset:3648
s_mov_b64 exec, -1
v_cmp_eq_u32 vcc, 50, v11
s_mov_b64 exec, vcc
ds_read_b32 v74, v8 offset:3584
ds_read_b32 v78, v8 offset:3648
s_mov_b64 exec, -1
v_cmp_eq_u32 vcc, 51, v11
s_mov_b64 exec, vcc
ds_read_b32 v75, v8 offset:3584
ds_read_b32 v79, v8 offset:3648
s_mov_b64 exec, -1
s_waitcnt lgkmcnt(0)
s_branch pback_118
cross_128:
s_cmp_eq_u32 s67, 122880
s_cbranch_scc0 cr2_150
v_add_u32 v5, s34, 18
s_mov_b64 exec, 1
ds_write_b32 v3, v5
s_mov_b64 exec, -1
s_add_u32 s70, s72, 270336
s_mov_b64 exec, 1
s_waitcnt vmcnt(0)
buffer_store_dword v5, v3, s[24:27], s70 offen sc1
s_mov_b64 exec, -1
v_mov_b32 v9, 0xf149f2ca
v_xor_b32 v216, v9, v216
v_xor_b32 v217, v9, v217
v_xor_b32 v218, v9, v218
v_xor_b32 v219, v9, v219
v_xor_b32 v220, v9, v220
v_xor_b32 v221, v9, v221
v_xor_b32 v222, v9, v222
v_xor_b32 v223, v9, v223
v_xor_b32 v224, v9, v224
v_xor_b32 v225, v9, v225
v_xor_b32 v226, v9, v226
v_xor_b32 v227, v9, v227
v_xor_b32 v228, v9, v228
v_xor_b32 v229, v9, v229
v_xor_b32 v230, v9, v230
v_xor_b32 v231, v9, v231
s_mov_b32 s67, 90112
s_cmp_eq_u32 s63, 0
s_cbranch_scc0 cr3_151
v_and_b32 v9, 15, v0
v_lshlrev_b32 v9, 11, v9
v_bfe_u32 v10, v0, 4, 1
v_lshl_add_u32 v9, v10, 5, v9
v_lshrrev_b32 v10, 5, v0
v_lshl_add_u32 v9, v10, 4, v9
s_lshl2_add_u32 s70, s61, s58
s_lshl_b32 s70, s70, 16
s_lshl_b32 s71, s62, 7
s_add_u32 s70, s70, s71
s_add_u32 s71, s70, 0x8000
buffer_load_dwordx4 v[240:243], v9, s[8:11], s70 offen offset:0
buffer_load_dwordx4 v[244:247], v9, s[8:11], s70 offen offset:64
buffer_load_dwordx4 v[248:251], v9, s[8:11], s71 offen offset:0
buffer_load_dwordx4 v[252:255], v9, s[8:11], s71 offen offset:64
cr3_151:
s_cmp_eq_u32 s59, 0
s_cbranch_scc1 cback_129
v_mov_b32 v9, 0
s_add_u32 s35, s34, 17
lw_152:
ds_read_b32 v5, v9 offset:16
s_waitcnt lgkmcnt(0)
v_cmp_gt_i32 vcc, s35, v5
s_cbranch_vccz lwd_153
s_sub_u32 s32, s32, 1
s_cmp_gt_i32 s32, 0
s_cbranch_scc1 lw_152
lwd_153:
s_branch cback_129
cr2_150:
v_add_u32 v5, s34, 19
s_mov_b64 exec, 1
ds_write_b32 v3, v5
s_mov_b64 exec, -1
s_mov_b32 s66, 28672
s_cmp_lt_u32 s59, 2
s_cbranch_scc1 cback_129
s_add_u32 s35, s34, 17
lw_154:
ds_read_b32 v5, v2 offset:16
s_waitcnt lgkmcnt(0)
v_cmp_gt_i32 vcc, s35, v5
s_cbranch_vccz lwd_155
s_sub_u32 s32, s32, 1
s_cmp_gt_i32 s32, 0
s_cbranch_scc1 lw_154
lwd_155:
s_branch cback_129
cross_130:
s_cmp_eq_u32 s67, 122880
s_cbranch_scc0 cr2_156
v_add_u32 v5, s34, 18
s_mov_b64 exec, 1
ds_write_b32 v3, v5
s_mov_b64 exec, -1
s_add_u32 s70, s72, 270336
s_mov_b64 exec, 1
s_waitcnt vmcnt(0)
buffer_store_dword v5, v3, s[24:27], s70 offen sc1
s_mov_b64 exec, -1
v_mov_b32 v9, 0xf149f2ca
v_xor_b32 v216, v9, v216
v_xor_b32 v217, v9, v217
v_xor_b32 v218, v9, v218
v_xor_b32 v219, v9, v219
v_xor_b32 v220, v9, v220
v_xor_b32 v221, v9, v221
v_xor_b32 v222, v9, v222
v_xor_b32 v223, v9, v223
v_xor_b32 v224, v9, v224
v_xor_b32 v225, v9, v225
v_xor_b32 v226, v9, v226
v_xor_b32 v227, v9, v227
v_xor_b32 v228, v9, v228
v_xor_b32 v229, v9, v229
v_xor_b32 v230, v9, v230
v_xor_b32 v231, v9, v231
s_mov_b32 s67, 90112
s_cmp_eq_u32 s63, 0
s_cbranch_scc0 cr3_157
v_and_b32 v9, 15, v0
v_lshlrev_b32 v9, 11, v9
v_bfe_u32 v10, v0, 4, 1
v_lshl_add_u32 v9, v10, 5, v9
v_lshrrev_b32 v10, 5, v0
v_lshl_add_u32 v9, v10, 4, v9
s_lshl2_add_u32 s70, s61, s58
s_lshl_b32 s70, s70, 16
s_lshl_b32 s71, s62, 7
s_add_u32 s70, s70, s71
s_add_u32 s71, s70, 0x8000
buffer_load_dwordx4 v[240:243], v9, s[8:11], s70 offen offset:0
buffer_load_dwordx4 v[244:247], v9, s[8:11], s70 offen offset:64
buffer_load_dwordx4 v[248:251], v9, s[8:11], s71 offen offset:0
buffer_load_dwordx4 v[252:255], v9, s[8:11], s71 offen offset:64
cr3_157:
s_cmp_eq_u32 s59, 0
s_cbranch_scc1 cback_131
v_mov_b32 v9, 0
s_add_u32 s35, s34, 17
lw_158:
ds_read_b32 v5, v9 offset:16
s_waitcnt lgkmcnt(0)
v_cmp_gt_i32 vcc, s35, v5
s_cbranch_vccz lwd_159
s_sub_u32 s32, s32, 1
s_cmp_gt_i32 s32, 0
s_cbranch_scc1 lw_158
lwd_159:
s_branch cback_131
cr2_156:
v_add_u32 v5, s34, 19
s_mov_b64 exec, 1
ds_write_b32 v3, v5
s_mov_b64 exec, -1
s_mov_b32 s66, 28672
s_cmp_lt_u32 s59, 2
s_cbranch_scc1 cback_131
s_add_u32 s35, s34, 17
lw_160:
ds_read_b32 v5, v2 offset:16
s_waitcnt lgkmcnt(0)
v_cmp_gt_i32 vcc, s35, v5
s_cbranch_vccz lwd_161
s_sub_u32 s32, s32, 1
s_cmp_gt_i32 s32, 0
s_cbranch_scc1 lw_160
lwd_161:
s_branch cback_131
slow_132:
s_add_u32 s70, s72, 270336
poll_162:
buffer_load_dword v10, v1, s[24:27], s70 offen sc1
pchk_163:
s_waitcnt vmcnt(0)
v_cmp_eq_u32 vcc, 0, v10
s_cbranch_vccz pdone_164
s_sub_u32 s32, s32, 1
s_cmp_gt_i32 s32, 0
s_cbranch_scc1 poll_162
pdone_164:
s_lshl_b32 s73, s60, 15
s_lshl_b32 s74, s63, 23
s_add_u32 s73, s73, s74
s_add_u32 s73, s73, 1048576
v_mov_b32 v10, 0xf149f2ca
v_mov_b32 v11, 0
v_mov_b32 v192, 0
v_mov_b32 v193, 0
v_mov_b32 v194, 0
v_mov_b32 v195, 0
v_mov_b32 v196, 0
v_mov_b32 v197, 0
v_mov_b32 v198, 0
v_mov_b32 v199, 0
v_mov_b32 v200, 0
v_mov_b32 v201, 0
v_mov_b32 v202, 0
v_mov_b32 v203, 0
v_mov_b32 v204, 0
v_mov_b32 v205, 0
v_mov_b32 v206, 0
v_mov_b32 v207, 0
v_mov_b32 v208, 0
v_mov_b32 v209, 0
v_mov_b32 v210, 0
v_mov_b32 v211, 0
s_lshl2_add_u32 s74, s59, s65
s_mov_b32 s75, 0
sl_165:
s_lshr_b32 s76, s74, 2
s_lshl_b32 s76, s76, 19
s_and_b32 s77, s74, 3
s_lshl_b32 s77, s77, 13
s_add_u32 s76, s76, s77
s_add_u32 s76, s76, s73
buffer_load_dwordx4 v[152:155], v6, s[20:23], s76 offen offset:0 sc1
buffer_load_dwordx4 v[156:159], v6, s[20:23], s76 offen offset:1024 sc1
s_cmp_eq_u32 s75, 0
s_cselect_b32 s76, 0xf149f2ca, 0
s_and_b32 s77, s75, 7
s_cselect_b32 s77, 0, -1
v_xor_b32 v112, s76, v216
v_and_b32 v112, s77, v112
v_xor_b32 v113, s76, v217
v_and_b32 v113, s77, v113
v_xor_b32 v114, s76, v218
v_and_b32 v114, s77, v114
v_xor_b32 v115, s76, v219
v_and_b32 v115, s77, v115
v_xor_b32 v116, s76, v220
v_and_b32 v116, s77, v116
v_xor_b32 v117, s76, v221
v_and_b32 v117, s77, v117
v_xor_b32 v118, s76, v222
v_and_b32 v118, s77, v118
v_xor_b32 v119, s76, v223
v_and_b32 v119, s77, v119
v_xor_b32 v120, s76, v224
v_and_b32 v120, s77, v120
v_xor_b32 v121, s76, v225
v_and_b32 v121, s77, v121
v_xor_b32 v122, s76, v226
v_and_b32 v122, s77, v122
v_xor_b32 v123, s76, v227
v_and_b32 v123, s77, v123
v_xor_b32 v124, s76, v228
v_and_b32 v124, s77, v124
v_xor_b32 v125, s76, v229
v_and_b32 v125, s77, v125
v_xor_b32 v126, s76, v230
v_and_b32 v126, s77, v126
v_xor_b32 v127, s76, v231
v_and_b32 v127, s77, v127
s_waitcnt vmcnt(1)
s_nop 0
v_mfma_f32_32x32x16_bf16 v[112:127], v[152:155], v[80:83], v[112:127]
s_waitcnt vmcnt(0)
v_mfma_f32_32x32x16_bf16 v[112:127], v[156:159], v[88:91], v[112:127]
s_nop 11
v_max3_f32 v10, v10, v112, v113
v_max3_f32 v10, v10, v114, v115
v_max3_f32 v10, v10, v116, v117
v_max3_f32 v10, v10, v118, v119
v_max3_f32 v10, v10, v120, v121
v_max3_f32 v10, v10, v122, v123
v_max3_f32 v10, v10, v124, v125
v_max3_f32 v10, v10, v126, v127
s_add_u32 s75, s75, 1
s_sub_u32 s74, s74, 1
s_cselect_b32 s75, 9, s75
s_cmp_lt_u32 s75, 9
s_cbranch_scc1 sl_165
v_mov_b32 v11, v10
s_nop 1
v_permlane32_swap_b32 v11, v10
v_max_f32 v10, v10, v11
s_lshl2_add_u32 s74, s59, s65
s_mov_b32 s75, 0
sl_166:
s_lshr_b32 s76, s74, 2
s_lshl_b32 s76, s76, 19
s_and_b32 s77, s74, 3
s_lshl_b32 s77, s77, 13
s_add_u32 s76, s76, s77
s_add_u32 s76, s76, s73
buffer_load_dwordx4 v[152:155], v6, s[20:23], s76 offen offset:0 sc1
buffer_load_dwordx4 v[156:159], v6, s[20:23], s76 offen offset:1024 sc1
buffer_load_dwordx4 v[160:163], v6, s[20:23], s76 offen offset:2048 sc1
buffer_load_dwordx4 v[164:167], v6, s[20:23], s76 offen offset:3072 sc1
s_cmp_eq_u32 s75, 0
s_cselect_b32 s76, 0xf149f2ca, 0
s_and_b32 s77, s75, 7
s_cselect_b32 s77, 0, -1
v_xor_b32 v112, s76, v216
v_and_b32 v112, s77, v112
v_sub_f32 v112, v112, v10
v_xor_b32 v113, s76, v217
v_and_b32 v113, s77, v113
v_sub_f32 v113, v113, v10
v_xor_b32 v114, s76, v218
v_and_b32 v114, s77, v114
v_sub_f32 v114, v114, v10
v_xor_b32 v115, s76, v219
v_and_b32 v115, s77, v115
v_sub_f32 v115, v115, v10
v_xor_b32 v116, s76, v220
v_and_b32 v116, s77, v116
v_sub_f32 v116, v116, v10
v_xor_b32 v117, s76, v221
v_and_b32 v117, s77, v117
v_sub_f32 v117, v117, v10
v_xor_b32 v118, s76, v222
v_and_b32 v118, s77, v118
v_sub_f32 v118, v118, v10
v_xor_b32 v119, s76, v223
v_and_b32 v119, s77, v119
v_sub_f32 v119, v119, v10
v_xor_b32 v120, s76, v224
v_and_b32 v120, s77, v120
v_sub_f32 v120, v120, v10
v_xor_b32 v121, s76, v225
v_and_b32 v121, s77, v121
v_sub_f32 v121, v121, v10
v_xor_b32 v122, s76, v226
v_and_b32 v122, s77, v122
v_sub_f32 v122, v122, v10
v_xor_b32 v123, s76, v227
v_and_b32 v123, s77, v123
v_sub_f32 v123, v123, v10
v_xor_b32 v124, s76, v228
v_and_b32 v124, s77, v124
v_sub_f32 v124, v124, v10
v_xor_b32 v125, s76, v229
v_and_b32 v125, s77, v125
v_sub_f32 v125, v125, v10
v_xor_b32 v126, s76, v230
v_and_b32 v126, s77, v126
v_sub_f32 v126, v126, v10
v_xor_b32 v127, s76, v231
v_and_b32 v127, s77, v127
v_sub_f32 v127, v127, v10
s_waitcnt vmcnt(3)
s_nop 0
v_mfma_f32_32x32x16_bf16 v[112:127], v[152:155], v[80:83], v[112:127]
s_waitcnt vmcnt(2)
v_mfma_f32_32x32x16_bf16 v[112:127], v[156:159], v[88:91], v[112:127]
s_nop 11
v_exp_f32 v112, v112
v_exp_f32 v113, v113
v_exp_f32 v114, v114
v_exp_f32 v115, v115
v_exp_f32 v116, v116
v_exp_f32 v117, v117
v_exp_f32 v118, v118
v_exp_f32 v119, v119
v_exp_f32 v120, v120
v_exp_f32 v121, v121
v_exp_f32 v122, v122
v_exp_f32 v123, v123
v_exp_f32 v124, v124
v_exp_f32 v125, v125
v_exp_f32 v126, v126
v_exp_f32 v127, v127
v_cvt_pk_bf16_f32 v144, v112, v113
v_cvt_pk_bf16_f32 v145, v114, v115
v_cvt_pk_bf16_f32 v146, v116, v117
v_cvt_pk_bf16_f32 v147, v118, v119
v_cvt_pk_bf16_f32 v148, v120, v121
v_cvt_pk_bf16_f32 v149, v122, v123
v_cvt_pk_bf16_f32 v150, v124, v125
v_cvt_pk_bf16_f32 v151, v126, v127
s_waitcnt vmcnt(1)
v_mfma_f32_32x32x16_bf16 v[192:207], v[160:163], v[144:147], v[192:207]
v_mfma_f32_16x16x32_bf16 v[208:211], v[212:215], v[144:147], v[208:211]
s_waitcnt vmcnt(0)
v_mfma_f32_32x32x16_bf16 v[192:207], v[164:167], v[148:151], v[192:207]
v_mfma_f32_16x16x32_bf16 v[208:211], v[212:215], v[148:151], v[208:211]
s_add_u32 s75, s75, 1
s_sub_u32 s74, s74, 1
s_cselect_b32 s75, 9, s75
s_cmp_lt_u32 s75, 9
s_cbranch_scc1 sl_166
v_mov_b32 v10, 0xf149f2ca
v_mov_b32 v11, 0
v_mov_b32 v16, 0
v_mov_b32 v17, 0
v_mov_b32 v18, 0
v_mov_b32 v19, 0
v_mov_b32 v20, 0
v_mov_b32 v21, 0
v_mov_b32 v22, 0
v_mov_b32 v23, 0
v_mov_b32 v24, 0
v_mov_b32 v25, 0
v_mov_b32 v26, 0
v_mov_b32 v27, 0
v_mov_b32 v28, 0
v_mov_b32 v29, 0
v_mov_b32 v30, 0
v_mov_b32 v31, 0
v_mov_b32 v32, 0
v_mov_b32 v33, 0
v_mov_b32 v34, 0
v_mov_b32 v35, 0
s_sub_u32 s74, 3, s65
s_lshl2_add_u32 s74, s59, s74
s_mov_b32 s75, 0
sl_167:
s_lshr_b32 s76, s74, 2
s_lshl_b32 s76, s76, 19
s_and_b32 s77, s74, 3
s_lshl_b32 s77, s77, 13
s_add_u32 s76, s76, s77
s_add_u32 s76, s76, s73
buffer_load_dwordx4 v[152:155], v6, s[20:23], s76 offen offset:0 sc1
buffer_load_dwordx4 v[156:159], v6, s[20:23], s76 offen offset:1024 sc1
s_cmp_eq_u32 s75, 0
s_cselect_b32 s76, 0xf149f2ca, 0
s_and_b32 s77, s75, 7
s_cselect_b32 s77, 0, -1
v_xor_b32 v112, s76, v216
v_and_b32 v112, s77, v112
v_xor_b32 v113, s76, v217
v_and_b32 v113, s77, v113
v_xor_b32 v114, s76, v218
v_and_b32 v114, s77, v114
v_xor_b32 v115, s76, v219
v_and_b32 v115, s77, v115
v_xor_b32 v116, s76, v220
v_and_b32 v116, s77, v116
v_xor_b32 v117, s76, v221
v_and_b32 v117, s77, v117
v_xor_b32 v118, s76, v222
v_and_b32 v118, s77, v118
v_xor_b32 v119, s76, v223
v_and_b32 v119, s77, v119
v_xor_b32 v120, s76, v224
v_and_b32 v120, s77, v120
v_xor_b32 v121, s76, v225
v_and_b32 v121, s77, v121
v_xor_b32 v122, s76, v226
v_and_b32 v122, s77, v122
v_xor_b32 v123, s76, v227
v_and_b32 v123, s77, v123
v_xor_b32 v124, s76, v228
v_and_b32 v124, s77, v124
v_xor_b32 v125, s76, v229
v_and_b32 v125, s77, v125
v_xor_b32 v126, s76, v230
v_and_b32 v126, s77, v126
v_xor_b32 v127, s76, v231
v_and_b32 v127, s77, v127
s_waitcnt vmcnt(1)
s_nop 0
v_mfma_f32_32x32x16_bf16 v[112:127], v[152:155], v[96:99], v[112:127]
s_waitcnt vmcnt(0)
v_mfma_f32_32x32x16_bf16 v[112:127], v[156:159], v[104:107], v[112:127]
s_nop 11
v_max3_f32 v10, v10, v112, v113
v_max3_f32 v10, v10, v114, v115
v_max3_f32 v10, v10, v116, v117
v_max3_f32 v10, v10, v118, v119
v_max3_f32 v10, v10, v120, v121
v_max3_f32 v10, v10, v122, v123
v_max3_f32 v10, v10, v124, v125
v_max3_f32 v10, v10, v126, v127
s_add_u32 s75, s75, 1
s_sub_u32 s74, s74, 1
s_cselect_b32 s75, 9, s75
s_cmp_lt_u32 s75, 9
s_cbranch_scc1 sl_167
v_mov_b32 v11, v10
s_nop 1
v_permlane32_swap_b32 v11, v10
v_max_f32 v10, v10, v11
s_sub_u32 s74, 3, s65
s_lshl2_add_u32 s74, s59, s74
s_mov_b32 s75, 0
sl_168:
s_lshr_b32 s76, s74, 2
s_lshl_b32 s76, s76, 19
s_and_b32 s77, s74, 3
s_lshl_b32 s77, s77, 13
s_add_u32 s76, s76, s77
s_add_u32 s76, s76, s73
buffer_load_dwordx4 v[152:155], v6, s[20:23], s76 offen offset:0 sc1
buffer_load_dwordx4 v[156:159], v6, s[20:23], s76 offen offset:1024 sc1
buffer_load_dwordx4 v[160:163], v6, s[20:23], s76 offen offset:2048 sc1
buffer_load_dwordx4 v[164:167], v6, s[20:23], s76 offen offset:3072 sc1
s_cmp_eq_u32 s75, 0
s_cselect_b32 s76, 0xf149f2ca, 0
s_and_b32 s77, s75, 7
s_cselect_b32 s77, 0, -1
v_xor_b32 v112, s76, v216
v_and_b32 v112, s77, v112
v_sub_f32 v112, v112, v10
v_xor_b32 v113, s76, v217
v_and_b32 v113, s77, v113
v_sub_f32 v113, v113, v10
v_xor_b32 v114, s76, v218
v_and_b32 v114, s77, v114
v_sub_f32 v114, v114, v10
v_xor_b32 v115, s76, v219
v_and_b32 v115, s77, v115
v_sub_f32 v115, v115, v10
v_xor_b32 v116, s76, v220
v_and_b32 v116, s77, v116
v_sub_f32 v116, v116, v10
v_xor_b32 v117, s76, v221
v_and_b32 v117, s77, v117
v_sub_f32 v117, v117, v10
v_xor_b32 v118, s76, v222
v_and_b32 v118, s77, v118
v_sub_f32 v118, v118, v10
v_xor_b32 v119, s76, v223
v_and_b32 v119, s77, v119
v_sub_f32 v119, v119, v10
v_xor_b32 v120, s76, v224
v_and_b32 v120, s77, v120
v_sub_f32 v120, v120, v10
v_xor_b32 v121, s76, v225
v_and_b32 v121, s77, v121
v_sub_f32 v121, v121, v10
v_xor_b32 v122, s76, v226
v_and_b32 v122, s77, v122
v_sub_f32 v122, v122, v10
v_xor_b32 v123, s76, v227
v_and_b32 v123, s77, v123
v_sub_f32 v123, v123, v10
v_xor_b32 v124, s76, v228
v_and_b32 v124, s77, v124
v_sub_f32 v124, v124, v10
v_xor_b32 v125, s76, v229
v_and_b32 v125, s77, v125
v_sub_f32 v125, v125, v10
v_xor_b32 v126, s76, v230
v_and_b32 v126, s77, v126
v_sub_f32 v126, v126, v10
v_xor_b32 v127, s76, v231
v_and_b32 v127, s77, v127
v_sub_f32 v127, v127, v10
s_waitcnt vmcnt(3)
s_nop 0
v_mfma_f32_32x32x16_bf16 v[112:127], v[152:155], v[96:99], v[112:127]
s_waitcnt vmcnt(2)
v_mfma_f32_32x32x16_bf16 v[112:127], v[156:159], v[104:107], v[112:127]
s_nop 11
v_exp_f32 v112, v112
v_exp_f32 v113, v113
v_exp_f32 v114, v114
v_exp_f32 v115, v115
v_exp_f32 v116, v116
v_exp_f32 v117, v117
v_exp_f32 v118, v118
v_exp_f32 v119, v119
v_exp_f32 v120, v120
v_exp_f32 v121, v121
v_exp_f32 v122, v122
v_exp_f32 v123, v123
v_exp_f32 v124, v124
v_exp_f32 v125, v125
v_exp_f32 v126, v126
v_exp_f32 v127, v127
v_cvt_pk_bf16_f32 v144, v112, v113
v_cvt_pk_bf16_f32 v145, v114, v115
v_cvt_pk_bf16_f32 v146, v116, v117
v_cvt_pk_bf16_f32 v147, v118, v119
v_cvt_pk_bf16_f32 v148, v120, v121
v_cvt_pk_bf16_f32 v149, v122, v123
v_cvt_pk_bf16_f32 v150, v124, v125
v_cvt_pk_bf16_f32 v151, v126, v127
s_waitcnt vmcnt(1)
v_mfma_f32_32x32x16_bf16 v[16:31], v[160:163], v[144:147], v[16:31]
v_mfma_f32_16x16x32_bf16 v[32:35], v[212:215], v[144:147], v[32:35]
s_waitcnt vmcnt(0)
v_mfma_f32_32x32x16_bf16 v[16:31], v[164:167], v[148:151], v[16:31]
v_mfma_f32_16x16x32_bf16 v[32:35], v[212:215], v[148:151], v[32:35]
s_add_u32 s75, s75, 1
s_sub_u32 s74, s74, 1
s_cselect_b32 s75, 9, s75
s_cmp_lt_u32 s75, 9
s_cbranch_scc1 sl_168
s_branch sback_133
mo_136:
s_lshr_b32 s67, s33, 5
s_cmp_eq_u32 s67, s66
s_cbranch_scc0 mo_137
s_and_b32 s67, s33, 31
v_sub_u32 v48, s67, v48
v_lshlrev_b32 v49, 4, v49
s_lshl_b32 s67, s62, 14
s_add_u32 s67, s67, 30686208
poll_169:
buffer_load_dwordx4 v[56:59], v49, s[20:23], s67 offen offset:0 sc1
buffer_load_dwordx4 v[60:63], v49, s[20:23], s67 offen offset:64 sc1
pchk_170:
s_waitcnt vmcnt(1)
v_min3_u32 v50, v56, v57, v58
s_waitcnt vmcnt(0)
v_min3_u32 v50, v50, v59, v60
v_min3_u32 v50, v50, v61, v62
v_min_u32 v50, v50, v63
v_cmp_eq_u32 vcc, 0, v50
s_cbranch_vccz pdone_171
s_sub_u32 s32, s32, 1
s_cmp_gt_i32 s32, 0
s_cbranch_scc1 poll_169
pdone_171:
v_cmp_eq_u32 vcc, 0, v48
s_nop 1
v_cndmask_b32 v240, v240, v56, vcc
v_cndmask_b32 v241, v241, v57, vcc
v_cndmask_b32 v242, v242, v58, vcc
v_cndmask_b32 v243, v243, v59, vcc
v_cndmask_b32 v244, v244, v60, vcc
v_cndmask_b32 v245, v245, v61, vcc
v_cndmask_b32 v246, v246, v62, vcc
v_cndmask_b32 v247, v247, v63, vcc
v_cmp_eq_u32 vcc, 16, v48
s_nop 1
v_cndmask_b32 v248, v248, v56, vcc
v_cndmask_b32 v249, v249, v57, vcc
v_cndmask_b32 v250, v250, v58, vcc
v_cndmask_b32 v251, v251, v59, vcc
v_cndmask_b32 v252, v252, v60, vcc
v_cndmask_b32 v253, v253, v61, vcc
v_cndmask_b32 v254, v254, v62, vcc
v_cndmask_b32 v255, v255, v63, vcc
s_branch mo_137
L_end:
L_fin:
s_endpgm
.section .rodata,"a"
.p2align 6
.amdhsa_kernel interleave_layers__sliding_block__moe_arch_mod__prompt_kernel
  .amdhsa_next_free_vgpr 256
  .amdhsa_next_free_sgpr 102
  .amdhsa_accum_offset 256
  .amdhsa_group_segment_fixed_size 0
  .amdhsa_kernarg_size 88
  .amdhsa_user_sgpr_count 2
  .amdhsa_user_sgpr_kernarg_segment_ptr 1
  .amdhsa_system_sgpr_workgroup_id_x 1
  .amdhsa_float_denorm_mode_32 3
.end_amdhsa_kernel
```

```asm
; @launch grid=(256,1,1) block=(512,1,1) lds=163840
.amdgcn_target "amdgcn-amd-amdhsa--gfx950"
.text
.globl interleave_layers__sliding_block__moe_arch_mod__prompt_kernel
.p2align 8
.type interleave_layers__sliding_block__moe_arch_mod__prompt_kernel,@function
interleave_layers__sliding_block__moe_arch_mod__prompt_kernel:
s_cmp_ge_u32 s2, 256
s_cbranch_scc1 L_fin
s_load_dwordx16 s[36:51], s[0:1], 0
s_load_dwordx4 s[52:55], s[0:1], 64
s_load_dwordx2 s[56:57], s[0:1], 80
v_lshrrev_b32 v1, 6, v0
v_and_b32 v0, 63, v0
s_and_b32 s64, s2, 7
v_readfirstlane_b32 s3, v1
s_lshr_b32 s65, s2, 3
s_and_b32 s66, s65, 7
s_and_b32 s67, s64, 1
s_lshl3_add_u32 s59, s67, s66
s_lshr_b32 s66, s65, 3
s_lshr_b32 s67, s64, 1
s_lshl2_add_u32 s60, s67, s66
s_and_b32 s66, s65, 1
s_lshl1_add_u32 s61, s64, s66
s_lshr_b32 s62, s65, 1
s_mov_b32 s63, 0
s_mov_b32 s34, 0
s_mov_b32 s32, 200000
s_mov_b32 s33, -1
s_cmp_ge_u32 s3, 4
s_cselect_b32 s66, 3, 1
s_and_b32 s58, s3, s66
s_waitcnt lgkmcnt(0)
s_mov_b32 s8, s36
s_mov_b32 s9, s37
s_mov_b32 s10, 0x400000
s_mov_b32 s11, 0x00020000
s_mov_b32 s12, s38
s_mov_b32 s13, s39
s_mov_b32 s14, 0x600000
s_mov_b32 s15, 0x00020000
s_mov_b32 s16, s40
s_mov_b32 s17, s41
s_mov_b32 s18, 0x200000
s_mov_b32 s19, 0x00020000
s_mov_b32 s20, s56
s_mov_b32 s21, s57
s_mov_b32 s22, 0x2500000
s_mov_b32 s23, 0x00020000
s_add_u32 s24, s56, 30408704
s_addc_u32 s25, s57, 0
s_mov_b32 s26, 2818048
s_mov_b32 s27, 0x00020000
s_mov_b32 s28, s52
s_mov_b32 s29, s53
s_mov_b32 s30, 0x400000
s_mov_b32 s31, 0x00020000
s_cmp_ge_u32 s3, 4
s_cbranch_scc1 L_m
s_cmp_ge_u32 s3, 2
s_cbranch_scc1 L_f
s_setprio 1
v_and_b32 v22, 7, v0
v_lshrrev_b32 v23, 4, v0
v_lshrrev_b32 v6, 3, v0
v_xor_b32 v7, v22, v23
v_lshlrev_b32 v7, 4, v7
v_lshl_add_u32 v8, v6, 11, v7
v_xor_b32 v7, 64, v8
v_add_u32 v9, 15360, v7
v_add_u32 v10, 30720, v8
v_add_u32 v11, 46080, v7
s_lshl_b32 s70, s59, 18
s_lshl_b32 s71, s58, 16
s_add_u32 s68, s70, s71
s_sub_u32 s69, s70, s71
s_add_u32 s69, s69, 196608
s_mov_b32 s67, 128
s_lshl_b32 s75, s58, 13
s_mov_b32 s65, 86016
s_mov_b32 s64, 0
s_mul_i32 s70, s64, s67
s_add_u32 m0, s65, s75
s_add_u32 s71, s70, s68
buffer_load_dwordx4 v8, s[8:11], s71 offen offset:0 lds
buffer_load_dwordx4 v9, s[8:11], s71 offen offset:1024 lds
buffer_load_dwordx4 v10, s[8:11], s71 offen offset:2048 lds
buffer_load_dwordx4 v11, s[8:11], s71 offen offset:3072 lds
s_add_u32 m0, m0, 4096
s_add_u32 s71, s70, s69
buffer_load_dwordx4 v8, s[8:11], s71 offen offset:0 lds
buffer_load_dwordx4 v9, s[8:11], s71 offen offset:1024 lds
buffer_load_dwordx4 v10, s[8:11], s71 offen offset:2048 lds
buffer_load_dwordx4 v11, s[8:11], s71 offen offset:3072 lds
v_and_b32 v7, 2, v6
v_xor_b32 v7, v7, v22
v_mul_u32_u24 v6, 6144, v6
v_lshl_add_u32 v12, v7, 4, v6
v_xor_b32 v6, 64, v12
v_add_u32 v13, 48128, v6
v_add_u32 v14, 96256, v12
v_add_u32 v15, 144384, v6
s_mul_i32 s76, s58, 12288
s_add_u32 s76, s76, 16384
s_lshl_b32 s70, s60, 7
s_cmp_eq_u32 s58, 0
s_mov_b32 s71, 198656
s_cselect_b32 s72, 0, s71
s_mov_b32 s71, 4096
s_cselect_b32 s73, 196608, s71
s_mov_b32 s71, 200704
s_cselect_b32 s74, 2048, s71
s_add_u32 s72, s72, s70
s_add_u32 s73, s73, s70
s_add_u32 s74, s74, s70
s_mul_i32 s70, s64, 393216
s_add_u32 m0, s65, s76
s_add_u32 s71, s70, s72
buffer_load_dwordx4 v12, s[12:15], s71 offen offset:0 lds
buffer_load_dwordx4 v13, s[12:15], s71 offen offset:1024 lds
buffer_load_dwordx4 v14, s[12:15], s71 offen offset:2048 lds
buffer_load_dwordx4 v15, s[12:15], s71 offen offset:3072 lds
s_add_u32 m0, m0, 4096
s_add_u32 s71, s70, s73
buffer_load_dwordx4 v12, s[12:15], s71 offen offset:0 lds
buffer_load_dwordx4 v13, s[12:15], s71 offen offset:1024 lds
buffer_load_dwordx4 v14, s[12:15], s71 offen offset:2048 lds
buffer_load_dwordx4 v15, s[12:15], s71 offen offset:3072 lds
s_add_u32 m0, m0, 4096
s_add_u32 s71, s70, s74
buffer_load_dwordx4 v12, s[12:15], s71 offen offset:0 lds
buffer_load_dwordx4 v13, s[12:15], s71 offen offset:1024 lds
buffer_load_dwordx4 v14, s[12:15], s71 offen offset:2048 lds
buffer_load_dwordx4 v15, s[12:15], s71 offen offset:3072 lds
s_add_u32 s64, s64, 1
s_and_b32 s64, s64, 15
s_sub_u32 s65, s65, 40960
s_cselect_b32 s65, 86016, s65
v_and_b32 v1, 3, v0
v_lshlrev_b32 v1, 2, v1
v_and_b32 v2, 4, v1
s_lshl2_add_u32 s35, s58, 16
v_mov_b32 v3, s35
v_lshlrev_b32 v20, 4, v0
v_lshrrev_b32 v6, 2, v0
v_lshl_add_u32 v21, v6, 7, v1
v_lshrrev_b32 v6, 3, v0
v_lshlrev_b32 v23, 1, v23
v_xor_b32 v23, v23, v22
v_lshlrev_b32 v23, 4, v23
v_lshl_add_u32 v23, v6, 11, v23
s_lshl_b32 s70, s62, 7
s_lshl_b32 s71, s58, 16
s_add_u32 s70, s70, s71
v_add_u32 v16, s70, v23
v_add_u32 v17, 15360, v16
v_add_u32 v18, 30720, v16
v_add_u32 v19, 46080, v16
s_add_u32 s77, s61, s62
s_lshl_b32 s77, s77, 17
s_lshl_b32 s78, s58, 12
s_mov_b32 s66, -2
s_barrier
.p2align 4
lq_1:
s_add_u32 s35, s66, 1
lw_4:
ds_read_b32 v5, v1 offset:0
s_waitcnt lgkmcnt(0)
v_cmp_gt_i32 vcc, s35, v5
s_cbranch_vccz lwd_5
s_sub_u32 s32, s32, 1
s_cmp_gt_i32 s32, 0
s_cbranch_scc1 lw_4
lwd_5:
s_mul_i32 s70, s64, s67
s_add_u32 m0, s65, s75
s_add_u32 s71, s70, s68
buffer_load_dwordx4 v8, s[8:11], s71 offen offset:0 sc1 lds
buffer_load_dwordx4 v9, s[8:11], s71 offen offset:1024 sc1 lds
buffer_load_dwordx4 v10, s[8:11], s71 offen offset:2048 sc1 lds
buffer_load_dwordx4 v11, s[8:11], s71 offen offset:3072 sc1 lds
buffer_load_dword v30, off, s[12:15], 0
s_add_u32 m0, m0, 4096
s_add_u32 s71, s70, s69
buffer_load_dwordx4 v8, s[8:11], s71 offen offset:0 sc1 lds
buffer_load_dwordx4 v9, s[8:11], s71 offen offset:1024 sc1 lds
buffer_load_dwordx4 v10, s[8:11], s71 offen offset:2048 sc1 lds
buffer_load_dwordx4 v11, s[8:11], s71 offen offset:3072 sc1 lds
buffer_load_dword v30, off, s[12:15], 0
s_mul_i32 s70, s64, 393216
s_add_u32 m0, s65, s76
s_add_u32 s71, s70, s72
buffer_load_dwordx4 v12, s[12:15], s71 offen offset:0 lds
buffer_load_dwordx4 v13, s[12:15], s71 offen offset:1024 lds
buffer_load_dwordx4 v14, s[12:15], s71 offen offset:2048 lds
buffer_load_dwordx4 v15, s[12:15], s71 offen offset:3072 lds
buffer_load_dword v30, off, s[12:15], 0
v_add_u32 v5, s66, 3
s_mov_b64 exec, 1
s_cmp_eq_u32 s66, 2
s_waitcnt vmcnt(30)
s_cbranch_scc1 lze_6
s_waitcnt vmcnt(15)
lze_6:
ds_write_b32 v3, v5
s_mov_b64 exec, -1
s_mul_i32 s70, s64, 393216
s_add_u32 m0, m0, 4096
s_add_u32 s71, s70, s73
buffer_load_dwordx4 v12, s[12:15], s71 offen offset:0 lds
buffer_load_dwordx4 v13, s[12:15], s71 offen offset:1024 lds
buffer_load_dwordx4 v14, s[12:15], s71 offen offset:2048 lds
buffer_load_dwordx4 v15, s[12:15], s71 offen offset:3072 lds
buffer_load_dword v30, off, s[12:15], 0
s_mul_i32 s70, s64, 393216
s_add_u32 m0, m0, 4096
s_add_u32 s71, s70, s74
buffer_load_dwordx4 v12, s[12:15], s71 offen offset:0 lds
buffer_load_dwordx4 v13, s[12:15], s71 offen offset:1024 lds
buffer_load_dwordx4 v14, s[12:15], s71 offen offset:2048 lds
buffer_load_dwordx4 v15, s[12:15], s71 offen offset:3072 lds
buffer_load_dword v30, off, s[12:15], 0
s_cmp_eq_u32 s66, 1
s_cbranch_scc1 lcs_2
lcb_3:
s_add_u32 s64, s64, 1
s_and_b32 s64, s64, 15
s_sub_u32 s65, s65, 40960
s_cselect_b32 s65, 86016, s65
s_add_u32 s66, s66, 1
s_and_b32 s70, s66, 31
s_cmp_eq_u32 s70, 13
s_cbranch_scc0 lq_1
s_waitcnt vmcnt(0)
v_add_u32 v5, s34, 16
s_mov_b64 exec, 1
ds_write_b32 v3, v5
s_mov_b64 exec, -1
s_add_u32 s35, s34, 14
lw_7:
ds_read_b32 v5, v1 offset:0
s_waitcnt lgkmcnt(0)
v_cmp_gt_i32 vcc, s35, v5
s_cbranch_vccz lwd_8
s_sleep 1
s_sub_u32 s32, s32, 1
s_cmp_gt_i32 s32, 0
s_cbranch_scc1 lw_7
lwd_8:
s_add_u32 s70, s77, 262144
s_add_u32 m0, s78, 49152
s_and_b32 s70, s70, 0x1fffff
buffer_load_dwordx4 v16, s[16:19], s70 offen offset:0 lds
buffer_load_dwordx4 v17, s[16:19], s70 offen offset:1024 lds
buffer_load_dwordx4 v18, s[16:19], s70 offen offset:2048 lds
buffer_load_dwordx4 v19, s[16:19], s70 offen offset:3072 lds
buffer_load_dword v30, off, s[12:15], 0
s_add_u32 s70, s77, 393216
s_add_u32 m0, s78, 57344
s_and_b32 s70, s70, 0x1fffff
buffer_load_dwordx4 v16, s[16:19], s70 offen offset:0 lds
buffer_load_dwordx4 v17, s[16:19], s70 offen offset:1024 lds
buffer_load_dwordx4 v18, s[16:19], s70 offen offset:2048 lds
buffer_load_dwordx4 v19, s[16:19], s70 offen offset:3072 lds
buffer_load_dword v30, off, s[12:15], 0
s_add_u32 s70, s77, 524288
s_add_u32 m0, s78, 65536
s_and_b32 s70, s70, 0x1fffff
buffer_load_dwordx4 v16, s[16:19], s70 offen offset:0 lds
buffer_load_dwordx4 v17, s[16:19], s70 offen offset:1024 lds
buffer_load_dwordx4 v18, s[16:19], s70 offen offset:2048 lds
buffer_load_dwordx4 v19, s[16:19], s70 offen offset:3072 lds
buffer_load_dword v30, off, s[12:15], 0
s_add_u32 s70, s77, 655360
s_add_u32 m0, s78, 73728
s_and_b32 s70, s70, 0x1fffff
buffer_load_dwordx4 v16, s[16:19], s70 offen offset:0 lds
buffer_load_dwordx4 v17, s[16:19], s70 offen offset:1024 lds
buffer_load_dwordx4 v18, s[16:19], s70 offen offset:2048 lds
buffer_load_dwordx4 v19, s[16:19], s70 offen offset:3072 lds
buffer_load_dword v30, off, s[12:15], 0
s_sub_u32 s70, s59, s58
s_lshl_b32 s71, s70, 7
s_add_u32 s71, s71, s60
s_lshl4_add_u32 s70, s70, s60
s_sub_u32 s70, s70, 16
s_lshl_b32 s66, s71, 7
s_add_u32 s66, s66, 253952
s_lshl_b32 s70, s70, 15
s_lshl_b32 s71, s63, 23
s_add_u32 s70, s70, s71
s_add_u32 s64, s70, 1077248
s_mul_i32 s65, s58, -94208
s_add_u32 s35, s34, 16
lw_9:
ds_read_b32 v5, v1 offset:0
s_waitcnt lgkmcnt(0)
v_cmp_gt_i32 vcc, s35, v5
s_cbranch_vccz lwd_10
s_sleep 1
s_sub_u32 s32, s32, 1
s_cmp_gt_i32 s32, 0
s_cbranch_scc1 lw_9
lwd_10:
s_add_u32 s70, s77, 131072
s_add_u32 m0, s78, 40960
s_and_b32 s70, s70, 0x1fffff
buffer_load_dwordx4 v16, s[16:19], s70 offen offset:0 lds
buffer_load_dwordx4 v17, s[16:19], s70 offen offset:1024 lds
buffer_load_dwordx4 v18, s[16:19], s70 offen offset:2048 lds
buffer_load_dwordx4 v19, s[16:19], s70 offen offset:3072 lds
buffer_load_dword v30, off, s[12:15], 0
s_add_u32 s70, s77, 786432
s_add_u32 m0, s78, 81920
s_and_b32 s70, s70, 0x1fffff
buffer_load_dwordx4 v16, s[16:19], s70 offen offset:0 lds
buffer_load_dwordx4 v17, s[16:19], s70 offen offset:1024 lds
buffer_load_dwordx4 v18, s[16:19], s70 offen offset:2048 lds
buffer_load_dwordx4 v19, s[16:19], s70 offen offset:3072 lds
buffer_load_dword v30, off, s[12:15], 0
s_add_u32 s70, s77, 917504
s_add_u32 m0, s78, 90112
s_and_b32 s70, s70, 0x1fffff
buffer_load_dwordx4 v16, s[16:19], s70 offen offset:0 lds
buffer_load_dwordx4 v17, s[16:19], s70 offen offset:1024 lds
buffer_load_dwordx4 v18, s[16:19], s70 offen offset:2048 lds
buffer_load_dwordx4 v19, s[16:19], s70 offen offset:3072 lds
buffer_load_dword v30, off, s[12:15], 0
s_add_u32 s35, s34, 17
lw_12:
ds_read_b32 v5, v1 offset:0
s_waitcnt lgkmcnt(0)
v_cmp_gt_i32 vcc, s35, v5
s_cbranch_vccz lwd_13
s_sleep 1
s_sub_u32 s32, s32, 1
s_cmp_gt_i32 s32, 0
s_cbranch_scc1 lw_12
lwd_13:
s_cmp_gt_u32 s59, s58
s_cbranch_scc0 nokv_11
poll_14:
buffer_load_dword v6, v1, s[24:27], s66 offen sc1
pchk_15:
s_waitcnt vmcnt(0)
v_cmp_eq_u32 vcc, 0, v6
s_cbranch_vccz pdone_16
s_sub_u32 s32, s32, 1
s_cmp_gt_i32 s32, 0
s_cbranch_scc1 poll_14
pdone_16:
s_add_u32 m0, s65, 126976
s_nop 0
buffer_load_dwordx4 v20, s[20:23], s64 offen offset:0 sc1 lds
buffer_load_dwordx4 v20, s[20:23], s64 offen offset:1024 sc1 lds
buffer_load_dwordx4 v20, s[20:23], s64 offen offset:2048 sc1 lds
buffer_load_dwordx4 v20, s[20:23], s64 offen offset:3072 sc1 lds
buffer_load_dword v30, off, s[12:15], 0
s_add_u32 m0, s65, 122880
s_sub_u32 s64, s64, 4096
buffer_load_dwordx4 v20, s[20:23], s64 offen offset:0 sc1 lds
buffer_load_dwordx4 v20, s[20:23], s64 offen offset:1024 sc1 lds
buffer_load_dwordx4 v20, s[20:23], s64 offen offset:2048 sc1 lds
buffer_load_dwordx4 v20, s[20:23], s64 offen offset:3072 sc1 lds
buffer_load_dword v30, off, s[12:15], 0
s_add_u32 m0, s65, 118784
s_sub_u32 s64, s64, 4096
buffer_load_dwordx4 v20, s[20:23], s64 offen offset:0 sc1 lds
buffer_load_dwordx4 v20, s[20:23], s64 offen offset:1024 sc1 lds
buffer_load_dwordx4 v20, s[20:23], s64 offen offset:2048 sc1 lds
buffer_load_dwordx4 v20, s[20:23], s64 offen offset:3072 sc1 lds
buffer_load_dword v30, off, s[12:15], 0
s_add_u32 m0, s65, 114688
s_sub_u32 s64, s64, 4096
buffer_load_dwordx4 v20, s[20:23], s64 offen offset:0 sc1 lds
buffer_load_dwordx4 v20, s[20:23], s64 offen offset:1024 sc1 lds
buffer_load_dwordx4 v20, s[20:23], s64 offen offset:2048 sc1 lds
buffer_load_dwordx4 v20, s[20:23], s64 offen offset:3072 sc1 lds
buffer_load_dword v30, off, s[12:15], 0
s_add_u32 m0, s65, 110592
s_sub_u32 s64, s64, 4096
buffer_load_dwordx4 v20, s[20:23], s64 offen offset:0 sc1 lds
buffer_load_dwordx4 v20, s[20:23], s64 offen offset:1024 sc1 lds
buffer_load_dwordx4 v20, s[20:23], s64 offen offset:2048 sc1 lds
buffer_load_dwordx4 v20, s[20:23], s64 offen offset:3072 sc1 lds
buffer_load_dword v30, off, s[12:15], 0
s_add_u32 m0, s65, 106496
s_sub_u32 s64, s64, 4096
buffer_load_dwordx4 v20, s[20:23], s64 offen offset:0 sc1 lds
buffer_load_dwordx4 v20, s[20:23], s64 offen offset:1024 sc1 lds
buffer_load_dwordx4 v20, s[20:23], s64 offen offset:2048 sc1 lds
buffer_load_dwordx4 v20, s[20:23], s64 offen offset:3072 sc1 lds
buffer_load_dword v30, off, s[12:15], 0
s_add_u32 m0, s65, 102400
s_sub_u32 s64, s64, 4096
buffer_load_dwordx4 v20, s[20:23], s64 offen offset:0 sc1 lds
buffer_load_dwordx4 v20, s[20:23], s64 offen offset:1024 sc1 lds
buffer_load_dwordx4 v20, s[20:23], s64 offen offset:2048 sc1 lds
buffer_load_dwordx4 v20, s[20:23], s64 offen offset:3072 sc1 lds
buffer_load_dword v30, off, s[12:15], 0
s_add_u32 m0, s65, 98304
s_sub_u32 s64, s64, 4096
buffer_load_dwordx4 v20, s[20:23], s64 offen offset:0 sc1 lds
buffer_load_dwordx4 v20, s[20:23], s64 offen offset:1024 sc1 lds
buffer_load_dwordx4 v20, s[20:23], s64 offen offset:2048 sc1 lds
buffer_load_dwordx4 v20, s[20:23], s64 offen offset:3072 sc1 lds
buffer_load_dword v30, off, s[12:15], 0
nokv_11:
s_lshl_b32 s66, s61, 14
s_add_u32 s66, s66, 268288
s_waitcnt vmcnt(0)
v_add_u32 v5, s34, 17
s_mov_b64 exec, 1
ds_write_b32 v3, v5
s_mov_b64 exec, -1
s_add_u32 s35, s34, 18
lw_18:
ds_read_b32 v5, v1 offset:0
s_waitcnt lgkmcnt(0)
v_cmp_gt_i32 vcc, s35, v5
s_cbranch_vccz lwd_19
s_sleep 1
s_sub_u32 s32, s32, 1
s_cmp_gt_i32 s32, 0
s_cbranch_scc1 lw_18
lwd_19:
s_add_u32 s70, s77, 1572864
s_add_u32 m0, s78, 131072
s_and_b32 s70, s70, 0x1fffff
buffer_load_dwordx4 v16, s[16:19], s70 offen offset:0 lds
buffer_load_dwordx4 v17, s[16:19], s70 offen offset:1024 lds
buffer_load_dwordx4 v18, s[16:19], s70 offen offset:2048 lds
buffer_load_dwordx4 v19, s[16:19], s70 offen offset:3072 lds
buffer_load_dword v30, off, s[12:15], 0
s_add_u32 s70, s77, 1703936
s_add_u32 m0, s78, 139264
s_and_b32 s70, s70, 0x1fffff
buffer_load_dwordx4 v16, s[16:19], s70 offen offset:0 lds
buffer_load_dwordx4 v17, s[16:19], s70 offen offset:1024 lds
buffer_load_dwordx4 v18, s[16:19], s70 offen offset:2048 lds
buffer_load_dwordx4 v19, s[16:19], s70 offen offset:3072 lds
buffer_load_dword v30, off, s[12:15], 0
s_add_u32 s70, s77, 1835008
s_add_u32 m0, s78, 147456
s_and_b32 s70, s70, 0x1fffff
buffer_load_dwordx4 v16, s[16:19], s70 offen offset:0 lds
buffer_load_dwordx4 v17, s[16:19], s70 offen offset:1024 lds
buffer_load_dwordx4 v18, s[16:19], s70 offen offset:2048 lds
buffer_load_dwordx4 v19, s[16:19], s70 offen offset:3072 lds
buffer_load_dword v30, off, s[12:15], 0
s_add_u32 s70, s77, 1966080
s_add_u32 m0, s78, 155648
s_and_b32 s70, s70, 0x1fffff
buffer_load_dwordx4 v16, s[16:19], s70 offen offset:0 lds
buffer_load_dwordx4 v17, s[16:19], s70 offen offset:1024 lds
buffer_load_dwordx4 v18, s[16:19], s70 offen offset:2048 lds
buffer_load_dwordx4 v19, s[16:19], s70 offen offset:3072 lds
buffer_load_dword v30, off, s[12:15], 0
s_add_u32 s35, s34, 19
lw_20:
ds_read_b32 v5, v1 offset:0
s_waitcnt lgkmcnt(0)
v_cmp_gt_i32 vcc, s35, v5
s_cbranch_vccz lwd_21
s_sleep 2
s_sub_u32 s32, s32, 1
s_cmp_gt_i32 s32, 0
s_cbranch_scc1 lw_20
lwd_21:
s_add_u32 s70, s77, 1048576
s_add_u32 m0, s78, 98304
s_and_b32 s70, s70, 0x1fffff
buffer_load_dwordx4 v16, s[16:19], s70 offen offset:0 lds
buffer_load_dwordx4 v17, s[16:19], s70 offen offset:1024 lds
buffer_load_dwordx4 v18, s[16:19], s70 offen offset:2048 lds
buffer_load_dwordx4 v19, s[16:19], s70 offen offset:3072 lds
buffer_load_dword v30, off, s[12:15], 0
s_add_u32 s70, s77, 1179648
s_add_u32 m0, s78, 106496
s_and_b32 s70, s70, 0x1fffff
buffer_load_dwordx4 v16, s[16:19], s70 offen offset:0 lds
buffer_load_dwordx4 v17, s[16:19], s70 offen offset:1024 lds
buffer_load_dwordx4 v18, s[16:19], s70 offen offset:2048 lds
buffer_load_dwordx4 v19, s[16:19], s70 offen offset:3072 lds
buffer_load_dword v30, off, s[12:15], 0
s_add_u32 s70, s77, 1310720
s_add_u32 m0, s78, 114688
s_and_b32 s70, s70, 0x1fffff
buffer_load_dwordx4 v16, s[16:19], s70 offen offset:0 lds
buffer_load_dwordx4 v17, s[16:19], s70 offen offset:1024 lds
buffer_load_dwordx4 v18, s[16:19], s70 offen offset:2048 lds
buffer_load_dwordx4 v19, s[16:19], s70 offen offset:3072 lds
buffer_load_dword v30, off, s[12:15], 0
s_add_u32 s70, s77, 1441792
s_add_u32 m0, s78, 122880
s_and_b32 s70, s70, 0x1fffff
buffer_load_dwordx4 v16, s[16:19], s70 offen offset:0 lds
buffer_load_dwordx4 v17, s[16:19], s70 offen offset:1024 lds
buffer_load_dwordx4 v18, s[16:19], s70 offen offset:2048 lds
buffer_load_dwordx4 v19, s[16:19], s70 offen offset:3072 lds
buffer_load_dword v30, off, s[12:15], 0
s_add_u32 s35, s34, 20
lw_22:
ds_read_b32 v5, v1 offset:0
s_waitcnt lgkmcnt(0)
v_cmp_gt_i32 vcc, s35, v5
s_cbranch_vccz lwd_23
s_sleep 2
s_sub_u32 s32, s32, 1
s_cmp_gt_i32 s32, 0
s_cbranch_scc1 lw_22
lwd_23:
s_add_u32 s70, s77, 0
s_add_u32 m0, s78, 32768
s_and_b32 s70, s70, 0x1fffff
buffer_load_dwordx4 v16, s[16:19], s70 offen offset:0 lds
buffer_load_dwordx4 v17, s[16:19], s70 offen offset:1024 lds
buffer_load_dwordx4 v18, s[16:19], s70 offen offset:2048 lds
buffer_load_dwordx4 v19, s[16:19], s70 offen offset:3072 lds
buffer_load_dword v30, off, s[12:15], 0
s_cmp_eq_u32 s58, 0
s_cbranch_scc0 nofo_17
s_add_u32 s35, s34, 21
lw_24:
ds_read_b32 v5, v1 offset:0
s_waitcnt lgkmcnt(0)
v_cmp_gt_i32 vcc, s35, v5
s_cbranch_vccz lwd_25
s_sleep 1
s_sub_u32 s32, s32, 1
s_cmp_gt_i32 s32, 0
s_cbranch_scc1 lw_24
lwd_25:
poll_26:
buffer_load_dword v6, v21, s[24:27], s66 offen sc1
pchk_27:
s_waitcnt vmcnt(0)
v_cmp_eq_u32 vcc, 0, v6
s_cbranch_vccz pdone_28
s_sub_u32 s32, s32, 1
s_cmp_gt_i32 s32, 0
s_cbranch_scc1 poll_26
pdone_28:
nofo_17:
s_waitcnt vmcnt(0)
v_add_u32 v5, s34, 18
s_mov_b64 exec, 1
ds_write_b32 v3, v5
s_mov_b64 exec, -1
s_cmp_eq_u32 s63, 0
s_cbranch_scc0 L_end
v_bfe_u32 v6, v0, 3, 2
v_and_b32 v7, 2, v6
v_xor_b32 v7, v7, v22
v_lshrrev_b32 v23, 5, v0
v_lshl_add_u32 v6, v23, 4, v6
v_mul_u32_u24 v6, 6144, v6
v_lshl_add_u32 v12, v7, 4, v6
v_xor_b32 v6, 64, v12
v_add_u32 v13, 23552, v6
v_add_u32 v14, 47104, v12
v_add_u32 v15, 70656, v6
v_mov_b32 v8, v20
v_mov_b32 v9, v20
v_mov_b32 v10, v20
v_mov_b32 v11, v20
s_mov_b32 s8, s56
s_mov_b32 s9, s57
s_mov_b32 s10, 0x2500000
s_mov_b32 s11, 0x00020000
s_lshl_b32 s70, s59, 18
s_add_u32 s70, s70, 26214400
s_add_u32 s68, s70, s78
s_sub_u32 s69, s70, s78
s_add_u32 s69, s69, 12288
s_mov_b32 s67, 16384
s_lshl_b32 s66, s59, 14
s_add_u32 s66, s66, 274432
s_and_b32 s64, s61, 14
s_mov_b32 s65, 86016
s_add_u32 s35, s34, 22
lw_29:
ds_read_b32 v5, v1 offset:0
s_waitcnt lgkmcnt(0)
v_cmp_gt_i32 vcc, s35, v5
s_cbranch_vccz lwd_30
s_sleep 2
s_sub_u32 s32, s32, 1
s_cmp_gt_i32 s32, 0
s_cbranch_scc1 lw_29
lwd_30:
s_mul_i32 s70, s64, 393216
s_add_u32 m0, s65, s76
s_add_u32 s71, s70, s72
buffer_load_dwordx4 v12, s[12:15], s71 offen offset:0 lds
buffer_load_dwordx4 v13, s[12:15], s71 offen offset:1024 lds
buffer_load_dwordx4 v14, s[12:15], s71 offen offset:2048 lds
buffer_load_dwordx4 v15, s[12:15], s71 offen offset:3072 lds
buffer_load_dword v30, off, s[12:15], 0
s_add_u32 m0, m0, 4096
s_add_u32 s71, s70, s73
buffer_load_dwordx4 v12, s[12:15], s71 offen offset:0 lds
buffer_load_dwordx4 v13, s[12:15], s71 offen offset:1024 lds
buffer_load_dwordx4 v14, s[12:15], s71 offen offset:2048 lds
buffer_load_dwordx4 v15, s[12:15], s71 offen offset:3072 lds
buffer_load_dword v30, off, s[12:15], 0
s_add_u32 m0, m0, 4096
s_add_u32 s71, s70, s74
buffer_load_dwordx4 v12, s[12:15], s71 offen offset:0 lds
buffer_load_dwordx4 v13, s[12:15], s71 offen offset:1024 lds
buffer_load_dwordx4 v14, s[12:15], s71 offen offset:2048 lds
buffer_load_dwordx4 v15, s[12:15], s71 offen offset:3072 lds
buffer_load_dword v30, off, s[12:15], 0
s_add_u32 s64, s64, 1
s_and_b32 s64, s64, 15
s_sub_u32 s65, s65, 40960
s_cselect_b32 s65, 86016, s65
s_mul_i32 s70, s64, 393216
s_add_u32 m0, s65, s76
s_add_u32 s71, s70, s72
buffer_load_dwordx4 v12, s[12:15], s71 offen offset:0 lds
buffer_load_dwordx4 v13, s[12:15], s71 offen offset:1024 lds
buffer_load_dwordx4 v14, s[12:15], s71 offen offset:2048 lds
buffer_load_dwordx4 v15, s[12:15], s71 offen offset:3072 lds
buffer_load_dword v30, off, s[12:15], 0
s_add_u32 m0, m0, 4096
s_add_u32 s71, s70, s73
buffer_load_dwordx4 v12, s[12:15], s71 offen offset:0 lds
buffer_load_dwordx4 v13, s[12:15], s71 offen offset:1024 lds
buffer_load_dwordx4 v14, s[12:15], s71 offen offset:2048 lds
buffer_load_dwordx4 v15, s[12:15], s71 offen offset:3072 lds
buffer_load_dword v30, off, s[12:15], 0
s_add_u32 m0, m0, 4096
s_add_u32 s71, s70, s74
buffer_load_dwordx4 v12, s[12:15], s71 offen offset:0 lds
buffer_load_dwordx4 v13, s[12:15], s71 offen offset:1024 lds
buffer_load_dwordx4 v14, s[12:15], s71 offen offset:2048 lds
buffer_load_dwordx4 v15, s[12:15], s71 offen offset:3072 lds
buffer_load_dword v30, off, s[12:15], 0
s_add_u32 s64, s64, 1
s_and_b32 s64, s64, 15
s_sub_u32 s65, s65, 40960
s_cselect_b32 s65, 86016, s65
s_mul_i32 s70, s64, 393216
s_add_u32 m0, s65, s76
s_add_u32 s71, s70, s72
buffer_load_dwordx4 v12, s[12:15], s71 offen offset:0 lds
buffer_load_dwordx4 v13, s[12:15], s71 offen offset:1024 lds
buffer_load_dwordx4 v14, s[12:15], s71 offen offset:2048 lds
buffer_load_dwordx4 v15, s[12:15], s71 offen offset:3072 lds
buffer_load_dword v30, off, s[12:15], 0
s_add_u32 m0, m0, 4096
s_add_u32 s71, s70, s73
buffer_load_dwordx4 v12, s[12:15], s71 offen offset:0 lds
buffer_load_dwordx4 v13, s[12:15], s71 offen offset:1024 lds
buffer_load_dwordx4 v14, s[12:15], s71 offen offset:2048 lds
buffer_load_dwordx4 v15, s[12:15], s71 offen offset:3072 lds
buffer_load_dword v30, off, s[12:15], 0
s_add_u32 m0, m0, 4096
s_add_u32 s71, s70, s74
buffer_load_dwordx4 v12, s[12:15], s71 offen offset:0 lds
buffer_load_dwordx4 v13, s[12:15], s71 offen offset:1024 lds
buffer_load_dwordx4 v14, s[12:15], s71 offen offset:2048 lds
buffer_load_dwordx4 v15, s[12:15], s71 offen offset:3072 lds
buffer_load_dword v30, off, s[12:15], 0
s_add_u32 s64, s64, 1
s_and_b32 s64, s64, 15
s_sub_u32 s65, s65, 40960
s_cselect_b32 s65, 86016, s65
s_mov_b32 s36, s64
s_mov_b32 s37, s65
s_mov_b32 s64, s59
s_mov_b32 s65, 114688
s_mul_i32 s70, s64, 393216
s_add_u32 m0, s65, s76
s_add_u32 s71, s70, s72
buffer_load_dwordx4 v12, s[12:15], s71 offen offset:0 lds
buffer_load_dwordx4 v13, s[12:15], s71 offen offset:1024 lds
buffer_load_dwordx4 v14, s[12:15], s71 offen offset:2048 lds
buffer_load_dwordx4 v15, s[12:15], s71 offen offset:3072 lds
buffer_load_dword v30, off, s[12:15], 0
s_add_u32 m0, m0, 4096
s_add_u32 s71, s70, s73
buffer_load_dwordx4 v12, s[12:15], s71 offen offset:0 lds
buffer_load_dwordx4 v13, s[12:15], s71 offen offset:1024 lds
buffer_load_dwordx4 v14, s[12:15], s71 offen offset:2048 lds
buffer_load_dwordx4 v15, s[12:15], s71 offen offset:3072 lds
buffer_load_dword v30, off, s[12:15], 0
s_add_u32 m0, m0, 4096
s_add_u32 s71, s70, s74
buffer_load_dwordx4 v12, s[12:15], s71 offen offset:0 lds
buffer_load_dwordx4 v13, s[12:15], s71 offen offset:1024 lds
buffer_load_dwordx4 v14, s[12:15], s71 offen offset:2048 lds
buffer_load_dwordx4 v15, s[12:15], s71 offen offset:3072 lds
buffer_load_dword v30, off, s[12:15], 0
s_mov_b32 s64, s36
s_mov_b32 s65, s37
s_and_b32 s64, s61, 14
s_mov_b32 s65, 86016
s_add_u32 s35, s34, 23
lw_31:
ds_read_b32 v5, v1 offset:0
s_waitcnt lgkmcnt(0)
v_cmp_gt_i32 vcc, s35, v5
s_cbranch_vccz lwd_32
s_sleep 1
s_sub_u32 s32, s32, 1
s_cmp_gt_i32 s32, 0
s_cbranch_scc1 lw_31
lwd_32:
poll_33:
buffer_load_dword v6, v21, s[24:27], s66 offen sc1
pchk_34:
s_waitcnt vmcnt(0)
v_cmp_eq_u32 vcc, 0, v6
s_cbranch_vccz pdone_35
s_sub_u32 s32, s32, 1
s_cmp_gt_i32 s32, 0
s_cbranch_scc1 poll_33
pdone_35:
s_mul_i32 s70, s64, s67
s_add_u32 m0, s65, s75
s_add_u32 s71, s70, s68
buffer_load_dwordx4 v8, s[8:11], s71 offen offset:0 sc1 lds
buffer_load_dwordx4 v9, s[8:11], s71 offen offset:1024 sc1 lds
buffer_load_dwordx4 v10, s[8:11], s71 offen offset:2048 sc1 lds
buffer_load_dwordx4 v11, s[8:11], s71 offen offset:3072 sc1 lds
buffer_load_dword v30, off, s[12:15], 0
s_add_u32 m0, m0, 4096
s_add_u32 s71, s70, s69
buffer_load_dwordx4 v8, s[8:11], s71 offen offset:0 sc1 lds
buffer_load_dwordx4 v9, s[8:11], s71 offen offset:1024 sc1 lds
buffer_load_dwordx4 v10, s[8:11], s71 offen offset:2048 sc1 lds
buffer_load_dwordx4 v11, s[8:11], s71 offen offset:3072 sc1 lds
buffer_load_dword v30, off, s[12:15], 0
s_add_u32 s64, s64, 1
s_and_b32 s64, s64, 15
s_sub_u32 s65, s65, 40960
s_cselect_b32 s65, 86016, s65
s_mul_i32 s70, s64, s67
s_add_u32 m0, s65, s75
s_add_u32 s71, s70, s68
buffer_load_dwordx4 v8, s[8:11], s71 offen offset:0 sc1 lds
buffer_load_dwordx4 v9, s[8:11], s71 offen offset:1024 sc1 lds
buffer_load_dwordx4 v10, s[8:11], s71 offen offset:2048 sc1 lds
buffer_load_dwordx4 v11, s[8:11], s71 offen offset:3072 sc1 lds
buffer_load_dword v30, off, s[12:15], 0
s_add_u32 m0, m0, 4096
s_add_u32 s71, s70, s69
buffer_load_dwordx4 v8, s[8:11], s71 offen offset:0 sc1 lds
buffer_load_dwordx4 v9, s[8:11], s71 offen offset:1024 sc1 lds
buffer_load_dwordx4 v10, s[8:11], s71 offen offset:2048 sc1 lds
buffer_load_dwordx4 v11, s[8:11], s71 offen offset:3072 sc1 lds
buffer_load_dword v30, off, s[12:15], 0
s_add_u32 s64, s64, 1
s_and_b32 s64, s64, 15
s_sub_u32 s65, s65, 40960
s_cselect_b32 s65, 86016, s65
s_mul_i32 s70, s64, s67
s_add_u32 m0, s65, s75
s_add_u32 s71, s70, s68
buffer_load_dwordx4 v8, s[8:11], s71 offen offset:0 sc1 lds
buffer_load_dwordx4 v9, s[8:11], s71 offen offset:1024 sc1 lds
buffer_load_dwordx4 v10, s[8:11], s71 offen offset:2048 sc1 lds
buffer_load_dwordx4 v11, s[8:11], s71 offen offset:3072 sc1 lds
buffer_load_dword v30, off, s[12:15], 0
s_add_u32 m0, m0, 4096
s_add_u32 s71, s70, s69
buffer_load_dwordx4 v8, s[8:11], s71 offen offset:0 sc1 lds
buffer_load_dwordx4 v9, s[8:11], s71 offen offset:1024 sc1 lds
buffer_load_dwordx4 v10, s[8:11], s71 offen offset:2048 sc1 lds
buffer_load_dwordx4 v11, s[8:11], s71 offen offset:3072 sc1 lds
buffer_load_dword v30, off, s[12:15], 0
s_add_u32 s64, s64, 1
s_and_b32 s64, s64, 15
s_sub_u32 s65, s65, 40960
s_cselect_b32 s65, 86016, s65
s_waitcnt vmcnt(20)
v_add_u32 v5, s34, 33
s_mov_b64 exec, 1
ds_write_b32 v3, v5
s_mov_b64 exec, -1
s_waitcnt vmcnt(10)
v_add_u32 v5, s34, 34
s_mov_b64 exec, 1
ds_write_b32 v3, v5
s_mov_b64 exec, -1
s_mov_b32 s63, 1
s_mov_b32 s34, 32
s_add_u32 s24, s24, 1409024
s_addc_u32 s25, s25, 0
s_mov_b32 s26, 1409024
s_mov_b32 s66, 32
s_branch lq_1
lcs_2:
s_mov_b32 s36, s64
s_mov_b32 s37, s65
s_mov_b32 s64, s59
s_mov_b32 s65, 114688
s_mul_i32 s70, s64, 393216
s_add_u32 m0, s65, s76
s_add_u32 s71, s70, s72
buffer_load_dwordx4 v12, s[12:15], s71 offen offset:0 lds
buffer_load_dwordx4 v13, s[12:15], s71 offen offset:1024 lds
buffer_load_dwordx4 v14, s[12:15], s71 offen offset:2048 lds
buffer_load_dwordx4 v15, s[12:15], s71 offen offset:3072 lds
buffer_load_dword v30, off, s[12:15], 0
s_add_u32 m0, m0, 4096
s_add_u32 s71, s70, s73
buffer_load_dwordx4 v12, s[12:15], s71 offen offset:0 lds
buffer_load_dwordx4 v13, s[12:15], s71 offen offset:1024 lds
buffer_load_dwordx4 v14, s[12:15], s71 offen offset:2048 lds
buffer_load_dwordx4 v15, s[12:15], s71 offen offset:3072 lds
buffer_load_dword v30, off, s[12:15], 0
s_add_u32 m0, m0, 4096
s_add_u32 s71, s70, s74
buffer_load_dwordx4 v12, s[12:15], s71 offen offset:0 lds
buffer_load_dwordx4 v13, s[12:15], s71 offen offset:1024 lds
buffer_load_dwordx4 v14, s[12:15], s71 offen offset:2048 lds
buffer_load_dwordx4 v15, s[12:15], s71 offen offset:3072 lds
buffer_load_dword v30, off, s[12:15], 0
s_mov_b32 s64, s36
s_mov_b32 s65, s37
s_branch lcb_3
L_f:
v_lshlrev_b32 v4, 4, v0
s_lshl4_add_u32 s78, s59, s60
v_mov_b32 v252, 0
v_mov_b32 v253, 0
v_mov_b32 v254, 0
v_mov_b32 v255, 0
s_lshl_b32 s35, s78, 10
s_cmp_eq_u32 s58, 0
s_cselect_b64 exec, -1, 0
buffer_store_dwordx4 v[252:255], v4, s[24:27], s35 offen offset:0 sc1
s_add_u32 s35, s35, 262144
buffer_store_dwordx4 v[252:255], v4, s[24:27], s35 offen offset:0 sc1
s_mov_b64 exec, -1
s_setprio 3
v_and_b32 v1, 3, v0
v_lshlrev_b32 v1, 2, v1
v_and_b32 v2, 4, v1
s_lshl2_add_u32 s35, s58, 24
v_mov_b32 v3, s35
s_mov_b32 s4, s54
s_mov_b32 s5, s55
s_mov_b32 s6, 0x100
s_mov_b32 s7, 0x00020000
s_add_u32 s70, s60, 4
s_lshr_b32 s70, s70, 3
s_sub_u32 s70, s60, s70
s_lshl4_add_u32 s64, s70, s59
s_and_b32 s70, s60, 7
s_cmp_eq_u32 s70, 3
s_cselect_b32 s65, 1, 0
s_mov_b32 s69, 0x3f803f80
s_barrier
s_cmp_eq_u32 s58, 0
s_cselect_b32 s16, s46, s48
s_cselect_b32 s17, s47, s49
s_mov_b32 s12, s50
s_mov_b32 s13, s51
s_mov_b32 s14, 0x0
s_mov_b32 s15, 0x00020000
s_cmp_eq_u32 s65, 0
s_cselect_b32 s18, 7340032, 0
s_mov_b32 s14, s18
s_lshr_b32 s70, s64, 3
s_and_b32 s71, s64, 7
s_lshl_b32 s66, s70, 10
s_add_u32 s66, s66, s71
s_lshl1_add_u32 s66, s66, s58
s_lshl_b32 s66, s66, 7
s_mul_i32 s71, s71, 917504
s_lshl_b32 s70, s70, 8
s_add_u32 s77, s71, s70
s_and_b32 s73, s2, 3
s_lshl_b32 s73, s73, 6
v_mov_b32 v14, 1
s_sub_u32 exec_lo, 1, s58
s_mov_b32 exec_hi, 0
s_waitcnt vmcnt(0)
buffer_atomic_add v14, off, s[4:7], s73 sc1
s_mov_b64 exec, -1
v_mov_b32 v8, s69
v_mov_b32 v9, s69
v_mov_b32 v10, s69
v_mov_b32 v11, s69
v_mov_b32 v12, s69
v_mov_b32 v13, s69
v_mov_b32 v14, s69
v_mov_b32 v15, s69
s_mov_b32 s70, 131072
ftop_38:
v_lshrrev_b32 v6, 4, v0
v_bfe_u32 v7, v0, 2, 2
v_lshl_add_u32 v6, v6, 3, v7
v_bfe_u32 v7, v0, 3, 2
s_lshl_b32 s71, s58, 1
v_xor_b32 v7, s71, v7
v_lshl_add_u32 v7, v7, 5, s70
v_lshl_add_u32 v6, v6, 7, v7
v_lshl_add_u32 v6, v1, 1, v6
v_xor_b32 v7, 32, v6
s_mul_i32 s71, s63, 29
s_add_u32 s35, s71, 6
lw_39:
ds_read_b32 v5, v2 offset:16
s_waitcnt lgkmcnt(0)
v_cmp_gt_i32 vcc, s35, v5
s_cbranch_vccz lwd_40
s_sleep 1
s_sub_u32 s32, s32, 1
s_cmp_gt_i32 s32, 0
s_cbranch_scc1 lw_39
lwd_40:
ds_read_b64_tr_b16 v[24:25], v6 offset:0
ds_read_b64_tr_b16 v[26:27], v6 offset:512
ds_read_b64_tr_b16 v[28:29], v6 offset:4096
ds_read_b64_tr_b16 v[30:31], v6 offset:4608
ds_read_b64_tr_b16 v[32:33], v7 offset:0
ds_read_b64_tr_b16 v[34:35], v7 offset:512
ds_read_b64_tr_b16 v[36:37], v7 offset:4096
ds_read_b64_tr_b16 v[38:39], v7 offset:4608
ds_read_b64_tr_b16 v[40:41], v6 offset:8192
ds_read_b64_tr_b16 v[42:43], v6 offset:8704
ds_read_b64_tr_b16 v[44:45], v6 offset:12288
ds_read_b64_tr_b16 v[46:47], v6 offset:12800
ds_read_b64_tr_b16 v[48:49], v7 offset:8192
ds_read_b64_tr_b16 v[50:51], v7 offset:8704
ds_read_b64_tr_b16 v[52:53], v7 offset:12288
ds_read_b64_tr_b16 v[54:55], v7 offset:12800
s_lshl_b32 s72, s60, 14
s_lshl_b32 s70, s58, 9
s_add_u32 s72, s72, s70
s_lshl_b32 s70, s59, 10
s_add_u32 s71, s72, s70
s_lshl_b32 s76, s59, 14
s_add_u32 s73, s76, 30686208
s_add_u32 s76, s76, 266240
s_waitcnt lgkmcnt(14)
v_mfma_f32_16x16x32_bf16 v[248:251], v[8:11], v[24:27], 0
s_waitcnt lgkmcnt(10)
v_mfma_f32_16x16x32_bf16 v[252:255], v[8:11], v[32:35], 0
v_mfma_f32_16x16x32_bf16 v[248:251], v[12:15], v[28:31], v[248:251]
s_waitcnt lgkmcnt(8)
v_mfma_f32_16x16x32_bf16 v[252:255], v[12:15], v[36:39], v[252:255]
ds_read_b64_tr_b16 v[24:25], v6 offset:16384
ds_read_b64_tr_b16 v[26:27], v6 offset:16896
ds_read_b64_tr_b16 v[28:29], v6 offset:20480
ds_read_b64_tr_b16 v[30:31], v6 offset:20992
ds_read_b64_tr_b16 v[32:33], v7 offset:16384
ds_read_b64_tr_b16 v[34:35], v7 offset:16896
ds_read_b64_tr_b16 v[36:37], v7 offset:20480
ds_read_b64_tr_b16 v[38:39], v7 offset:20992
s_waitcnt lgkmcnt(14)
v_mfma_f32_16x16x32_bf16 v[16:19], v[8:11], v[40:43], 0
s_waitcnt lgkmcnt(10)
v_mfma_f32_16x16x32_bf16 v[20:23], v[8:11], v[48:51], 0
v_mfma_f32_16x16x32_bf16 v[16:19], v[12:15], v[44:47], v[16:19]
s_waitcnt lgkmcnt(8)
v_mfma_f32_16x16x32_bf16 v[20:23], v[12:15], v[52:55], v[20:23]
v_mov_b32 v249, v252
v_mov_b32 v252, s69
v_mov_b32 v253, s69
v_mov_b32 v254, s69
v_mov_b32 v255, s69
v_mfma_f32_16x16x32_bf16 v[52:55], v[8:11], v[8:11], 0
s_nop 0
v_mfma_f32_16x16x32_bf16 v[48:51], v[8:11], v[252:255], 0
v_mfma_f32_16x16x32_bf16 v[52:55], v[12:15], v[12:15], v[52:55]
v_mfma_f32_16x16x32_bf16 v[48:51], v[12:15], v[252:255], v[48:51]
s_waitcnt lgkmcnt(6)
v_mfma_f32_16x16x32_bf16 v[40:43], v[8:11], v[24:27], 0
s_waitcnt lgkmcnt(2)
v_mfma_f32_16x16x32_bf16 v[44:47], v[8:11], v[32:35], 0
v_mfma_f32_16x16x32_bf16 v[40:43], v[12:15], v[28:31], v[40:43]
s_waitcnt lgkmcnt(0)
v_mfma_f32_16x16x32_bf16 v[44:47], v[12:15], v[36:39], v[44:47]
v_lshlrev_b32 v6, 3, v0
v_and_b32 v7, 48, v0
v_mov_b32_dpp v248, v16 quad_perm:[0,1,2,3] row_mask:0x2 bank_mask:0xf
v_mov_b32_dpp v249, v20 quad_perm:[0,1,2,3] row_mask:0x2 bank_mask:0xf
s_nop 0
v_mov_b32_dpp v248, v48 quad_perm:[0,1,2,3] row_mask:0x8 bank_mask:0xf
v_mov_b32_dpp v249, v52 quad_perm:[0,1,2,3] row_mask:0x8 bank_mask:0xf
s_nop 0
v_mov_b32_dpp v248, v40 quad_perm:[0,1,2,3] row_mask:0x4 bank_mask:0xf
v_mov_b32_dpp v249, v44 quad_perm:[0,1,2,3] row_mask:0x4 bank_mask:0xf
v_max_u32 v248, 1, v248
v_max_u32 v249, 1, v249
s_cmp_eq_u32 s63, 0
s_cbranch_scc1 fst_36
fsb_37:
buffer_store_dwordx2 v[248:249], v6, s[24:27], s71 offen sc1
s_lshl4_add_u32 s70, s58, s60
s_add_u32 s70, s70, s34
s_cmp_eq_u32 s70, 51
s_cbranch_scc1 fxt_41
fxb_42:
s_add_u32 s73, s72, 4096
s_add_u32 s74, s72, 8192
s_add_u32 s75, s72, 12288
v_lshrrev_b32 v7, 2, v0
v_lshlrev_b32 v7, 7, v7
v_lshl_add_u32 v7, v1, 2, v7
v_lshrrev_b32 v8, 5, v0
v_lshrrev_b32 v9, 4, v0
v_xor_b32 v10, v8, v9
v_and_b32 v10, 1, v10
v_lshl_add_u32 v8, v10, 1, v8
v_and_b32 v10, 15, v0
v_lshlrev_b32 v8, 7, v8
v_lshl_add_u32 v8, v10, 3, v8
v_add_u32 v8, 1280, v8
s_mul_i32 s70, s58, 384
s_lshl_b32 s71, s63, 10
s_add_u32 s70, s70, s71
s_add_u32 s70, s70, 2304
v_lshl_add_u32 v9, v9, 7, s70
v_lshl_add_u32 v9, v10, 2, v9
s_cmp_eq_u32 s63, 0
s_cbranch_scc1 fg_43
fg_44:
poll_45:
buffer_load_dwordx4 v[12:15], v7, s[24:27], s76 offen sc1
pchk_46:
s_waitcnt vmcnt(0)
v_min3_u32 v10, v12, v13, v14
v_min_u32 v10, v10, v15
v_cmp_eq_u32 vcc, 0, v10
s_cbranch_vccz pdone_47
s_sub_u32 s32, s32, 1
s_cmp_gt_i32 s32, 0
s_cbranch_scc1 poll_45
pdone_47:
s_lshr_b32 s70, s33, 7
s_sub_u32 s70, s70, s59
s_mul_i32 s70, s70, s63
s_cmp_eq_u32 s70, 0
s_cbranch_scc0 fng_48
poll_49:
buffer_load_dwordx2 v[24:25], v6, s[24:27], s72 offen offset:0 sc1
buffer_load_dwordx2 v[26:27], v6, s[24:27], s72 offen offset:1024 sc1
buffer_load_dwordx2 v[28:29], v6, s[24:27], s72 offen offset:2048 sc1
buffer_load_dwordx2 v[30:31], v6, s[24:27], s72 offen offset:3072 sc1
buffer_load_dwordx2 v[32:33], v6, s[24:27], s73 offen offset:0 sc1
buffer_load_dwordx2 v[34:35], v6, s[24:27], s73 offen offset:1024 sc1
buffer_load_dwordx2 v[36:37], v6, s[24:27], s73 offen offset:2048 sc1
buffer_load_dwordx2 v[38:39], v6, s[24:27], s73 offen offset:3072 sc1
buffer_load_dwordx2 v[40:41], v6, s[24:27], s74 offen offset:0 sc1
buffer_load_dwordx2 v[42:43], v6, s[24:27], s74 offen offset:1024 sc1
buffer_load_dwordx2 v[44:45], v6, s[24:27], s74 offen offset:2048 sc1
buffer_load_dwordx2 v[46:47], v6, s[24:27], s74 offen offset:3072 sc1
buffer_load_dwordx2 v[48:49], v6, s[24:27], s75 offen offset:0 sc1
buffer_load_dwordx2 v[50:51], v6, s[24:27], s75 offen offset:1024 sc1
buffer_load_dwordx2 v[52:53], v6, s[24:27], s75 offen offset:2048 sc1
buffer_load_dwordx2 v[54:55], v6, s[24:27], s75 offen offset:3072 sc1
pchk_50:
s_waitcnt vmcnt(14)
v_min3_u32 v10, v24, v25, v26
s_waitcnt vmcnt(13)
v_min3_u32 v10, v10, v27, v28
s_waitcnt vmcnt(12)
v_min3_u32 v10, v10, v29, v30
s_waitcnt vmcnt(11)
v_min3_u32 v10, v10, v31, v32
s_waitcnt vmcnt(10)
v_min3_u32 v10, v10, v33, v34
s_waitcnt vmcnt(9)
v_min3_u32 v10, v10, v35, v36
s_waitcnt vmcnt(8)
v_min3_u32 v10, v10, v37, v38
s_waitcnt vmcnt(7)
v_min3_u32 v10, v10, v39, v40
s_waitcnt vmcnt(6)
v_min3_u32 v10, v10, v41, v42
s_waitcnt vmcnt(5)
v_min3_u32 v10, v10, v43, v44
s_waitcnt vmcnt(4)
v_min3_u32 v10, v10, v45, v46
s_waitcnt vmcnt(3)
v_min3_u32 v10, v10, v47, v48
s_waitcnt vmcnt(2)
v_min3_u32 v10, v10, v49, v50
s_waitcnt vmcnt(1)
v_min3_u32 v10, v10, v51, v52
s_waitcnt vmcnt(0)
v_min3_u32 v10, v10, v53, v54
v_min_u32 v10, v10, v55
v_cmp_eq_u32 vcc, 0, v10
s_cbranch_vccz pdone_51
s_sub_u32 s32, s32, 1
s_cmp_gt_i32 s32, 0
s_cbranch_scc1 poll_49
pdone_51:
v_add_f32 v24, v24, v40
v_add_f32 v25, v25, v41
v_add_f32 v26, v26, v42
v_add_f32 v27, v27, v43
v_add_f32 v28, v28, v44
v_add_f32 v29, v29, v45
v_add_f32 v30, v30, v46
v_add_f32 v31, v31, v47
v_add_f32 v32, v32, v48
v_add_f32 v33, v33, v49
v_add_f32 v34, v34, v50
v_add_f32 v35, v35, v51
v_add_f32 v36, v36, v52
v_add_f32 v37, v37, v53
v_add_f32 v38, v38, v54
v_add_f32 v39, v39, v55
v_add_f32 v24, v24, v32
v_add_f32 v25, v25, v33
v_add_f32 v26, v26, v34
v_add_f32 v27, v27, v35
v_add_f32 v28, v28, v36
v_add_f32 v29, v29, v37
v_add_f32 v30, v30, v38
v_add_f32 v31, v31, v39
v_add_f32 v24, v24, v28
v_add_f32 v25, v25, v29
v_add_f32 v26, v26, v30
v_add_f32 v27, v27, v31
v_add_f32 v24, v24, v26
v_add_f32 v25, v25, v27
s_mov_b32 exec_hi, 0xffff
ds_write2_b32 v9, v24, v25 offset1:16
s_mov_b32 exec_hi, -1
v_mul_f32 v5, 0xba800000, v24
v_mul_f32 v25, 0x3a800000, v25
v_fma_f32 v25, -v5, v5, v25
v_max_f32 v25, 0, v25
v_add_f32 v25, 0x3727c5ac, v25
v_rsq_f32 v24, v25
s_nop 0
v_mul_f32 v25, v5, v24
s_lshl_b32 s70, s59, 7
s_sub_u32 s70, s33, s70
v_lshlrev_b32 v10, 1, v0
v_sub_u32 v10, s70, v10
v_readlane_b32 s70, v24, 48
v_readlane_b32 s71, v25, 48
v_cmp_eq_u32 vcc, 0, v10
s_mov_b64 exec, vcc
v_mov_b32 v12, s70
v_mov_b32 v13, s71
s_mov_b64 exec, -1
v_cmp_eq_u32 vcc, 1, v10
s_mov_b64 exec, vcc
v_mov_b32 v14, s70
v_mov_b32 v15, s71
s_mov_b64 exec, -1
fng_48:
ds_write2_b32 v8, v12, v14 offset1:1
ds_write2_b32 v8, v13, v15 offset0:128 offset1:129
s_add_u32 s71, s34, s63
v_add_u32 v5, s71, 2
s_mov_b64 exec, 1
ds_write_b32 v3, v5
s_mov_b64 exec, -1
s_setprio 0
s_cmp_eq_u32 s63, 0
s_cbranch_scc1 fnw_52
fnw_53:
s_and_b32 s70, s64, 7
s_lshl_b32 s70, s70, 7
s_add_u32 s73, s70, 276480
s_lshl1_add_u32 s72, s70, 272384
s_lshr_b32 s71, s64, 3
s_lshl_b32 s76, s71, 13
s_add_u32 s76, s76, 1048576
s_lshl2_add_u32 s74, s70, s76
s_lshl_b32 s70, s58, 8
s_add_u32 s74, s74, s70
s_add_u32 s75, s74, 4096
s_lshl4_add_u32 s76, s70, s76
v_and_b32 v251, 15, v0
v_lshlrev_b32 v6, 14, v251
v_lshrrev_b32 v252, 4, v0
v_lshl_add_u32 v7, v252, 5, v6
v_lshlrev_b32 v251, 4, v251
s_lshl_b32 s70, s58, 3
v_lshl_add_u32 v253, v252, 1, s70
v_add_u32 v253, v253, v251
v_lshlrev_b32 v254, 5, v252
v_lshl_add_u32 v254, v2, 2, v254
v_and_b32 v255, 7, v0
v_lshl_add_u32 v255, v255, 2, v252
v_lshlrev_b32 v255, 3, v255
s_add_u32 s35, s34, 22
lw_54:
ds_read_b32 v5, v1 offset:0
s_waitcnt lgkmcnt(0)
v_cmp_gt_i32 vcc, s35, v5
s_cbranch_vccz lwd_55
s_sleep 4
s_sub_u32 s32, s32, 1
s_cmp_gt_i32 s32, 0
s_cbranch_scc1 lw_54
lwd_55:
s_setprio 3
s_add_u32 s35, s34, 24
lw_56:
ds_read_b32 v5, v1 offset:0
s_waitcnt lgkmcnt(0)
v_cmp_gt_i32 vcc, s35, v5
s_cbranch_vccz lwd_57
s_sleep 2
s_sub_u32 s32, s32, 1
s_cmp_gt_i32 s32, 0
s_cbranch_scc1 lw_56
lwd_57:
s_mul_i32 s79, s63, 64
s_sub_u32 s79, 32, s79
s_add_u32 s35, s79, 3
lw_58:
ds_read_b32 v5, v2 offset:16
s_waitcnt lgkmcnt(0)
v_cmp_gt_i32 vcc, s35, v5
s_cbranch_vccz lwd_59
s_sleep 4
s_sub_u32 s32, s32, 1
s_cmp_gt_i32 s32, 0
s_cbranch_scc1 lw_58
lwd_59:
s_cmp_eq_u32 s65, 0
s_cbranch_scc0 fnd_61
poll_62:
buffer_load_dwordx2 v[248:249], v6, s[24:27], s73 offen sc1
buffer_load_dwordx4 v[8:11], v7, s[24:27], s72 offen offset:0 sc1
buffer_load_dwordx4 v[12:15], v7, s[24:27], s72 offen offset:16 sc1
buffer_load_dwordx4 v[16:19], v7, s[24:27], s72 offen offset:128 sc1
buffer_load_dwordx4 v[20:23], v7, s[24:27], s72 offen offset:144 sc1
pchk_63:
s_waitcnt vmcnt(3)
v_min3_u32 v5, v248, v249, v8
v_min3_u32 v5, v5, v9, v10
s_waitcnt vmcnt(2)
v_min3_u32 v5, v5, v11, v12
v_min3_u32 v5, v5, v13, v14
s_waitcnt vmcnt(1)
v_min3_u32 v5, v5, v15, v16
v_min3_u32 v5, v5, v17, v18
s_waitcnt vmcnt(0)
v_min3_u32 v5, v5, v19, v20
v_min3_u32 v5, v5, v21, v22
v_min_u32 v5, v5, v23
v_cmp_eq_u32 vcc, 0, v5
s_cbranch_vccz pdone_64
s_sub_u32 s32, s32, 1
s_cmp_gt_i32 s32, 0
s_cbranch_scc1 poll_62
pdone_64:
v_mfma_f32_16x16x32_bf16 v[24:27], v[8:11], v[56:59], 0
v_mov_b32 v250, v248
v_mfma_f32_16x16x32_bf16 v[28:31], v[8:11], v[60:63], 0
s_nop 0
v_max_f32_dpp v250, v250, v250 row_ror:1 row_mask:0xf bank_mask:0xf
v_mfma_f32_16x16x32_bf16 v[32:35], v[8:11], v[64:67], 0
s_nop 0
v_max_f32_dpp v250, v250, v250 row_ror:2 row_mask:0xf bank_mask:0xf
v_mfma_f32_16x16x32_bf16 v[36:39], v[8:11], v[68:71], 0
s_nop 0
v_max_f32_dpp v250, v250, v250 row_ror:4 row_mask:0xf bank_mask:0xf
v_mfma_f32_16x16x32_bf16 v[40:43], v[8:11], v[72:75], 0
s_nop 0
v_max_f32_dpp v250, v250, v250 row_ror:8 row_mask:0xf bank_mask:0xf
v_mfma_f32_16x16x32_bf16 v[44:47], v[8:11], v[76:79], 0
v_cmp_eq_f32 vcc, v250, v248
v_mfma_f32_16x16x32_bf16 v[48:51], v[8:11], v[80:83], 0
s_ff1_i32_b64 s68, vcc
v_mfma_f32_16x16x32_bf16 v[52:55], v[8:11], v[84:87], 0
s_and_b32 s68, s68, 15
v_mfma_f32_16x16x32_bf16 v[24:27], v[12:15], v[88:91], v[24:27]
v_readlane_b32 s33, v249, s68
v_mfma_f32_16x16x32_bf16 v[28:31], v[12:15], v[92:95], v[28:31]
v_readlane_b32 s67, v248, s68
v_mfma_f32_16x16x32_bf16 v[32:35], v[12:15], v[96:99], v[32:35]
v_add_u32 v5, s34, 4
v_mfma_f32_16x16x32_bf16 v[36:39], v[12:15], v[100:103], v[36:39]
v_mov_b32 v250, s33
v_mfma_f32_16x16x32_bf16 v[40:43], v[12:15], v[104:107], v[40:43]
s_mov_b64 exec, 1
ds_write2_b32 v3, v5, v250 offset1:2
s_mov_b64 exec, -1
v_mfma_f32_16x16x32_bf16 v[44:47], v[12:15], v[108:111], v[44:47]
s_sub_u32 s33, s33, 1
v_mfma_f32_16x16x32_bf16 v[48:51], v[12:15], v[112:115], v[48:51]
s_and_b32 s33, s33, 2047
v_mfma_f32_16x16x32_bf16 v[52:55], v[12:15], v[116:119], v[52:55]
v_mfma_f32_16x16x32_bf16 v[24:27], v[16:19], v[120:123], v[24:27]
v_mfma_f32_16x16x32_bf16 v[28:31], v[16:19], v[124:127], v[28:31]
v_mfma_f32_16x16x32_bf16 v[32:35], v[16:19], v[128:131], v[32:35]
v_mfma_f32_16x16x32_bf16 v[36:39], v[16:19], v[132:135], v[36:39]
v_mfma_f32_16x16x32_bf16 v[40:43], v[16:19], v[136:139], v[40:43]
v_mfma_f32_16x16x32_bf16 v[44:47], v[16:19], v[140:143], v[44:47]
v_mfma_f32_16x16x32_bf16 v[48:51], v[16:19], v[144:147], v[48:51]
v_mfma_f32_16x16x32_bf16 v[52:55], v[16:19], v[148:151], v[52:55]
v_mfma_f32_16x16x32_bf16 v[24:27], v[20:23], v[152:155], v[24:27]
s_and_b32 s70, s68, 12
s_lshl_b32 s70, s70, 2
s_bitcmp1_b32 s68, 1
v_mfma_f32_16x16x32_bf16 v[28:31], v[20:23], v[156:159], v[28:31]
v_mfma_f32_16x16x32_bf16 v[32:35], v[20:23], v[160:163], v[32:35]
v_mfma_f32_16x16x32_bf16 v[36:39], v[20:23], v[164:167], v[36:39]
v_mfma_f32_16x16x32_bf16 v[40:43], v[20:23], v[168:171], v[40:43]
v_mfma_f32_16x16x32_bf16 v[44:47], v[20:23], v[172:175], v[44:47]
v_mfma_f32_16x16x32_bf16 v[48:51], v[20:23], v[176:179], v[48:51]
v_mfma_f32_16x16x32_bf16 v[52:55], v[20:23], v[180:183], v[52:55]
s_cbranch_scc1 fsel_67
fsel_65:
s_bitcmp1_b32 s68, 0
s_cbranch_scc1 fsel_66
v_max_u32 v8, 1, v24
v_max_u32 v9, 1, v28
v_max_u32 v10, 1, v32
v_max_u32 v11, 1, v36
v_max_u32 v12, 1, v40
v_max_u32 v13, 1, v44
v_max_u32 v14, 1, v48
v_max_u32 v15, 1, v52
s_branch fsel_69
fsel_66:
v_max_u32 v8, 1, v25
v_max_u32 v9, 1, v29
v_max_u32 v10, 1, v33
v_max_u32 v11, 1, v37
v_max_u32 v12, 1, v41
v_max_u32 v13, 1, v45
v_max_u32 v14, 1, v49
v_max_u32 v15, 1, v53
s_branch fsel_69
fsel_67:
s_bitcmp1_b32 s68, 0
s_cbranch_scc1 fsel_68
v_max_u32 v8, 1, v26
v_max_u32 v9, 1, v30
v_max_u32 v10, 1, v34
v_max_u32 v11, 1, v38
v_max_u32 v12, 1, v42
v_max_u32 v13, 1, v46
v_max_u32 v14, 1, v50
v_max_u32 v15, 1, v54
s_branch fsel_69
fsel_68:
v_max_u32 v8, 1, v27
v_max_u32 v9, 1, v31
v_max_u32 v10, 1, v35
v_max_u32 v11, 1, v39
v_max_u32 v12, 1, v43
v_max_u32 v13, 1, v47
v_max_u32 v14, 1, v51
v_max_u32 v15, 1, v55
fsel_69:
s_bfm_b64 exec, 16, s70
buffer_store_dwordx4 v[8:11], v251, s[24:27], s74 offen sc1
buffer_store_dwordx4 v[12:15], v251, s[24:27], s75 offen sc1
s_mov_b64 exec, -1
s_and_b32 s70, s64, 7
s_lshl1_add_u32 s70, s70, s58
s_mul_i32 s70, s70, 28
s_add_u32 s70, s70, s71
s_lshl_b32 s70, s70, 8
s_add_u32 s70, s70, 1277952
s_waitcnt vmcnt(0)
s_mul_i32 s79, s63, 64
s_sub_u32 s79, 32, s79
s_add_u32 s35, s79, 7
lw_70:
ds_read_b32 v5, v2 offset:16
s_waitcnt lgkmcnt(0)
v_cmp_gt_i32 vcc, s35, v5
s_cbranch_vccz lwd_71
s_sleep 4
s_sub_u32 s32, s32, 1
s_cmp_gt_i32 s32, 0
s_cbranch_scc1 lw_70
lwd_71:
poll_72:
buffer_load_dwordx4 v[24:27], v4, s[24:27], s76 offen offset:0 sc1
buffer_load_dwordx4 v[28:31], v4, s[24:27], s76 offen offset:1024 sc1
buffer_load_dwordx4 v[32:35], v4, s[24:27], s76 offen offset:2048 sc1
buffer_load_dwordx4 v[36:39], v4, s[24:27], s76 offen offset:3072 sc1
pchk_73:
s_waitcnt vmcnt(3)
v_min3_u32 v5, v24, v25, v26
s_waitcnt vmcnt(2)
v_min3_u32 v5, v5, v27, v28
v_min3_u32 v5, v5, v29, v30
s_waitcnt vmcnt(1)
v_min3_u32 v5, v5, v31, v32
v_min3_u32 v5, v5, v33, v34
s_waitcnt vmcnt(0)
v_min3_u32 v5, v5, v35, v36
v_min3_u32 v5, v5, v37, v38
v_min_u32 v5, v5, v39
v_cmp_eq_u32 vcc, 0, v5
s_cbranch_vccz pdone_74
s_sub_u32 s32, s32, 1
s_cmp_gt_i32 s32, 0
s_cbranch_scc1 poll_72
pdone_74:
v_add_f32 v24, v24, v32
v_add_f32 v25, v25, v33
v_add_f32 v26, v26, v34
v_add_f32 v27, v27, v35
v_add_f32 v28, v28, v36
v_add_f32 v29, v29, v37
v_add_f32 v30, v30, v38
v_add_f32 v31, v31, v39
v_add_f32 v24, v24, v28
v_add_f32 v25, v25, v29
v_add_f32 v26, v26, v30
v_add_f32 v27, v27, v31
s_nop 0
v_permlane32_swap_b32 v24, v26
v_permlane32_swap_b32 v25, v27
v_add_f32 v24, v24, v26
v_add_f32 v25, v25, v27
s_nop 1
v_permlane16_swap_b32 v24, v25
v_mul_f32 v26, 0xbfb8aa3b, v24
v_exp_f32 v26, v26
v_mul_f32 v24, v24, v25
v_add_f32 v26, 1.0, v26
v_rcp_f32 v26, v26
v_add_u32 v5, s34, 5
v_mul_f32 v24, v24, v26
v_cvt_pk_bf16_f32 v24, v24, v24
ds_write_b16 v253, v24 offset:512
s_mov_b64 exec, 1
ds_write_b32 v3, v5
s_mov_b64 exec, -1
s_add_u32 s35, s34, 5
poll_75:
ds_read_b32 v5, v2 offset:24
ds_read_b128 v[8:11], v254 offset:512
ds_read_b128 v[12:15], v254 offset:640
pchk_76:
s_waitcnt lgkmcnt(2)
v_cmp_gt_i32 vcc, s35, v5
s_cbranch_vccz pdone_77
s_sleep 1
s_sub_u32 s32, s32, 1
s_cmp_gt_i32 s32, 0
s_cbranch_scc1 poll_75
pdone_77:
s_waitcnt lgkmcnt(1)
v_mfma_f32_16x16x32_bf16 v[24:27], v[8:11], v[184:187], 0
v_mfma_f32_16x16x32_bf16 v[28:31], v[8:11], v[188:191], 0
v_mfma_f32_16x16x32_bf16 v[32:35], v[8:11], v[192:195], 0
v_mfma_f32_16x16x32_bf16 v[36:39], v[8:11], v[196:199], 0
v_mfma_f32_16x16x32_bf16 v[40:43], v[8:11], v[200:203], 0
v_mfma_f32_16x16x32_bf16 v[44:47], v[8:11], v[204:207], 0
v_mfma_f32_16x16x32_bf16 v[48:51], v[8:11], v[208:211], 0
v_mfma_f32_16x16x32_bf16 v[52:55], v[8:11], v[212:215], 0
s_waitcnt lgkmcnt(0)
v_mfma_f32_16x16x32_bf16 v[24:27], v[12:15], v[216:219], v[24:27]
v_mfma_f32_16x16x32_bf16 v[28:31], v[12:15], v[220:223], v[28:31]
v_mfma_f32_16x16x32_bf16 v[32:35], v[12:15], v[224:227], v[32:35]
v_mfma_f32_16x16x32_bf16 v[36:39], v[12:15], v[228:231], v[36:39]
v_mfma_f32_16x16x32_bf16 v[40:43], v[12:15], v[232:235], v[40:43]
v_mfma_f32_16x16x32_bf16 v[44:47], v[12:15], v[236:239], v[44:47]
v_mfma_f32_16x16x32_bf16 v[48:51], v[12:15], v[240:243], v[48:51]
v_mfma_f32_16x16x32_bf16 v[52:55], v[12:15], v[244:247], v[52:55]
s_nop 0
v_add_f32_dpp v16, v25, v24 row_ror:8 row_mask:0x1 bank_mask:0xf
v_add_f32_dpp v17, v29, v28 row_ror:8 row_mask:0x1 bank_mask:0xf
s_nop 0
v_add_f32_dpp v16, v33, v32 row_ror:8 row_mask:0x2 bank_mask:0xf
v_add_f32_dpp v17, v37, v36 row_ror:8 row_mask:0x2 bank_mask:0xf
s_nop 0
v_add_f32_dpp v16, v41, v40 row_ror:8 row_mask:0x4 bank_mask:0xf
v_add_f32_dpp v17, v45, v44 row_ror:8 row_mask:0x4 bank_mask:0xf
s_nop 0
v_add_f32_dpp v16, v49, v48 row_ror:8 row_mask:0x8 bank_mask:0xf
v_add_f32_dpp v17, v53, v52 row_ror:8 row_mask:0x8 bank_mask:0xf
v_max_u32 v16, 1, v16
v_max_u32 v17, 1, v17
s_mov_b32 exec_lo, 0x00ff00ff
s_mov_b32 exec_hi, 0x00ff00ff
buffer_store_dwordx2 v[16:17], v255, s[24:27], s70 offen sc1
s_mov_b64 exec, -1
fnd_60:
s_sub_u32 s70, s60, 3
s_mul_i32 s70, s70, s63
s_or_b32 s70, s70, s58
s_cbranch_scc1 fnr_78
s_mul_i32 s72, s59, 7168
s_add_u32 s72, s72, 1277952
s_add_u32 s73, s72, 4096
s_lshl_b32 s70, s68, 6
s_add_u32 s70, s70, s59
s_lshl_b32 s70, s70, 8
s_add_u32 s76, s70, 262144
v_mov_b32 v12, s67
v_mul_f32 v12, 0xbfb8aa3b, v12
v_exp_f32 v12, v12
v_lshl_add_u32 v6, v252, 2, v251
v_add_f32 v12, 1.0, v12
v_rcp_f32 v12, v12
v_lshrrev_b32 v7, 1, v6
s_lshl4_add_u32 s70, s33, s59
s_lshl_b32 s70, s70, 7
v_and_b32 v8, 0x46, v7
v_lshl_add_u32 v8, v1, 2, v8
v_and_b32 v9, 4, v0
v_lshl_add_u32 v8, v9, 1, v8
s_waitcnt vmcnt(0)
s_cmp_gt_u32 s65, s63
s_cbranch_scc1 fpre_80
fpre_81:
s_mul_i32 s79, s63, 64
s_sub_u32 s79, 32, s79
s_add_u32 s35, s79, 11
lw_82:
ds_read_b32 v5, v2 offset:16
s_waitcnt lgkmcnt(0)
v_cmp_gt_i32 vcc, s35, v5
s_cbranch_vccz lwd_83
s_sleep 4
s_sub_u32 s32, s32, 1
s_cmp_gt_i32 s32, 0
s_cbranch_scc1 lw_82
lwd_83:
poll_84:
buffer_load_dword v52, v6, s[24:27], s76 offen sc1
buffer_load_dwordx4 v[24:27], v4, s[24:27], s72 offen offset:0 sc1
buffer_load_dwordx4 v[28:31], v4, s[24:27], s72 offen offset:1024 sc1
buffer_load_dwordx4 v[32:35], v4, s[24:27], s72 offen offset:2048 sc1
buffer_load_dwordx4 v[36:39], v4, s[24:27], s72 offen offset:3072 sc1
buffer_load_dwordx4 v[40:43], v4, s[24:27], s73 offen offset:0 sc1
buffer_load_dwordx4 v[44:47], v4, s[24:27], s73 offen offset:1024 sc1
buffer_load_dwordx4 v[48:51], v4, s[24:27], s73 offen offset:2048 sc1
pchk_85:
s_waitcnt vmcnt(6)
v_min3_u32 v5, v24, v25, v26
s_waitcnt vmcnt(5)
v_min3_u32 v5, v5, v27, v28
v_min3_u32 v5, v5, v29, v30
s_waitcnt vmcnt(4)
v_min3_u32 v5, v5, v31, v32
v_min3_u32 v5, v5, v33, v34
s_waitcnt vmcnt(3)
v_min3_u32 v5, v5, v35, v36
v_min3_u32 v5, v5, v37, v38
s_waitcnt vmcnt(2)
v_min3_u32 v5, v5, v39, v40
v_min3_u32 v5, v5, v41, v42
s_waitcnt vmcnt(1)
v_min3_u32 v5, v5, v43, v44
v_min3_u32 v5, v5, v45, v46
s_waitcnt vmcnt(0)
v_min3_u32 v5, v5, v47, v48
v_min3_u32 v5, v5, v49, v50
v_min3_u32 v5, v5, v51, v52
v_cmp_eq_u32 vcc, 0, v5
s_cbranch_vccz pdone_86
s_sub_u32 s32, s32, 1
s_cmp_gt_i32 s32, 0
s_cbranch_scc1 poll_84
pdone_86:
v_add_f32 v24, v24, v40
v_add_f32 v25, v25, v41
v_add_f32 v26, v26, v42
v_add_f32 v27, v27, v43
v_add_f32 v28, v28, v44
v_add_f32 v29, v29, v45
v_add_f32 v30, v30, v46
v_add_f32 v31, v31, v47
v_add_f32 v32, v32, v48
v_add_f32 v33, v33, v49
v_add_f32 v34, v34, v50
v_add_f32 v35, v35, v51
v_add_f32 v24, v24, v32
v_add_f32 v25, v25, v33
v_add_f32 v26, v26, v34
v_add_f32 v27, v27, v35
v_add_f32 v28, v28, v36
v_add_f32 v29, v29, v37
v_add_f32 v30, v30, v38
v_add_f32 v31, v31, v39
v_add_f32 v24, v24, v28
v_add_f32 v25, v25, v29
v_add_f32 v26, v26, v30
v_add_f32 v27, v27, v31
s_nop 0
v_permlane32_swap_b32 v24, v26
v_permlane32_swap_b32 v25, v27
v_add_f32 v24, v24, v26
v_add_f32 v25, v25, v27
s_nop 1
v_permlane16_swap_b32 v24, v25
v_add_f32 v24, v24, v25
v_fma_f32 v24, v24, v12, v52
v_cvt_pk_bf16_f32 v24, v24, v24
s_cmp_eq_u32 s63, 0
s_cbranch_scc1 fl0_79
buffer_store_short v24, v7, s[28:31], s70 offen
s_branch L_end
fl0_79:
ds_write_b16 v8, v24 offset:384
fnr_78:
s_cmp_eq_u32 s63, 0
s_cbranch_scc0 L_end
v_add_u32 v5, s34, 6
s_mov_b64 exec, 1
ds_write_b32 v3, v5
s_mov_b64 exec, -1
v_and_b32 v6, 48, v0
s_add_u32 s35, s34, 6
poll_87:
ds_read_b32 v5, v2 offset:24
ds_read_b128 v[8:11], v6 offset:384
ds_read_b128 v[12:15], v6 offset:448
pchk_88:
s_waitcnt lgkmcnt(2)
v_cmp_gt_i32 vcc, s35, v5
s_cbranch_vccz pdone_89
s_sleep 1
s_sub_u32 s32, s32, 1
s_cmp_gt_i32 s32, 0
s_cbranch_scc1 poll_87
pdone_89:
s_mov_b32 s63, 1
s_mov_b32 s34, 32
s_add_u32 s24, s24, 1409024
s_addc_u32 s25, s25, 0
s_mov_b32 s26, 1409024
s_mov_b32 s70, 131072
s_mov_b32 s79, 34
s_branch ftop_38
fxt_41:
v_max_u32 v8, 1, v8
v_max_u32 v9, 1, v9
v_max_u32 v10, 1, v10
v_max_u32 v11, 1, v11
v_max_u32 v12, 1, v12
v_max_u32 v13, 1, v13
v_max_u32 v14, 1, v14
v_max_u32 v15, 1, v15
s_mov_b32 exec_lo, 0x10001
s_mov_b32 exec_hi, 0x10001
buffer_store_dwordx4 v[8:11], v7, s[20:23], s73 offen offset:0 sc1
buffer_store_dwordx4 v[12:15], v7, s[20:23], s73 offen offset:64 sc1
s_mov_b64 exec, -1
s_branch fxb_42
fst_36:
s_lshl1_add_u32 s70, s78, s58
s_lshl_b32 s70, s70, 13
v_bfe_u32 v8, v0, 2, 2
v_lshl_add_u32 v8, v8, 9, v7
v_add_u32 v8, v8, v1
v_lshlrev_b32 v8, 2, v8
buffer_load_dwordx4 v[24:27], v8, s[8:11], s70 offen offset:0
buffer_load_dwordx4 v[28:31], v8, s[8:11], s70 offen offset:256
buffer_load_dwordx4 v[32:35], v8, s[8:11], s70 offen offset:512
buffer_load_dwordx4 v[36:39], v8, s[8:11], s70 offen offset:768
buffer_load_dwordx4 v[40:43], v8, s[8:11], s70 offen offset:1024
buffer_load_dwordx4 v[44:47], v8, s[8:11], s70 offen offset:1280
buffer_load_dwordx4 v[48:51], v8, s[8:11], s70 offen offset:1536
buffer_load_dwordx4 v[52:55], v8, s[8:11], s70 offen offset:1792
v_lshlrev_b32 v9, 4, v1
s_waitcnt vmcnt(7)
v_mfma_f32_16x16x32_bf16 v[16:19], v[24:27], v[252:255], 0
v_mfma_f32_16x16x32_bf16 v[20:23], v[24:27], v[24:27], 0
s_waitcnt vmcnt(6)
v_mfma_f32_16x16x32_bf16 v[16:19], v[28:31], v[252:255], v[16:19]
v_mfma_f32_16x16x32_bf16 v[20:23], v[28:31], v[28:31], v[20:23]
s_waitcnt vmcnt(5)
v_mfma_f32_16x16x32_bf16 v[16:19], v[32:35], v[252:255], v[16:19]
v_mfma_f32_16x16x32_bf16 v[20:23], v[32:35], v[32:35], v[20:23]
s_waitcnt vmcnt(4)
v_mfma_f32_16x16x32_bf16 v[16:19], v[36:39], v[252:255], v[16:19]
v_mfma_f32_16x16x32_bf16 v[20:23], v[36:39], v[36:39], v[20:23]
s_waitcnt vmcnt(3)
v_mfma_f32_16x16x32_bf16 v[16:19], v[40:43], v[252:255], v[16:19]
v_mfma_f32_16x16x32_bf16 v[20:23], v[40:43], v[40:43], v[20:23]
s_waitcnt vmcnt(2)
v_mfma_f32_16x16x32_bf16 v[16:19], v[44:47], v[252:255], v[16:19]
v_mfma_f32_16x16x32_bf16 v[20:23], v[44:47], v[44:47], v[20:23]
s_waitcnt vmcnt(1)
v_mfma_f32_16x16x32_bf16 v[16:19], v[48:51], v[252:255], v[16:19]
v_mfma_f32_16x16x32_bf16 v[20:23], v[48:51], v[48:51], v[20:23]
s_waitcnt vmcnt(0)
v_mfma_f32_16x16x32_bf16 v[16:19], v[52:55], v[252:255], v[16:19]
v_mfma_f32_16x16x32_bf16 v[20:23], v[52:55], v[52:55], v[20:23]
s_nop 6
v_add_f32 v16, v16, v18
v_add_f32 v17, v17, v19
v_add_f32 v16, v16, v17
s_nop 0
v_mov_b32_dpp v17, v20 quad_perm:[0,0,0,0] row_mask:0xf bank_mask:0xf
s_nop 1
v_add_f32_dpp v17, v21, v17 quad_perm:[1,1,1,1] row_mask:0xf bank_mask:0xf
s_nop 1
v_add_f32_dpp v17, v22, v17 quad_perm:[2,2,2,2] row_mask:0xf bank_mask:0xf
s_nop 1
v_add_f32_dpp v17, v23, v17 quad_perm:[3,3,3,3] row_mask:0xf bank_mask:0xf
v_mul_f32 v5, 0xba800000, v16
v_mul_f32 v17, 0x3a800000, v17
v_fma_f32 v17, -v5, v5, v17
v_max_f32 v17, 0, v17
v_add_f32 v17, 0x3727c5ac, v17
v_rsq_f32 v16, v17
s_nop 0
v_mul_f32 v17, v5, v16
v_max_u32 v17, 1, v17
s_lshl_b32 s70, s60, 7
s_add_u32 s70, s70, s76
s_lshl_b32 s73, s58, 5
s_add_u32 s70, s70, s73
v_lshrrev_b32 v7, 1, v7
s_add_u32 s35, s34, 5
lw_90:
ds_read_b32 v5, v2 offset:16
s_waitcnt lgkmcnt(0)
v_cmp_gt_i32 vcc, s35, v5
s_cbranch_vccz lwd_91
s_sleep 4
s_sub_u32 s32, s32, 1
s_cmp_gt_i32 s32, 0
s_cbranch_scc1 lw_90
lwd_91:
poll_92:
buffer_load_dword v12, v9, s[4:7], 0 offen sc1
pchk_93:
s_waitcnt vmcnt(0)
v_cmp_gt_u32 vcc, 64, v12
s_cbranch_vccz pdone_94
s_sleep 16
s_sub_u32 s32, s32, 1
s_cmp_gt_i32 s32, 0
s_cbranch_scc1 poll_92
pdone_94:
s_mov_b32 exec_lo, 0x00100001
s_mov_b32 exec_hi, 0x10000100
buffer_store_dwordx2 v[16:17], v7, s[24:27], s70 offen sc1
s_mov_b64 exec, -1
s_branch fsb_37
fg_43:
s_lshl1_add_u32 s35, s2, s58
s_lshl_b32 s35, s35, 12
s_add_u32 s44, s40, s35
s_addc_u32 s45, s41, 0
s_mov_b32 s35, 4
ft_95:
s_load_dwordx2 s[42:43], s[44:45], 60
s_load_dwordx2 s[42:43], s[44:45], 188
s_load_dwordx2 s[42:43], s[44:45], 316
s_load_dwordx2 s[42:43], s[44:45], 444
s_load_dwordx2 s[42:43], s[44:45], 572
s_load_dwordx2 s[42:43], s[44:45], 700
s_load_dwordx2 s[42:43], s[44:45], 828
s_load_dwordx2 s[42:43], s[44:45], 956
s_add_u32 s44, s44, 1024
s_addc_u32 s45, s45, 0
s_sub_u32 s35, s35, 1
s_cmp_eq_u32 s35, 0
s_cbranch_scc0 ft_95
v_lshrrev_b32 v250, 3, v0
v_mul_u32_u24 v250, 16256, v250
v_add_u32 v250, v250, v4
s_add_u32 s35, s66, 131072
buffer_load_dwordx4 v[184:187], v250, s[12:15], s35 offen nt
s_add_u32 s35, s66, 133120
buffer_load_dwordx4 v[188:191], v250, s[12:15], s35 offen nt
s_add_u32 s35, s66, 135168
buffer_load_dwordx4 v[192:195], v250, s[12:15], s35 offen nt
s_add_u32 s35, s66, 137216
buffer_load_dwordx4 v[196:199], v250, s[12:15], s35 offen nt
s_add_u32 s35, s66, 139264
buffer_load_dwordx4 v[200:203], v250, s[12:15], s35 offen nt
s_add_u32 s35, s66, 141312
buffer_load_dwordx4 v[204:207], v250, s[12:15], s35 offen nt
s_add_u32 s35, s66, 143360
buffer_load_dwordx4 v[208:211], v250, s[12:15], s35 offen nt
s_add_u32 s35, s66, 145408
buffer_load_dwordx4 v[212:215], v250, s[12:15], s35 offen nt
v_lshrrev_b32 v250, 3, v0
v_mul_u32_u24 v250, 16256, v250
v_add_u32 v250, v250, v4
s_add_u32 s35, s66, 0
buffer_load_dwordx4 v[152:155], v250, s[12:15], s35 offen nt
s_add_u32 s35, s66, 2048
buffer_load_dwordx4 v[156:159], v250, s[12:15], s35 offen nt
s_add_u32 s35, s66, 4096
buffer_load_dwordx4 v[160:163], v250, s[12:15], s35 offen nt
s_add_u32 s35, s66, 6144
buffer_load_dwordx4 v[164:167], v250, s[12:15], s35 offen nt
s_add_u32 s35, s66, 8192
buffer_load_dwordx4 v[168:171], v250, s[12:15], s35 offen nt
s_add_u32 s35, s66, 10240
buffer_load_dwordx4 v[172:175], v250, s[12:15], s35 offen nt
s_add_u32 s35, s66, 12288
buffer_load_dwordx4 v[176:179], v250, s[12:15], s35 offen nt
s_add_u32 s35, s66, 14336
buffer_load_dwordx4 v[180:183], v250, s[12:15], s35 offen nt
s_add_u32 s35, s34, 10
lw_96:
ds_read_b32 v5, v2 offset:16
s_waitcnt lgkmcnt(0)
v_cmp_gt_i32 vcc, s35, v5
s_cbranch_vccz lwd_97
s_sleep 4
s_sub_u32 s32, s32, 1
s_cmp_gt_i32 s32, 0
s_cbranch_scc1 lw_96
lwd_97:
s_branch fg_44
fnw_52:
s_waitcnt lgkmcnt(0)
v_mov_b32 v252, 0
v_mov_b32 v253, 0
v_mov_b32 v254, 0
v_mov_b32 v255, 0
s_mul_i32 s42, s58, 1409024
s_mul_i32 s35, s78, 2048
s_add_u32 s35, s35, s42
s_add_u32 s35, s35, 524288
buffer_store_dwordx4 v[252:255], v4, s[24:27], s35 offen offset:0 sc1
buffer_store_dwordx4 v[252:255], v4, s[24:27], s35 offen offset:1024 sc1
s_mul_i32 s35, s78, 1408
s_add_u32 s35, s35, s42
s_add_u32 s35, s35, 1048576
buffer_store_dwordx4 v[252:255], v4, s[24:27], s35 offen offset:0 sc1
buffer_store_dwordx4 v[252:255], v4, s[24:27], s35 offen offset:384 sc1
s_lshl_b32 s35, s78, 10
s_add_u32 s35, s35, 1409024
s_cmp_eq_u32 s58, 1
s_cselect_b64 exec, -1, 0
buffer_store_dwordx4 v[252:255], v4, s[24:27], s35 offen offset:0 sc1
s_add_u32 s35, s35, 262144
buffer_store_dwordx4 v[252:255], v4, s[24:27], s35 offen offset:0 sc1
s_mov_b64 exec, -1
s_waitcnt vmcnt(0)
v_add_u32 v5, s34, 3
s_mov_b64 exec, 1
ds_write_b32 v3, v5
s_mov_b64 exec, -1
s_add_u32 s35, s34, 17
lw_98:
ds_read_b32 v5, v2 offset:16
s_waitcnt lgkmcnt(0)
v_cmp_gt_i32 vcc, s35, v5
s_cbranch_vccz lwd_99
s_sleep 4
s_sub_u32 s32, s32, 1
s_cmp_gt_i32 s32, 0
s_cbranch_scc1 lw_98
lwd_99:
v_lshrrev_b32 v250, 4, v0
v_mul_u32_u24 v250, 28416, v250
v_add_u32 v250, v250, v4
s_add_u32 s35, s77, 688128
buffer_load_dwordx4 v[120:123], v250, s[16:19], s35 offen nt
s_add_u32 s35, s77, 695296
buffer_load_dwordx4 v[124:127], v250, s[16:19], s35 offen nt
s_add_u32 s35, s77, 702464
buffer_load_dwordx4 v[128:131], v250, s[16:19], s35 offen nt
s_add_u32 s35, s77, 709632
buffer_load_dwordx4 v[132:135], v250, s[16:19], s35 offen nt
s_add_u32 s35, s77, 802816
buffer_load_dwordx4 v[136:139], v250, s[16:19], s35 offen nt
s_add_u32 s35, s77, 809984
buffer_load_dwordx4 v[140:143], v250, s[16:19], s35 offen nt
s_add_u32 s35, s77, 817152
buffer_load_dwordx4 v[144:147], v250, s[16:19], s35 offen nt
s_add_u32 s35, s77, 824320
buffer_load_dwordx4 v[148:151], v250, s[16:19], s35 offen nt
v_lshrrev_b32 v250, 4, v0
v_mul_u32_u24 v250, 28416, v250
v_add_u32 v250, v250, v4
s_add_u32 s35, s77, 458752
buffer_load_dwordx4 v[88:91], v250, s[16:19], s35 offen nt
s_add_u32 s35, s77, 465920
buffer_load_dwordx4 v[92:95], v250, s[16:19], s35 offen nt
s_add_u32 s35, s77, 473088
buffer_load_dwordx4 v[96:99], v250, s[16:19], s35 offen nt
s_add_u32 s35, s77, 480256
buffer_load_dwordx4 v[100:103], v250, s[16:19], s35 offen nt
s_add_u32 s35, s77, 573440
buffer_load_dwordx4 v[104:107], v250, s[16:19], s35 offen nt
s_add_u32 s35, s77, 580608
buffer_load_dwordx4 v[108:111], v250, s[16:19], s35 offen nt
s_add_u32 s35, s77, 587776
buffer_load_dwordx4 v[112:115], v250, s[16:19], s35 offen nt
s_add_u32 s35, s77, 594944
buffer_load_dwordx4 v[116:119], v250, s[16:19], s35 offen nt
v_lshrrev_b32 v250, 4, v0
v_mul_u32_u24 v250, 28416, v250
v_add_u32 v250, v250, v4
s_add_u32 s35, s77, 229376
buffer_load_dwordx4 v[56:59], v250, s[16:19], s35 offen nt
s_add_u32 s35, s77, 236544
buffer_load_dwordx4 v[60:63], v250, s[16:19], s35 offen nt
s_add_u32 s35, s77, 243712
buffer_load_dwordx4 v[64:67], v250, s[16:19], s35 offen nt
s_add_u32 s35, s77, 250880
buffer_load_dwordx4 v[68:71], v250, s[16:19], s35 offen nt
s_add_u32 s35, s77, 344064
buffer_load_dwordx4 v[72:75], v250, s[16:19], s35 offen nt
s_add_u32 s35, s77, 351232
buffer_load_dwordx4 v[76:79], v250, s[16:19], s35 offen nt
s_add_u32 s35, s77, 358400
buffer_load_dwordx4 v[80:83], v250, s[16:19], s35 offen nt
s_add_u32 s35, s77, 365568
buffer_load_dwordx4 v[84:87], v250, s[16:19], s35 offen nt
v_lshrrev_b32 v250, 4, v0
v_mul_u32_u24 v250, 28416, v250
v_add_u32 v250, v250, v4
s_add_u32 s35, s77, 0
buffer_load_dwordx4 v[24:27], v250, s[16:19], s35 offen nt
s_add_u32 s35, s77, 7168
buffer_load_dwordx4 v[28:31], v250, s[16:19], s35 offen nt
s_add_u32 s35, s77, 14336
buffer_load_dwordx4 v[32:35], v250, s[16:19], s35 offen nt
s_add_u32 s35, s77, 21504
buffer_load_dwordx4 v[36:39], v250, s[16:19], s35 offen nt
s_add_u32 s35, s77, 114688
buffer_load_dwordx4 v[40:43], v250, s[16:19], s35 offen nt
s_add_u32 s35, s77, 121856
buffer_load_dwordx4 v[44:47], v250, s[16:19], s35 offen nt
s_add_u32 s35, s77, 129024
buffer_load_dwordx4 v[48:51], v250, s[16:19], s35 offen nt
s_add_u32 s35, s77, 136192
buffer_load_dwordx4 v[52:55], v250, s[16:19], s35 offen nt
s_waitcnt lgkmcnt(0)
s_mov_b32 s42, 0x05040100
s_mov_b32 s43, 0x07060302
s_cmp_eq_u32 s65, 0
s_cbranch_scc0 fq_100
v_perm_b32 v216, v188, v184, s42
v_perm_b32 v220, v188, v184, s43
v_perm_b32 v224, v189, v185, s42
v_perm_b32 v228, v189, v185, s43
v_perm_b32 v232, v190, v186, s42
v_perm_b32 v236, v190, v186, s43
v_perm_b32 v240, v191, v187, s42
v_perm_b32 v244, v191, v187, s43
v_perm_b32 v217, v196, v192, s42
v_perm_b32 v221, v196, v192, s43
v_perm_b32 v225, v197, v193, s42
v_perm_b32 v229, v197, v193, s43
v_perm_b32 v233, v198, v194, s42
v_perm_b32 v237, v198, v194, s43
v_perm_b32 v241, v199, v195, s42
v_perm_b32 v245, v199, v195, s43
v_perm_b32 v218, v204, v200, s42
v_perm_b32 v222, v204, v200, s43
v_perm_b32 v226, v205, v201, s42
v_perm_b32 v230, v205, v201, s43
v_perm_b32 v234, v206, v202, s42
v_perm_b32 v238, v206, v202, s43
v_perm_b32 v242, v207, v203, s42
v_perm_b32 v246, v207, v203, s43
v_perm_b32 v219, v212, v208, s42
v_perm_b32 v223, v212, v208, s43
v_perm_b32 v227, v213, v209, s42
v_perm_b32 v231, v213, v209, s43
v_perm_b32 v235, v214, v210, s42
v_perm_b32 v239, v214, v210, s43
v_perm_b32 v243, v215, v211, s42
v_perm_b32 v247, v215, v211, s43
v_perm_b32 v184, v156, v152, s42
v_perm_b32 v188, v156, v152, s43
v_perm_b32 v192, v157, v153, s42
v_perm_b32 v196, v157, v153, s43
v_perm_b32 v200, v158, v154, s42
v_perm_b32 v204, v158, v154, s43
v_perm_b32 v208, v159, v155, s42
v_perm_b32 v212, v159, v155, s43
v_perm_b32 v185, v164, v160, s42
v_perm_b32 v189, v164, v160, s43
v_perm_b32 v193, v165, v161, s42
v_perm_b32 v197, v165, v161, s43
v_perm_b32 v201, v166, v162, s42
v_perm_b32 v205, v166, v162, s43
v_perm_b32 v209, v167, v163, s42
v_perm_b32 v213, v167, v163, s43
v_perm_b32 v186, v172, v168, s42
v_perm_b32 v190, v172, v168, s43
v_perm_b32 v194, v173, v169, s42
v_perm_b32 v198, v173, v169, s43
v_perm_b32 v202, v174, v170, s42
v_perm_b32 v206, v174, v170, s43
v_perm_b32 v210, v175, v171, s42
v_perm_b32 v214, v175, v171, s43
v_perm_b32 v187, v180, v176, s42
v_perm_b32 v191, v180, v176, s43
v_perm_b32 v195, v181, v177, s42
v_perm_b32 v199, v181, v177, s43
v_perm_b32 v203, v182, v178, s42
v_perm_b32 v207, v182, v178, s43
v_perm_b32 v211, v183, v179, s42
v_perm_b32 v215, v183, v179, s43
s_waitcnt vmcnt(30)
v_perm_b32 v152, v124, v120, s42
v_perm_b32 v156, v124, v120, s43
v_perm_b32 v160, v125, v121, s42
v_perm_b32 v164, v125, v121, s43
v_perm_b32 v168, v126, v122, s42
v_perm_b32 v172, v126, v122, s43
v_perm_b32 v176, v127, v123, s42
v_perm_b32 v180, v127, v123, s43
s_waitcnt vmcnt(28)
v_perm_b32 v153, v132, v128, s42
v_perm_b32 v157, v132, v128, s43
v_perm_b32 v161, v133, v129, s42
v_perm_b32 v165, v133, v129, s43
v_perm_b32 v169, v134, v130, s42
v_perm_b32 v173, v134, v130, s43
v_perm_b32 v177, v135, v131, s42
v_perm_b32 v181, v135, v131, s43
s_waitcnt vmcnt(26)
v_perm_b32 v154, v140, v136, s42
v_perm_b32 v158, v140, v136, s43
v_perm_b32 v162, v141, v137, s42
v_perm_b32 v166, v141, v137, s43
v_perm_b32 v170, v142, v138, s42
v_perm_b32 v174, v142, v138, s43
v_perm_b32 v178, v143, v139, s42
v_perm_b32 v182, v143, v139, s43
s_waitcnt vmcnt(24)
v_perm_b32 v155, v148, v144, s42
v_perm_b32 v159, v148, v144, s43
v_perm_b32 v163, v149, v145, s42
v_perm_b32 v167, v149, v145, s43
v_perm_b32 v171, v150, v146, s42
v_perm_b32 v175, v150, v146, s43
v_perm_b32 v179, v151, v147, s42
v_perm_b32 v183, v151, v147, s43
s_waitcnt vmcnt(22)
v_perm_b32 v120, v92, v88, s42
v_perm_b32 v124, v92, v88, s43
v_perm_b32 v128, v93, v89, s42
v_perm_b32 v132, v93, v89, s43
v_perm_b32 v136, v94, v90, s42
v_perm_b32 v140, v94, v90, s43
v_perm_b32 v144, v95, v91, s42
v_perm_b32 v148, v95, v91, s43
s_waitcnt vmcnt(20)
v_perm_b32 v121, v100, v96, s42
v_perm_b32 v125, v100, v96, s43
v_perm_b32 v129, v101, v97, s42
v_perm_b32 v133, v101, v97, s43
v_perm_b32 v137, v102, v98, s42
v_perm_b32 v141, v102, v98, s43
v_perm_b32 v145, v103, v99, s42
v_perm_b32 v149, v103, v99, s43
s_waitcnt vmcnt(18)
v_perm_b32 v122, v108, v104, s42
v_perm_b32 v126, v108, v104, s43
v_perm_b32 v130, v109, v105, s42
v_perm_b32 v134, v109, v105, s43
v_perm_b32 v138, v110, v106, s42
v_perm_b32 v142, v110, v106, s43
v_perm_b32 v146, v111, v107, s42
v_perm_b32 v150, v111, v107, s43
s_waitcnt vmcnt(16)
v_perm_b32 v123, v116, v112, s42
v_perm_b32 v127, v116, v112, s43
v_perm_b32 v131, v117, v113, s42
v_perm_b32 v135, v117, v113, s43
v_perm_b32 v139, v118, v114, s42
v_perm_b32 v143, v118, v114, s43
v_perm_b32 v147, v119, v115, s42
v_perm_b32 v151, v119, v115, s43
s_waitcnt vmcnt(14)
v_perm_b32 v88, v60, v56, s42
v_perm_b32 v92, v60, v56, s43
v_perm_b32 v96, v61, v57, s42
v_perm_b32 v100, v61, v57, s43
v_perm_b32 v104, v62, v58, s42
v_perm_b32 v108, v62, v58, s43
v_perm_b32 v112, v63, v59, s42
v_perm_b32 v116, v63, v59, s43
s_waitcnt vmcnt(12)
v_perm_b32 v89, v68, v64, s42
v_perm_b32 v93, v68, v64, s43
v_perm_b32 v97, v69, v65, s42
v_perm_b32 v101, v69, v65, s43
v_perm_b32 v105, v70, v66, s42
v_perm_b32 v109, v70, v66, s43
v_perm_b32 v113, v71, v67, s42
v_perm_b32 v117, v71, v67, s43
s_waitcnt vmcnt(10)
v_perm_b32 v90, v76, v72, s42
v_perm_b32 v94, v76, v72, s43
v_perm_b32 v98, v77, v73, s42
v_perm_b32 v102, v77, v73, s43
v_perm_b32 v106, v78, v74, s42
v_perm_b32 v110, v78, v74, s43
v_perm_b32 v114, v79, v75, s42
v_perm_b32 v118, v79, v75, s43
s_waitcnt vmcnt(8)
v_perm_b32 v91, v84, v80, s42
v_perm_b32 v95, v84, v80, s43
v_perm_b32 v99, v85, v81, s42
v_perm_b32 v103, v85, v81, s43
v_perm_b32 v107, v86, v82, s42
v_perm_b32 v111, v86, v82, s43
v_perm_b32 v115, v87, v83, s42
v_perm_b32 v119, v87, v83, s43
s_waitcnt vmcnt(6)
v_perm_b32 v56, v28, v24, s42
v_perm_b32 v60, v28, v24, s43
v_perm_b32 v64, v29, v25, s42
v_perm_b32 v68, v29, v25, s43
v_perm_b32 v72, v30, v26, s42
v_perm_b32 v76, v30, v26, s43
v_perm_b32 v80, v31, v27, s42
v_perm_b32 v84, v31, v27, s43
s_waitcnt vmcnt(4)
v_perm_b32 v57, v36, v32, s42
v_perm_b32 v61, v36, v32, s43
v_perm_b32 v65, v37, v33, s42
v_perm_b32 v69, v37, v33, s43
v_perm_b32 v73, v38, v34, s42
v_perm_b32 v77, v38, v34, s43
v_perm_b32 v81, v39, v35, s42
v_perm_b32 v85, v39, v35, s43
s_waitcnt vmcnt(2)
v_perm_b32 v58, v44, v40, s42
v_perm_b32 v62, v44, v40, s43
v_perm_b32 v66, v45, v41, s42
v_perm_b32 v70, v45, v41, s43
v_perm_b32 v74, v46, v42, s42
v_perm_b32 v78, v46, v42, s43
v_perm_b32 v82, v47, v43, s42
v_perm_b32 v86, v47, v43, s43
s_waitcnt vmcnt(0)
v_perm_b32 v59, v52, v48, s42
v_perm_b32 v63, v52, v48, s43
v_perm_b32 v67, v53, v49, s42
v_perm_b32 v71, v53, v49, s43
v_perm_b32 v75, v54, v50, s42
v_perm_b32 v79, v54, v50, s43
v_perm_b32 v83, v55, v51, s42
v_perm_b32 v87, v55, v51, s43
fq_100:
s_branch fnw_53
fnd_61:
poll_101:
buffer_load_dwordx2 v[248:249], v6, s[24:27], s73 offen sc1
pchk_102:
s_waitcnt vmcnt(0)
v_min_u32 v5, v248, v249
v_cmp_eq_u32 vcc, 0, v5
s_cbranch_vccz pdone_103
s_sleep 1
s_sub_u32 s32, s32, 1
s_cmp_gt_i32 s32, 0
s_cbranch_scc1 poll_101
pdone_103:
v_mov_b32 v250, v248
s_nop 1
v_max_f32_dpp v250, v250, v250 row_ror:1 row_mask:0xf bank_mask:0xf
s_nop 1
v_max_f32_dpp v250, v250, v250 row_ror:2 row_mask:0xf bank_mask:0xf
s_nop 1
v_max_f32_dpp v250, v250, v250 row_ror:4 row_mask:0xf bank_mask:0xf
s_nop 1
v_max_f32_dpp v250, v250, v250 row_ror:8 row_mask:0xf bank_mask:0xf
v_cmp_eq_f32 vcc, v250, v248
s_ff1_i32_b64 s68, vcc
s_and_b32 s68, s68, 15
v_readlane_b32 s33, v249, s68
v_readlane_b32 s67, v248, s68
v_add_u32 v5, s34, 4
v_mov_b32 v250, s33
s_mov_b64 exec, 1
ds_write2_b32 v3, v5, v250 offset1:2
s_mov_b64 exec, -1
s_sub_u32 s33, s33, 1
s_and_b32 s33, s33, 2047
s_branch fnd_60
fpre_80:
poll_104:
buffer_load_dwordx4 v[24:27], v4, s[24:27], s72 offen offset:0 sc1
pchk_105:
s_waitcnt vmcnt(0)
v_min3_u32 v5, v24, v25, v26
v_min_u32 v5, v5, v27
v_cmp_eq_u32 vcc, 0, v5
s_cbranch_vccz pdone_106
s_sleep 8
s_sub_u32 s32, s32, 1
s_cmp_gt_i32 s32, 0
s_cbranch_scc1 poll_104
pdone_106:
s_branch fpre_81
L_m:
s_setprio 2
v_mov_b32 v6, 0
v_mov_b32 v7, 0
v_lshlrev_b32 v8, 3, v0
ds_write_b64 v8, v[6:7]
s_waitcnt lgkmcnt(0)
s_barrier
s_lshr_b32 s64, s58, 1
s_and_b32 s65, s58, 1
v_and_b32 v1, 3, v0
v_lshlrev_b32 v1, 2, v1
v_and_b32 v2, 4, v1
s_lshl2_add_u32 s35, s58, 0
v_mov_b32 v3, s35
s_mov_b32 s4, s44
s_mov_b32 s5, s45
s_mov_b32 s6, 0x800
s_mov_b32 s7, 0x00020000
v_lshrrev_b32 v6, 4, v0
v_lshlrev_b32 v6, 3, v6
s_lshl_b32 s66, s62, 7
buffer_load_dwordx2 v[232:233], v6, s[4:7], s66 offen offset:0
buffer_load_dwordx2 v[234:235], v6, s[4:7], s66 offen offset:32
buffer_load_dwordx2 v[236:237], v6, s[4:7], s66 offen offset:64
buffer_load_dwordx2 v[238:239], v6, s[4:7], s66 offen offset:96
v_and_b32 v6, 31, v0
v_lshrrev_b32 v7, 5, v0
v_lshlrev_b32 v7, 3, v7
v_sub_u32 v6, v6, v7
v_mov_b32 v7, 0xf149f2ca
v_cmp_le_i32 vcc, 0, v6
s_nop 1
v_cndmask_b32 v216, 0, v7, vcc
v_cmp_le_i32 vcc, 1, v6
s_nop 1
v_cndmask_b32 v217, 0, v7, vcc
v_cmp_le_i32 vcc, 2, v6
s_nop 1
v_cndmask_b32 v218, 0, v7, vcc
v_cmp_le_i32 vcc, 3, v6
s_nop 1
v_cndmask_b32 v219, 0, v7, vcc
v_cmp_le_i32 vcc, 16, v6
s_nop 1
v_cndmask_b32 v220, 0, v7, vcc
v_cmp_le_i32 vcc, 17, v6
s_nop 1
v_cndmask_b32 v221, 0, v7, vcc
v_cmp_le_i32 vcc, 18, v6
s_nop 1
v_cndmask_b32 v222, 0, v7, vcc
v_cmp_le_i32 vcc, 19, v6
s_nop 1
v_cndmask_b32 v223, 0, v7, vcc
v_cmp_le_i32 vcc, 4, v6
s_nop 1
v_cndmask_b32 v224, 0, v7, vcc
v_cmp_le_i32 vcc, 5, v6
s_nop 1
v_cndmask_b32 v225, 0, v7, vcc
v_cmp_le_i32 vcc, 6, v6
s_nop 1
v_cndmask_b32 v226, 0, v7, vcc
v_cmp_le_i32 vcc, 7, v6
s_nop 1
v_cndmask_b32 v227, 0, v7, vcc
v_cmp_le_i32 vcc, 20, v6
s_nop 1
v_cndmask_b32 v228, 0, v7, vcc
v_cmp_le_i32 vcc, 21, v6
s_nop 1
v_cndmask_b32 v229, 0, v7, vcc
v_cmp_le_i32 vcc, 22, v6
s_nop 1
v_cndmask_b32 v230, 0, v7, vcc
v_cmp_le_i32 vcc, 23, v6
s_nop 1
v_cndmask_b32 v231, 0, v7, vcc
v_lshrrev_b32 v6, 2, v0
v_xor_b32 v6, v6, v0
v_and_b32 v6, 4, v6
v_mov_b32 v7, 0x3f803f80
v_cmp_eq_u32 vcc, 0, v6
s_nop 1
v_cndmask_b32 v212, 0, v7, vcc
v_cndmask_b32 v213, 0, v7, vcc
v_cndmask_b32 v214, 0, v7, vcc
v_cndmask_b32 v215, 0, v7, vcc
L_mtop:
v_lshrrev_b32 v10, 4, v0
s_cmp_eq_u32 s63, 0
s_cbranch_scc0 mq_107
v_bfe_u32 v11, v0, 1, 3
v_xor_b32 v11, v11, v10
v_lshlrev_b32 v11, 4, v11
v_and_b32 v12, 15, v0
v_lshl_add_u32 v6, v12, 7, v11
v_xor_b32 v7, 64, v6
s_branch mq_108
mq_107:
v_lshlrev_b32 v6, 4, v0
v_add_u32 v7, 1024, v6
mq_108:
s_lshl_b32 s66, s65, 13
s_add_u32 s66, s66, 86016
v_add_u32 v6, s66, v6
v_add_u32 v7, s66, v7
v_bfe_u32 v11, v0, 2, 2
v_lshl_add_u32 v11, v10, 3, v11
v_bfe_u32 v12, v0, 3, 2
s_lshl_b32 s66, s64, 1
v_xor_b32 v12, s66, v12
v_lshlrev_b32 v12, 5, v12
v_lshl_add_u32 v11, v11, 7, v12
v_and_b32 v12, 3, v0
v_lshl_add_u32 v11, v12, 3, v11
v_add_u32 v8, 102400, v11
v_xor_b32 v9, 32, v8
v_mov_b32 v11, 0xf149f2ca
v_xor_b32 v216, v11, v216
v_xor_b32 v217, v11, v217
v_xor_b32 v218, v11, v218
v_xor_b32 v219, v11, v219
v_xor_b32 v220, v11, v220
v_xor_b32 v221, v11, v221
v_xor_b32 v222, v11, v222
v_xor_b32 v223, v11, v223
v_xor_b32 v224, v11, v224
v_xor_b32 v225, v11, v225
v_xor_b32 v226, v11, v226
v_xor_b32 v227, v11, v227
v_xor_b32 v228, v11, v228
v_xor_b32 v229, v11, v229
v_xor_b32 v230, v11, v230
v_xor_b32 v231, v11, v231
v_mov_b32 v16, 0
v_mov_b32 v17, 0
v_mov_b32 v18, 0
v_mov_b32 v19, 0
v_mov_b32 v20, 0
v_mov_b32 v21, 0
v_mov_b32 v22, 0
v_mov_b32 v23, 0
v_mov_b32 v24, 0
v_mov_b32 v25, 0
v_mov_b32 v26, 0
v_mov_b32 v27, 0
v_mov_b32 v28, 0
v_mov_b32 v29, 0
v_mov_b32 v30, 0
v_mov_b32 v31, 0
v_mov_b32 v32, 0
v_mov_b32 v33, 0
v_mov_b32 v34, 0
v_mov_b32 v35, 0
v_mov_b32 v36, 0
v_mov_b32 v37, 0
v_mov_b32 v38, 0
v_mov_b32 v39, 0
v_mov_b32 v40, 0
v_mov_b32 v41, 0
v_mov_b32 v42, 0
v_mov_b32 v43, 0
v_mov_b32 v44, 0
v_mov_b32 v45, 0
v_mov_b32 v46, 0
v_mov_b32 v47, 0
v_mov_b32 v48, 0
v_mov_b32 v49, 0
v_mov_b32 v50, 0
v_mov_b32 v51, 0
v_mov_b32 v52, 0
v_mov_b32 v53, 0
v_mov_b32 v54, 0
v_mov_b32 v55, 0
v_mov_b32 v56, 0
v_mov_b32 v57, 0
v_mov_b32 v58, 0
v_mov_b32 v59, 0
v_mov_b32 v60, 0
v_mov_b32 v61, 0
v_mov_b32 v62, 0
v_mov_b32 v63, 0
v_mov_b32 v64, 0
v_mov_b32 v65, 0
v_mov_b32 v66, 0
v_mov_b32 v67, 0
v_mov_b32 v68, 0
v_mov_b32 v69, 0
v_mov_b32 v70, 0
v_mov_b32 v71, 0
v_mov_b32 v72, 0
v_mov_b32 v73, 0
v_mov_b32 v74, 0
v_mov_b32 v75, 0
v_mov_b32 v76, 0
v_mov_b32 v77, 0
v_mov_b32 v78, 0
v_mov_b32 v79, 0
v_mov_b32 v80, 0
v_mov_b32 v81, 0
v_mov_b32 v82, 0
v_mov_b32 v83, 0
v_mov_b32 v84, 0
v_mov_b32 v85, 0
v_mov_b32 v86, 0
v_mov_b32 v87, 0
v_mov_b32 v88, 0
v_mov_b32 v89, 0
v_mov_b32 v90, 0
v_mov_b32 v91, 0
v_mov_b32 v92, 0
v_mov_b32 v93, 0
v_mov_b32 v94, 0
v_mov_b32 v95, 0
v_mov_b32 v96, 0
v_mov_b32 v97, 0
v_mov_b32 v98, 0
v_mov_b32 v99, 0
v_mov_b32 v100, 0
v_mov_b32 v101, 0
v_mov_b32 v102, 0
v_mov_b32 v103, 0
v_mov_b32 v104, 0
v_mov_b32 v105, 0
v_mov_b32 v106, 0
v_mov_b32 v107, 0
v_mov_b32 v108, 0
v_mov_b32 v109, 0
v_mov_b32 v110, 0
v_mov_b32 v111, 0
v_mov_b32 v192, 0
v_mov_b32 v193, 0
v_mov_b32 v194, 0
v_mov_b32 v195, 0
v_mov_b32 v196, 0
v_mov_b32 v197, 0
v_mov_b32 v198, 0
v_mov_b32 v199, 0
v_mov_b32 v200, 0
v_mov_b32 v201, 0
v_mov_b32 v202, 0
v_mov_b32 v203, 0
v_mov_b32 v204, 0
v_mov_b32 v205, 0
v_mov_b32 v206, 0
v_mov_b32 v207, 0
v_mov_b32 v208, 0
v_mov_b32 v209, 0
v_mov_b32 v210, 0
v_mov_b32 v211, 0
v_add_u32 v4, s34, 1
s_mov_b32 s66, 16
s_mov_b32 s67, -40960
s_mov_b32 s68, -40960
s_mov_b32 s69, 81920
s_add_u32 s35, s34, 1
lw_109:
ds_read_b32 v5, v2 offset:16
s_waitcnt lgkmcnt(0)
v_cmp_gt_i32 vcc, s35, v5
s_cbranch_vccz lwd_110
s_sub_u32 s32, s32, 1
s_cmp_gt_i32 s32, 0
s_cbranch_scc1 lw_109
lwd_110:
ds_read_b64_tr_b16 v[144:145], v8 offset:8192
ds_read_b64_tr_b16 v[146:147], v8 offset:8704
ds_read_b64_tr_b16 v[148:149], v8 offset:12288
ds_read_b64_tr_b16 v[150:151], v8 offset:12800
ds_read_b128 v[112:115], v6 offset:0
ds_read_b128 v[116:119], v7 offset:0
ds_read_b64_tr_b16 v[152:153], v9 offset:8192
ds_read_b64_tr_b16 v[154:155], v9 offset:8704
ds_read_b64_tr_b16 v[156:157], v9 offset:12288
ds_read_b64_tr_b16 v[158:159], v9 offset:12800
ds_read_b128 v[120:123], v6 offset:2048
ds_read_b128 v[124:127], v7 offset:2048
ds_read_b128 v[128:131], v6 offset:4096
ds_read_b128 v[132:135], v7 offset:4096
ds_read_b128 v[136:139], v6 offset:6144
ds_read_b128 v[140:143], v7 offset:6144
.p2align 6
mqkv_111:
s_waitcnt lgkmcnt(7)
v_mfma_f32_16x16x32_bf16 v[16:19], v[144:147], v[112:115], v[16:19]
ds_read_b64_tr_b16 v[160:161], v8 offset:16384
s_waitcnt lgkmcnt(7)
v_mfma_f32_16x16x32_bf16 v[16:19], v[148:151], v[116:119], v[16:19]
ds_read_b64_tr_b16 v[162:163], v8 offset:16896
v_mfma_f32_16x16x32_bf16 v[20:23], v[152:155], v[112:115], v[20:23]
ds_read_b64_tr_b16 v[164:165], v8 offset:20480
v_mfma_f32_16x16x32_bf16 v[20:23], v[156:159], v[116:119], v[20:23]
ds_read_b64_tr_b16 v[166:167], v8 offset:20992
s_waitcnt lgkmcnt(9)
v_mfma_f32_16x16x32_bf16 v[24:27], v[144:147], v[120:123], v[24:27]
ds_read_b64_tr_b16 v[168:169], v9 offset:16384
s_waitcnt lgkmcnt(9)
v_mfma_f32_16x16x32_bf16 v[24:27], v[148:151], v[124:127], v[24:27]
ds_read_b64_tr_b16 v[170:171], v9 offset:16896
v_mfma_f32_16x16x32_bf16 v[28:31], v[152:155], v[120:123], v[28:31]
ds_read_b64_tr_b16 v[172:173], v9 offset:20480
v_mfma_f32_16x16x32_bf16 v[28:31], v[156:159], v[124:127], v[28:31]
ds_read_b64_tr_b16 v[174:175], v9 offset:20992
s_waitcnt lgkmcnt(11)
v_mfma_f32_16x16x32_bf16 v[32:35], v[144:147], v[128:131], v[32:35]
ds_read_b64_tr_b16 v[176:177], v8 offset:0
s_waitcnt lgkmcnt(11)
v_mfma_f32_16x16x32_bf16 v[32:35], v[148:151], v[132:135], v[32:35]
ds_read_b64_tr_b16 v[178:179], v8 offset:512
v_mfma_f32_16x16x32_bf16 v[36:39], v[152:155], v[128:131], v[36:39]
ds_read_b64_tr_b16 v[180:181], v8 offset:4096
v_mfma_f32_16x16x32_bf16 v[36:39], v[156:159], v[132:135], v[36:39]
ds_read_b64_tr_b16 v[182:183], v8 offset:4608
s_waitcnt lgkmcnt(13)
v_mfma_f32_16x16x32_bf16 v[40:43], v[144:147], v[136:139], v[40:43]
ds_read_b64_tr_b16 v[184:185], v9 offset:0
s_waitcnt lgkmcnt(13)
v_mfma_f32_16x16x32_bf16 v[40:43], v[148:151], v[140:143], v[40:43]
ds_read_b64_tr_b16 v[186:187], v9 offset:512
v_mfma_f32_16x16x32_bf16 v[44:47], v[152:155], v[136:139], v[44:47]
ds_read_b64_tr_b16 v[188:189], v9 offset:4096
v_mfma_f32_16x16x32_bf16 v[44:47], v[156:159], v[140:143], v[44:47]
ds_read_b64_tr_b16 v[190:191], v9 offset:4608
s_waitcnt lgkmcnt(14)
v_mfma_f32_16x16x32_bf16 v[48:51], v[112:115], v[160:163], v[48:51]
s_mov_b64 exec, 1
ds_write_b32 v3, v4
s_mov_b64 exec, -1
s_waitcnt lgkmcnt(13)
v_mfma_f32_16x16x32_bf16 v[48:51], v[116:119], v[164:167], v[48:51]
v_add_u32 v8, s67, v8
v_add_u32 v9, s67, v9
s_waitcnt lgkmcnt(11)
v_mfma_f32_16x16x32_bf16 v[52:55], v[112:115], v[168:171], v[52:55]
v_add_u32 v6, s67, v6
v_add_u32 v7, s67, v7
s_waitcnt lgkmcnt(9)
v_mfma_f32_16x16x32_bf16 v[52:55], v[116:119], v[172:175], v[52:55]
s_mov_b32 s70, s67
s_mov_b32 s67, s68
s_mov_b32 s68, s69
s_mov_b32 s69, s70
v_mfma_f32_16x16x32_bf16 v[56:59], v[120:123], v[160:163], v[56:59]
ds_read_b32 v5, v2 offset:16
v_mfma_f32_16x16x32_bf16 v[56:59], v[124:127], v[164:167], v[56:59]
v_mfma_f32_16x16x32_bf16 v[60:63], v[120:123], v[168:171], v[60:63]
v_mfma_f32_16x16x32_bf16 v[60:63], v[124:127], v[172:175], v[60:63]
v_mfma_f32_16x16x32_bf16 v[64:67], v[128:131], v[160:163], v[64:67]
s_waitcnt lgkmcnt(0)
v_cmp_ge_u32 vcc, v4, v5
s_cbranch_vccnz mspin_112
mback_113:
v_add_u32 v4, 1, v4
v_mfma_f32_16x16x32_bf16 v[64:67], v[132:135], v[164:167], v[64:67]
ds_read_b64_tr_b16 v[144:145], v8 offset:8192
v_mfma_f32_16x16x32_bf16 v[68:71], v[128:131], v[168:171], v[68:71]
ds_read_b64_tr_b16 v[146:147], v8 offset:8704
v_mfma_f32_16x16x32_bf16 v[68:71], v[132:135], v[172:175], v[68:71]
ds_read_b64_tr_b16 v[148:149], v8 offset:12288
v_mfma_f32_16x16x32_bf16 v[72:75], v[136:139], v[160:163], v[72:75]
ds_read_b64_tr_b16 v[150:151], v8 offset:12800
v_mfma_f32_16x16x32_bf16 v[72:75], v[140:143], v[164:167], v[72:75]
ds_read_b64_tr_b16 v[152:153], v9 offset:8192
v_mfma_f32_16x16x32_bf16 v[76:79], v[136:139], v[168:171], v[76:79]
ds_read_b64_tr_b16 v[154:155], v9 offset:8704
v_mfma_f32_16x16x32_bf16 v[76:79], v[140:143], v[172:175], v[76:79]
ds_read_b64_tr_b16 v[156:157], v9 offset:12288
v_mfma_f32_16x16x32_bf16 v[80:83], v[176:179], v[112:115], v[80:83]
ds_read_b64_tr_b16 v[158:159], v9 offset:12800
v_mfma_f32_16x16x32_bf16 v[80:83], v[180:183], v[116:119], v[80:83]
v_mfma_f32_16x16x32_bf16 v[84:87], v[184:187], v[112:115], v[84:87]
v_mfma_f32_16x16x32_bf16 v[84:87], v[188:191], v[116:119], v[84:87]
ds_read_b128 v[112:115], v6 offset:0
ds_read_b128 v[116:119], v7 offset:0
v_mfma_f32_16x16x32_bf16 v[88:91], v[176:179], v[120:123], v[88:91]
v_mfma_f32_16x16x32_bf16 v[88:91], v[180:183], v[124:127], v[88:91]
v_mfma_f32_16x16x32_bf16 v[92:95], v[184:187], v[120:123], v[92:95]
v_mfma_f32_16x16x32_bf16 v[92:95], v[188:191], v[124:127], v[92:95]
ds_read_b128 v[120:123], v6 offset:2048
ds_read_b128 v[124:127], v7 offset:2048
v_mfma_f32_16x16x32_bf16 v[96:99], v[176:179], v[128:131], v[96:99]
v_mfma_f32_16x16x32_bf16 v[96:99], v[180:183], v[132:135], v[96:99]
v_mfma_f32_16x16x32_bf16 v[100:103], v[184:187], v[128:131], v[100:103]
v_mfma_f32_16x16x32_bf16 v[100:103], v[188:191], v[132:135], v[100:103]
ds_read_b128 v[128:131], v6 offset:4096
ds_read_b128 v[132:135], v7 offset:4096
v_mfma_f32_16x16x32_bf16 v[104:107], v[176:179], v[136:139], v[104:107]
v_mfma_f32_16x16x32_bf16 v[104:107], v[180:183], v[140:143], v[104:107]
s_sub_u32 s66, s66, 1
s_cmp_eq_u32 s66, 0
v_mfma_f32_16x16x32_bf16 v[108:111], v[184:187], v[136:139], v[108:111]
v_mfma_f32_16x16x32_bf16 v[108:111], v[188:191], v[140:143], v[108:111]
ds_read_b128 v[136:139], v6 offset:6144
ds_read_b128 v[140:143], v7 offset:6144
s_cbranch_scc0 mqkv_111
v_and_b32 v10, 15, v0
v_lshrrev_b32 v11, 4, v0
s_lshl_b32 s66, s65, 8
s_add_u32 s66, s66, 1280
s_mul_i32 s67, s64, 384
v_lshl_add_u32 v6, v10, 2, s66
v_lshl_add_u32 v7, v11, 4, s66
v_lshl_add_u32 v8, v10, 2, s67
v_lshl_add_u32 v9, v11, 4, s67
v_and_b32 v12, 1, v11
v_lshrrev_b32 v11, 1, v11
v_lshlrev_b32 v11, 9, v11
v_lshl_add_u32 v11, v12, 10, v11
s_lshl_b32 s66, s64, 12
s_lshl_b32 s67, s65, 13
s_add_u32 s66, s66, 131072
s_add_u32 s68, s66, 24576
s_sub_u32 s68, s68, s67
s_add_u32 s67, s66, s67
v_lshl_add_u32 v14, v10, 4, v11
v_and_b32 v12, 3, v0
v_lshl_add_u32 v11, v12, 4, v11
v_bfe_u32 v12, v0, 3, 1
v_lshl_add_u32 v11, v12, 6, v11
v_bfe_u32 v12, v0, 2, 1
v_lshl_add_u32 v12, v12, 8, v11
v_add_u32 v13, s68, v12
v_add_u32 v12, s67, v12
v_add_u32 v15, s68, v14
v_add_u32 v14, s67, v14
s_lshl_b32 s66, s59, 4
s_add_u32 s66, s66, s60
s_lshl_b32 s72, s59, 7
s_add_u32 s72, s72, s60
s_lshl_b32 s72, s72, 7
s_lshl_b32 s66, s66, 15
s_lshl_b32 s67, s63, 23
s_add_u32 s66, s66, s67
s_add_u32 s71, s66, 917504
s_add_u32 s35, s34, 2
lw_114:
ds_read_b32 v5, v2 offset:24
s_waitcnt lgkmcnt(0)
v_cmp_gt_i32 vcc, s35, v5
s_cbranch_vccz lwd_115
s_sub_u32 s32, s32, 1
s_cmp_gt_i32 s32, 0
s_cbranch_scc1 lw_114
lwd_115:
v_mov_b32 v10, 0
ds_read_b32 v10, v10 offset:32
ds_read2_b32 v[144:145], v6 offset0:0 offset1:128
ds_read2_b32 v[146:147], v6 offset0:16 offset1:144
ds_read2_b32 v[148:149], v6 offset0:32 offset1:160
ds_read2_b32 v[150:151], v6 offset0:48 offset1:176
ds_read_b128 v[152:155], v9 offset:2432
ds_read_b128 v[156:159], v9 offset:2496
ds_read_b32 v168, v8 offset:2560
ds_read_b32 v169, v8 offset:2624
ds_read_b128 v[112:115], v7 offset:0
ds_read_b128 v[128:131], v7 offset:512
ds_read_b128 v[116:119], v7 offset:64
ds_read_b128 v[132:135], v7 offset:576
s_waitcnt lgkmcnt(12)
v_readfirstlane_b32 s33, v10
s_sub_u32 s33, s33, 1
s_lshr_b32 s66, s33, 7
s_cmp_eq_u32 s66, s59
s_cbranch_scc1 patch_116
pback_117:
s_waitcnt lgkmcnt(11)
v_pk_mul_f32 v[16:17], v[16:17], v[144:145] op_sel:[0,0] op_sel_hi:[1,0]
v_pk_mul_f32 v[18:19], v[18:19], v[144:145] op_sel:[0,0] op_sel_hi:[1,0]
v_pk_mul_f32 v[20:21], v[20:21], v[144:145] op_sel:[0,0] op_sel_hi:[1,0]
v_pk_mul_f32 v[22:23], v[22:23], v[144:145] op_sel:[0,0] op_sel_hi:[1,0]
s_waitcnt lgkmcnt(7)
v_pk_fma_f32 v[16:17], v[152:153], v[144:145], v[16:17] op_sel:[0,1,0] op_sel_hi:[1,1,1]
v_pk_fma_f32 v[18:19], v[154:155], v[144:145], v[18:19] op_sel:[0,1,0] op_sel_hi:[1,1,1]
s_waitcnt lgkmcnt(6)
v_pk_fma_f32 v[20:21], v[156:157], v[144:145], v[20:21] op_sel:[0,1,0] op_sel_hi:[1,1,1]
v_pk_fma_f32 v[22:23], v[158:159], v[144:145], v[22:23] op_sel:[0,1,0] op_sel_hi:[1,1,1]
v_cvt_pk_bf16_f32 v16, v16, v17
v_cvt_pk_bf16_f32 v17, v18, v19
v_cvt_pk_bf16_f32 v18, v20, v21
v_cvt_pk_bf16_f32 v19, v22, v23
buffer_store_dwordx4 v[16:19], v12, s[20:23], s71 offen offset:0 sc1
ds_write_b128 v12, v[16:19] offset:0
ds_read_b128 v[120:123], v7 offset:128
ds_read_b128 v[136:139], v7 offset:640
ds_read_b128 v[124:127], v7 offset:192
ds_read_b128 v[140:143], v7 offset:704
ds_read_b128 v[160:163], v9 offset:2304
ds_read_b128 v[164:167], v9 offset:2368
v_pk_mul_f32 v[24:25], v[24:25], v[146:147] op_sel:[0,0] op_sel_hi:[1,0]
v_pk_mul_f32 v[26:27], v[26:27], v[146:147] op_sel:[0,0] op_sel_hi:[1,0]
v_pk_mul_f32 v[28:29], v[28:29], v[146:147] op_sel:[0,0] op_sel_hi:[1,0]
v_pk_mul_f32 v[30:31], v[30:31], v[146:147] op_sel:[0,0] op_sel_hi:[1,0]
v_pk_fma_f32 v[24:25], v[152:153], v[146:147], v[24:25] op_sel:[0,1,0] op_sel_hi:[1,1,1]
v_pk_fma_f32 v[26:27], v[154:155], v[146:147], v[26:27] op_sel:[0,1,0] op_sel_hi:[1,1,1]
v_pk_fma_f32 v[28:29], v[156:157], v[146:147], v[28:29] op_sel:[0,1,0] op_sel_hi:[1,1,1]
v_pk_fma_f32 v[30:31], v[158:159], v[146:147], v[30:31] op_sel:[0,1,0] op_sel_hi:[1,1,1]
v_cvt_pk_bf16_f32 v24, v24, v25
v_cvt_pk_bf16_f32 v25, v26, v27
v_cvt_pk_bf16_f32 v26, v28, v29
v_cvt_pk_bf16_f32 v27, v30, v31
buffer_store_dwordx4 v[24:27], v12, s[20:23], s71 offen offset:128 sc1
ds_write_b128 v12, v[24:27] offset:128
v_pk_mul_f32 v[32:33], v[32:33], v[148:149] op_sel:[0,0] op_sel_hi:[1,0]
v_pk_mul_f32 v[34:35], v[34:35], v[148:149] op_sel:[0,0] op_sel_hi:[1,0]
v_pk_mul_f32 v[36:37], v[36:37], v[148:149] op_sel:[0,0] op_sel_hi:[1,0]
v_pk_mul_f32 v[38:39], v[38:39], v[148:149] op_sel:[0,0] op_sel_hi:[1,0]
v_pk_fma_f32 v[32:33], v[152:153], v[148:149], v[32:33] op_sel:[0,1,0] op_sel_hi:[1,1,1]
v_pk_fma_f32 v[34:35], v[154:155], v[148:149], v[34:35] op_sel:[0,1,0] op_sel_hi:[1,1,1]
v_pk_fma_f32 v[36:37], v[156:157], v[148:149], v[36:37] op_sel:[0,1,0] op_sel_hi:[1,1,1]
v_pk_fma_f32 v[38:39], v[158:159], v[148:149], v[38:39] op_sel:[0,1,0] op_sel_hi:[1,1,1]
v_cvt_pk_bf16_f32 v32, v32, v33
v_cvt_pk_bf16_f32 v33, v34, v35
v_cvt_pk_bf16_f32 v34, v36, v37
v_cvt_pk_bf16_f32 v35, v38, v39
buffer_store_dwordx4 v[32:35], v13, s[20:23], s71 offen offset:0 sc1
ds_write_b128 v13, v[32:35] offset:0
v_pk_mul_f32 v[40:41], v[40:41], v[150:151] op_sel:[0,0] op_sel_hi:[1,0]
v_pk_mul_f32 v[42:43], v[42:43], v[150:151] op_sel:[0,0] op_sel_hi:[1,0]
v_pk_mul_f32 v[44:45], v[44:45], v[150:151] op_sel:[0,0] op_sel_hi:[1,0]
v_pk_mul_f32 v[46:47], v[46:47], v[150:151] op_sel:[0,0] op_sel_hi:[1,0]
v_pk_fma_f32 v[40:41], v[152:153], v[150:151], v[40:41] op_sel:[0,1,0] op_sel_hi:[1,1,1]
v_pk_fma_f32 v[42:43], v[154:155], v[150:151], v[42:43] op_sel:[0,1,0] op_sel_hi:[1,1,1]
v_pk_fma_f32 v[44:45], v[156:157], v[150:151], v[44:45] op_sel:[0,1,0] op_sel_hi:[1,1,1]
v_pk_fma_f32 v[46:47], v[158:159], v[150:151], v[46:47] op_sel:[0,1,0] op_sel_hi:[1,1,1]
v_cvt_pk_bf16_f32 v40, v40, v41
v_cvt_pk_bf16_f32 v41, v42, v43
v_cvt_pk_bf16_f32 v42, v44, v45
v_cvt_pk_bf16_f32 v43, v46, v47
buffer_store_dwordx4 v[40:43], v13, s[20:23], s71 offen offset:128 sc1
ds_write_b128 v13, v[40:43] offset:128
s_waitcnt lgkmcnt(13)
v_pk_mul_f32 v[48:49], v[48:49], v[112:113]
v_pk_mul_f32 v[50:51], v[50:51], v[114:115]
s_waitcnt lgkmcnt(12)
v_pk_fma_f32 v[48:49], v[128:129], v[168:169], v[48:49] op_sel:[0,0,0] op_sel_hi:[1,0,1]
v_pk_fma_f32 v[50:51], v[130:131], v[168:169], v[50:51] op_sel:[0,0,0] op_sel_hi:[1,0,1]
s_waitcnt lgkmcnt(11)
v_pk_mul_f32 v[56:57], v[56:57], v[116:117]
v_pk_mul_f32 v[58:59], v[58:59], v[118:119]
s_waitcnt lgkmcnt(10)
v_pk_fma_f32 v[56:57], v[132:133], v[168:169], v[56:57] op_sel:[0,0,0] op_sel_hi:[1,0,1]
v_pk_fma_f32 v[58:59], v[134:135], v[168:169], v[58:59] op_sel:[0,0,0] op_sel_hi:[1,0,1]
v_cvt_pk_bf16_f32 v48, v48, v49
v_cvt_pk_bf16_f32 v49, v50, v51
v_cvt_pk_bf16_f32 v50, v56, v57
v_cvt_pk_bf16_f32 v51, v58, v59
buffer_store_dwordx4 v[48:51], v14, s[20:23], s71 offen offset:2048 sc1
ds_write_b128 v14, v[48:51] offset:2048
v_pk_mul_f32 v[52:53], v[52:53], v[112:113]
v_pk_mul_f32 v[54:55], v[54:55], v[114:115]
v_pk_fma_f32 v[52:53], v[128:129], v[168:169], v[52:53] op_sel:[0,1,0] op_sel_hi:[1,1,1]
v_pk_fma_f32 v[54:55], v[130:131], v[168:169], v[54:55] op_sel:[0,1,0] op_sel_hi:[1,1,1]
v_pk_mul_f32 v[60:61], v[60:61], v[116:117]
v_pk_mul_f32 v[62:63], v[62:63], v[118:119]
v_pk_fma_f32 v[60:61], v[132:133], v[168:169], v[60:61] op_sel:[0,1,0] op_sel_hi:[1,1,1]
v_pk_fma_f32 v[62:63], v[134:135], v[168:169], v[62:63] op_sel:[0,1,0] op_sel_hi:[1,1,1]
v_cvt_pk_bf16_f32 v52, v52, v53
v_cvt_pk_bf16_f32 v53, v54, v55
v_cvt_pk_bf16_f32 v54, v60, v61
v_cvt_pk_bf16_f32 v55, v62, v63
buffer_store_dwordx4 v[52:55], v14, s[20:23], s71 offen offset:2304 sc1
ds_write_b128 v14, v[52:55] offset:2304
s_waitcnt lgkmcnt(10)
v_pk_mul_f32 v[64:65], v[64:65], v[120:121]
v_pk_mul_f32 v[66:67], v[66:67], v[122:123]
s_waitcnt lgkmcnt(9)
v_pk_fma_f32 v[64:65], v[136:137], v[168:169], v[64:65] op_sel:[0,0,0] op_sel_hi:[1,0,1]
v_pk_fma_f32 v[66:67], v[138:139], v[168:169], v[66:67] op_sel:[0,0,0] op_sel_hi:[1,0,1]
s_waitcnt lgkmcnt(8)
v_pk_mul_f32 v[72:73], v[72:73], v[124:125]
v_pk_mul_f32 v[74:75], v[74:75], v[126:127]
s_waitcnt lgkmcnt(7)
v_pk_fma_f32 v[72:73], v[140:141], v[168:169], v[72:73] op_sel:[0,0,0] op_sel_hi:[1,0,1]
v_pk_fma_f32 v[74:75], v[142:143], v[168:169], v[74:75] op_sel:[0,0,0] op_sel_hi:[1,0,1]
v_cvt_pk_bf16_f32 v64, v64, v65
v_cvt_pk_bf16_f32 v65, v66, v67
v_cvt_pk_bf16_f32 v66, v72, v73
v_cvt_pk_bf16_f32 v67, v74, v75
buffer_store_dwordx4 v[64:67], v15, s[20:23], s71 offen offset:2048 sc1
ds_write_b128 v15, v[64:67] offset:2048
v_pk_mul_f32 v[68:69], v[68:69], v[120:121]
v_pk_mul_f32 v[70:71], v[70:71], v[122:123]
v_pk_fma_f32 v[68:69], v[136:137], v[168:169], v[68:69] op_sel:[0,1,0] op_sel_hi:[1,1,1]
v_pk_fma_f32 v[70:71], v[138:139], v[168:169], v[70:71] op_sel:[0,1,0] op_sel_hi:[1,1,1]
v_pk_mul_f32 v[76:77], v[76:77], v[124:125]
v_pk_mul_f32 v[78:79], v[78:79], v[126:127]
v_pk_fma_f32 v[76:77], v[140:141], v[168:169], v[76:77] op_sel:[0,1,0] op_sel_hi:[1,1,1]
v_pk_fma_f32 v[78:79], v[142:143], v[168:169], v[78:79] op_sel:[0,1,0] op_sel_hi:[1,1,1]
v_cvt_pk_bf16_f32 v68, v68, v69
v_cvt_pk_bf16_f32 v69, v70, v71
v_cvt_pk_bf16_f32 v70, v76, v77
v_cvt_pk_bf16_f32 v71, v78, v79
buffer_store_dwordx4 v[68:71], v15, s[20:23], s71 offen offset:2304 sc1
ds_write_b128 v15, v[68:71] offset:2304
v_add_u32 v5, s34, 17
s_mov_b64 exec, 1
ds_write_b32 v3, v5
s_mov_b64 exec, -1
s_mov_b32 s66, 0x3e8293ee
v_mul_f32 v144, s66, v144
v_mul_f32 v145, s66, v145
v_mul_f32 v146, s66, v146
v_mul_f32 v147, s66, v147
v_mul_f32 v148, s66, v148
v_mul_f32 v149, s66, v149
v_mul_f32 v150, s66, v150
v_mul_f32 v151, s66, v151
v_pk_mul_f32 v[96:97], v[96:97], v[148:149] op_sel:[0,0] op_sel_hi:[1,0]
v_pk_mul_f32 v[98:99], v[98:99], v[148:149] op_sel:[0,0] op_sel_hi:[1,0]
v_pk_mul_f32 v[100:101], v[100:101], v[148:149] op_sel:[0,0] op_sel_hi:[1,0]
v_pk_mul_f32 v[102:103], v[102:103], v[148:149] op_sel:[0,0] op_sel_hi:[1,0]
s_waitcnt lgkmcnt(9)
v_pk_fma_f32 v[96:97], v[160:161], v[148:149], v[96:97] op_sel:[0,1,0] op_sel_hi:[1,1,1]
v_pk_fma_f32 v[98:99], v[162:163], v[148:149], v[98:99] op_sel:[0,1,0] op_sel_hi:[1,1,1]
s_waitcnt lgkmcnt(8)
v_pk_fma_f32 v[100:101], v[164:165], v[148:149], v[100:101] op_sel:[0,1,0] op_sel_hi:[1,1,1]
v_pk_fma_f32 v[102:103], v[166:167], v[148:149], v[102:103] op_sel:[0,1,0] op_sel_hi:[1,1,1]
v_cvt_pk_bf16_f32 v96, v96, v97
v_cvt_pk_bf16_f32 v97, v98, v99
v_cvt_pk_bf16_f32 v98, v100, v101
v_cvt_pk_bf16_f32 v99, v102, v103
v_pk_mul_f32 v[104:105], v[104:105], v[150:151] op_sel:[0,0] op_sel_hi:[1,0]
v_pk_mul_f32 v[106:107], v[106:107], v[150:151] op_sel:[0,0] op_sel_hi:[1,0]
v_pk_mul_f32 v[108:109], v[108:109], v[150:151] op_sel:[0,0] op_sel_hi:[1,0]
v_pk_mul_f32 v[110:111], v[110:111], v[150:151] op_sel:[0,0] op_sel_hi:[1,0]
v_pk_fma_f32 v[104:105], v[160:161], v[150:151], v[104:105] op_sel:[0,1,0] op_sel_hi:[1,1,1]
v_pk_fma_f32 v[106:107], v[162:163], v[150:151], v[106:107] op_sel:[0,1,0] op_sel_hi:[1,1,1]
v_pk_fma_f32 v[108:109], v[164:165], v[150:151], v[108:109] op_sel:[0,1,0] op_sel_hi:[1,1,1]
v_pk_fma_f32 v[110:111], v[166:167], v[150:151], v[110:111] op_sel:[0,1,0] op_sel_hi:[1,1,1]
v_cvt_pk_bf16_f32 v104, v104, v105
v_cvt_pk_bf16_f32 v105, v106, v107
v_cvt_pk_bf16_f32 v106, v108, v109
v_cvt_pk_bf16_f32 v107, v110, v111
v_pk_mul_f32 v[80:81], v[80:81], v[144:145] op_sel:[0,0] op_sel_hi:[1,0]
v_pk_mul_f32 v[82:83], v[82:83], v[144:145] op_sel:[0,0] op_sel_hi:[1,0]
v_pk_mul_f32 v[84:85], v[84:85], v[144:145] op_sel:[0,0] op_sel_hi:[1,0]
v_pk_mul_f32 v[86:87], v[86:87], v[144:145] op_sel:[0,0] op_sel_hi:[1,0]
v_pk_fma_f32 v[80:81], v[160:161], v[144:145], v[80:81] op_sel:[0,1,0] op_sel_hi:[1,1,1]
v_pk_fma_f32 v[82:83], v[162:163], v[144:145], v[82:83] op_sel:[0,1,0] op_sel_hi:[1,1,1]
v_pk_fma_f32 v[84:85], v[164:165], v[144:145], v[84:85] op_sel:[0,1,0] op_sel_hi:[1,1,1]
v_pk_fma_f32 v[86:87], v[166:167], v[144:145], v[86:87] op_sel:[0,1,0] op_sel_hi:[1,1,1]
v_cvt_pk_bf16_f32 v80, v80, v81
v_cvt_pk_bf16_f32 v81, v82, v83
v_cvt_pk_bf16_f32 v82, v84, v85
v_cvt_pk_bf16_f32 v83, v86, v87
v_pk_mul_f32 v[88:89], v[88:89], v[146:147] op_sel:[0,0] op_sel_hi:[1,0]
v_pk_mul_f32 v[90:91], v[90:91], v[146:147] op_sel:[0,0] op_sel_hi:[1,0]
v_pk_mul_f32 v[92:93], v[92:93], v[146:147] op_sel:[0,0] op_sel_hi:[1,0]
v_pk_mul_f32 v[94:95], v[94:95], v[146:147] op_sel:[0,0] op_sel_hi:[1,0]
v_pk_fma_f32 v[88:89], v[160:161], v[146:147], v[88:89] op_sel:[0,1,0] op_sel_hi:[1,1,1]
v_pk_fma_f32 v[90:91], v[162:163], v[146:147], v[90:91] op_sel:[0,1,0] op_sel_hi:[1,1,1]
v_pk_fma_f32 v[92:93], v[164:165], v[146:147], v[92:93] op_sel:[0,1,0] op_sel_hi:[1,1,1]
v_pk_fma_f32 v[94:95], v[166:167], v[146:147], v[94:95] op_sel:[0,1,0] op_sel_hi:[1,1,1]
v_cvt_pk_bf16_f32 v88, v88, v89
v_cvt_pk_bf16_f32 v89, v90, v91
v_cvt_pk_bf16_f32 v90, v92, v93
v_cvt_pk_bf16_f32 v91, v94, v95
v_permlane16_swap_b32 v96, v104
v_permlane16_swap_b32 v97, v105
v_permlane16_swap_b32 v98, v106
v_permlane16_swap_b32 v99, v107
v_permlane16_swap_b32 v80, v88
v_permlane16_swap_b32 v81, v89
v_permlane16_swap_b32 v82, v90
v_permlane16_swap_b32 v83, v91
s_lshl_b32 s69, s64, 12
v_lshl_add_u32 v6, v0, 4, s69
v_add_u32 v7, 131072, v6
s_lshl_b32 s69, s65, 13
s_add_u32 s66, s69, 131072
s_sub_u32 s69, 147456, s69
v_add_u32 v8, s69, v6
ds_read_b128 v[152:155], v8 offset:8192
ds_read_b128 v[156:159], v8 offset:9216
s_mov_b32 s67, 122880
s_min_u32 s69, s59, 1
s_lshl2_add_u32 s68, s69, s65
s_cmp_ge_u32 s59, 2
s_cselect_b32 s69, s65, 0
s_add_u32 s68, s68, s69
ds_read_b128 v[160:163], v8 offset:10240
ds_read_b128 v[164:167], v8 offset:11264
s_waitcnt lgkmcnt(3)
v_mfma_f32_32x32x16_bf16 v[112:127], v[152:155], v[96:99], v[216:231]
s_waitcnt lgkmcnt(2)
v_mfma_f32_32x32x16_bf16 v[112:127], v[156:159], v[104:107], v[112:127]
s_add_u32 s35, s34, 17
lw_118:
ds_read_b32 v5, v1 offset:0
s_waitcnt lgkmcnt(0)
v_cmp_gt_i32 vcc, s35, v5
s_cbranch_vccz lwd_119
s_sub_u32 s32, s32, 1
s_cmp_gt_i32 s32, 0
s_cbranch_scc1 lw_118
lwd_119:
ds_read_b128 v[152:155], v8 offset:0
ds_read_b128 v[156:159], v8 offset:1024
.p2align 3
s_nop 4
v_exp_f32 v112, v112
v_exp_f32 v113, v113
v_exp_f32 v114, v114
v_exp_f32 v115, v115
v_exp_f32 v116, v116
v_exp_f32 v117, v117
s_waitcnt lgkmcnt(1)
v_mfma_f32_32x32x16_bf16 v[128:143], v[152:155], v[96:99], 0
v_exp_f32 v118, v118
v_exp_f32 v119, v119
v_cvt_pk_bf16_f32 v144, v112, v113
v_cvt_pk_bf16_f32 v145, v114, v115
s_waitcnt lgkmcnt(0)
v_mfma_f32_32x32x16_bf16 v[128:143], v[156:159], v[104:107], v[128:143]
ds_read_b128 v[152:155], v7 offset:8192
ds_read_b128 v[156:159], v7 offset:9216
v_cvt_pk_bf16_f32 v146, v116, v117
v_cvt_pk_bf16_f32 v147, v118, v119
v_exp_f32 v120, v120
v_exp_f32 v121, v121
v_mfma_f32_32x32x16_bf16 v[16:31], v[160:163], v[144:147], 0
ds_read_b128 v[160:163], v8 offset:2048
v_exp_f32 v122, v122
v_exp_f32 v123, v123
v_exp_f32 v124, v124
v_mfma_f32_16x16x32_bf16 v[32:35], v[212:215], v[144:147], 0
s_cmp_eq_u32 s65, 1
v_exp_f32 v125, v125
v_exp_f32 v126, v126
v_exp_f32 v127, v127
v_cvt_pk_bf16_f32 v148, v120, v121
v_cvt_pk_bf16_f32 v149, v122, v123
v_cvt_pk_bf16_f32 v150, v124, v125
v_cvt_pk_bf16_f32 v151, v126, v127
s_cbranch_scc1 at_120
v_exp_f32 v128, v128
v_exp_f32 v129, v129
v_mfma_f32_32x32x16_bf16 v[16:31], v[164:167], v[148:151], v[16:31]
ds_read_b128 v[164:167], v8 offset:3072
v_exp_f32 v130, v130
v_exp_f32 v131, v131
v_exp_f32 v132, v132
v_mfma_f32_16x16x32_bf16 v[32:35], v[212:215], v[148:151], v[32:35]
v_exp_f32 v133, v133
s_waitcnt lgkmcnt(3)
v_mfma_f32_32x32x16_bf16 v[112:127], v[152:155], v[96:99], 0
v_exp_f32 v134, v134
v_exp_f32 v135, v135
v_cvt_pk_bf16_f32 v144, v128, v129
v_cvt_pk_bf16_f32 v145, v130, v131
s_waitcnt lgkmcnt(2)
v_mfma_f32_32x32x16_bf16 v[112:127], v[156:159], v[104:107], v[112:127]
ds_read_b128 v[152:155], v7 offset:0
ds_read_b128 v[156:159], v7 offset:1024
v_cvt_pk_bf16_f32 v146, v132, v133
v_cvt_pk_bf16_f32 v147, v134, v135
v_exp_f32 v136, v136
v_exp_f32 v137, v137
s_waitcnt lgkmcnt(3)
v_mfma_f32_32x32x16_bf16 v[16:31], v[160:163], v[144:147], v[16:31]
ds_read_b128 v[160:163], v7 offset:10240
v_exp_f32 v138, v138
v_exp_f32 v139, v139
v_exp_f32 v140, v140
v_mfma_f32_16x16x32_bf16 v[32:35], v[212:215], v[144:147], v[32:35]
v_exp_f32 v141, v141
v_exp_f32 v142, v142
v_exp_f32 v143, v143
v_cvt_pk_bf16_f32 v148, v136, v137
v_cvt_pk_bf16_f32 v149, v138, v139
v_cvt_pk_bf16_f32 v150, v140, v141
v_cvt_pk_bf16_f32 v151, v142, v143
v_exp_f32 v112, v112
v_exp_f32 v113, v113
s_waitcnt lgkmcnt(3)
v_mfma_f32_32x32x16_bf16 v[16:31], v[164:167], v[148:151], v[16:31]
ds_read_b128 v[164:167], v7 offset:11264
v_exp_f32 v114, v114
v_exp_f32 v115, v115
v_exp_f32 v116, v116
v_mfma_f32_16x16x32_bf16 v[32:35], v[212:215], v[148:151], v[32:35]
v_exp_f32 v117, v117
s_waitcnt lgkmcnt(3)
v_mfma_f32_32x32x16_bf16 v[128:143], v[152:155], v[96:99], 0
v_exp_f32 v118, v118
v_exp_f32 v119, v119
v_cvt_pk_bf16_f32 v144, v112, v113
v_cvt_pk_bf16_f32 v145, v114, v115
s_waitcnt lgkmcnt(2)
v_mfma_f32_32x32x16_bf16 v[128:143], v[156:159], v[104:107], v[128:143]
v_cvt_pk_bf16_f32 v146, v116, v117
v_cvt_pk_bf16_f32 v147, v118, v119
v_exp_f32 v120, v120
v_exp_f32 v121, v121
s_waitcnt lgkmcnt(1)
v_mfma_f32_32x32x16_bf16 v[16:31], v[160:163], v[144:147], v[16:31]
ds_read_b128 v[160:163], v7 offset:2048
v_exp_f32 v122, v122
v_exp_f32 v123, v123
v_exp_f32 v124, v124
v_mfma_f32_16x16x32_bf16 v[32:35], v[212:215], v[144:147], v[32:35]
v_mov_b32 v8, v7
v_exp_f32 v125, v125
v_exp_f32 v126, v126
v_exp_f32 v127, v127
v_cvt_pk_bf16_f32 v148, v120, v121
v_cvt_pk_bf16_f32 v149, v122, v123
v_cvt_pk_bf16_f32 v150, v124, v125
v_cvt_pk_bf16_f32 v151, v126, v127
.p2align 3
at_120:
v_exp_f32 v128, v128
v_exp_f32 v129, v129
s_waitcnt lgkmcnt(1)
v_mfma_f32_32x32x16_bf16 v[16:31], v[164:167], v[148:151], v[16:31]
ds_read_b128 v[164:167], v8 offset:3072
v_exp_f32 v130, v130
v_exp_f32 v131, v131
v_exp_f32 v132, v132
v_mfma_f32_16x16x32_bf16 v[32:35], v[212:215], v[148:151], v[32:35]
v_exp_f32 v133, v133
v_mfma_f32_32x32x16_bf16 v[112:127], v[152:155], v[80:83], v[216:231]
v_exp_f32 v134, v134
v_exp_f32 v135, v135
v_cvt_pk_bf16_f32 v144, v128, v129
v_cvt_pk_bf16_f32 v145, v130, v131
v_mfma_f32_32x32x16_bf16 v[112:127], v[156:159], v[88:91], v[112:127]
s_sub_u32 s66, s66, 8192
s_cmp_eq_u32 s66, s67
s_cbranch_scc1 cross_127
cback_128:
v_add_u32 v8, s66, v6
ds_read_b128 v[152:155], v8 offset:0
ds_read_b128 v[156:159], v8 offset:1024
v_cvt_pk_bf16_f32 v146, v132, v133
v_cvt_pk_bf16_f32 v147, v134, v135
v_exp_f32 v136, v136
v_exp_f32 v137, v137
s_waitcnt lgkmcnt(3)
v_mfma_f32_32x32x16_bf16 v[16:31], v[160:163], v[144:147], v[16:31]
v_exp_f32 v138, v138
v_exp_f32 v139, v139
v_exp_f32 v140, v140
v_mfma_f32_16x16x32_bf16 v[32:35], v[212:215], v[144:147], v[32:35]
s_cmp_eq_u32 s68, 0
v_exp_f32 v141, v141
v_exp_f32 v142, v142
v_exp_f32 v143, v143
v_cvt_pk_bf16_f32 v148, v136, v137
v_cvt_pk_bf16_f32 v149, v138, v139
v_cvt_pk_bf16_f32 v150, v140, v141
v_cvt_pk_bf16_f32 v151, v142, v143
s_cbranch_scc1 at_124
.p2align 3
at_121:
v_exp_f32 v112, v112
v_exp_f32 v113, v113
s_waitcnt lgkmcnt(2)
v_mfma_f32_32x32x16_bf16 v[16:31], v[164:167], v[148:151], v[16:31]
v_exp_f32 v114, v114
v_exp_f32 v115, v115
v_exp_f32 v116, v116
v_mfma_f32_16x16x32_bf16 v[32:35], v[212:215], v[148:151], v[32:35]
v_exp_f32 v117, v117
s_waitcnt lgkmcnt(1)
v_mfma_f32_32x32x16_bf16 v[128:143], v[152:155], v[96:99], 0
v_exp_f32 v118, v118
v_exp_f32 v119, v119
v_cvt_pk_bf16_f32 v144, v112, v113
v_cvt_pk_bf16_f32 v145, v114, v115
s_waitcnt lgkmcnt(0)
v_mfma_f32_32x32x16_bf16 v[128:143], v[156:159], v[104:107], v[128:143]
v_cvt_pk_bf16_f32 v146, v116, v117
v_cvt_pk_bf16_f32 v147, v118, v119
v_exp_f32 v120, v120
v_exp_f32 v121, v121
v_mfma_f32_32x32x16_bf16 v[192:207], v[160:163], v[144:147], v[192:207]
ds_read_b128 v[160:163], v8 offset:2048
v_exp_f32 v122, v122
v_exp_f32 v123, v123
v_exp_f32 v124, v124
v_mfma_f32_16x16x32_bf16 v[208:211], v[212:215], v[144:147], v[208:211]
v_exp_f32 v125, v125
v_exp_f32 v126, v126
v_exp_f32 v127, v127
v_cvt_pk_bf16_f32 v148, v120, v121
v_cvt_pk_bf16_f32 v149, v122, v123
v_cvt_pk_bf16_f32 v150, v124, v125
v_cvt_pk_bf16_f32 v151, v126, v127
v_exp_f32 v128, v128
v_exp_f32 v129, v129
v_mfma_f32_32x32x16_bf16 v[192:207], v[164:167], v[148:151], v[192:207]
ds_read_b128 v[164:167], v8 offset:3072
v_exp_f32 v130, v130
v_exp_f32 v131, v131
v_exp_f32 v132, v132
v_mfma_f32_16x16x32_bf16 v[208:211], v[212:215], v[148:151], v[208:211]
v_exp_f32 v133, v133
v_mfma_f32_32x32x16_bf16 v[112:127], v[152:155], v[80:83], 0
v_exp_f32 v134, v134
v_exp_f32 v135, v135
v_cvt_pk_bf16_f32 v144, v128, v129
v_cvt_pk_bf16_f32 v145, v130, v131
v_mfma_f32_32x32x16_bf16 v[112:127], v[156:159], v[88:91], v[112:127]
s_sub_u32 s66, s66, 8192
s_cmp_eq_u32 s66, s67
s_cbranch_scc1 cross_129
cback_130:
v_add_u32 v8, s66, v6
ds_read_b128 v[152:155], v8 offset:0
ds_read_b128 v[156:159], v8 offset:1024
v_cvt_pk_bf16_f32 v146, v132, v133
v_cvt_pk_bf16_f32 v147, v134, v135
v_exp_f32 v136, v136
v_exp_f32 v137, v137
s_waitcnt lgkmcnt(3)
v_mfma_f32_32x32x16_bf16 v[16:31], v[160:163], v[144:147], v[16:31]
v_exp_f32 v138, v138
v_exp_f32 v139, v139
v_exp_f32 v140, v140
v_mfma_f32_16x16x32_bf16 v[32:35], v[212:215], v[144:147], v[32:35]
s_sub_u32 s68, s68, 1
s_cmp_eq_u32 s68, 0
v_exp_f32 v141, v141
v_exp_f32 v142, v142
v_exp_f32 v143, v143
v_cvt_pk_bf16_f32 v148, v136, v137
v_cvt_pk_bf16_f32 v149, v138, v139
v_cvt_pk_bf16_f32 v150, v140, v141
v_cvt_pk_bf16_f32 v151, v142, v143
s_cbranch_scc0 at_121
s_cmp_lt_u32 s59, 2
s_cbranch_scc1 at_124
.p2align 3
v_exp_f32 v112, v112
v_exp_f32 v113, v113
s_waitcnt lgkmcnt(2)
v_mfma_f32_32x32x16_bf16 v[16:31], v[164:167], v[148:151], v[16:31]
v_exp_f32 v114, v114
v_exp_f32 v115, v115
v_exp_f32 v116, v116
v_mfma_f32_16x16x32_bf16 v[32:35], v[212:215], v[148:151], v[32:35]
v_exp_f32 v117, v117
s_waitcnt lgkmcnt(1)
v_mfma_f32_32x32x16_bf16 v[128:143], v[152:155], v[96:99], v[216:231]
v_exp_f32 v118, v118
v_exp_f32 v119, v119
v_cvt_pk_bf16_f32 v144, v112, v113
v_cvt_pk_bf16_f32 v145, v114, v115
s_waitcnt lgkmcnt(0)
v_mfma_f32_32x32x16_bf16 v[128:143], v[156:159], v[104:107], v[128:143]
v_cvt_pk_bf16_f32 v146, v116, v117
v_cvt_pk_bf16_f32 v147, v118, v119
v_exp_f32 v120, v120
v_exp_f32 v121, v121
v_mfma_f32_32x32x16_bf16 v[192:207], v[160:163], v[144:147], v[192:207]
ds_read_b128 v[160:163], v8 offset:2048
v_exp_f32 v122, v122
v_exp_f32 v123, v123
v_exp_f32 v124, v124
v_mfma_f32_16x16x32_bf16 v[208:211], v[212:215], v[144:147], v[208:211]
v_exp_f32 v125, v125
v_exp_f32 v126, v126
v_exp_f32 v127, v127
v_cvt_pk_bf16_f32 v148, v120, v121
v_cvt_pk_bf16_f32 v149, v122, v123
v_cvt_pk_bf16_f32 v150, v124, v125
v_cvt_pk_bf16_f32 v151, v126, v127
v_exp_f32 v128, v128
v_exp_f32 v129, v129
v_mfma_f32_32x32x16_bf16 v[192:207], v[164:167], v[148:151], v[192:207]
ds_read_b128 v[164:167], v8 offset:3072
v_exp_f32 v130, v130
v_exp_f32 v131, v131
v_exp_f32 v132, v132
v_mfma_f32_16x16x32_bf16 v[208:211], v[212:215], v[148:151], v[208:211]
v_exp_f32 v133, v133
v_mfma_f32_32x32x16_bf16 v[112:127], v[152:155], v[80:83], 0
v_exp_f32 v134, v134
v_exp_f32 v135, v135
v_cvt_pk_bf16_f32 v144, v128, v129
v_cvt_pk_bf16_f32 v145, v130, v131
v_mfma_f32_32x32x16_bf16 v[112:127], v[156:159], v[88:91], v[112:127]
v_subrev_u32 v8, 8192, v8
ds_read_b128 v[152:155], v8 offset:0
ds_read_b128 v[156:159], v8 offset:1024
v_cvt_pk_bf16_f32 v146, v132, v133
v_cvt_pk_bf16_f32 v147, v134, v135
v_exp_f32 v136, v136
v_exp_f32 v137, v137
s_waitcnt lgkmcnt(3)
v_mfma_f32_32x32x16_bf16 v[16:31], v[160:163], v[144:147], v[16:31]
v_exp_f32 v138, v138
v_exp_f32 v139, v139
v_exp_f32 v140, v140
v_mfma_f32_16x16x32_bf16 v[32:35], v[212:215], v[144:147], v[32:35]
s_cmp_eq_u32 s65, 1
v_exp_f32 v141, v141
v_exp_f32 v142, v142
v_exp_f32 v143, v143
v_cvt_pk_bf16_f32 v148, v136, v137
v_cvt_pk_bf16_f32 v149, v138, v139
v_cvt_pk_bf16_f32 v150, v140, v141
v_cvt_pk_bf16_f32 v151, v142, v143
s_cbranch_scc1 at_123
.p2align 3
v_exp_f32 v112, v112
v_exp_f32 v113, v113
s_waitcnt lgkmcnt(2)
v_mfma_f32_32x32x16_bf16 v[16:31], v[164:167], v[148:151], v[16:31]
v_exp_f32 v114, v114
v_exp_f32 v115, v115
v_exp_f32 v116, v116
v_mfma_f32_16x16x32_bf16 v[32:35], v[212:215], v[148:151], v[32:35]
v_exp_f32 v117, v117
s_waitcnt lgkmcnt(1)
v_mfma_f32_32x32x16_bf16 v[128:143], v[152:155], v[80:83], 0
v_exp_f32 v118, v118
v_exp_f32 v119, v119
v_cvt_pk_bf16_f32 v144, v112, v113
v_cvt_pk_bf16_f32 v145, v114, v115
s_waitcnt lgkmcnt(0)
v_mfma_f32_32x32x16_bf16 v[128:143], v[156:159], v[88:91], v[128:143]
v_subrev_u32 v8, 8192, v8
ds_read_b128 v[152:155], v8 offset:0
ds_read_b128 v[156:159], v8 offset:1024
v_cvt_pk_bf16_f32 v146, v116, v117
v_cvt_pk_bf16_f32 v147, v118, v119
v_exp_f32 v120, v120
v_exp_f32 v121, v121
v_mfma_f32_32x32x16_bf16 v[192:207], v[160:163], v[144:147], v[192:207]
ds_read_b128 v[160:163], v8 offset:10240
v_exp_f32 v122, v122
v_exp_f32 v123, v123
v_exp_f32 v124, v124
v_mfma_f32_16x16x32_bf16 v[208:211], v[212:215], v[144:147], v[208:211]
v_exp_f32 v125, v125
v_exp_f32 v126, v126
v_exp_f32 v127, v127
v_cvt_pk_bf16_f32 v148, v120, v121
v_cvt_pk_bf16_f32 v149, v122, v123
v_cvt_pk_bf16_f32 v150, v124, v125
v_cvt_pk_bf16_f32 v151, v126, v127
v_exp_f32 v128, v128
v_exp_f32 v129, v129
v_mfma_f32_32x32x16_bf16 v[192:207], v[164:167], v[148:151], v[192:207]
ds_read_b128 v[164:167], v8 offset:11264
v_exp_f32 v130, v130
v_exp_f32 v131, v131
v_exp_f32 v132, v132
v_mfma_f32_16x16x32_bf16 v[208:211], v[212:215], v[148:151], v[208:211]
v_exp_f32 v133, v133
s_waitcnt lgkmcnt(3)
v_mfma_f32_32x32x16_bf16 v[112:127], v[152:155], v[80:83], 0
v_exp_f32 v134, v134
v_exp_f32 v135, v135
v_cvt_pk_bf16_f32 v144, v128, v129
v_cvt_pk_bf16_f32 v145, v130, v131
s_waitcnt lgkmcnt(2)
v_mfma_f32_32x32x16_bf16 v[112:127], v[156:159], v[88:91], v[112:127]
v_subrev_u32 v8, 8192, v8
ds_read_b128 v[152:155], v8 offset:0
ds_read_b128 v[156:159], v8 offset:1024
v_cvt_pk_bf16_f32 v146, v132, v133
v_cvt_pk_bf16_f32 v147, v134, v135
v_exp_f32 v136, v136
v_exp_f32 v137, v137
s_waitcnt lgkmcnt(3)
v_mfma_f32_32x32x16_bf16 v[192:207], v[160:163], v[144:147], v[192:207]
ds_read_b128 v[160:163], v8 offset:10240
v_exp_f32 v138, v138
v_exp_f32 v139, v139
v_exp_f32 v140, v140
v_mfma_f32_16x16x32_bf16 v[208:211], v[212:215], v[144:147], v[208:211]
v_exp_f32 v141, v141
v_exp_f32 v142, v142
v_exp_f32 v143, v143
v_cvt_pk_bf16_f32 v148, v136, v137
v_cvt_pk_bf16_f32 v149, v138, v139
v_cvt_pk_bf16_f32 v150, v140, v141
v_cvt_pk_bf16_f32 v151, v142, v143
v_exp_f32 v112, v112
v_exp_f32 v113, v113
s_waitcnt lgkmcnt(3)
v_mfma_f32_32x32x16_bf16 v[192:207], v[164:167], v[148:151], v[192:207]
ds_read_b128 v[164:167], v8 offset:11264
v_exp_f32 v114, v114
v_exp_f32 v115, v115
v_exp_f32 v116, v116
v_mfma_f32_16x16x32_bf16 v[208:211], v[212:215], v[148:151], v[208:211]
v_exp_f32 v117, v117
s_waitcnt lgkmcnt(3)
v_mfma_f32_32x32x16_bf16 v[128:143], v[152:155], v[80:83], v[216:231]
v_exp_f32 v118, v118
v_exp_f32 v119, v119
v_cvt_pk_bf16_f32 v144, v112, v113
v_cvt_pk_bf16_f32 v145, v114, v115
s_waitcnt lgkmcnt(2)
v_mfma_f32_32x32x16_bf16 v[128:143], v[156:159], v[88:91], v[128:143]
v_cvt_pk_bf16_f32 v146, v116, v117
v_cvt_pk_bf16_f32 v147, v118, v119
v_exp_f32 v120, v120
v_exp_f32 v121, v121
s_waitcnt lgkmcnt(1)
v_mfma_f32_32x32x16_bf16 v[192:207], v[160:163], v[144:147], v[192:207]
ds_read_b128 v[160:163], v8 offset:2048
v_exp_f32 v122, v122
v_exp_f32 v123, v123
v_exp_f32 v124, v124
v_mfma_f32_16x16x32_bf16 v[208:211], v[212:215], v[144:147], v[208:211]
v_exp_f32 v125, v125
v_exp_f32 v126, v126
v_exp_f32 v127, v127
v_cvt_pk_bf16_f32 v148, v120, v121
v_cvt_pk_bf16_f32 v149, v122, v123
v_cvt_pk_bf16_f32 v150, v124, v125
v_cvt_pk_bf16_f32 v151, v126, v127
s_branch at_125
.p2align 3
at_124:
v_add_u32 v5, s34, 20
s_mov_b64 exec, 1
ds_write_b32 v3, v5
s_mov_b64 exec, -1
v_exp_f32 v112, v112
v_exp_f32 v113, v113
s_waitcnt lgkmcnt(3)
v_mfma_f32_32x32x16_bf16 v[16:31], v[164:167], v[148:151], v[16:31]
v_exp_f32 v114, v114
v_exp_f32 v115, v115
v_exp_f32 v116, v116
v_mfma_f32_16x16x32_bf16 v[32:35], v[212:215], v[148:151], v[32:35]
v_exp_f32 v117, v117
v_exp_f32 v118, v118
v_exp_f32 v119, v119
v_cvt_pk_bf16_f32 v144, v112, v113
v_cvt_pk_bf16_f32 v145, v114, v115
v_cvt_pk_bf16_f32 v146, v116, v117
v_cvt_pk_bf16_f32 v147, v118, v119
v_exp_f32 v120, v120
v_exp_f32 v121, v121
v_mfma_f32_32x32x16_bf16 v[192:207], v[160:163], v[144:147], v[192:207]
v_exp_f32 v122, v122
v_exp_f32 v123, v123
v_exp_f32 v124, v124
v_mfma_f32_16x16x32_bf16 v[208:211], v[212:215], v[144:147], v[208:211]
v_exp_f32 v125, v125
v_exp_f32 v126, v126
v_exp_f32 v127, v127
v_cvt_pk_bf16_f32 v148, v120, v121
v_cvt_pk_bf16_f32 v149, v122, v123
v_cvt_pk_bf16_f32 v150, v124, v125
v_cvt_pk_bf16_f32 v151, v126, v127
s_branch at_126
.p2align 3
at_123:
v_exp_f32 v112, v112
v_exp_f32 v113, v113
s_waitcnt lgkmcnt(2)
v_mfma_f32_32x32x16_bf16 v[16:31], v[164:167], v[148:151], v[16:31]
v_exp_f32 v114, v114
v_exp_f32 v115, v115
v_exp_f32 v116, v116
v_mfma_f32_16x16x32_bf16 v[32:35], v[212:215], v[148:151], v[32:35]
v_exp_f32 v117, v117
s_waitcnt lgkmcnt(1)
v_mfma_f32_32x32x16_bf16 v[128:143], v[152:155], v[80:83], v[216:231]
v_exp_f32 v118, v118
v_exp_f32 v119, v119
v_cvt_pk_bf16_f32 v144, v112, v113
v_cvt_pk_bf16_f32 v145, v114, v115
s_waitcnt lgkmcnt(0)
v_mfma_f32_32x32x16_bf16 v[128:143], v[156:159], v[88:91], v[128:143]
v_cvt_pk_bf16_f32 v146, v116, v117
v_cvt_pk_bf16_f32 v147, v118, v119
v_exp_f32 v120, v120
v_exp_f32 v121, v121
v_mfma_f32_32x32x16_bf16 v[192:207], v[160:163], v[144:147], v[192:207]
ds_read_b128 v[160:163], v8 offset:2048
v_exp_f32 v122, v122
v_exp_f32 v123, v123
v_exp_f32 v124, v124
v_mfma_f32_16x16x32_bf16 v[208:211], v[212:215], v[144:147], v[208:211]
v_exp_f32 v125, v125
v_exp_f32 v126, v126
v_exp_f32 v127, v127
v_cvt_pk_bf16_f32 v148, v120, v121
v_cvt_pk_bf16_f32 v149, v122, v123
v_cvt_pk_bf16_f32 v150, v124, v125
v_cvt_pk_bf16_f32 v151, v126, v127
.p2align 3
at_125:
v_exp_f32 v128, v128
v_exp_f32 v129, v129
s_waitcnt lgkmcnt(1)
v_mfma_f32_32x32x16_bf16 v[192:207], v[164:167], v[148:151], v[192:207]
ds_read_b128 v[164:167], v8 offset:3072
v_exp_f32 v130, v130
v_exp_f32 v131, v131
v_exp_f32 v132, v132
v_mfma_f32_16x16x32_bf16 v[208:211], v[212:215], v[148:151], v[208:211]
v_exp_f32 v133, v133
v_exp_f32 v134, v134
v_exp_f32 v135, v135
v_cvt_pk_bf16_f32 v144, v128, v129
v_cvt_pk_bf16_f32 v145, v130, v131
v_add_u32 v5, s34, 20
s_mov_b64 exec, 1
ds_write_b32 v3, v5
s_mov_b64 exec, -1
v_cvt_pk_bf16_f32 v146, v132, v133
v_cvt_pk_bf16_f32 v147, v134, v135
v_exp_f32 v136, v136
v_exp_f32 v137, v137
s_waitcnt lgkmcnt(2)
v_mfma_f32_32x32x16_bf16 v[192:207], v[160:163], v[144:147], v[192:207]
v_exp_f32 v138, v138
v_exp_f32 v139, v139
v_exp_f32 v140, v140
v_mfma_f32_16x16x32_bf16 v[208:211], v[212:215], v[144:147], v[208:211]
v_exp_f32 v141, v141
v_exp_f32 v142, v142
v_exp_f32 v143, v143
v_cvt_pk_bf16_f32 v148, v136, v137
v_cvt_pk_bf16_f32 v149, v138, v139
v_cvt_pk_bf16_f32 v150, v140, v141
v_cvt_pk_bf16_f32 v151, v142, v143
at_126:
s_lshl_b32 s66, s59, 18
s_lshl_b32 s67, s63, 22
v_mfma_f32_16x16x32_bf16 v[208:211], v[212:215], v[148:151], v[208:211]
s_add_u32 s66, s66, s67
s_lshl1_add_u32 s67, s60, s64
s_waitcnt lgkmcnt(1)
v_mfma_f32_32x32x16_bf16 v[192:207], v[164:167], v[148:151], v[192:207]
s_lshl_b32 s67, s67, 11
s_add_u32 s66, s66, s67
s_lshl_b32 s68, s65, 16
s_add_u32 s67, s66, 18022400
s_sub_u32 s67, s67, s68
s_add_u32 s66, s66, s68
s_add_u32 s66, s66, 17825792
v_lshlrev_b32 v9, 4, v0
v_subrev_u32 v10, 0x2f800000, v32
v_subrev_u32 v11, 0x2f800000, v208
v_max_u32 v10, v10, v11
v_cmp_lt_u32 vcc, 0x20000000, v10
s_cbranch_vccnz slow_131
sback_132:
s_nop 1
v_rcp_f32 v12, v32
s_nop 1
v_pk_mul_f32 v[16:17], v[16:17], v[12:13] op_sel:[0,0] op_sel_hi:[1,0]
v_pk_mul_f32 v[18:19], v[18:19], v[12:13] op_sel:[0,0] op_sel_hi:[1,0]
v_pk_mul_f32 v[20:21], v[20:21], v[12:13] op_sel:[0,0] op_sel_hi:[1,0]
v_pk_mul_f32 v[22:23], v[22:23], v[12:13] op_sel:[0,0] op_sel_hi:[1,0]
v_pk_mul_f32 v[24:25], v[24:25], v[12:13] op_sel:[0,0] op_sel_hi:[1,0]
v_pk_mul_f32 v[26:27], v[26:27], v[12:13] op_sel:[0,0] op_sel_hi:[1,0]
v_pk_mul_f32 v[28:29], v[28:29], v[12:13] op_sel:[0,0] op_sel_hi:[1,0]
v_pk_mul_f32 v[30:31], v[30:31], v[12:13] op_sel:[0,0] op_sel_hi:[1,0]
v_cvt_pk_bf16_f32 v16, v16, v17
v_cvt_pk_bf16_f32 v17, v18, v19
v_cvt_pk_bf16_f32 v18, v20, v21
v_cvt_pk_bf16_f32 v19, v22, v23
v_cvt_pk_bf16_f32 v20, v24, v25
v_cvt_pk_bf16_f32 v21, v26, v27
v_cvt_pk_bf16_f32 v22, v28, v29
v_cvt_pk_bf16_f32 v23, v30, v31
buffer_store_dwordx4 v[16:19], v9, s[20:23], s67 offen offset:0 sc1
buffer_store_dwordx4 v[20:23], v9, s[20:23], s67 offen offset:1024 sc1
v_rcp_f32 v12, v208
s_nop 0
v_pk_mul_f32 v[192:193], v[192:193], v[12:13] op_sel:[0,0] op_sel_hi:[1,0]
v_pk_mul_f32 v[194:195], v[194:195], v[12:13] op_sel:[0,0] op_sel_hi:[1,0]
v_pk_mul_f32 v[196:197], v[196:197], v[12:13] op_sel:[0,0] op_sel_hi:[1,0]
v_pk_mul_f32 v[198:199], v[198:199], v[12:13] op_sel:[0,0] op_sel_hi:[1,0]
v_pk_mul_f32 v[200:201], v[200:201], v[12:13] op_sel:[0,0] op_sel_hi:[1,0]
v_pk_mul_f32 v[202:203], v[202:203], v[12:13] op_sel:[0,0] op_sel_hi:[1,0]
v_pk_mul_f32 v[204:205], v[204:205], v[12:13] op_sel:[0,0] op_sel_hi:[1,0]
v_pk_mul_f32 v[206:207], v[206:207], v[12:13] op_sel:[0,0] op_sel_hi:[1,0]
v_cvt_pk_bf16_f32 v192, v192, v193
v_cvt_pk_bf16_f32 v193, v194, v195
v_cvt_pk_bf16_f32 v194, v196, v197
v_cvt_pk_bf16_f32 v195, v198, v199
v_cvt_pk_bf16_f32 v196, v200, v201
v_cvt_pk_bf16_f32 v197, v202, v203
v_cvt_pk_bf16_f32 v198, v204, v205
v_cvt_pk_bf16_f32 v199, v206, v207
buffer_store_dwordx4 v[192:195], v9, s[20:23], s66 offen offset:0 sc1
buffer_store_dwordx4 v[196:199], v9, s[20:23], s66 offen offset:1024 sc1
v_bfe_u32 v48, v0, 2, 3
v_lshrrev_b32 v49, 5, v0
v_lshl_add_u32 v48, v49, 4, v48
v_lshlrev_b32 v48, 7, v48
v_bfe_u32 v49, v0, 3, 2
v_lshl_add_u32 v48, v49, 5, v48
v_and_b32 v49, 3, v0
v_lshl_add_u32 v48, v49, 3, v48
v_add_u32 v8, 32768, v48
v_xor_b32 v9, 32, v8
v_xor_b32 v10, 64, v8
v_xor_b32 v11, 96, v8
v_add_u32 v12, 0x10000, v8
v_add_u32 v13, 0x10000, v9
v_add_u32 v14, 0x10000, v10
v_add_u32 v15, 0x10000, v11
v_and_b32 v48, 15, v0
v_lshrrev_b32 v49, 4, v0
s_lshl2_add_u32 s66, s61, s58
s_lshl_b32 s67, s66, 16
s_lshl_b32 s68, s63, 22
s_add_u32 s67, s67, s68
s_add_u32 s67, s67, 17825792
v_lshl_add_u32 v6, v48, 4, s67
v_lshl_add_u32 v6, v49, 9, v6
s_add_u32 s70, s72, 268288
s_add_u32 s35, s34, 3
lw_133:
ds_read_b32 v5, v2 offset:24
s_waitcnt lgkmcnt(0)
v_cmp_gt_i32 vcc, s35, v5
s_cbranch_vccz lwd_134
s_sub_u32 s32, s32, 1
s_cmp_gt_i32 s32, 0
s_cbranch_scc1 lw_133
lwd_134:
s_mov_b64 exec, 1
s_waitcnt vmcnt(0)
buffer_store_dword v212, v3, s[24:27], s70 offen sc1
s_mov_b64 exec, -1
v_add_u32 v5, s34, 21
s_mov_b64 exec, 1
ds_write_b32 v3, v5
s_mov_b64 exec, -1
s_cmp_eq_u32 s63, 0
s_cbranch_scc0 mo_135
v_permlane16_swap_b32 v240, v242
v_permlane16_swap_b32 v241, v243
v_permlane16_swap_b32 v244, v246
v_permlane16_swap_b32 v245, v247
v_permlane16_swap_b32 v248, v250
v_permlane16_swap_b32 v249, v251
v_permlane16_swap_b32 v252, v254
v_permlane16_swap_b32 v253, v255
mo_136:
v_lshlrev_b32 v16, 16, v240
v_and_b32 v17, 0xffff0000, v240
v_lshlrev_b32 v18, 16, v241
v_and_b32 v19, 0xffff0000, v241
v_lshlrev_b32 v20, 16, v242
v_and_b32 v21, 0xffff0000, v242
v_lshlrev_b32 v22, 16, v243
v_and_b32 v23, 0xffff0000, v243
v_lshlrev_b32 v24, 16, v244
v_and_b32 v25, 0xffff0000, v244
v_lshlrev_b32 v26, 16, v245
v_and_b32 v27, 0xffff0000, v245
v_lshlrev_b32 v28, 16, v246
v_and_b32 v29, 0xffff0000, v246
v_lshlrev_b32 v30, 16, v247
v_and_b32 v31, 0xffff0000, v247
v_lshlrev_b32 v32, 16, v248
v_and_b32 v33, 0xffff0000, v248
v_lshlrev_b32 v34, 16, v249
v_and_b32 v35, 0xffff0000, v249
v_lshlrev_b32 v36, 16, v250
v_and_b32 v37, 0xffff0000, v250
v_lshlrev_b32 v38, 16, v251
v_and_b32 v39, 0xffff0000, v251
v_lshlrev_b32 v40, 16, v252
v_and_b32 v41, 0xffff0000, v252
v_lshlrev_b32 v42, 16, v253
v_and_b32 v43, 0xffff0000, v253
v_lshlrev_b32 v44, 16, v254
v_and_b32 v45, 0xffff0000, v254
v_lshlrev_b32 v46, 16, v255
v_and_b32 v47, 0xffff0000, v255
s_add_u32 s66, s61, s62
s_and_b32 s66, s66, 15
s_lshl_b32 s66, s66, 12
s_add_u32 s35, s34, 18
lw_137:
ds_read_b32 v5, v2 offset:16
s_waitcnt lgkmcnt(0)
v_cmp_gt_i32 vcc, s35, v5
s_cbranch_vccz lwd_138
s_sub_u32 s32, s32, 1
s_cmp_gt_i32 s32, 0
s_cbranch_scc1 lw_137
lwd_138:
buffer_load_dwordx4 v[80:83], v6, s[20:23], s66 offen offset:0 sc1
buffer_load_dwordx4 v[88:91], v6, s[20:23], s66 offen offset:2048 sc1
buffer_load_dwordx4 v[84:87], v6, s[20:23], s66 offen offset:256 sc1
buffer_load_dwordx4 v[92:95], v6, s[20:23], s66 offen offset:2304 sc1
s_add_u32 s66, s66, 4096
s_and_b32 s66, s66, 0xffff
ds_read_b64_tr_b16 v[48:49], v8 offset:0
ds_read_b64_tr_b16 v[50:51], v8 offset:1024
ds_read_b64_tr_b16 v[52:53], v8 offset:4096
ds_read_b64_tr_b16 v[54:55], v8 offset:5120
buffer_load_dwordx4 v[96:99], v6, s[20:23], s66 offen offset:0 sc1
buffer_load_dwordx4 v[104:107], v6, s[20:23], s66 offen offset:2048 sc1
buffer_load_dwordx4 v[100:103], v6, s[20:23], s66 offen offset:256 sc1
buffer_load_dwordx4 v[108:111], v6, s[20:23], s66 offen offset:2304 sc1
s_add_u32 s66, s66, 4096
s_and_b32 s66, s66, 0xffff
ds_read_b64_tr_b16 v[56:57], v9 offset:0
ds_read_b64_tr_b16 v[58:59], v9 offset:1024
ds_read_b64_tr_b16 v[60:61], v9 offset:4096
ds_read_b64_tr_b16 v[62:63], v9 offset:5120
buffer_load_dwordx4 v[112:115], v6, s[20:23], s66 offen offset:0 sc1
buffer_load_dwordx4 v[120:123], v6, s[20:23], s66 offen offset:2048 sc1
buffer_load_dwordx4 v[116:119], v6, s[20:23], s66 offen offset:256 sc1
buffer_load_dwordx4 v[124:127], v6, s[20:23], s66 offen offset:2304 sc1
s_add_u32 s66, s66, 4096
s_and_b32 s66, s66, 0xffff
ds_read_b64_tr_b16 v[64:65], v10 offset:0
ds_read_b64_tr_b16 v[66:67], v10 offset:1024
ds_read_b64_tr_b16 v[68:69], v10 offset:4096
ds_read_b64_tr_b16 v[70:71], v10 offset:5120
buffer_load_dwordx4 v[128:131], v6, s[20:23], s66 offen offset:0 sc1
buffer_load_dwordx4 v[136:139], v6, s[20:23], s66 offen offset:2048 sc1
buffer_load_dwordx4 v[132:135], v6, s[20:23], s66 offen offset:256 sc1
buffer_load_dwordx4 v[140:143], v6, s[20:23], s66 offen offset:2304 sc1
s_add_u32 s66, s66, 4096
s_and_b32 s66, s66, 0xffff
buffer_load_dwordx4 v[144:147], v6, s[20:23], s66 offen offset:0 sc1
buffer_load_dwordx4 v[152:155], v6, s[20:23], s66 offen offset:2048 sc1
buffer_load_dwordx4 v[148:151], v6, s[20:23], s66 offen offset:256 sc1
buffer_load_dwordx4 v[156:159], v6, s[20:23], s66 offen offset:2304 sc1
s_add_u32 s66, s66, 4096
s_and_b32 s66, s66, 0xffff
buffer_load_dwordx4 v[160:163], v6, s[20:23], s66 offen offset:0 sc1
buffer_load_dwordx4 v[168:171], v6, s[20:23], s66 offen offset:2048 sc1
buffer_load_dwordx4 v[164:167], v6, s[20:23], s66 offen offset:256 sc1
buffer_load_dwordx4 v[172:175], v6, s[20:23], s66 offen offset:2304 sc1
s_add_u32 s66, s66, 4096
s_and_b32 s66, s66, 0xffff
buffer_load_dwordx4 v[176:179], v6, s[20:23], s66 offen offset:0 sc1
buffer_load_dwordx4 v[184:187], v6, s[20:23], s66 offen offset:2048 sc1
buffer_load_dwordx4 v[180:183], v6, s[20:23], s66 offen offset:256 sc1
buffer_load_dwordx4 v[188:191], v6, s[20:23], s66 offen offset:2304 sc1
s_add_u32 s66, s66, 4096
s_and_b32 s66, s66, 0xffff
buffer_load_dwordx4 v[192:195], v6, s[20:23], s66 offen offset:0 sc1
buffer_load_dwordx4 v[200:203], v6, s[20:23], s66 offen offset:2048 sc1
buffer_load_dwordx4 v[196:199], v6, s[20:23], s66 offen offset:256 sc1
buffer_load_dwordx4 v[204:207], v6, s[20:23], s66 offen offset:2304 sc1
s_add_u32 s66, s66, 4096
s_and_b32 s66, s66, 0xffff
.p2align 3
s_waitcnt vmcnt(31) lgkmcnt(10)
v_mfma_f32_16x16x32_bf16 v[16:19], v[48:51], v[80:83], v[16:19]
ds_read_b64_tr_b16 v[72:73], v11 offset:0
s_waitcnt vmcnt(30) lgkmcnt(9)
v_mfma_f32_16x16x32_bf16 v[16:19], v[52:55], v[88:91], v[16:19]
ds_read_b64_tr_b16 v[74:75], v11 offset:1024
s_waitcnt vmcnt(29)
v_mfma_f32_16x16x32_bf16 v[32:35], v[48:51], v[84:87], v[32:35]
ds_read_b64_tr_b16 v[76:77], v11 offset:4096
s_waitcnt vmcnt(28)
v_mfma_f32_16x16x32_bf16 v[32:35], v[52:55], v[92:95], v[32:35]
ds_read_b64_tr_b16 v[78:79], v11 offset:5120
s_waitcnt lgkmcnt(10)
v_mfma_f32_16x16x32_bf16 v[20:23], v[56:59], v[80:83], v[20:23]
ds_read_b64_tr_b16 v[48:49], v8 offset:8192
s_waitcnt lgkmcnt(9)
v_mfma_f32_16x16x32_bf16 v[20:23], v[60:63], v[88:91], v[20:23]
ds_read_b64_tr_b16 v[50:51], v8 offset:9216
v_mfma_f32_16x16x32_bf16 v[36:39], v[56:59], v[84:87], v[36:39]
ds_read_b64_tr_b16 v[52:53], v8 offset:12288
v_mfma_f32_16x16x32_bf16 v[36:39], v[60:63], v[92:95], v[36:39]
ds_read_b64_tr_b16 v[54:55], v8 offset:13312
s_waitcnt lgkmcnt(10)
v_mfma_f32_16x16x32_bf16 v[24:27], v[64:67], v[80:83], v[24:27]
ds_read_b64_tr_b16 v[56:57], v9 offset:8192
s_waitcnt lgkmcnt(9)
v_mfma_f32_16x16x32_bf16 v[24:27], v[68:71], v[88:91], v[24:27]
ds_read_b64_tr_b16 v[58:59], v9 offset:9216
v_mfma_f32_16x16x32_bf16 v[40:43], v[64:67], v[84:87], v[40:43]
ds_read_b64_tr_b16 v[60:61], v9 offset:12288
v_mfma_f32_16x16x32_bf16 v[40:43], v[68:71], v[92:95], v[40:43]
ds_read_b64_tr_b16 v[62:63], v9 offset:13312
s_waitcnt lgkmcnt(10)
v_mfma_f32_16x16x32_bf16 v[28:31], v[72:75], v[80:83], v[28:31]
ds_read_b64_tr_b16 v[64:65], v10 offset:8192
s_waitcnt lgkmcnt(9)
v_mfma_f32_16x16x32_bf16 v[28:31], v[76:79], v[88:91], v[28:31]
ds_read_b64_tr_b16 v[66:67], v10 offset:9216
v_mfma_f32_16x16x32_bf16 v[44:47], v[72:75], v[84:87], v[44:47]
ds_read_b64_tr_b16 v[68:69], v10 offset:12288
v_mfma_f32_16x16x32_bf16 v[44:47], v[76:79], v[92:95], v[44:47]
ds_read_b64_tr_b16 v[70:71], v10 offset:13312
s_waitcnt vmcnt(27) lgkmcnt(10)
v_mfma_f32_16x16x32_bf16 v[16:19], v[48:51], v[96:99], v[16:19]
ds_read_b64_tr_b16 v[72:73], v11 offset:8192
buffer_load_dwordx4 v[80:83], v6, s[20:23], s66 offen offset:0 sc1
s_waitcnt vmcnt(27) lgkmcnt(9)
v_mfma_f32_16x16x32_bf16 v[16:19], v[52:55], v[104:107], v[16:19]
ds_read_b64_tr_b16 v[74:75], v11 offset:9216
buffer_load_dwordx4 v[88:91], v6, s[20:23], s66 offen offset:2048 sc1
s_waitcnt vmcnt(27)
v_mfma_f32_16x16x32_bf16 v[32:35], v[48:51], v[100:103], v[32:35]
ds_read_b64_tr_b16 v[76:77], v11 offset:12288
buffer_load_dwordx4 v[84:87], v6, s[20:23], s66 offen offset:256 sc1
s_waitcnt vmcnt(27)
v_mfma_f32_16x16x32_bf16 v[32:35], v[52:55], v[108:111], v[32:35]
ds_read_b64_tr_b16 v[78:79], v11 offset:13312
buffer_load_dwordx4 v[92:95], v6, s[20:23], s66 offen offset:2304 sc1
s_waitcnt lgkmcnt(10)
v_mfma_f32_16x16x32_bf16 v[20:23], v[56:59], v[96:99], v[20:23]
ds_read_b64_tr_b16 v[48:49], v8 offset:16384
s_add_u32 s66, s66, 4096
s_and_b32 s66, s66, 0xffff
s_waitcnt lgkmcnt(9)
v_mfma_f32_16x16x32_bf16 v[20:23], v[60:63], v[104:107], v[20:23]
ds_read_b64_tr_b16 v[50:51], v8 offset:17408
v_mfma_f32_16x16x32_bf16 v[36:39], v[56:59], v[100:103], v[36:39]
ds_read_b64_tr_b16 v[52:53], v8 offset:20480
v_mfma_f32_16x16x32_bf16 v[36:39], v[60:63], v[108:111], v[36:39]
ds_read_b64_tr_b16 v[54:55], v8 offset:21504
s_waitcnt lgkmcnt(10)
v_mfma_f32_16x16x32_bf16 v[24:27], v[64:67], v[96:99], v[24:27]
ds_read_b64_tr_b16 v[56:57], v9 offset:16384
s_waitcnt lgkmcnt(9)
v_mfma_f32_16x16x32_bf16 v[24:27], v[68:71], v[104:107], v[24:27]
ds_read_b64_tr_b16 v[58:59], v9 offset:17408
v_mfma_f32_16x16x32_bf16 v[40:43], v[64:67], v[100:103], v[40:43]
ds_read_b64_tr_b16 v[60:61], v9 offset:20480
v_mfma_f32_16x16x32_bf16 v[40:43], v[68:71], v[108:111], v[40:43]
ds_read_b64_tr_b16 v[62:63], v9 offset:21504
s_waitcnt lgkmcnt(10)
v_mfma_f32_16x16x32_bf16 v[28:31], v[72:75], v[96:99], v[28:31]
ds_read_b64_tr_b16 v[64:65], v10 offset:16384
s_waitcnt lgkmcnt(9)
v_mfma_f32_16x16x32_bf16 v[28:31], v[76:79], v[104:107], v[28:31]
ds_read_b64_tr_b16 v[66:67], v10 offset:17408
v_mfma_f32_16x16x32_bf16 v[44:47], v[72:75], v[100:103], v[44:47]
ds_read_b64_tr_b16 v[68:69], v10 offset:20480
v_mfma_f32_16x16x32_bf16 v[44:47], v[76:79], v[108:111], v[44:47]
ds_read_b64_tr_b16 v[70:71], v10 offset:21504
s_waitcnt vmcnt(27) lgkmcnt(10)
v_mfma_f32_16x16x32_bf16 v[16:19], v[48:51], v[112:115], v[16:19]
ds_read_b64_tr_b16 v[72:73], v11 offset:16384
buffer_load_dwordx4 v[96:99], v6, s[20:23], s66 offen offset:0 sc1
s_waitcnt vmcnt(27) lgkmcnt(9)
v_mfma_f32_16x16x32_bf16 v[16:19], v[52:55], v[120:123], v[16:19]
ds_read_b64_tr_b16 v[74:75], v11 offset:17408
buffer_load_dwordx4 v[104:107], v6, s[20:23], s66 offen offset:2048 sc1
s_waitcnt vmcnt(27)
v_mfma_f32_16x16x32_bf16 v[32:35], v[48:51], v[116:119], v[32:35]
ds_read_b64_tr_b16 v[76:77], v11 offset:20480
buffer_load_dwordx4 v[100:103], v6, s[20:23], s66 offen offset:256 sc1
s_waitcnt vmcnt(27)
v_mfma_f32_16x16x32_bf16 v[32:35], v[52:55], v[124:127], v[32:35]
ds_read_b64_tr_b16 v[78:79], v11 offset:21504
buffer_load_dwordx4 v[108:111], v6, s[20:23], s66 offen offset:2304 sc1
s_waitcnt lgkmcnt(10)
v_mfma_f32_16x16x32_bf16 v[20:23], v[56:59], v[112:115], v[20:23]
ds_read_b64_tr_b16 v[48:49], v8 offset:24576
s_add_u32 s66, s66, 4096
s_and_b32 s66, s66, 0xffff
s_waitcnt lgkmcnt(9)
v_mfma_f32_16x16x32_bf16 v[20:23], v[60:63], v[120:123], v[20:23]
ds_read_b64_tr_b16 v[50:51], v8 offset:25600
v_mfma_f32_16x16x32_bf16 v[36:39], v[56:59], v[116:119], v[36:39]
ds_read_b64_tr_b16 v[52:53], v8 offset:28672
v_mfma_f32_16x16x32_bf16 v[36:39], v[60:63], v[124:127], v[36:39]
ds_read_b64_tr_b16 v[54:55], v8 offset:29696
s_waitcnt lgkmcnt(10)
v_mfma_f32_16x16x32_bf16 v[24:27], v[64:67], v[112:115], v[24:27]
ds_read_b64_tr_b16 v[56:57], v9 offset:24576
s_waitcnt lgkmcnt(9)
v_mfma_f32_16x16x32_bf16 v[24:27], v[68:71], v[120:123], v[24:27]
ds_read_b64_tr_b16 v[58:59], v9 offset:25600
v_mfma_f32_16x16x32_bf16 v[40:43], v[64:67], v[116:119], v[40:43]
ds_read_b64_tr_b16 v[60:61], v9 offset:28672
v_mfma_f32_16x16x32_bf16 v[40:43], v[68:71], v[124:127], v[40:43]
ds_read_b64_tr_b16 v[62:63], v9 offset:29696
s_waitcnt lgkmcnt(10)
v_mfma_f32_16x16x32_bf16 v[28:31], v[72:75], v[112:115], v[28:31]
ds_read_b64_tr_b16 v[64:65], v10 offset:24576
s_waitcnt lgkmcnt(9)
v_mfma_f32_16x16x32_bf16 v[28:31], v[76:79], v[120:123], v[28:31]
ds_read_b64_tr_b16 v[66:67], v10 offset:25600
v_mfma_f32_16x16x32_bf16 v[44:47], v[72:75], v[116:119], v[44:47]
ds_read_b64_tr_b16 v[68:69], v10 offset:28672
v_mfma_f32_16x16x32_bf16 v[44:47], v[76:79], v[124:127], v[44:47]
ds_read_b64_tr_b16 v[70:71], v10 offset:29696
s_waitcnt vmcnt(27) lgkmcnt(10)
v_mfma_f32_16x16x32_bf16 v[16:19], v[48:51], v[128:131], v[16:19]
ds_read_b64_tr_b16 v[72:73], v11 offset:24576
buffer_load_dwordx4 v[112:115], v6, s[20:23], s66 offen offset:0 sc1
s_waitcnt vmcnt(27) lgkmcnt(9)
v_mfma_f32_16x16x32_bf16 v[16:19], v[52:55], v[136:139], v[16:19]
ds_read_b64_tr_b16 v[74:75], v11 offset:25600
buffer_load_dwordx4 v[120:123], v6, s[20:23], s66 offen offset:2048 sc1
s_waitcnt vmcnt(27)
v_mfma_f32_16x16x32_bf16 v[32:35], v[48:51], v[132:135], v[32:35]
ds_read_b64_tr_b16 v[76:77], v11 offset:28672
buffer_load_dwordx4 v[116:119], v6, s[20:23], s66 offen offset:256 sc1
s_waitcnt vmcnt(27)
v_mfma_f32_16x16x32_bf16 v[32:35], v[52:55], v[140:143], v[32:35]
ds_read_b64_tr_b16 v[78:79], v11 offset:29696
buffer_load_dwordx4 v[124:127], v6, s[20:23], s66 offen offset:2304 sc1
s_waitcnt lgkmcnt(10)
v_mfma_f32_16x16x32_bf16 v[20:23], v[56:59], v[128:131], v[20:23]
ds_read_b64_tr_b16 v[48:49], v8 offset:32768
s_add_u32 s66, s66, 4096
s_and_b32 s66, s66, 0xffff
s_waitcnt lgkmcnt(9)
v_mfma_f32_16x16x32_bf16 v[20:23], v[60:63], v[136:139], v[20:23]
ds_read_b64_tr_b16 v[50:51], v8 offset:33792
v_mfma_f32_16x16x32_bf16 v[36:39], v[56:59], v[132:135], v[36:39]
ds_read_b64_tr_b16 v[52:53], v8 offset:36864
v_mfma_f32_16x16x32_bf16 v[36:39], v[60:63], v[140:143], v[36:39]
ds_read_b64_tr_b16 v[54:55], v8 offset:37888
s_waitcnt lgkmcnt(10)
v_mfma_f32_16x16x32_bf16 v[24:27], v[64:67], v[128:131], v[24:27]
ds_read_b64_tr_b16 v[56:57], v9 offset:32768
s_waitcnt lgkmcnt(9)
v_mfma_f32_16x16x32_bf16 v[24:27], v[68:71], v[136:139], v[24:27]
ds_read_b64_tr_b16 v[58:59], v9 offset:33792
v_mfma_f32_16x16x32_bf16 v[40:43], v[64:67], v[132:135], v[40:43]
ds_read_b64_tr_b16 v[60:61], v9 offset:36864
v_mfma_f32_16x16x32_bf16 v[40:43], v[68:71], v[140:143], v[40:43]
ds_read_b64_tr_b16 v[62:63], v9 offset:37888
s_waitcnt lgkmcnt(10)
v_mfma_f32_16x16x32_bf16 v[28:31], v[72:75], v[128:131], v[28:31]
ds_read_b64_tr_b16 v[64:65], v10 offset:32768
s_waitcnt lgkmcnt(9)
v_mfma_f32_16x16x32_bf16 v[28:31], v[76:79], v[136:139], v[28:31]
ds_read_b64_tr_b16 v[66:67], v10 offset:33792
v_mfma_f32_16x16x32_bf16 v[44:47], v[72:75], v[132:135], v[44:47]
ds_read_b64_tr_b16 v[68:69], v10 offset:36864
v_mfma_f32_16x16x32_bf16 v[44:47], v[76:79], v[140:143], v[44:47]
ds_read_b64_tr_b16 v[70:71], v10 offset:37888
s_waitcnt vmcnt(27) lgkmcnt(10)
v_mfma_f32_16x16x32_bf16 v[16:19], v[48:51], v[144:147], v[16:19]
ds_read_b64_tr_b16 v[72:73], v11 offset:32768
buffer_load_dwordx4 v[128:131], v6, s[20:23], s66 offen offset:0 sc1
s_waitcnt vmcnt(27) lgkmcnt(9)
v_mfma_f32_16x16x32_bf16 v[16:19], v[52:55], v[152:155], v[16:19]
ds_read_b64_tr_b16 v[74:75], v11 offset:33792
buffer_load_dwordx4 v[136:139], v6, s[20:23], s66 offen offset:2048 sc1
s_waitcnt vmcnt(27)
v_mfma_f32_16x16x32_bf16 v[32:35], v[48:51], v[148:151], v[32:35]
ds_read_b64_tr_b16 v[76:77], v11 offset:36864
buffer_load_dwordx4 v[132:135], v6, s[20:23], s66 offen offset:256 sc1
s_waitcnt vmcnt(27)
v_mfma_f32_16x16x32_bf16 v[32:35], v[52:55], v[156:159], v[32:35]
ds_read_b64_tr_b16 v[78:79], v11 offset:37888
buffer_load_dwordx4 v[140:143], v6, s[20:23], s66 offen offset:2304 sc1
s_waitcnt lgkmcnt(10)
v_mfma_f32_16x16x32_bf16 v[20:23], v[56:59], v[144:147], v[20:23]
ds_read_b64_tr_b16 v[48:49], v8 offset:40960
s_add_u32 s66, s66, 4096
s_and_b32 s66, s66, 0xffff
s_waitcnt lgkmcnt(9)
v_mfma_f32_16x16x32_bf16 v[20:23], v[60:63], v[152:155], v[20:23]
ds_read_b64_tr_b16 v[50:51], v8 offset:41984
v_mfma_f32_16x16x32_bf16 v[36:39], v[56:59], v[148:151], v[36:39]
ds_read_b64_tr_b16 v[52:53], v8 offset:45056
v_mfma_f32_16x16x32_bf16 v[36:39], v[60:63], v[156:159], v[36:39]
ds_read_b64_tr_b16 v[54:55], v8 offset:46080
s_waitcnt lgkmcnt(10)
v_mfma_f32_16x16x32_bf16 v[24:27], v[64:67], v[144:147], v[24:27]
ds_read_b64_tr_b16 v[56:57], v9 offset:40960
s_waitcnt lgkmcnt(9)
v_mfma_f32_16x16x32_bf16 v[24:27], v[68:71], v[152:155], v[24:27]
ds_read_b64_tr_b16 v[58:59], v9 offset:41984
v_mfma_f32_16x16x32_bf16 v[40:43], v[64:67], v[148:151], v[40:43]
ds_read_b64_tr_b16 v[60:61], v9 offset:45056
v_mfma_f32_16x16x32_bf16 v[40:43], v[68:71], v[156:159], v[40:43]
ds_read_b64_tr_b16 v[62:63], v9 offset:46080
s_waitcnt lgkmcnt(10)
v_mfma_f32_16x16x32_bf16 v[28:31], v[72:75], v[144:147], v[28:31]
ds_read_b64_tr_b16 v[64:65], v10 offset:40960
s_waitcnt lgkmcnt(9)
v_mfma_f32_16x16x32_bf16 v[28:31], v[76:79], v[152:155], v[28:31]
ds_read_b64_tr_b16 v[66:67], v10 offset:41984
v_mfma_f32_16x16x32_bf16 v[44:47], v[72:75], v[148:151], v[44:47]
ds_read_b64_tr_b16 v[68:69], v10 offset:45056
v_mfma_f32_16x16x32_bf16 v[44:47], v[76:79], v[156:159], v[44:47]
ds_read_b64_tr_b16 v[70:71], v10 offset:46080
s_waitcnt vmcnt(27) lgkmcnt(10)
v_mfma_f32_16x16x32_bf16 v[16:19], v[48:51], v[160:163], v[16:19]
ds_read_b64_tr_b16 v[72:73], v11 offset:40960
buffer_load_dwordx4 v[144:147], v6, s[20:23], s66 offen offset:0 sc1
s_waitcnt vmcnt(27) lgkmcnt(9)
v_mfma_f32_16x16x32_bf16 v[16:19], v[52:55], v[168:171], v[16:19]
ds_read_b64_tr_b16 v[74:75], v11 offset:41984
buffer_load_dwordx4 v[152:155], v6, s[20:23], s66 offen offset:2048 sc1
s_waitcnt vmcnt(27)
v_mfma_f32_16x16x32_bf16 v[32:35], v[48:51], v[164:167], v[32:35]
ds_read_b64_tr_b16 v[76:77], v11 offset:45056
buffer_load_dwordx4 v[148:151], v6, s[20:23], s66 offen offset:256 sc1
s_waitcnt vmcnt(27)
v_mfma_f32_16x16x32_bf16 v[32:35], v[52:55], v[172:175], v[32:35]
ds_read_b64_tr_b16 v[78:79], v11 offset:46080
buffer_load_dwordx4 v[156:159], v6, s[20:23], s66 offen offset:2304 sc1
s_waitcnt lgkmcnt(10)
v_mfma_f32_16x16x32_bf16 v[20:23], v[56:59], v[160:163], v[20:23]
ds_read_b64_tr_b16 v[48:49], v8 offset:49152
s_add_u32 s66, s66, 4096
s_and_b32 s66, s66, 0xffff
s_waitcnt lgkmcnt(9)
v_mfma_f32_16x16x32_bf16 v[20:23], v[60:63], v[168:171], v[20:23]
ds_read_b64_tr_b16 v[50:51], v8 offset:50176
v_mfma_f32_16x16x32_bf16 v[36:39], v[56:59], v[164:167], v[36:39]
ds_read_b64_tr_b16 v[52:53], v8 offset:53248
v_mfma_f32_16x16x32_bf16 v[36:39], v[60:63], v[172:175], v[36:39]
ds_read_b64_tr_b16 v[54:55], v8 offset:54272
s_waitcnt lgkmcnt(10)
v_mfma_f32_16x16x32_bf16 v[24:27], v[64:67], v[160:163], v[24:27]
ds_read_b64_tr_b16 v[56:57], v9 offset:49152
s_waitcnt lgkmcnt(9)
v_mfma_f32_16x16x32_bf16 v[24:27], v[68:71], v[168:171], v[24:27]
ds_read_b64_tr_b16 v[58:59], v9 offset:50176
v_mfma_f32_16x16x32_bf16 v[40:43], v[64:67], v[164:167], v[40:43]
ds_read_b64_tr_b16 v[60:61], v9 offset:53248
v_mfma_f32_16x16x32_bf16 v[40:43], v[68:71], v[172:175], v[40:43]
ds_read_b64_tr_b16 v[62:63], v9 offset:54272
s_waitcnt lgkmcnt(10)
v_mfma_f32_16x16x32_bf16 v[28:31], v[72:75], v[160:163], v[28:31]
ds_read_b64_tr_b16 v[64:65], v10 offset:49152
s_waitcnt lgkmcnt(9)
v_mfma_f32_16x16x32_bf16 v[28:31], v[76:79], v[168:171], v[28:31]
ds_read_b64_tr_b16 v[66:67], v10 offset:50176
v_mfma_f32_16x16x32_bf16 v[44:47], v[72:75], v[164:167], v[44:47]
ds_read_b64_tr_b16 v[68:69], v10 offset:53248
v_mfma_f32_16x16x32_bf16 v[44:47], v[76:79], v[172:175], v[44:47]
ds_read_b64_tr_b16 v[70:71], v10 offset:54272
s_waitcnt vmcnt(27) lgkmcnt(10)
v_mfma_f32_16x16x32_bf16 v[16:19], v[48:51], v[176:179], v[16:19]
ds_read_b64_tr_b16 v[72:73], v11 offset:49152
buffer_load_dwordx4 v[160:163], v6, s[20:23], s66 offen offset:0 sc1
s_waitcnt vmcnt(27) lgkmcnt(9)
v_mfma_f32_16x16x32_bf16 v[16:19], v[52:55], v[184:187], v[16:19]
ds_read_b64_tr_b16 v[74:75], v11 offset:50176
buffer_load_dwordx4 v[168:171], v6, s[20:23], s66 offen offset:2048 sc1
s_waitcnt vmcnt(27)
v_mfma_f32_16x16x32_bf16 v[32:35], v[48:51], v[180:183], v[32:35]
ds_read_b64_tr_b16 v[76:77], v11 offset:53248
buffer_load_dwordx4 v[164:167], v6, s[20:23], s66 offen offset:256 sc1
s_waitcnt vmcnt(27)
v_mfma_f32_16x16x32_bf16 v[32:35], v[52:55], v[188:191], v[32:35]
ds_read_b64_tr_b16 v[78:79], v11 offset:54272
buffer_load_dwordx4 v[172:175], v6, s[20:23], s66 offen offset:2304 sc1
s_waitcnt lgkmcnt(10)
v_mfma_f32_16x16x32_bf16 v[20:23], v[56:59], v[176:179], v[20:23]
ds_read_b64_tr_b16 v[48:49], v8 offset:57344
s_add_u32 s66, s66, 4096
s_and_b32 s66, s66, 0xffff
s_waitcnt lgkmcnt(9)
v_mfma_f32_16x16x32_bf16 v[20:23], v[60:63], v[184:187], v[20:23]
ds_read_b64_tr_b16 v[50:51], v8 offset:58368
v_mfma_f32_16x16x32_bf16 v[36:39], v[56:59], v[180:183], v[36:39]
ds_read_b64_tr_b16 v[52:53], v8 offset:61440
v_mfma_f32_16x16x32_bf16 v[36:39], v[60:63], v[188:191], v[36:39]
ds_read_b64_tr_b16 v[54:55], v8 offset:62464
s_waitcnt lgkmcnt(10)
v_mfma_f32_16x16x32_bf16 v[24:27], v[64:67], v[176:179], v[24:27]
ds_read_b64_tr_b16 v[56:57], v9 offset:57344
s_waitcnt lgkmcnt(9)
v_mfma_f32_16x16x32_bf16 v[24:27], v[68:71], v[184:187], v[24:27]
ds_read_b64_tr_b16 v[58:59], v9 offset:58368
v_mfma_f32_16x16x32_bf16 v[40:43], v[64:67], v[180:183], v[40:43]
ds_read_b64_tr_b16 v[60:61], v9 offset:61440
v_mfma_f32_16x16x32_bf16 v[40:43], v[68:71], v[188:191], v[40:43]
ds_read_b64_tr_b16 v[62:63], v9 offset:62464
s_waitcnt lgkmcnt(10)
v_mfma_f32_16x16x32_bf16 v[28:31], v[72:75], v[176:179], v[28:31]
ds_read_b64_tr_b16 v[64:65], v10 offset:57344
s_waitcnt lgkmcnt(9)
v_mfma_f32_16x16x32_bf16 v[28:31], v[76:79], v[184:187], v[28:31]
ds_read_b64_tr_b16 v[66:67], v10 offset:58368
v_mfma_f32_16x16x32_bf16 v[44:47], v[72:75], v[180:183], v[44:47]
ds_read_b64_tr_b16 v[68:69], v10 offset:61440
v_mfma_f32_16x16x32_bf16 v[44:47], v[76:79], v[188:191], v[44:47]
ds_read_b64_tr_b16 v[70:71], v10 offset:62464
s_waitcnt vmcnt(27) lgkmcnt(10)
v_mfma_f32_16x16x32_bf16 v[16:19], v[48:51], v[192:195], v[16:19]
ds_read_b64_tr_b16 v[72:73], v11 offset:57344
buffer_load_dwordx4 v[176:179], v6, s[20:23], s66 offen offset:0 sc1
s_waitcnt vmcnt(27) lgkmcnt(9)
v_mfma_f32_16x16x32_bf16 v[16:19], v[52:55], v[200:203], v[16:19]
ds_read_b64_tr_b16 v[74:75], v11 offset:58368
buffer_load_dwordx4 v[184:187], v6, s[20:23], s66 offen offset:2048 sc1
s_waitcnt vmcnt(27)
v_mfma_f32_16x16x32_bf16 v[32:35], v[48:51], v[196:199], v[32:35]
ds_read_b64_tr_b16 v[76:77], v11 offset:61440
buffer_load_dwordx4 v[180:183], v6, s[20:23], s66 offen offset:256 sc1
s_waitcnt vmcnt(27)
v_mfma_f32_16x16x32_bf16 v[32:35], v[52:55], v[204:207], v[32:35]
ds_read_b64_tr_b16 v[78:79], v11 offset:62464
buffer_load_dwordx4 v[188:191], v6, s[20:23], s66 offen offset:2304 sc1
s_waitcnt lgkmcnt(10)
v_mfma_f32_16x16x32_bf16 v[20:23], v[56:59], v[192:195], v[20:23]
ds_read_b64_tr_b16 v[48:49], v12 offset:0
s_add_u32 s66, s66, 4096
s_and_b32 s66, s66, 0xffff
s_waitcnt lgkmcnt(9)
v_mfma_f32_16x16x32_bf16 v[20:23], v[60:63], v[200:203], v[20:23]
ds_read_b64_tr_b16 v[50:51], v12 offset:1024
v_mfma_f32_16x16x32_bf16 v[36:39], v[56:59], v[196:199], v[36:39]
ds_read_b64_tr_b16 v[52:53], v12 offset:4096
v_mfma_f32_16x16x32_bf16 v[36:39], v[60:63], v[204:207], v[36:39]
ds_read_b64_tr_b16 v[54:55], v12 offset:5120
s_waitcnt lgkmcnt(10)
v_mfma_f32_16x16x32_bf16 v[24:27], v[64:67], v[192:195], v[24:27]
ds_read_b64_tr_b16 v[56:57], v13 offset:0
s_waitcnt lgkmcnt(9)
v_mfma_f32_16x16x32_bf16 v[24:27], v[68:71], v[200:203], v[24:27]
ds_read_b64_tr_b16 v[58:59], v13 offset:1024
v_mfma_f32_16x16x32_bf16 v[40:43], v[64:67], v[196:199], v[40:43]
ds_read_b64_tr_b16 v[60:61], v13 offset:4096
v_mfma_f32_16x16x32_bf16 v[40:43], v[68:71], v[204:207], v[40:43]
ds_read_b64_tr_b16 v[62:63], v13 offset:5120
s_waitcnt lgkmcnt(10)
v_mfma_f32_16x16x32_bf16 v[28:31], v[72:75], v[192:195], v[28:31]
ds_read_b64_tr_b16 v[64:65], v14 offset:0
s_waitcnt lgkmcnt(9)
v_mfma_f32_16x16x32_bf16 v[28:31], v[76:79], v[200:203], v[28:31]
ds_read_b64_tr_b16 v[66:67], v14 offset:1024
v_mfma_f32_16x16x32_bf16 v[44:47], v[72:75], v[196:199], v[44:47]
ds_read_b64_tr_b16 v[68:69], v14 offset:4096
v_mfma_f32_16x16x32_bf16 v[44:47], v[76:79], v[204:207], v[44:47]
ds_read_b64_tr_b16 v[70:71], v14 offset:5120
s_waitcnt vmcnt(27) lgkmcnt(10)
v_mfma_f32_16x16x32_bf16 v[16:19], v[48:51], v[80:83], v[16:19]
ds_read_b64_tr_b16 v[72:73], v15 offset:0
buffer_load_dwordx4 v[192:195], v6, s[20:23], s66 offen offset:0 sc1
s_waitcnt vmcnt(27) lgkmcnt(9)
v_mfma_f32_16x16x32_bf16 v[16:19], v[52:55], v[88:91], v[16:19]
ds_read_b64_tr_b16 v[74:75], v15 offset:1024
buffer_load_dwordx4 v[200:203], v6, s[20:23], s66 offen offset:2048 sc1
s_waitcnt vmcnt(27)
v_mfma_f32_16x16x32_bf16 v[32:35], v[48:51], v[84:87], v[32:35]
ds_read_b64_tr_b16 v[76:77], v15 offset:4096
buffer_load_dwordx4 v[196:199], v6, s[20:23], s66 offen offset:256 sc1
s_waitcnt vmcnt(27)
v_mfma_f32_16x16x32_bf16 v[32:35], v[52:55], v[92:95], v[32:35]
ds_read_b64_tr_b16 v[78:79], v15 offset:5120
buffer_load_dwordx4 v[204:207], v6, s[20:23], s66 offen offset:2304 sc1
s_waitcnt lgkmcnt(10)
v_mfma_f32_16x16x32_bf16 v[20:23], v[56:59], v[80:83], v[20:23]
ds_read_b64_tr_b16 v[48:49], v12 offset:8192
s_add_u32 s66, s66, 4096
s_and_b32 s66, s66, 0xffff
s_waitcnt lgkmcnt(9)
v_mfma_f32_16x16x32_bf16 v[20:23], v[60:63], v[88:91], v[20:23]
ds_read_b64_tr_b16 v[50:51], v12 offset:9216
v_mfma_f32_16x16x32_bf16 v[36:39], v[56:59], v[84:87], v[36:39]
ds_read_b64_tr_b16 v[52:53], v12 offset:12288
v_mfma_f32_16x16x32_bf16 v[36:39], v[60:63], v[92:95], v[36:39]
ds_read_b64_tr_b16 v[54:55], v12 offset:13312
s_waitcnt lgkmcnt(10)
v_mfma_f32_16x16x32_bf16 v[24:27], v[64:67], v[80:83], v[24:27]
ds_read_b64_tr_b16 v[56:57], v13 offset:8192
s_waitcnt lgkmcnt(9)
v_mfma_f32_16x16x32_bf16 v[24:27], v[68:71], v[88:91], v[24:27]
ds_read_b64_tr_b16 v[58:59], v13 offset:9216
v_mfma_f32_16x16x32_bf16 v[40:43], v[64:67], v[84:87], v[40:43]
ds_read_b64_tr_b16 v[60:61], v13 offset:12288
v_mfma_f32_16x16x32_bf16 v[40:43], v[68:71], v[92:95], v[40:43]
ds_read_b64_tr_b16 v[62:63], v13 offset:13312
s_waitcnt lgkmcnt(10)
v_mfma_f32_16x16x32_bf16 v[28:31], v[72:75], v[80:83], v[28:31]
ds_read_b64_tr_b16 v[64:65], v14 offset:8192
s_waitcnt lgkmcnt(9)
v_mfma_f32_16x16x32_bf16 v[28:31], v[76:79], v[88:91], v[28:31]
ds_read_b64_tr_b16 v[66:67], v14 offset:9216
v_mfma_f32_16x16x32_bf16 v[44:47], v[72:75], v[84:87], v[44:47]
ds_read_b64_tr_b16 v[68:69], v14 offset:12288
v_mfma_f32_16x16x32_bf16 v[44:47], v[76:79], v[92:95], v[44:47]
ds_read_b64_tr_b16 v[70:71], v14 offset:13312
s_waitcnt vmcnt(27) lgkmcnt(10)
v_mfma_f32_16x16x32_bf16 v[16:19], v[48:51], v[96:99], v[16:19]
ds_read_b64_tr_b16 v[72:73], v15 offset:8192
s_waitcnt vmcnt(26) lgkmcnt(9)
v_mfma_f32_16x16x32_bf16 v[16:19], v[52:55], v[104:107], v[16:19]
ds_read_b64_tr_b16 v[74:75], v15 offset:9216
s_waitcnt vmcnt(25)
v_mfma_f32_16x16x32_bf16 v[32:35], v[48:51], v[100:103], v[32:35]
ds_read_b64_tr_b16 v[76:77], v15 offset:12288
s_waitcnt vmcnt(24)
v_mfma_f32_16x16x32_bf16 v[32:35], v[52:55], v[108:111], v[32:35]
ds_read_b64_tr_b16 v[78:79], v15 offset:13312
s_waitcnt lgkmcnt(10)
v_mfma_f32_16x16x32_bf16 v[20:23], v[56:59], v[96:99], v[20:23]
ds_read_b64_tr_b16 v[48:49], v12 offset:16384
s_waitcnt lgkmcnt(9)
v_mfma_f32_16x16x32_bf16 v[20:23], v[60:63], v[104:107], v[20:23]
ds_read_b64_tr_b16 v[50:51], v12 offset:17408
v_mfma_f32_16x16x32_bf16 v[36:39], v[56:59], v[100:103], v[36:39]
ds_read_b64_tr_b16 v[52:53], v12 offset:20480
v_mfma_f32_16x16x32_bf16 v[36:39], v[60:63], v[108:111], v[36:39]
ds_read_b64_tr_b16 v[54:55], v12 offset:21504
s_waitcnt lgkmcnt(10)
v_mfma_f32_16x16x32_bf16 v[24:27], v[64:67], v[96:99], v[24:27]
ds_read_b64_tr_b16 v[56:57], v13 offset:16384
s_waitcnt lgkmcnt(9)
v_mfma_f32_16x16x32_bf16 v[24:27], v[68:71], v[104:107], v[24:27]
ds_read_b64_tr_b16 v[58:59], v13 offset:17408
v_mfma_f32_16x16x32_bf16 v[40:43], v[64:67], v[100:103], v[40:43]
ds_read_b64_tr_b16 v[60:61], v13 offset:20480
v_mfma_f32_16x16x32_bf16 v[40:43], v[68:71], v[108:111], v[40:43]
ds_read_b64_tr_b16 v[62:63], v13 offset:21504
s_waitcnt lgkmcnt(10)
v_mfma_f32_16x16x32_bf16 v[28:31], v[72:75], v[96:99], v[28:31]
ds_read_b64_tr_b16 v[64:65], v14 offset:16384
s_waitcnt lgkmcnt(9)
v_mfma_f32_16x16x32_bf16 v[28:31], v[76:79], v[104:107], v[28:31]
ds_read_b64_tr_b16 v[66:67], v14 offset:17408
v_mfma_f32_16x16x32_bf16 v[44:47], v[72:75], v[100:103], v[44:47]
ds_read_b64_tr_b16 v[68:69], v14 offset:20480
v_mfma_f32_16x16x32_bf16 v[44:47], v[76:79], v[108:111], v[44:47]
ds_read_b64_tr_b16 v[70:71], v14 offset:21504
s_waitcnt vmcnt(23) lgkmcnt(10)
v_mfma_f32_16x16x32_bf16 v[16:19], v[48:51], v[112:115], v[16:19]
ds_read_b64_tr_b16 v[72:73], v15 offset:16384
s_waitcnt vmcnt(22) lgkmcnt(9)
v_mfma_f32_16x16x32_bf16 v[16:19], v[52:55], v[120:123], v[16:19]
ds_read_b64_tr_b16 v[74:75], v15 offset:17408
s_waitcnt vmcnt(21)
v_mfma_f32_16x16x32_bf16 v[32:35], v[48:51], v[116:119], v[32:35]
ds_read_b64_tr_b16 v[76:77], v15 offset:20480
s_waitcnt vmcnt(20)
v_mfma_f32_16x16x32_bf16 v[32:35], v[52:55], v[124:127], v[32:35]
ds_read_b64_tr_b16 v[78:79], v15 offset:21504
s_waitcnt lgkmcnt(10)
v_mfma_f32_16x16x32_bf16 v[20:23], v[56:59], v[112:115], v[20:23]
ds_read_b64_tr_b16 v[48:49], v12 offset:24576
s_waitcnt lgkmcnt(9)
v_mfma_f32_16x16x32_bf16 v[20:23], v[60:63], v[120:123], v[20:23]
ds_read_b64_tr_b16 v[50:51], v12 offset:25600
v_mfma_f32_16x16x32_bf16 v[36:39], v[56:59], v[116:119], v[36:39]
ds_read_b64_tr_b16 v[52:53], v12 offset:28672
v_mfma_f32_16x16x32_bf16 v[36:39], v[60:63], v[124:127], v[36:39]
ds_read_b64_tr_b16 v[54:55], v12 offset:29696
s_waitcnt lgkmcnt(10)
v_mfma_f32_16x16x32_bf16 v[24:27], v[64:67], v[112:115], v[24:27]
ds_read_b64_tr_b16 v[56:57], v13 offset:24576
s_waitcnt lgkmcnt(9)
v_mfma_f32_16x16x32_bf16 v[24:27], v[68:71], v[120:123], v[24:27]
ds_read_b64_tr_b16 v[58:59], v13 offset:25600
v_mfma_f32_16x16x32_bf16 v[40:43], v[64:67], v[116:119], v[40:43]
ds_read_b64_tr_b16 v[60:61], v13 offset:28672
v_mfma_f32_16x16x32_bf16 v[40:43], v[68:71], v[124:127], v[40:43]
ds_read_b64_tr_b16 v[62:63], v13 offset:29696
s_waitcnt lgkmcnt(10)
v_mfma_f32_16x16x32_bf16 v[28:31], v[72:75], v[112:115], v[28:31]
ds_read_b64_tr_b16 v[64:65], v14 offset:24576
s_waitcnt lgkmcnt(9)
v_mfma_f32_16x16x32_bf16 v[28:31], v[76:79], v[120:123], v[28:31]
ds_read_b64_tr_b16 v[66:67], v14 offset:25600
v_mfma_f32_16x16x32_bf16 v[44:47], v[72:75], v[116:119], v[44:47]
ds_read_b64_tr_b16 v[68:69], v14 offset:28672
v_mfma_f32_16x16x32_bf16 v[44:47], v[76:79], v[124:127], v[44:47]
ds_read_b64_tr_b16 v[70:71], v14 offset:29696
s_waitcnt vmcnt(19) lgkmcnt(10)
v_mfma_f32_16x16x32_bf16 v[16:19], v[48:51], v[128:131], v[16:19]
ds_read_b64_tr_b16 v[72:73], v15 offset:24576
s_waitcnt vmcnt(18) lgkmcnt(9)
v_mfma_f32_16x16x32_bf16 v[16:19], v[52:55], v[136:139], v[16:19]
ds_read_b64_tr_b16 v[74:75], v15 offset:25600
s_waitcnt vmcnt(17)
v_mfma_f32_16x16x32_bf16 v[32:35], v[48:51], v[132:135], v[32:35]
ds_read_b64_tr_b16 v[76:77], v15 offset:28672
s_waitcnt vmcnt(16)
v_mfma_f32_16x16x32_bf16 v[32:35], v[52:55], v[140:143], v[32:35]
ds_read_b64_tr_b16 v[78:79], v15 offset:29696
s_waitcnt lgkmcnt(10)
v_mfma_f32_16x16x32_bf16 v[20:23], v[56:59], v[128:131], v[20:23]
ds_read_b64_tr_b16 v[48:49], v12 offset:32768
s_waitcnt lgkmcnt(9)
v_mfma_f32_16x16x32_bf16 v[20:23], v[60:63], v[136:139], v[20:23]
ds_read_b64_tr_b16 v[50:51], v12 offset:33792
v_mfma_f32_16x16x32_bf16 v[36:39], v[56:59], v[132:135], v[36:39]
ds_read_b64_tr_b16 v[52:53], v12 offset:36864
v_mfma_f32_16x16x32_bf16 v[36:39], v[60:63], v[140:143], v[36:39]
ds_read_b64_tr_b16 v[54:55], v12 offset:37888
s_waitcnt lgkmcnt(10)
v_mfma_f32_16x16x32_bf16 v[24:27], v[64:67], v[128:131], v[24:27]
ds_read_b64_tr_b16 v[56:57], v13 offset:32768
s_waitcnt lgkmcnt(9)
v_mfma_f32_16x16x32_bf16 v[24:27], v[68:71], v[136:139], v[24:27]
ds_read_b64_tr_b16 v[58:59], v13 offset:33792
v_mfma_f32_16x16x32_bf16 v[40:43], v[64:67], v[132:135], v[40:43]
ds_read_b64_tr_b16 v[60:61], v13 offset:36864
v_mfma_f32_16x16x32_bf16 v[40:43], v[68:71], v[140:143], v[40:43]
ds_read_b64_tr_b16 v[62:63], v13 offset:37888
s_waitcnt lgkmcnt(10)
v_mfma_f32_16x16x32_bf16 v[28:31], v[72:75], v[128:131], v[28:31]
ds_read_b64_tr_b16 v[64:65], v14 offset:32768
s_waitcnt lgkmcnt(9)
v_mfma_f32_16x16x32_bf16 v[28:31], v[76:79], v[136:139], v[28:31]
ds_read_b64_tr_b16 v[66:67], v14 offset:33792
v_mfma_f32_16x16x32_bf16 v[44:47], v[72:75], v[132:135], v[44:47]
ds_read_b64_tr_b16 v[68:69], v14 offset:36864
v_mfma_f32_16x16x32_bf16 v[44:47], v[76:79], v[140:143], v[44:47]
ds_read_b64_tr_b16 v[70:71], v14 offset:37888
s_waitcnt vmcnt(15) lgkmcnt(10)
v_mfma_f32_16x16x32_bf16 v[16:19], v[48:51], v[144:147], v[16:19]
ds_read_b64_tr_b16 v[72:73], v15 offset:32768
s_waitcnt vmcnt(14) lgkmcnt(9)
v_mfma_f32_16x16x32_bf16 v[16:19], v[52:55], v[152:155], v[16:19]
ds_read_b64_tr_b16 v[74:75], v15 offset:33792
s_waitcnt vmcnt(13)
v_mfma_f32_16x16x32_bf16 v[32:35], v[48:51], v[148:151], v[32:35]
ds_read_b64_tr_b16 v[76:77], v15 offset:36864
s_waitcnt vmcnt(12)
v_mfma_f32_16x16x32_bf16 v[32:35], v[52:55], v[156:159], v[32:35]
ds_read_b64_tr_b16 v[78:79], v15 offset:37888
s_waitcnt lgkmcnt(10)
v_mfma_f32_16x16x32_bf16 v[20:23], v[56:59], v[144:147], v[20:23]
ds_read_b64_tr_b16 v[48:49], v12 offset:40960
s_waitcnt lgkmcnt(9)
v_mfma_f32_16x16x32_bf16 v[20:23], v[60:63], v[152:155], v[20:23]
ds_read_b64_tr_b16 v[50:51], v12 offset:41984
v_mfma_f32_16x16x32_bf16 v[36:39], v[56:59], v[148:151], v[36:39]
ds_read_b64_tr_b16 v[52:53], v12 offset:45056
v_mfma_f32_16x16x32_bf16 v[36:39], v[60:63], v[156:159], v[36:39]
ds_read_b64_tr_b16 v[54:55], v12 offset:46080
s_waitcnt lgkmcnt(10)
v_mfma_f32_16x16x32_bf16 v[24:27], v[64:67], v[144:147], v[24:27]
ds_read_b64_tr_b16 v[56:57], v13 offset:40960
s_waitcnt lgkmcnt(9)
v_mfma_f32_16x16x32_bf16 v[24:27], v[68:71], v[152:155], v[24:27]
ds_read_b64_tr_b16 v[58:59], v13 offset:41984
v_mfma_f32_16x16x32_bf16 v[40:43], v[64:67], v[148:151], v[40:43]
ds_read_b64_tr_b16 v[60:61], v13 offset:45056
v_mfma_f32_16x16x32_bf16 v[40:43], v[68:71], v[156:159], v[40:43]
ds_read_b64_tr_b16 v[62:63], v13 offset:46080
s_waitcnt lgkmcnt(10)
v_mfma_f32_16x16x32_bf16 v[28:31], v[72:75], v[144:147], v[28:31]
ds_read_b64_tr_b16 v[64:65], v14 offset:40960
s_waitcnt lgkmcnt(9)
v_mfma_f32_16x16x32_bf16 v[28:31], v[76:79], v[152:155], v[28:31]
ds_read_b64_tr_b16 v[66:67], v14 offset:41984
v_mfma_f32_16x16x32_bf16 v[44:47], v[72:75], v[148:151], v[44:47]
ds_read_b64_tr_b16 v[68:69], v14 offset:45056
v_mfma_f32_16x16x32_bf16 v[44:47], v[76:79], v[156:159], v[44:47]
ds_read_b64_tr_b16 v[70:71], v14 offset:46080
s_waitcnt vmcnt(11) lgkmcnt(10)
v_mfma_f32_16x16x32_bf16 v[16:19], v[48:51], v[160:163], v[16:19]
ds_read_b64_tr_b16 v[72:73], v15 offset:40960
s_waitcnt vmcnt(10) lgkmcnt(9)
v_mfma_f32_16x16x32_bf16 v[16:19], v[52:55], v[168:171], v[16:19]
ds_read_b64_tr_b16 v[74:75], v15 offset:41984
s_waitcnt vmcnt(9)
v_mfma_f32_16x16x32_bf16 v[32:35], v[48:51], v[164:167], v[32:35]
ds_read_b64_tr_b16 v[76:77], v15 offset:45056
s_waitcnt vmcnt(8)
v_mfma_f32_16x16x32_bf16 v[32:35], v[52:55], v[172:175], v[32:35]
ds_read_b64_tr_b16 v[78:79], v15 offset:46080
s_waitcnt lgkmcnt(10)
v_mfma_f32_16x16x32_bf16 v[20:23], v[56:59], v[160:163], v[20:23]
ds_read_b64_tr_b16 v[48:49], v12 offset:49152
s_waitcnt lgkmcnt(9)
v_mfma_f32_16x16x32_bf16 v[20:23], v[60:63], v[168:171], v[20:23]
ds_read_b64_tr_b16 v[50:51], v12 offset:50176
v_mfma_f32_16x16x32_bf16 v[36:39], v[56:59], v[164:167], v[36:39]
ds_read_b64_tr_b16 v[52:53], v12 offset:53248
v_mfma_f32_16x16x32_bf16 v[36:39], v[60:63], v[172:175], v[36:39]
ds_read_b64_tr_b16 v[54:55], v12 offset:54272
s_waitcnt lgkmcnt(10)
v_mfma_f32_16x16x32_bf16 v[24:27], v[64:67], v[160:163], v[24:27]
ds_read_b64_tr_b16 v[56:57], v13 offset:49152
s_waitcnt lgkmcnt(9)
v_mfma_f32_16x16x32_bf16 v[24:27], v[68:71], v[168:171], v[24:27]
ds_read_b64_tr_b16 v[58:59], v13 offset:50176
v_mfma_f32_16x16x32_bf16 v[40:43], v[64:67], v[164:167], v[40:43]
ds_read_b64_tr_b16 v[60:61], v13 offset:53248
v_mfma_f32_16x16x32_bf16 v[40:43], v[68:71], v[172:175], v[40:43]
ds_read_b64_tr_b16 v[62:63], v13 offset:54272
s_waitcnt lgkmcnt(10)
v_mfma_f32_16x16x32_bf16 v[28:31], v[72:75], v[160:163], v[28:31]
ds_read_b64_tr_b16 v[64:65], v14 offset:49152
s_waitcnt lgkmcnt(9)
v_mfma_f32_16x16x32_bf16 v[28:31], v[76:79], v[168:171], v[28:31]
ds_read_b64_tr_b16 v[66:67], v14 offset:50176
v_mfma_f32_16x16x32_bf16 v[44:47], v[72:75], v[164:167], v[44:47]
ds_read_b64_tr_b16 v[68:69], v14 offset:53248
v_mfma_f32_16x16x32_bf16 v[44:47], v[76:79], v[172:175], v[44:47]
ds_read_b64_tr_b16 v[70:71], v14 offset:54272
s_waitcnt vmcnt(7) lgkmcnt(10)
v_mfma_f32_16x16x32_bf16 v[16:19], v[48:51], v[176:179], v[16:19]
ds_read_b64_tr_b16 v[72:73], v15 offset:49152
s_waitcnt vmcnt(6) lgkmcnt(9)
v_mfma_f32_16x16x32_bf16 v[16:19], v[52:55], v[184:187], v[16:19]
ds_read_b64_tr_b16 v[74:75], v15 offset:50176
s_waitcnt vmcnt(5)
v_mfma_f32_16x16x32_bf16 v[32:35], v[48:51], v[180:183], v[32:35]
ds_read_b64_tr_b16 v[76:77], v15 offset:53248
s_waitcnt vmcnt(4)
v_mfma_f32_16x16x32_bf16 v[32:35], v[52:55], v[188:191], v[32:35]
ds_read_b64_tr_b16 v[78:79], v15 offset:54272
s_waitcnt lgkmcnt(10)
v_mfma_f32_16x16x32_bf16 v[20:23], v[56:59], v[176:179], v[20:23]
ds_read_b64_tr_b16 v[48:49], v12 offset:57344
s_waitcnt lgkmcnt(9)
v_mfma_f32_16x16x32_bf16 v[20:23], v[60:63], v[184:187], v[20:23]
ds_read_b64_tr_b16 v[50:51], v12 offset:58368
v_mfma_f32_16x16x32_bf16 v[36:39], v[56:59], v[180:183], v[36:39]
ds_read_b64_tr_b16 v[52:53], v12 offset:61440
v_mfma_f32_16x16x32_bf16 v[36:39], v[60:63], v[188:191], v[36:39]
ds_read_b64_tr_b16 v[54:55], v12 offset:62464
s_waitcnt lgkmcnt(10)
v_mfma_f32_16x16x32_bf16 v[24:27], v[64:67], v[176:179], v[24:27]
ds_read_b64_tr_b16 v[56:57], v13 offset:57344
s_waitcnt lgkmcnt(9)
v_mfma_f32_16x16x32_bf16 v[24:27], v[68:71], v[184:187], v[24:27]
ds_read_b64_tr_b16 v[58:59], v13 offset:58368
v_mfma_f32_16x16x32_bf16 v[40:43], v[64:67], v[180:183], v[40:43]
ds_read_b64_tr_b16 v[60:61], v13 offset:61440
v_mfma_f32_16x16x32_bf16 v[40:43], v[68:71], v[188:191], v[40:43]
ds_read_b64_tr_b16 v[62:63], v13 offset:62464
s_waitcnt lgkmcnt(10)
v_mfma_f32_16x16x32_bf16 v[28:31], v[72:75], v[176:179], v[28:31]
ds_read_b64_tr_b16 v[64:65], v14 offset:57344
s_waitcnt lgkmcnt(9)
v_mfma_f32_16x16x32_bf16 v[28:31], v[76:79], v[184:187], v[28:31]
ds_read_b64_tr_b16 v[66:67], v14 offset:58368
v_mfma_f32_16x16x32_bf16 v[44:47], v[72:75], v[180:183], v[44:47]
ds_read_b64_tr_b16 v[68:69], v14 offset:61440
v_mfma_f32_16x16x32_bf16 v[44:47], v[76:79], v[188:191], v[44:47]
ds_read_b64_tr_b16 v[70:71], v14 offset:62464
s_waitcnt vmcnt(3) lgkmcnt(10)
v_mfma_f32_16x16x32_bf16 v[16:19], v[48:51], v[192:195], v[16:19]
ds_read_b64_tr_b16 v[72:73], v15 offset:57344
s_waitcnt vmcnt(2) lgkmcnt(9)
v_mfma_f32_16x16x32_bf16 v[16:19], v[52:55], v[200:203], v[16:19]
ds_read_b64_tr_b16 v[74:75], v15 offset:58368
s_waitcnt vmcnt(1)
v_mfma_f32_16x16x32_bf16 v[32:35], v[48:51], v[196:199], v[32:35]
ds_read_b64_tr_b16 v[76:77], v15 offset:61440
s_waitcnt vmcnt(0)
v_mfma_f32_16x16x32_bf16 v[32:35], v[52:55], v[204:207], v[32:35]
ds_read_b64_tr_b16 v[78:79], v15 offset:62464
s_waitcnt lgkmcnt(10)
v_mfma_f32_16x16x32_bf16 v[20:23], v[56:59], v[192:195], v[20:23]
v_add_u32 v5, s34, 22
s_mov_b64 exec, 1
ds_write_b32 v3, v5
s_mov_b64 exec, -1
s_waitcnt lgkmcnt(9)
v_mfma_f32_16x16x32_bf16 v[20:23], v[60:63], v[200:203], v[20:23]
v_mfma_f32_16x16x32_bf16 v[36:39], v[56:59], v[196:199], v[36:39]
v_mfma_f32_16x16x32_bf16 v[36:39], v[60:63], v[204:207], v[36:39]
s_waitcnt lgkmcnt(7)
v_mfma_f32_16x16x32_bf16 v[24:27], v[64:67], v[192:195], v[24:27]
s_waitcnt lgkmcnt(5)
v_mfma_f32_16x16x32_bf16 v[24:27], v[68:71], v[200:203], v[24:27]
v_mfma_f32_16x16x32_bf16 v[40:43], v[64:67], v[196:199], v[40:43]
v_mfma_f32_16x16x32_bf16 v[40:43], v[68:71], v[204:207], v[40:43]
s_waitcnt lgkmcnt(3)
v_mfma_f32_16x16x32_bf16 v[28:31], v[72:75], v[192:195], v[28:31]
s_waitcnt lgkmcnt(1)
v_mfma_f32_16x16x32_bf16 v[28:31], v[76:79], v[200:203], v[28:31]
v_mfma_f32_16x16x32_bf16 v[44:47], v[72:75], v[196:199], v[44:47]
v_mfma_f32_16x16x32_bf16 v[44:47], v[76:79], v[204:207], v[44:47]
s_lshl2_add_u32 s73, s61, s58
s_lshl4_add_u32 s66, s61, s62
s_lshl2_add_u32 s68, s66, s58
s_lshl_b32 s68, s68, 12
s_add_u32 s68, s68, 26214400
s_lshl_b32 s66, s61, 7
s_add_u32 s66, s66, s62
s_lshl_b32 s66, s66, 7
s_add_u32 s66, s66, 274432
s_lshl_b32 s74, s73, 13
s_add_u32 s74, s74, 524288
s_lshl_b32 s67, s62, 9
s_add_u32 s67, s67, s74
v_lshlrev_b32 v6, 4, v0
s_mov_b32 s69, 0x3f803f80
v_mov_b32 v8, 0
v_mov_b32 v9, 0
v_mov_b32 v10, 0
v_mov_b32 v11, 0
v_mov_b32 v12, 0
v_mov_b32 v13, 0
v_mov_b32 v14, 0
v_dot2c_f32_bf16 v11, s69, v232
v_dot2c_f32_bf16 v11, s69, v233
v_dot2c_f32_bf16 v11, s69, v234
v_dot2c_f32_bf16 v11, s69, v235
v_dot2c_f32_bf16 v11, s69, v236
v_dot2c_f32_bf16 v11, s69, v237
v_dot2c_f32_bf16 v11, s69, v238
v_dot2c_f32_bf16 v11, s69, v239
s_cmp_eq_u32 s63, 0
v_cvt_pk_bf16_f32 v240, v16, v17
v_cvt_pk_bf16_f32 v241, v18, v19
v_cvt_pk_bf16_f32 v242, v20, v21
v_cvt_pk_bf16_f32 v243, v22, v23
v_cvt_pk_bf16_f32 v244, v24, v25
v_cvt_pk_bf16_f32 v245, v26, v27
v_cvt_pk_bf16_f32 v246, v28, v29
v_cvt_pk_bf16_f32 v247, v30, v31
v_cvt_pk_bf16_f32 v248, v32, v33
v_cvt_pk_bf16_f32 v249, v34, v35
v_cvt_pk_bf16_f32 v250, v36, v37
v_cvt_pk_bf16_f32 v251, v38, v39
v_cvt_pk_bf16_f32 v252, v40, v41
v_cvt_pk_bf16_f32 v253, v42, v43
v_cvt_pk_bf16_f32 v254, v44, v45
v_cvt_pk_bf16_f32 v255, v46, v47
s_cselect_b64 exec, -1, 0
buffer_store_dwordx4 v[240:243], v6, s[20:23], s68 offen offset:0 sc1
buffer_store_dwordx4 v[244:247], v6, s[20:23], s68 offen offset:1024 sc1
buffer_store_dwordx4 v[248:251], v6, s[20:23], s68 offen offset:2048 sc1
buffer_store_dwordx4 v[252:255], v6, s[20:23], s68 offen offset:3072 sc1
s_mov_b64 exec, -1
v_dot2c_f32_bf16 v8, s69, v240
v_dot2c_f32_bf16 v9, v240, v240
v_dot2c_f32_bf16 v10, v232, v240
v_dot2c_f32_bf16 v12, s69, v248
v_dot2c_f32_bf16 v13, v248, v248
v_dot2c_f32_bf16 v14, v232, v248
v_dot2c_f32_bf16 v8, s69, v241
v_dot2c_f32_bf16 v9, v241, v241
v_dot2c_f32_bf16 v10, v233, v241
v_dot2c_f32_bf16 v12, s69, v249
v_dot2c_f32_bf16 v13, v249, v249
v_dot2c_f32_bf16 v14, v233, v249
v_dot2c_f32_bf16 v8, s69, v242
v_dot2c_f32_bf16 v9, v242, v242
v_dot2c_f32_bf16 v10, v234, v242
v_dot2c_f32_bf16 v12, s69, v250
v_dot2c_f32_bf16 v13, v250, v250
v_dot2c_f32_bf16 v14, v234, v250
v_dot2c_f32_bf16 v8, s69, v243
v_dot2c_f32_bf16 v9, v243, v243
v_dot2c_f32_bf16 v10, v235, v243
v_dot2c_f32_bf16 v12, s69, v251
v_dot2c_f32_bf16 v13, v251, v251
v_dot2c_f32_bf16 v14, v235, v251
v_dot2c_f32_bf16 v8, s69, v244
v_dot2c_f32_bf16 v9, v244, v244
v_dot2c_f32_bf16 v10, v236, v244
v_dot2c_f32_bf16 v12, s69, v252
v_dot2c_f32_bf16 v13, v252, v252
v_dot2c_f32_bf16 v14, v236, v252
v_dot2c_f32_bf16 v8, s69, v245
v_dot2c_f32_bf16 v9, v245, v245
v_dot2c_f32_bf16 v10, v237, v245
v_dot2c_f32_bf16 v12, s69, v253
v_dot2c_f32_bf16 v13, v253, v253
v_dot2c_f32_bf16 v14, v237, v253
v_dot2c_f32_bf16 v8, s69, v246
v_dot2c_f32_bf16 v9, v246, v246
v_dot2c_f32_bf16 v10, v238, v246
v_dot2c_f32_bf16 v12, s69, v254
v_dot2c_f32_bf16 v13, v254, v254
v_dot2c_f32_bf16 v14, v238, v254
v_dot2c_f32_bf16 v8, s69, v247
v_dot2c_f32_bf16 v9, v247, v247
v_dot2c_f32_bf16 v10, v239, v247
v_dot2c_f32_bf16 v12, s69, v255
v_dot2c_f32_bf16 v13, v255, v255
v_dot2c_f32_bf16 v14, v239, v255
v_mov_b32 v15, v11
v_lshrrev_b32 v7, 5, v0
v_mul_u32_u24 v7, 3584, v7
v_permlane16_swap_b32 v8, v12
v_permlane16_swap_b32 v9, v13
v_permlane16_swap_b32 v10, v14
v_permlane16_swap_b32 v11, v15
v_pk_add_f32 v[8:9], v[8:9], v[12:13]
v_pk_add_f32 v[10:11], v[10:11], v[14:15]
v_mov_b32 v12, v8
v_mov_b32 v13, v9
v_mov_b32 v14, v10
v_mov_b32 v15, v11
v_permlane32_swap_b32 v12, v8
v_permlane32_swap_b32 v13, v9
v_permlane32_swap_b32 v14, v10
v_permlane32_swap_b32 v15, v11
v_pk_add_f32 v[8:9], v[8:9], v[12:13]
v_pk_add_f32 v[10:11], v[10:11], v[14:15]
v_add_u32 v7, v6, v7
v_max_u32 v8, 1, v8
v_max_u32 v9, 1, v9
v_max_u32 v10, 1, v10
v_max_u32 v11, 1, v11
s_mov_b32 exec_hi, 0
buffer_store_dwordx4 v[8:11], v6, s[24:27], s67 offen sc1
s_mov_b32 exec_hi, -1
v_lshlrev_b32 v16, 16, v240
v_and_b32 v17, 0xffff0000, v240
v_lshlrev_b32 v18, 16, v241
v_and_b32 v19, 0xffff0000, v241
v_lshlrev_b32 v20, 16, v242
v_and_b32 v21, 0xffff0000, v242
v_lshlrev_b32 v22, 16, v243
v_and_b32 v23, 0xffff0000, v243
v_lshlrev_b32 v24, 16, v244
v_and_b32 v25, 0xffff0000, v244
v_lshlrev_b32 v26, 16, v245
v_and_b32 v27, 0xffff0000, v245
v_lshlrev_b32 v28, 16, v246
v_and_b32 v29, 0xffff0000, v246
v_lshlrev_b32 v30, 16, v247
v_and_b32 v31, 0xffff0000, v247
v_lshlrev_b32 v32, 16, v248
v_and_b32 v33, 0xffff0000, v248
v_lshlrev_b32 v34, 16, v249
v_and_b32 v35, 0xffff0000, v249
v_lshlrev_b32 v36, 16, v250
v_and_b32 v37, 0xffff0000, v250
v_lshlrev_b32 v38, 16, v251
v_and_b32 v39, 0xffff0000, v251
v_lshlrev_b32 v40, 16, v252
v_and_b32 v41, 0xffff0000, v252
v_lshlrev_b32 v42, 16, v253
v_and_b32 v43, 0xffff0000, v253
v_lshlrev_b32 v44, 16, v254
v_and_b32 v45, 0xffff0000, v254
v_lshlrev_b32 v46, 16, v255
v_and_b32 v47, 0xffff0000, v255
v_and_b32 v14, 15, v0
v_lshlrev_b32 v14, 11, v14
v_bfe_u32 v15, v0, 4, 1
v_lshl_add_u32 v14, v15, 5, v14
v_lshrrev_b32 v15, 5, v0
v_lshl_add_u32 v14, v15, 4, v14
s_lshl2_add_u32 s70, s61, s58
s_lshl_b32 s70, s70, 16
s_lshl_b32 s71, s62, 7
s_add_u32 s70, s70, s71
s_add_u32 s71, s70, 0x8000
s_lshl_b32 s67, s62, 6
s_sub_u32 s68, s66, 2048
s_lshl1_add_u32 s69, s67, s68
s_sub_u32 s69, s69, 10240
s_sub_u32 s72, s68, s67
s_add_u32 s72, s72, 4096
s_lshl_b32 s75, s73, 5
s_add_u32 s75, s75, 1
v_and_b32 v15, 48, v0
v_add_u32 v13, s75, v0
v_lshlrev_b32 v4, 1, v15
s_mov_b64 exec, 1
s_waitcnt vmcnt(1)
buffer_store_dword v212, v3, s[24:27], s66 offen sc1
s_mov_b64 exec, -1
v_add_u32 v5, s34, 23
s_mov_b64 exec, 1
ds_write_b32 v3, v5
s_mov_b64 exec, -1
s_waitcnt vmcnt(1)
poll_139:
buffer_load_dwordx4 v[80:83], v7, s[24:27], s74 offen offset:0 sc1
buffer_load_dwordx4 v[84:87], v7, s[24:27], s74 offen offset:512 sc1
buffer_load_dwordx4 v[88:91], v7, s[24:27], s74 offen offset:1024 sc1
buffer_load_dwordx4 v[92:95], v7, s[24:27], s74 offen offset:1536 sc1
buffer_load_dwordx4 v[96:99], v7, s[24:27], s74 offen offset:2048 sc1
buffer_load_dwordx4 v[100:103], v7, s[24:27], s74 offen offset:2560 sc1
buffer_load_dwordx4 v[104:107], v7, s[24:27], s74 offen offset:3072 sc1
buffer_load_dwordx4 v[108:111], v7, s[24:27], s74 offen offset:3584 sc1
pchk_140:
s_waitcnt vmcnt(7)
v_min3_u32 v8, v80, v81, v82
s_waitcnt vmcnt(6)
v_min3_u32 v8, v8, v83, v84
v_min3_u32 v8, v8, v85, v86
s_waitcnt vmcnt(5)
v_min3_u32 v8, v8, v87, v88
v_min3_u32 v8, v8, v89, v90
s_waitcnt vmcnt(4)
v_min3_u32 v8, v8, v91, v92
v_min3_u32 v8, v8, v93, v94
s_waitcnt vmcnt(3)
v_min3_u32 v8, v8, v95, v96
v_min3_u32 v8, v8, v97, v98
s_waitcnt vmcnt(2)
v_min3_u32 v8, v8, v99, v100
v_min3_u32 v8, v8, v101, v102
s_waitcnt vmcnt(1)
v_min3_u32 v8, v8, v103, v104
v_min3_u32 v8, v8, v105, v106
s_waitcnt vmcnt(0)
v_min3_u32 v8, v8, v107, v108
v_min3_u32 v8, v8, v109, v110
v_min_u32 v8, v8, v111
v_cmp_eq_u32 vcc, 0, v8
s_cbranch_vccz pdone_141
s_sub_u32 s32, s32, 1
s_cmp_gt_i32 s32, 0
s_cbranch_scc1 poll_139
pdone_141:
v_pk_add_f32 v[80:81], v[80:81], v[96:97]
v_pk_add_f32 v[82:83], v[82:83], v[98:99]
v_pk_add_f32 v[84:85], v[84:85], v[100:101]
v_pk_add_f32 v[86:87], v[86:87], v[102:103]
v_pk_add_f32 v[88:89], v[88:89], v[104:105]
v_pk_add_f32 v[90:91], v[90:91], v[106:107]
v_pk_add_f32 v[92:93], v[92:93], v[108:109]
v_pk_add_f32 v[94:95], v[94:95], v[110:111]
v_pk_add_f32 v[80:81], v[80:81], v[88:89]
v_pk_add_f32 v[82:83], v[82:83], v[90:91]
v_pk_add_f32 v[84:85], v[84:85], v[92:93]
v_pk_add_f32 v[86:87], v[86:87], v[94:95]
v_pk_add_f32 v[80:81], v[80:81], v[84:85]
v_pk_add_f32 v[82:83], v[82:83], v[86:87]
v_mov_b32 v8, v80
v_mov_b32 v9, v81
v_mov_b32 v10, v82
v_mov_b32 v11, v83
v_permlane32_swap_b32 v8, v80
v_permlane32_swap_b32 v9, v81
v_permlane32_swap_b32 v10, v82
v_permlane32_swap_b32 v11, v83
v_pk_add_f32 v[8:9], v[8:9], v[80:81]
v_pk_add_f32 v[10:11], v[10:11], v[82:83]
v_mul_f32 v8, 0xba800000, v8
v_mul_f32 v9, 0x3a800000, v9
v_fma_f32 v9, -v8, v8, v9
v_max_f32 v9, 0, v9
v_add_f32 v12, 0x3727c5ac, v9
v_rsq_f32 v80, v12
v_fma_f32 v10, v8, v11, v10
v_mul_f32 v12, v80, v10
v_max_u32 v12, 1, v12
v_add_u32 v7, s34, v3
v_mov_b32 v6, v12
s_nop 1
v_max_f32_dpp v6, v6, v6 row_ror:1 row_mask:0xf bank_mask:0xf
s_nop 1
v_max_f32_dpp v6, v6, v6 row_ror:2 row_mask:0xf bank_mask:0xf
s_nop 1
v_max_f32_dpp v6, v6, v6 row_ror:4 row_mask:0xf bank_mask:0xf
s_nop 1
v_max_f32_dpp v6, v6, v6 row_ror:8 row_mask:0xf bank_mask:0xf
v_mov_b32 v11, v6
s_nop 1
v_permlane16_swap_b32 v11, v6
v_max_f32 v6, v6, v11
v_cmp_eq_f32 vcc, v6, v12
s_ff1_i32_b64 s66, vcc
s_and_b32 s66, s66, 31
s_mov_b64 exec, 1
ds_write_b32 v7, v6 offset:256
s_mov_b64 exec, -1
v_add_u32 v7, s34, v1
v_mul_f32 v81, v8, v80
v_add_f32 v10, 1.0, v80
v_mov_b32 v82, v80
v_mov_b32 v83, v81
s_and_b32 s67, s66, 15
s_lshl_b32 s67, 0x10001, s67
s_bitcmp0_b32 s66, 4
v_permlane16_swap_b32 v80, v82
v_permlane16_swap_b32 v81, v83
s_cselect_b32 s76, s67, 0
s_cselect_b32 s78, 0, s67
s_cselect_b32 s77, s67, 0
s_cselect_b32 s79, 0, s67
s_add_u32 s75, s75, s66
v_pk_fma_f32 v[48:49], v[16:17], v[80:81], v[80:81] op_sel:[0,0,1] op_sel_hi:[1,0,1]
v_pk_fma_f32 v[50:51], v[18:19], v[80:81], v[80:81] op_sel:[0,0,1] op_sel_hi:[1,0,1]
v_pk_fma_f32 v[52:53], v[20:21], v[80:81], v[80:81] op_sel:[0,0,1] op_sel_hi:[1,0,1]
v_pk_fma_f32 v[54:55], v[22:23], v[80:81], v[80:81] op_sel:[0,0,1] op_sel_hi:[1,0,1]
v_pk_fma_f32 v[56:57], v[24:25], v[80:81], v[80:81] op_sel:[0,0,1] op_sel_hi:[1,0,1]
v_pk_fma_f32 v[58:59], v[26:27], v[80:81], v[80:81] op_sel:[0,0,1] op_sel_hi:[1,0,1]
v_pk_fma_f32 v[60:61], v[28:29], v[80:81], v[80:81] op_sel:[0,0,1] op_sel_hi:[1,0,1]
v_pk_fma_f32 v[62:63], v[30:31], v[80:81], v[80:81] op_sel:[0,0,1] op_sel_hi:[1,0,1]
v_pk_fma_f32 v[64:65], v[32:33], v[82:83], v[82:83] op_sel:[0,0,1] op_sel_hi:[1,0,1]
v_pk_fma_f32 v[66:67], v[34:35], v[82:83], v[82:83] op_sel:[0,0,1] op_sel_hi:[1,0,1]
v_pk_fma_f32 v[68:69], v[36:37], v[82:83], v[82:83] op_sel:[0,0,1] op_sel_hi:[1,0,1]
v_pk_fma_f32 v[70:71], v[38:39], v[82:83], v[82:83] op_sel:[0,0,1] op_sel_hi:[1,0,1]
v_pk_fma_f32 v[72:73], v[40:41], v[82:83], v[82:83] op_sel:[0,0,1] op_sel_hi:[1,0,1]
v_pk_fma_f32 v[74:75], v[42:43], v[82:83], v[82:83] op_sel:[0,0,1] op_sel_hi:[1,0,1]
v_pk_fma_f32 v[76:77], v[44:45], v[82:83], v[82:83] op_sel:[0,0,1] op_sel_hi:[1,0,1]
v_pk_fma_f32 v[78:79], v[46:47], v[82:83], v[82:83] op_sel:[0,0,1] op_sel_hi:[1,0,1]
v_cvt_pk_bf16_f32 v84, v48, v49
v_cvt_pk_bf16_f32 v85, v50, v51
v_cvt_pk_bf16_f32 v86, v52, v53
v_cvt_pk_bf16_f32 v87, v54, v55
v_cvt_pk_bf16_f32 v88, v56, v57
v_cvt_pk_bf16_f32 v89, v58, v59
v_cvt_pk_bf16_f32 v90, v60, v61
v_cvt_pk_bf16_f32 v91, v62, v63
v_cvt_pk_bf16_f32 v92, v64, v65
v_cvt_pk_bf16_f32 v93, v66, v67
v_cvt_pk_bf16_f32 v94, v68, v69
v_cvt_pk_bf16_f32 v95, v70, v71
v_cvt_pk_bf16_f32 v96, v72, v73
v_cvt_pk_bf16_f32 v97, v74, v75
v_cvt_pk_bf16_f32 v98, v76, v77
v_cvt_pk_bf16_f32 v99, v78, v79
ds_read_b32 v11, v7 offset:256
v_max_u32 v84, 1, v84
v_max_u32 v85, 1, v85
v_max_u32 v86, 1, v86
v_max_u32 v87, 1, v87
v_max_u32 v88, 1, v88
v_max_u32 v89, 1, v89
v_max_u32 v90, 1, v90
v_max_u32 v91, 1, v91
v_max_u32 v92, 1, v92
v_max_u32 v93, 1, v93
v_max_u32 v94, 1, v94
v_max_u32 v95, 1, v95
v_max_u32 v96, 1, v96
v_max_u32 v97, 1, v97
v_max_u32 v98, 1, v98
v_max_u32 v99, 1, v99
s_branch pchk_143
poll_142:
ds_read_b32 v11, v7 offset:256
pchk_143:
s_waitcnt lgkmcnt(0)
v_cmp_eq_u32 vcc, 0, v11
s_cbranch_vccz pdone_144
s_sub_u32 s32, s32, 1
s_cmp_gt_i32 s32, 0
s_cbranch_scc1 poll_142
pdone_144:
v_cmp_eq_f32 vcc, v11, v6
s_bfm_b32 s67, s58, 0
s_and_b32 s67, s67, vcc_lo
v_cmp_gt_f32 vcc, v11, v6
s_lshl_b32 s66, 1, s66
s_or_b32 s67, s67, vcc_lo
s_cselect_b64 s[76:77], 0, s[76:77]
s_cselect_b64 s[78:79], 0, s[78:79]
s_cselect_b64 exec, 0, s[66:67]
s_bitcmp0_b32 s62, 0
s_cselect_b64 exec, exec, 0
buffer_store_dwordx2 v[12:13], off, s[24:27], s72 sc1
s_mov_b64 exec, s[76:77]
buffer_store_dwordx4 v[84:87], v4, s[24:27], s68 offen offset:0 sc1
buffer_store_dwordx4 v[88:91], v4, s[24:27], s68 offen offset:16 sc1
s_mov_b64 exec, s[78:79]
buffer_store_dwordx4 v[92:95], v4, s[24:27], s68 offen offset:0 sc1
buffer_store_dwordx4 v[96:99], v4, s[24:27], s68 offen offset:16 sc1
s_mov_b64 exec, -1
v_add_u32 v5, s34, 24
s_mov_b64 exec, 1
ds_write_b32 v3, v5
s_mov_b64 exec, -1
v_pk_add_f32 v[16:17], v[16:17], v[48:49]
v_pk_add_f32 v[18:19], v[18:19], v[50:51]
v_pk_add_f32 v[20:21], v[20:21], v[52:53]
v_pk_add_f32 v[22:23], v[22:23], v[54:55]
v_pk_add_f32 v[24:25], v[24:25], v[56:57]
v_pk_add_f32 v[26:27], v[26:27], v[58:59]
v_pk_add_f32 v[28:29], v[28:29], v[60:61]
v_pk_add_f32 v[30:31], v[30:31], v[62:63]
v_pk_add_f32 v[32:33], v[32:33], v[64:65]
v_pk_add_f32 v[34:35], v[34:35], v[66:67]
v_pk_add_f32 v[36:37], v[36:37], v[68:69]
v_pk_add_f32 v[38:39], v[38:39], v[70:71]
v_pk_add_f32 v[40:41], v[40:41], v[72:73]
v_pk_add_f32 v[42:43], v[42:43], v[74:75]
v_pk_add_f32 v[44:45], v[44:45], v[76:77]
v_pk_add_f32 v[46:47], v[46:47], v[78:79]
v_cvt_pk_bf16_f32 v240, v16, v17
v_cvt_pk_bf16_f32 v241, v18, v19
v_cvt_pk_bf16_f32 v242, v20, v21
v_cvt_pk_bf16_f32 v243, v22, v23
v_cvt_pk_bf16_f32 v244, v24, v25
v_cvt_pk_bf16_f32 v245, v26, v27
v_cvt_pk_bf16_f32 v246, v28, v29
v_cvt_pk_bf16_f32 v247, v30, v31
v_cvt_pk_bf16_f32 v248, v32, v33
v_cvt_pk_bf16_f32 v249, v34, v35
v_cvt_pk_bf16_f32 v250, v36, v37
v_cvt_pk_bf16_f32 v251, v38, v39
v_cvt_pk_bf16_f32 v252, v40, v41
v_cvt_pk_bf16_f32 v253, v42, v43
v_cvt_pk_bf16_f32 v254, v44, v45
v_cvt_pk_bf16_f32 v255, v46, v47
v_max_u32 v16, 1, v16
v_max_u32 v17, 1, v17
v_max_u32 v18, 1, v18
v_max_u32 v19, 1, v19
v_max_u32 v20, 1, v20
v_max_u32 v21, 1, v21
v_max_u32 v22, 1, v22
v_max_u32 v23, 1, v23
v_max_u32 v24, 1, v24
v_max_u32 v25, 1, v25
v_max_u32 v26, 1, v26
v_max_u32 v27, 1, v27
v_max_u32 v28, 1, v28
v_max_u32 v29, 1, v29
v_max_u32 v30, 1, v30
v_max_u32 v31, 1, v31
v_max_u32 v32, 1, v32
v_max_u32 v33, 1, v33
v_max_u32 v34, 1, v34
v_max_u32 v35, 1, v35
v_max_u32 v36, 1, v36
v_max_u32 v37, 1, v37
v_max_u32 v38, 1, v38
v_max_u32 v39, 1, v39
v_max_u32 v40, 1, v40
v_max_u32 v41, 1, v41
v_max_u32 v42, 1, v42
v_max_u32 v43, 1, v43
v_max_u32 v44, 1, v44
v_max_u32 v45, 1, v45
v_max_u32 v46, 1, v46
v_max_u32 v47, 1, v47
s_mov_b64 exec, s[76:77]
buffer_store_dwordx4 v[16:19], v15, s[24:27], s69 offen offset:0 sc1
buffer_store_dwordx4 v[20:23], v15, s[24:27], s69 offen offset:64 sc1
buffer_store_dwordx4 v[24:27], v15, s[24:27], s69 offen offset:128 sc1
buffer_store_dwordx4 v[28:31], v15, s[24:27], s69 offen offset:192 sc1
s_mov_b64 exec, s[78:79]
buffer_store_dwordx4 v[32:35], v15, s[24:27], s69 offen offset:0 sc1
buffer_store_dwordx4 v[36:39], v15, s[24:27], s69 offen offset:64 sc1
buffer_store_dwordx4 v[40:43], v15, s[24:27], s69 offen offset:128 sc1
buffer_store_dwordx4 v[44:47], v15, s[24:27], s69 offen offset:192 sc1
s_mov_b64 exec, -1
s_cmp_eq_u32 s63, 0
s_cbranch_scc0 mout_145
v_mul_f32 v11, v10, v10
v_mov_b32 v12, 0x3727c5ac
v_fma_f32 v11, v11, v9, v12
v_rsq_f32 v11, v11
v_lshrrev_b32 v12, 3, v0
v_lshlrev_b32 v12, 6, v12
v_lshl_add_u32 v12, v0, 3, v12
v_mul_f32 v10, v10, v11
v_mul_f32 v11, v8, v10
s_lshl_b32 s66, s61, 5
s_add_u32 s66, s66, s58
s_lshl_b32 s66, s66, 9
s_add_u32 s66, s66, 1675264
v_max_u32 v11, 1, v11
s_cmp_eq_u32 s62, 8
s_cselect_b32 exec_lo, -1, 0
s_mov_b32 exec_hi, 0
buffer_store_dwordx2 v[10:11], v12, s[24:27], s66 offen sc1
s_mov_b64 exec, -1
s_mov_b32 s63, 1
s_mov_b32 s34, 32
s_add_u32 s24, s24, 1409024
s_addc_u32 s25, s25, 0
s_mov_b32 s26, 1409024
s_branch L_mtop
mout_145:
v_permlane16_swap_b32 v240, v242
v_permlane16_swap_b32 v241, v243
v_permlane16_swap_b32 v244, v246
v_permlane16_swap_b32 v245, v247
v_permlane16_swap_b32 v248, v250
v_permlane16_swap_b32 v249, v251
v_permlane16_swap_b32 v252, v254
v_permlane16_swap_b32 v253, v255
s_not_b64 exec, s[76:77]
buffer_store_dwordx4 v[240:243], v14, s[28:31], s70 offen offset:0
buffer_store_dwordx4 v[244:247], v14, s[28:31], s70 offen offset:64
s_not_b64 exec, s[78:79]
buffer_store_dwordx4 v[248:251], v14, s[28:31], s71 offen offset:0
buffer_store_dwordx4 v[252:255], v14, s[28:31], s71 offen offset:64
s_mov_b64 exec, -1
s_or_b32 s66, s76, s78
s_cbranch_scc0 L_end
v_mov_b32 v11, 0
s_add_u32 s35, s34, 4
lw_146:
ds_read_b32 v5, v2 offset:24
s_waitcnt lgkmcnt(0)
v_cmp_gt_i32 vcc, s35, v5
s_cbranch_vccz lwd_147
s_sleep 2
s_sub_u32 s32, s32, 1
s_cmp_gt_i32 s32, 0
s_cbranch_scc1 lw_146
lwd_147:
ds_read_b32 v11, v11 offset:32
s_waitcnt lgkmcnt(0)
v_cmp_eq_u32 vcc, s75, v11
s_cbranch_vccnz L_end
s_mov_b64 exec, s[76:77]
buffer_store_dwordx4 v[240:243], v14, s[28:31], s70 offen offset:0
buffer_store_dwordx4 v[244:247], v14, s[28:31], s70 offen offset:64
s_mov_b64 exec, s[78:79]
buffer_store_dwordx4 v[248:251], v14, s[28:31], s71 offen offset:0
buffer_store_dwordx4 v[252:255], v14, s[28:31], s71 offen offset:64
s_mov_b64 exec, -1
s_branch L_end
mspin_112:
s_cmp_eq_u32 s66, 1
s_cbranch_scc1 mback_113
msp_148:
ds_read_b32 v5, v2 offset:16
s_waitcnt lgkmcnt(0)
v_cmp_ge_u32 vcc, v4, v5
s_cbranch_vccz mback_113
s_sub_u32 s32, s32, 1
s_cmp_gt_i32 s32, 0
s_cbranch_scc1 msp_148
s_branch mback_113
patch_116:
s_bfe_u32 s66, s33, 0x20005
s_lshr_b32 s67, s66, 1
s_xor_b32 s66, s66, s67
s_and_b32 s66, s66, 1
s_cmp_eq_u32 s66, s65
s_cbranch_scc0 pback_117
s_lshl_b32 s67, s67, 5
s_and_b32 s66, s33, 31
s_add_u32 s66, s66, s67
v_and_b32 v10, 15, v0
v_sub_u32 v10, s66, v10
v_lshrrev_b32 v11, 4, v0
v_lshlrev_b32 v11, 2, v11
v_sub_u32 v11, s66, v11
v_cmp_eq_u32 vcc, 0, v10
s_mov_b64 exec, vcc
ds_read_b128 v[16:19], v9 offset:3456
ds_read_b128 v[20:23], v9 offset:3520
ds_read_b128 v[80:83], v9 offset:3328
ds_read_b128 v[84:87], v9 offset:3392
s_mov_b64 exec, -1
v_cmp_eq_u32 vcc, 0, v11
s_mov_b64 exec, vcc
ds_read_b32 v48, v8 offset:3584
ds_read_b32 v52, v8 offset:3648
s_mov_b64 exec, -1
v_cmp_eq_u32 vcc, 1, v11
s_mov_b64 exec, vcc
ds_read_b32 v49, v8 offset:3584
ds_read_b32 v53, v8 offset:3648
s_mov_b64 exec, -1
v_cmp_eq_u32 vcc, 2, v11
s_mov_b64 exec, vcc
ds_read_b32 v50, v8 offset:3584
ds_read_b32 v54, v8 offset:3648
s_mov_b64 exec, -1
v_cmp_eq_u32 vcc, 3, v11
s_mov_b64 exec, vcc
ds_read_b32 v51, v8 offset:3584
ds_read_b32 v55, v8 offset:3648
s_mov_b64 exec, -1
s_waitcnt lgkmcnt(0)
v_cmp_eq_u32 vcc, 16, v10
s_mov_b64 exec, vcc
ds_read_b128 v[24:27], v9 offset:3456
ds_read_b128 v[28:31], v9 offset:3520
ds_read_b128 v[88:91], v9 offset:3328
ds_read_b128 v[92:95], v9 offset:3392
s_mov_b64 exec, -1
v_cmp_eq_u32 vcc, 16, v11
s_mov_b64 exec, vcc
ds_read_b32 v56, v8 offset:3584
ds_read_b32 v60, v8 offset:3648
s_mov_b64 exec, -1
v_cmp_eq_u32 vcc, 17, v11
s_mov_b64 exec, vcc
ds_read_b32 v57, v8 offset:3584
ds_read_b32 v61, v8 offset:3648
s_mov_b64 exec, -1
v_cmp_eq_u32 vcc, 18, v11
s_mov_b64 exec, vcc
ds_read_b32 v58, v8 offset:3584
ds_read_b32 v62, v8 offset:3648
s_mov_b64 exec, -1
v_cmp_eq_u32 vcc, 19, v11
s_mov_b64 exec, vcc
ds_read_b32 v59, v8 offset:3584
ds_read_b32 v63, v8 offset:3648
s_mov_b64 exec, -1
s_waitcnt lgkmcnt(0)
v_cmp_eq_u32 vcc, 32, v10
s_mov_b64 exec, vcc
ds_read_b128 v[32:35], v9 offset:3456
ds_read_b128 v[36:39], v9 offset:3520
ds_read_b128 v[96:99], v9 offset:3328
ds_read_b128 v[100:103], v9 offset:3392
s_mov_b64 exec, -1
v_cmp_eq_u32 vcc, 32, v11
s_mov_b64 exec, vcc
ds_read_b32 v64, v8 offset:3584
ds_read_b32 v68, v8 offset:3648
s_mov_b64 exec, -1
v_cmp_eq_u32 vcc, 33, v11
s_mov_b64 exec, vcc
ds_read_b32 v65, v8 offset:3584
ds_read_b32 v69, v8 offset:3648
s_mov_b64 exec, -1
v_cmp_eq_u32 vcc, 34, v11
s_mov_b64 exec, vcc
ds_read_b32 v66, v8 offset:3584
ds_read_b32 v70, v8 offset:3648
s_mov_b64 exec, -1
v_cmp_eq_u32 vcc, 35, v11
s_mov_b64 exec, vcc
ds_read_b32 v67, v8 offset:3584
ds_read_b32 v71, v8 offset:3648
s_mov_b64 exec, -1
s_waitcnt lgkmcnt(0)
v_cmp_eq_u32 vcc, 48, v10
s_mov_b64 exec, vcc
ds_read_b128 v[40:43], v9 offset:3456
ds_read_b128 v[44:47], v9 offset:3520
ds_read_b128 v[104:107], v9 offset:3328
ds_read_b128 v[108:111], v9 offset:3392
s_mov_b64 exec, -1
v_cmp_eq_u32 vcc, 48, v11
s_mov_b64 exec, vcc
ds_read_b32 v72, v8 offset:3584
ds_read_b32 v76, v8 offset:3648
s_mov_b64 exec, -1
v_cmp_eq_u32 vcc, 49, v11
s_mov_b64 exec, vcc
ds_read_b32 v73, v8 offset:3584
ds_read_b32 v77, v8 offset:3648
s_mov_b64 exec, -1
v_cmp_eq_u32 vcc, 50, v11
s_mov_b64 exec, vcc
ds_read_b32 v74, v8 offset:3584
ds_read_b32 v78, v8 offset:3648
s_mov_b64 exec, -1
v_cmp_eq_u32 vcc, 51, v11
s_mov_b64 exec, vcc
ds_read_b32 v75, v8 offset:3584
ds_read_b32 v79, v8 offset:3648
s_mov_b64 exec, -1
s_waitcnt lgkmcnt(0)
s_branch pback_117
cross_127:
s_cmp_eq_u32 s67, 122880
s_cbranch_scc0 cr2_149
v_add_u32 v5, s34, 18
s_mov_b64 exec, 1
ds_write_b32 v3, v5
s_mov_b64 exec, -1
s_add_u32 s70, s72, 270336
s_mov_b64 exec, 1
s_waitcnt vmcnt(0)
buffer_store_dword v5, v3, s[24:27], s70 offen sc1
s_mov_b64 exec, -1
v_mov_b32 v9, 0xf149f2ca
v_xor_b32 v216, v9, v216
v_xor_b32 v217, v9, v217
v_xor_b32 v218, v9, v218
v_xor_b32 v219, v9, v219
v_xor_b32 v220, v9, v220
v_xor_b32 v221, v9, v221
v_xor_b32 v222, v9, v222
v_xor_b32 v223, v9, v223
v_xor_b32 v224, v9, v224
v_xor_b32 v225, v9, v225
v_xor_b32 v226, v9, v226
v_xor_b32 v227, v9, v227
v_xor_b32 v228, v9, v228
v_xor_b32 v229, v9, v229
v_xor_b32 v230, v9, v230
v_xor_b32 v231, v9, v231
s_mov_b32 s67, 90112
s_cmp_eq_u32 s63, 0
s_cbranch_scc0 cr3_150
v_and_b32 v9, 15, v0
v_lshlrev_b32 v9, 11, v9
v_bfe_u32 v10, v0, 4, 1
v_lshl_add_u32 v9, v10, 5, v9
v_lshrrev_b32 v10, 5, v0
v_lshl_add_u32 v9, v10, 4, v9
s_lshl2_add_u32 s70, s61, s58
s_lshl_b32 s70, s70, 16
s_lshl_b32 s71, s62, 7
s_add_u32 s70, s70, s71
s_add_u32 s71, s70, 0x8000
buffer_load_dwordx4 v[240:243], v9, s[8:11], s70 offen offset:0
buffer_load_dwordx4 v[244:247], v9, s[8:11], s70 offen offset:64
buffer_load_dwordx4 v[248:251], v9, s[8:11], s71 offen offset:0
buffer_load_dwordx4 v[252:255], v9, s[8:11], s71 offen offset:64
cr3_150:
s_cmp_eq_u32 s59, 0
s_cbranch_scc1 cback_128
v_mov_b32 v9, 0
s_add_u32 s35, s34, 17
lw_151:
ds_read_b32 v5, v9 offset:16
s_waitcnt lgkmcnt(0)
v_cmp_gt_i32 vcc, s35, v5
s_cbranch_vccz lwd_152
s_sub_u32 s32, s32, 1
s_cmp_gt_i32 s32, 0
s_cbranch_scc1 lw_151
lwd_152:
s_branch cback_128
cr2_149:
v_add_u32 v5, s34, 19
s_mov_b64 exec, 1
ds_write_b32 v3, v5
s_mov_b64 exec, -1
s_mov_b32 s66, 28672
s_cmp_lt_u32 s59, 2
s_cbranch_scc1 cback_128
s_add_u32 s35, s34, 17
lw_153:
ds_read_b32 v5, v2 offset:16
s_waitcnt lgkmcnt(0)
v_cmp_gt_i32 vcc, s35, v5
s_cbranch_vccz lwd_154
s_sub_u32 s32, s32, 1
s_cmp_gt_i32 s32, 0
s_cbranch_scc1 lw_153
lwd_154:
s_branch cback_128
cross_129:
s_cmp_eq_u32 s67, 122880
s_cbranch_scc0 cr2_155
v_add_u32 v5, s34, 18
s_mov_b64 exec, 1
ds_write_b32 v3, v5
s_mov_b64 exec, -1
s_add_u32 s70, s72, 270336
s_mov_b64 exec, 1
s_waitcnt vmcnt(0)
buffer_store_dword v5, v3, s[24:27], s70 offen sc1
s_mov_b64 exec, -1
v_mov_b32 v9, 0xf149f2ca
v_xor_b32 v216, v9, v216
v_xor_b32 v217, v9, v217
v_xor_b32 v218, v9, v218
v_xor_b32 v219, v9, v219
v_xor_b32 v220, v9, v220
v_xor_b32 v221, v9, v221
v_xor_b32 v222, v9, v222
v_xor_b32 v223, v9, v223
v_xor_b32 v224, v9, v224
v_xor_b32 v225, v9, v225
v_xor_b32 v226, v9, v226
v_xor_b32 v227, v9, v227
v_xor_b32 v228, v9, v228
v_xor_b32 v229, v9, v229
v_xor_b32 v230, v9, v230
v_xor_b32 v231, v9, v231
s_mov_b32 s67, 90112
s_cmp_eq_u32 s63, 0
s_cbranch_scc0 cr3_156
v_and_b32 v9, 15, v0
v_lshlrev_b32 v9, 11, v9
v_bfe_u32 v10, v0, 4, 1
v_lshl_add_u32 v9, v10, 5, v9
v_lshrrev_b32 v10, 5, v0
v_lshl_add_u32 v9, v10, 4, v9
s_lshl2_add_u32 s70, s61, s58
s_lshl_b32 s70, s70, 16
s_lshl_b32 s71, s62, 7
s_add_u32 s70, s70, s71
s_add_u32 s71, s70, 0x8000
buffer_load_dwordx4 v[240:243], v9, s[8:11], s70 offen offset:0
buffer_load_dwordx4 v[244:247], v9, s[8:11], s70 offen offset:64
buffer_load_dwordx4 v[248:251], v9, s[8:11], s71 offen offset:0
buffer_load_dwordx4 v[252:255], v9, s[8:11], s71 offen offset:64
cr3_156:
s_cmp_eq_u32 s59, 0
s_cbranch_scc1 cback_130
v_mov_b32 v9, 0
s_add_u32 s35, s34, 17
lw_157:
ds_read_b32 v5, v9 offset:16
s_waitcnt lgkmcnt(0)
v_cmp_gt_i32 vcc, s35, v5
s_cbranch_vccz lwd_158
s_sub_u32 s32, s32, 1
s_cmp_gt_i32 s32, 0
s_cbranch_scc1 lw_157
lwd_158:
s_branch cback_130
cr2_155:
v_add_u32 v5, s34, 19
s_mov_b64 exec, 1
ds_write_b32 v3, v5
s_mov_b64 exec, -1
s_mov_b32 s66, 28672
s_cmp_lt_u32 s59, 2
s_cbranch_scc1 cback_130
s_add_u32 s35, s34, 17
lw_159:
ds_read_b32 v5, v2 offset:16
s_waitcnt lgkmcnt(0)
v_cmp_gt_i32 vcc, s35, v5
s_cbranch_vccz lwd_160
s_sub_u32 s32, s32, 1
s_cmp_gt_i32 s32, 0
s_cbranch_scc1 lw_159
lwd_160:
s_branch cback_130
slow_131:
s_add_u32 s70, s72, 270336
poll_161:
buffer_load_dword v10, v1, s[24:27], s70 offen sc1
pchk_162:
s_waitcnt vmcnt(0)
v_cmp_eq_u32 vcc, 0, v10
s_cbranch_vccz pdone_163
s_sub_u32 s32, s32, 1
s_cmp_gt_i32 s32, 0
s_cbranch_scc1 poll_161
pdone_163:
s_lshl_b32 s73, s60, 15
s_lshl_b32 s74, s63, 23
s_add_u32 s73, s73, s74
s_add_u32 s73, s73, 1048576
v_mov_b32 v10, 0xf149f2ca
v_mov_b32 v11, 0
v_mov_b32 v192, 0
v_mov_b32 v193, 0
v_mov_b32 v194, 0
v_mov_b32 v195, 0
v_mov_b32 v196, 0
v_mov_b32 v197, 0
v_mov_b32 v198, 0
v_mov_b32 v199, 0
v_mov_b32 v200, 0
v_mov_b32 v201, 0
v_mov_b32 v202, 0
v_mov_b32 v203, 0
v_mov_b32 v204, 0
v_mov_b32 v205, 0
v_mov_b32 v206, 0
v_mov_b32 v207, 0
v_mov_b32 v208, 0
v_mov_b32 v209, 0
v_mov_b32 v210, 0
v_mov_b32 v211, 0
s_lshl2_add_u32 s74, s59, s65
s_mov_b32 s75, 0
sl_164:
s_lshr_b32 s76, s74, 2
s_lshl_b32 s76, s76, 19
s_and_b32 s77, s74, 3
s_lshl_b32 s77, s77, 13
s_add_u32 s76, s76, s77
s_add_u32 s76, s76, s73
buffer_load_dwordx4 v[152:155], v6, s[20:23], s76 offen offset:0 sc1
buffer_load_dwordx4 v[156:159], v6, s[20:23], s76 offen offset:1024 sc1
s_cmp_eq_u32 s75, 0
s_cselect_b32 s76, 0xf149f2ca, 0
s_and_b32 s77, s75, 7
s_cselect_b32 s77, 0, -1
v_xor_b32 v112, s76, v216
v_and_b32 v112, s77, v112
v_xor_b32 v113, s76, v217
v_and_b32 v113, s77, v113
v_xor_b32 v114, s76, v218
v_and_b32 v114, s77, v114
v_xor_b32 v115, s76, v219
v_and_b32 v115, s77, v115
v_xor_b32 v116, s76, v220
v_and_b32 v116, s77, v116
v_xor_b32 v117, s76, v221
v_and_b32 v117, s77, v117
v_xor_b32 v118, s76, v222
v_and_b32 v118, s77, v118
v_xor_b32 v119, s76, v223
v_and_b32 v119, s77, v119
v_xor_b32 v120, s76, v224
v_and_b32 v120, s77, v120
v_xor_b32 v121, s76, v225
v_and_b32 v121, s77, v121
v_xor_b32 v122, s76, v226
v_and_b32 v122, s77, v122
v_xor_b32 v123, s76, v227
v_and_b32 v123, s77, v123
v_xor_b32 v124, s76, v228
v_and_b32 v124, s77, v124
v_xor_b32 v125, s76, v229
v_and_b32 v125, s77, v125
v_xor_b32 v126, s76, v230
v_and_b32 v126, s77, v126
v_xor_b32 v127, s76, v231
v_and_b32 v127, s77, v127
s_waitcnt vmcnt(1)
s_nop 0
v_mfma_f32_32x32x16_bf16 v[112:127], v[152:155], v[80:83], v[112:127]
s_waitcnt vmcnt(0)
v_mfma_f32_32x32x16_bf16 v[112:127], v[156:159], v[88:91], v[112:127]
s_nop 11
v_max3_f32 v10, v10, v112, v113
v_max3_f32 v10, v10, v114, v115
v_max3_f32 v10, v10, v116, v117
v_max3_f32 v10, v10, v118, v119
v_max3_f32 v10, v10, v120, v121
v_max3_f32 v10, v10, v122, v123
v_max3_f32 v10, v10, v124, v125
v_max3_f32 v10, v10, v126, v127
s_add_u32 s75, s75, 1
s_sub_u32 s74, s74, 1
s_cselect_b32 s75, 9, s75
s_cmp_lt_u32 s75, 9
s_cbranch_scc1 sl_164
v_mov_b32 v11, v10
s_nop 1
v_permlane32_swap_b32 v11, v10
v_max_f32 v10, v10, v11
s_lshl2_add_u32 s74, s59, s65
s_mov_b32 s75, 0
sl_165:
s_lshr_b32 s76, s74, 2
s_lshl_b32 s76, s76, 19
s_and_b32 s77, s74, 3
s_lshl_b32 s77, s77, 13
s_add_u32 s76, s76, s77
s_add_u32 s76, s76, s73
buffer_load_dwordx4 v[152:155], v6, s[20:23], s76 offen offset:0 sc1
buffer_load_dwordx4 v[156:159], v6, s[20:23], s76 offen offset:1024 sc1
buffer_load_dwordx4 v[160:163], v6, s[20:23], s76 offen offset:2048 sc1
buffer_load_dwordx4 v[164:167], v6, s[20:23], s76 offen offset:3072 sc1
s_cmp_eq_u32 s75, 0
s_cselect_b32 s76, 0xf149f2ca, 0
s_and_b32 s77, s75, 7
s_cselect_b32 s77, 0, -1
v_xor_b32 v112, s76, v216
v_and_b32 v112, s77, v112
v_sub_f32 v112, v112, v10
v_xor_b32 v113, s76, v217
v_and_b32 v113, s77, v113
v_sub_f32 v113, v113, v10
v_xor_b32 v114, s76, v218
v_and_b32 v114, s77, v114
v_sub_f32 v114, v114, v10
v_xor_b32 v115, s76, v219
v_and_b32 v115, s77, v115
v_sub_f32 v115, v115, v10
v_xor_b32 v116, s76, v220
v_and_b32 v116, s77, v116
v_sub_f32 v116, v116, v10
v_xor_b32 v117, s76, v221
v_and_b32 v117, s77, v117
v_sub_f32 v117, v117, v10
v_xor_b32 v118, s76, v222
v_and_b32 v118, s77, v118
v_sub_f32 v118, v118, v10
v_xor_b32 v119, s76, v223
v_and_b32 v119, s77, v119
v_sub_f32 v119, v119, v10
v_xor_b32 v120, s76, v224
v_and_b32 v120, s77, v120
v_sub_f32 v120, v120, v10
v_xor_b32 v121, s76, v225
v_and_b32 v121, s77, v121
v_sub_f32 v121, v121, v10
v_xor_b32 v122, s76, v226
v_and_b32 v122, s77, v122
v_sub_f32 v122, v122, v10
v_xor_b32 v123, s76, v227
v_and_b32 v123, s77, v123
v_sub_f32 v123, v123, v10
v_xor_b32 v124, s76, v228
v_and_b32 v124, s77, v124
v_sub_f32 v124, v124, v10
v_xor_b32 v125, s76, v229
v_and_b32 v125, s77, v125
v_sub_f32 v125, v125, v10
v_xor_b32 v126, s76, v230
v_and_b32 v126, s77, v126
v_sub_f32 v126, v126, v10
v_xor_b32 v127, s76, v231
v_and_b32 v127, s77, v127
v_sub_f32 v127, v127, v10
s_waitcnt vmcnt(3)
s_nop 0
v_mfma_f32_32x32x16_bf16 v[112:127], v[152:155], v[80:83], v[112:127]
s_waitcnt vmcnt(2)
v_mfma_f32_32x32x16_bf16 v[112:127], v[156:159], v[88:91], v[112:127]
s_nop 11
v_exp_f32 v112, v112
v_exp_f32 v113, v113
v_exp_f32 v114, v114
v_exp_f32 v115, v115
v_exp_f32 v116, v116
v_exp_f32 v117, v117
v_exp_f32 v118, v118
v_exp_f32 v119, v119
v_exp_f32 v120, v120
v_exp_f32 v121, v121
v_exp_f32 v122, v122
v_exp_f32 v123, v123
v_exp_f32 v124, v124
v_exp_f32 v125, v125
v_exp_f32 v126, v126
v_exp_f32 v127, v127
v_cvt_pk_bf16_f32 v144, v112, v113
v_cvt_pk_bf16_f32 v145, v114, v115
v_cvt_pk_bf16_f32 v146, v116, v117
v_cvt_pk_bf16_f32 v147, v118, v119
v_cvt_pk_bf16_f32 v148, v120, v121
v_cvt_pk_bf16_f32 v149, v122, v123
v_cvt_pk_bf16_f32 v150, v124, v125
v_cvt_pk_bf16_f32 v151, v126, v127
s_waitcnt vmcnt(1)
v_mfma_f32_32x32x16_bf16 v[192:207], v[160:163], v[144:147], v[192:207]
v_mfma_f32_16x16x32_bf16 v[208:211], v[212:215], v[144:147], v[208:211]
s_waitcnt vmcnt(0)
v_mfma_f32_32x32x16_bf16 v[192:207], v[164:167], v[148:151], v[192:207]
v_mfma_f32_16x16x32_bf16 v[208:211], v[212:215], v[148:151], v[208:211]
s_add_u32 s75, s75, 1
s_sub_u32 s74, s74, 1
s_cselect_b32 s75, 9, s75
s_cmp_lt_u32 s75, 9
s_cbranch_scc1 sl_165
v_mov_b32 v10, 0xf149f2ca
v_mov_b32 v11, 0
v_mov_b32 v16, 0
v_mov_b32 v17, 0
v_mov_b32 v18, 0
v_mov_b32 v19, 0
v_mov_b32 v20, 0
v_mov_b32 v21, 0
v_mov_b32 v22, 0
v_mov_b32 v23, 0
v_mov_b32 v24, 0
v_mov_b32 v25, 0
v_mov_b32 v26, 0
v_mov_b32 v27, 0
v_mov_b32 v28, 0
v_mov_b32 v29, 0
v_mov_b32 v30, 0
v_mov_b32 v31, 0
v_mov_b32 v32, 0
v_mov_b32 v33, 0
v_mov_b32 v34, 0
v_mov_b32 v35, 0
s_sub_u32 s74, 3, s65
s_lshl2_add_u32 s74, s59, s74
s_mov_b32 s75, 0
sl_166:
s_lshr_b32 s76, s74, 2
s_lshl_b32 s76, s76, 19
s_and_b32 s77, s74, 3
s_lshl_b32 s77, s77, 13
s_add_u32 s76, s76, s77
s_add_u32 s76, s76, s73
buffer_load_dwordx4 v[152:155], v6, s[20:23], s76 offen offset:0 sc1
buffer_load_dwordx4 v[156:159], v6, s[20:23], s76 offen offset:1024 sc1
s_cmp_eq_u32 s75, 0
s_cselect_b32 s76, 0xf149f2ca, 0
s_and_b32 s77, s75, 7
s_cselect_b32 s77, 0, -1
v_xor_b32 v112, s76, v216
v_and_b32 v112, s77, v112
v_xor_b32 v113, s76, v217
v_and_b32 v113, s77, v113
v_xor_b32 v114, s76, v218
v_and_b32 v114, s77, v114
v_xor_b32 v115, s76, v219
v_and_b32 v115, s77, v115
v_xor_b32 v116, s76, v220
v_and_b32 v116, s77, v116
v_xor_b32 v117, s76, v221
v_and_b32 v117, s77, v117
v_xor_b32 v118, s76, v222
v_and_b32 v118, s77, v118
v_xor_b32 v119, s76, v223
v_and_b32 v119, s77, v119
v_xor_b32 v120, s76, v224
v_and_b32 v120, s77, v120
v_xor_b32 v121, s76, v225
v_and_b32 v121, s77, v121
v_xor_b32 v122, s76, v226
v_and_b32 v122, s77, v122
v_xor_b32 v123, s76, v227
v_and_b32 v123, s77, v123
v_xor_b32 v124, s76, v228
v_and_b32 v124, s77, v124
v_xor_b32 v125, s76, v229
v_and_b32 v125, s77, v125
v_xor_b32 v126, s76, v230
v_and_b32 v126, s77, v126
v_xor_b32 v127, s76, v231
v_and_b32 v127, s77, v127
s_waitcnt vmcnt(1)
s_nop 0
v_mfma_f32_32x32x16_bf16 v[112:127], v[152:155], v[96:99], v[112:127]
s_waitcnt vmcnt(0)
v_mfma_f32_32x32x16_bf16 v[112:127], v[156:159], v[104:107], v[112:127]
s_nop 11
v_max3_f32 v10, v10, v112, v113
v_max3_f32 v10, v10, v114, v115
v_max3_f32 v10, v10, v116, v117
v_max3_f32 v10, v10, v118, v119
v_max3_f32 v10, v10, v120, v121
v_max3_f32 v10, v10, v122, v123
v_max3_f32 v10, v10, v124, v125
v_max3_f32 v10, v10, v126, v127
s_add_u32 s75, s75, 1
s_sub_u32 s74, s74, 1
s_cselect_b32 s75, 9, s75
s_cmp_lt_u32 s75, 9
s_cbranch_scc1 sl_166
v_mov_b32 v11, v10
s_nop 1
v_permlane32_swap_b32 v11, v10
v_max_f32 v10, v10, v11
s_sub_u32 s74, 3, s65
s_lshl2_add_u32 s74, s59, s74
s_mov_b32 s75, 0
sl_167:
s_lshr_b32 s76, s74, 2
s_lshl_b32 s76, s76, 19
s_and_b32 s77, s74, 3
s_lshl_b32 s77, s77, 13
s_add_u32 s76, s76, s77
s_add_u32 s76, s76, s73
buffer_load_dwordx4 v[152:155], v6, s[20:23], s76 offen offset:0 sc1
buffer_load_dwordx4 v[156:159], v6, s[20:23], s76 offen offset:1024 sc1
buffer_load_dwordx4 v[160:163], v6, s[20:23], s76 offen offset:2048 sc1
buffer_load_dwordx4 v[164:167], v6, s[20:23], s76 offen offset:3072 sc1
s_cmp_eq_u32 s75, 0
s_cselect_b32 s76, 0xf149f2ca, 0
s_and_b32 s77, s75, 7
s_cselect_b32 s77, 0, -1
v_xor_b32 v112, s76, v216
v_and_b32 v112, s77, v112
v_sub_f32 v112, v112, v10
v_xor_b32 v113, s76, v217
v_and_b32 v113, s77, v113
v_sub_f32 v113, v113, v10
v_xor_b32 v114, s76, v218
v_and_b32 v114, s77, v114
v_sub_f32 v114, v114, v10
v_xor_b32 v115, s76, v219
v_and_b32 v115, s77, v115
v_sub_f32 v115, v115, v10
v_xor_b32 v116, s76, v220
v_and_b32 v116, s77, v116
v_sub_f32 v116, v116, v10
v_xor_b32 v117, s76, v221
v_and_b32 v117, s77, v117
v_sub_f32 v117, v117, v10
v_xor_b32 v118, s76, v222
v_and_b32 v118, s77, v118
v_sub_f32 v118, v118, v10
v_xor_b32 v119, s76, v223
v_and_b32 v119, s77, v119
v_sub_f32 v119, v119, v10
v_xor_b32 v120, s76, v224
v_and_b32 v120, s77, v120
v_sub_f32 v120, v120, v10
v_xor_b32 v121, s76, v225
v_and_b32 v121, s77, v121
v_sub_f32 v121, v121, v10
v_xor_b32 v122, s76, v226
v_and_b32 v122, s77, v122
v_sub_f32 v122, v122, v10
v_xor_b32 v123, s76, v227
v_and_b32 v123, s77, v123
v_sub_f32 v123, v123, v10
v_xor_b32 v124, s76, v228
v_and_b32 v124, s77, v124
v_sub_f32 v124, v124, v10
v_xor_b32 v125, s76, v229
v_and_b32 v125, s77, v125
v_sub_f32 v125, v125, v10
v_xor_b32 v126, s76, v230
v_and_b32 v126, s77, v126
v_sub_f32 v126, v126, v10
v_xor_b32 v127, s76, v231
v_and_b32 v127, s77, v127
v_sub_f32 v127, v127, v10
s_waitcnt vmcnt(3)
s_nop 0
v_mfma_f32_32x32x16_bf16 v[112:127], v[152:155], v[96:99], v[112:127]
s_waitcnt vmcnt(2)
v_mfma_f32_32x32x16_bf16 v[112:127], v[156:159], v[104:107], v[112:127]
s_nop 11
v_exp_f32 v112, v112
v_exp_f32 v113, v113
v_exp_f32 v114, v114
v_exp_f32 v115, v115
v_exp_f32 v116, v116
v_exp_f32 v117, v117
v_exp_f32 v118, v118
v_exp_f32 v119, v119
v_exp_f32 v120, v120
v_exp_f32 v121, v121
v_exp_f32 v122, v122
v_exp_f32 v123, v123
v_exp_f32 v124, v124
v_exp_f32 v125, v125
v_exp_f32 v126, v126
v_exp_f32 v127, v127
v_cvt_pk_bf16_f32 v144, v112, v113
v_cvt_pk_bf16_f32 v145, v114, v115
v_cvt_pk_bf16_f32 v146, v116, v117
v_cvt_pk_bf16_f32 v147, v118, v119
v_cvt_pk_bf16_f32 v148, v120, v121
v_cvt_pk_bf16_f32 v149, v122, v123
v_cvt_pk_bf16_f32 v150, v124, v125
v_cvt_pk_bf16_f32 v151, v126, v127
s_waitcnt vmcnt(1)
v_mfma_f32_32x32x16_bf16 v[16:31], v[160:163], v[144:147], v[16:31]
v_mfma_f32_16x16x32_bf16 v[32:35], v[212:215], v[144:147], v[32:35]
s_waitcnt vmcnt(0)
v_mfma_f32_32x32x16_bf16 v[16:31], v[164:167], v[148:151], v[16:31]
v_mfma_f32_16x16x32_bf16 v[32:35], v[212:215], v[148:151], v[32:35]
s_add_u32 s75, s75, 1
s_sub_u32 s74, s74, 1
s_cselect_b32 s75, 9, s75
s_cmp_lt_u32 s75, 9
s_cbranch_scc1 sl_167
s_branch sback_132
mo_135:
s_lshr_b32 s67, s33, 5
s_cmp_eq_u32 s67, s66
s_cbranch_scc0 mo_136
s_and_b32 s67, s33, 31
v_sub_u32 v48, s67, v48
v_lshlrev_b32 v49, 4, v49
s_lshl_b32 s67, s62, 14
s_add_u32 s67, s67, 30686208
poll_168:
buffer_load_dwordx4 v[56:59], v49, s[20:23], s67 offen offset:0 sc1
buffer_load_dwordx4 v[60:63], v49, s[20:23], s67 offen offset:64 sc1
pchk_169:
s_waitcnt vmcnt(1)
v_min3_u32 v50, v56, v57, v58
s_waitcnt vmcnt(0)
v_min3_u32 v50, v50, v59, v60
v_min3_u32 v50, v50, v61, v62
v_min_u32 v50, v50, v63
v_cmp_eq_u32 vcc, 0, v50
s_cbranch_vccz pdone_170
s_sub_u32 s32, s32, 1
s_cmp_gt_i32 s32, 0
s_cbranch_scc1 poll_168
pdone_170:
v_cmp_eq_u32 vcc, 0, v48
s_nop 1
v_cndmask_b32 v240, v240, v56, vcc
v_cndmask_b32 v241, v241, v57, vcc
v_cndmask_b32 v242, v242, v58, vcc
v_cndmask_b32 v243, v243, v59, vcc
v_cndmask_b32 v244, v244, v60, vcc
v_cndmask_b32 v245, v245, v61, vcc
v_cndmask_b32 v246, v246, v62, vcc
v_cndmask_b32 v247, v247, v63, vcc
v_cmp_eq_u32 vcc, 16, v48
s_nop 1
v_cndmask_b32 v248, v248, v56, vcc
v_cndmask_b32 v249, v249, v57, vcc
v_cndmask_b32 v250, v250, v58, vcc
v_cndmask_b32 v251, v251, v59, vcc
v_cndmask_b32 v252, v252, v60, vcc
v_cndmask_b32 v253, v253, v61, vcc
v_cndmask_b32 v254, v254, v62, vcc
v_cndmask_b32 v255, v255, v63, vcc
s_branch mo_136
L_end:
L_fin:
s_endpgm
.section .rodata,"a"
.p2align 6
.amdhsa_kernel interleave_layers__sliding_block__moe_arch_mod__prompt_kernel
  .amdhsa_next_free_vgpr 256
  .amdhsa_next_free_sgpr 102
  .amdhsa_accum_offset 256
  .amdhsa_group_segment_fixed_size 0
  .amdhsa_kernarg_size 88
  .amdhsa_user_sgpr_count 2
  .amdhsa_user_sgpr_kernarg_segment_ptr 1
  .amdhsa_system_sgpr_workgroup_id_x 1
  .amdhsa_float_denorm_mode_32 3
.end_amdhsa_kernel
```

```asm
; @launch grid=(256,1,1) block=(512,1,1) lds=163840
.amdgcn_target "amdgcn-amd-amdhsa--gfx950"
.text
.globl interleave_layers__sliding_block__moe_arch_mod__prompt_kernel
.p2align 8
.type interleave_layers__sliding_block__moe_arch_mod__prompt_kernel,@function
interleave_layers__sliding_block__moe_arch_mod__prompt_kernel:
s_cmp_ge_u32 s2, 256
s_cbranch_scc1 L_fin
s_load_dwordx16 s[36:51], s[0:1], 0
s_load_dwordx4 s[52:55], s[0:1], 64
s_load_dwordx2 s[56:57], s[0:1], 80
v_lshrrev_b32 v1, 6, v0
v_and_b32 v0, 63, v0
s_and_b32 s64, s2, 7
v_readfirstlane_b32 s3, v1
s_lshr_b32 s65, s2, 3
s_and_b32 s66, s65, 7
s_and_b32 s67, s64, 1
s_lshl3_add_u32 s59, s67, s66
s_lshr_b32 s66, s65, 3
s_lshr_b32 s67, s64, 1
s_lshl2_add_u32 s60, s67, s66
s_and_b32 s66, s65, 1
s_lshl1_add_u32 s61, s64, s66
s_lshr_b32 s62, s65, 1
s_mov_b32 s59, s61
s_mov_b32 s60, s62
s_mov_b32 s63, 0
s_mov_b32 s34, 0
s_mov_b32 s32, 200000
s_mov_b32 s33, -1
s_cmp_ge_u32 s3, 4
s_cselect_b32 s66, 3, 1
s_and_b32 s58, s3, s66
s_waitcnt lgkmcnt(0)
s_mov_b32 s8, s36
s_mov_b32 s9, s37
s_mov_b32 s10, 0x400000
s_mov_b32 s11, 0x00020000
s_mov_b32 s12, s38
s_mov_b32 s13, s39
s_mov_b32 s14, 0x600000
s_mov_b32 s15, 0x00020000
s_mov_b32 s16, s40
s_mov_b32 s17, s41
s_mov_b32 s18, 0x200000
s_mov_b32 s19, 0x00020000
s_mov_b32 s20, s56
s_mov_b32 s21, s57
s_mov_b32 s22, 0x2500000
s_mov_b32 s23, 0x00020000
s_add_u32 s24, s56, 30408704
s_addc_u32 s25, s57, 0
s_mov_b32 s26, 2818048
s_mov_b32 s27, 0x00020000
s_mov_b32 s28, s52
s_mov_b32 s29, s53
s_mov_b32 s30, 0x400000
s_mov_b32 s31, 0x00020000
s_cmp_ge_u32 s3, 4
s_cbranch_scc1 L_m
s_cmp_ge_u32 s3, 2
s_cbranch_scc1 L_f
s_setprio 1
v_and_b32 v22, 7, v0
v_lshrrev_b32 v23, 4, v0
v_lshrrev_b32 v6, 3, v0
v_xor_b32 v7, v22, v23
v_lshlrev_b32 v7, 4, v7
v_lshl_add_u32 v8, v6, 11, v7
v_xor_b32 v7, 64, v8
v_add_u32 v9, 15360, v7
v_add_u32 v10, 30720, v8
v_add_u32 v11, 46080, v7
s_lshl_b32 s70, s59, 18
s_lshl_b32 s71, s58, 16
s_add_u32 s68, s70, s71
s_sub_u32 s69, s70, s71
s_add_u32 s69, s69, 196608
s_mov_b32 s67, 128
s_lshl_b32 s75, s58, 13
s_mov_b32 s65, 86016
s_and_b32 s79, s59, 1
s_mul_i32 s70, s60, 1
s_and_b32 s71, s59, 14
s_add_u32 s70, s70, s71
s_and_b32 s70, s70, 15
s_xor_b32 s64, s70, s79
s_mul_i32 s70, s64, s67
s_add_u32 m0, s65, s75
s_add_u32 s71, s70, s68
buffer_load_dwordx4 v8, s[8:11], s71 offen offset:0 lds
buffer_load_dwordx4 v9, s[8:11], s71 offen offset:1024 lds
buffer_load_dwordx4 v10, s[8:11], s71 offen offset:2048 lds
buffer_load_dwordx4 v11, s[8:11], s71 offen offset:3072 lds
s_add_u32 m0, m0, 4096
s_add_u32 s71, s70, s69
buffer_load_dwordx4 v8, s[8:11], s71 offen offset:0 lds
buffer_load_dwordx4 v9, s[8:11], s71 offen offset:1024 lds
buffer_load_dwordx4 v10, s[8:11], s71 offen offset:2048 lds
buffer_load_dwordx4 v11, s[8:11], s71 offen offset:3072 lds
v_and_b32 v7, 2, v6
v_xor_b32 v7, v7, v22
v_mul_u32_u24 v6, 6144, v6
v_lshl_add_u32 v12, v7, 4, v6
v_xor_b32 v6, 64, v12
v_add_u32 v13, 48128, v6
v_add_u32 v14, 96256, v12
v_add_u32 v15, 144384, v6
s_mul_i32 s76, s58, 12288
s_add_u32 s76, s76, 16384
s_lshl_b32 s70, s60, 7
s_cmp_eq_u32 s58, 0
s_mov_b32 s71, 198656
s_cselect_b32 s72, 0, s71
s_mov_b32 s71, 4096
s_cselect_b32 s73, 196608, s71
s_mov_b32 s71, 200704
s_cselect_b32 s74, 2048, s71
s_add_u32 s72, s72, s70
s_add_u32 s73, s73, s70
s_add_u32 s74, s74, s70
s_mul_i32 s70, s64, 393216
s_add_u32 m0, s65, s76
s_add_u32 s71, s70, s72
buffer_load_dwordx4 v12, s[12:15], s71 offen offset:0 lds
buffer_load_dwordx4 v13, s[12:15], s71 offen offset:1024 lds
buffer_load_dwordx4 v14, s[12:15], s71 offen offset:2048 lds
buffer_load_dwordx4 v15, s[12:15], s71 offen offset:3072 lds
s_add_u32 m0, m0, 4096
s_add_u32 s71, s70, s73
buffer_load_dwordx4 v12, s[12:15], s71 offen offset:0 lds
buffer_load_dwordx4 v13, s[12:15], s71 offen offset:1024 lds
buffer_load_dwordx4 v14, s[12:15], s71 offen offset:2048 lds
buffer_load_dwordx4 v15, s[12:15], s71 offen offset:3072 lds
s_add_u32 m0, m0, 4096
s_add_u32 s71, s70, s74
buffer_load_dwordx4 v12, s[12:15], s71 offen offset:0 lds
buffer_load_dwordx4 v13, s[12:15], s71 offen offset:1024 lds
buffer_load_dwordx4 v14, s[12:15], s71 offen offset:2048 lds
buffer_load_dwordx4 v15, s[12:15], s71 offen offset:3072 lds
s_xor_b32 s64, s64, s79
s_add_u32 s64, s64, 1
s_and_b32 s64, s64, 15
s_xor_b32 s64, s64, s79
s_sub_u32 s65, s65, 40960
s_cselect_b32 s65, 86016, s65
v_and_b32 v1, 3, v0
v_lshlrev_b32 v1, 2, v1
v_and_b32 v2, 4, v1
s_lshl2_add_u32 s35, s58, 16
v_mov_b32 v3, s35
v_lshlrev_b32 v20, 4, v0
v_lshrrev_b32 v6, 2, v0
v_lshl_add_u32 v21, v6, 7, v1
v_lshrrev_b32 v6, 3, v0
v_lshlrev_b32 v23, 1, v23
v_xor_b32 v23, v23, v22
v_lshlrev_b32 v23, 4, v23
v_lshl_add_u32 v23, v6, 11, v23
s_lshl_b32 s70, s62, 7
s_lshl_b32 s71, s58, 16
s_add_u32 s70, s70, s71
v_add_u32 v16, s70, v23
v_add_u32 v17, 15360, v16
v_add_u32 v18, 30720, v16
v_add_u32 v19, 46080, v16
s_add_u32 s77, s61, s62
s_lshl_b32 s77, s77, 17
s_lshl_b32 s78, s58, 12
s_mov_b32 s66, -2
s_barrier
.p2align 4
lq_1:
s_add_u32 s35, s66, 1
lw_4:
ds_read_b32 v5, v1 offset:0
s_waitcnt lgkmcnt(0)
v_cmp_gt_i32 vcc, s35, v5
s_cbranch_vccz lwd_5
s_sub_u32 s32, s32, 1
s_cmp_gt_i32 s32, 0
s_cbranch_scc1 lw_4
lwd_5:
s_cmp_eq_u32 s66, 0
s_cbranch_scc1 lcs_2
lcb_3:
s_mul_i32 s70, s64, s67
s_add_u32 m0, s65, s75
s_add_u32 s71, s70, s68
buffer_load_dwordx4 v8, s[8:11], s71 offen offset:0 sc1 lds
buffer_load_dwordx4 v9, s[8:11], s71 offen offset:1024 sc1 lds
buffer_load_dwordx4 v10, s[8:11], s71 offen offset:2048 sc1 lds
buffer_load_dwordx4 v11, s[8:11], s71 offen offset:3072 sc1 lds
buffer_load_dword v30, off, s[12:15], 0
s_add_u32 m0, m0, 4096
s_add_u32 s71, s70, s69
buffer_load_dwordx4 v8, s[8:11], s71 offen offset:0 sc1 lds
buffer_load_dwordx4 v9, s[8:11], s71 offen offset:1024 sc1 lds
buffer_load_dwordx4 v10, s[8:11], s71 offen offset:2048 sc1 lds
buffer_load_dwordx4 v11, s[8:11], s71 offen offset:3072 sc1 lds
buffer_load_dword v30, off, s[12:15], 0
s_mul_i32 s70, s64, 393216
s_add_u32 m0, s65, s76
s_add_u32 s71, s70, s72
buffer_load_dwordx4 v12, s[12:15], s71 offen offset:0 lds
buffer_load_dwordx4 v13, s[12:15], s71 offen offset:1024 lds
buffer_load_dwordx4 v14, s[12:15], s71 offen offset:2048 lds
buffer_load_dwordx4 v15, s[12:15], s71 offen offset:3072 lds
buffer_load_dword v30, off, s[12:15], 0
v_add_u32 v5, s66, 3
s_mov_b64 exec, 1
s_waitcnt vmcnt(15)
ds_write_b32 v3, v5
s_mov_b64 exec, -1
s_mul_i32 s70, s64, 393216
s_add_u32 m0, m0, 4096
s_add_u32 s71, s70, s73
buffer_load_dwordx4 v12, s[12:15], s71 offen offset:0 lds
buffer_load_dwordx4 v13, s[12:15], s71 offen offset:1024 lds
buffer_load_dwordx4 v14, s[12:15], s71 offen offset:2048 lds
buffer_load_dwordx4 v15, s[12:15], s71 offen offset:3072 lds
buffer_load_dword v30, off, s[12:15], 0
s_mul_i32 s70, s64, 393216
s_add_u32 m0, m0, 4096
s_add_u32 s71, s70, s74
buffer_load_dwordx4 v12, s[12:15], s71 offen offset:0 lds
buffer_load_dwordx4 v13, s[12:15], s71 offen offset:1024 lds
buffer_load_dwordx4 v14, s[12:15], s71 offen offset:2048 lds
buffer_load_dwordx4 v15, s[12:15], s71 offen offset:3072 lds
buffer_load_dword v30, off, s[12:15], 0
s_xor_b32 s64, s64, s79
s_add_u32 s64, s64, 1
s_and_b32 s64, s64, 15
s_xor_b32 s64, s64, s79
s_sub_u32 s65, s65, 40960
s_cselect_b32 s65, 86016, s65
s_add_u32 s66, s66, 1
s_and_b32 s70, s66, 31
s_cmp_eq_u32 s70, 13
s_cbranch_scc0 lq_1
s_waitcnt vmcnt(0)
v_add_u32 v5, s34, 16
s_mov_b64 exec, 1
ds_write_b32 v3, v5
s_mov_b64 exec, -1
s_add_u32 s35, s34, 14
lw_6:
ds_read_b32 v5, v1 offset:0
s_waitcnt lgkmcnt(0)
v_cmp_gt_i32 vcc, s35, v5
s_cbranch_vccz lwd_7
s_sleep 1
s_sub_u32 s32, s32, 1
s_cmp_gt_i32 s32, 0
s_cbranch_scc1 lw_6
lwd_7:
s_add_u32 s70, s77, 262144
s_add_u32 m0, s78, 49152
s_and_b32 s70, s70, 0x1fffff
buffer_load_dwordx4 v16, s[16:19], s70 offen offset:0 lds
buffer_load_dwordx4 v17, s[16:19], s70 offen offset:1024 lds
buffer_load_dwordx4 v18, s[16:19], s70 offen offset:2048 lds
buffer_load_dwordx4 v19, s[16:19], s70 offen offset:3072 lds
buffer_load_dword v30, off, s[12:15], 0
s_add_u32 s70, s77, 393216
s_add_u32 m0, s78, 57344
s_and_b32 s70, s70, 0x1fffff
buffer_load_dwordx4 v16, s[16:19], s70 offen offset:0 lds
buffer_load_dwordx4 v17, s[16:19], s70 offen offset:1024 lds
buffer_load_dwordx4 v18, s[16:19], s70 offen offset:2048 lds
buffer_load_dwordx4 v19, s[16:19], s70 offen offset:3072 lds
buffer_load_dword v30, off, s[12:15], 0
s_add_u32 s70, s77, 524288
s_add_u32 m0, s78, 65536
s_and_b32 s70, s70, 0x1fffff
buffer_load_dwordx4 v16, s[16:19], s70 offen offset:0 lds
buffer_load_dwordx4 v17, s[16:19], s70 offen offset:1024 lds
buffer_load_dwordx4 v18, s[16:19], s70 offen offset:2048 lds
buffer_load_dwordx4 v19, s[16:19], s70 offen offset:3072 lds
buffer_load_dword v30, off, s[12:15], 0
s_add_u32 s70, s77, 655360
s_add_u32 m0, s78, 73728
s_and_b32 s70, s70, 0x1fffff
buffer_load_dwordx4 v16, s[16:19], s70 offen offset:0 lds
buffer_load_dwordx4 v17, s[16:19], s70 offen offset:1024 lds
buffer_load_dwordx4 v18, s[16:19], s70 offen offset:2048 lds
buffer_load_dwordx4 v19, s[16:19], s70 offen offset:3072 lds
buffer_load_dword v30, off, s[12:15], 0
s_sub_u32 s70, s59, s58
s_lshl_b32 s71, s70, 7
s_add_u32 s71, s71, s60
s_lshl4_add_u32 s70, s70, s60
s_sub_u32 s70, s70, 16
s_lshl_b32 s66, s71, 7
s_add_u32 s66, s66, 253952
s_lshl_b32 s70, s70, 15
s_lshl_b32 s71, s63, 23
s_add_u32 s70, s70, s71
s_add_u32 s64, s70, 1077248
s_mul_i32 s65, s58, -94208
s_add_u32 s35, s34, 16
lw_8:
ds_read_b32 v5, v1 offset:0
s_waitcnt lgkmcnt(0)
v_cmp_gt_i32 vcc, s35, v5
s_cbranch_vccz lwd_9
s_sleep 1
s_sub_u32 s32, s32, 1
s_cmp_gt_i32 s32, 0
s_cbranch_scc1 lw_8
lwd_9:
s_add_u32 s70, s77, 131072
s_add_u32 m0, s78, 40960
s_and_b32 s70, s70, 0x1fffff
buffer_load_dwordx4 v16, s[16:19], s70 offen offset:0 lds
buffer_load_dwordx4 v17, s[16:19], s70 offen offset:1024 lds
buffer_load_dwordx4 v18, s[16:19], s70 offen offset:2048 lds
buffer_load_dwordx4 v19, s[16:19], s70 offen offset:3072 lds
buffer_load_dword v30, off, s[12:15], 0
s_add_u32 s70, s77, 786432
s_add_u32 m0, s78, 81920
s_and_b32 s70, s70, 0x1fffff
buffer_load_dwordx4 v16, s[16:19], s70 offen offset:0 lds
buffer_load_dwordx4 v17, s[16:19], s70 offen offset:1024 lds
buffer_load_dwordx4 v18, s[16:19], s70 offen offset:2048 lds
buffer_load_dwordx4 v19, s[16:19], s70 offen offset:3072 lds
buffer_load_dword v30, off, s[12:15], 0
s_add_u32 s70, s77, 917504
s_add_u32 m0, s78, 90112
s_and_b32 s70, s70, 0x1fffff
buffer_load_dwordx4 v16, s[16:19], s70 offen offset:0 lds
buffer_load_dwordx4 v17, s[16:19], s70 offen offset:1024 lds
buffer_load_dwordx4 v18, s[16:19], s70 offen offset:2048 lds
buffer_load_dwordx4 v19, s[16:19], s70 offen offset:3072 lds
buffer_load_dword v30, off, s[12:15], 0
s_add_u32 s35, s34, 17
lw_11:
ds_read_b32 v5, v1 offset:0
s_waitcnt lgkmcnt(0)
v_cmp_gt_i32 vcc, s35, v5
s_cbranch_vccz lwd_12
s_sleep 1
s_sub_u32 s32, s32, 1
s_cmp_gt_i32 s32, 0
s_cbranch_scc1 lw_11
lwd_12:
s_cmp_gt_u32 s59, s58
s_cbranch_scc0 nokv_10
poll_13:
buffer_load_dword v6, v1, s[24:27], s66 offen sc1
pchk_14:
s_waitcnt vmcnt(0)
v_cmp_eq_u32 vcc, 0, v6
s_cbranch_vccz pdone_15
s_sub_u32 s32, s32, 1
s_cmp_gt_i32 s32, 0
s_cbranch_scc1 poll_13
pdone_15:
s_add_u32 m0, s65, 126976
s_nop 0
buffer_load_dwordx4 v20, s[20:23], s64 offen offset:0 sc1 lds
buffer_load_dwordx4 v20, s[20:23], s64 offen offset:1024 sc1 lds
buffer_load_dwordx4 v20, s[20:23], s64 offen offset:2048 sc1 lds
buffer_load_dwordx4 v20, s[20:23], s64 offen offset:3072 sc1 lds
buffer_load_dword v30, off, s[12:15], 0
s_add_u32 m0, s65, 122880
s_sub_u32 s64, s64, 4096
buffer_load_dwordx4 v20, s[20:23], s64 offen offset:0 sc1 lds
buffer_load_dwordx4 v20, s[20:23], s64 offen offset:1024 sc1 lds
buffer_load_dwordx4 v20, s[20:23], s64 offen offset:2048 sc1 lds
buffer_load_dwordx4 v20, s[20:23], s64 offen offset:3072 sc1 lds
buffer_load_dword v30, off, s[12:15], 0
s_add_u32 m0, s65, 118784
s_sub_u32 s64, s64, 4096
buffer_load_dwordx4 v20, s[20:23], s64 offen offset:0 sc1 lds
buffer_load_dwordx4 v20, s[20:23], s64 offen offset:1024 sc1 lds
buffer_load_dwordx4 v20, s[20:23], s64 offen offset:2048 sc1 lds
buffer_load_dwordx4 v20, s[20:23], s64 offen offset:3072 sc1 lds
buffer_load_dword v30, off, s[12:15], 0
s_add_u32 m0, s65, 114688
s_sub_u32 s64, s64, 4096
buffer_load_dwordx4 v20, s[20:23], s64 offen offset:0 sc1 lds
buffer_load_dwordx4 v20, s[20:23], s64 offen offset:1024 sc1 lds
buffer_load_dwordx4 v20, s[20:23], s64 offen offset:2048 sc1 lds
buffer_load_dwordx4 v20, s[20:23], s64 offen offset:3072 sc1 lds
buffer_load_dword v30, off, s[12:15], 0
s_add_u32 m0, s65, 110592
s_sub_u32 s64, s64, 4096
buffer_load_dwordx4 v20, s[20:23], s64 offen offset:0 sc1 lds
buffer_load_dwordx4 v20, s[20:23], s64 offen offset:1024 sc1 lds
buffer_load_dwordx4 v20, s[20:23], s64 offen offset:2048 sc1 lds
buffer_load_dwordx4 v20, s[20:23], s64 offen offset:3072 sc1 lds
buffer_load_dword v30, off, s[12:15], 0
s_add_u32 m0, s65, 106496
s_sub_u32 s64, s64, 4096
buffer_load_dwordx4 v20, s[20:23], s64 offen offset:0 sc1 lds
buffer_load_dwordx4 v20, s[20:23], s64 offen offset:1024 sc1 lds
buffer_load_dwordx4 v20, s[20:23], s64 offen offset:2048 sc1 lds
buffer_load_dwordx4 v20, s[20:23], s64 offen offset:3072 sc1 lds
buffer_load_dword v30, off, s[12:15], 0
s_add_u32 m0, s65, 102400
s_sub_u32 s64, s64, 4096
buffer_load_dwordx4 v20, s[20:23], s64 offen offset:0 sc1 lds
buffer_load_dwordx4 v20, s[20:23], s64 offen offset:1024 sc1 lds
buffer_load_dwordx4 v20, s[20:23], s64 offen offset:2048 sc1 lds
buffer_load_dwordx4 v20, s[20:23], s64 offen offset:3072 sc1 lds
buffer_load_dword v30, off, s[12:15], 0
s_add_u32 m0, s65, 98304
s_sub_u32 s64, s64, 4096
buffer_load_dwordx4 v20, s[20:23], s64 offen offset:0 sc1 lds
buffer_load_dwordx4 v20, s[20:23], s64 offen offset:1024 sc1 lds
buffer_load_dwordx4 v20, s[20:23], s64 offen offset:2048 sc1 lds
buffer_load_dwordx4 v20, s[20:23], s64 offen offset:3072 sc1 lds
buffer_load_dword v30, off, s[12:15], 0
nokv_10:
s_lshl_b32 s66, s61, 14
s_add_u32 s66, s66, 268288
s_waitcnt vmcnt(0)
v_add_u32 v5, s34, 17
s_mov_b64 exec, 1
ds_write_b32 v3, v5
s_mov_b64 exec, -1
s_add_u32 s35, s34, 18
lw_17:
ds_read_b32 v5, v1 offset:0
s_waitcnt lgkmcnt(0)
v_cmp_gt_i32 vcc, s35, v5
s_cbranch_vccz lwd_18
s_sleep 1
s_sub_u32 s32, s32, 1
s_cmp_gt_i32 s32, 0
s_cbranch_scc1 lw_17
lwd_18:
s_add_u32 s70, s77, 1572864
s_add_u32 m0, s78, 131072
s_and_b32 s70, s70, 0x1fffff
buffer_load_dwordx4 v16, s[16:19], s70 offen offset:0 lds
buffer_load_dwordx4 v17, s[16:19], s70 offen offset:1024 lds
buffer_load_dwordx4 v18, s[16:19], s70 offen offset:2048 lds
buffer_load_dwordx4 v19, s[16:19], s70 offen offset:3072 lds
buffer_load_dword v30, off, s[12:15], 0
s_add_u32 s70, s77, 1703936
s_add_u32 m0, s78, 139264
s_and_b32 s70, s70, 0x1fffff
buffer_load_dwordx4 v16, s[16:19], s70 offen offset:0 lds
buffer_load_dwordx4 v17, s[16:19], s70 offen offset:1024 lds
buffer_load_dwordx4 v18, s[16:19], s70 offen offset:2048 lds
buffer_load_dwordx4 v19, s[16:19], s70 offen offset:3072 lds
buffer_load_dword v30, off, s[12:15], 0
s_add_u32 s70, s77, 1835008
s_add_u32 m0, s78, 147456
s_and_b32 s70, s70, 0x1fffff
buffer_load_dwordx4 v16, s[16:19], s70 offen offset:0 lds
buffer_load_dwordx4 v17, s[16:19], s70 offen offset:1024 lds
buffer_load_dwordx4 v18, s[16:19], s70 offen offset:2048 lds
buffer_load_dwordx4 v19, s[16:19], s70 offen offset:3072 lds
buffer_load_dword v30, off, s[12:15], 0
s_add_u32 s70, s77, 1966080
s_add_u32 m0, s78, 155648
s_and_b32 s70, s70, 0x1fffff
buffer_load_dwordx4 v16, s[16:19], s70 offen offset:0 lds
buffer_load_dwordx4 v17, s[16:19], s70 offen offset:1024 lds
buffer_load_dwordx4 v18, s[16:19], s70 offen offset:2048 lds
buffer_load_dwordx4 v19, s[16:19], s70 offen offset:3072 lds
buffer_load_dword v30, off, s[12:15], 0
s_add_u32 s35, s34, 19
lw_19:
ds_read_b32 v5, v1 offset:0
s_waitcnt lgkmcnt(0)
v_cmp_gt_i32 vcc, s35, v5
s_cbranch_vccz lwd_20
s_sleep 2
s_sub_u32 s32, s32, 1
s_cmp_gt_i32 s32, 0
s_cbranch_scc1 lw_19
lwd_20:
s_add_u32 s70, s77, 1048576
s_add_u32 m0, s78, 98304
s_and_b32 s70, s70, 0x1fffff
buffer_load_dwordx4 v16, s[16:19], s70 offen offset:0 lds
buffer_load_dwordx4 v17, s[16:19], s70 offen offset:1024 lds
buffer_load_dwordx4 v18, s[16:19], s70 offen offset:2048 lds
buffer_load_dwordx4 v19, s[16:19], s70 offen offset:3072 lds
buffer_load_dword v30, off, s[12:15], 0
s_add_u32 s70, s77, 1179648
s_add_u32 m0, s78, 106496
s_and_b32 s70, s70, 0x1fffff
buffer_load_dwordx4 v16, s[16:19], s70 offen offset:0 lds
buffer_load_dwordx4 v17, s[16:19], s70 offen offset:1024 lds
buffer_load_dwordx4 v18, s[16:19], s70 offen offset:2048 lds
buffer_load_dwordx4 v19, s[16:19], s70 offen offset:3072 lds
buffer_load_dword v30, off, s[12:15], 0
s_add_u32 s70, s77, 1310720
s_add_u32 m0, s78, 114688
s_and_b32 s70, s70, 0x1fffff
buffer_load_dwordx4 v16, s[16:19], s70 offen offset:0 lds
buffer_load_dwordx4 v17, s[16:19], s70 offen offset:1024 lds
buffer_load_dwordx4 v18, s[16:19], s70 offen offset:2048 lds
buffer_load_dwordx4 v19, s[16:19], s70 offen offset:3072 lds
buffer_load_dword v30, off, s[12:15], 0
s_add_u32 s70, s77, 1441792
s_add_u32 m0, s78, 122880
s_and_b32 s70, s70, 0x1fffff
buffer_load_dwordx4 v16, s[16:19], s70 offen offset:0 lds
buffer_load_dwordx4 v17, s[16:19], s70 offen offset:1024 lds
buffer_load_dwordx4 v18, s[16:19], s70 offen offset:2048 lds
buffer_load_dwordx4 v19, s[16:19], s70 offen offset:3072 lds
buffer_load_dword v30, off, s[12:15], 0
s_add_u32 s35, s34, 20
lw_21:
ds_read_b32 v5, v1 offset:0
s_waitcnt lgkmcnt(0)
v_cmp_gt_i32 vcc, s35, v5
s_cbranch_vccz lwd_22
s_sleep 2
s_sub_u32 s32, s32, 1
s_cmp_gt_i32 s32, 0
s_cbranch_scc1 lw_21
lwd_22:
s_add_u32 s70, s77, 0
s_add_u32 m0, s78, 32768
s_and_b32 s70, s70, 0x1fffff
buffer_load_dwordx4 v16, s[16:19], s70 offen offset:0 lds
buffer_load_dwordx4 v17, s[16:19], s70 offen offset:1024 lds
buffer_load_dwordx4 v18, s[16:19], s70 offen offset:2048 lds
buffer_load_dwordx4 v19, s[16:19], s70 offen offset:3072 lds
buffer_load_dword v30, off, s[12:15], 0
s_cmp_eq_u32 s58, 0
s_cbranch_scc0 nofo_16
s_add_u32 s35, s34, 21
lw_23:
ds_read_b32 v5, v1 offset:0
s_waitcnt lgkmcnt(0)
v_cmp_gt_i32 vcc, s35, v5
s_cbranch_vccz lwd_24
s_sleep 1
s_sub_u32 s32, s32, 1
s_cmp_gt_i32 s32, 0
s_cbranch_scc1 lw_23
lwd_24:
poll_25:
buffer_load_dword v6, v21, s[24:27], s66 offen sc1
pchk_26:
s_waitcnt vmcnt(0)
v_cmp_eq_u32 vcc, 0, v6
s_cbranch_vccz pdone_27
s_sub_u32 s32, s32, 1
s_cmp_gt_i32 s32, 0
s_cbranch_scc1 poll_25
pdone_27:
nofo_16:
s_waitcnt vmcnt(0)
v_add_u32 v5, s34, 18
s_mov_b64 exec, 1
ds_write_b32 v3, v5
s_mov_b64 exec, -1
s_cmp_eq_u32 s63, 0
s_cbranch_scc0 L_end
v_bfe_u32 v6, v0, 3, 2
v_and_b32 v7, 2, v6
v_xor_b32 v7, v7, v22
v_lshrrev_b32 v23, 5, v0
v_lshl_add_u32 v6, v23, 4, v6
v_mul_u32_u24 v6, 6144, v6
v_lshl_add_u32 v12, v7, 4, v6
v_xor_b32 v6, 64, v12
v_add_u32 v13, 23552, v6
v_add_u32 v14, 47104, v12
v_add_u32 v15, 70656, v6
v_mov_b32 v8, v20
v_mov_b32 v9, v20
v_mov_b32 v10, v20
v_mov_b32 v11, v20
s_mov_b32 s8, s56
s_mov_b32 s9, s57
s_mov_b32 s10, 0x2500000
s_mov_b32 s11, 0x00020000
s_lshl_b32 s70, s59, 18
s_add_u32 s70, s70, 26214400
s_add_u32 s68, s70, s78
s_sub_u32 s69, s70, s78
s_add_u32 s69, s69, 12288
s_mov_b32 s67, 16384
s_lshl_b32 s66, s59, 14
s_add_u32 s66, s66, 274432
s_and_b32 s79, s59, 1
s_mul_i32 s79, s79, 1
s_mul_i32 s70, s60, 1
s_and_b32 s71, s59, 14
s_add_u32 s70, s70, s71
s_and_b32 s70, s70, 15
s_xor_b32 s64, s70, s79
s_mov_b32 s65, 86016
s_add_u32 s35, s34, 22
lw_28:
ds_read_b32 v5, v1 offset:0
s_waitcnt lgkmcnt(0)
v_cmp_gt_i32 vcc, s35, v5
s_cbranch_vccz lwd_29
s_sleep 2
s_sub_u32 s32, s32, 1
s_cmp_gt_i32 s32, 0
s_cbranch_scc1 lw_28
lwd_29:
s_mul_i32 s70, s64, 393216
s_add_u32 m0, s65, s76
s_add_u32 s71, s70, s72
buffer_load_dwordx4 v12, s[12:15], s71 offen offset:0 lds
buffer_load_dwordx4 v13, s[12:15], s71 offen offset:1024 lds
buffer_load_dwordx4 v14, s[12:15], s71 offen offset:2048 lds
buffer_load_dwordx4 v15, s[12:15], s71 offen offset:3072 lds
buffer_load_dword v30, off, s[12:15], 0
s_add_u32 m0, m0, 4096
s_add_u32 s71, s70, s73
buffer_load_dwordx4 v12, s[12:15], s71 offen offset:0 lds
buffer_load_dwordx4 v13, s[12:15], s71 offen offset:1024 lds
buffer_load_dwordx4 v14, s[12:15], s71 offen offset:2048 lds
buffer_load_dwordx4 v15, s[12:15], s71 offen offset:3072 lds
buffer_load_dword v30, off, s[12:15], 0
s_add_u32 m0, m0, 4096
s_add_u32 s71, s70, s74
buffer_load_dwordx4 v12, s[12:15], s71 offen offset:0 lds
buffer_load_dwordx4 v13, s[12:15], s71 offen offset:1024 lds
buffer_load_dwordx4 v14, s[12:15], s71 offen offset:2048 lds
buffer_load_dwordx4 v15, s[12:15], s71 offen offset:3072 lds
buffer_load_dword v30, off, s[12:15], 0
s_and_b32 s79, s59, 1
s_mul_i32 s79, s79, 1
s_mul_i32 s70, s60, 1
s_and_b32 s71, s59, 14
s_add_u32 s70, s70, s71
s_and_b32 s70, s70, 15
s_xor_b32 s64, s70, s79
s_mov_b32 s65, 86016
s_add_u32 s35, s34, 23
lw_30:
ds_read_b32 v5, v1 offset:0
s_waitcnt lgkmcnt(0)
v_cmp_gt_i32 vcc, s35, v5
s_cbranch_vccz lwd_31
s_sleep 1
s_sub_u32 s32, s32, 1
s_cmp_gt_i32 s32, 0
s_cbranch_scc1 lw_30
lwd_31:
poll_32:
buffer_load_dword v6, v21, s[24:27], s66 offen sc1
pchk_33:
s_waitcnt vmcnt(0)
v_cmp_eq_u32 vcc, 0, v6
s_cbranch_vccz pdone_34
s_sub_u32 s32, s32, 1
s_cmp_gt_i32 s32, 0
s_cbranch_scc1 poll_32
pdone_34:
s_mul_i32 s70, s64, s67
s_add_u32 m0, s65, s75
s_add_u32 s71, s70, s68
buffer_load_dwordx4 v8, s[8:11], s71 offen offset:0 sc1 lds
buffer_load_dwordx4 v9, s[8:11], s71 offen offset:1024 sc1 lds
buffer_load_dwordx4 v10, s[8:11], s71 offen offset:2048 sc1 lds
buffer_load_dwordx4 v11, s[8:11], s71 offen offset:3072 sc1 lds
buffer_load_dword v30, off, s[12:15], 0
s_add_u32 m0, m0, 4096
s_add_u32 s71, s70, s69
buffer_load_dwordx4 v8, s[8:11], s71 offen offset:0 sc1 lds
buffer_load_dwordx4 v9, s[8:11], s71 offen offset:1024 sc1 lds
buffer_load_dwordx4 v10, s[8:11], s71 offen offset:2048 sc1 lds
buffer_load_dwordx4 v11, s[8:11], s71 offen offset:3072 sc1 lds
buffer_load_dword v30, off, s[12:15], 0
s_xor_b32 s64, s64, s79
s_add_u32 s64, s64, 1
s_and_b32 s64, s64, 15
s_xor_b32 s64, s64, s79
s_sub_u32 s65, s65, 40960
s_cselect_b32 s65, 86016, s65
s_mul_i32 s70, s64, s67
s_add_u32 m0, s65, s75
s_add_u32 s71, s70, s68
buffer_load_dwordx4 v8, s[8:11], s71 offen offset:0 sc1 lds
buffer_load_dwordx4 v9, s[8:11], s71 offen offset:1024 sc1 lds
buffer_load_dwordx4 v10, s[8:11], s71 offen offset:2048 sc1 lds
buffer_load_dwordx4 v11, s[8:11], s71 offen offset:3072 sc1 lds
buffer_load_dword v30, off, s[12:15], 0
s_add_u32 m0, m0, 4096
s_add_u32 s71, s70, s69
buffer_load_dwordx4 v8, s[8:11], s71 offen offset:0 sc1 lds
buffer_load_dwordx4 v9, s[8:11], s71 offen offset:1024 sc1 lds
buffer_load_dwordx4 v10, s[8:11], s71 offen offset:2048 sc1 lds
buffer_load_dwordx4 v11, s[8:11], s71 offen offset:3072 sc1 lds
buffer_load_dword v30, off, s[12:15], 0
s_mul_i32 s70, s64, 393216
s_add_u32 m0, s65, s76
s_add_u32 s71, s70, s72
buffer_load_dwordx4 v12, s[12:15], s71 offen offset:0 lds
buffer_load_dwordx4 v13, s[12:15], s71 offen offset:1024 lds
buffer_load_dwordx4 v14, s[12:15], s71 offen offset:2048 lds
buffer_load_dwordx4 v15, s[12:15], s71 offen offset:3072 lds
buffer_load_dword v30, off, s[12:15], 0
s_add_u32 m0, m0, 4096
s_add_u32 s71, s70, s73
buffer_load_dwordx4 v12, s[12:15], s71 offen offset:0 lds
buffer_load_dwordx4 v13, s[12:15], s71 offen offset:1024 lds
buffer_load_dwordx4 v14, s[12:15], s71 offen offset:2048 lds
buffer_load_dwordx4 v15, s[12:15], s71 offen offset:3072 lds
buffer_load_dword v30, off, s[12:15], 0
s_add_u32 m0, m0, 4096
s_add_u32 s71, s70, s74
buffer_load_dwordx4 v12, s[12:15], s71 offen offset:0 lds
buffer_load_dwordx4 v13, s[12:15], s71 offen offset:1024 lds
buffer_load_dwordx4 v14, s[12:15], s71 offen offset:2048 lds
buffer_load_dwordx4 v15, s[12:15], s71 offen offset:3072 lds
buffer_load_dword v30, off, s[12:15], 0
s_xor_b32 s64, s64, s79
s_add_u32 s64, s64, 1
s_and_b32 s64, s64, 15
s_xor_b32 s64, s64, s79
s_sub_u32 s65, s65, 40960
s_cselect_b32 s65, 86016, s65
s_mul_i32 s70, s64, s67
s_add_u32 m0, s65, s75
s_add_u32 s71, s70, s68
buffer_load_dwordx4 v8, s[8:11], s71 offen offset:0 sc1 lds
buffer_load_dwordx4 v9, s[8:11], s71 offen offset:1024 sc1 lds
buffer_load_dwordx4 v10, s[8:11], s71 offen offset:2048 sc1 lds
buffer_load_dwordx4 v11, s[8:11], s71 offen offset:3072 sc1 lds
buffer_load_dword v30, off, s[12:15], 0
s_add_u32 m0, m0, 4096
s_add_u32 s71, s70, s69
buffer_load_dwordx4 v8, s[8:11], s71 offen offset:0 sc1 lds
buffer_load_dwordx4 v9, s[8:11], s71 offen offset:1024 sc1 lds
buffer_load_dwordx4 v10, s[8:11], s71 offen offset:2048 sc1 lds
buffer_load_dwordx4 v11, s[8:11], s71 offen offset:3072 sc1 lds
buffer_load_dword v30, off, s[12:15], 0
s_mul_i32 s70, s64, 393216
s_add_u32 m0, s65, s76
s_add_u32 s71, s70, s72
buffer_load_dwordx4 v12, s[12:15], s71 offen offset:0 lds
buffer_load_dwordx4 v13, s[12:15], s71 offen offset:1024 lds
buffer_load_dwordx4 v14, s[12:15], s71 offen offset:2048 lds
buffer_load_dwordx4 v15, s[12:15], s71 offen offset:3072 lds
buffer_load_dword v30, off, s[12:15], 0
s_add_u32 m0, m0, 4096
s_add_u32 s71, s70, s73
buffer_load_dwordx4 v12, s[12:15], s71 offen offset:0 lds
buffer_load_dwordx4 v13, s[12:15], s71 offen offset:1024 lds
buffer_load_dwordx4 v14, s[12:15], s71 offen offset:2048 lds
buffer_load_dwordx4 v15, s[12:15], s71 offen offset:3072 lds
buffer_load_dword v30, off, s[12:15], 0
s_add_u32 m0, m0, 4096
s_add_u32 s71, s70, s74
buffer_load_dwordx4 v12, s[12:15], s71 offen offset:0 lds
buffer_load_dwordx4 v13, s[12:15], s71 offen offset:1024 lds
buffer_load_dwordx4 v14, s[12:15], s71 offen offset:2048 lds
buffer_load_dwordx4 v15, s[12:15], s71 offen offset:3072 lds
buffer_load_dword v30, off, s[12:15], 0
s_xor_b32 s64, s64, s79
s_add_u32 s64, s64, 1
s_and_b32 s64, s64, 15
s_xor_b32 s64, s64, s79
s_sub_u32 s65, s65, 40960
s_cselect_b32 s65, 86016, s65
s_waitcnt vmcnt(50)
v_add_u32 v5, s34, 33
s_mov_b64 exec, 1
ds_write_b32 v3, v5
s_mov_b64 exec, -1
s_mov_b32 s36, s64
s_mov_b32 s37, s65
s_mov_b32 s64, s59
s_mov_b32 s65, 114688
s_mul_i32 s70, s64, 393216
s_add_u32 m0, s65, s76
s_add_u32 s71, s70, s72
buffer_load_dwordx4 v12, s[12:15], s71 offen offset:0 lds
buffer_load_dwordx4 v13, s[12:15], s71 offen offset:1024 lds
buffer_load_dwordx4 v14, s[12:15], s71 offen offset:2048 lds
buffer_load_dwordx4 v15, s[12:15], s71 offen offset:3072 lds
buffer_load_dword v30, off, s[12:15], 0
s_add_u32 m0, m0, 4096
s_add_u32 s71, s70, s73
buffer_load_dwordx4 v12, s[12:15], s71 offen offset:0 lds
buffer_load_dwordx4 v13, s[12:15], s71 offen offset:1024 lds
buffer_load_dwordx4 v14, s[12:15], s71 offen offset:2048 lds
buffer_load_dwordx4 v15, s[12:15], s71 offen offset:3072 lds
buffer_load_dword v30, off, s[12:15], 0
s_add_u32 m0, m0, 4096
s_add_u32 s71, s70, s74
buffer_load_dwordx4 v12, s[12:15], s71 offen offset:0 lds
buffer_load_dwordx4 v13, s[12:15], s71 offen offset:1024 lds
buffer_load_dwordx4 v14, s[12:15], s71 offen offset:2048 lds
buffer_load_dwordx4 v15, s[12:15], s71 offen offset:3072 lds
buffer_load_dword v30, off, s[12:15], 0
s_mov_b32 s64, s36
s_mov_b32 s65, s37
s_waitcnt vmcnt(40)
v_add_u32 v5, s34, 34
s_mov_b64 exec, 1
ds_write_b32 v3, v5
s_mov_b64 exec, -1
s_mov_b32 s63, 1
s_mov_b32 s34, 32
s_add_u32 s24, s24, 1409024
s_addc_u32 s25, s25, 0
s_mov_b32 s26, 1409024
s_mov_b32 s66, 32
s_branch lq_1
lcs_2:
s_add_u32 s35, s34, 1
lw_35:
ds_read_b32 v5, v2 offset:24
s_waitcnt lgkmcnt(0)
v_cmp_gt_i32 vcc, s35, v5
s_cbranch_vccz lwd_36
s_sub_u32 s32, s32, 1
s_cmp_gt_i32 s32, 0
s_cbranch_scc1 lw_35
lwd_36:
s_branch lcb_3
L_f:
v_lshlrev_b32 v4, 4, v0
s_lshl4_add_u32 s78, s59, s60
v_mov_b32 v252, 0
v_mov_b32 v253, 0
v_mov_b32 v254, 0
v_mov_b32 v255, 0
s_lshl_b32 s35, s78, 10
s_cmp_eq_u32 s58, 0
s_cselect_b64 exec, -1, 0
buffer_store_dwordx4 v[252:255], v4, s[24:27], s35 offen offset:0 sc1
s_add_u32 s35, s35, 262144
buffer_store_dwordx4 v[252:255], v4, s[24:27], s35 offen offset:0 sc1
s_mov_b64 exec, -1
s_setprio 3
v_and_b32 v1, 3, v0
v_lshlrev_b32 v1, 2, v1
v_and_b32 v2, 4, v1
s_lshl2_add_u32 s35, s58, 24
v_mov_b32 v3, s35
s_mov_b32 s4, s54
s_mov_b32 s5, s55
s_mov_b32 s6, 0x100
s_mov_b32 s7, 0x00020000
s_add_u32 s70, s60, 4
s_lshr_b32 s70, s70, 3
s_sub_u32 s70, s60, s70
s_lshl4_add_u32 s64, s70, s59
s_and_b32 s70, s60, 7
s_cmp_eq_u32 s70, 3
s_cselect_b32 s65, 1, 0
s_mov_b32 s69, 0x3f803f80
s_barrier
s_cmp_eq_u32 s58, 0
s_cselect_b32 s16, s46, s48
s_cselect_b32 s17, s47, s49
s_mov_b32 s12, s50
s_mov_b32 s13, s51
s_mov_b32 s14, 0x0
s_mov_b32 s15, 0x00020000
s_cmp_eq_u32 s65, 0
s_cselect_b32 s18, 7340032, 0
s_mov_b32 s14, s18
s_lshr_b32 s70, s64, 3
s_and_b32 s71, s64, 7
s_lshl_b32 s66, s70, 10
s_add_u32 s66, s66, s71
s_lshl1_add_u32 s66, s66, s58
s_lshl_b32 s66, s66, 7
s_mul_i32 s71, s71, 917504
s_lshl_b32 s70, s70, 8
s_add_u32 s77, s71, s70
s_and_b32 s73, s2, 3
s_lshl_b32 s73, s73, 6
v_mov_b32 v14, 1
s_sub_u32 exec_lo, 1, s58
s_mov_b32 exec_hi, 0
s_waitcnt vmcnt(0)
buffer_atomic_add v14, off, s[4:7], s73 sc1
s_mov_b64 exec, -1
v_mov_b32 v8, s69
v_mov_b32 v9, s69
v_mov_b32 v10, s69
v_mov_b32 v11, s69
v_mov_b32 v12, s69
v_mov_b32 v13, s69
v_mov_b32 v14, s69
v_mov_b32 v15, s69
s_mov_b32 s70, 102400
ftop_39:
v_lshrrev_b32 v6, 4, v0
v_bfe_u32 v7, v0, 2, 2
v_lshl_add_u32 v6, v6, 3, v7
v_bfe_u32 v7, v0, 3, 2
s_lshl_b32 s71, s58, 1
v_xor_b32 v7, s71, v7
v_lshl_add_u32 v7, v7, 5, s70
v_lshl_add_u32 v6, v6, 7, v7
v_lshl_add_u32 v6, v1, 1, v6
v_xor_b32 v7, 32, v6
s_mul_i32 s71, s63, 34
s_add_u32 s35, s71, 1
lw_40:
ds_read_b32 v5, v2 offset:16
s_waitcnt lgkmcnt(0)
v_cmp_gt_i32 vcc, s35, v5
s_cbranch_vccz lwd_41
s_sleep 1
s_sub_u32 s32, s32, 1
s_cmp_gt_i32 s32, 0
s_cbranch_scc1 lw_40
lwd_41:
ds_read_b64_tr_b16 v[24:25], v6 offset:0
ds_read_b64_tr_b16 v[26:27], v6 offset:512
ds_read_b64_tr_b16 v[28:29], v6 offset:4096
ds_read_b64_tr_b16 v[30:31], v6 offset:4608
ds_read_b64_tr_b16 v[32:33], v7 offset:0
ds_read_b64_tr_b16 v[34:35], v7 offset:512
ds_read_b64_tr_b16 v[36:37], v7 offset:4096
ds_read_b64_tr_b16 v[38:39], v7 offset:4608
ds_read_b64_tr_b16 v[40:41], v6 offset:8192
ds_read_b64_tr_b16 v[42:43], v6 offset:8704
ds_read_b64_tr_b16 v[44:45], v6 offset:12288
ds_read_b64_tr_b16 v[46:47], v6 offset:12800
ds_read_b64_tr_b16 v[48:49], v7 offset:8192
ds_read_b64_tr_b16 v[50:51], v7 offset:8704
ds_read_b64_tr_b16 v[52:53], v7 offset:12288
ds_read_b64_tr_b16 v[54:55], v7 offset:12800
s_lshl_b32 s72, s60, 14
s_lshl_b32 s70, s58, 9
s_add_u32 s72, s72, s70
s_lshl_b32 s70, s59, 10
s_add_u32 s71, s72, s70
s_lshl_b32 s76, s59, 14
s_add_u32 s73, s76, 30686208
s_add_u32 s76, s76, 266240
s_waitcnt lgkmcnt(14)
v_mfma_f32_16x16x32_bf16 v[248:251], v[8:11], v[24:27], 0
s_waitcnt lgkmcnt(10)
v_mfma_f32_16x16x32_bf16 v[252:255], v[8:11], v[32:35], 0
v_mfma_f32_16x16x32_bf16 v[248:251], v[12:15], v[28:31], v[248:251]
s_waitcnt lgkmcnt(8)
v_mfma_f32_16x16x32_bf16 v[252:255], v[12:15], v[36:39], v[252:255]
ds_read_b64_tr_b16 v[24:25], v6 offset:16384
ds_read_b64_tr_b16 v[26:27], v6 offset:16896
ds_read_b64_tr_b16 v[28:29], v6 offset:20480
ds_read_b64_tr_b16 v[30:31], v6 offset:20992
ds_read_b64_tr_b16 v[32:33], v7 offset:16384
ds_read_b64_tr_b16 v[34:35], v7 offset:16896
ds_read_b64_tr_b16 v[36:37], v7 offset:20480
ds_read_b64_tr_b16 v[38:39], v7 offset:20992
v_add_u32 v5, s34, 1
s_mov_b64 exec, 1
ds_write_b32 v3, v5
s_mov_b64 exec, -1
s_waitcnt lgkmcnt(14)
v_mfma_f32_16x16x32_bf16 v[16:19], v[8:11], v[40:43], 0
s_waitcnt lgkmcnt(11)
v_mfma_f32_16x16x32_bf16 v[20:23], v[8:11], v[48:51], 0
v_mfma_f32_16x16x32_bf16 v[16:19], v[12:15], v[44:47], v[16:19]
s_waitcnt lgkmcnt(9)
v_mfma_f32_16x16x32_bf16 v[20:23], v[12:15], v[52:55], v[20:23]
v_mov_b32 v249, v252
v_mov_b32 v252, s69
v_mov_b32 v253, s69
v_mov_b32 v254, s69
v_mov_b32 v255, s69
v_mfma_f32_16x16x32_bf16 v[52:55], v[8:11], v[8:11], 0
s_nop 0
v_mfma_f32_16x16x32_bf16 v[48:51], v[8:11], v[252:255], 0
v_mfma_f32_16x16x32_bf16 v[52:55], v[12:15], v[12:15], v[52:55]
v_mfma_f32_16x16x32_bf16 v[48:51], v[12:15], v[252:255], v[48:51]
s_waitcnt lgkmcnt(7)
v_mfma_f32_16x16x32_bf16 v[40:43], v[8:11], v[24:27], 0
s_waitcnt lgkmcnt(3)
v_mfma_f32_16x16x32_bf16 v[44:47], v[8:11], v[32:35], 0
v_mfma_f32_16x16x32_bf16 v[40:43], v[12:15], v[28:31], v[40:43]
s_waitcnt lgkmcnt(1)
v_mfma_f32_16x16x32_bf16 v[44:47], v[12:15], v[36:39], v[44:47]
v_lshlrev_b32 v6, 3, v0
v_and_b32 v7, 48, v0
v_mov_b32_dpp v248, v16 quad_perm:[0,1,2,3] row_mask:0x2 bank_mask:0xf
v_mov_b32_dpp v249, v20 quad_perm:[0,1,2,3] row_mask:0x2 bank_mask:0xf
s_nop 0
v_mov_b32_dpp v248, v48 quad_perm:[0,1,2,3] row_mask:0x8 bank_mask:0xf
v_mov_b32_dpp v249, v52 quad_perm:[0,1,2,3] row_mask:0x8 bank_mask:0xf
s_nop 0
v_mov_b32_dpp v248, v40 quad_perm:[0,1,2,3] row_mask:0x4 bank_mask:0xf
v_mov_b32_dpp v249, v44 quad_perm:[0,1,2,3] row_mask:0x4 bank_mask:0xf
v_max_u32 v248, 1, v248
v_max_u32 v249, 1, v249
s_cmp_eq_u32 s63, 0
s_cbranch_scc1 fst_37
fsb_38:
buffer_store_dwordx2 v[248:249], v6, s[24:27], s71 offen sc1
s_lshl4_add_u32 s70, s58, s60
s_add_u32 s70, s70, s34
s_cmp_eq_u32 s70, 51
s_cbranch_scc1 fxt_42
fxb_43:
s_add_u32 s73, s72, 4096
s_add_u32 s74, s72, 8192
s_add_u32 s75, s72, 12288
v_lshrrev_b32 v7, 2, v0
v_lshlrev_b32 v7, 7, v7
v_lshl_add_u32 v7, v1, 2, v7
v_lshrrev_b32 v8, 5, v0
v_lshrrev_b32 v9, 4, v0
v_xor_b32 v10, v8, v9
v_and_b32 v10, 1, v10
v_lshl_add_u32 v8, v10, 1, v8
v_and_b32 v10, 15, v0
v_lshlrev_b32 v8, 7, v8
v_lshl_add_u32 v8, v10, 3, v8
v_add_u32 v8, 1280, v8
s_mul_i32 s70, s58, 384
s_lshl_b32 s71, s63, 10
s_add_u32 s70, s70, s71
s_add_u32 s70, s70, 2304
v_lshl_add_u32 v9, v9, 7, s70
v_lshl_add_u32 v9, v10, 2, v9
s_cmp_eq_u32 s63, 0
s_cbranch_scc1 fg_44
fg_45:
poll_46:
buffer_load_dwordx4 v[12:15], v7, s[24:27], s76 offen sc1
pchk_47:
s_waitcnt vmcnt(0)
v_min3_u32 v10, v12, v13, v14
v_min_u32 v10, v10, v15
v_cmp_eq_u32 vcc, 0, v10
s_cbranch_vccz pdone_48
s_sub_u32 s32, s32, 1
s_cmp_gt_i32 s32, 0
s_cbranch_scc1 poll_46
pdone_48:
s_lshr_b32 s70, s33, 7
s_sub_u32 s70, s70, s59
s_mul_i32 s70, s70, s63
s_cmp_eq_u32 s70, 0
s_cbranch_scc0 fng_49
poll_50:
buffer_load_dwordx2 v[24:25], v6, s[24:27], s72 offen offset:0 sc1
buffer_load_dwordx2 v[26:27], v6, s[24:27], s72 offen offset:1024 sc1
buffer_load_dwordx2 v[28:29], v6, s[24:27], s72 offen offset:2048 sc1
buffer_load_dwordx2 v[30:31], v6, s[24:27], s72 offen offset:3072 sc1
buffer_load_dwordx2 v[32:33], v6, s[24:27], s73 offen offset:0 sc1
buffer_load_dwordx2 v[34:35], v6, s[24:27], s73 offen offset:1024 sc1
buffer_load_dwordx2 v[36:37], v6, s[24:27], s73 offen offset:2048 sc1
buffer_load_dwordx2 v[38:39], v6, s[24:27], s73 offen offset:3072 sc1
buffer_load_dwordx2 v[40:41], v6, s[24:27], s74 offen offset:0 sc1
buffer_load_dwordx2 v[42:43], v6, s[24:27], s74 offen offset:1024 sc1
buffer_load_dwordx2 v[44:45], v6, s[24:27], s74 offen offset:2048 sc1
buffer_load_dwordx2 v[46:47], v6, s[24:27], s74 offen offset:3072 sc1
buffer_load_dwordx2 v[48:49], v6, s[24:27], s75 offen offset:0 sc1
buffer_load_dwordx2 v[50:51], v6, s[24:27], s75 offen offset:1024 sc1
buffer_load_dwordx2 v[52:53], v6, s[24:27], s75 offen offset:2048 sc1
buffer_load_dwordx2 v[54:55], v6, s[24:27], s75 offen offset:3072 sc1
pchk_51:
s_waitcnt vmcnt(14)
v_min3_u32 v10, v24, v25, v26
s_waitcnt vmcnt(13)
v_min3_u32 v10, v10, v27, v28
s_waitcnt vmcnt(12)
v_min3_u32 v10, v10, v29, v30
s_waitcnt vmcnt(11)
v_min3_u32 v10, v10, v31, v32
s_waitcnt vmcnt(10)
v_min3_u32 v10, v10, v33, v34
s_waitcnt vmcnt(9)
v_min3_u32 v10, v10, v35, v36
s_waitcnt vmcnt(8)
v_min3_u32 v10, v10, v37, v38
s_waitcnt vmcnt(7)
v_min3_u32 v10, v10, v39, v40
s_waitcnt vmcnt(6)
v_min3_u32 v10, v10, v41, v42
s_waitcnt vmcnt(5)
v_min3_u32 v10, v10, v43, v44
s_waitcnt vmcnt(4)
v_min3_u32 v10, v10, v45, v46
s_waitcnt vmcnt(3)
v_min3_u32 v10, v10, v47, v48
s_waitcnt vmcnt(2)
v_min3_u32 v10, v10, v49, v50
s_waitcnt vmcnt(1)
v_min3_u32 v10, v10, v51, v52
s_waitcnt vmcnt(0)
v_min3_u32 v10, v10, v53, v54
v_min_u32 v10, v10, v55
v_cmp_eq_u32 vcc, 0, v10
s_cbranch_vccz pdone_52
s_sub_u32 s32, s32, 1
s_cmp_gt_i32 s32, 0
s_cbranch_scc1 poll_50
pdone_52:
v_add_f32 v24, v24, v40
v_add_f32 v25, v25, v41
v_add_f32 v26, v26, v42
v_add_f32 v27, v27, v43
v_add_f32 v28, v28, v44
v_add_f32 v29, v29, v45
v_add_f32 v30, v30, v46
v_add_f32 v31, v31, v47
v_add_f32 v32, v32, v48
v_add_f32 v33, v33, v49
v_add_f32 v34, v34, v50
v_add_f32 v35, v35, v51
v_add_f32 v36, v36, v52
v_add_f32 v37, v37, v53
v_add_f32 v38, v38, v54
v_add_f32 v39, v39, v55
v_add_f32 v24, v24, v32
v_add_f32 v25, v25, v33
v_add_f32 v26, v26, v34
v_add_f32 v27, v27, v35
v_add_f32 v28, v28, v36
v_add_f32 v29, v29, v37
v_add_f32 v30, v30, v38
v_add_f32 v31, v31, v39
v_add_f32 v24, v24, v28
v_add_f32 v25, v25, v29
v_add_f32 v26, v26, v30
v_add_f32 v27, v27, v31
v_add_f32 v24, v24, v26
v_add_f32 v25, v25, v27
s_mov_b32 exec_hi, 0xffff
ds_write2_b32 v9, v24, v25 offset1:16
s_mov_b32 exec_hi, -1
v_mul_f32 v5, 0xba800000, v24
v_mul_f32 v25, 0x3a800000, v25
v_fma_f32 v25, -v5, v5, v25
v_max_f32 v25, 0, v25
v_add_f32 v25, 0x3727c5ac, v25
v_rsq_f32 v24, v25
s_nop 0
v_mul_f32 v25, v5, v24
s_lshl_b32 s70, s59, 7
s_sub_u32 s70, s33, s70
v_lshlrev_b32 v10, 1, v0
v_sub_u32 v10, s70, v10
v_readlane_b32 s70, v24, 48
v_readlane_b32 s71, v25, 48
v_cmp_eq_u32 vcc, 0, v10
s_mov_b64 exec, vcc
v_mov_b32 v12, s70
v_mov_b32 v13, s71
s_mov_b64 exec, -1
v_cmp_eq_u32 vcc, 1, v10
s_mov_b64 exec, vcc
v_mov_b32 v14, s70
v_mov_b32 v15, s71
s_mov_b64 exec, -1
fng_49:
ds_write2_b32 v8, v12, v14 offset1:1
ds_write2_b32 v8, v13, v15 offset0:128 offset1:129
s_add_u32 s71, s34, s63
v_add_u32 v5, s71, 2
s_mov_b64 exec, 1
ds_write_b32 v3, v5
s_mov_b64 exec, -1
s_setprio 0
s_cmp_eq_u32 s63, 0
s_cbranch_scc1 fnw_53
fnw_54:
s_and_b32 s70, s64, 7
s_lshl_b32 s70, s70, 7
s_add_u32 s73, s70, 276480
s_lshl1_add_u32 s72, s70, 272384
s_lshr_b32 s71, s64, 3
s_lshl_b32 s76, s71, 13
s_add_u32 s76, s76, 1048576
s_lshl2_add_u32 s74, s70, s76
s_lshl_b32 s70, s58, 8
s_add_u32 s74, s74, s70
s_add_u32 s75, s74, 4096
s_lshl4_add_u32 s76, s70, s76
v_and_b32 v251, 15, v0
v_lshlrev_b32 v6, 14, v251
v_lshrrev_b32 v252, 4, v0
v_lshl_add_u32 v7, v252, 5, v6
v_lshlrev_b32 v251, 4, v251
s_lshl_b32 s70, s58, 3
v_lshl_add_u32 v253, v252, 1, s70
v_add_u32 v253, v253, v251
v_lshlrev_b32 v254, 5, v252
v_lshl_add_u32 v254, v2, 2, v254
v_and_b32 v255, 7, v0
v_lshl_add_u32 v255, v255, 2, v252
v_lshlrev_b32 v255, 3, v255
s_add_u32 s35, s34, 22
lw_55:
ds_read_b32 v5, v1 offset:0
s_waitcnt lgkmcnt(0)
v_cmp_gt_i32 vcc, s35, v5
s_cbranch_vccz lwd_56
s_sleep 4
s_sub_u32 s32, s32, 1
s_cmp_gt_i32 s32, 0
s_cbranch_scc1 lw_55
lwd_56:
s_setprio 3
s_add_u32 s35, s34, 24
lw_57:
ds_read_b32 v5, v1 offset:0
s_waitcnt lgkmcnt(0)
v_cmp_gt_i32 vcc, s35, v5
s_cbranch_vccz lwd_58
s_sleep 2
s_sub_u32 s32, s32, 1
s_cmp_gt_i32 s32, 0
s_cbranch_scc1 lw_57
lwd_58:
s_mul_i32 s79, s63, 64
s_sub_u32 s79, 32, s79
s_add_u32 s35, s79, 3
lw_59:
ds_read_b32 v5, v2 offset:16
s_waitcnt lgkmcnt(0)
v_cmp_gt_i32 vcc, s35, v5
s_cbranch_vccz lwd_60
s_sleep 4
s_sub_u32 s32, s32, 1
s_cmp_gt_i32 s32, 0
s_cbranch_scc1 lw_59
lwd_60:
s_cmp_eq_u32 s65, 0
s_cbranch_scc0 fnd_62
poll_63:
buffer_load_dwordx2 v[248:249], v6, s[24:27], s73 offen sc1
buffer_load_dwordx4 v[8:11], v7, s[24:27], s72 offen offset:0 sc1
buffer_load_dwordx4 v[12:15], v7, s[24:27], s72 offen offset:16 sc1
buffer_load_dwordx4 v[16:19], v7, s[24:27], s72 offen offset:128 sc1
buffer_load_dwordx4 v[20:23], v7, s[24:27], s72 offen offset:144 sc1
pchk_64:
s_waitcnt vmcnt(3)
v_min3_u32 v5, v248, v249, v8
v_min3_u32 v5, v5, v9, v10
s_waitcnt vmcnt(2)
v_min3_u32 v5, v5, v11, v12
v_min3_u32 v5, v5, v13, v14
s_waitcnt vmcnt(1)
v_min3_u32 v5, v5, v15, v16
v_min3_u32 v5, v5, v17, v18
s_waitcnt vmcnt(0)
v_min3_u32 v5, v5, v19, v20
v_min3_u32 v5, v5, v21, v22
v_min_u32 v5, v5, v23
v_cmp_eq_u32 vcc, 0, v5
s_cbranch_vccz pdone_65
s_sub_u32 s32, s32, 1
s_cmp_gt_i32 s32, 0
s_cbranch_scc1 poll_63
pdone_65:
v_mfma_f32_16x16x32_bf16 v[24:27], v[8:11], v[56:59], 0
v_mov_b32 v250, v248
v_mfma_f32_16x16x32_bf16 v[28:31], v[8:11], v[60:63], 0
s_nop 0
v_max_f32_dpp v250, v250, v250 row_ror:1 row_mask:0xf bank_mask:0xf
v_mfma_f32_16x16x32_bf16 v[32:35], v[8:11], v[64:67], 0
s_nop 0
v_max_f32_dpp v250, v250, v250 row_ror:2 row_mask:0xf bank_mask:0xf
v_mfma_f32_16x16x32_bf16 v[36:39], v[8:11], v[68:71], 0
s_nop 0
v_max_f32_dpp v250, v250, v250 row_ror:4 row_mask:0xf bank_mask:0xf
v_mfma_f32_16x16x32_bf16 v[40:43], v[8:11], v[72:75], 0
s_nop 0
v_max_f32_dpp v250, v250, v250 row_ror:8 row_mask:0xf bank_mask:0xf
v_mfma_f32_16x16x32_bf16 v[44:47], v[8:11], v[76:79], 0
v_cmp_eq_f32 vcc, v250, v248
v_mfma_f32_16x16x32_bf16 v[48:51], v[8:11], v[80:83], 0
s_ff1_i32_b64 s68, vcc
v_mfma_f32_16x16x32_bf16 v[52:55], v[8:11], v[84:87], 0
s_and_b32 s68, s68, 15
v_mfma_f32_16x16x32_bf16 v[24:27], v[12:15], v[88:91], v[24:27]
v_readlane_b32 s33, v249, s68
v_mfma_f32_16x16x32_bf16 v[28:31], v[12:15], v[92:95], v[28:31]
v_readlane_b32 s67, v248, s68
v_mfma_f32_16x16x32_bf16 v[32:35], v[12:15], v[96:99], v[32:35]
v_add_u32 v5, s34, 4
v_mfma_f32_16x16x32_bf16 v[36:39], v[12:15], v[100:103], v[36:39]
v_mov_b32 v250, s33
v_mfma_f32_16x16x32_bf16 v[40:43], v[12:15], v[104:107], v[40:43]
s_mov_b64 exec, 1
ds_write2_b32 v3, v5, v250 offset1:2
s_mov_b64 exec, -1
v_mfma_f32_16x16x32_bf16 v[44:47], v[12:15], v[108:111], v[44:47]
s_sub_u32 s33, s33, 1
v_mfma_f32_16x16x32_bf16 v[48:51], v[12:15], v[112:115], v[48:51]
s_and_b32 s33, s33, 2047
v_mfma_f32_16x16x32_bf16 v[52:55], v[12:15], v[116:119], v[52:55]
v_mfma_f32_16x16x32_bf16 v[24:27], v[16:19], v[120:123], v[24:27]
v_mfma_f32_16x16x32_bf16 v[28:31], v[16:19], v[124:127], v[28:31]
v_mfma_f32_16x16x32_bf16 v[32:35], v[16:19], v[128:131], v[32:35]
v_mfma_f32_16x16x32_bf16 v[36:39], v[16:19], v[132:135], v[36:39]
v_mfma_f32_16x16x32_bf16 v[40:43], v[16:19], v[136:139], v[40:43]
v_mfma_f32_16x16x32_bf16 v[44:47], v[16:19], v[140:143], v[44:47]
v_mfma_f32_16x16x32_bf16 v[48:51], v[16:19], v[144:147], v[48:51]
v_mfma_f32_16x16x32_bf16 v[52:55], v[16:19], v[148:151], v[52:55]
v_mfma_f32_16x16x32_bf16 v[24:27], v[20:23], v[152:155], v[24:27]
s_and_b32 s70, s68, 12
s_lshl_b32 s70, s70, 2
s_bitcmp1_b32 s68, 1
v_mfma_f32_16x16x32_bf16 v[28:31], v[20:23], v[156:159], v[28:31]
v_mfma_f32_16x16x32_bf16 v[32:35], v[20:23], v[160:163], v[32:35]
v_mfma_f32_16x16x32_bf16 v[36:39], v[20:23], v[164:167], v[36:39]
v_mfma_f32_16x16x32_bf16 v[40:43], v[20:23], v[168:171], v[40:43]
v_mfma_f32_16x16x32_bf16 v[44:47], v[20:23], v[172:175], v[44:47]
v_mfma_f32_16x16x32_bf16 v[48:51], v[20:23], v[176:179], v[48:51]
v_mfma_f32_16x16x32_bf16 v[52:55], v[20:23], v[180:183], v[52:55]
s_cbranch_scc1 fsel_68
fsel_66:
s_bitcmp1_b32 s68, 0
s_cbranch_scc1 fsel_67
v_max_u32 v8, 1, v24
v_max_u32 v9, 1, v28
v_max_u32 v10, 1, v32
v_max_u32 v11, 1, v36
v_max_u32 v12, 1, v40
v_max_u32 v13, 1, v44
v_max_u32 v14, 1, v48
v_max_u32 v15, 1, v52
s_branch fsel_70
fsel_67:
v_max_u32 v8, 1, v25
v_max_u32 v9, 1, v29
v_max_u32 v10, 1, v33
v_max_u32 v11, 1, v37
v_max_u32 v12, 1, v41
v_max_u32 v13, 1, v45
v_max_u32 v14, 1, v49
v_max_u32 v15, 1, v53
s_branch fsel_70
fsel_68:
s_bitcmp1_b32 s68, 0
s_cbranch_scc1 fsel_69
v_max_u32 v8, 1, v26
v_max_u32 v9, 1, v30
v_max_u32 v10, 1, v34
v_max_u32 v11, 1, v38
v_max_u32 v12, 1, v42
v_max_u32 v13, 1, v46
v_max_u32 v14, 1, v50
v_max_u32 v15, 1, v54
s_branch fsel_70
fsel_69:
v_max_u32 v8, 1, v27
v_max_u32 v9, 1, v31
v_max_u32 v10, 1, v35
v_max_u32 v11, 1, v39
v_max_u32 v12, 1, v43
v_max_u32 v13, 1, v47
v_max_u32 v14, 1, v51
v_max_u32 v15, 1, v55
fsel_70:
s_bfm_b64 exec, 16, s70
buffer_store_dwordx4 v[8:11], v251, s[24:27], s74 offen sc1
buffer_store_dwordx4 v[12:15], v251, s[24:27], s75 offen sc1
s_mov_b64 exec, -1
s_and_b32 s70, s64, 7
s_lshl1_add_u32 s70, s70, s58
s_mul_i32 s70, s70, 28
s_add_u32 s70, s70, s71
s_lshl_b32 s70, s70, 8
s_add_u32 s70, s70, 1277952
s_waitcnt vmcnt(0)
s_mul_i32 s79, s63, 64
s_sub_u32 s79, 32, s79
s_add_u32 s35, s79, 7
lw_71:
ds_read_b32 v5, v2 offset:16
s_waitcnt lgkmcnt(0)
v_cmp_gt_i32 vcc, s35, v5
s_cbranch_vccz lwd_72
s_sleep 4
s_sub_u32 s32, s32, 1
s_cmp_gt_i32 s32, 0
s_cbranch_scc1 lw_71
lwd_72:
poll_73:
buffer_load_dwordx4 v[24:27], v4, s[24:27], s76 offen offset:0 sc1
buffer_load_dwordx4 v[28:31], v4, s[24:27], s76 offen offset:1024 sc1
buffer_load_dwordx4 v[32:35], v4, s[24:27], s76 offen offset:2048 sc1
buffer_load_dwordx4 v[36:39], v4, s[24:27], s76 offen offset:3072 sc1
pchk_74:
s_waitcnt vmcnt(3)
v_min3_u32 v5, v24, v25, v26
s_waitcnt vmcnt(2)
v_min3_u32 v5, v5, v27, v28
v_min3_u32 v5, v5, v29, v30
s_waitcnt vmcnt(1)
v_min3_u32 v5, v5, v31, v32
v_min3_u32 v5, v5, v33, v34
s_waitcnt vmcnt(0)
v_min3_u32 v5, v5, v35, v36
v_min3_u32 v5, v5, v37, v38
v_min_u32 v5, v5, v39
v_cmp_eq_u32 vcc, 0, v5
s_cbranch_vccz pdone_75
s_sub_u32 s32, s32, 1
s_cmp_gt_i32 s32, 0
s_cbranch_scc1 poll_73
pdone_75:
v_add_f32 v24, v24, v32
v_add_f32 v25, v25, v33
v_add_f32 v26, v26, v34
v_add_f32 v27, v27, v35
v_add_f32 v28, v28, v36
v_add_f32 v29, v29, v37
v_add_f32 v30, v30, v38
v_add_f32 v31, v31, v39
v_add_f32 v24, v24, v28
v_add_f32 v25, v25, v29
v_add_f32 v26, v26, v30
v_add_f32 v27, v27, v31
s_nop 0
v_permlane32_swap_b32 v24, v26
v_permlane32_swap_b32 v25, v27
v_add_f32 v24, v24, v26
v_add_f32 v25, v25, v27
s_nop 1
v_permlane16_swap_b32 v24, v25
v_mul_f32 v26, 0xbfb8aa3b, v24
v_exp_f32 v26, v26
v_mul_f32 v24, v24, v25
v_add_f32 v26, 1.0, v26
v_rcp_f32 v26, v26
v_add_u32 v5, s34, 5
v_mul_f32 v24, v24, v26
v_cvt_pk_bf16_f32 v24, v24, v24
ds_write_b16 v253, v24 offset:512
s_mov_b64 exec, 1
ds_write_b32 v3, v5
s_mov_b64 exec, -1
s_add_u32 s35, s34, 5
poll_76:
ds_read_b32 v5, v2 offset:24
ds_read_b128 v[8:11], v254 offset:512
ds_read_b128 v[12:15], v254 offset:640
pchk_77:
s_waitcnt lgkmcnt(2)
v_cmp_gt_i32 vcc, s35, v5
s_cbranch_vccz pdone_78
s_sleep 1
s_sub_u32 s32, s32, 1
s_cmp_gt_i32 s32, 0
s_cbranch_scc1 poll_76
pdone_78:
s_waitcnt lgkmcnt(1)
v_mfma_f32_16x16x32_bf16 v[24:27], v[8:11], v[184:187], 0
v_mfma_f32_16x16x32_bf16 v[28:31], v[8:11], v[188:191], 0
v_mfma_f32_16x16x32_bf16 v[32:35], v[8:11], v[192:195], 0
v_mfma_f32_16x16x32_bf16 v[36:39], v[8:11], v[196:199], 0
v_mfma_f32_16x16x32_bf16 v[40:43], v[8:11], v[200:203], 0
v_mfma_f32_16x16x32_bf16 v[44:47], v[8:11], v[204:207], 0
v_mfma_f32_16x16x32_bf16 v[48:51], v[8:11], v[208:211], 0
v_mfma_f32_16x16x32_bf16 v[52:55], v[8:11], v[212:215], 0
s_waitcnt lgkmcnt(0)
v_mfma_f32_16x16x32_bf16 v[24:27], v[12:15], v[216:219], v[24:27]
v_mfma_f32_16x16x32_bf16 v[28:31], v[12:15], v[220:223], v[28:31]
v_mfma_f32_16x16x32_bf16 v[32:35], v[12:15], v[224:227], v[32:35]
v_mfma_f32_16x16x32_bf16 v[36:39], v[12:15], v[228:231], v[36:39]
v_mfma_f32_16x16x32_bf16 v[40:43], v[12:15], v[232:235], v[40:43]
v_mfma_f32_16x16x32_bf16 v[44:47], v[12:15], v[236:239], v[44:47]
v_mfma_f32_16x16x32_bf16 v[48:51], v[12:15], v[240:243], v[48:51]
v_mfma_f32_16x16x32_bf16 v[52:55], v[12:15], v[244:247], v[52:55]
s_nop 0
v_add_f32_dpp v16, v25, v24 row_ror:8 row_mask:0x1 bank_mask:0xf
v_add_f32_dpp v17, v29, v28 row_ror:8 row_mask:0x1 bank_mask:0xf
s_nop 0
v_add_f32_dpp v16, v33, v32 row_ror:8 row_mask:0x2 bank_mask:0xf
v_add_f32_dpp v17, v37, v36 row_ror:8 row_mask:0x2 bank_mask:0xf
s_nop 0
v_add_f32_dpp v16, v41, v40 row_ror:8 row_mask:0x4 bank_mask:0xf
v_add_f32_dpp v17, v45, v44 row_ror:8 row_mask:0x4 bank_mask:0xf
s_nop 0
v_add_f32_dpp v16, v49, v48 row_ror:8 row_mask:0x8 bank_mask:0xf
v_add_f32_dpp v17, v53, v52 row_ror:8 row_mask:0x8 bank_mask:0xf
v_max_u32 v16, 1, v16
v_max_u32 v17, 1, v17
s_mov_b32 exec_lo, 0x00ff00ff
s_mov_b32 exec_hi, 0x00ff00ff
buffer_store_dwordx2 v[16:17], v255, s[24:27], s70 offen sc1
s_mov_b64 exec, -1
fnd_61:
s_sub_u32 s70, s60, 3
s_mul_i32 s70, s70, s63
s_or_b32 s70, s70, s58
s_cbranch_scc1 fnr_79
s_mul_i32 s72, s59, 7168
s_add_u32 s72, s72, 1277952
s_add_u32 s73, s72, 4096
s_lshl_b32 s70, s68, 6
s_add_u32 s70, s70, s59
s_lshl_b32 s70, s70, 8
s_add_u32 s76, s70, 262144
v_mov_b32 v12, s67
v_mul_f32 v12, 0xbfb8aa3b, v12
v_exp_f32 v12, v12
v_lshl_add_u32 v6, v252, 2, v251
v_add_f32 v12, 1.0, v12
v_rcp_f32 v12, v12
v_lshrrev_b32 v7, 1, v6
s_lshl4_add_u32 s70, s33, s59
s_lshl_b32 s70, s70, 7
v_and_b32 v8, 0x46, v7
v_lshl_add_u32 v8, v1, 2, v8
v_and_b32 v9, 4, v0
v_lshl_add_u32 v8, v9, 1, v8
s_waitcnt vmcnt(0)
s_cmp_gt_u32 s65, s63
s_cbranch_scc1 fpre_81
fpre_82:
s_mul_i32 s79, s63, 64
s_sub_u32 s79, 32, s79
s_add_u32 s35, s79, 11
lw_83:
ds_read_b32 v5, v2 offset:16
s_waitcnt lgkmcnt(0)
v_cmp_gt_i32 vcc, s35, v5
s_cbranch_vccz lwd_84
s_sleep 4
s_sub_u32 s32, s32, 1
s_cmp_gt_i32 s32, 0
s_cbranch_scc1 lw_83
lwd_84:
poll_85:
buffer_load_dword v52, v6, s[24:27], s76 offen sc1
buffer_load_dwordx4 v[24:27], v4, s[24:27], s72 offen offset:0 sc1
buffer_load_dwordx4 v[28:31], v4, s[24:27], s72 offen offset:1024 sc1
buffer_load_dwordx4 v[32:35], v4, s[24:27], s72 offen offset:2048 sc1
buffer_load_dwordx4 v[36:39], v4, s[24:27], s72 offen offset:3072 sc1
buffer_load_dwordx4 v[40:43], v4, s[24:27], s73 offen offset:0 sc1
buffer_load_dwordx4 v[44:47], v4, s[24:27], s73 offen offset:1024 sc1
buffer_load_dwordx4 v[48:51], v4, s[24:27], s73 offen offset:2048 sc1
pchk_86:
s_waitcnt vmcnt(6)
v_min3_u32 v5, v24, v25, v26
s_waitcnt vmcnt(5)
v_min3_u32 v5, v5, v27, v28
v_min3_u32 v5, v5, v29, v30
s_waitcnt vmcnt(4)
v_min3_u32 v5, v5, v31, v32
v_min3_u32 v5, v5, v33, v34
s_waitcnt vmcnt(3)
v_min3_u32 v5, v5, v35, v36
v_min3_u32 v5, v5, v37, v38
s_waitcnt vmcnt(2)
v_min3_u32 v5, v5, v39, v40
v_min3_u32 v5, v5, v41, v42
s_waitcnt vmcnt(1)
v_min3_u32 v5, v5, v43, v44
v_min3_u32 v5, v5, v45, v46
s_waitcnt vmcnt(0)
v_min3_u32 v5, v5, v47, v48
v_min3_u32 v5, v5, v49, v50
v_min3_u32 v5, v5, v51, v52
v_cmp_eq_u32 vcc, 0, v5
s_cbranch_vccz pdone_87
s_sub_u32 s32, s32, 1
s_cmp_gt_i32 s32, 0
s_cbranch_scc1 poll_85
pdone_87:
v_add_f32 v24, v24, v40
v_add_f32 v25, v25, v41
v_add_f32 v26, v26, v42
v_add_f32 v27, v27, v43
v_add_f32 v28, v28, v44
v_add_f32 v29, v29, v45
v_add_f32 v30, v30, v46
v_add_f32 v31, v31, v47
v_add_f32 v32, v32, v48
v_add_f32 v33, v33, v49
v_add_f32 v34, v34, v50
v_add_f32 v35, v35, v51
v_add_f32 v24, v24, v32
v_add_f32 v25, v25, v33
v_add_f32 v26, v26, v34
v_add_f32 v27, v27, v35
v_add_f32 v28, v28, v36
v_add_f32 v29, v29, v37
v_add_f32 v30, v30, v38
v_add_f32 v31, v31, v39
v_add_f32 v24, v24, v28
v_add_f32 v25, v25, v29
v_add_f32 v26, v26, v30
v_add_f32 v27, v27, v31
s_nop 0
v_permlane32_swap_b32 v24, v26
v_permlane32_swap_b32 v25, v27
v_add_f32 v24, v24, v26
v_add_f32 v25, v25, v27
s_nop 1
v_permlane16_swap_b32 v24, v25
v_add_f32 v24, v24, v25
v_fma_f32 v24, v24, v12, v52
v_cvt_pk_bf16_f32 v24, v24, v24
s_cmp_eq_u32 s63, 0
s_cbranch_scc1 fl0_80
buffer_store_short v24, v7, s[28:31], s70 offen
s_branch L_end
fl0_80:
ds_write_b16 v8, v24 offset:384
fnr_79:
s_cmp_eq_u32 s63, 0
s_cbranch_scc0 L_end
v_add_u32 v5, s34, 6
s_mov_b64 exec, 1
ds_write_b32 v3, v5
s_mov_b64 exec, -1
v_and_b32 v6, 48, v0
s_add_u32 s35, s34, 6
poll_88:
ds_read_b32 v5, v2 offset:24
ds_read_b128 v[8:11], v6 offset:384
ds_read_b128 v[12:15], v6 offset:448
pchk_89:
s_waitcnt lgkmcnt(2)
v_cmp_gt_i32 vcc, s35, v5
s_cbranch_vccz pdone_90
s_sleep 1
s_sub_u32 s32, s32, 1
s_cmp_gt_i32 s32, 0
s_cbranch_scc1 poll_88
pdone_90:
s_mov_b32 s63, 1
s_mov_b32 s34, 32
s_add_u32 s24, s24, 1409024
s_addc_u32 s25, s25, 0
s_mov_b32 s26, 1409024
s_mov_b32 s70, 131072
s_mov_b32 s79, 34
s_branch ftop_39
fxt_42:
v_max_u32 v8, 1, v8
v_max_u32 v9, 1, v9
v_max_u32 v10, 1, v10
v_max_u32 v11, 1, v11
v_max_u32 v12, 1, v12
v_max_u32 v13, 1, v13
v_max_u32 v14, 1, v14
v_max_u32 v15, 1, v15
s_mov_b32 exec_lo, 0x10001
s_mov_b32 exec_hi, 0x10001
buffer_store_dwordx4 v[8:11], v7, s[20:23], s73 offen offset:0 sc1
buffer_store_dwordx4 v[12:15], v7, s[20:23], s73 offen offset:64 sc1
s_mov_b64 exec, -1
s_branch fxb_43
fst_37:
s_lshl1_add_u32 s70, s78, s58
s_lshl_b32 s70, s70, 13
v_bfe_u32 v8, v0, 2, 2
v_lshl_add_u32 v8, v8, 9, v7
v_add_u32 v8, v8, v1
v_lshlrev_b32 v8, 2, v8
buffer_load_dwordx4 v[24:27], v8, s[8:11], s70 offen offset:0
buffer_load_dwordx4 v[28:31], v8, s[8:11], s70 offen offset:256
buffer_load_dwordx4 v[32:35], v8, s[8:11], s70 offen offset:512
buffer_load_dwordx4 v[36:39], v8, s[8:11], s70 offen offset:768
buffer_load_dwordx4 v[40:43], v8, s[8:11], s70 offen offset:1024
buffer_load_dwordx4 v[44:47], v8, s[8:11], s70 offen offset:1280
buffer_load_dwordx4 v[48:51], v8, s[8:11], s70 offen offset:1536
buffer_load_dwordx4 v[52:55], v8, s[8:11], s70 offen offset:1792
v_lshlrev_b32 v9, 4, v1
s_waitcnt vmcnt(7)
v_mfma_f32_16x16x32_bf16 v[16:19], v[24:27], v[252:255], 0
v_mfma_f32_16x16x32_bf16 v[20:23], v[24:27], v[24:27], 0
s_waitcnt vmcnt(6)
v_mfma_f32_16x16x32_bf16 v[16:19], v[28:31], v[252:255], v[16:19]
v_mfma_f32_16x16x32_bf16 v[20:23], v[28:31], v[28:31], v[20:23]
s_waitcnt vmcnt(5)
v_mfma_f32_16x16x32_bf16 v[16:19], v[32:35], v[252:255], v[16:19]
v_mfma_f32_16x16x32_bf16 v[20:23], v[32:35], v[32:35], v[20:23]
s_waitcnt vmcnt(4)
v_mfma_f32_16x16x32_bf16 v[16:19], v[36:39], v[252:255], v[16:19]
v_mfma_f32_16x16x32_bf16 v[20:23], v[36:39], v[36:39], v[20:23]
s_waitcnt vmcnt(3)
v_mfma_f32_16x16x32_bf16 v[16:19], v[40:43], v[252:255], v[16:19]
v_mfma_f32_16x16x32_bf16 v[20:23], v[40:43], v[40:43], v[20:23]
s_waitcnt vmcnt(2)
v_mfma_f32_16x16x32_bf16 v[16:19], v[44:47], v[252:255], v[16:19]
v_mfma_f32_16x16x32_bf16 v[20:23], v[44:47], v[44:47], v[20:23]
s_waitcnt vmcnt(1)
v_mfma_f32_16x16x32_bf16 v[16:19], v[48:51], v[252:255], v[16:19]
v_mfma_f32_16x16x32_bf16 v[20:23], v[48:51], v[48:51], v[20:23]
s_waitcnt vmcnt(0)
v_mfma_f32_16x16x32_bf16 v[16:19], v[52:55], v[252:255], v[16:19]
v_mfma_f32_16x16x32_bf16 v[20:23], v[52:55], v[52:55], v[20:23]
s_nop 6
v_add_f32 v16, v16, v18
v_add_f32 v17, v17, v19
v_add_f32 v16, v16, v17
s_nop 0
v_mov_b32_dpp v17, v20 quad_perm:[0,0,0,0] row_mask:0xf bank_mask:0xf
s_nop 1
v_add_f32_dpp v17, v21, v17 quad_perm:[1,1,1,1] row_mask:0xf bank_mask:0xf
s_nop 1
v_add_f32_dpp v17, v22, v17 quad_perm:[2,2,2,2] row_mask:0xf bank_mask:0xf
s_nop 1
v_add_f32_dpp v17, v23, v17 quad_perm:[3,3,3,3] row_mask:0xf bank_mask:0xf
v_mul_f32 v5, 0xba800000, v16
v_mul_f32 v17, 0x3a800000, v17
v_fma_f32 v17, -v5, v5, v17
v_max_f32 v17, 0, v17
v_add_f32 v17, 0x3727c5ac, v17
v_rsq_f32 v16, v17
s_nop 0
v_mul_f32 v17, v5, v16
v_max_u32 v17, 1, v17
s_lshl_b32 s70, s60, 7
s_add_u32 s70, s70, s76
s_lshl_b32 s73, s58, 5
s_add_u32 s70, s70, s73
v_lshrrev_b32 v7, 1, v7
s_add_u32 s35, s34, 5
lw_91:
ds_read_b32 v5, v2 offset:16
s_waitcnt lgkmcnt(0)
v_cmp_gt_i32 vcc, s35, v5
s_cbranch_vccz lwd_92
s_sleep 4
s_sub_u32 s32, s32, 1
s_cmp_gt_i32 s32, 0
s_cbranch_scc1 lw_91
lwd_92:
poll_93:
buffer_load_dword v12, v9, s[4:7], 0 offen sc1
pchk_94:
s_waitcnt vmcnt(0)
v_cmp_gt_u32 vcc, 64, v12
s_cbranch_vccz pdone_95
s_sleep 16
s_sub_u32 s32, s32, 1
s_cmp_gt_i32 s32, 0
s_cbranch_scc1 poll_93
pdone_95:
s_mov_b32 exec_lo, 0x00100001
s_mov_b32 exec_hi, 0x10000100
buffer_store_dwordx2 v[16:17], v7, s[24:27], s70 offen sc1
s_getreg_b32 s73, hwreg(HW_REG_XCC_ID)
s_mov_b64 exec, 1
v_add_u32 v12, s73, 1
buffer_store_dword v12, off, s[24:27], s70 offset:64 sc1
s_mov_b64 exec, -1
s_branch fsb_38
fg_44:
s_lshl1_add_u32 s35, s2, s58
s_lshl_b32 s35, s35, 12
s_add_u32 s44, s40, s35
s_addc_u32 s45, s41, 0
s_mov_b32 s35, 4
ft_96:
s_load_dwordx2 s[42:43], s[44:45], 60
s_load_dwordx2 s[42:43], s[44:45], 188
s_load_dwordx2 s[42:43], s[44:45], 316
s_load_dwordx2 s[42:43], s[44:45], 444
s_load_dwordx2 s[42:43], s[44:45], 572
s_load_dwordx2 s[42:43], s[44:45], 700
s_load_dwordx2 s[42:43], s[44:45], 828
s_load_dwordx2 s[42:43], s[44:45], 956
s_add_u32 s44, s44, 1024
s_addc_u32 s45, s45, 0
s_sub_u32 s35, s35, 1
s_cmp_eq_u32 s35, 0
s_cbranch_scc0 ft_96
v_lshrrev_b32 v250, 3, v0
v_mul_u32_u24 v250, 16256, v250
v_add_u32 v250, v250, v4
s_add_u32 s35, s66, 131072
buffer_load_dwordx4 v[184:187], v250, s[12:15], s35 offen nt
s_add_u32 s35, s66, 133120
buffer_load_dwordx4 v[188:191], v250, s[12:15], s35 offen nt
s_add_u32 s35, s66, 135168
buffer_load_dwordx4 v[192:195], v250, s[12:15], s35 offen nt
s_add_u32 s35, s66, 137216
buffer_load_dwordx4 v[196:199], v250, s[12:15], s35 offen nt
s_add_u32 s35, s66, 139264
buffer_load_dwordx4 v[200:203], v250, s[12:15], s35 offen nt
s_add_u32 s35, s66, 141312
buffer_load_dwordx4 v[204:207], v250, s[12:15], s35 offen nt
s_add_u32 s35, s66, 143360
buffer_load_dwordx4 v[208:211], v250, s[12:15], s35 offen nt
s_add_u32 s35, s66, 145408
buffer_load_dwordx4 v[212:215], v250, s[12:15], s35 offen nt
v_lshrrev_b32 v250, 3, v0
v_mul_u32_u24 v250, 16256, v250
v_add_u32 v250, v250, v4
s_add_u32 s35, s66, 0
buffer_load_dwordx4 v[152:155], v250, s[12:15], s35 offen nt
s_add_u32 s35, s66, 2048
buffer_load_dwordx4 v[156:159], v250, s[12:15], s35 offen nt
s_add_u32 s35, s66, 4096
buffer_load_dwordx4 v[160:163], v250, s[12:15], s35 offen nt
s_add_u32 s35, s66, 6144
buffer_load_dwordx4 v[164:167], v250, s[12:15], s35 offen nt
s_add_u32 s35, s66, 8192
buffer_load_dwordx4 v[168:171], v250, s[12:15], s35 offen nt
s_add_u32 s35, s66, 10240
buffer_load_dwordx4 v[172:175], v250, s[12:15], s35 offen nt
s_add_u32 s35, s66, 12288
buffer_load_dwordx4 v[176:179], v250, s[12:15], s35 offen nt
s_add_u32 s35, s66, 14336
buffer_load_dwordx4 v[180:183], v250, s[12:15], s35 offen nt
s_add_u32 s35, s34, 10
lw_97:
ds_read_b32 v5, v2 offset:16
s_waitcnt lgkmcnt(0)
v_cmp_gt_i32 vcc, s35, v5
s_cbranch_vccz lwd_98
s_sleep 4
s_sub_u32 s32, s32, 1
s_cmp_gt_i32 s32, 0
s_cbranch_scc1 lw_97
lwd_98:
v_and_b32 v10, 0x7a0, v7
s_getreg_b32 s70, hwreg(HW_REG_XCC_ID)
s_add_u32 s70, s70, 1
poll_99:
buffer_load_dword v12, v10, s[24:27], s76 offen offset:64 sc1
pchk_100:
s_waitcnt vmcnt(0)
v_cmp_eq_u32 vcc, 0, v12
s_cbranch_vccz pdone_101
s_sub_u32 s32, s32, 1
s_cmp_gt_i32 s32, 0
s_cbranch_scc1 poll_99
pdone_101:
v_cmp_eq_u32 vcc, s70, v12
s_cmp_eq_u64 vcc, exec
s_cselect_b32 s70, 1, 0
v_mov_b32 v12, s70
v_mov_b32 v10, 0
s_mov_b64 exec, 1
ds_write_b32 v10, v12 offset:56
s_mov_b64 exec, -1
s_branch fg_45
fnw_53:
s_waitcnt lgkmcnt(0)
v_mov_b32 v252, 0
v_mov_b32 v253, 0
v_mov_b32 v254, 0
v_mov_b32 v255, 0
s_mul_i32 s42, s58, 1409024
s_mul_i32 s35, s78, 2048
s_add_u32 s35, s35, s42
s_add_u32 s35, s35, 524288
buffer_store_dwordx4 v[252:255], v4, s[24:27], s35 offen offset:0 sc1
buffer_store_dwordx4 v[252:255], v4, s[24:27], s35 offen offset:1024 sc1
s_mul_i32 s35, s78, 1408
s_add_u32 s35, s35, s42
s_add_u32 s35, s35, 1048576
buffer_store_dwordx4 v[252:255], v4, s[24:27], s35 offen offset:0 sc1
buffer_store_dwordx4 v[252:255], v4, s[24:27], s35 offen offset:384 sc1
s_lshl_b32 s35, s78, 10
s_add_u32 s35, s35, 1409024
s_cmp_eq_u32 s58, 1
s_cselect_b64 exec, -1, 0
buffer_store_dwordx4 v[252:255], v4, s[24:27], s35 offen offset:0 sc1
s_add_u32 s35, s35, 262144
buffer_store_dwordx4 v[252:255], v4, s[24:27], s35 offen offset:0 sc1
s_mov_b64 exec, -1
s_waitcnt vmcnt(0)
v_add_u32 v5, s34, 3
s_mov_b64 exec, 1
ds_write_b32 v3, v5
s_mov_b64 exec, -1
s_add_u32 s35, s34, 17
lw_102:
ds_read_b32 v5, v2 offset:16
s_waitcnt lgkmcnt(0)
v_cmp_gt_i32 vcc, s35, v5
s_cbranch_vccz lwd_103
s_sleep 4
s_sub_u32 s32, s32, 1
s_cmp_gt_i32 s32, 0
s_cbranch_scc1 lw_102
lwd_103:
v_lshrrev_b32 v250, 4, v0
v_mul_u32_u24 v250, 28416, v250
v_add_u32 v250, v250, v4
s_add_u32 s35, s77, 688128
buffer_load_dwordx4 v[120:123], v250, s[16:19], s35 offen nt
s_add_u32 s35, s77, 695296
buffer_load_dwordx4 v[124:127], v250, s[16:19], s35 offen nt
s_add_u32 s35, s77, 702464
buffer_load_dwordx4 v[128:131], v250, s[16:19], s35 offen nt
s_add_u32 s35, s77, 709632
buffer_load_dwordx4 v[132:135], v250, s[16:19], s35 offen nt
s_add_u32 s35, s77, 802816
buffer_load_dwordx4 v[136:139], v250, s[16:19], s35 offen nt
s_add_u32 s35, s77, 809984
buffer_load_dwordx4 v[140:143], v250, s[16:19], s35 offen nt
s_add_u32 s35, s77, 817152
buffer_load_dwordx4 v[144:147], v250, s[16:19], s35 offen nt
s_add_u32 s35, s77, 824320
buffer_load_dwordx4 v[148:151], v250, s[16:19], s35 offen nt
v_lshrrev_b32 v250, 4, v0
v_mul_u32_u24 v250, 28416, v250
v_add_u32 v250, v250, v4
s_add_u32 s35, s77, 458752
buffer_load_dwordx4 v[88:91], v250, s[16:19], s35 offen nt
s_add_u32 s35, s77, 465920
buffer_load_dwordx4 v[92:95], v250, s[16:19], s35 offen nt
s_add_u32 s35, s77, 473088
buffer_load_dwordx4 v[96:99], v250, s[16:19], s35 offen nt
s_add_u32 s35, s77, 480256
buffer_load_dwordx4 v[100:103], v250, s[16:19], s35 offen nt
s_add_u32 s35, s77, 573440
buffer_load_dwordx4 v[104:107], v250, s[16:19], s35 offen nt
s_add_u32 s35, s77, 580608
buffer_load_dwordx4 v[108:111], v250, s[16:19], s35 offen nt
s_add_u32 s35, s77, 587776
buffer_load_dwordx4 v[112:115], v250, s[16:19], s35 offen nt
s_add_u32 s35, s77, 594944
buffer_load_dwordx4 v[116:119], v250, s[16:19], s35 offen nt
v_lshrrev_b32 v250, 4, v0
v_mul_u32_u24 v250, 28416, v250
v_add_u32 v250, v250, v4
s_add_u32 s35, s77, 229376
buffer_load_dwordx4 v[56:59], v250, s[16:19], s35 offen nt
s_add_u32 s35, s77, 236544
buffer_load_dwordx4 v[60:63], v250, s[16:19], s35 offen nt
s_add_u32 s35, s77, 243712
buffer_load_dwordx4 v[64:67], v250, s[16:19], s35 offen nt
s_add_u32 s35, s77, 250880
buffer_load_dwordx4 v[68:71], v250, s[16:19], s35 offen nt
s_add_u32 s35, s77, 344064
buffer_load_dwordx4 v[72:75], v250, s[16:19], s35 offen nt
s_add_u32 s35, s77, 351232
buffer_load_dwordx4 v[76:79], v250, s[16:19], s35 offen nt
s_add_u32 s35, s77, 358400
buffer_load_dwordx4 v[80:83], v250, s[16:19], s35 offen nt
s_add_u32 s35, s77, 365568
buffer_load_dwordx4 v[84:87], v250, s[16:19], s35 offen nt
v_lshrrev_b32 v250, 4, v0
v_mul_u32_u24 v250, 28416, v250
v_add_u32 v250, v250, v4
s_add_u32 s35, s77, 0
buffer_load_dwordx4 v[24:27], v250, s[16:19], s35 offen nt
s_add_u32 s35, s77, 7168
buffer_load_dwordx4 v[28:31], v250, s[16:19], s35 offen nt
s_add_u32 s35, s77, 14336
buffer_load_dwordx4 v[32:35], v250, s[16:19], s35 offen nt
s_add_u32 s35, s77, 21504
buffer_load_dwordx4 v[36:39], v250, s[16:19], s35 offen nt
s_add_u32 s35, s77, 114688
buffer_load_dwordx4 v[40:43], v250, s[16:19], s35 offen nt
s_add_u32 s35, s77, 121856
buffer_load_dwordx4 v[44:47], v250, s[16:19], s35 offen nt
s_add_u32 s35, s77, 129024
buffer_load_dwordx4 v[48:51], v250, s[16:19], s35 offen nt
s_add_u32 s35, s77, 136192
buffer_load_dwordx4 v[52:55], v250, s[16:19], s35 offen nt
s_waitcnt lgkmcnt(0)
s_mov_b32 s42, 0x05040100
s_mov_b32 s43, 0x07060302
s_cmp_eq_u32 s65, 0
s_cbranch_scc0 fq_104
v_perm_b32 v216, v188, v184, s42
v_perm_b32 v220, v188, v184, s43
v_perm_b32 v224, v189, v185, s42
v_perm_b32 v228, v189, v185, s43
v_perm_b32 v232, v190, v186, s42
v_perm_b32 v236, v190, v186, s43
v_perm_b32 v240, v191, v187, s42
v_perm_b32 v244, v191, v187, s43
v_perm_b32 v217, v196, v192, s42
v_perm_b32 v221, v196, v192, s43
v_perm_b32 v225, v197, v193, s42
v_perm_b32 v229, v197, v193, s43
v_perm_b32 v233, v198, v194, s42
v_perm_b32 v237, v198, v194, s43
v_perm_b32 v241, v199, v195, s42
v_perm_b32 v245, v199, v195, s43
v_perm_b32 v218, v204, v200, s42
v_perm_b32 v222, v204, v200, s43
v_perm_b32 v226, v205, v201, s42
v_perm_b32 v230, v205, v201, s43
v_perm_b32 v234, v206, v202, s42
v_perm_b32 v238, v206, v202, s43
v_perm_b32 v242, v207, v203, s42
v_perm_b32 v246, v207, v203, s43
v_perm_b32 v219, v212, v208, s42
v_perm_b32 v223, v212, v208, s43
v_perm_b32 v227, v213, v209, s42
v_perm_b32 v231, v213, v209, s43
v_perm_b32 v235, v214, v210, s42
v_perm_b32 v239, v214, v210, s43
v_perm_b32 v243, v215, v211, s42
v_perm_b32 v247, v215, v211, s43
v_perm_b32 v184, v156, v152, s42
v_perm_b32 v188, v156, v152, s43
v_perm_b32 v192, v157, v153, s42
v_perm_b32 v196, v157, v153, s43
v_perm_b32 v200, v158, v154, s42
v_perm_b32 v204, v158, v154, s43
v_perm_b32 v208, v159, v155, s42
v_perm_b32 v212, v159, v155, s43
v_perm_b32 v185, v164, v160, s42
v_perm_b32 v189, v164, v160, s43
v_perm_b32 v193, v165, v161, s42
v_perm_b32 v197, v165, v161, s43
v_perm_b32 v201, v166, v162, s42
v_perm_b32 v205, v166, v162, s43
v_perm_b32 v209, v167, v163, s42
v_perm_b32 v213, v167, v163, s43
v_perm_b32 v186, v172, v168, s42
v_perm_b32 v190, v172, v168, s43
v_perm_b32 v194, v173, v169, s42
v_perm_b32 v198, v173, v169, s43
v_perm_b32 v202, v174, v170, s42
v_perm_b32 v206, v174, v170, s43
v_perm_b32 v210, v175, v171, s42
v_perm_b32 v214, v175, v171, s43
v_perm_b32 v187, v180, v176, s42
v_perm_b32 v191, v180, v176, s43
v_perm_b32 v195, v181, v177, s42
v_perm_b32 v199, v181, v177, s43
v_perm_b32 v203, v182, v178, s42
v_perm_b32 v207, v182, v178, s43
v_perm_b32 v211, v183, v179, s42
v_perm_b32 v215, v183, v179, s43
s_waitcnt vmcnt(30)
v_perm_b32 v152, v124, v120, s42
v_perm_b32 v156, v124, v120, s43
v_perm_b32 v160, v125, v121, s42
v_perm_b32 v164, v125, v121, s43
v_perm_b32 v168, v126, v122, s42
v_perm_b32 v172, v126, v122, s43
v_perm_b32 v176, v127, v123, s42
v_perm_b32 v180, v127, v123, s43
s_waitcnt vmcnt(28)
v_perm_b32 v153, v132, v128, s42
v_perm_b32 v157, v132, v128, s43
v_perm_b32 v161, v133, v129, s42
v_perm_b32 v165, v133, v129, s43
v_perm_b32 v169, v134, v130, s42
v_perm_b32 v173, v134, v130, s43
v_perm_b32 v177, v135, v131, s42
v_perm_b32 v181, v135, v131, s43
s_waitcnt vmcnt(26)
v_perm_b32 v154, v140, v136, s42
v_perm_b32 v158, v140, v136, s43
v_perm_b32 v162, v141, v137, s42
v_perm_b32 v166, v141, v137, s43
v_perm_b32 v170, v142, v138, s42
v_perm_b32 v174, v142, v138, s43
v_perm_b32 v178, v143, v139, s42
v_perm_b32 v182, v143, v139, s43
s_waitcnt vmcnt(24)
v_perm_b32 v155, v148, v144, s42
v_perm_b32 v159, v148, v144, s43
v_perm_b32 v163, v149, v145, s42
v_perm_b32 v167, v149, v145, s43
v_perm_b32 v171, v150, v146, s42
v_perm_b32 v175, v150, v146, s43
v_perm_b32 v179, v151, v147, s42
v_perm_b32 v183, v151, v147, s43
s_waitcnt vmcnt(22)
v_perm_b32 v120, v92, v88, s42
v_perm_b32 v124, v92, v88, s43
v_perm_b32 v128, v93, v89, s42
v_perm_b32 v132, v93, v89, s43
v_perm_b32 v136, v94, v90, s42
v_perm_b32 v140, v94, v90, s43
v_perm_b32 v144, v95, v91, s42
v_perm_b32 v148, v95, v91, s43
s_waitcnt vmcnt(20)
v_perm_b32 v121, v100, v96, s42
v_perm_b32 v125, v100, v96, s43
v_perm_b32 v129, v101, v97, s42
v_perm_b32 v133, v101, v97, s43
v_perm_b32 v137, v102, v98, s42
v_perm_b32 v141, v102, v98, s43
v_perm_b32 v145, v103, v99, s42
v_perm_b32 v149, v103, v99, s43
s_waitcnt vmcnt(18)
v_perm_b32 v122, v108, v104, s42
v_perm_b32 v126, v108, v104, s43
v_perm_b32 v130, v109, v105, s42
v_perm_b32 v134, v109, v105, s43
v_perm_b32 v138, v110, v106, s42
v_perm_b32 v142, v110, v106, s43
v_perm_b32 v146, v111, v107, s42
v_perm_b32 v150, v111, v107, s43
s_waitcnt vmcnt(16)
v_perm_b32 v123, v116, v112, s42
v_perm_b32 v127, v116, v112, s43
v_perm_b32 v131, v117, v113, s42
v_perm_b32 v135, v117, v113, s43
v_perm_b32 v139, v118, v114, s42
v_perm_b32 v143, v118, v114, s43
v_perm_b32 v147, v119, v115, s42
v_perm_b32 v151, v119, v115, s43
s_waitcnt vmcnt(14)
v_perm_b32 v88, v60, v56, s42
v_perm_b32 v92, v60, v56, s43
v_perm_b32 v96, v61, v57, s42
v_perm_b32 v100, v61, v57, s43
v_perm_b32 v104, v62, v58, s42
v_perm_b32 v108, v62, v58, s43
v_perm_b32 v112, v63, v59, s42
v_perm_b32 v116, v63, v59, s43
s_waitcnt vmcnt(12)
v_perm_b32 v89, v68, v64, s42
v_perm_b32 v93, v68, v64, s43
v_perm_b32 v97, v69, v65, s42
v_perm_b32 v101, v69, v65, s43
v_perm_b32 v105, v70, v66, s42
v_perm_b32 v109, v70, v66, s43
v_perm_b32 v113, v71, v67, s42
v_perm_b32 v117, v71, v67, s43
s_waitcnt vmcnt(10)
v_perm_b32 v90, v76, v72, s42
v_perm_b32 v94, v76, v72, s43
v_perm_b32 v98, v77, v73, s42
v_perm_b32 v102, v77, v73, s43
v_perm_b32 v106, v78, v74, s42
v_perm_b32 v110, v78, v74, s43
v_perm_b32 v114, v79, v75, s42
v_perm_b32 v118, v79, v75, s43
s_waitcnt vmcnt(8)
v_perm_b32 v91, v84, v80, s42
v_perm_b32 v95, v84, v80, s43
v_perm_b32 v99, v85, v81, s42
v_perm_b32 v103, v85, v81, s43
v_perm_b32 v107, v86, v82, s42
v_perm_b32 v111, v86, v82, s43
v_perm_b32 v115, v87, v83, s42
v_perm_b32 v119, v87, v83, s43
s_waitcnt vmcnt(6)
v_perm_b32 v56, v28, v24, s42
v_perm_b32 v60, v28, v24, s43
v_perm_b32 v64, v29, v25, s42
v_perm_b32 v68, v29, v25, s43
v_perm_b32 v72, v30, v26, s42
v_perm_b32 v76, v30, v26, s43
v_perm_b32 v80, v31, v27, s42
v_perm_b32 v84, v31, v27, s43
s_waitcnt vmcnt(4)
v_perm_b32 v57, v36, v32, s42
v_perm_b32 v61, v36, v32, s43
v_perm_b32 v65, v37, v33, s42
v_perm_b32 v69, v37, v33, s43
v_perm_b32 v73, v38, v34, s42
v_perm_b32 v77, v38, v34, s43
v_perm_b32 v81, v39, v35, s42
v_perm_b32 v85, v39, v35, s43
s_waitcnt vmcnt(2)
v_perm_b32 v58, v44, v40, s42
v_perm_b32 v62, v44, v40, s43
v_perm_b32 v66, v45, v41, s42
v_perm_b32 v70, v45, v41, s43
v_perm_b32 v74, v46, v42, s42
v_perm_b32 v78, v46, v42, s43
v_perm_b32 v82, v47, v43, s42
v_perm_b32 v86, v47, v43, s43
s_waitcnt vmcnt(0)
v_perm_b32 v59, v52, v48, s42
v_perm_b32 v63, v52, v48, s43
v_perm_b32 v67, v53, v49, s42
v_perm_b32 v71, v53, v49, s43
v_perm_b32 v75, v54, v50, s42
v_perm_b32 v79, v54, v50, s43
v_perm_b32 v83, v55, v51, s42
v_perm_b32 v87, v55, v51, s43
fq_104:
s_branch fnw_54
fnd_62:
poll_105:
buffer_load_dwordx2 v[248:249], v6, s[24:27], s73 offen sc1
pchk_106:
s_waitcnt vmcnt(0)
v_min_u32 v5, v248, v249
v_cmp_eq_u32 vcc, 0, v5
s_cbranch_vccz pdone_107
s_sleep 1
s_sub_u32 s32, s32, 1
s_cmp_gt_i32 s32, 0
s_cbranch_scc1 poll_105
pdone_107:
v_mov_b32 v250, v248
s_nop 1
v_max_f32_dpp v250, v250, v250 row_ror:1 row_mask:0xf bank_mask:0xf
s_nop 1
v_max_f32_dpp v250, v250, v250 row_ror:2 row_mask:0xf bank_mask:0xf
s_nop 1
v_max_f32_dpp v250, v250, v250 row_ror:4 row_mask:0xf bank_mask:0xf
s_nop 1
v_max_f32_dpp v250, v250, v250 row_ror:8 row_mask:0xf bank_mask:0xf
v_cmp_eq_f32 vcc, v250, v248
s_ff1_i32_b64 s68, vcc
s_and_b32 s68, s68, 15
v_readlane_b32 s33, v249, s68
v_readlane_b32 s67, v248, s68
v_add_u32 v5, s34, 4
v_mov_b32 v250, s33
s_mov_b64 exec, 1
ds_write2_b32 v3, v5, v250 offset1:2
s_mov_b64 exec, -1
s_sub_u32 s33, s33, 1
s_and_b32 s33, s33, 2047
s_branch fnd_61
fpre_81:
poll_108:
buffer_load_dwordx4 v[24:27], v4, s[24:27], s72 offen offset:0 sc1
pchk_109:
s_waitcnt vmcnt(0)
v_min3_u32 v5, v24, v25, v26
v_min_u32 v5, v5, v27
v_cmp_eq_u32 vcc, 0, v5
s_cbranch_vccz pdone_110
s_sleep 8
s_sub_u32 s32, s32, 1
s_cmp_gt_i32 s32, 0
s_cbranch_scc1 poll_108
pdone_110:
s_branch fpre_82
L_m:
s_setprio 2
v_mov_b32 v6, 0
v_mov_b32 v7, 0
v_lshlrev_b32 v8, 3, v0
ds_write_b64 v8, v[6:7]
s_waitcnt lgkmcnt(0)
s_barrier
s_lshr_b32 s64, s58, 1
s_and_b32 s65, s58, 1
v_and_b32 v1, 3, v0
v_lshlrev_b32 v1, 2, v1
v_and_b32 v2, 4, v1
s_lshl2_add_u32 s35, s58, 0
v_mov_b32 v3, s35
s_mov_b32 s4, s44
s_mov_b32 s5, s45
s_mov_b32 s6, 0x800
s_mov_b32 s7, 0x00020000
v_lshrrev_b32 v6, 4, v0
v_lshlrev_b32 v6, 3, v6
s_lshl_b32 s66, s62, 7
buffer_load_dwordx2 v[232:233], v6, s[4:7], s66 offen offset:0
buffer_load_dwordx2 v[234:235], v6, s[4:7], s66 offen offset:32
buffer_load_dwordx2 v[236:237], v6, s[4:7], s66 offen offset:64
buffer_load_dwordx2 v[238:239], v6, s[4:7], s66 offen offset:96
v_and_b32 v6, 31, v0
v_lshrrev_b32 v7, 5, v0
v_lshlrev_b32 v7, 3, v7
v_sub_u32 v6, v6, v7
v_mov_b32 v7, 0xf149f2ca
v_cmp_le_i32 vcc, 0, v6
s_nop 1
v_cndmask_b32 v216, 0, v7, vcc
v_cmp_le_i32 vcc, 1, v6
s_nop 1
v_cndmask_b32 v217, 0, v7, vcc
v_cmp_le_i32 vcc, 2, v6
s_nop 1
v_cndmask_b32 v218, 0, v7, vcc
v_cmp_le_i32 vcc, 3, v6
s_nop 1
v_cndmask_b32 v219, 0, v7, vcc
v_cmp_le_i32 vcc, 16, v6
s_nop 1
v_cndmask_b32 v220, 0, v7, vcc
v_cmp_le_i32 vcc, 17, v6
s_nop 1
v_cndmask_b32 v221, 0, v7, vcc
v_cmp_le_i32 vcc, 18, v6
s_nop 1
v_cndmask_b32 v222, 0, v7, vcc
v_cmp_le_i32 vcc, 19, v6
s_nop 1
v_cndmask_b32 v223, 0, v7, vcc
v_cmp_le_i32 vcc, 4, v6
s_nop 1
v_cndmask_b32 v224, 0, v7, vcc
v_cmp_le_i32 vcc, 5, v6
s_nop 1
v_cndmask_b32 v225, 0, v7, vcc
v_cmp_le_i32 vcc, 6, v6
s_nop 1
v_cndmask_b32 v226, 0, v7, vcc
v_cmp_le_i32 vcc, 7, v6
s_nop 1
v_cndmask_b32 v227, 0, v7, vcc
v_cmp_le_i32 vcc, 20, v6
s_nop 1
v_cndmask_b32 v228, 0, v7, vcc
v_cmp_le_i32 vcc, 21, v6
s_nop 1
v_cndmask_b32 v229, 0, v7, vcc
v_cmp_le_i32 vcc, 22, v6
s_nop 1
v_cndmask_b32 v230, 0, v7, vcc
v_cmp_le_i32 vcc, 23, v6
s_nop 1
v_cndmask_b32 v231, 0, v7, vcc
v_lshrrev_b32 v6, 2, v0
v_xor_b32 v6, v6, v0
v_and_b32 v6, 4, v6
v_mov_b32 v7, 0x3f803f80
v_cmp_eq_u32 vcc, 0, v6
s_nop 1
v_cndmask_b32 v212, 0, v7, vcc
v_cndmask_b32 v213, 0, v7, vcc
v_cndmask_b32 v214, 0, v7, vcc
v_cndmask_b32 v215, 0, v7, vcc
L_mtop:
v_lshrrev_b32 v10, 4, v0
s_cmp_eq_u32 s63, 0
s_cbranch_scc0 mq_111
v_bfe_u32 v11, v0, 1, 3
v_xor_b32 v11, v11, v10
v_lshlrev_b32 v11, 4, v11
v_and_b32 v12, 15, v0
v_lshl_add_u32 v6, v12, 7, v11
v_xor_b32 v7, 64, v6
s_branch mq_112
mq_111:
v_lshlrev_b32 v6, 4, v0
v_add_u32 v7, 1024, v6
mq_112:
s_lshl_b32 s66, s65, 13
s_add_u32 s66, s66, 86016
v_add_u32 v6, s66, v6
v_add_u32 v7, s66, v7
v_bfe_u32 v11, v0, 2, 2
v_lshl_add_u32 v11, v10, 3, v11
v_bfe_u32 v12, v0, 3, 2
s_lshl_b32 s66, s64, 1
v_xor_b32 v12, s66, v12
v_lshlrev_b32 v12, 5, v12
v_lshl_add_u32 v11, v11, 7, v12
v_and_b32 v12, 3, v0
v_lshl_add_u32 v11, v12, 3, v11
v_add_u32 v8, 102400, v11
v_xor_b32 v9, 32, v8
v_mov_b32 v11, 0xf149f2ca
v_xor_b32 v216, v11, v216
v_xor_b32 v217, v11, v217
v_xor_b32 v218, v11, v218
v_xor_b32 v219, v11, v219
v_xor_b32 v220, v11, v220
v_xor_b32 v221, v11, v221
v_xor_b32 v222, v11, v222
v_xor_b32 v223, v11, v223
v_xor_b32 v224, v11, v224
v_xor_b32 v225, v11, v225
v_xor_b32 v226, v11, v226
v_xor_b32 v227, v11, v227
v_xor_b32 v228, v11, v228
v_xor_b32 v229, v11, v229
v_xor_b32 v230, v11, v230
v_xor_b32 v231, v11, v231
v_mov_b32 v16, 0
v_mov_b32 v17, 0
v_mov_b32 v18, 0
v_mov_b32 v19, 0
v_mov_b32 v20, 0
v_mov_b32 v21, 0
v_mov_b32 v22, 0
v_mov_b32 v23, 0
v_mov_b32 v24, 0
v_mov_b32 v25, 0
v_mov_b32 v26, 0
v_mov_b32 v27, 0
v_mov_b32 v28, 0
v_mov_b32 v29, 0
v_mov_b32 v30, 0
v_mov_b32 v31, 0
v_mov_b32 v32, 0
v_mov_b32 v33, 0
v_mov_b32 v34, 0
v_mov_b32 v35, 0
v_mov_b32 v36, 0
v_mov_b32 v37, 0
v_mov_b32 v38, 0
v_mov_b32 v39, 0
v_mov_b32 v40, 0
v_mov_b32 v41, 0
v_mov_b32 v42, 0
v_mov_b32 v43, 0
v_mov_b32 v44, 0
v_mov_b32 v45, 0
v_mov_b32 v46, 0
v_mov_b32 v47, 0
v_mov_b32 v48, 0
v_mov_b32 v49, 0
v_mov_b32 v50, 0
v_mov_b32 v51, 0
v_mov_b32 v52, 0
v_mov_b32 v53, 0
v_mov_b32 v54, 0
v_mov_b32 v55, 0
v_mov_b32 v56, 0
v_mov_b32 v57, 0
v_mov_b32 v58, 0
v_mov_b32 v59, 0
v_mov_b32 v60, 0
v_mov_b32 v61, 0
v_mov_b32 v62, 0
v_mov_b32 v63, 0
v_mov_b32 v64, 0
v_mov_b32 v65, 0
v_mov_b32 v66, 0
v_mov_b32 v67, 0
v_mov_b32 v68, 0
v_mov_b32 v69, 0
v_mov_b32 v70, 0
v_mov_b32 v71, 0
v_mov_b32 v72, 0
v_mov_b32 v73, 0
v_mov_b32 v74, 0
v_mov_b32 v75, 0
v_mov_b32 v76, 0
v_mov_b32 v77, 0
v_mov_b32 v78, 0
v_mov_b32 v79, 0
v_mov_b32 v80, 0
v_mov_b32 v81, 0
v_mov_b32 v82, 0
v_mov_b32 v83, 0
v_mov_b32 v84, 0
v_mov_b32 v85, 0
v_mov_b32 v86, 0
v_mov_b32 v87, 0
v_mov_b32 v88, 0
v_mov_b32 v89, 0
v_mov_b32 v90, 0
v_mov_b32 v91, 0
v_mov_b32 v92, 0
v_mov_b32 v93, 0
v_mov_b32 v94, 0
v_mov_b32 v95, 0
v_mov_b32 v96, 0
v_mov_b32 v97, 0
v_mov_b32 v98, 0
v_mov_b32 v99, 0
v_mov_b32 v100, 0
v_mov_b32 v101, 0
v_mov_b32 v102, 0
v_mov_b32 v103, 0
v_mov_b32 v104, 0
v_mov_b32 v105, 0
v_mov_b32 v106, 0
v_mov_b32 v107, 0
v_mov_b32 v108, 0
v_mov_b32 v109, 0
v_mov_b32 v110, 0
v_mov_b32 v111, 0
v_mov_b32 v192, 0
v_mov_b32 v193, 0
v_mov_b32 v194, 0
v_mov_b32 v195, 0
v_mov_b32 v196, 0
v_mov_b32 v197, 0
v_mov_b32 v198, 0
v_mov_b32 v199, 0
v_mov_b32 v200, 0
v_mov_b32 v201, 0
v_mov_b32 v202, 0
v_mov_b32 v203, 0
v_mov_b32 v204, 0
v_mov_b32 v205, 0
v_mov_b32 v206, 0
v_mov_b32 v207, 0
v_mov_b32 v208, 0
v_mov_b32 v209, 0
v_mov_b32 v210, 0
v_mov_b32 v211, 0
v_add_u32 v4, s34, 1
s_mov_b32 s66, 16
s_mov_b32 s67, -40960
s_mov_b32 s68, -40960
s_mov_b32 s69, 81920
s_add_u32 s35, s34, 1
lw_113:
ds_read_b32 v5, v2 offset:16
s_waitcnt lgkmcnt(0)
v_cmp_gt_i32 vcc, s35, v5
s_cbranch_vccz lwd_114
s_sub_u32 s32, s32, 1
s_cmp_gt_i32 s32, 0
s_cbranch_scc1 lw_113
lwd_114:
ds_read_b64_tr_b16 v[144:145], v8 offset:8192
ds_read_b64_tr_b16 v[146:147], v8 offset:8704
ds_read_b64_tr_b16 v[148:149], v8 offset:12288
ds_read_b64_tr_b16 v[150:151], v8 offset:12800
ds_read_b128 v[112:115], v6 offset:0
ds_read_b128 v[116:119], v7 offset:0
ds_read_b64_tr_b16 v[152:153], v9 offset:8192
ds_read_b64_tr_b16 v[154:155], v9 offset:8704
ds_read_b64_tr_b16 v[156:157], v9 offset:12288
ds_read_b64_tr_b16 v[158:159], v9 offset:12800
ds_read_b128 v[120:123], v6 offset:2048
ds_read_b128 v[124:127], v7 offset:2048
ds_read_b128 v[128:131], v6 offset:4096
ds_read_b128 v[132:135], v7 offset:4096
ds_read_b128 v[136:139], v6 offset:6144
ds_read_b128 v[140:143], v7 offset:6144
.p2align 6
mqkv_115:
s_waitcnt lgkmcnt(7)
v_mfma_f32_16x16x32_bf16 v[16:19], v[144:147], v[112:115], v[16:19]
ds_read_b64_tr_b16 v[160:161], v8 offset:16384
s_waitcnt lgkmcnt(7)
v_mfma_f32_16x16x32_bf16 v[16:19], v[148:151], v[116:119], v[16:19]
ds_read_b64_tr_b16 v[162:163], v8 offset:16896
v_mfma_f32_16x16x32_bf16 v[20:23], v[152:155], v[112:115], v[20:23]
ds_read_b64_tr_b16 v[164:165], v8 offset:20480
v_mfma_f32_16x16x32_bf16 v[20:23], v[156:159], v[116:119], v[20:23]
ds_read_b64_tr_b16 v[166:167], v8 offset:20992
s_waitcnt lgkmcnt(9)
v_mfma_f32_16x16x32_bf16 v[24:27], v[144:147], v[120:123], v[24:27]
ds_read_b64_tr_b16 v[168:169], v9 offset:16384
s_waitcnt lgkmcnt(9)
v_mfma_f32_16x16x32_bf16 v[24:27], v[148:151], v[124:127], v[24:27]
ds_read_b64_tr_b16 v[170:171], v9 offset:16896
v_mfma_f32_16x16x32_bf16 v[28:31], v[152:155], v[120:123], v[28:31]
ds_read_b64_tr_b16 v[172:173], v9 offset:20480
v_mfma_f32_16x16x32_bf16 v[28:31], v[156:159], v[124:127], v[28:31]
ds_read_b64_tr_b16 v[174:175], v9 offset:20992
s_waitcnt lgkmcnt(11)
v_mfma_f32_16x16x32_bf16 v[32:35], v[144:147], v[128:131], v[32:35]
ds_read_b64_tr_b16 v[176:177], v8 offset:0
s_waitcnt lgkmcnt(11)
v_mfma_f32_16x16x32_bf16 v[32:35], v[148:151], v[132:135], v[32:35]
ds_read_b64_tr_b16 v[178:179], v8 offset:512
v_mfma_f32_16x16x32_bf16 v[36:39], v[152:155], v[128:131], v[36:39]
ds_read_b64_tr_b16 v[180:181], v8 offset:4096
v_mfma_f32_16x16x32_bf16 v[36:39], v[156:159], v[132:135], v[36:39]
ds_read_b64_tr_b16 v[182:183], v8 offset:4608
s_waitcnt lgkmcnt(13)
v_mfma_f32_16x16x32_bf16 v[40:43], v[144:147], v[136:139], v[40:43]
ds_read_b64_tr_b16 v[184:185], v9 offset:0
s_waitcnt lgkmcnt(13)
v_mfma_f32_16x16x32_bf16 v[40:43], v[148:151], v[140:143], v[40:43]
ds_read_b64_tr_b16 v[186:187], v9 offset:512
v_mfma_f32_16x16x32_bf16 v[44:47], v[152:155], v[136:139], v[44:47]
ds_read_b64_tr_b16 v[188:189], v9 offset:4096
v_mfma_f32_16x16x32_bf16 v[44:47], v[156:159], v[140:143], v[44:47]
ds_read_b64_tr_b16 v[190:191], v9 offset:4608
s_waitcnt lgkmcnt(14)
v_mfma_f32_16x16x32_bf16 v[48:51], v[112:115], v[160:163], v[48:51]
s_mov_b64 exec, 1
ds_write_b32 v3, v4
s_mov_b64 exec, -1
s_waitcnt lgkmcnt(13)
v_mfma_f32_16x16x32_bf16 v[48:51], v[116:119], v[164:167], v[48:51]
v_add_u32 v8, s67, v8
v_add_u32 v9, s67, v9
s_waitcnt lgkmcnt(11)
v_mfma_f32_16x16x32_bf16 v[52:55], v[112:115], v[168:171], v[52:55]
v_add_u32 v6, s67, v6
v_add_u32 v7, s67, v7
s_waitcnt lgkmcnt(9)
v_mfma_f32_16x16x32_bf16 v[52:55], v[116:119], v[172:175], v[52:55]
s_mov_b32 s70, s67
s_mov_b32 s67, s68
s_mov_b32 s68, s69
s_mov_b32 s69, s70
v_mfma_f32_16x16x32_bf16 v[56:59], v[120:123], v[160:163], v[56:59]
ds_read_b32 v5, v2 offset:16
v_mfma_f32_16x16x32_bf16 v[56:59], v[124:127], v[164:167], v[56:59]
v_mfma_f32_16x16x32_bf16 v[60:63], v[120:123], v[168:171], v[60:63]
v_mfma_f32_16x16x32_bf16 v[60:63], v[124:127], v[172:175], v[60:63]
v_mfma_f32_16x16x32_bf16 v[64:67], v[128:131], v[160:163], v[64:67]
s_waitcnt lgkmcnt(0)
v_cmp_ge_u32 vcc, v4, v5
s_cbranch_vccnz mspin_116
mback_117:
v_add_u32 v4, 1, v4
v_mfma_f32_16x16x32_bf16 v[64:67], v[132:135], v[164:167], v[64:67]
ds_read_b64_tr_b16 v[144:145], v8 offset:8192
v_mfma_f32_16x16x32_bf16 v[68:71], v[128:131], v[168:171], v[68:71]
ds_read_b64_tr_b16 v[146:147], v8 offset:8704
v_mfma_f32_16x16x32_bf16 v[68:71], v[132:135], v[172:175], v[68:71]
ds_read_b64_tr_b16 v[148:149], v8 offset:12288
v_mfma_f32_16x16x32_bf16 v[72:75], v[136:139], v[160:163], v[72:75]
ds_read_b64_tr_b16 v[150:151], v8 offset:12800
v_mfma_f32_16x16x32_bf16 v[72:75], v[140:143], v[164:167], v[72:75]
ds_read_b64_tr_b16 v[152:153], v9 offset:8192
v_mfma_f32_16x16x32_bf16 v[76:79], v[136:139], v[168:171], v[76:79]
ds_read_b64_tr_b16 v[154:155], v9 offset:8704
v_mfma_f32_16x16x32_bf16 v[76:79], v[140:143], v[172:175], v[76:79]
ds_read_b64_tr_b16 v[156:157], v9 offset:12288
v_mfma_f32_16x16x32_bf16 v[80:83], v[176:179], v[112:115], v[80:83]
ds_read_b64_tr_b16 v[158:159], v9 offset:12800
v_mfma_f32_16x16x32_bf16 v[80:83], v[180:183], v[116:119], v[80:83]
v_mfma_f32_16x16x32_bf16 v[84:87], v[184:187], v[112:115], v[84:87]
v_mfma_f32_16x16x32_bf16 v[84:87], v[188:191], v[116:119], v[84:87]
ds_read_b128 v[112:115], v6 offset:0
ds_read_b128 v[116:119], v7 offset:0
v_mfma_f32_16x16x32_bf16 v[88:91], v[176:179], v[120:123], v[88:91]
v_mfma_f32_16x16x32_bf16 v[88:91], v[180:183], v[124:127], v[88:91]
v_mfma_f32_16x16x32_bf16 v[92:95], v[184:187], v[120:123], v[92:95]
v_mfma_f32_16x16x32_bf16 v[92:95], v[188:191], v[124:127], v[92:95]
ds_read_b128 v[120:123], v6 offset:2048
ds_read_b128 v[124:127], v7 offset:2048
v_mfma_f32_16x16x32_bf16 v[96:99], v[176:179], v[128:131], v[96:99]
v_mfma_f32_16x16x32_bf16 v[96:99], v[180:183], v[132:135], v[96:99]
v_mfma_f32_16x16x32_bf16 v[100:103], v[184:187], v[128:131], v[100:103]
v_mfma_f32_16x16x32_bf16 v[100:103], v[188:191], v[132:135], v[100:103]
ds_read_b128 v[128:131], v6 offset:4096
ds_read_b128 v[132:135], v7 offset:4096
v_mfma_f32_16x16x32_bf16 v[104:107], v[176:179], v[136:139], v[104:107]
v_mfma_f32_16x16x32_bf16 v[104:107], v[180:183], v[140:143], v[104:107]
s_sub_u32 s66, s66, 1
s_cmp_eq_u32 s66, 0
v_mfma_f32_16x16x32_bf16 v[108:111], v[184:187], v[136:139], v[108:111]
v_mfma_f32_16x16x32_bf16 v[108:111], v[188:191], v[140:143], v[108:111]
ds_read_b128 v[136:139], v6 offset:6144
ds_read_b128 v[140:143], v7 offset:6144
s_cbranch_scc0 mqkv_115
v_and_b32 v10, 15, v0
v_lshrrev_b32 v11, 4, v0
s_lshl_b32 s66, s65, 8
s_add_u32 s66, s66, 1280
s_mul_i32 s67, s64, 384
v_lshl_add_u32 v6, v10, 2, s66
v_lshl_add_u32 v7, v11, 4, s66
v_lshl_add_u32 v8, v10, 2, s67
v_lshl_add_u32 v9, v11, 4, s67
v_and_b32 v12, 1, v11
v_lshrrev_b32 v11, 1, v11
v_lshlrev_b32 v11, 9, v11
v_lshl_add_u32 v11, v12, 10, v11
s_lshl_b32 s66, s64, 12
s_lshl_b32 s67, s65, 13
s_add_u32 s66, s66, 131072
s_add_u32 s68, s66, 24576
s_sub_u32 s68, s68, s67
s_add_u32 s67, s66, s67
v_lshl_add_u32 v14, v10, 4, v11
v_and_b32 v12, 3, v0
v_lshl_add_u32 v11, v12, 4, v11
v_bfe_u32 v12, v0, 3, 1
v_lshl_add_u32 v11, v12, 6, v11
v_bfe_u32 v12, v0, 2, 1
v_lshl_add_u32 v12, v12, 8, v11
v_add_u32 v13, s68, v12
v_add_u32 v12, s67, v12
v_add_u32 v15, s68, v14
v_add_u32 v14, s67, v14
s_lshl_b32 s66, s59, 4
s_add_u32 s66, s66, s60
s_lshl_b32 s72, s59, 7
s_add_u32 s72, s72, s60
s_lshl_b32 s72, s72, 7
s_lshl_b32 s66, s66, 15
s_lshl_b32 s67, s63, 23
s_add_u32 s66, s66, s67
s_add_u32 s71, s66, 917504
s_add_u32 s35, s34, 2
lw_118:
ds_read_b32 v5, v2 offset:24
s_waitcnt lgkmcnt(0)
v_cmp_gt_i32 vcc, s35, v5
s_cbranch_vccz lwd_119
s_sub_u32 s32, s32, 1
s_cmp_gt_i32 s32, 0
s_cbranch_scc1 lw_118
lwd_119:
v_mov_b32 v10, 0
ds_read2_b32 v[10:11], v10 offset0:8 offset1:14
ds_read2_b32 v[144:145], v6 offset0:0 offset1:128
ds_read2_b32 v[146:147], v6 offset0:16 offset1:144
ds_read2_b32 v[148:149], v6 offset0:32 offset1:160
ds_read2_b32 v[150:151], v6 offset0:48 offset1:176
ds_read_b128 v[152:155], v9 offset:2432
ds_read_b128 v[156:159], v9 offset:2496
ds_read_b32 v168, v8 offset:2560
ds_read_b32 v169, v8 offset:2624
ds_read_b128 v[112:115], v7 offset:0
ds_read_b128 v[128:131], v7 offset:512
ds_read_b128 v[116:119], v7 offset:64
ds_read_b128 v[132:135], v7 offset:576
s_waitcnt lgkmcnt(12)
v_readfirstlane_b32 s33, v10
v_readfirstlane_b32 s57, v11
s_sub_u32 s33, s33, 1
s_lshr_b32 s66, s33, 7
s_cmp_eq_u32 s66, s59
s_cbranch_scc1 patch_120
pback_121:
s_waitcnt lgkmcnt(11)
v_pk_mul_f32 v[16:17], v[16:17], v[144:145] op_sel:[0,0] op_sel_hi:[1,0]
v_pk_mul_f32 v[18:19], v[18:19], v[144:145] op_sel:[0,0] op_sel_hi:[1,0]
v_pk_mul_f32 v[20:21], v[20:21], v[144:145] op_sel:[0,0] op_sel_hi:[1,0]
v_pk_mul_f32 v[22:23], v[22:23], v[144:145] op_sel:[0,0] op_sel_hi:[1,0]
s_waitcnt lgkmcnt(7)
v_pk_fma_f32 v[16:17], v[152:153], v[144:145], v[16:17] op_sel:[0,1,0] op_sel_hi:[1,1,1]
v_pk_fma_f32 v[18:19], v[154:155], v[144:145], v[18:19] op_sel:[0,1,0] op_sel_hi:[1,1,1]
s_waitcnt lgkmcnt(6)
v_pk_fma_f32 v[20:21], v[156:157], v[144:145], v[20:21] op_sel:[0,1,0] op_sel_hi:[1,1,1]
v_pk_fma_f32 v[22:23], v[158:159], v[144:145], v[22:23] op_sel:[0,1,0] op_sel_hi:[1,1,1]
v_cvt_pk_bf16_f32 v16, v16, v17
v_cvt_pk_bf16_f32 v17, v18, v19
v_cvt_pk_bf16_f32 v18, v20, v21
v_cvt_pk_bf16_f32 v19, v22, v23
buffer_store_dwordx4 v[16:19], v12, s[20:23], s71 offen offset:0 sc1
ds_write_b128 v12, v[16:19] offset:0
ds_read_b128 v[120:123], v7 offset:128
ds_read_b128 v[136:139], v7 offset:640
ds_read_b128 v[124:127], v7 offset:192
ds_read_b128 v[140:143], v7 offset:704
ds_read_b128 v[160:163], v9 offset:2304
ds_read_b128 v[164:167], v9 offset:2368
v_pk_mul_f32 v[24:25], v[24:25], v[146:147] op_sel:[0,0] op_sel_hi:[1,0]
v_pk_mul_f32 v[26:27], v[26:27], v[146:147] op_sel:[0,0] op_sel_hi:[1,0]
v_pk_mul_f32 v[28:29], v[28:29], v[146:147] op_sel:[0,0] op_sel_hi:[1,0]
v_pk_mul_f32 v[30:31], v[30:31], v[146:147] op_sel:[0,0] op_sel_hi:[1,0]
v_pk_fma_f32 v[24:25], v[152:153], v[146:147], v[24:25] op_sel:[0,1,0] op_sel_hi:[1,1,1]
v_pk_fma_f32 v[26:27], v[154:155], v[146:147], v[26:27] op_sel:[0,1,0] op_sel_hi:[1,1,1]
v_pk_fma_f32 v[28:29], v[156:157], v[146:147], v[28:29] op_sel:[0,1,0] op_sel_hi:[1,1,1]
v_pk_fma_f32 v[30:31], v[158:159], v[146:147], v[30:31] op_sel:[0,1,0] op_sel_hi:[1,1,1]
v_cvt_pk_bf16_f32 v24, v24, v25
v_cvt_pk_bf16_f32 v25, v26, v27
v_cvt_pk_bf16_f32 v26, v28, v29
v_cvt_pk_bf16_f32 v27, v30, v31
buffer_store_dwordx4 v[24:27], v12, s[20:23], s71 offen offset:128 sc1
ds_write_b128 v12, v[24:27] offset:128
v_pk_mul_f32 v[32:33], v[32:33], v[148:149] op_sel:[0,0] op_sel_hi:[1,0]
v_pk_mul_f32 v[34:35], v[34:35], v[148:149] op_sel:[0,0] op_sel_hi:[1,0]
v_pk_mul_f32 v[36:37], v[36:37], v[148:149] op_sel:[0,0] op_sel_hi:[1,0]
v_pk_mul_f32 v[38:39], v[38:39], v[148:149] op_sel:[0,0] op_sel_hi:[1,0]
v_pk_fma_f32 v[32:33], v[152:153], v[148:149], v[32:33] op_sel:[0,1,0] op_sel_hi:[1,1,1]
v_pk_fma_f32 v[34:35], v[154:155], v[148:149], v[34:35] op_sel:[0,1,0] op_sel_hi:[1,1,1]
v_pk_fma_f32 v[36:37], v[156:157], v[148:149], v[36:37] op_sel:[0,1,0] op_sel_hi:[1,1,1]
v_pk_fma_f32 v[38:39], v[158:159], v[148:149], v[38:39] op_sel:[0,1,0] op_sel_hi:[1,1,1]
v_cvt_pk_bf16_f32 v32, v32, v33
v_cvt_pk_bf16_f32 v33, v34, v35
v_cvt_pk_bf16_f32 v34, v36, v37
v_cvt_pk_bf16_f32 v35, v38, v39
buffer_store_dwordx4 v[32:35], v13, s[20:23], s71 offen offset:0 sc1
ds_write_b128 v13, v[32:35] offset:0
v_pk_mul_f32 v[40:41], v[40:41], v[150:151] op_sel:[0,0] op_sel_hi:[1,0]
v_pk_mul_f32 v[42:43], v[42:43], v[150:151] op_sel:[0,0] op_sel_hi:[1,0]
v_pk_mul_f32 v[44:45], v[44:45], v[150:151] op_sel:[0,0] op_sel_hi:[1,0]
v_pk_mul_f32 v[46:47], v[46:47], v[150:151] op_sel:[0,0] op_sel_hi:[1,0]
v_pk_fma_f32 v[40:41], v[152:153], v[150:151], v[40:41] op_sel:[0,1,0] op_sel_hi:[1,1,1]
v_pk_fma_f32 v[42:43], v[154:155], v[150:151], v[42:43] op_sel:[0,1,0] op_sel_hi:[1,1,1]
v_pk_fma_f32 v[44:45], v[156:157], v[150:151], v[44:45] op_sel:[0,1,0] op_sel_hi:[1,1,1]
v_pk_fma_f32 v[46:47], v[158:159], v[150:151], v[46:47] op_sel:[0,1,0] op_sel_hi:[1,1,1]
v_cvt_pk_bf16_f32 v40, v40, v41
v_cvt_pk_bf16_f32 v41, v42, v43
v_cvt_pk_bf16_f32 v42, v44, v45
v_cvt_pk_bf16_f32 v43, v46, v47
buffer_store_dwordx4 v[40:43], v13, s[20:23], s71 offen offset:128 sc1
ds_write_b128 v13, v[40:43] offset:128
s_waitcnt lgkmcnt(13)
v_pk_mul_f32 v[48:49], v[48:49], v[112:113]
v_pk_mul_f32 v[50:51], v[50:51], v[114:115]
s_waitcnt lgkmcnt(12)
v_pk_fma_f32 v[48:49], v[128:129], v[168:169], v[48:49] op_sel:[0,0,0] op_sel_hi:[1,0,1]
v_pk_fma_f32 v[50:51], v[130:131], v[168:169], v[50:51] op_sel:[0,0,0] op_sel_hi:[1,0,1]
s_waitcnt lgkmcnt(11)
v_pk_mul_f32 v[56:57], v[56:57], v[116:117]
v_pk_mul_f32 v[58:59], v[58:59], v[118:119]
s_waitcnt lgkmcnt(10)
v_pk_fma_f32 v[56:57], v[132:133], v[168:169], v[56:57] op_sel:[0,0,0] op_sel_hi:[1,0,1]
v_pk_fma_f32 v[58:59], v[134:135], v[168:169], v[58:59] op_sel:[0,0,0] op_sel_hi:[1,0,1]
v_cvt_pk_bf16_f32 v48, v48, v49
v_cvt_pk_bf16_f32 v49, v50, v51
v_cvt_pk_bf16_f32 v50, v56, v57
v_cvt_pk_bf16_f32 v51, v58, v59
buffer_store_dwordx4 v[48:51], v14, s[20:23], s71 offen offset:2048 sc1
ds_write_b128 v14, v[48:51] offset:2048
v_pk_mul_f32 v[52:53], v[52:53], v[112:113]
v_pk_mul_f32 v[54:55], v[54:55], v[114:115]
v_pk_fma_f32 v[52:53], v[128:129], v[168:169], v[52:53] op_sel:[0,1,0] op_sel_hi:[1,1,1]
v_pk_fma_f32 v[54:55], v[130:131], v[168:169], v[54:55] op_sel:[0,1,0] op_sel_hi:[1,1,1]
v_pk_mul_f32 v[60:61], v[60:61], v[116:117]
v_pk_mul_f32 v[62:63], v[62:63], v[118:119]
v_pk_fma_f32 v[60:61], v[132:133], v[168:169], v[60:61] op_sel:[0,1,0] op_sel_hi:[1,1,1]
v_pk_fma_f32 v[62:63], v[134:135], v[168:169], v[62:63] op_sel:[0,1,0] op_sel_hi:[1,1,1]
v_cvt_pk_bf16_f32 v52, v52, v53
v_cvt_pk_bf16_f32 v53, v54, v55
v_cvt_pk_bf16_f32 v54, v60, v61
v_cvt_pk_bf16_f32 v55, v62, v63
buffer_store_dwordx4 v[52:55], v14, s[20:23], s71 offen offset:2304 sc1
ds_write_b128 v14, v[52:55] offset:2304
s_waitcnt lgkmcnt(10)
v_pk_mul_f32 v[64:65], v[64:65], v[120:121]
v_pk_mul_f32 v[66:67], v[66:67], v[122:123]
s_waitcnt lgkmcnt(9)
v_pk_fma_f32 v[64:65], v[136:137], v[168:169], v[64:65] op_sel:[0,0,0] op_sel_hi:[1,0,1]
v_pk_fma_f32 v[66:67], v[138:139], v[168:169], v[66:67] op_sel:[0,0,0] op_sel_hi:[1,0,1]
s_waitcnt lgkmcnt(8)
v_pk_mul_f32 v[72:73], v[72:73], v[124:125]
v_pk_mul_f32 v[74:75], v[74:75], v[126:127]
s_waitcnt lgkmcnt(7)
v_pk_fma_f32 v[72:73], v[140:141], v[168:169], v[72:73] op_sel:[0,0,0] op_sel_hi:[1,0,1]
v_pk_fma_f32 v[74:75], v[142:143], v[168:169], v[74:75] op_sel:[0,0,0] op_sel_hi:[1,0,1]
v_cvt_pk_bf16_f32 v64, v64, v65
v_cvt_pk_bf16_f32 v65, v66, v67
v_cvt_pk_bf16_f32 v66, v72, v73
v_cvt_pk_bf16_f32 v67, v74, v75
buffer_store_dwordx4 v[64:67], v15, s[20:23], s71 offen offset:2048 sc1
ds_write_b128 v15, v[64:67] offset:2048
v_pk_mul_f32 v[68:69], v[68:69], v[120:121]
v_pk_mul_f32 v[70:71], v[70:71], v[122:123]
v_pk_fma_f32 v[68:69], v[136:137], v[168:169], v[68:69] op_sel:[0,1,0] op_sel_hi:[1,1,1]
v_pk_fma_f32 v[70:71], v[138:139], v[168:169], v[70:71] op_sel:[0,1,0] op_sel_hi:[1,1,1]
v_pk_mul_f32 v[76:77], v[76:77], v[124:125]
v_pk_mul_f32 v[78:79], v[78:79], v[126:127]
v_pk_fma_f32 v[76:77], v[140:141], v[168:169], v[76:77] op_sel:[0,1,0] op_sel_hi:[1,1,1]
v_pk_fma_f32 v[78:79], v[142:143], v[168:169], v[78:79] op_sel:[0,1,0] op_sel_hi:[1,1,1]
v_cvt_pk_bf16_f32 v68, v68, v69
v_cvt_pk_bf16_f32 v69, v70, v71
v_cvt_pk_bf16_f32 v70, v76, v77
v_cvt_pk_bf16_f32 v71, v78, v79
buffer_store_dwordx4 v[68:71], v15, s[20:23], s71 offen offset:2304 sc1
ds_write_b128 v15, v[68:71] offset:2304
v_add_u32 v5, s34, 17
s_mov_b64 exec, 1
ds_write_b32 v3, v5
s_mov_b64 exec, -1
s_mov_b32 s66, 0x3e8293ee
v_mul_f32 v144, s66, v144
v_mul_f32 v145, s66, v145
v_mul_f32 v146, s66, v146
v_mul_f32 v147, s66, v147
v_mul_f32 v148, s66, v148
v_mul_f32 v149, s66, v149
v_mul_f32 v150, s66, v150
v_mul_f32 v151, s66, v151
v_pk_mul_f32 v[96:97], v[96:97], v[148:149] op_sel:[0,0] op_sel_hi:[1,0]
v_pk_mul_f32 v[98:99], v[98:99], v[148:149] op_sel:[0,0] op_sel_hi:[1,0]
v_pk_mul_f32 v[100:101], v[100:101], v[148:149] op_sel:[0,0] op_sel_hi:[1,0]
v_pk_mul_f32 v[102:103], v[102:103], v[148:149] op_sel:[0,0] op_sel_hi:[1,0]
s_waitcnt lgkmcnt(9)
v_pk_fma_f32 v[96:97], v[160:161], v[148:149], v[96:97] op_sel:[0,1,0] op_sel_hi:[1,1,1]
v_pk_fma_f32 v[98:99], v[162:163], v[148:149], v[98:99] op_sel:[0,1,0] op_sel_hi:[1,1,1]
s_waitcnt lgkmcnt(8)
v_pk_fma_f32 v[100:101], v[164:165], v[148:149], v[100:101] op_sel:[0,1,0] op_sel_hi:[1,1,1]
v_pk_fma_f32 v[102:103], v[166:167], v[148:149], v[102:103] op_sel:[0,1,0] op_sel_hi:[1,1,1]
v_cvt_pk_bf16_f32 v96, v96, v97
v_cvt_pk_bf16_f32 v97, v98, v99
v_cvt_pk_bf16_f32 v98, v100, v101
v_cvt_pk_bf16_f32 v99, v102, v103
v_pk_mul_f32 v[104:105], v[104:105], v[150:151] op_sel:[0,0] op_sel_hi:[1,0]
v_pk_mul_f32 v[106:107], v[106:107], v[150:151] op_sel:[0,0] op_sel_hi:[1,0]
v_pk_mul_f32 v[108:109], v[108:109], v[150:151] op_sel:[0,0] op_sel_hi:[1,0]
v_pk_mul_f32 v[110:111], v[110:111], v[150:151] op_sel:[0,0] op_sel_hi:[1,0]
v_pk_fma_f32 v[104:105], v[160:161], v[150:151], v[104:105] op_sel:[0,1,0] op_sel_hi:[1,1,1]
v_pk_fma_f32 v[106:107], v[162:163], v[150:151], v[106:107] op_sel:[0,1,0] op_sel_hi:[1,1,1]
v_pk_fma_f32 v[108:109], v[164:165], v[150:151], v[108:109] op_sel:[0,1,0] op_sel_hi:[1,1,1]
v_pk_fma_f32 v[110:111], v[166:167], v[150:151], v[110:111] op_sel:[0,1,0] op_sel_hi:[1,1,1]
v_cvt_pk_bf16_f32 v104, v104, v105
v_cvt_pk_bf16_f32 v105, v106, v107
v_cvt_pk_bf16_f32 v106, v108, v109
v_cvt_pk_bf16_f32 v107, v110, v111
v_pk_mul_f32 v[80:81], v[80:81], v[144:145] op_sel:[0,0] op_sel_hi:[1,0]
v_pk_mul_f32 v[82:83], v[82:83], v[144:145] op_sel:[0,0] op_sel_hi:[1,0]
v_pk_mul_f32 v[84:85], v[84:85], v[144:145] op_sel:[0,0] op_sel_hi:[1,0]
v_pk_mul_f32 v[86:87], v[86:87], v[144:145] op_sel:[0,0] op_sel_hi:[1,0]
v_pk_fma_f32 v[80:81], v[160:161], v[144:145], v[80:81] op_sel:[0,1,0] op_sel_hi:[1,1,1]
v_pk_fma_f32 v[82:83], v[162:163], v[144:145], v[82:83] op_sel:[0,1,0] op_sel_hi:[1,1,1]
v_pk_fma_f32 v[84:85], v[164:165], v[144:145], v[84:85] op_sel:[0,1,0] op_sel_hi:[1,1,1]
v_pk_fma_f32 v[86:87], v[166:167], v[144:145], v[86:87] op_sel:[0,1,0] op_sel_hi:[1,1,1]
v_cvt_pk_bf16_f32 v80, v80, v81
v_cvt_pk_bf16_f32 v81, v82, v83
v_cvt_pk_bf16_f32 v82, v84, v85
v_cvt_pk_bf16_f32 v83, v86, v87
v_pk_mul_f32 v[88:89], v[88:89], v[146:147] op_sel:[0,0] op_sel_hi:[1,0]
v_pk_mul_f32 v[90:91], v[90:91], v[146:147] op_sel:[0,0] op_sel_hi:[1,0]
v_pk_mul_f32 v[92:93], v[92:93], v[146:147] op_sel:[0,0] op_sel_hi:[1,0]
v_pk_mul_f32 v[94:95], v[94:95], v[146:147] op_sel:[0,0] op_sel_hi:[1,0]
v_pk_fma_f32 v[88:89], v[160:161], v[146:147], v[88:89] op_sel:[0,1,0] op_sel_hi:[1,1,1]
v_pk_fma_f32 v[90:91], v[162:163], v[146:147], v[90:91] op_sel:[0,1,0] op_sel_hi:[1,1,1]
v_pk_fma_f32 v[92:93], v[164:165], v[146:147], v[92:93] op_sel:[0,1,0] op_sel_hi:[1,1,1]
v_pk_fma_f32 v[94:95], v[166:167], v[146:147], v[94:95] op_sel:[0,1,0] op_sel_hi:[1,1,1]
v_cvt_pk_bf16_f32 v88, v88, v89
v_cvt_pk_bf16_f32 v89, v90, v91
v_cvt_pk_bf16_f32 v90, v92, v93
v_cvt_pk_bf16_f32 v91, v94, v95
v_permlane16_swap_b32 v96, v104
v_permlane16_swap_b32 v97, v105
v_permlane16_swap_b32 v98, v106
v_permlane16_swap_b32 v99, v107
v_permlane16_swap_b32 v80, v88
v_permlane16_swap_b32 v81, v89
v_permlane16_swap_b32 v82, v90
v_permlane16_swap_b32 v83, v91
s_lshl_b32 s69, s64, 12
v_lshl_add_u32 v6, v0, 4, s69
v_add_u32 v7, 131072, v6
s_lshl_b32 s69, s65, 13
s_add_u32 s66, s69, 131072
s_sub_u32 s69, 147456, s69
v_add_u32 v8, s69, v6
ds_read_b128 v[152:155], v8 offset:8192
ds_read_b128 v[156:159], v8 offset:9216
s_mov_b32 s67, 122880
s_min_u32 s69, s59, 1
s_lshl2_add_u32 s68, s69, s65
s_cmp_ge_u32 s59, 2
s_cselect_b32 s69, s65, 0
s_add_u32 s68, s68, s69
ds_read_b128 v[160:163], v8 offset:10240
ds_read_b128 v[164:167], v8 offset:11264
s_waitcnt lgkmcnt(3)
v_mfma_f32_32x32x16_bf16 v[112:127], v[152:155], v[96:99], v[216:231]
s_waitcnt lgkmcnt(2)
v_mfma_f32_32x32x16_bf16 v[112:127], v[156:159], v[104:107], v[112:127]
s_add_u32 s35, s34, 17
lw_122:
ds_read_b32 v5, v1 offset:0
s_waitcnt lgkmcnt(0)
v_cmp_gt_i32 vcc, s35, v5
s_cbranch_vccz lwd_123
s_sub_u32 s32, s32, 1
s_cmp_gt_i32 s32, 0
s_cbranch_scc1 lw_122
lwd_123:
ds_read_b128 v[152:155], v8 offset:0
ds_read_b128 v[156:159], v8 offset:1024
.p2align 3
s_nop 4
v_exp_f32 v112, v112
v_exp_f32 v113, v113
v_exp_f32 v114, v114
v_exp_f32 v115, v115
v_exp_f32 v116, v116
v_exp_f32 v117, v117
s_waitcnt lgkmcnt(1)
v_mfma_f32_32x32x16_bf16 v[128:143], v[152:155], v[96:99], 0
v_exp_f32 v118, v118
v_exp_f32 v119, v119
v_cvt_pk_bf16_f32 v144, v112, v113
v_cvt_pk_bf16_f32 v145, v114, v115
s_waitcnt lgkmcnt(0)
v_mfma_f32_32x32x16_bf16 v[128:143], v[156:159], v[104:107], v[128:143]
ds_read_b128 v[152:155], v7 offset:8192
ds_read_b128 v[156:159], v7 offset:9216
v_cvt_pk_bf16_f32 v146, v116, v117
v_cvt_pk_bf16_f32 v147, v118, v119
v_exp_f32 v120, v120
v_exp_f32 v121, v121
v_mfma_f32_32x32x16_bf16 v[16:31], v[160:163], v[144:147], 0
ds_read_b128 v[160:163], v8 offset:2048
v_exp_f32 v122, v122
v_exp_f32 v123, v123
v_exp_f32 v124, v124
v_mfma_f32_16x16x32_bf16 v[32:35], v[212:215], v[144:147], 0
s_cmp_eq_u32 s65, 1
v_exp_f32 v125, v125
v_exp_f32 v126, v126
v_exp_f32 v127, v127
v_cvt_pk_bf16_f32 v148, v120, v121
v_cvt_pk_bf16_f32 v149, v122, v123
v_cvt_pk_bf16_f32 v150, v124, v125
v_cvt_pk_bf16_f32 v151, v126, v127
s_cbranch_scc1 at_124
v_exp_f32 v128, v128
v_exp_f32 v129, v129
v_mfma_f32_32x32x16_bf16 v[16:31], v[164:167], v[148:151], v[16:31]
ds_read_b128 v[164:167], v8 offset:3072
v_exp_f32 v130, v130
v_exp_f32 v131, v131
v_exp_f32 v132, v132
v_mfma_f32_16x16x32_bf16 v[32:35], v[212:215], v[148:151], v[32:35]
v_exp_f32 v133, v133
s_waitcnt lgkmcnt(3)
v_mfma_f32_32x32x16_bf16 v[112:127], v[152:155], v[96:99], 0
v_exp_f32 v134, v134
v_exp_f32 v135, v135
v_cvt_pk_bf16_f32 v144, v128, v129
v_cvt_pk_bf16_f32 v145, v130, v131
s_waitcnt lgkmcnt(2)
v_mfma_f32_32x32x16_bf16 v[112:127], v[156:159], v[104:107], v[112:127]
ds_read_b128 v[152:155], v7 offset:0
ds_read_b128 v[156:159], v7 offset:1024
v_cvt_pk_bf16_f32 v146, v132, v133
v_cvt_pk_bf16_f32 v147, v134, v135
v_exp_f32 v136, v136
v_exp_f32 v137, v137
s_waitcnt lgkmcnt(3)
v_mfma_f32_32x32x16_bf16 v[16:31], v[160:163], v[144:147], v[16:31]
ds_read_b128 v[160:163], v7 offset:10240
v_exp_f32 v138, v138
v_exp_f32 v139, v139
v_exp_f32 v140, v140
v_mfma_f32_16x16x32_bf16 v[32:35], v[212:215], v[144:147], v[32:35]
v_exp_f32 v141, v141
v_exp_f32 v142, v142
v_exp_f32 v143, v143
v_cvt_pk_bf16_f32 v148, v136, v137
v_cvt_pk_bf16_f32 v149, v138, v139
v_cvt_pk_bf16_f32 v150, v140, v141
v_cvt_pk_bf16_f32 v151, v142, v143
v_exp_f32 v112, v112
v_exp_f32 v113, v113
s_waitcnt lgkmcnt(3)
v_mfma_f32_32x32x16_bf16 v[16:31], v[164:167], v[148:151], v[16:31]
ds_read_b128 v[164:167], v7 offset:11264
v_exp_f32 v114, v114
v_exp_f32 v115, v115
v_exp_f32 v116, v116
v_mfma_f32_16x16x32_bf16 v[32:35], v[212:215], v[148:151], v[32:35]
v_exp_f32 v117, v117
s_waitcnt lgkmcnt(3)
v_mfma_f32_32x32x16_bf16 v[128:143], v[152:155], v[96:99], 0
v_exp_f32 v118, v118
v_exp_f32 v119, v119
v_cvt_pk_bf16_f32 v144, v112, v113
v_cvt_pk_bf16_f32 v145, v114, v115
s_waitcnt lgkmcnt(2)
v_mfma_f32_32x32x16_bf16 v[128:143], v[156:159], v[104:107], v[128:143]
v_cvt_pk_bf16_f32 v146, v116, v117
v_cvt_pk_bf16_f32 v147, v118, v119
v_exp_f32 v120, v120
v_exp_f32 v121, v121
s_waitcnt lgkmcnt(1)
v_mfma_f32_32x32x16_bf16 v[16:31], v[160:163], v[144:147], v[16:31]
ds_read_b128 v[160:163], v7 offset:2048
v_exp_f32 v122, v122
v_exp_f32 v123, v123
v_exp_f32 v124, v124
v_mfma_f32_16x16x32_bf16 v[32:35], v[212:215], v[144:147], v[32:35]
v_mov_b32 v8, v7
v_exp_f32 v125, v125
v_exp_f32 v126, v126
v_exp_f32 v127, v127
v_cvt_pk_bf16_f32 v148, v120, v121
v_cvt_pk_bf16_f32 v149, v122, v123
v_cvt_pk_bf16_f32 v150, v124, v125
v_cvt_pk_bf16_f32 v151, v126, v127
.p2align 3
at_124:
v_exp_f32 v128, v128
v_exp_f32 v129, v129
s_waitcnt lgkmcnt(1)
v_mfma_f32_32x32x16_bf16 v[16:31], v[164:167], v[148:151], v[16:31]
ds_read_b128 v[164:167], v8 offset:3072
v_exp_f32 v130, v130
v_exp_f32 v131, v131
v_exp_f32 v132, v132
v_mfma_f32_16x16x32_bf16 v[32:35], v[212:215], v[148:151], v[32:35]
v_exp_f32 v133, v133
v_mfma_f32_32x32x16_bf16 v[112:127], v[152:155], v[80:83], v[216:231]
v_exp_f32 v134, v134
v_exp_f32 v135, v135
v_cvt_pk_bf16_f32 v144, v128, v129
v_cvt_pk_bf16_f32 v145, v130, v131
v_mfma_f32_32x32x16_bf16 v[112:127], v[156:159], v[88:91], v[112:127]
s_sub_u32 s66, s66, 8192
s_cmp_eq_u32 s66, s67
s_cbranch_scc1 cross_131
cback_132:
v_add_u32 v8, s66, v6
ds_read_b128 v[152:155], v8 offset:0
ds_read_b128 v[156:159], v8 offset:1024
v_cvt_pk_bf16_f32 v146, v132, v133
v_cvt_pk_bf16_f32 v147, v134, v135
v_exp_f32 v136, v136
v_exp_f32 v137, v137
s_waitcnt lgkmcnt(3)
v_mfma_f32_32x32x16_bf16 v[16:31], v[160:163], v[144:147], v[16:31]
v_exp_f32 v138, v138
v_exp_f32 v139, v139
v_exp_f32 v140, v140
v_mfma_f32_16x16x32_bf16 v[32:35], v[212:215], v[144:147], v[32:35]
s_cmp_eq_u32 s68, 0
v_exp_f32 v141, v141
v_exp_f32 v142, v142
v_exp_f32 v143, v143
v_cvt_pk_bf16_f32 v148, v136, v137
v_cvt_pk_bf16_f32 v149, v138, v139
v_cvt_pk_bf16_f32 v150, v140, v141
v_cvt_pk_bf16_f32 v151, v142, v143
s_cbranch_scc1 at_128
.p2align 3
at_125:
v_exp_f32 v112, v112
v_exp_f32 v113, v113
s_waitcnt lgkmcnt(2)
v_mfma_f32_32x32x16_bf16 v[16:31], v[164:167], v[148:151], v[16:31]
v_exp_f32 v114, v114
v_exp_f32 v115, v115
v_exp_f32 v116, v116
v_mfma_f32_16x16x32_bf16 v[32:35], v[212:215], v[148:151], v[32:35]
v_exp_f32 v117, v117
s_waitcnt lgkmcnt(1)
v_mfma_f32_32x32x16_bf16 v[128:143], v[152:155], v[96:99], 0
v_exp_f32 v118, v118
v_exp_f32 v119, v119
v_cvt_pk_bf16_f32 v144, v112, v113
v_cvt_pk_bf16_f32 v145, v114, v115
s_waitcnt lgkmcnt(0)
v_mfma_f32_32x32x16_bf16 v[128:143], v[156:159], v[104:107], v[128:143]
v_cvt_pk_bf16_f32 v146, v116, v117
v_cvt_pk_bf16_f32 v147, v118, v119
v_exp_f32 v120, v120
v_exp_f32 v121, v121
v_mfma_f32_32x32x16_bf16 v[192:207], v[160:163], v[144:147], v[192:207]
ds_read_b128 v[160:163], v8 offset:2048
v_exp_f32 v122, v122
v_exp_f32 v123, v123
v_exp_f32 v124, v124
v_mfma_f32_16x16x32_bf16 v[208:211], v[212:215], v[144:147], v[208:211]
v_exp_f32 v125, v125
v_exp_f32 v126, v126
v_exp_f32 v127, v127
v_cvt_pk_bf16_f32 v148, v120, v121
v_cvt_pk_bf16_f32 v149, v122, v123
v_cvt_pk_bf16_f32 v150, v124, v125
v_cvt_pk_bf16_f32 v151, v126, v127
v_exp_f32 v128, v128
v_exp_f32 v129, v129
v_mfma_f32_32x32x16_bf16 v[192:207], v[164:167], v[148:151], v[192:207]
ds_read_b128 v[164:167], v8 offset:3072
v_exp_f32 v130, v130
v_exp_f32 v131, v131
v_exp_f32 v132, v132
v_mfma_f32_16x16x32_bf16 v[208:211], v[212:215], v[148:151], v[208:211]
v_exp_f32 v133, v133
v_mfma_f32_32x32x16_bf16 v[112:127], v[152:155], v[80:83], 0
v_exp_f32 v134, v134
v_exp_f32 v135, v135
v_cvt_pk_bf16_f32 v144, v128, v129
v_cvt_pk_bf16_f32 v145, v130, v131
v_mfma_f32_32x32x16_bf16 v[112:127], v[156:159], v[88:91], v[112:127]
s_sub_u32 s66, s66, 8192
s_cmp_eq_u32 s66, s67
s_cbranch_scc1 cross_133
cback_134:
v_add_u32 v8, s66, v6
ds_read_b128 v[152:155], v8 offset:0
ds_read_b128 v[156:159], v8 offset:1024
v_cvt_pk_bf16_f32 v146, v132, v133
v_cvt_pk_bf16_f32 v147, v134, v135
v_exp_f32 v136, v136
v_exp_f32 v137, v137
s_waitcnt lgkmcnt(3)
v_mfma_f32_32x32x16_bf16 v[16:31], v[160:163], v[144:147], v[16:31]
v_exp_f32 v138, v138
v_exp_f32 v139, v139
v_exp_f32 v140, v140
v_mfma_f32_16x16x32_bf16 v[32:35], v[212:215], v[144:147], v[32:35]
s_sub_u32 s68, s68, 1
s_cmp_eq_u32 s68, 0
v_exp_f32 v141, v141
v_exp_f32 v142, v142
v_exp_f32 v143, v143
v_cvt_pk_bf16_f32 v148, v136, v137
v_cvt_pk_bf16_f32 v149, v138, v139
v_cvt_pk_bf16_f32 v150, v140, v141
v_cvt_pk_bf16_f32 v151, v142, v143
s_cbranch_scc0 at_125
s_cmp_lt_u32 s59, 2
s_cbranch_scc1 at_128
.p2align 3
v_exp_f32 v112, v112
v_exp_f32 v113, v113
s_waitcnt lgkmcnt(2)
v_mfma_f32_32x32x16_bf16 v[16:31], v[164:167], v[148:151], v[16:31]
v_exp_f32 v114, v114
v_exp_f32 v115, v115
v_exp_f32 v116, v116
v_mfma_f32_16x16x32_bf16 v[32:35], v[212:215], v[148:151], v[32:35]
v_exp_f32 v117, v117
s_waitcnt lgkmcnt(1)
v_mfma_f32_32x32x16_bf16 v[128:143], v[152:155], v[96:99], v[216:231]
v_exp_f32 v118, v118
v_exp_f32 v119, v119
v_cvt_pk_bf16_f32 v144, v112, v113
v_cvt_pk_bf16_f32 v145, v114, v115
s_waitcnt lgkmcnt(0)
v_mfma_f32_32x32x16_bf16 v[128:143], v[156:159], v[104:107], v[128:143]
v_cvt_pk_bf16_f32 v146, v116, v117
v_cvt_pk_bf16_f32 v147, v118, v119
v_exp_f32 v120, v120
v_exp_f32 v121, v121
v_mfma_f32_32x32x16_bf16 v[192:207], v[160:163], v[144:147], v[192:207]
ds_read_b128 v[160:163], v8 offset:2048
v_exp_f32 v122, v122
v_exp_f32 v123, v123
v_exp_f32 v124, v124
v_mfma_f32_16x16x32_bf16 v[208:211], v[212:215], v[144:147], v[208:211]
v_exp_f32 v125, v125
v_exp_f32 v126, v126
v_exp_f32 v127, v127
v_cvt_pk_bf16_f32 v148, v120, v121
v_cvt_pk_bf16_f32 v149, v122, v123
v_cvt_pk_bf16_f32 v150, v124, v125
v_cvt_pk_bf16_f32 v151, v126, v127
v_exp_f32 v128, v128
v_exp_f32 v129, v129
v_mfma_f32_32x32x16_bf16 v[192:207], v[164:167], v[148:151], v[192:207]
ds_read_b128 v[164:167], v8 offset:3072
v_exp_f32 v130, v130
v_exp_f32 v131, v131
v_exp_f32 v132, v132
v_mfma_f32_16x16x32_bf16 v[208:211], v[212:215], v[148:151], v[208:211]
v_exp_f32 v133, v133
v_mfma_f32_32x32x16_bf16 v[112:127], v[152:155], v[80:83], 0
v_exp_f32 v134, v134
v_exp_f32 v135, v135
v_cvt_pk_bf16_f32 v144, v128, v129
v_cvt_pk_bf16_f32 v145, v130, v131
v_mfma_f32_32x32x16_bf16 v[112:127], v[156:159], v[88:91], v[112:127]
v_subrev_u32 v8, 8192, v8
ds_read_b128 v[152:155], v8 offset:0
ds_read_b128 v[156:159], v8 offset:1024
v_cvt_pk_bf16_f32 v146, v132, v133
v_cvt_pk_bf16_f32 v147, v134, v135
v_exp_f32 v136, v136
v_exp_f32 v137, v137
s_waitcnt lgkmcnt(3)
v_mfma_f32_32x32x16_bf16 v[16:31], v[160:163], v[144:147], v[16:31]
v_exp_f32 v138, v138
v_exp_f32 v139, v139
v_exp_f32 v140, v140
v_mfma_f32_16x16x32_bf16 v[32:35], v[212:215], v[144:147], v[32:35]
s_cmp_eq_u32 s65, 1
v_exp_f32 v141, v141
v_exp_f32 v142, v142
v_exp_f32 v143, v143
v_cvt_pk_bf16_f32 v148, v136, v137
v_cvt_pk_bf16_f32 v149, v138, v139
v_cvt_pk_bf16_f32 v150, v140, v141
v_cvt_pk_bf16_f32 v151, v142, v143
s_cbranch_scc1 at_127
.p2align 3
v_exp_f32 v112, v112
v_exp_f32 v113, v113
s_waitcnt lgkmcnt(2)
v_mfma_f32_32x32x16_bf16 v[16:31], v[164:167], v[148:151], v[16:31]
v_exp_f32 v114, v114
v_exp_f32 v115, v115
v_exp_f32 v116, v116
v_mfma_f32_16x16x32_bf16 v[32:35], v[212:215], v[148:151], v[32:35]
v_exp_f32 v117, v117
s_waitcnt lgkmcnt(1)
v_mfma_f32_32x32x16_bf16 v[128:143], v[152:155], v[80:83], 0
v_exp_f32 v118, v118
v_exp_f32 v119, v119
v_cvt_pk_bf16_f32 v144, v112, v113
v_cvt_pk_bf16_f32 v145, v114, v115
s_waitcnt lgkmcnt(0)
v_mfma_f32_32x32x16_bf16 v[128:143], v[156:159], v[88:91], v[128:143]
v_subrev_u32 v8, 8192, v8
ds_read_b128 v[152:155], v8 offset:0
ds_read_b128 v[156:159], v8 offset:1024
v_cvt_pk_bf16_f32 v146, v116, v117
v_cvt_pk_bf16_f32 v147, v118, v119
v_exp_f32 v120, v120
v_exp_f32 v121, v121
v_mfma_f32_32x32x16_bf16 v[192:207], v[160:163], v[144:147], v[192:207]
ds_read_b128 v[160:163], v8 offset:10240
v_exp_f32 v122, v122
v_exp_f32 v123, v123
v_exp_f32 v124, v124
v_mfma_f32_16x16x32_bf16 v[208:211], v[212:215], v[144:147], v[208:211]
v_exp_f32 v125, v125
v_exp_f32 v126, v126
v_exp_f32 v127, v127
v_cvt_pk_bf16_f32 v148, v120, v121
v_cvt_pk_bf16_f32 v149, v122, v123
v_cvt_pk_bf16_f32 v150, v124, v125
v_cvt_pk_bf16_f32 v151, v126, v127
v_exp_f32 v128, v128
v_exp_f32 v129, v129
v_mfma_f32_32x32x16_bf16 v[192:207], v[164:167], v[148:151], v[192:207]
ds_read_b128 v[164:167], v8 offset:11264
v_exp_f32 v130, v130
v_exp_f32 v131, v131
v_exp_f32 v132, v132
v_mfma_f32_16x16x32_bf16 v[208:211], v[212:215], v[148:151], v[208:211]
v_exp_f32 v133, v133
s_waitcnt lgkmcnt(3)
v_mfma_f32_32x32x16_bf16 v[112:127], v[152:155], v[80:83], 0
v_exp_f32 v134, v134
v_exp_f32 v135, v135
v_cvt_pk_bf16_f32 v144, v128, v129
v_cvt_pk_bf16_f32 v145, v130, v131
s_waitcnt lgkmcnt(2)
v_mfma_f32_32x32x16_bf16 v[112:127], v[156:159], v[88:91], v[112:127]
v_subrev_u32 v8, 8192, v8
ds_read_b128 v[152:155], v8 offset:0
ds_read_b128 v[156:159], v8 offset:1024
v_cvt_pk_bf16_f32 v146, v132, v133
v_cvt_pk_bf16_f32 v147, v134, v135
v_exp_f32 v136, v136
v_exp_f32 v137, v137
s_waitcnt lgkmcnt(3)
v_mfma_f32_32x32x16_bf16 v[192:207], v[160:163], v[144:147], v[192:207]
ds_read_b128 v[160:163], v8 offset:10240
v_exp_f32 v138, v138
v_exp_f32 v139, v139
v_exp_f32 v140, v140
v_mfma_f32_16x16x32_bf16 v[208:211], v[212:215], v[144:147], v[208:211]
v_exp_f32 v141, v141
v_exp_f32 v142, v142
v_exp_f32 v143, v143
v_cvt_pk_bf16_f32 v148, v136, v137
v_cvt_pk_bf16_f32 v149, v138, v139
v_cvt_pk_bf16_f32 v150, v140, v141
v_cvt_pk_bf16_f32 v151, v142, v143
v_exp_f32 v112, v112
v_exp_f32 v113, v113
s_waitcnt lgkmcnt(3)
v_mfma_f32_32x32x16_bf16 v[192:207], v[164:167], v[148:151], v[192:207]
ds_read_b128 v[164:167], v8 offset:11264
v_exp_f32 v114, v114
v_exp_f32 v115, v115
v_exp_f32 v116, v116
v_mfma_f32_16x16x32_bf16 v[208:211], v[212:215], v[148:151], v[208:211]
v_exp_f32 v117, v117
s_waitcnt lgkmcnt(3)
v_mfma_f32_32x32x16_bf16 v[128:143], v[152:155], v[80:83], v[216:231]
v_exp_f32 v118, v118
v_exp_f32 v119, v119
v_cvt_pk_bf16_f32 v144, v112, v113
v_cvt_pk_bf16_f32 v145, v114, v115
s_waitcnt lgkmcnt(2)
v_mfma_f32_32x32x16_bf16 v[128:143], v[156:159], v[88:91], v[128:143]
v_cvt_pk_bf16_f32 v146, v116, v117
v_cvt_pk_bf16_f32 v147, v118, v119
v_exp_f32 v120, v120
v_exp_f32 v121, v121
s_waitcnt lgkmcnt(1)
v_mfma_f32_32x32x16_bf16 v[192:207], v[160:163], v[144:147], v[192:207]
ds_read_b128 v[160:163], v8 offset:2048
v_exp_f32 v122, v122
v_exp_f32 v123, v123
v_exp_f32 v124, v124
v_mfma_f32_16x16x32_bf16 v[208:211], v[212:215], v[144:147], v[208:211]
v_exp_f32 v125, v125
v_exp_f32 v126, v126
v_exp_f32 v127, v127
v_cvt_pk_bf16_f32 v148, v120, v121
v_cvt_pk_bf16_f32 v149, v122, v123
v_cvt_pk_bf16_f32 v150, v124, v125
v_cvt_pk_bf16_f32 v151, v126, v127
s_branch at_129
.p2align 3
at_128:
v_add_u32 v5, s34, 20
s_mov_b64 exec, 1
ds_write_b32 v3, v5
s_mov_b64 exec, -1
v_exp_f32 v112, v112
v_exp_f32 v113, v113
s_waitcnt lgkmcnt(3)
v_mfma_f32_32x32x16_bf16 v[16:31], v[164:167], v[148:151], v[16:31]
v_exp_f32 v114, v114
v_exp_f32 v115, v115
v_exp_f32 v116, v116
v_mfma_f32_16x16x32_bf16 v[32:35], v[212:215], v[148:151], v[32:35]
v_exp_f32 v117, v117
v_exp_f32 v118, v118
v_exp_f32 v119, v119
v_cvt_pk_bf16_f32 v144, v112, v113
v_cvt_pk_bf16_f32 v145, v114, v115
v_cvt_pk_bf16_f32 v146, v116, v117
v_cvt_pk_bf16_f32 v147, v118, v119
v_exp_f32 v120, v120
v_exp_f32 v121, v121
v_mfma_f32_32x32x16_bf16 v[192:207], v[160:163], v[144:147], v[192:207]
v_exp_f32 v122, v122
v_exp_f32 v123, v123
v_exp_f32 v124, v124
v_mfma_f32_16x16x32_bf16 v[208:211], v[212:215], v[144:147], v[208:211]
v_exp_f32 v125, v125
v_exp_f32 v126, v126
v_exp_f32 v127, v127
v_cvt_pk_bf16_f32 v148, v120, v121
v_cvt_pk_bf16_f32 v149, v122, v123
v_cvt_pk_bf16_f32 v150, v124, v125
v_cvt_pk_bf16_f32 v151, v126, v127
s_branch at_130
.p2align 3
at_127:
v_exp_f32 v112, v112
v_exp_f32 v113, v113
s_waitcnt lgkmcnt(2)
v_mfma_f32_32x32x16_bf16 v[16:31], v[164:167], v[148:151], v[16:31]
v_exp_f32 v114, v114
v_exp_f32 v115, v115
v_exp_f32 v116, v116
v_mfma_f32_16x16x32_bf16 v[32:35], v[212:215], v[148:151], v[32:35]
v_exp_f32 v117, v117
s_waitcnt lgkmcnt(1)
v_mfma_f32_32x32x16_bf16 v[128:143], v[152:155], v[80:83], v[216:231]
v_exp_f32 v118, v118
v_exp_f32 v119, v119
v_cvt_pk_bf16_f32 v144, v112, v113
v_cvt_pk_bf16_f32 v145, v114, v115
s_waitcnt lgkmcnt(0)
v_mfma_f32_32x32x16_bf16 v[128:143], v[156:159], v[88:91], v[128:143]
v_cvt_pk_bf16_f32 v146, v116, v117
v_cvt_pk_bf16_f32 v147, v118, v119
v_exp_f32 v120, v120
v_exp_f32 v121, v121
v_mfma_f32_32x32x16_bf16 v[192:207], v[160:163], v[144:147], v[192:207]
ds_read_b128 v[160:163], v8 offset:2048
v_exp_f32 v122, v122
v_exp_f32 v123, v123
v_exp_f32 v124, v124
v_mfma_f32_16x16x32_bf16 v[208:211], v[212:215], v[144:147], v[208:211]
v_exp_f32 v125, v125
v_exp_f32 v126, v126
v_exp_f32 v127, v127
v_cvt_pk_bf16_f32 v148, v120, v121
v_cvt_pk_bf16_f32 v149, v122, v123
v_cvt_pk_bf16_f32 v150, v124, v125
v_cvt_pk_bf16_f32 v151, v126, v127
.p2align 3
at_129:
v_exp_f32 v128, v128
v_exp_f32 v129, v129
s_waitcnt lgkmcnt(1)
v_mfma_f32_32x32x16_bf16 v[192:207], v[164:167], v[148:151], v[192:207]
ds_read_b128 v[164:167], v8 offset:3072
v_exp_f32 v130, v130
v_exp_f32 v131, v131
v_exp_f32 v132, v132
v_mfma_f32_16x16x32_bf16 v[208:211], v[212:215], v[148:151], v[208:211]
v_exp_f32 v133, v133
v_exp_f32 v134, v134
v_exp_f32 v135, v135
v_cvt_pk_bf16_f32 v144, v128, v129
v_cvt_pk_bf16_f32 v145, v130, v131
v_add_u32 v5, s34, 20
s_mov_b64 exec, 1
ds_write_b32 v3, v5
s_mov_b64 exec, -1
v_cvt_pk_bf16_f32 v146, v132, v133
v_cvt_pk_bf16_f32 v147, v134, v135
v_exp_f32 v136, v136
v_exp_f32 v137, v137
s_waitcnt lgkmcnt(2)
v_mfma_f32_32x32x16_bf16 v[192:207], v[160:163], v[144:147], v[192:207]
v_exp_f32 v138, v138
v_exp_f32 v139, v139
v_exp_f32 v140, v140
v_mfma_f32_16x16x32_bf16 v[208:211], v[212:215], v[144:147], v[208:211]
v_exp_f32 v141, v141
v_exp_f32 v142, v142
v_exp_f32 v143, v143
v_cvt_pk_bf16_f32 v148, v136, v137
v_cvt_pk_bf16_f32 v149, v138, v139
v_cvt_pk_bf16_f32 v150, v140, v141
v_cvt_pk_bf16_f32 v151, v142, v143
at_130:
s_lshl_b32 s66, s59, 18
s_lshl_b32 s67, s63, 22
v_mfma_f32_16x16x32_bf16 v[208:211], v[212:215], v[148:151], v[208:211]
s_add_u32 s66, s66, s67
s_lshl1_add_u32 s67, s60, s64
s_waitcnt lgkmcnt(1)
v_mfma_f32_32x32x16_bf16 v[192:207], v[164:167], v[148:151], v[192:207]
s_lshl_b32 s67, s67, 11
s_add_u32 s66, s66, s67
s_lshl_b32 s68, s65, 16
s_add_u32 s67, s66, 18022400
s_sub_u32 s67, s67, s68
s_add_u32 s66, s66, s68
s_add_u32 s66, s66, 17825792
v_lshlrev_b32 v9, 4, v0
v_subrev_u32 v10, 0x2f800000, v32
v_subrev_u32 v11, 0x2f800000, v208
v_max_u32 v10, v10, v11
v_cmp_lt_u32 vcc, 0x20000000, v10
s_cbranch_vccnz slow_135
sback_136:
s_nop 1
v_rcp_f32 v12, v32
s_nop 1
v_pk_mul_f32 v[16:17], v[16:17], v[12:13] op_sel:[0,0] op_sel_hi:[1,0]
v_pk_mul_f32 v[18:19], v[18:19], v[12:13] op_sel:[0,0] op_sel_hi:[1,0]
v_pk_mul_f32 v[20:21], v[20:21], v[12:13] op_sel:[0,0] op_sel_hi:[1,0]
v_pk_mul_f32 v[22:23], v[22:23], v[12:13] op_sel:[0,0] op_sel_hi:[1,0]
v_pk_mul_f32 v[24:25], v[24:25], v[12:13] op_sel:[0,0] op_sel_hi:[1,0]
v_pk_mul_f32 v[26:27], v[26:27], v[12:13] op_sel:[0,0] op_sel_hi:[1,0]
v_pk_mul_f32 v[28:29], v[28:29], v[12:13] op_sel:[0,0] op_sel_hi:[1,0]
v_pk_mul_f32 v[30:31], v[30:31], v[12:13] op_sel:[0,0] op_sel_hi:[1,0]
v_cvt_pk_bf16_f32 v16, v16, v17
v_cvt_pk_bf16_f32 v17, v18, v19
v_cvt_pk_bf16_f32 v18, v20, v21
v_cvt_pk_bf16_f32 v19, v22, v23
v_cvt_pk_bf16_f32 v20, v24, v25
v_cvt_pk_bf16_f32 v21, v26, v27
v_cvt_pk_bf16_f32 v22, v28, v29
v_cvt_pk_bf16_f32 v23, v30, v31
s_cmp_eq_u32 s57, 0
s_cbranch_scc1 far_137
buffer_store_dwordx4 v[16:19], v9, s[20:23], s67 offen offset:0
buffer_store_dwordx4 v[20:23], v9, s[20:23], s67 offen offset:1024
near_138:
v_rcp_f32 v12, v208
s_nop 0
v_pk_mul_f32 v[192:193], v[192:193], v[12:13] op_sel:[0,0] op_sel_hi:[1,0]
v_pk_mul_f32 v[194:195], v[194:195], v[12:13] op_sel:[0,0] op_sel_hi:[1,0]
v_pk_mul_f32 v[196:197], v[196:197], v[12:13] op_sel:[0,0] op_sel_hi:[1,0]
v_pk_mul_f32 v[198:199], v[198:199], v[12:13] op_sel:[0,0] op_sel_hi:[1,0]
v_pk_mul_f32 v[200:201], v[200:201], v[12:13] op_sel:[0,0] op_sel_hi:[1,0]
v_pk_mul_f32 v[202:203], v[202:203], v[12:13] op_sel:[0,0] op_sel_hi:[1,0]
v_pk_mul_f32 v[204:205], v[204:205], v[12:13] op_sel:[0,0] op_sel_hi:[1,0]
v_pk_mul_f32 v[206:207], v[206:207], v[12:13] op_sel:[0,0] op_sel_hi:[1,0]
v_cvt_pk_bf16_f32 v192, v192, v193
v_cvt_pk_bf16_f32 v193, v194, v195
v_cvt_pk_bf16_f32 v194, v196, v197
v_cvt_pk_bf16_f32 v195, v198, v199
v_cvt_pk_bf16_f32 v196, v200, v201
v_cvt_pk_bf16_f32 v197, v202, v203
v_cvt_pk_bf16_f32 v198, v204, v205
v_cvt_pk_bf16_f32 v199, v206, v207
s_cmp_eq_u32 s57, 0
s_cbranch_scc1 far_139
buffer_store_dwordx4 v[192:195], v9, s[20:23], s66 offen offset:0
buffer_store_dwordx4 v[196:199], v9, s[20:23], s66 offen offset:1024
near_140:
v_bfe_u32 v48, v0, 2, 3
v_lshrrev_b32 v49, 5, v0
v_lshl_add_u32 v48, v49, 4, v48
v_lshlrev_b32 v48, 7, v48
v_bfe_u32 v49, v0, 3, 2
v_lshl_add_u32 v48, v49, 5, v48
v_and_b32 v49, 3, v0
v_lshl_add_u32 v48, v49, 3, v48
v_add_u32 v8, 32768, v48
v_xor_b32 v9, 32, v8
v_xor_b32 v10, 64, v8
v_xor_b32 v11, 96, v8
v_add_u32 v12, 0x10000, v8
v_add_u32 v13, 0x10000, v9
v_add_u32 v14, 0x10000, v10
v_add_u32 v15, 0x10000, v11
v_and_b32 v48, 15, v0
v_lshrrev_b32 v49, 4, v0
s_lshl2_add_u32 s66, s61, s58
s_lshl_b32 s67, s66, 16
s_lshl_b32 s68, s63, 22
s_add_u32 s67, s67, s68
s_add_u32 s67, s67, 17825792
v_lshl_add_u32 v6, v48, 4, s67
v_lshl_add_u32 v6, v49, 9, v6
s_add_u32 s70, s72, 268288
s_add_u32 s35, s34, 3
lw_141:
ds_read_b32 v5, v2 offset:24
s_waitcnt lgkmcnt(0)
v_cmp_gt_i32 vcc, s35, v5
s_cbranch_vccz lwd_142
s_sub_u32 s32, s32, 1
s_cmp_gt_i32 s32, 0
s_cbranch_scc1 lw_141
lwd_142:
s_mov_b64 exec, 1
s_waitcnt vmcnt(0)
s_cmp_eq_u32 s57, 0
s_cbranch_scc1 far_143
buffer_store_dword v212, v3, s[24:27], s70 offen
near_144:
s_mov_b64 exec, -1
v_add_u32 v5, s34, 21
s_mov_b64 exec, 1
ds_write_b32 v3, v5
s_mov_b64 exec, -1
s_cmp_eq_u32 s63, 0
s_cbranch_scc0 mo_145
v_permlane16_swap_b32 v240, v242
v_permlane16_swap_b32 v241, v243
v_permlane16_swap_b32 v244, v246
v_permlane16_swap_b32 v245, v247
v_permlane16_swap_b32 v248, v250
v_permlane16_swap_b32 v249, v251
v_permlane16_swap_b32 v252, v254
v_permlane16_swap_b32 v253, v255
mo_146:
v_lshlrev_b32 v16, 16, v240
v_and_b32 v17, 0xffff0000, v240
v_lshlrev_b32 v18, 16, v241
v_and_b32 v19, 0xffff0000, v241
v_lshlrev_b32 v20, 16, v242
v_and_b32 v21, 0xffff0000, v242
v_lshlrev_b32 v22, 16, v243
v_and_b32 v23, 0xffff0000, v243
v_lshlrev_b32 v24, 16, v244
v_and_b32 v25, 0xffff0000, v244
v_lshlrev_b32 v26, 16, v245
v_and_b32 v27, 0xffff0000, v245
v_lshlrev_b32 v28, 16, v246
v_and_b32 v29, 0xffff0000, v246
v_lshlrev_b32 v30, 16, v247
v_and_b32 v31, 0xffff0000, v247
v_lshlrev_b32 v32, 16, v248
v_and_b32 v33, 0xffff0000, v248
v_lshlrev_b32 v34, 16, v249
v_and_b32 v35, 0xffff0000, v249
v_lshlrev_b32 v36, 16, v250
v_and_b32 v37, 0xffff0000, v250
v_lshlrev_b32 v38, 16, v251
v_and_b32 v39, 0xffff0000, v251
v_lshlrev_b32 v40, 16, v252
v_and_b32 v41, 0xffff0000, v252
v_lshlrev_b32 v42, 16, v253
v_and_b32 v43, 0xffff0000, v253
v_lshlrev_b32 v44, 16, v254
v_and_b32 v45, 0xffff0000, v254
v_lshlrev_b32 v46, 16, v255
v_and_b32 v47, 0xffff0000, v255
s_add_u32 s66, s61, s62
s_and_b32 s66, s66, 15
s_lshl_b32 s66, s66, 12
s_add_u32 s35, s34, 18
lw_147:
ds_read_b32 v5, v2 offset:16
s_waitcnt lgkmcnt(0)
v_cmp_gt_i32 vcc, s35, v5
s_cbranch_vccz lwd_148
s_sub_u32 s32, s32, 1
s_cmp_gt_i32 s32, 0
s_cbranch_scc1 lw_147
lwd_148:
buffer_load_dwordx4 v[80:83], v6, s[20:23], s66 offen offset:0 sc1
buffer_load_dwordx4 v[88:91], v6, s[20:23], s66 offen offset:2048 sc1
buffer_load_dwordx4 v[84:87], v6, s[20:23], s66 offen offset:256 sc1
buffer_load_dwordx4 v[92:95], v6, s[20:23], s66 offen offset:2304 sc1
s_add_u32 s66, s66, 4096
s_and_b32 s66, s66, 0xffff
ds_read_b64_tr_b16 v[48:49], v8 offset:0
ds_read_b64_tr_b16 v[50:51], v8 offset:1024
ds_read_b64_tr_b16 v[52:53], v8 offset:4096
ds_read_b64_tr_b16 v[54:55], v8 offset:5120
buffer_load_dwordx4 v[96:99], v6, s[20:23], s66 offen offset:0 sc1
buffer_load_dwordx4 v[104:107], v6, s[20:23], s66 offen offset:2048 sc1
buffer_load_dwordx4 v[100:103], v6, s[20:23], s66 offen offset:256 sc1
buffer_load_dwordx4 v[108:111], v6, s[20:23], s66 offen offset:2304 sc1
s_add_u32 s66, s66, 4096
s_and_b32 s66, s66, 0xffff
ds_read_b64_tr_b16 v[56:57], v9 offset:0
ds_read_b64_tr_b16 v[58:59], v9 offset:1024
ds_read_b64_tr_b16 v[60:61], v9 offset:4096
ds_read_b64_tr_b16 v[62:63], v9 offset:5120
buffer_load_dwordx4 v[112:115], v6, s[20:23], s66 offen offset:0 sc1
buffer_load_dwordx4 v[120:123], v6, s[20:23], s66 offen offset:2048 sc1
buffer_load_dwordx4 v[116:119], v6, s[20:23], s66 offen offset:256 sc1
buffer_load_dwordx4 v[124:127], v6, s[20:23], s66 offen offset:2304 sc1
s_add_u32 s66, s66, 4096
s_and_b32 s66, s66, 0xffff
ds_read_b64_tr_b16 v[64:65], v10 offset:0
ds_read_b64_tr_b16 v[66:67], v10 offset:1024
ds_read_b64_tr_b16 v[68:69], v10 offset:4096
ds_read_b64_tr_b16 v[70:71], v10 offset:5120
buffer_load_dwordx4 v[128:131], v6, s[20:23], s66 offen offset:0 sc1
buffer_load_dwordx4 v[136:139], v6, s[20:23], s66 offen offset:2048 sc1
buffer_load_dwordx4 v[132:135], v6, s[20:23], s66 offen offset:256 sc1
buffer_load_dwordx4 v[140:143], v6, s[20:23], s66 offen offset:2304 sc1
s_add_u32 s66, s66, 4096
s_and_b32 s66, s66, 0xffff
buffer_load_dwordx4 v[144:147], v6, s[20:23], s66 offen offset:0 sc1
buffer_load_dwordx4 v[152:155], v6, s[20:23], s66 offen offset:2048 sc1
buffer_load_dwordx4 v[148:151], v6, s[20:23], s66 offen offset:256 sc1
buffer_load_dwordx4 v[156:159], v6, s[20:23], s66 offen offset:2304 sc1
s_add_u32 s66, s66, 4096
s_and_b32 s66, s66, 0xffff
buffer_load_dwordx4 v[160:163], v6, s[20:23], s66 offen offset:0 sc1
buffer_load_dwordx4 v[168:171], v6, s[20:23], s66 offen offset:2048 sc1
buffer_load_dwordx4 v[164:167], v6, s[20:23], s66 offen offset:256 sc1
buffer_load_dwordx4 v[172:175], v6, s[20:23], s66 offen offset:2304 sc1
s_add_u32 s66, s66, 4096
s_and_b32 s66, s66, 0xffff
buffer_load_dwordx4 v[176:179], v6, s[20:23], s66 offen offset:0 sc1
buffer_load_dwordx4 v[184:187], v6, s[20:23], s66 offen offset:2048 sc1
buffer_load_dwordx4 v[180:183], v6, s[20:23], s66 offen offset:256 sc1
buffer_load_dwordx4 v[188:191], v6, s[20:23], s66 offen offset:2304 sc1
s_add_u32 s66, s66, 4096
s_and_b32 s66, s66, 0xffff
buffer_load_dwordx4 v[192:195], v6, s[20:23], s66 offen offset:0 sc1
buffer_load_dwordx4 v[200:203], v6, s[20:23], s66 offen offset:2048 sc1
buffer_load_dwordx4 v[196:199], v6, s[20:23], s66 offen offset:256 sc1
buffer_load_dwordx4 v[204:207], v6, s[20:23], s66 offen offset:2304 sc1
s_add_u32 s66, s66, 4096
s_and_b32 s66, s66, 0xffff
.p2align 3
s_waitcnt vmcnt(31) lgkmcnt(10)
v_mfma_f32_16x16x32_bf16 v[16:19], v[48:51], v[80:83], v[16:19]
ds_read_b64_tr_b16 v[72:73], v11 offset:0
s_waitcnt vmcnt(30) lgkmcnt(9)
v_mfma_f32_16x16x32_bf16 v[16:19], v[52:55], v[88:91], v[16:19]
ds_read_b64_tr_b16 v[74:75], v11 offset:1024
s_waitcnt vmcnt(29)
v_mfma_f32_16x16x32_bf16 v[32:35], v[48:51], v[84:87], v[32:35]
ds_read_b64_tr_b16 v[76:77], v11 offset:4096
s_waitcnt vmcnt(28)
v_mfma_f32_16x16x32_bf16 v[32:35], v[52:55], v[92:95], v[32:35]
ds_read_b64_tr_b16 v[78:79], v11 offset:5120
s_waitcnt lgkmcnt(10)
v_mfma_f32_16x16x32_bf16 v[20:23], v[56:59], v[80:83], v[20:23]
ds_read_b64_tr_b16 v[48:49], v8 offset:8192
s_waitcnt lgkmcnt(9)
v_mfma_f32_16x16x32_bf16 v[20:23], v[60:63], v[88:91], v[20:23]
ds_read_b64_tr_b16 v[50:51], v8 offset:9216
v_mfma_f32_16x16x32_bf16 v[36:39], v[56:59], v[84:87], v[36:39]
ds_read_b64_tr_b16 v[52:53], v8 offset:12288
v_mfma_f32_16x16x32_bf16 v[36:39], v[60:63], v[92:95], v[36:39]
ds_read_b64_tr_b16 v[54:55], v8 offset:13312
s_waitcnt lgkmcnt(10)
v_mfma_f32_16x16x32_bf16 v[24:27], v[64:67], v[80:83], v[24:27]
ds_read_b64_tr_b16 v[56:57], v9 offset:8192
s_waitcnt lgkmcnt(9)
v_mfma_f32_16x16x32_bf16 v[24:27], v[68:71], v[88:91], v[24:27]
ds_read_b64_tr_b16 v[58:59], v9 offset:9216
v_mfma_f32_16x16x32_bf16 v[40:43], v[64:67], v[84:87], v[40:43]
ds_read_b64_tr_b16 v[60:61], v9 offset:12288
v_mfma_f32_16x16x32_bf16 v[40:43], v[68:71], v[92:95], v[40:43]
ds_read_b64_tr_b16 v[62:63], v9 offset:13312
s_waitcnt lgkmcnt(10)
v_mfma_f32_16x16x32_bf16 v[28:31], v[72:75], v[80:83], v[28:31]
ds_read_b64_tr_b16 v[64:65], v10 offset:8192
s_waitcnt lgkmcnt(9)
v_mfma_f32_16x16x32_bf16 v[28:31], v[76:79], v[88:91], v[28:31]
ds_read_b64_tr_b16 v[66:67], v10 offset:9216
v_mfma_f32_16x16x32_bf16 v[44:47], v[72:75], v[84:87], v[44:47]
ds_read_b64_tr_b16 v[68:69], v10 offset:12288
v_mfma_f32_16x16x32_bf16 v[44:47], v[76:79], v[92:95], v[44:47]
ds_read_b64_tr_b16 v[70:71], v10 offset:13312
s_waitcnt vmcnt(27) lgkmcnt(10)
v_mfma_f32_16x16x32_bf16 v[16:19], v[48:51], v[96:99], v[16:19]
ds_read_b64_tr_b16 v[72:73], v11 offset:8192
buffer_load_dwordx4 v[80:83], v6, s[20:23], s66 offen offset:0 sc1
s_waitcnt vmcnt(27) lgkmcnt(9)
v_mfma_f32_16x16x32_bf16 v[16:19], v[52:55], v[104:107], v[16:19]
ds_read_b64_tr_b16 v[74:75], v11 offset:9216
buffer_load_dwordx4 v[88:91], v6, s[20:23], s66 offen offset:2048 sc1
s_waitcnt vmcnt(27)
v_mfma_f32_16x16x32_bf16 v[32:35], v[48:51], v[100:103], v[32:35]
ds_read_b64_tr_b16 v[76:77], v11 offset:12288
buffer_load_dwordx4 v[84:87], v6, s[20:23], s66 offen offset:256 sc1
s_waitcnt vmcnt(27)
v_mfma_f32_16x16x32_bf16 v[32:35], v[52:55], v[108:111], v[32:35]
ds_read_b64_tr_b16 v[78:79], v11 offset:13312
buffer_load_dwordx4 v[92:95], v6, s[20:23], s66 offen offset:2304 sc1
s_waitcnt lgkmcnt(10)
v_mfma_f32_16x16x32_bf16 v[20:23], v[56:59], v[96:99], v[20:23]
ds_read_b64_tr_b16 v[48:49], v8 offset:16384
s_add_u32 s66, s66, 4096
s_and_b32 s66, s66, 0xffff
s_waitcnt lgkmcnt(9)
v_mfma_f32_16x16x32_bf16 v[20:23], v[60:63], v[104:107], v[20:23]
ds_read_b64_tr_b16 v[50:51], v8 offset:17408
v_mfma_f32_16x16x32_bf16 v[36:39], v[56:59], v[100:103], v[36:39]
ds_read_b64_tr_b16 v[52:53], v8 offset:20480
v_mfma_f32_16x16x32_bf16 v[36:39], v[60:63], v[108:111], v[36:39]
ds_read_b64_tr_b16 v[54:55], v8 offset:21504
s_waitcnt lgkmcnt(10)
v_mfma_f32_16x16x32_bf16 v[24:27], v[64:67], v[96:99], v[24:27]
ds_read_b64_tr_b16 v[56:57], v9 offset:16384
s_waitcnt lgkmcnt(9)
v_mfma_f32_16x16x32_bf16 v[24:27], v[68:71], v[104:107], v[24:27]
ds_read_b64_tr_b16 v[58:59], v9 offset:17408
v_mfma_f32_16x16x32_bf16 v[40:43], v[64:67], v[100:103], v[40:43]
ds_read_b64_tr_b16 v[60:61], v9 offset:20480
v_mfma_f32_16x16x32_bf16 v[40:43], v[68:71], v[108:111], v[40:43]
ds_read_b64_tr_b16 v[62:63], v9 offset:21504
s_waitcnt lgkmcnt(10)
v_mfma_f32_16x16x32_bf16 v[28:31], v[72:75], v[96:99], v[28:31]
ds_read_b64_tr_b16 v[64:65], v10 offset:16384
s_waitcnt lgkmcnt(9)
v_mfma_f32_16x16x32_bf16 v[28:31], v[76:79], v[104:107], v[28:31]
ds_read_b64_tr_b16 v[66:67], v10 offset:17408
v_mfma_f32_16x16x32_bf16 v[44:47], v[72:75], v[100:103], v[44:47]
ds_read_b64_tr_b16 v[68:69], v10 offset:20480
v_mfma_f32_16x16x32_bf16 v[44:47], v[76:79], v[108:111], v[44:47]
ds_read_b64_tr_b16 v[70:71], v10 offset:21504
s_waitcnt vmcnt(27) lgkmcnt(10)
v_mfma_f32_16x16x32_bf16 v[16:19], v[48:51], v[112:115], v[16:19]
ds_read_b64_tr_b16 v[72:73], v11 offset:16384
buffer_load_dwordx4 v[96:99], v6, s[20:23], s66 offen offset:0 sc1
s_waitcnt vmcnt(27) lgkmcnt(9)
v_mfma_f32_16x16x32_bf16 v[16:19], v[52:55], v[120:123], v[16:19]
ds_read_b64_tr_b16 v[74:75], v11 offset:17408
buffer_load_dwordx4 v[104:107], v6, s[20:23], s66 offen offset:2048 sc1
s_waitcnt vmcnt(27)
v_mfma_f32_16x16x32_bf16 v[32:35], v[48:51], v[116:119], v[32:35]
ds_read_b64_tr_b16 v[76:77], v11 offset:20480
buffer_load_dwordx4 v[100:103], v6, s[20:23], s66 offen offset:256 sc1
s_waitcnt vmcnt(27)
v_mfma_f32_16x16x32_bf16 v[32:35], v[52:55], v[124:127], v[32:35]
ds_read_b64_tr_b16 v[78:79], v11 offset:21504
buffer_load_dwordx4 v[108:111], v6, s[20:23], s66 offen offset:2304 sc1
s_waitcnt lgkmcnt(10)
v_mfma_f32_16x16x32_bf16 v[20:23], v[56:59], v[112:115], v[20:23]
ds_read_b64_tr_b16 v[48:49], v8 offset:24576
s_add_u32 s66, s66, 4096
s_and_b32 s66, s66, 0xffff
s_waitcnt lgkmcnt(9)
v_mfma_f32_16x16x32_bf16 v[20:23], v[60:63], v[120:123], v[20:23]
ds_read_b64_tr_b16 v[50:51], v8 offset:25600
v_mfma_f32_16x16x32_bf16 v[36:39], v[56:59], v[116:119], v[36:39]
ds_read_b64_tr_b16 v[52:53], v8 offset:28672
v_mfma_f32_16x16x32_bf16 v[36:39], v[60:63], v[124:127], v[36:39]
ds_read_b64_tr_b16 v[54:55], v8 offset:29696
s_waitcnt lgkmcnt(10)
v_mfma_f32_16x16x32_bf16 v[24:27], v[64:67], v[112:115], v[24:27]
ds_read_b64_tr_b16 v[56:57], v9 offset:24576
s_waitcnt lgkmcnt(9)
v_mfma_f32_16x16x32_bf16 v[24:27], v[68:71], v[120:123], v[24:27]
ds_read_b64_tr_b16 v[58:59], v9 offset:25600
v_mfma_f32_16x16x32_bf16 v[40:43], v[64:67], v[116:119], v[40:43]
ds_read_b64_tr_b16 v[60:61], v9 offset:28672
v_mfma_f32_16x16x32_bf16 v[40:43], v[68:71], v[124:127], v[40:43]
ds_read_b64_tr_b16 v[62:63], v9 offset:29696
s_waitcnt lgkmcnt(10)
v_mfma_f32_16x16x32_bf16 v[28:31], v[72:75], v[112:115], v[28:31]
ds_read_b64_tr_b16 v[64:65], v10 offset:24576
s_waitcnt lgkmcnt(9)
v_mfma_f32_16x16x32_bf16 v[28:31], v[76:79], v[120:123], v[28:31]
ds_read_b64_tr_b16 v[66:67], v10 offset:25600
v_mfma_f32_16x16x32_bf16 v[44:47], v[72:75], v[116:119], v[44:47]
ds_read_b64_tr_b16 v[68:69], v10 offset:28672
v_mfma_f32_16x16x32_bf16 v[44:47], v[76:79], v[124:127], v[44:47]
ds_read_b64_tr_b16 v[70:71], v10 offset:29696
s_waitcnt vmcnt(27) lgkmcnt(10)
v_mfma_f32_16x16x32_bf16 v[16:19], v[48:51], v[128:131], v[16:19]
ds_read_b64_tr_b16 v[72:73], v11 offset:24576
buffer_load_dwordx4 v[112:115], v6, s[20:23], s66 offen offset:0 sc1
s_waitcnt vmcnt(27) lgkmcnt(9)
v_mfma_f32_16x16x32_bf16 v[16:19], v[52:55], v[136:139], v[16:19]
ds_read_b64_tr_b16 v[74:75], v11 offset:25600
buffer_load_dwordx4 v[120:123], v6, s[20:23], s66 offen offset:2048 sc1
s_waitcnt vmcnt(27)
v_mfma_f32_16x16x32_bf16 v[32:35], v[48:51], v[132:135], v[32:35]
ds_read_b64_tr_b16 v[76:77], v11 offset:28672
buffer_load_dwordx4 v[116:119], v6, s[20:23], s66 offen offset:256 sc1
s_waitcnt vmcnt(27)
v_mfma_f32_16x16x32_bf16 v[32:35], v[52:55], v[140:143], v[32:35]
ds_read_b64_tr_b16 v[78:79], v11 offset:29696
buffer_load_dwordx4 v[124:127], v6, s[20:23], s66 offen offset:2304 sc1
s_waitcnt lgkmcnt(10)
v_mfma_f32_16x16x32_bf16 v[20:23], v[56:59], v[128:131], v[20:23]
ds_read_b64_tr_b16 v[48:49], v8 offset:32768
s_add_u32 s66, s66, 4096
s_and_b32 s66, s66, 0xffff
s_waitcnt lgkmcnt(9)
v_mfma_f32_16x16x32_bf16 v[20:23], v[60:63], v[136:139], v[20:23]
ds_read_b64_tr_b16 v[50:51], v8 offset:33792
v_mfma_f32_16x16x32_bf16 v[36:39], v[56:59], v[132:135], v[36:39]
ds_read_b64_tr_b16 v[52:53], v8 offset:36864
v_mfma_f32_16x16x32_bf16 v[36:39], v[60:63], v[140:143], v[36:39]
ds_read_b64_tr_b16 v[54:55], v8 offset:37888
s_waitcnt lgkmcnt(10)
v_mfma_f32_16x16x32_bf16 v[24:27], v[64:67], v[128:131], v[24:27]
ds_read_b64_tr_b16 v[56:57], v9 offset:32768
s_waitcnt lgkmcnt(9)
v_mfma_f32_16x16x32_bf16 v[24:27], v[68:71], v[136:139], v[24:27]
ds_read_b64_tr_b16 v[58:59], v9 offset:33792
v_mfma_f32_16x16x32_bf16 v[40:43], v[64:67], v[132:135], v[40:43]
ds_read_b64_tr_b16 v[60:61], v9 offset:36864
v_mfma_f32_16x16x32_bf16 v[40:43], v[68:71], v[140:143], v[40:43]
ds_read_b64_tr_b16 v[62:63], v9 offset:37888
s_waitcnt lgkmcnt(10)
v_mfma_f32_16x16x32_bf16 v[28:31], v[72:75], v[128:131], v[28:31]
ds_read_b64_tr_b16 v[64:65], v10 offset:32768
s_waitcnt lgkmcnt(9)
v_mfma_f32_16x16x32_bf16 v[28:31], v[76:79], v[136:139], v[28:31]
ds_read_b64_tr_b16 v[66:67], v10 offset:33792
v_mfma_f32_16x16x32_bf16 v[44:47], v[72:75], v[132:135], v[44:47]
ds_read_b64_tr_b16 v[68:69], v10 offset:36864
v_mfma_f32_16x16x32_bf16 v[44:47], v[76:79], v[140:143], v[44:47]
ds_read_b64_tr_b16 v[70:71], v10 offset:37888
s_waitcnt vmcnt(27) lgkmcnt(10)
v_mfma_f32_16x16x32_bf16 v[16:19], v[48:51], v[144:147], v[16:19]
ds_read_b64_tr_b16 v[72:73], v11 offset:32768
buffer_load_dwordx4 v[128:131], v6, s[20:23], s66 offen offset:0 sc1
s_waitcnt vmcnt(27) lgkmcnt(9)
v_mfma_f32_16x16x32_bf16 v[16:19], v[52:55], v[152:155], v[16:19]
ds_read_b64_tr_b16 v[74:75], v11 offset:33792
buffer_load_dwordx4 v[136:139], v6, s[20:23], s66 offen offset:2048 sc1
s_waitcnt vmcnt(27)
v_mfma_f32_16x16x32_bf16 v[32:35], v[48:51], v[148:151], v[32:35]
ds_read_b64_tr_b16 v[76:77], v11 offset:36864
buffer_load_dwordx4 v[132:135], v6, s[20:23], s66 offen offset:256 sc1
s_waitcnt vmcnt(27)
v_mfma_f32_16x16x32_bf16 v[32:35], v[52:55], v[156:159], v[32:35]
ds_read_b64_tr_b16 v[78:79], v11 offset:37888
buffer_load_dwordx4 v[140:143], v6, s[20:23], s66 offen offset:2304 sc1
s_waitcnt lgkmcnt(10)
v_mfma_f32_16x16x32_bf16 v[20:23], v[56:59], v[144:147], v[20:23]
ds_read_b64_tr_b16 v[48:49], v8 offset:40960
s_add_u32 s66, s66, 4096
s_and_b32 s66, s66, 0xffff
s_waitcnt lgkmcnt(9)
v_mfma_f32_16x16x32_bf16 v[20:23], v[60:63], v[152:155], v[20:23]
ds_read_b64_tr_b16 v[50:51], v8 offset:41984
v_mfma_f32_16x16x32_bf16 v[36:39], v[56:59], v[148:151], v[36:39]
ds_read_b64_tr_b16 v[52:53], v8 offset:45056
v_mfma_f32_16x16x32_bf16 v[36:39], v[60:63], v[156:159], v[36:39]
ds_read_b64_tr_b16 v[54:55], v8 offset:46080
s_waitcnt lgkmcnt(10)
v_mfma_f32_16x16x32_bf16 v[24:27], v[64:67], v[144:147], v[24:27]
ds_read_b64_tr_b16 v[56:57], v9 offset:40960
s_waitcnt lgkmcnt(9)
v_mfma_f32_16x16x32_bf16 v[24:27], v[68:71], v[152:155], v[24:27]
ds_read_b64_tr_b16 v[58:59], v9 offset:41984
v_mfma_f32_16x16x32_bf16 v[40:43], v[64:67], v[148:151], v[40:43]
ds_read_b64_tr_b16 v[60:61], v9 offset:45056
v_mfma_f32_16x16x32_bf16 v[40:43], v[68:71], v[156:159], v[40:43]
ds_read_b64_tr_b16 v[62:63], v9 offset:46080
s_waitcnt lgkmcnt(10)
v_mfma_f32_16x16x32_bf16 v[28:31], v[72:75], v[144:147], v[28:31]
ds_read_b64_tr_b16 v[64:65], v10 offset:40960
s_waitcnt lgkmcnt(9)
v_mfma_f32_16x16x32_bf16 v[28:31], v[76:79], v[152:155], v[28:31]
ds_read_b64_tr_b16 v[66:67], v10 offset:41984
v_mfma_f32_16x16x32_bf16 v[44:47], v[72:75], v[148:151], v[44:47]
ds_read_b64_tr_b16 v[68:69], v10 offset:45056
v_mfma_f32_16x16x32_bf16 v[44:47], v[76:79], v[156:159], v[44:47]
ds_read_b64_tr_b16 v[70:71], v10 offset:46080
s_waitcnt vmcnt(27) lgkmcnt(10)
v_mfma_f32_16x16x32_bf16 v[16:19], v[48:51], v[160:163], v[16:19]
ds_read_b64_tr_b16 v[72:73], v11 offset:40960
buffer_load_dwordx4 v[144:147], v6, s[20:23], s66 offen offset:0 sc1
s_waitcnt vmcnt(27) lgkmcnt(9)
v_mfma_f32_16x16x32_bf16 v[16:19], v[52:55], v[168:171], v[16:19]
ds_read_b64_tr_b16 v[74:75], v11 offset:41984
buffer_load_dwordx4 v[152:155], v6, s[20:23], s66 offen offset:2048 sc1
s_waitcnt vmcnt(27)
v_mfma_f32_16x16x32_bf16 v[32:35], v[48:51], v[164:167], v[32:35]
ds_read_b64_tr_b16 v[76:77], v11 offset:45056
buffer_load_dwordx4 v[148:151], v6, s[20:23], s66 offen offset:256 sc1
s_waitcnt vmcnt(27)
v_mfma_f32_16x16x32_bf16 v[32:35], v[52:55], v[172:175], v[32:35]
ds_read_b64_tr_b16 v[78:79], v11 offset:46080
buffer_load_dwordx4 v[156:159], v6, s[20:23], s66 offen offset:2304 sc1
s_waitcnt lgkmcnt(10)
v_mfma_f32_16x16x32_bf16 v[20:23], v[56:59], v[160:163], v[20:23]
ds_read_b64_tr_b16 v[48:49], v8 offset:49152
s_add_u32 s66, s66, 4096
s_and_b32 s66, s66, 0xffff
s_waitcnt lgkmcnt(9)
v_mfma_f32_16x16x32_bf16 v[20:23], v[60:63], v[168:171], v[20:23]
ds_read_b64_tr_b16 v[50:51], v8 offset:50176
v_mfma_f32_16x16x32_bf16 v[36:39], v[56:59], v[164:167], v[36:39]
ds_read_b64_tr_b16 v[52:53], v8 offset:53248
v_mfma_f32_16x16x32_bf16 v[36:39], v[60:63], v[172:175], v[36:39]
ds_read_b64_tr_b16 v[54:55], v8 offset:54272
s_waitcnt lgkmcnt(10)
v_mfma_f32_16x16x32_bf16 v[24:27], v[64:67], v[160:163], v[24:27]
ds_read_b64_tr_b16 v[56:57], v9 offset:49152
s_waitcnt lgkmcnt(9)
v_mfma_f32_16x16x32_bf16 v[24:27], v[68:71], v[168:171], v[24:27]
ds_read_b64_tr_b16 v[58:59], v9 offset:50176
v_mfma_f32_16x16x32_bf16 v[40:43], v[64:67], v[164:167], v[40:43]
ds_read_b64_tr_b16 v[60:61], v9 offset:53248
v_mfma_f32_16x16x32_bf16 v[40:43], v[68:71], v[172:175], v[40:43]
ds_read_b64_tr_b16 v[62:63], v9 offset:54272
s_waitcnt lgkmcnt(10)
v_mfma_f32_16x16x32_bf16 v[28:31], v[72:75], v[160:163], v[28:31]
ds_read_b64_tr_b16 v[64:65], v10 offset:49152
s_waitcnt lgkmcnt(9)
v_mfma_f32_16x16x32_bf16 v[28:31], v[76:79], v[168:171], v[28:31]
ds_read_b64_tr_b16 v[66:67], v10 offset:50176
v_mfma_f32_16x16x32_bf16 v[44:47], v[72:75], v[164:167], v[44:47]
ds_read_b64_tr_b16 v[68:69], v10 offset:53248
v_mfma_f32_16x16x32_bf16 v[44:47], v[76:79], v[172:175], v[44:47]
ds_read_b64_tr_b16 v[70:71], v10 offset:54272
s_waitcnt vmcnt(27) lgkmcnt(10)
v_mfma_f32_16x16x32_bf16 v[16:19], v[48:51], v[176:179], v[16:19]
ds_read_b64_tr_b16 v[72:73], v11 offset:49152
buffer_load_dwordx4 v[160:163], v6, s[20:23], s66 offen offset:0 sc1
s_waitcnt vmcnt(27) lgkmcnt(9)
v_mfma_f32_16x16x32_bf16 v[16:19], v[52:55], v[184:187], v[16:19]
ds_read_b64_tr_b16 v[74:75], v11 offset:50176
buffer_load_dwordx4 v[168:171], v6, s[20:23], s66 offen offset:2048 sc1
s_waitcnt vmcnt(27)
v_mfma_f32_16x16x32_bf16 v[32:35], v[48:51], v[180:183], v[32:35]
ds_read_b64_tr_b16 v[76:77], v11 offset:53248
buffer_load_dwordx4 v[164:167], v6, s[20:23], s66 offen offset:256 sc1
s_waitcnt vmcnt(27)
v_mfma_f32_16x16x32_bf16 v[32:35], v[52:55], v[188:191], v[32:35]
ds_read_b64_tr_b16 v[78:79], v11 offset:54272
buffer_load_dwordx4 v[172:175], v6, s[20:23], s66 offen offset:2304 sc1
s_waitcnt lgkmcnt(10)
v_mfma_f32_16x16x32_bf16 v[20:23], v[56:59], v[176:179], v[20:23]
ds_read_b64_tr_b16 v[48:49], v8 offset:57344
s_add_u32 s66, s66, 4096
s_and_b32 s66, s66, 0xffff
s_waitcnt lgkmcnt(9)
v_mfma_f32_16x16x32_bf16 v[20:23], v[60:63], v[184:187], v[20:23]
ds_read_b64_tr_b16 v[50:51], v8 offset:58368
v_mfma_f32_16x16x32_bf16 v[36:39], v[56:59], v[180:183], v[36:39]
ds_read_b64_tr_b16 v[52:53], v8 offset:61440
v_mfma_f32_16x16x32_bf16 v[36:39], v[60:63], v[188:191], v[36:39]
ds_read_b64_tr_b16 v[54:55], v8 offset:62464
s_waitcnt lgkmcnt(10)
v_mfma_f32_16x16x32_bf16 v[24:27], v[64:67], v[176:179], v[24:27]
ds_read_b64_tr_b16 v[56:57], v9 offset:57344
s_waitcnt lgkmcnt(9)
v_mfma_f32_16x16x32_bf16 v[24:27], v[68:71], v[184:187], v[24:27]
ds_read_b64_tr_b16 v[58:59], v9 offset:58368
v_mfma_f32_16x16x32_bf16 v[40:43], v[64:67], v[180:183], v[40:43]
ds_read_b64_tr_b16 v[60:61], v9 offset:61440
v_mfma_f32_16x16x32_bf16 v[40:43], v[68:71], v[188:191], v[40:43]
ds_read_b64_tr_b16 v[62:63], v9 offset:62464
s_waitcnt lgkmcnt(10)
v_mfma_f32_16x16x32_bf16 v[28:31], v[72:75], v[176:179], v[28:31]
ds_read_b64_tr_b16 v[64:65], v10 offset:57344
s_waitcnt lgkmcnt(9)
v_mfma_f32_16x16x32_bf16 v[28:31], v[76:79], v[184:187], v[28:31]
ds_read_b64_tr_b16 v[66:67], v10 offset:58368
v_mfma_f32_16x16x32_bf16 v[44:47], v[72:75], v[180:183], v[44:47]
ds_read_b64_tr_b16 v[68:69], v10 offset:61440
v_mfma_f32_16x16x32_bf16 v[44:47], v[76:79], v[188:191], v[44:47]
ds_read_b64_tr_b16 v[70:71], v10 offset:62464
s_waitcnt vmcnt(27) lgkmcnt(10)
v_mfma_f32_16x16x32_bf16 v[16:19], v[48:51], v[192:195], v[16:19]
ds_read_b64_tr_b16 v[72:73], v11 offset:57344
buffer_load_dwordx4 v[176:179], v6, s[20:23], s66 offen offset:0 sc1
s_waitcnt vmcnt(27) lgkmcnt(9)
v_mfma_f32_16x16x32_bf16 v[16:19], v[52:55], v[200:203], v[16:19]
ds_read_b64_tr_b16 v[74:75], v11 offset:58368
buffer_load_dwordx4 v[184:187], v6, s[20:23], s66 offen offset:2048 sc1
s_waitcnt vmcnt(27)
v_mfma_f32_16x16x32_bf16 v[32:35], v[48:51], v[196:199], v[32:35]
ds_read_b64_tr_b16 v[76:77], v11 offset:61440
buffer_load_dwordx4 v[180:183], v6, s[20:23], s66 offen offset:256 sc1
s_waitcnt vmcnt(27)
v_mfma_f32_16x16x32_bf16 v[32:35], v[52:55], v[204:207], v[32:35]
ds_read_b64_tr_b16 v[78:79], v11 offset:62464
buffer_load_dwordx4 v[188:191], v6, s[20:23], s66 offen offset:2304 sc1
s_waitcnt lgkmcnt(10)
v_mfma_f32_16x16x32_bf16 v[20:23], v[56:59], v[192:195], v[20:23]
ds_read_b64_tr_b16 v[48:49], v12 offset:0
s_add_u32 s66, s66, 4096
s_and_b32 s66, s66, 0xffff
s_waitcnt lgkmcnt(9)
v_mfma_f32_16x16x32_bf16 v[20:23], v[60:63], v[200:203], v[20:23]
ds_read_b64_tr_b16 v[50:51], v12 offset:1024
v_mfma_f32_16x16x32_bf16 v[36:39], v[56:59], v[196:199], v[36:39]
ds_read_b64_tr_b16 v[52:53], v12 offset:4096
v_mfma_f32_16x16x32_bf16 v[36:39], v[60:63], v[204:207], v[36:39]
ds_read_b64_tr_b16 v[54:55], v12 offset:5120
s_waitcnt lgkmcnt(10)
v_mfma_f32_16x16x32_bf16 v[24:27], v[64:67], v[192:195], v[24:27]
ds_read_b64_tr_b16 v[56:57], v13 offset:0
s_waitcnt lgkmcnt(9)
v_mfma_f32_16x16x32_bf16 v[24:27], v[68:71], v[200:203], v[24:27]
ds_read_b64_tr_b16 v[58:59], v13 offset:1024
v_mfma_f32_16x16x32_bf16 v[40:43], v[64:67], v[196:199], v[40:43]
ds_read_b64_tr_b16 v[60:61], v13 offset:4096
v_mfma_f32_16x16x32_bf16 v[40:43], v[68:71], v[204:207], v[40:43]
ds_read_b64_tr_b16 v[62:63], v13 offset:5120
s_waitcnt lgkmcnt(10)
v_mfma_f32_16x16x32_bf16 v[28:31], v[72:75], v[192:195], v[28:31]
ds_read_b64_tr_b16 v[64:65], v14 offset:0
s_waitcnt lgkmcnt(9)
v_mfma_f32_16x16x32_bf16 v[28:31], v[76:79], v[200:203], v[28:31]
ds_read_b64_tr_b16 v[66:67], v14 offset:1024
v_mfma_f32_16x16x32_bf16 v[44:47], v[72:75], v[196:199], v[44:47]
ds_read_b64_tr_b16 v[68:69], v14 offset:4096
v_mfma_f32_16x16x32_bf16 v[44:47], v[76:79], v[204:207], v[44:47]
ds_read_b64_tr_b16 v[70:71], v14 offset:5120
s_waitcnt vmcnt(27) lgkmcnt(10)
v_mfma_f32_16x16x32_bf16 v[16:19], v[48:51], v[80:83], v[16:19]
ds_read_b64_tr_b16 v[72:73], v15 offset:0
buffer_load_dwordx4 v[192:195], v6, s[20:23], s66 offen offset:0 sc1
s_waitcnt vmcnt(27) lgkmcnt(9)
v_mfma_f32_16x16x32_bf16 v[16:19], v[52:55], v[88:91], v[16:19]
ds_read_b64_tr_b16 v[74:75], v15 offset:1024
buffer_load_dwordx4 v[200:203], v6, s[20:23], s66 offen offset:2048 sc1
s_waitcnt vmcnt(27)
v_mfma_f32_16x16x32_bf16 v[32:35], v[48:51], v[84:87], v[32:35]
ds_read_b64_tr_b16 v[76:77], v15 offset:4096
buffer_load_dwordx4 v[196:199], v6, s[20:23], s66 offen offset:256 sc1
s_waitcnt vmcnt(27)
v_mfma_f32_16x16x32_bf16 v[32:35], v[52:55], v[92:95], v[32:35]
ds_read_b64_tr_b16 v[78:79], v15 offset:5120
buffer_load_dwordx4 v[204:207], v6, s[20:23], s66 offen offset:2304 sc1
s_waitcnt lgkmcnt(10)
v_mfma_f32_16x16x32_bf16 v[20:23], v[56:59], v[80:83], v[20:23]
ds_read_b64_tr_b16 v[48:49], v12 offset:8192
s_add_u32 s66, s66, 4096
s_and_b32 s66, s66, 0xffff
s_waitcnt lgkmcnt(9)
v_mfma_f32_16x16x32_bf16 v[20:23], v[60:63], v[88:91], v[20:23]
ds_read_b64_tr_b16 v[50:51], v12 offset:9216
v_mfma_f32_16x16x32_bf16 v[36:39], v[56:59], v[84:87], v[36:39]
ds_read_b64_tr_b16 v[52:53], v12 offset:12288
v_mfma_f32_16x16x32_bf16 v[36:39], v[60:63], v[92:95], v[36:39]
ds_read_b64_tr_b16 v[54:55], v12 offset:13312
s_waitcnt lgkmcnt(10)
v_mfma_f32_16x16x32_bf16 v[24:27], v[64:67], v[80:83], v[24:27]
ds_read_b64_tr_b16 v[56:57], v13 offset:8192
s_waitcnt lgkmcnt(9)
v_mfma_f32_16x16x32_bf16 v[24:27], v[68:71], v[88:91], v[24:27]
ds_read_b64_tr_b16 v[58:59], v13 offset:9216
v_mfma_f32_16x16x32_bf16 v[40:43], v[64:67], v[84:87], v[40:43]
ds_read_b64_tr_b16 v[60:61], v13 offset:12288
v_mfma_f32_16x16x32_bf16 v[40:43], v[68:71], v[92:95], v[40:43]
ds_read_b64_tr_b16 v[62:63], v13 offset:13312
s_waitcnt lgkmcnt(10)
v_mfma_f32_16x16x32_bf16 v[28:31], v[72:75], v[80:83], v[28:31]
ds_read_b64_tr_b16 v[64:65], v14 offset:8192
s_waitcnt lgkmcnt(9)
v_mfma_f32_16x16x32_bf16 v[28:31], v[76:79], v[88:91], v[28:31]
ds_read_b64_tr_b16 v[66:67], v14 offset:9216
v_mfma_f32_16x16x32_bf16 v[44:47], v[72:75], v[84:87], v[44:47]
ds_read_b64_tr_b16 v[68:69], v14 offset:12288
v_mfma_f32_16x16x32_bf16 v[44:47], v[76:79], v[92:95], v[44:47]
ds_read_b64_tr_b16 v[70:71], v14 offset:13312
s_waitcnt vmcnt(27) lgkmcnt(10)
v_mfma_f32_16x16x32_bf16 v[16:19], v[48:51], v[96:99], v[16:19]
ds_read_b64_tr_b16 v[72:73], v15 offset:8192
s_waitcnt vmcnt(26) lgkmcnt(9)
v_mfma_f32_16x16x32_bf16 v[16:19], v[52:55], v[104:107], v[16:19]
ds_read_b64_tr_b16 v[74:75], v15 offset:9216
s_waitcnt vmcnt(25)
v_mfma_f32_16x16x32_bf16 v[32:35], v[48:51], v[100:103], v[32:35]
ds_read_b64_tr_b16 v[76:77], v15 offset:12288
s_waitcnt vmcnt(24)
v_mfma_f32_16x16x32_bf16 v[32:35], v[52:55], v[108:111], v[32:35]
ds_read_b64_tr_b16 v[78:79], v15 offset:13312
s_waitcnt lgkmcnt(10)
v_mfma_f32_16x16x32_bf16 v[20:23], v[56:59], v[96:99], v[20:23]
ds_read_b64_tr_b16 v[48:49], v12 offset:16384
s_waitcnt lgkmcnt(9)
v_mfma_f32_16x16x32_bf16 v[20:23], v[60:63], v[104:107], v[20:23]
ds_read_b64_tr_b16 v[50:51], v12 offset:17408
v_mfma_f32_16x16x32_bf16 v[36:39], v[56:59], v[100:103], v[36:39]
ds_read_b64_tr_b16 v[52:53], v12 offset:20480
v_mfma_f32_16x16x32_bf16 v[36:39], v[60:63], v[108:111], v[36:39]
ds_read_b64_tr_b16 v[54:55], v12 offset:21504
s_waitcnt lgkmcnt(10)
v_mfma_f32_16x16x32_bf16 v[24:27], v[64:67], v[96:99], v[24:27]
ds_read_b64_tr_b16 v[56:57], v13 offset:16384
s_waitcnt lgkmcnt(9)
v_mfma_f32_16x16x32_bf16 v[24:27], v[68:71], v[104:107], v[24:27]
ds_read_b64_tr_b16 v[58:59], v13 offset:17408
v_mfma_f32_16x16x32_bf16 v[40:43], v[64:67], v[100:103], v[40:43]
ds_read_b64_tr_b16 v[60:61], v13 offset:20480
v_mfma_f32_16x16x32_bf16 v[40:43], v[68:71], v[108:111], v[40:43]
ds_read_b64_tr_b16 v[62:63], v13 offset:21504
s_waitcnt lgkmcnt(10)
v_mfma_f32_16x16x32_bf16 v[28:31], v[72:75], v[96:99], v[28:31]
ds_read_b64_tr_b16 v[64:65], v14 offset:16384
s_waitcnt lgkmcnt(9)
v_mfma_f32_16x16x32_bf16 v[28:31], v[76:79], v[104:107], v[28:31]
ds_read_b64_tr_b16 v[66:67], v14 offset:17408
v_mfma_f32_16x16x32_bf16 v[44:47], v[72:75], v[100:103], v[44:47]
ds_read_b64_tr_b16 v[68:69], v14 offset:20480
v_mfma_f32_16x16x32_bf16 v[44:47], v[76:79], v[108:111], v[44:47]
ds_read_b64_tr_b16 v[70:71], v14 offset:21504
s_waitcnt vmcnt(23) lgkmcnt(10)
v_mfma_f32_16x16x32_bf16 v[16:19], v[48:51], v[112:115], v[16:19]
ds_read_b64_tr_b16 v[72:73], v15 offset:16384
s_waitcnt vmcnt(22) lgkmcnt(9)
v_mfma_f32_16x16x32_bf16 v[16:19], v[52:55], v[120:123], v[16:19]
ds_read_b64_tr_b16 v[74:75], v15 offset:17408
s_waitcnt vmcnt(21)
v_mfma_f32_16x16x32_bf16 v[32:35], v[48:51], v[116:119], v[32:35]
ds_read_b64_tr_b16 v[76:77], v15 offset:20480
s_waitcnt vmcnt(20)
v_mfma_f32_16x16x32_bf16 v[32:35], v[52:55], v[124:127], v[32:35]
ds_read_b64_tr_b16 v[78:79], v15 offset:21504
s_waitcnt lgkmcnt(10)
v_mfma_f32_16x16x32_bf16 v[20:23], v[56:59], v[112:115], v[20:23]
ds_read_b64_tr_b16 v[48:49], v12 offset:24576
s_waitcnt lgkmcnt(9)
v_mfma_f32_16x16x32_bf16 v[20:23], v[60:63], v[120:123], v[20:23]
ds_read_b64_tr_b16 v[50:51], v12 offset:25600
v_mfma_f32_16x16x32_bf16 v[36:39], v[56:59], v[116:119], v[36:39]
ds_read_b64_tr_b16 v[52:53], v12 offset:28672
v_mfma_f32_16x16x32_bf16 v[36:39], v[60:63], v[124:127], v[36:39]
ds_read_b64_tr_b16 v[54:55], v12 offset:29696
s_waitcnt lgkmcnt(10)
v_mfma_f32_16x16x32_bf16 v[24:27], v[64:67], v[112:115], v[24:27]
ds_read_b64_tr_b16 v[56:57], v13 offset:24576
s_waitcnt lgkmcnt(9)
v_mfma_f32_16x16x32_bf16 v[24:27], v[68:71], v[120:123], v[24:27]
ds_read_b64_tr_b16 v[58:59], v13 offset:25600
v_mfma_f32_16x16x32_bf16 v[40:43], v[64:67], v[116:119], v[40:43]
ds_read_b64_tr_b16 v[60:61], v13 offset:28672
v_mfma_f32_16x16x32_bf16 v[40:43], v[68:71], v[124:127], v[40:43]
ds_read_b64_tr_b16 v[62:63], v13 offset:29696
s_waitcnt lgkmcnt(10)
v_mfma_f32_16x16x32_bf16 v[28:31], v[72:75], v[112:115], v[28:31]
ds_read_b64_tr_b16 v[64:65], v14 offset:24576
s_waitcnt lgkmcnt(9)
v_mfma_f32_16x16x32_bf16 v[28:31], v[76:79], v[120:123], v[28:31]
ds_read_b64_tr_b16 v[66:67], v14 offset:25600
v_mfma_f32_16x16x32_bf16 v[44:47], v[72:75], v[116:119], v[44:47]
ds_read_b64_tr_b16 v[68:69], v14 offset:28672
v_mfma_f32_16x16x32_bf16 v[44:47], v[76:79], v[124:127], v[44:47]
ds_read_b64_tr_b16 v[70:71], v14 offset:29696
s_waitcnt vmcnt(19) lgkmcnt(10)
v_mfma_f32_16x16x32_bf16 v[16:19], v[48:51], v[128:131], v[16:19]
ds_read_b64_tr_b16 v[72:73], v15 offset:24576
s_waitcnt vmcnt(18) lgkmcnt(9)
v_mfma_f32_16x16x32_bf16 v[16:19], v[52:55], v[136:139], v[16:19]
ds_read_b64_tr_b16 v[74:75], v15 offset:25600
s_waitcnt vmcnt(17)
v_mfma_f32_16x16x32_bf16 v[32:35], v[48:51], v[132:135], v[32:35]
ds_read_b64_tr_b16 v[76:77], v15 offset:28672
s_waitcnt vmcnt(16)
v_mfma_f32_16x16x32_bf16 v[32:35], v[52:55], v[140:143], v[32:35]
ds_read_b64_tr_b16 v[78:79], v15 offset:29696
s_waitcnt lgkmcnt(10)
v_mfma_f32_16x16x32_bf16 v[20:23], v[56:59], v[128:131], v[20:23]
ds_read_b64_tr_b16 v[48:49], v12 offset:32768
s_waitcnt lgkmcnt(9)
v_mfma_f32_16x16x32_bf16 v[20:23], v[60:63], v[136:139], v[20:23]
ds_read_b64_tr_b16 v[50:51], v12 offset:33792
v_mfma_f32_16x16x32_bf16 v[36:39], v[56:59], v[132:135], v[36:39]
ds_read_b64_tr_b16 v[52:53], v12 offset:36864
v_mfma_f32_16x16x32_bf16 v[36:39], v[60:63], v[140:143], v[36:39]
ds_read_b64_tr_b16 v[54:55], v12 offset:37888
s_waitcnt lgkmcnt(10)
v_mfma_f32_16x16x32_bf16 v[24:27], v[64:67], v[128:131], v[24:27]
ds_read_b64_tr_b16 v[56:57], v13 offset:32768
s_waitcnt lgkmcnt(9)
v_mfma_f32_16x16x32_bf16 v[24:27], v[68:71], v[136:139], v[24:27]
ds_read_b64_tr_b16 v[58:59], v13 offset:33792
v_mfma_f32_16x16x32_bf16 v[40:43], v[64:67], v[132:135], v[40:43]
ds_read_b64_tr_b16 v[60:61], v13 offset:36864
v_mfma_f32_16x16x32_bf16 v[40:43], v[68:71], v[140:143], v[40:43]
ds_read_b64_tr_b16 v[62:63], v13 offset:37888
s_waitcnt lgkmcnt(10)
v_mfma_f32_16x16x32_bf16 v[28:31], v[72:75], v[128:131], v[28:31]
ds_read_b64_tr_b16 v[64:65], v14 offset:32768
s_waitcnt lgkmcnt(9)
v_mfma_f32_16x16x32_bf16 v[28:31], v[76:79], v[136:139], v[28:31]
ds_read_b64_tr_b16 v[66:67], v14 offset:33792
v_mfma_f32_16x16x32_bf16 v[44:47], v[72:75], v[132:135], v[44:47]
ds_read_b64_tr_b16 v[68:69], v14 offset:36864
v_mfma_f32_16x16x32_bf16 v[44:47], v[76:79], v[140:143], v[44:47]
ds_read_b64_tr_b16 v[70:71], v14 offset:37888
s_waitcnt vmcnt(15) lgkmcnt(10)
v_mfma_f32_16x16x32_bf16 v[16:19], v[48:51], v[144:147], v[16:19]
ds_read_b64_tr_b16 v[72:73], v15 offset:32768
s_waitcnt vmcnt(14) lgkmcnt(9)
v_mfma_f32_16x16x32_bf16 v[16:19], v[52:55], v[152:155], v[16:19]
ds_read_b64_tr_b16 v[74:75], v15 offset:33792
s_waitcnt vmcnt(13)
v_mfma_f32_16x16x32_bf16 v[32:35], v[48:51], v[148:151], v[32:35]
ds_read_b64_tr_b16 v[76:77], v15 offset:36864
s_waitcnt vmcnt(12)
v_mfma_f32_16x16x32_bf16 v[32:35], v[52:55], v[156:159], v[32:35]
ds_read_b64_tr_b16 v[78:79], v15 offset:37888
s_waitcnt lgkmcnt(10)
v_mfma_f32_16x16x32_bf16 v[20:23], v[56:59], v[144:147], v[20:23]
ds_read_b64_tr_b16 v[48:49], v12 offset:40960
s_waitcnt lgkmcnt(9)
v_mfma_f32_16x16x32_bf16 v[20:23], v[60:63], v[152:155], v[20:23]
ds_read_b64_tr_b16 v[50:51], v12 offset:41984
v_mfma_f32_16x16x32_bf16 v[36:39], v[56:59], v[148:151], v[36:39]
ds_read_b64_tr_b16 v[52:53], v12 offset:45056
v_mfma_f32_16x16x32_bf16 v[36:39], v[60:63], v[156:159], v[36:39]
ds_read_b64_tr_b16 v[54:55], v12 offset:46080
s_waitcnt lgkmcnt(10)
v_mfma_f32_16x16x32_bf16 v[24:27], v[64:67], v[144:147], v[24:27]
ds_read_b64_tr_b16 v[56:57], v13 offset:40960
s_waitcnt lgkmcnt(9)
v_mfma_f32_16x16x32_bf16 v[24:27], v[68:71], v[152:155], v[24:27]
ds_read_b64_tr_b16 v[58:59], v13 offset:41984
v_mfma_f32_16x16x32_bf16 v[40:43], v[64:67], v[148:151], v[40:43]
ds_read_b64_tr_b16 v[60:61], v13 offset:45056
v_mfma_f32_16x16x32_bf16 v[40:43], v[68:71], v[156:159], v[40:43]
ds_read_b64_tr_b16 v[62:63], v13 offset:46080
s_waitcnt lgkmcnt(10)
v_mfma_f32_16x16x32_bf16 v[28:31], v[72:75], v[144:147], v[28:31]
ds_read_b64_tr_b16 v[64:65], v14 offset:40960
s_waitcnt lgkmcnt(9)
v_mfma_f32_16x16x32_bf16 v[28:31], v[76:79], v[152:155], v[28:31]
ds_read_b64_tr_b16 v[66:67], v14 offset:41984
v_mfma_f32_16x16x32_bf16 v[44:47], v[72:75], v[148:151], v[44:47]
ds_read_b64_tr_b16 v[68:69], v14 offset:45056
v_mfma_f32_16x16x32_bf16 v[44:47], v[76:79], v[156:159], v[44:47]
ds_read_b64_tr_b16 v[70:71], v14 offset:46080
s_waitcnt vmcnt(11) lgkmcnt(10)
v_mfma_f32_16x16x32_bf16 v[16:19], v[48:51], v[160:163], v[16:19]
ds_read_b64_tr_b16 v[72:73], v15 offset:40960
s_waitcnt vmcnt(10) lgkmcnt(9)
v_mfma_f32_16x16x32_bf16 v[16:19], v[52:55], v[168:171], v[16:19]
ds_read_b64_tr_b16 v[74:75], v15 offset:41984
s_waitcnt vmcnt(9)
v_mfma_f32_16x16x32_bf16 v[32:35], v[48:51], v[164:167], v[32:35]
ds_read_b64_tr_b16 v[76:77], v15 offset:45056
s_waitcnt vmcnt(8)
v_mfma_f32_16x16x32_bf16 v[32:35], v[52:55], v[172:175], v[32:35]
ds_read_b64_tr_b16 v[78:79], v15 offset:46080
s_waitcnt lgkmcnt(10)
v_mfma_f32_16x16x32_bf16 v[20:23], v[56:59], v[160:163], v[20:23]
ds_read_b64_tr_b16 v[48:49], v12 offset:49152
s_waitcnt lgkmcnt(9)
v_mfma_f32_16x16x32_bf16 v[20:23], v[60:63], v[168:171], v[20:23]
ds_read_b64_tr_b16 v[50:51], v12 offset:50176
v_mfma_f32_16x16x32_bf16 v[36:39], v[56:59], v[164:167], v[36:39]
ds_read_b64_tr_b16 v[52:53], v12 offset:53248
v_mfma_f32_16x16x32_bf16 v[36:39], v[60:63], v[172:175], v[36:39]
ds_read_b64_tr_b16 v[54:55], v12 offset:54272
s_waitcnt lgkmcnt(10)
v_mfma_f32_16x16x32_bf16 v[24:27], v[64:67], v[160:163], v[24:27]
ds_read_b64_tr_b16 v[56:57], v13 offset:49152
s_waitcnt lgkmcnt(9)
v_mfma_f32_16x16x32_bf16 v[24:27], v[68:71], v[168:171], v[24:27]
ds_read_b64_tr_b16 v[58:59], v13 offset:50176
v_mfma_f32_16x16x32_bf16 v[40:43], v[64:67], v[164:167], v[40:43]
ds_read_b64_tr_b16 v[60:61], v13 offset:53248
v_mfma_f32_16x16x32_bf16 v[40:43], v[68:71], v[172:175], v[40:43]
ds_read_b64_tr_b16 v[62:63], v13 offset:54272
s_waitcnt lgkmcnt(10)
v_mfma_f32_16x16x32_bf16 v[28:31], v[72:75], v[160:163], v[28:31]
ds_read_b64_tr_b16 v[64:65], v14 offset:49152
s_waitcnt lgkmcnt(9)
v_mfma_f32_16x16x32_bf16 v[28:31], v[76:79], v[168:171], v[28:31]
ds_read_b64_tr_b16 v[66:67], v14 offset:50176
v_mfma_f32_16x16x32_bf16 v[44:47], v[72:75], v[164:167], v[44:47]
ds_read_b64_tr_b16 v[68:69], v14 offset:53248
v_mfma_f32_16x16x32_bf16 v[44:47], v[76:79], v[172:175], v[44:47]
ds_read_b64_tr_b16 v[70:71], v14 offset:54272
s_waitcnt vmcnt(7) lgkmcnt(10)
v_mfma_f32_16x16x32_bf16 v[16:19], v[48:51], v[176:179], v[16:19]
ds_read_b64_tr_b16 v[72:73], v15 offset:49152
s_waitcnt vmcnt(6) lgkmcnt(9)
v_mfma_f32_16x16x32_bf16 v[16:19], v[52:55], v[184:187], v[16:19]
ds_read_b64_tr_b16 v[74:75], v15 offset:50176
s_waitcnt vmcnt(5)
v_mfma_f32_16x16x32_bf16 v[32:35], v[48:51], v[180:183], v[32:35]
ds_read_b64_tr_b16 v[76:77], v15 offset:53248
s_waitcnt vmcnt(4)
v_mfma_f32_16x16x32_bf16 v[32:35], v[52:55], v[188:191], v[32:35]
ds_read_b64_tr_b16 v[78:79], v15 offset:54272
s_waitcnt lgkmcnt(10)
v_mfma_f32_16x16x32_bf16 v[20:23], v[56:59], v[176:179], v[20:23]
ds_read_b64_tr_b16 v[48:49], v12 offset:57344
s_waitcnt lgkmcnt(9)
v_mfma_f32_16x16x32_bf16 v[20:23], v[60:63], v[184:187], v[20:23]
ds_read_b64_tr_b16 v[50:51], v12 offset:58368
v_mfma_f32_16x16x32_bf16 v[36:39], v[56:59], v[180:183], v[36:39]
ds_read_b64_tr_b16 v[52:53], v12 offset:61440
v_mfma_f32_16x16x32_bf16 v[36:39], v[60:63], v[188:191], v[36:39]
ds_read_b64_tr_b16 v[54:55], v12 offset:62464
s_waitcnt lgkmcnt(10)
v_mfma_f32_16x16x32_bf16 v[24:27], v[64:67], v[176:179], v[24:27]
ds_read_b64_tr_b16 v[56:57], v13 offset:57344
s_waitcnt lgkmcnt(9)
v_mfma_f32_16x16x32_bf16 v[24:27], v[68:71], v[184:187], v[24:27]
ds_read_b64_tr_b16 v[58:59], v13 offset:58368
v_mfma_f32_16x16x32_bf16 v[40:43], v[64:67], v[180:183], v[40:43]
ds_read_b64_tr_b16 v[60:61], v13 offset:61440
v_mfma_f32_16x16x32_bf16 v[40:43], v[68:71], v[188:191], v[40:43]
ds_read_b64_tr_b16 v[62:63], v13 offset:62464
s_waitcnt lgkmcnt(10)
v_mfma_f32_16x16x32_bf16 v[28:31], v[72:75], v[176:179], v[28:31]
ds_read_b64_tr_b16 v[64:65], v14 offset:57344
s_waitcnt lgkmcnt(9)
v_mfma_f32_16x16x32_bf16 v[28:31], v[76:79], v[184:187], v[28:31]
ds_read_b64_tr_b16 v[66:67], v14 offset:58368
v_mfma_f32_16x16x32_bf16 v[44:47], v[72:75], v[180:183], v[44:47]
ds_read_b64_tr_b16 v[68:69], v14 offset:61440
v_mfma_f32_16x16x32_bf16 v[44:47], v[76:79], v[188:191], v[44:47]
ds_read_b64_tr_b16 v[70:71], v14 offset:62464
s_waitcnt vmcnt(3) lgkmcnt(10)
v_mfma_f32_16x16x32_bf16 v[16:19], v[48:51], v[192:195], v[16:19]
ds_read_b64_tr_b16 v[72:73], v15 offset:57344
s_waitcnt vmcnt(2) lgkmcnt(9)
v_mfma_f32_16x16x32_bf16 v[16:19], v[52:55], v[200:203], v[16:19]
ds_read_b64_tr_b16 v[74:75], v15 offset:58368
s_waitcnt vmcnt(1)
v_mfma_f32_16x16x32_bf16 v[32:35], v[48:51], v[196:199], v[32:35]
ds_read_b64_tr_b16 v[76:77], v15 offset:61440
s_waitcnt vmcnt(0)
v_mfma_f32_16x16x32_bf16 v[32:35], v[52:55], v[204:207], v[32:35]
ds_read_b64_tr_b16 v[78:79], v15 offset:62464
s_waitcnt lgkmcnt(10)
v_mfma_f32_16x16x32_bf16 v[20:23], v[56:59], v[192:195], v[20:23]
v_add_u32 v5, s34, 22
s_mov_b64 exec, 1
ds_write_b32 v3, v5
s_mov_b64 exec, -1
s_waitcnt lgkmcnt(9)
v_mfma_f32_16x16x32_bf16 v[20:23], v[60:63], v[200:203], v[20:23]
v_mfma_f32_16x16x32_bf16 v[36:39], v[56:59], v[196:199], v[36:39]
v_mfma_f32_16x16x32_bf16 v[36:39], v[60:63], v[204:207], v[36:39]
s_waitcnt lgkmcnt(7)
v_mfma_f32_16x16x32_bf16 v[24:27], v[64:67], v[192:195], v[24:27]
s_waitcnt lgkmcnt(5)
v_mfma_f32_16x16x32_bf16 v[24:27], v[68:71], v[200:203], v[24:27]
v_mfma_f32_16x16x32_bf16 v[40:43], v[64:67], v[196:199], v[40:43]
v_mfma_f32_16x16x32_bf16 v[40:43], v[68:71], v[204:207], v[40:43]
s_waitcnt lgkmcnt(3)
v_mfma_f32_16x16x32_bf16 v[28:31], v[72:75], v[192:195], v[28:31]
s_waitcnt lgkmcnt(1)
v_mfma_f32_16x16x32_bf16 v[28:31], v[76:79], v[200:203], v[28:31]
v_mfma_f32_16x16x32_bf16 v[44:47], v[72:75], v[196:199], v[44:47]
v_mfma_f32_16x16x32_bf16 v[44:47], v[76:79], v[204:207], v[44:47]
s_lshl2_add_u32 s73, s61, s58
s_lshl4_add_u32 s66, s61, s62
s_lshl2_add_u32 s68, s66, s58
s_lshl_b32 s68, s68, 12
s_add_u32 s68, s68, 26214400
s_lshl_b32 s66, s61, 7
s_add_u32 s66, s66, s62
s_lshl_b32 s66, s66, 7
s_add_u32 s66, s66, 274432
s_lshl_b32 s74, s73, 13
s_add_u32 s74, s74, 524288
s_lshl_b32 s67, s62, 9
s_add_u32 s67, s67, s74
v_lshlrev_b32 v6, 4, v0
s_mov_b32 s69, 0x3f803f80
v_mov_b32 v8, 0
v_mov_b32 v9, 0
v_mov_b32 v10, 0
v_mov_b32 v11, 0
v_mov_b32 v12, 0
v_mov_b32 v13, 0
v_mov_b32 v14, 0
v_dot2c_f32_bf16 v11, s69, v232
v_dot2c_f32_bf16 v11, s69, v233
v_dot2c_f32_bf16 v11, s69, v234
v_dot2c_f32_bf16 v11, s69, v235
v_dot2c_f32_bf16 v11, s69, v236
v_dot2c_f32_bf16 v11, s69, v237
v_dot2c_f32_bf16 v11, s69, v238
v_dot2c_f32_bf16 v11, s69, v239
s_cmp_eq_u32 s63, 0
v_cvt_pk_bf16_f32 v240, v16, v17
v_cvt_pk_bf16_f32 v241, v18, v19
v_cvt_pk_bf16_f32 v242, v20, v21
v_cvt_pk_bf16_f32 v243, v22, v23
v_cvt_pk_bf16_f32 v244, v24, v25
v_cvt_pk_bf16_f32 v245, v26, v27
v_cvt_pk_bf16_f32 v246, v28, v29
v_cvt_pk_bf16_f32 v247, v30, v31
v_cvt_pk_bf16_f32 v248, v32, v33
v_cvt_pk_bf16_f32 v249, v34, v35
v_cvt_pk_bf16_f32 v250, v36, v37
v_cvt_pk_bf16_f32 v251, v38, v39
v_cvt_pk_bf16_f32 v252, v40, v41
v_cvt_pk_bf16_f32 v253, v42, v43
v_cvt_pk_bf16_f32 v254, v44, v45
v_cvt_pk_bf16_f32 v255, v46, v47
s_cselect_b64 exec, -1, 0
s_cmp_eq_u32 s57, 0
s_cbranch_scc1 far_149
buffer_store_dwordx4 v[240:243], v6, s[20:23], s68 offen offset:0
buffer_store_dwordx4 v[244:247], v6, s[20:23], s68 offen offset:1024
buffer_store_dwordx4 v[248:251], v6, s[20:23], s68 offen offset:2048
buffer_store_dwordx4 v[252:255], v6, s[20:23], s68 offen offset:3072
near_150:
s_mov_b64 exec, -1
v_dot2c_f32_bf16 v8, s69, v240
v_dot2c_f32_bf16 v9, v240, v240
v_dot2c_f32_bf16 v10, v232, v240
v_dot2c_f32_bf16 v12, s69, v248
v_dot2c_f32_bf16 v13, v248, v248
v_dot2c_f32_bf16 v14, v232, v248
v_dot2c_f32_bf16 v8, s69, v241
v_dot2c_f32_bf16 v9, v241, v241
v_dot2c_f32_bf16 v10, v233, v241
v_dot2c_f32_bf16 v12, s69, v249
v_dot2c_f32_bf16 v13, v249, v249
v_dot2c_f32_bf16 v14, v233, v249
v_dot2c_f32_bf16 v8, s69, v242
v_dot2c_f32_bf16 v9, v242, v242
v_dot2c_f32_bf16 v10, v234, v242
v_dot2c_f32_bf16 v12, s69, v250
v_dot2c_f32_bf16 v13, v250, v250
v_dot2c_f32_bf16 v14, v234, v250
v_dot2c_f32_bf16 v8, s69, v243
v_dot2c_f32_bf16 v9, v243, v243
v_dot2c_f32_bf16 v10, v235, v243
v_dot2c_f32_bf16 v12, s69, v251
v_dot2c_f32_bf16 v13, v251, v251
v_dot2c_f32_bf16 v14, v235, v251
v_dot2c_f32_bf16 v8, s69, v244
v_dot2c_f32_bf16 v9, v244, v244
v_dot2c_f32_bf16 v10, v236, v244
v_dot2c_f32_bf16 v12, s69, v252
v_dot2c_f32_bf16 v13, v252, v252
v_dot2c_f32_bf16 v14, v236, v252
v_dot2c_f32_bf16 v8, s69, v245
v_dot2c_f32_bf16 v9, v245, v245
v_dot2c_f32_bf16 v10, v237, v245
v_dot2c_f32_bf16 v12, s69, v253
v_dot2c_f32_bf16 v13, v253, v253
v_dot2c_f32_bf16 v14, v237, v253
v_dot2c_f32_bf16 v8, s69, v246
v_dot2c_f32_bf16 v9, v246, v246
v_dot2c_f32_bf16 v10, v238, v246
v_dot2c_f32_bf16 v12, s69, v254
v_dot2c_f32_bf16 v13, v254, v254
v_dot2c_f32_bf16 v14, v238, v254
v_dot2c_f32_bf16 v8, s69, v247
v_dot2c_f32_bf16 v9, v247, v247
v_dot2c_f32_bf16 v10, v239, v247
v_dot2c_f32_bf16 v12, s69, v255
v_dot2c_f32_bf16 v13, v255, v255
v_dot2c_f32_bf16 v14, v239, v255
v_mov_b32 v15, v11
v_lshrrev_b32 v7, 5, v0
v_mul_u32_u24 v7, 3584, v7
v_permlane16_swap_b32 v8, v12
v_permlane16_swap_b32 v9, v13
v_permlane16_swap_b32 v10, v14
v_permlane16_swap_b32 v11, v15
v_pk_add_f32 v[8:9], v[8:9], v[12:13]
v_pk_add_f32 v[10:11], v[10:11], v[14:15]
v_mov_b32 v12, v8
v_mov_b32 v13, v9
v_mov_b32 v14, v10
v_mov_b32 v15, v11
v_permlane32_swap_b32 v12, v8
v_permlane32_swap_b32 v13, v9
v_permlane32_swap_b32 v14, v10
v_permlane32_swap_b32 v15, v11
v_pk_add_f32 v[8:9], v[8:9], v[12:13]
v_pk_add_f32 v[10:11], v[10:11], v[14:15]
v_add_u32 v7, v6, v7
v_max_u32 v8, 1, v8
v_max_u32 v9, 1, v9
v_max_u32 v10, 1, v10
v_max_u32 v11, 1, v11
s_mov_b32 exec_hi, 0
s_cmp_eq_u32 s57, 0
s_cbranch_scc1 far_151
buffer_store_dwordx4 v[8:11], v6, s[24:27], s67 offen
near_152:
s_mov_b32 exec_hi, -1
v_lshlrev_b32 v16, 16, v240
v_and_b32 v17, 0xffff0000, v240
v_lshlrev_b32 v18, 16, v241
v_and_b32 v19, 0xffff0000, v241
v_lshlrev_b32 v20, 16, v242
v_and_b32 v21, 0xffff0000, v242
v_lshlrev_b32 v22, 16, v243
v_and_b32 v23, 0xffff0000, v243
v_lshlrev_b32 v24, 16, v244
v_and_b32 v25, 0xffff0000, v244
v_lshlrev_b32 v26, 16, v245
v_and_b32 v27, 0xffff0000, v245
v_lshlrev_b32 v28, 16, v246
v_and_b32 v29, 0xffff0000, v246
v_lshlrev_b32 v30, 16, v247
v_and_b32 v31, 0xffff0000, v247
v_lshlrev_b32 v32, 16, v248
v_and_b32 v33, 0xffff0000, v248
v_lshlrev_b32 v34, 16, v249
v_and_b32 v35, 0xffff0000, v249
v_lshlrev_b32 v36, 16, v250
v_and_b32 v37, 0xffff0000, v250
v_lshlrev_b32 v38, 16, v251
v_and_b32 v39, 0xffff0000, v251
v_lshlrev_b32 v40, 16, v252
v_and_b32 v41, 0xffff0000, v252
v_lshlrev_b32 v42, 16, v253
v_and_b32 v43, 0xffff0000, v253
v_lshlrev_b32 v44, 16, v254
v_and_b32 v45, 0xffff0000, v254
v_lshlrev_b32 v46, 16, v255
v_and_b32 v47, 0xffff0000, v255
v_and_b32 v14, 15, v0
v_lshlrev_b32 v14, 11, v14
v_bfe_u32 v15, v0, 4, 1
v_lshl_add_u32 v14, v15, 5, v14
v_lshrrev_b32 v15, 5, v0
v_lshl_add_u32 v14, v15, 4, v14
s_lshl2_add_u32 s70, s61, s58
s_lshl_b32 s70, s70, 16
s_lshl_b32 s71, s62, 7
s_add_u32 s70, s70, s71
s_add_u32 s71, s70, 0x8000
s_lshl_b32 s67, s62, 6
s_sub_u32 s68, s66, 2048
s_lshl1_add_u32 s69, s67, s68
s_sub_u32 s69, s69, 10240
s_sub_u32 s72, s68, s67
s_add_u32 s72, s72, 4096
s_lshl_b32 s75, s73, 5
s_add_u32 s75, s75, 1
v_and_b32 v15, 48, v0
v_add_u32 v13, s75, v0
v_lshlrev_b32 v4, 1, v15
s_mov_b64 exec, 1
s_waitcnt vmcnt(1)
s_cmp_eq_u32 s57, 0
s_cbranch_scc1 far_153
buffer_store_dword v212, v3, s[24:27], s66 offen
near_154:
s_mov_b64 exec, -1
v_add_u32 v5, s34, 23
s_mov_b64 exec, 1
ds_write_b32 v3, v5
s_mov_b64 exec, -1
s_waitcnt vmcnt(1)
poll_155:
buffer_load_dwordx4 v[80:83], v7, s[24:27], s74 offen offset:0 sc1
buffer_load_dwordx4 v[84:87], v7, s[24:27], s74 offen offset:512 sc1
buffer_load_dwordx4 v[88:91], v7, s[24:27], s74 offen offset:1024 sc1
buffer_load_dwordx4 v[92:95], v7, s[24:27], s74 offen offset:1536 sc1
buffer_load_dwordx4 v[96:99], v7, s[24:27], s74 offen offset:2048 sc1
buffer_load_dwordx4 v[100:103], v7, s[24:27], s74 offen offset:2560 sc1
buffer_load_dwordx4 v[104:107], v7, s[24:27], s74 offen offset:3072 sc1
buffer_load_dwordx4 v[108:111], v7, s[24:27], s74 offen offset:3584 sc1
pchk_156:
s_waitcnt vmcnt(7)
v_min3_u32 v8, v80, v81, v82
s_waitcnt vmcnt(6)
v_min3_u32 v8, v8, v83, v84
v_min3_u32 v8, v8, v85, v86
s_waitcnt vmcnt(5)
v_min3_u32 v8, v8, v87, v88
v_min3_u32 v8, v8, v89, v90
s_waitcnt vmcnt(4)
v_min3_u32 v8, v8, v91, v92
v_min3_u32 v8, v8, v93, v94
s_waitcnt vmcnt(3)
v_min3_u32 v8, v8, v95, v96
v_min3_u32 v8, v8, v97, v98
s_waitcnt vmcnt(2)
v_min3_u32 v8, v8, v99, v100
v_min3_u32 v8, v8, v101, v102
s_waitcnt vmcnt(1)
v_min3_u32 v8, v8, v103, v104
v_min3_u32 v8, v8, v105, v106
s_waitcnt vmcnt(0)
v_min3_u32 v8, v8, v107, v108
v_min3_u32 v8, v8, v109, v110
v_min_u32 v8, v8, v111
v_cmp_eq_u32 vcc, 0, v8
s_cbranch_vccz pdone_157
s_sub_u32 s32, s32, 1
s_cmp_gt_i32 s32, 0
s_cbranch_scc1 poll_155
pdone_157:
v_pk_add_f32 v[80:81], v[80:81], v[96:97]
v_pk_add_f32 v[82:83], v[82:83], v[98:99]
v_pk_add_f32 v[84:85], v[84:85], v[100:101]
v_pk_add_f32 v[86:87], v[86:87], v[102:103]
v_pk_add_f32 v[88:89], v[88:89], v[104:105]
v_pk_add_f32 v[90:91], v[90:91], v[106:107]
v_pk_add_f32 v[92:93], v[92:93], v[108:109]
v_pk_add_f32 v[94:95], v[94:95], v[110:111]
v_pk_add_f32 v[80:81], v[80:81], v[88:89]
v_pk_add_f32 v[82:83], v[82:83], v[90:91]
v_pk_add_f32 v[84:85], v[84:85], v[92:93]
v_pk_add_f32 v[86:87], v[86:87], v[94:95]
v_pk_add_f32 v[80:81], v[80:81], v[84:85]
v_pk_add_f32 v[82:83], v[82:83], v[86:87]
v_mov_b32 v8, v80
v_mov_b32 v9, v81
v_mov_b32 v10, v82
v_mov_b32 v11, v83
v_permlane32_swap_b32 v8, v80
v_permlane32_swap_b32 v9, v81
v_permlane32_swap_b32 v10, v82
v_permlane32_swap_b32 v11, v83
v_pk_add_f32 v[8:9], v[8:9], v[80:81]
v_pk_add_f32 v[10:11], v[10:11], v[82:83]
v_mul_f32 v8, 0xba800000, v8
v_mul_f32 v9, 0x3a800000, v9
v_fma_f32 v9, -v8, v8, v9
v_max_f32 v9, 0, v9
v_add_f32 v12, 0x3727c5ac, v9
v_rsq_f32 v80, v12
v_fma_f32 v10, v8, v11, v10
v_mul_f32 v12, v80, v10
v_max_u32 v12, 1, v12
v_add_u32 v7, s34, v3
v_mov_b32 v6, v12
s_nop 1
v_max_f32_dpp v6, v6, v6 row_ror:1 row_mask:0xf bank_mask:0xf
s_nop 1
v_max_f32_dpp v6, v6, v6 row_ror:2 row_mask:0xf bank_mask:0xf
s_nop 1
v_max_f32_dpp v6, v6, v6 row_ror:4 row_mask:0xf bank_mask:0xf
s_nop 1
v_max_f32_dpp v6, v6, v6 row_ror:8 row_mask:0xf bank_mask:0xf
v_mov_b32 v11, v6
s_nop 1
v_permlane16_swap_b32 v11, v6
v_max_f32 v6, v6, v11
v_cmp_eq_f32 vcc, v6, v12
s_ff1_i32_b64 s66, vcc
s_and_b32 s66, s66, 31
s_mov_b64 exec, 1
ds_write_b32 v7, v6 offset:256
s_mov_b64 exec, -1
v_add_u32 v7, s34, v1
v_mul_f32 v81, v8, v80
v_add_f32 v10, 1.0, v80
v_mov_b32 v82, v80
v_mov_b32 v83, v81
s_and_b32 s67, s66, 15
s_lshl_b32 s67, 0x10001, s67
s_bitcmp0_b32 s66, 4
v_permlane16_swap_b32 v80, v82
v_permlane16_swap_b32 v81, v83
s_cselect_b32 s76, s67, 0
s_cselect_b32 s78, 0, s67
s_cselect_b32 s77, s67, 0
s_cselect_b32 s79, 0, s67
s_add_u32 s75, s75, s66
v_pk_fma_f32 v[48:49], v[16:17], v[80:81], v[80:81] op_sel:[0,0,1] op_sel_hi:[1,0,1]
v_pk_fma_f32 v[50:51], v[18:19], v[80:81], v[80:81] op_sel:[0,0,1] op_sel_hi:[1,0,1]
v_pk_fma_f32 v[52:53], v[20:21], v[80:81], v[80:81] op_sel:[0,0,1] op_sel_hi:[1,0,1]
v_pk_fma_f32 v[54:55], v[22:23], v[80:81], v[80:81] op_sel:[0,0,1] op_sel_hi:[1,0,1]
v_pk_fma_f32 v[56:57], v[24:25], v[80:81], v[80:81] op_sel:[0,0,1] op_sel_hi:[1,0,1]
v_pk_fma_f32 v[58:59], v[26:27], v[80:81], v[80:81] op_sel:[0,0,1] op_sel_hi:[1,0,1]
v_pk_fma_f32 v[60:61], v[28:29], v[80:81], v[80:81] op_sel:[0,0,1] op_sel_hi:[1,0,1]
v_pk_fma_f32 v[62:63], v[30:31], v[80:81], v[80:81] op_sel:[0,0,1] op_sel_hi:[1,0,1]
v_pk_fma_f32 v[64:65], v[32:33], v[82:83], v[82:83] op_sel:[0,0,1] op_sel_hi:[1,0,1]
v_pk_fma_f32 v[66:67], v[34:35], v[82:83], v[82:83] op_sel:[0,0,1] op_sel_hi:[1,0,1]
v_pk_fma_f32 v[68:69], v[36:37], v[82:83], v[82:83] op_sel:[0,0,1] op_sel_hi:[1,0,1]
v_pk_fma_f32 v[70:71], v[38:39], v[82:83], v[82:83] op_sel:[0,0,1] op_sel_hi:[1,0,1]
v_pk_fma_f32 v[72:73], v[40:41], v[82:83], v[82:83] op_sel:[0,0,1] op_sel_hi:[1,0,1]
v_pk_fma_f32 v[74:75], v[42:43], v[82:83], v[82:83] op_sel:[0,0,1] op_sel_hi:[1,0,1]
v_pk_fma_f32 v[76:77], v[44:45], v[82:83], v[82:83] op_sel:[0,0,1] op_sel_hi:[1,0,1]
v_pk_fma_f32 v[78:79], v[46:47], v[82:83], v[82:83] op_sel:[0,0,1] op_sel_hi:[1,0,1]
v_cvt_pk_bf16_f32 v84, v48, v49
v_cvt_pk_bf16_f32 v85, v50, v51
v_cvt_pk_bf16_f32 v86, v52, v53
v_cvt_pk_bf16_f32 v87, v54, v55
v_cvt_pk_bf16_f32 v88, v56, v57
v_cvt_pk_bf16_f32 v89, v58, v59
v_cvt_pk_bf16_f32 v90, v60, v61
v_cvt_pk_bf16_f32 v91, v62, v63
v_cvt_pk_bf16_f32 v92, v64, v65
v_cvt_pk_bf16_f32 v93, v66, v67
v_cvt_pk_bf16_f32 v94, v68, v69
v_cvt_pk_bf16_f32 v95, v70, v71
v_cvt_pk_bf16_f32 v96, v72, v73
v_cvt_pk_bf16_f32 v97, v74, v75
v_cvt_pk_bf16_f32 v98, v76, v77
v_cvt_pk_bf16_f32 v99, v78, v79
ds_read_b32 v11, v7 offset:256
v_max_u32 v84, 1, v84
v_max_u32 v85, 1, v85
v_max_u32 v86, 1, v86
v_max_u32 v87, 1, v87
v_max_u32 v88, 1, v88
v_max_u32 v89, 1, v89
v_max_u32 v90, 1, v90
v_max_u32 v91, 1, v91
v_max_u32 v92, 1, v92
v_max_u32 v93, 1, v93
v_max_u32 v94, 1, v94
v_max_u32 v95, 1, v95
v_max_u32 v96, 1, v96
v_max_u32 v97, 1, v97
v_max_u32 v98, 1, v98
v_max_u32 v99, 1, v99
s_branch pchk_159
poll_158:
ds_read_b32 v11, v7 offset:256
pchk_159:
s_waitcnt lgkmcnt(0)
v_cmp_eq_u32 vcc, 0, v11
s_cbranch_vccz pdone_160
s_sub_u32 s32, s32, 1
s_cmp_gt_i32 s32, 0
s_cbranch_scc1 poll_158
pdone_160:
v_cmp_eq_f32 vcc, v11, v6
s_bfm_b32 s67, s58, 0
s_and_b32 s67, s67, vcc_lo
v_cmp_gt_f32 vcc, v11, v6
s_lshl_b32 s66, 1, s66
s_or_b32 s67, s67, vcc_lo
s_cselect_b64 s[76:77], 0, s[76:77]
s_cselect_b64 s[78:79], 0, s[78:79]
s_cselect_b64 exec, 0, s[66:67]
s_bitcmp0_b32 s62, 0
s_cselect_b64 exec, exec, 0
buffer_store_dwordx2 v[12:13], off, s[24:27], s72 sc1
s_mov_b64 exec, s[76:77]
buffer_store_dwordx4 v[84:87], v4, s[24:27], s68 offen offset:0 sc1
buffer_store_dwordx4 v[88:91], v4, s[24:27], s68 offen offset:16 sc1
s_mov_b64 exec, s[78:79]
buffer_store_dwordx4 v[92:95], v4, s[24:27], s68 offen offset:0 sc1
buffer_store_dwordx4 v[96:99], v4, s[24:27], s68 offen offset:16 sc1
s_mov_b64 exec, -1
v_add_u32 v5, s34, 24
s_mov_b64 exec, 1
ds_write_b32 v3, v5
s_mov_b64 exec, -1
v_pk_add_f32 v[16:17], v[16:17], v[48:49]
v_pk_add_f32 v[18:19], v[18:19], v[50:51]
v_pk_add_f32 v[20:21], v[20:21], v[52:53]
v_pk_add_f32 v[22:23], v[22:23], v[54:55]
v_pk_add_f32 v[24:25], v[24:25], v[56:57]
v_pk_add_f32 v[26:27], v[26:27], v[58:59]
v_pk_add_f32 v[28:29], v[28:29], v[60:61]
v_pk_add_f32 v[30:31], v[30:31], v[62:63]
v_pk_add_f32 v[32:33], v[32:33], v[64:65]
v_pk_add_f32 v[34:35], v[34:35], v[66:67]
v_pk_add_f32 v[36:37], v[36:37], v[68:69]
v_pk_add_f32 v[38:39], v[38:39], v[70:71]
v_pk_add_f32 v[40:41], v[40:41], v[72:73]
v_pk_add_f32 v[42:43], v[42:43], v[74:75]
v_pk_add_f32 v[44:45], v[44:45], v[76:77]
v_pk_add_f32 v[46:47], v[46:47], v[78:79]
v_cvt_pk_bf16_f32 v240, v16, v17
v_cvt_pk_bf16_f32 v241, v18, v19
v_cvt_pk_bf16_f32 v242, v20, v21
v_cvt_pk_bf16_f32 v243, v22, v23
v_cvt_pk_bf16_f32 v244, v24, v25
v_cvt_pk_bf16_f32 v245, v26, v27
v_cvt_pk_bf16_f32 v246, v28, v29
v_cvt_pk_bf16_f32 v247, v30, v31
v_cvt_pk_bf16_f32 v248, v32, v33
v_cvt_pk_bf16_f32 v249, v34, v35
v_cvt_pk_bf16_f32 v250, v36, v37
v_cvt_pk_bf16_f32 v251, v38, v39
v_cvt_pk_bf16_f32 v252, v40, v41
v_cvt_pk_bf16_f32 v253, v42, v43
v_cvt_pk_bf16_f32 v254, v44, v45
v_cvt_pk_bf16_f32 v255, v46, v47
v_max_u32 v16, 1, v16
v_max_u32 v17, 1, v17
v_max_u32 v18, 1, v18
v_max_u32 v19, 1, v19
v_max_u32 v20, 1, v20
v_max_u32 v21, 1, v21
v_max_u32 v22, 1, v22
v_max_u32 v23, 1, v23
v_max_u32 v24, 1, v24
v_max_u32 v25, 1, v25
v_max_u32 v26, 1, v26
v_max_u32 v27, 1, v27
v_max_u32 v28, 1, v28
v_max_u32 v29, 1, v29
v_max_u32 v30, 1, v30
v_max_u32 v31, 1, v31
v_max_u32 v32, 1, v32
v_max_u32 v33, 1, v33
v_max_u32 v34, 1, v34
v_max_u32 v35, 1, v35
v_max_u32 v36, 1, v36
v_max_u32 v37, 1, v37
v_max_u32 v38, 1, v38
v_max_u32 v39, 1, v39
v_max_u32 v40, 1, v40
v_max_u32 v41, 1, v41
v_max_u32 v42, 1, v42
v_max_u32 v43, 1, v43
v_max_u32 v44, 1, v44
v_max_u32 v45, 1, v45
v_max_u32 v46, 1, v46
v_max_u32 v47, 1, v47
s_mov_b64 exec, s[76:77]
buffer_store_dwordx4 v[16:19], v15, s[24:27], s69 offen offset:0 sc1
buffer_store_dwordx4 v[20:23], v15, s[24:27], s69 offen offset:64 sc1
buffer_store_dwordx4 v[24:27], v15, s[24:27], s69 offen offset:128 sc1
buffer_store_dwordx4 v[28:31], v15, s[24:27], s69 offen offset:192 sc1
s_mov_b64 exec, s[78:79]
buffer_store_dwordx4 v[32:35], v15, s[24:27], s69 offen offset:0 sc1
buffer_store_dwordx4 v[36:39], v15, s[24:27], s69 offen offset:64 sc1
buffer_store_dwordx4 v[40:43], v15, s[24:27], s69 offen offset:128 sc1
buffer_store_dwordx4 v[44:47], v15, s[24:27], s69 offen offset:192 sc1
s_mov_b64 exec, -1
s_cmp_eq_u32 s63, 0
s_cbranch_scc0 mout_161
v_mul_f32 v11, v10, v10
v_mov_b32 v12, 0x3727c5ac
v_fma_f32 v11, v11, v9, v12
v_rsq_f32 v11, v11
v_lshrrev_b32 v12, 3, v0
v_lshlrev_b32 v12, 6, v12
v_lshl_add_u32 v12, v0, 3, v12
v_mul_f32 v10, v10, v11
v_mul_f32 v11, v8, v10
s_lshl_b32 s66, s61, 5
s_add_u32 s66, s66, s58
s_lshl_b32 s66, s66, 9
s_add_u32 s66, s66, 1675264
v_max_u32 v11, 1, v11
s_cmp_eq_u32 s62, 8
s_cselect_b32 exec_lo, -1, 0
s_mov_b32 exec_hi, 0
s_cmp_eq_u32 s57, 0
s_cbranch_scc1 far_162
buffer_store_dwordx2 v[10:11], v12, s[24:27], s66 offen
near_163:
s_mov_b64 exec, -1
s_mov_b32 s63, 1
s_mov_b32 s34, 32
s_add_u32 s24, s24, 1409024
s_addc_u32 s25, s25, 0
s_mov_b32 s26, 1409024
s_branch L_mtop
mout_161:
v_permlane16_swap_b32 v240, v242
v_permlane16_swap_b32 v241, v243
v_permlane16_swap_b32 v244, v246
v_permlane16_swap_b32 v245, v247
v_permlane16_swap_b32 v248, v250
v_permlane16_swap_b32 v249, v251
v_permlane16_swap_b32 v252, v254
v_permlane16_swap_b32 v253, v255
s_not_b64 exec, s[76:77]
buffer_store_dwordx4 v[240:243], v14, s[28:31], s70 offen offset:0
buffer_store_dwordx4 v[244:247], v14, s[28:31], s70 offen offset:64
s_not_b64 exec, s[78:79]
buffer_store_dwordx4 v[248:251], v14, s[28:31], s71 offen offset:0
buffer_store_dwordx4 v[252:255], v14, s[28:31], s71 offen offset:64
s_mov_b64 exec, -1
s_or_b32 s66, s76, s78
s_cbranch_scc0 L_end
v_mov_b32 v11, 0
s_add_u32 s35, s34, 4
lw_164:
ds_read_b32 v5, v2 offset:24
s_waitcnt lgkmcnt(0)
v_cmp_gt_i32 vcc, s35, v5
s_cbranch_vccz lwd_165
s_sleep 2
s_sub_u32 s32, s32, 1
s_cmp_gt_i32 s32, 0
s_cbranch_scc1 lw_164
lwd_165:
ds_read_b32 v11, v11 offset:32
s_waitcnt lgkmcnt(0)
v_cmp_eq_u32 vcc, s75, v11
s_cbranch_vccnz L_end
s_mov_b64 exec, s[76:77]
buffer_store_dwordx4 v[240:243], v14, s[28:31], s70 offen offset:0
buffer_store_dwordx4 v[244:247], v14, s[28:31], s70 offen offset:64
s_mov_b64 exec, s[78:79]
buffer_store_dwordx4 v[248:251], v14, s[28:31], s71 offen offset:0
buffer_store_dwordx4 v[252:255], v14, s[28:31], s71 offen offset:64
s_mov_b64 exec, -1
s_branch L_end
mspin_116:
s_cmp_eq_u32 s66, 1
s_cbranch_scc1 mback_117
msp_166:
ds_read_b32 v5, v2 offset:16
s_waitcnt lgkmcnt(0)
v_cmp_ge_u32 vcc, v4, v5
s_cbranch_vccz mback_117
s_sub_u32 s32, s32, 1
s_cmp_gt_i32 s32, 0
s_cbranch_scc1 msp_166
s_branch mback_117
patch_120:
s_bfe_u32 s66, s33, 0x20005
s_lshr_b32 s67, s66, 1
s_xor_b32 s66, s66, s67
s_and_b32 s66, s66, 1
s_cmp_eq_u32 s66, s65
s_cbranch_scc0 pback_121
s_lshl_b32 s67, s67, 5
s_and_b32 s66, s33, 31
s_add_u32 s66, s66, s67
v_and_b32 v10, 15, v0
v_sub_u32 v10, s66, v10
v_lshrrev_b32 v11, 4, v0
v_lshlrev_b32 v11, 2, v11
v_sub_u32 v11, s66, v11
v_cmp_eq_u32 vcc, 0, v10
s_mov_b64 exec, vcc
ds_read_b128 v[16:19], v9 offset:3456
ds_read_b128 v[20:23], v9 offset:3520
ds_read_b128 v[80:83], v9 offset:3328
ds_read_b128 v[84:87], v9 offset:3392
s_mov_b64 exec, -1
v_cmp_eq_u32 vcc, 0, v11
s_mov_b64 exec, vcc
ds_read_b32 v48, v8 offset:3584
ds_read_b32 v52, v8 offset:3648
s_mov_b64 exec, -1
v_cmp_eq_u32 vcc, 1, v11
s_mov_b64 exec, vcc
ds_read_b32 v49, v8 offset:3584
ds_read_b32 v53, v8 offset:3648
s_mov_b64 exec, -1
v_cmp_eq_u32 vcc, 2, v11
s_mov_b64 exec, vcc
ds_read_b32 v50, v8 offset:3584
ds_read_b32 v54, v8 offset:3648
s_mov_b64 exec, -1
v_cmp_eq_u32 vcc, 3, v11
s_mov_b64 exec, vcc
ds_read_b32 v51, v8 offset:3584
ds_read_b32 v55, v8 offset:3648
s_mov_b64 exec, -1
s_waitcnt lgkmcnt(0)
v_cmp_eq_u32 vcc, 16, v10
s_mov_b64 exec, vcc
ds_read_b128 v[24:27], v9 offset:3456
ds_read_b128 v[28:31], v9 offset:3520
ds_read_b128 v[88:91], v9 offset:3328
ds_read_b128 v[92:95], v9 offset:3392
s_mov_b64 exec, -1
v_cmp_eq_u32 vcc, 16, v11
s_mov_b64 exec, vcc
ds_read_b32 v56, v8 offset:3584
ds_read_b32 v60, v8 offset:3648
s_mov_b64 exec, -1
v_cmp_eq_u32 vcc, 17, v11
s_mov_b64 exec, vcc
ds_read_b32 v57, v8 offset:3584
ds_read_b32 v61, v8 offset:3648
s_mov_b64 exec, -1
v_cmp_eq_u32 vcc, 18, v11
s_mov_b64 exec, vcc
ds_read_b32 v58, v8 offset:3584
ds_read_b32 v62, v8 offset:3648
s_mov_b64 exec, -1
v_cmp_eq_u32 vcc, 19, v11
s_mov_b64 exec, vcc
ds_read_b32 v59, v8 offset:3584
ds_read_b32 v63, v8 offset:3648
s_mov_b64 exec, -1
s_waitcnt lgkmcnt(0)
v_cmp_eq_u32 vcc, 32, v10
s_mov_b64 exec, vcc
ds_read_b128 v[32:35], v9 offset:3456
ds_read_b128 v[36:39], v9 offset:3520
ds_read_b128 v[96:99], v9 offset:3328
ds_read_b128 v[100:103], v9 offset:3392
s_mov_b64 exec, -1
v_cmp_eq_u32 vcc, 32, v11
s_mov_b64 exec, vcc
ds_read_b32 v64, v8 offset:3584
ds_read_b32 v68, v8 offset:3648
s_mov_b64 exec, -1
v_cmp_eq_u32 vcc, 33, v11
s_mov_b64 exec, vcc
ds_read_b32 v65, v8 offset:3584
ds_read_b32 v69, v8 offset:3648
s_mov_b64 exec, -1
v_cmp_eq_u32 vcc, 34, v11
s_mov_b64 exec, vcc
ds_read_b32 v66, v8 offset:3584
ds_read_b32 v70, v8 offset:3648
s_mov_b64 exec, -1
v_cmp_eq_u32 vcc, 35, v11
s_mov_b64 exec, vcc
ds_read_b32 v67, v8 offset:3584
ds_read_b32 v71, v8 offset:3648
s_mov_b64 exec, -1
s_waitcnt lgkmcnt(0)
v_cmp_eq_u32 vcc, 48, v10
s_mov_b64 exec, vcc
ds_read_b128 v[40:43], v9 offset:3456
ds_read_b128 v[44:47], v9 offset:3520
ds_read_b128 v[104:107], v9 offset:3328
ds_read_b128 v[108:111], v9 offset:3392
s_mov_b64 exec, -1
v_cmp_eq_u32 vcc, 48, v11
s_mov_b64 exec, vcc
ds_read_b32 v72, v8 offset:3584
ds_read_b32 v76, v8 offset:3648
s_mov_b64 exec, -1
v_cmp_eq_u32 vcc, 49, v11
s_mov_b64 exec, vcc
ds_read_b32 v73, v8 offset:3584
ds_read_b32 v77, v8 offset:3648
s_mov_b64 exec, -1
v_cmp_eq_u32 vcc, 50, v11
s_mov_b64 exec, vcc
ds_read_b32 v74, v8 offset:3584
ds_read_b32 v78, v8 offset:3648
s_mov_b64 exec, -1
v_cmp_eq_u32 vcc, 51, v11
s_mov_b64 exec, vcc
ds_read_b32 v75, v8 offset:3584
ds_read_b32 v79, v8 offset:3648
s_mov_b64 exec, -1
s_waitcnt lgkmcnt(0)
s_branch pback_121
cross_131:
s_cmp_eq_u32 s67, 122880
s_cbranch_scc0 cr2_167
v_add_u32 v5, s34, 18
s_mov_b64 exec, 1
ds_write_b32 v3, v5
s_mov_b64 exec, -1
s_add_u32 s70, s72, 270336
s_mov_b64 exec, 1
s_waitcnt vmcnt(0)
buffer_store_dword v5, v3, s[24:27], s70 offen sc1
s_mov_b64 exec, -1
v_mov_b32 v9, 0xf149f2ca
v_xor_b32 v216, v9, v216
v_xor_b32 v217, v9, v217
v_xor_b32 v218, v9, v218
v_xor_b32 v219, v9, v219
v_xor_b32 v220, v9, v220
v_xor_b32 v221, v9, v221
v_xor_b32 v222, v9, v222
v_xor_b32 v223, v9, v223
v_xor_b32 v224, v9, v224
v_xor_b32 v225, v9, v225
v_xor_b32 v226, v9, v226
v_xor_b32 v227, v9, v227
v_xor_b32 v228, v9, v228
v_xor_b32 v229, v9, v229
v_xor_b32 v230, v9, v230
v_xor_b32 v231, v9, v231
s_mov_b32 s67, 90112
s_cmp_eq_u32 s63, 0
s_cbranch_scc0 cr3_168
v_and_b32 v9, 15, v0
v_lshlrev_b32 v9, 11, v9
v_bfe_u32 v10, v0, 4, 1
v_lshl_add_u32 v9, v10, 5, v9
v_lshrrev_b32 v10, 5, v0
v_lshl_add_u32 v9, v10, 4, v9
s_lshl2_add_u32 s70, s61, s58
s_lshl_b32 s70, s70, 16
s_lshl_b32 s71, s62, 7
s_add_u32 s70, s70, s71
s_add_u32 s71, s70, 0x8000
buffer_load_dwordx4 v[240:243], v9, s[8:11], s70 offen offset:0
buffer_load_dwordx4 v[244:247], v9, s[8:11], s70 offen offset:64
buffer_load_dwordx4 v[248:251], v9, s[8:11], s71 offen offset:0
buffer_load_dwordx4 v[252:255], v9, s[8:11], s71 offen offset:64
cr3_168:
s_cmp_eq_u32 s59, 0
s_cbranch_scc1 cback_132
v_mov_b32 v9, 0
s_add_u32 s35, s34, 17
lw_169:
ds_read_b32 v5, v9 offset:16
s_waitcnt lgkmcnt(0)
v_cmp_gt_i32 vcc, s35, v5
s_cbranch_vccz lwd_170
s_sub_u32 s32, s32, 1
s_cmp_gt_i32 s32, 0
s_cbranch_scc1 lw_169
lwd_170:
s_branch cback_132
cr2_167:
v_add_u32 v5, s34, 19
s_mov_b64 exec, 1
ds_write_b32 v3, v5
s_mov_b64 exec, -1
s_mov_b32 s66, 28672
s_cmp_lt_u32 s59, 2
s_cbranch_scc1 cback_132
s_add_u32 s35, s34, 17
lw_171:
ds_read_b32 v5, v2 offset:16
s_waitcnt lgkmcnt(0)
v_cmp_gt_i32 vcc, s35, v5
s_cbranch_vccz lwd_172
s_sub_u32 s32, s32, 1
s_cmp_gt_i32 s32, 0
s_cbranch_scc1 lw_171
lwd_172:
s_branch cback_132
cross_133:
s_cmp_eq_u32 s67, 122880
s_cbranch_scc0 cr2_173
v_add_u32 v5, s34, 18
s_mov_b64 exec, 1
ds_write_b32 v3, v5
s_mov_b64 exec, -1
s_add_u32 s70, s72, 270336
s_mov_b64 exec, 1
s_waitcnt vmcnt(0)
buffer_store_dword v5, v3, s[24:27], s70 offen sc1
s_mov_b64 exec, -1
v_mov_b32 v9, 0xf149f2ca
v_xor_b32 v216, v9, v216
v_xor_b32 v217, v9, v217
v_xor_b32 v218, v9, v218
v_xor_b32 v219, v9, v219
v_xor_b32 v220, v9, v220
v_xor_b32 v221, v9, v221
v_xor_b32 v222, v9, v222
v_xor_b32 v223, v9, v223
v_xor_b32 v224, v9, v224
v_xor_b32 v225, v9, v225
v_xor_b32 v226, v9, v226
v_xor_b32 v227, v9, v227
v_xor_b32 v228, v9, v228
v_xor_b32 v229, v9, v229
v_xor_b32 v230, v9, v230
v_xor_b32 v231, v9, v231
s_mov_b32 s67, 90112
s_cmp_eq_u32 s63, 0
s_cbranch_scc0 cr3_174
v_and_b32 v9, 15, v0
v_lshlrev_b32 v9, 11, v9
v_bfe_u32 v10, v0, 4, 1
v_lshl_add_u32 v9, v10, 5, v9
v_lshrrev_b32 v10, 5, v0
v_lshl_add_u32 v9, v10, 4, v9
s_lshl2_add_u32 s70, s61, s58
s_lshl_b32 s70, s70, 16
s_lshl_b32 s71, s62, 7
s_add_u32 s70, s70, s71
s_add_u32 s71, s70, 0x8000
buffer_load_dwordx4 v[240:243], v9, s[8:11], s70 offen offset:0
buffer_load_dwordx4 v[244:247], v9, s[8:11], s70 offen offset:64
buffer_load_dwordx4 v[248:251], v9, s[8:11], s71 offen offset:0
buffer_load_dwordx4 v[252:255], v9, s[8:11], s71 offen offset:64
cr3_174:
s_cmp_eq_u32 s59, 0
s_cbranch_scc1 cback_134
v_mov_b32 v9, 0
s_add_u32 s35, s34, 17
lw_175:
ds_read_b32 v5, v9 offset:16
s_waitcnt lgkmcnt(0)
v_cmp_gt_i32 vcc, s35, v5
s_cbranch_vccz lwd_176
s_sub_u32 s32, s32, 1
s_cmp_gt_i32 s32, 0
s_cbranch_scc1 lw_175
lwd_176:
s_branch cback_134
cr2_173:
v_add_u32 v5, s34, 19
s_mov_b64 exec, 1
ds_write_b32 v3, v5
s_mov_b64 exec, -1
s_mov_b32 s66, 28672
s_cmp_lt_u32 s59, 2
s_cbranch_scc1 cback_134
s_add_u32 s35, s34, 17
lw_177:
ds_read_b32 v5, v2 offset:16
s_waitcnt lgkmcnt(0)
v_cmp_gt_i32 vcc, s35, v5
s_cbranch_vccz lwd_178
s_sub_u32 s32, s32, 1
s_cmp_gt_i32 s32, 0
s_cbranch_scc1 lw_177
lwd_178:
s_branch cback_134
slow_135:
s_add_u32 s70, s72, 270336
poll_179:
buffer_load_dword v10, v1, s[24:27], s70 offen sc1
pchk_180:
s_waitcnt vmcnt(0)
v_cmp_eq_u32 vcc, 0, v10
s_cbranch_vccz pdone_181
s_sub_u32 s32, s32, 1
s_cmp_gt_i32 s32, 0
s_cbranch_scc1 poll_179
pdone_181:
s_lshl_b32 s73, s60, 15
s_lshl_b32 s74, s63, 23
s_add_u32 s73, s73, s74
s_add_u32 s73, s73, 1048576
v_mov_b32 v10, 0xf149f2ca
v_mov_b32 v11, 0
v_mov_b32 v192, 0
v_mov_b32 v193, 0
v_mov_b32 v194, 0
v_mov_b32 v195, 0
v_mov_b32 v196, 0
v_mov_b32 v197, 0
v_mov_b32 v198, 0
v_mov_b32 v199, 0
v_mov_b32 v200, 0
v_mov_b32 v201, 0
v_mov_b32 v202, 0
v_mov_b32 v203, 0
v_mov_b32 v204, 0
v_mov_b32 v205, 0
v_mov_b32 v206, 0
v_mov_b32 v207, 0
v_mov_b32 v208, 0
v_mov_b32 v209, 0
v_mov_b32 v210, 0
v_mov_b32 v211, 0
s_lshl2_add_u32 s74, s59, s65
s_mov_b32 s75, 0
sl_182:
s_lshr_b32 s76, s74, 2
s_lshl_b32 s76, s76, 19
s_and_b32 s77, s74, 3
s_lshl_b32 s77, s77, 13
s_add_u32 s76, s76, s77
s_add_u32 s76, s76, s73
buffer_load_dwordx4 v[152:155], v6, s[20:23], s76 offen offset:0 sc1
buffer_load_dwordx4 v[156:159], v6, s[20:23], s76 offen offset:1024 sc1
s_cmp_eq_u32 s75, 0
s_cselect_b32 s76, 0xf149f2ca, 0
s_and_b32 s77, s75, 7
s_cselect_b32 s77, 0, -1
v_xor_b32 v112, s76, v216
v_and_b32 v112, s77, v112
v_xor_b32 v113, s76, v217
v_and_b32 v113, s77, v113
v_xor_b32 v114, s76, v218
v_and_b32 v114, s77, v114
v_xor_b32 v115, s76, v219
v_and_b32 v115, s77, v115
v_xor_b32 v116, s76, v220
v_and_b32 v116, s77, v116
v_xor_b32 v117, s76, v221
v_and_b32 v117, s77, v117
v_xor_b32 v118, s76, v222
v_and_b32 v118, s77, v118
v_xor_b32 v119, s76, v223
v_and_b32 v119, s77, v119
v_xor_b32 v120, s76, v224
v_and_b32 v120, s77, v120
v_xor_b32 v121, s76, v225
v_and_b32 v121, s77, v121
v_xor_b32 v122, s76, v226
v_and_b32 v122, s77, v122
v_xor_b32 v123, s76, v227
v_and_b32 v123, s77, v123
v_xor_b32 v124, s76, v228
v_and_b32 v124, s77, v124
v_xor_b32 v125, s76, v229
v_and_b32 v125, s77, v125
v_xor_b32 v126, s76, v230
v_and_b32 v126, s77, v126
v_xor_b32 v127, s76, v231
v_and_b32 v127, s77, v127
s_waitcnt vmcnt(1)
s_nop 0
v_mfma_f32_32x32x16_bf16 v[112:127], v[152:155], v[80:83], v[112:127]
s_waitcnt vmcnt(0)
v_mfma_f32_32x32x16_bf16 v[112:127], v[156:159], v[88:91], v[112:127]
s_nop 11
v_max3_f32 v10, v10, v112, v113
v_max3_f32 v10, v10, v114, v115
v_max3_f32 v10, v10, v116, v117
v_max3_f32 v10, v10, v118, v119
v_max3_f32 v10, v10, v120, v121
v_max3_f32 v10, v10, v122, v123
v_max3_f32 v10, v10, v124, v125
v_max3_f32 v10, v10, v126, v127
s_add_u32 s75, s75, 1
s_sub_u32 s74, s74, 1
s_cselect_b32 s75, 9, s75
s_cmp_lt_u32 s75, 9
s_cbranch_scc1 sl_182
v_mov_b32 v11, v10
s_nop 1
v_permlane32_swap_b32 v11, v10
v_max_f32 v10, v10, v11
s_lshl2_add_u32 s74, s59, s65
s_mov_b32 s75, 0
sl_183:
s_lshr_b32 s76, s74, 2
s_lshl_b32 s76, s76, 19
s_and_b32 s77, s74, 3
s_lshl_b32 s77, s77, 13
s_add_u32 s76, s76, s77
s_add_u32 s76, s76, s73
buffer_load_dwordx4 v[152:155], v6, s[20:23], s76 offen offset:0 sc1
buffer_load_dwordx4 v[156:159], v6, s[20:23], s76 offen offset:1024 sc1
buffer_load_dwordx4 v[160:163], v6, s[20:23], s76 offen offset:2048 sc1
buffer_load_dwordx4 v[164:167], v6, s[20:23], s76 offen offset:3072 sc1
s_cmp_eq_u32 s75, 0
s_cselect_b32 s76, 0xf149f2ca, 0
s_and_b32 s77, s75, 7
s_cselect_b32 s77, 0, -1
v_xor_b32 v112, s76, v216
v_and_b32 v112, s77, v112
v_sub_f32 v112, v112, v10
v_xor_b32 v113, s76, v217
v_and_b32 v113, s77, v113
v_sub_f32 v113, v113, v10
v_xor_b32 v114, s76, v218
v_and_b32 v114, s77, v114
v_sub_f32 v114, v114, v10
v_xor_b32 v115, s76, v219
v_and_b32 v115, s77, v115
v_sub_f32 v115, v115, v10
v_xor_b32 v116, s76, v220
v_and_b32 v116, s77, v116
v_sub_f32 v116, v116, v10
v_xor_b32 v117, s76, v221
v_and_b32 v117, s77, v117
v_sub_f32 v117, v117, v10
v_xor_b32 v118, s76, v222
v_and_b32 v118, s77, v118
v_sub_f32 v118, v118, v10
v_xor_b32 v119, s76, v223
v_and_b32 v119, s77, v119
v_sub_f32 v119, v119, v10
v_xor_b32 v120, s76, v224
v_and_b32 v120, s77, v120
v_sub_f32 v120, v120, v10
v_xor_b32 v121, s76, v225
v_and_b32 v121, s77, v121
v_sub_f32 v121, v121, v10
v_xor_b32 v122, s76, v226
v_and_b32 v122, s77, v122
v_sub_f32 v122, v122, v10
v_xor_b32 v123, s76, v227
v_and_b32 v123, s77, v123
v_sub_f32 v123, v123, v10
v_xor_b32 v124, s76, v228
v_and_b32 v124, s77, v124
v_sub_f32 v124, v124, v10
v_xor_b32 v125, s76, v229
v_and_b32 v125, s77, v125
v_sub_f32 v125, v125, v10
v_xor_b32 v126, s76, v230
v_and_b32 v126, s77, v126
v_sub_f32 v126, v126, v10
v_xor_b32 v127, s76, v231
v_and_b32 v127, s77, v127
v_sub_f32 v127, v127, v10
s_waitcnt vmcnt(3)
s_nop 0
v_mfma_f32_32x32x16_bf16 v[112:127], v[152:155], v[80:83], v[112:127]
s_waitcnt vmcnt(2)
v_mfma_f32_32x32x16_bf16 v[112:127], v[156:159], v[88:91], v[112:127]
s_nop 11
v_exp_f32 v112, v112
v_exp_f32 v113, v113
v_exp_f32 v114, v114
v_exp_f32 v115, v115
v_exp_f32 v116, v116
v_exp_f32 v117, v117
v_exp_f32 v118, v118
v_exp_f32 v119, v119
v_exp_f32 v120, v120
v_exp_f32 v121, v121
v_exp_f32 v122, v122
v_exp_f32 v123, v123
v_exp_f32 v124, v124
v_exp_f32 v125, v125
v_exp_f32 v126, v126
v_exp_f32 v127, v127
v_cvt_pk_bf16_f32 v144, v112, v113
v_cvt_pk_bf16_f32 v145, v114, v115
v_cvt_pk_bf16_f32 v146, v116, v117
v_cvt_pk_bf16_f32 v147, v118, v119
v_cvt_pk_bf16_f32 v148, v120, v121
v_cvt_pk_bf16_f32 v149, v122, v123
v_cvt_pk_bf16_f32 v150, v124, v125
v_cvt_pk_bf16_f32 v151, v126, v127
s_waitcnt vmcnt(1)
v_mfma_f32_32x32x16_bf16 v[192:207], v[160:163], v[144:147], v[192:207]
v_mfma_f32_16x16x32_bf16 v[208:211], v[212:215], v[144:147], v[208:211]
s_waitcnt vmcnt(0)
v_mfma_f32_32x32x16_bf16 v[192:207], v[164:167], v[148:151], v[192:207]
v_mfma_f32_16x16x32_bf16 v[208:211], v[212:215], v[148:151], v[208:211]
s_add_u32 s75, s75, 1
s_sub_u32 s74, s74, 1
s_cselect_b32 s75, 9, s75
s_cmp_lt_u32 s75, 9
s_cbranch_scc1 sl_183
v_mov_b32 v10, 0xf149f2ca
v_mov_b32 v11, 0
v_mov_b32 v16, 0
v_mov_b32 v17, 0
v_mov_b32 v18, 0
v_mov_b32 v19, 0
v_mov_b32 v20, 0
v_mov_b32 v21, 0
v_mov_b32 v22, 0
v_mov_b32 v23, 0
v_mov_b32 v24, 0
v_mov_b32 v25, 0
v_mov_b32 v26, 0
v_mov_b32 v27, 0
v_mov_b32 v28, 0
v_mov_b32 v29, 0
v_mov_b32 v30, 0
v_mov_b32 v31, 0
v_mov_b32 v32, 0
v_mov_b32 v33, 0
v_mov_b32 v34, 0
v_mov_b32 v35, 0
s_sub_u32 s74, 3, s65
s_lshl2_add_u32 s74, s59, s74
s_mov_b32 s75, 0
sl_184:
s_lshr_b32 s76, s74, 2
s_lshl_b32 s76, s76, 19
s_and_b32 s77, s74, 3
s_lshl_b32 s77, s77, 13
s_add_u32 s76, s76, s77
s_add_u32 s76, s76, s73
buffer_load_dwordx4 v[152:155], v6, s[20:23], s76 offen offset:0 sc1
buffer_load_dwordx4 v[156:159], v6, s[20:23], s76 offen offset:1024 sc1
s_cmp_eq_u32 s75, 0
s_cselect_b32 s76, 0xf149f2ca, 0
s_and_b32 s77, s75, 7
s_cselect_b32 s77, 0, -1
v_xor_b32 v112, s76, v216
v_and_b32 v112, s77, v112
v_xor_b32 v113, s76, v217
v_and_b32 v113, s77, v113
v_xor_b32 v114, s76, v218
v_and_b32 v114, s77, v114
v_xor_b32 v115, s76, v219
v_and_b32 v115, s77, v115
v_xor_b32 v116, s76, v220
v_and_b32 v116, s77, v116
v_xor_b32 v117, s76, v221
v_and_b32 v117, s77, v117
v_xor_b32 v118, s76, v222
v_and_b32 v118, s77, v118
v_xor_b32 v119, s76, v223
v_and_b32 v119, s77, v119
v_xor_b32 v120, s76, v224
v_and_b32 v120, s77, v120
v_xor_b32 v121, s76, v225
v_and_b32 v121, s77, v121
v_xor_b32 v122, s76, v226
v_and_b32 v122, s77, v122
v_xor_b32 v123, s76, v227
v_and_b32 v123, s77, v123
v_xor_b32 v124, s76, v228
v_and_b32 v124, s77, v124
v_xor_b32 v125, s76, v229
v_and_b32 v125, s77, v125
v_xor_b32 v126, s76, v230
v_and_b32 v126, s77, v126
v_xor_b32 v127, s76, v231
v_and_b32 v127, s77, v127
s_waitcnt vmcnt(1)
s_nop 0
v_mfma_f32_32x32x16_bf16 v[112:127], v[152:155], v[96:99], v[112:127]
s_waitcnt vmcnt(0)
v_mfma_f32_32x32x16_bf16 v[112:127], v[156:159], v[104:107], v[112:127]
s_nop 11
v_max3_f32 v10, v10, v112, v113
v_max3_f32 v10, v10, v114, v115
v_max3_f32 v10, v10, v116, v117
v_max3_f32 v10, v10, v118, v119
v_max3_f32 v10, v10, v120, v121
v_max3_f32 v10, v10, v122, v123
v_max3_f32 v10, v10, v124, v125
v_max3_f32 v10, v10, v126, v127
s_add_u32 s75, s75, 1
s_sub_u32 s74, s74, 1
s_cselect_b32 s75, 9, s75
s_cmp_lt_u32 s75, 9
s_cbranch_scc1 sl_184
v_mov_b32 v11, v10
s_nop 1
v_permlane32_swap_b32 v11, v10
v_max_f32 v10, v10, v11
s_sub_u32 s74, 3, s65
s_lshl2_add_u32 s74, s59, s74
s_mov_b32 s75, 0
sl_185:
s_lshr_b32 s76, s74, 2
s_lshl_b32 s76, s76, 19
s_and_b32 s77, s74, 3
s_lshl_b32 s77, s77, 13
s_add_u32 s76, s76, s77
s_add_u32 s76, s76, s73
buffer_load_dwordx4 v[152:155], v6, s[20:23], s76 offen offset:0 sc1
buffer_load_dwordx4 v[156:159], v6, s[20:23], s76 offen offset:1024 sc1
buffer_load_dwordx4 v[160:163], v6, s[20:23], s76 offen offset:2048 sc1
buffer_load_dwordx4 v[164:167], v6, s[20:23], s76 offen offset:3072 sc1
s_cmp_eq_u32 s75, 0
s_cselect_b32 s76, 0xf149f2ca, 0
s_and_b32 s77, s75, 7
s_cselect_b32 s77, 0, -1
v_xor_b32 v112, s76, v216
v_and_b32 v112, s77, v112
v_sub_f32 v112, v112, v10
v_xor_b32 v113, s76, v217
v_and_b32 v113, s77, v113
v_sub_f32 v113, v113, v10
v_xor_b32 v114, s76, v218
v_and_b32 v114, s77, v114
v_sub_f32 v114, v114, v10
v_xor_b32 v115, s76, v219
v_and_b32 v115, s77, v115
v_sub_f32 v115, v115, v10
v_xor_b32 v116, s76, v220
v_and_b32 v116, s77, v116
v_sub_f32 v116, v116, v10
v_xor_b32 v117, s76, v221
v_and_b32 v117, s77, v117
v_sub_f32 v117, v117, v10
v_xor_b32 v118, s76, v222
v_and_b32 v118, s77, v118
v_sub_f32 v118, v118, v10
v_xor_b32 v119, s76, v223
v_and_b32 v119, s77, v119
v_sub_f32 v119, v119, v10
v_xor_b32 v120, s76, v224
v_and_b32 v120, s77, v120
v_sub_f32 v120, v120, v10
v_xor_b32 v121, s76, v225
v_and_b32 v121, s77, v121
v_sub_f32 v121, v121, v10
v_xor_b32 v122, s76, v226
v_and_b32 v122, s77, v122
v_sub_f32 v122, v122, v10
v_xor_b32 v123, s76, v227
v_and_b32 v123, s77, v123
v_sub_f32 v123, v123, v10
v_xor_b32 v124, s76, v228
v_and_b32 v124, s77, v124
v_sub_f32 v124, v124, v10
v_xor_b32 v125, s76, v229
v_and_b32 v125, s77, v125
v_sub_f32 v125, v125, v10
v_xor_b32 v126, s76, v230
v_and_b32 v126, s77, v126
v_sub_f32 v126, v126, v10
v_xor_b32 v127, s76, v231
v_and_b32 v127, s77, v127
v_sub_f32 v127, v127, v10
s_waitcnt vmcnt(3)
s_nop 0
v_mfma_f32_32x32x16_bf16 v[112:127], v[152:155], v[96:99], v[112:127]
s_waitcnt vmcnt(2)
v_mfma_f32_32x32x16_bf16 v[112:127], v[156:159], v[104:107], v[112:127]
s_nop 11
v_exp_f32 v112, v112
v_exp_f32 v113, v113
v_exp_f32 v114, v114
v_exp_f32 v115, v115
v_exp_f32 v116, v116
v_exp_f32 v117, v117
v_exp_f32 v118, v118
v_exp_f32 v119, v119
v_exp_f32 v120, v120
v_exp_f32 v121, v121
v_exp_f32 v122, v122
v_exp_f32 v123, v123
v_exp_f32 v124, v124
v_exp_f32 v125, v125
v_exp_f32 v126, v126
v_exp_f32 v127, v127
v_cvt_pk_bf16_f32 v144, v112, v113
v_cvt_pk_bf16_f32 v145, v114, v115
v_cvt_pk_bf16_f32 v146, v116, v117
v_cvt_pk_bf16_f32 v147, v118, v119
v_cvt_pk_bf16_f32 v148, v120, v121
v_cvt_pk_bf16_f32 v149, v122, v123
v_cvt_pk_bf16_f32 v150, v124, v125
v_cvt_pk_bf16_f32 v151, v126, v127
s_waitcnt vmcnt(1)
v_mfma_f32_32x32x16_bf16 v[16:31], v[160:163], v[144:147], v[16:31]
v_mfma_f32_16x16x32_bf16 v[32:35], v[212:215], v[144:147], v[32:35]
s_waitcnt vmcnt(0)
v_mfma_f32_32x32x16_bf16 v[16:31], v[164:167], v[148:151], v[16:31]
v_mfma_f32_16x16x32_bf16 v[32:35], v[212:215], v[148:151], v[32:35]
s_add_u32 s75, s75, 1
s_sub_u32 s74, s74, 1
s_cselect_b32 s75, 9, s75
s_cmp_lt_u32 s75, 9
s_cbranch_scc1 sl_185
s_branch sback_136
far_137:
buffer_store_dwordx4 v[16:19], v9, s[20:23], s67 offen offset:0 sc1
buffer_store_dwordx4 v[20:23], v9, s[20:23], s67 offen offset:1024 sc1
s_branch near_138
far_139:
buffer_store_dwordx4 v[192:195], v9, s[20:23], s66 offen offset:0 sc1
buffer_store_dwordx4 v[196:199], v9, s[20:23], s66 offen offset:1024 sc1
s_branch near_140
far_143:
buffer_store_dword v212, v3, s[24:27], s70 offen sc1
s_branch near_144
mo_145:
s_lshr_b32 s67, s33, 5
s_cmp_eq_u32 s67, s66
s_cbranch_scc0 mo_146
s_and_b32 s67, s33, 31
v_sub_u32 v48, s67, v48
v_lshlrev_b32 v49, 4, v49
s_lshl_b32 s67, s62, 14
s_add_u32 s67, s67, 30686208
poll_186:
buffer_load_dwordx4 v[56:59], v49, s[20:23], s67 offen offset:0 sc1
buffer_load_dwordx4 v[60:63], v49, s[20:23], s67 offen offset:64 sc1
pchk_187:
s_waitcnt vmcnt(1)
v_min3_u32 v50, v56, v57, v58
s_waitcnt vmcnt(0)
v_min3_u32 v50, v50, v59, v60
v_min3_u32 v50, v50, v61, v62
v_min_u32 v50, v50, v63
v_cmp_eq_u32 vcc, 0, v50
s_cbranch_vccz pdone_188
s_sub_u32 s32, s32, 1
s_cmp_gt_i32 s32, 0
s_cbranch_scc1 poll_186
pdone_188:
v_cmp_eq_u32 vcc, 0, v48
s_nop 1
v_cndmask_b32 v240, v240, v56, vcc
v_cndmask_b32 v241, v241, v57, vcc
v_cndmask_b32 v242, v242, v58, vcc
v_cndmask_b32 v243, v243, v59, vcc
v_cndmask_b32 v244, v244, v60, vcc
v_cndmask_b32 v245, v245, v61, vcc
v_cndmask_b32 v246, v246, v62, vcc
v_cndmask_b32 v247, v247, v63, vcc
v_cmp_eq_u32 vcc, 16, v48
s_nop 1
v_cndmask_b32 v248, v248, v56, vcc
v_cndmask_b32 v249, v249, v57, vcc
v_cndmask_b32 v250, v250, v58, vcc
v_cndmask_b32 v251, v251, v59, vcc
v_cndmask_b32 v252, v252, v60, vcc
v_cndmask_b32 v253, v253, v61, vcc
v_cndmask_b32 v254, v254, v62, vcc
v_cndmask_b32 v255, v255, v63, vcc
s_branch mo_146
far_149:
buffer_store_dwordx4 v[240:243], v6, s[20:23], s68 offen offset:0 sc1
buffer_store_dwordx4 v[244:247], v6, s[20:23], s68 offen offset:1024 sc1
buffer_store_dwordx4 v[248:251], v6, s[20:23], s68 offen offset:2048 sc1
buffer_store_dwordx4 v[252:255], v6, s[20:23], s68 offen offset:3072 sc1
s_branch near_150
far_151:
buffer_store_dwordx4 v[8:11], v6, s[24:27], s67 offen sc1
s_branch near_152
far_153:
buffer_store_dword v212, v3, s[24:27], s66 offen sc1
s_branch near_154
far_162:
buffer_store_dwordx2 v[10:11], v12, s[24:27], s66 offen sc1
s_branch near_163
L_end:
L_fin:
s_endpgm
.section .rodata,"a"
.p2align 6
.amdhsa_kernel interleave_layers__sliding_block__moe_arch_mod__prompt_kernel
  .amdhsa_next_free_vgpr 256
  .amdhsa_next_free_sgpr 102
  .amdhsa_accum_offset 256
  .amdhsa_group_segment_fixed_size 0
  .amdhsa_kernarg_size 88
  .amdhsa_user_sgpr_count 2
  .amdhsa_user_sgpr_kernarg_segment_ptr 1
  .amdhsa_system_sgpr_workgroup_id_x 1
  .amdhsa_float_denorm_mode_32 3
.end_amdhsa_kernel
```

```asm
; @launch grid=(256,1,1) block=(512,1,1) lds=163840
.amdgcn_target "amdgcn-amd-amdhsa--gfx950"
.text
.globl interleave_layers__sliding_block__moe_arch_mod__prompt_kernel
.p2align 8
.type interleave_layers__sliding_block__moe_arch_mod__prompt_kernel,@function
interleave_layers__sliding_block__moe_arch_mod__prompt_kernel:
s_cmp_ge_u32 s2, 256
s_cbranch_scc1 L_fin
s_load_dwordx16 s[36:51], s[0:1], 0
s_load_dwordx4 s[52:55], s[0:1], 64
s_load_dwordx2 s[56:57], s[0:1], 80
v_lshrrev_b32 v1, 6, v0
v_and_b32 v0, 63, v0
s_and_b32 s64, s2, 7
v_readfirstlane_b32 s3, v1
s_lshr_b32 s65, s2, 3
s_and_b32 s66, s65, 7
s_and_b32 s67, s64, 1
s_lshl3_add_u32 s59, s67, s66
s_lshr_b32 s66, s65, 3
s_lshr_b32 s67, s64, 1
s_lshl2_add_u32 s60, s67, s66
s_and_b32 s66, s65, 1
s_lshl1_add_u32 s61, s64, s66
s_lshr_b32 s62, s65, 1
s_mov_b32 s59, s61
s_xor_b32 s60, s62, 0
s_mov_b32 s63, 0
s_mov_b32 s34, 0
s_mov_b32 s32, 200000
s_mov_b32 s33, -1
s_cmp_ge_u32 s3, 4
s_cselect_b32 s66, 3, 1
s_and_b32 s58, s3, s66
s_waitcnt lgkmcnt(0)
s_mov_b32 s8, s36
s_mov_b32 s9, s37
s_mov_b32 s10, 0x400000
s_mov_b32 s11, 0x00020000
s_mov_b32 s12, s38
s_mov_b32 s13, s39
s_mov_b32 s14, 0x600000
s_mov_b32 s15, 0x00020000
s_mov_b32 s16, s40
s_mov_b32 s17, s41
s_mov_b32 s18, 0x200000
s_mov_b32 s19, 0x00020000
s_mov_b32 s20, s56
s_mov_b32 s21, s57
s_mov_b32 s22, 0x2500000
s_mov_b32 s23, 0x00020000
s_add_u32 s24, s56, 30408704
s_addc_u32 s25, s57, 0
s_mov_b32 s26, 2818048
s_mov_b32 s27, 0x00020000
s_mov_b32 s28, s52
s_mov_b32 s29, s53
s_mov_b32 s30, 0x400000
s_mov_b32 s31, 0x00020000
s_cmp_ge_u32 s3, 4
s_cbranch_scc1 L_m
s_cmp_ge_u32 s3, 2
s_cbranch_scc1 L_f
s_setprio 1
v_and_b32 v22, 7, v0
v_lshrrev_b32 v23, 4, v0
v_lshrrev_b32 v6, 3, v0
v_xor_b32 v7, v22, v23
v_lshlrev_b32 v7, 4, v7
v_lshl_add_u32 v8, v6, 11, v7
v_xor_b32 v7, 64, v8
v_add_u32 v9, 15360, v7
v_add_u32 v10, 30720, v8
v_add_u32 v11, 46080, v7
s_lshl_b32 s70, s59, 18
s_lshl_b32 s71, s58, 16
s_add_u32 s68, s70, s71
s_sub_u32 s69, s70, s71
s_add_u32 s69, s69, 196608
s_mov_b32 s67, 128
s_lshl_b32 s75, s58, 13
s_mov_b32 s65, 86016
s_and_b32 s79, s59, 1
s_mul_i32 s70, s60, 1
s_and_b32 s71, s59, 14
s_add_u32 s70, s70, s71
s_and_b32 s70, s70, 15
s_xor_b32 s64, s70, s79
s_mul_i32 s70, s64, s67
s_add_u32 m0, s65, s75
s_add_u32 s71, s70, s68
buffer_load_dwordx4 v8, s[8:11], s71 offen offset:0 lds
buffer_load_dwordx4 v9, s[8:11], s71 offen offset:1024 lds
buffer_load_dwordx4 v10, s[8:11], s71 offen offset:2048 lds
buffer_load_dwordx4 v11, s[8:11], s71 offen offset:3072 lds
s_add_u32 m0, m0, 4096
s_add_u32 s71, s70, s69
buffer_load_dwordx4 v8, s[8:11], s71 offen offset:0 lds
buffer_load_dwordx4 v9, s[8:11], s71 offen offset:1024 lds
buffer_load_dwordx4 v10, s[8:11], s71 offen offset:2048 lds
buffer_load_dwordx4 v11, s[8:11], s71 offen offset:3072 lds
v_and_b32 v7, 2, v6
v_xor_b32 v7, v7, v22
v_mul_u32_u24 v6, 6144, v6
v_lshl_add_u32 v12, v7, 4, v6
v_xor_b32 v6, 64, v12
v_add_u32 v13, 48128, v6
v_add_u32 v14, 96256, v12
v_add_u32 v15, 144384, v6
s_mul_i32 s76, s58, 12288
s_add_u32 s76, s76, 16384
s_lshl_b32 s70, s60, 7
s_cmp_eq_u32 s58, 0
s_mov_b32 s71, 198656
s_cselect_b32 s72, 0, s71
s_mov_b32 s71, 4096
s_cselect_b32 s73, 196608, s71
s_mov_b32 s71, 200704
s_cselect_b32 s74, 2048, s71
s_add_u32 s72, s72, s70
s_add_u32 s73, s73, s70
s_add_u32 s74, s74, s70
s_mul_i32 s70, s64, 393216
s_add_u32 m0, s65, s76
s_add_u32 s71, s70, s72
buffer_load_dwordx4 v12, s[12:15], s71 offen offset:0 lds
buffer_load_dwordx4 v13, s[12:15], s71 offen offset:1024 lds
buffer_load_dwordx4 v14, s[12:15], s71 offen offset:2048 lds
buffer_load_dwordx4 v15, s[12:15], s71 offen offset:3072 lds
s_add_u32 m0, m0, 4096
s_add_u32 s71, s70, s73
buffer_load_dwordx4 v12, s[12:15], s71 offen offset:0 lds
buffer_load_dwordx4 v13, s[12:15], s71 offen offset:1024 lds
buffer_load_dwordx4 v14, s[12:15], s71 offen offset:2048 lds
buffer_load_dwordx4 v15, s[12:15], s71 offen offset:3072 lds
s_add_u32 m0, m0, 4096
s_add_u32 s71, s70, s74
buffer_load_dwordx4 v12, s[12:15], s71 offen offset:0 lds
buffer_load_dwordx4 v13, s[12:15], s71 offen offset:1024 lds
buffer_load_dwordx4 v14, s[12:15], s71 offen offset:2048 lds
buffer_load_dwordx4 v15, s[12:15], s71 offen offset:3072 lds
s_xor_b32 s64, s64, s79
s_add_u32 s64, s64, 1
s_and_b32 s64, s64, 15
s_xor_b32 s64, s64, s79
s_sub_u32 s65, s65, 40960
s_cselect_b32 s65, 86016, s65
v_and_b32 v1, 3, v0
v_lshlrev_b32 v1, 2, v1
v_and_b32 v2, 4, v1
s_lshl2_add_u32 s35, s58, 16
v_mov_b32 v3, s35
v_lshlrev_b32 v20, 4, v0
v_lshrrev_b32 v6, 2, v0
v_lshl_add_u32 v21, v6, 7, v1
v_lshrrev_b32 v6, 3, v0
v_lshlrev_b32 v23, 1, v23
v_xor_b32 v23, v23, v22
v_lshlrev_b32 v23, 4, v23
v_lshl_add_u32 v23, v6, 11, v23
s_lshl_b32 s70, s62, 7
s_lshl_b32 s71, s58, 16
s_add_u32 s70, s70, s71
v_add_u32 v16, s70, v23
v_add_u32 v17, 15360, v16
v_add_u32 v18, 30720, v16
v_add_u32 v19, 46080, v16
s_add_u32 s77, s61, s62
s_lshl_b32 s77, s77, 17
s_lshl_b32 s78, s58, 12
s_mov_b32 s66, -2
s_barrier
.p2align 4
lq_1:
s_add_u32 s35, s66, 1
lw_4:
ds_read_b32 v5, v1 offset:0
s_waitcnt lgkmcnt(0)
v_cmp_gt_i32 vcc, s35, v5
s_cbranch_vccz lwd_5
s_sub_u32 s32, s32, 1
s_cmp_gt_i32 s32, 0
s_cbranch_scc1 lw_4
lwd_5:
s_cmp_eq_u32 s66, 0
s_cbranch_scc1 lcs_2
lcb_3:
s_mul_i32 s70, s64, s67
s_add_u32 m0, s65, s75
s_add_u32 s71, s70, s68
buffer_load_dwordx4 v8, s[8:11], s71 offen offset:0 sc1 lds
buffer_load_dwordx4 v9, s[8:11], s71 offen offset:1024 sc1 lds
buffer_load_dwordx4 v10, s[8:11], s71 offen offset:2048 sc1 lds
buffer_load_dwordx4 v11, s[8:11], s71 offen offset:3072 sc1 lds
buffer_load_dword v30, off, s[12:15], 0
s_add_u32 m0, m0, 4096
s_add_u32 s71, s70, s69
buffer_load_dwordx4 v8, s[8:11], s71 offen offset:0 sc1 lds
buffer_load_dwordx4 v9, s[8:11], s71 offen offset:1024 sc1 lds
buffer_load_dwordx4 v10, s[8:11], s71 offen offset:2048 sc1 lds
buffer_load_dwordx4 v11, s[8:11], s71 offen offset:3072 sc1 lds
buffer_load_dword v30, off, s[12:15], 0
s_mul_i32 s70, s64, 393216
s_add_u32 m0, s65, s76
s_add_u32 s71, s70, s72
buffer_load_dwordx4 v12, s[12:15], s71 offen offset:0 lds
buffer_load_dwordx4 v13, s[12:15], s71 offen offset:1024 lds
buffer_load_dwordx4 v14, s[12:15], s71 offen offset:2048 lds
buffer_load_dwordx4 v15, s[12:15], s71 offen offset:3072 lds
buffer_load_dword v30, off, s[12:15], 0
v_add_u32 v5, s66, 3
s_mov_b64 exec, 1
s_waitcnt vmcnt(15)
ds_write_b32 v3, v5
s_mov_b64 exec, -1
s_mul_i32 s70, s64, 393216
s_add_u32 m0, m0, 4096
s_add_u32 s71, s70, s73
buffer_load_dwordx4 v12, s[12:15], s71 offen offset:0 lds
buffer_load_dwordx4 v13, s[12:15], s71 offen offset:1024 lds
buffer_load_dwordx4 v14, s[12:15], s71 offen offset:2048 lds
buffer_load_dwordx4 v15, s[12:15], s71 offen offset:3072 lds
buffer_load_dword v30, off, s[12:15], 0
s_mul_i32 s70, s64, 393216
s_add_u32 m0, m0, 4096
s_add_u32 s71, s70, s74
buffer_load_dwordx4 v12, s[12:15], s71 offen offset:0 lds
buffer_load_dwordx4 v13, s[12:15], s71 offen offset:1024 lds
buffer_load_dwordx4 v14, s[12:15], s71 offen offset:2048 lds
buffer_load_dwordx4 v15, s[12:15], s71 offen offset:3072 lds
buffer_load_dword v30, off, s[12:15], 0
s_xor_b32 s64, s64, s79
s_add_u32 s64, s64, 1
s_and_b32 s64, s64, 15
s_xor_b32 s64, s64, s79
s_sub_u32 s65, s65, 40960
s_cselect_b32 s65, 86016, s65
s_add_u32 s66, s66, 1
s_and_b32 s70, s66, 31
s_cmp_eq_u32 s70, 13
s_cbranch_scc0 lq_1
s_waitcnt vmcnt(0)
v_add_u32 v5, s34, 16
s_mov_b64 exec, 1
ds_write_b32 v3, v5
s_mov_b64 exec, -1
s_add_u32 s35, s34, 14
lw_6:
ds_read_b32 v5, v1 offset:0
s_waitcnt lgkmcnt(0)
v_cmp_gt_i32 vcc, s35, v5
s_cbranch_vccz lwd_7
s_sleep 1
s_sub_u32 s32, s32, 1
s_cmp_gt_i32 s32, 0
s_cbranch_scc1 lw_6
lwd_7:
s_add_u32 s70, s77, 262144
s_add_u32 m0, s78, 49152
s_and_b32 s70, s70, 0x1fffff
buffer_load_dwordx4 v16, s[16:19], s70 offen offset:0 lds
buffer_load_dwordx4 v17, s[16:19], s70 offen offset:1024 lds
buffer_load_dwordx4 v18, s[16:19], s70 offen offset:2048 lds
buffer_load_dwordx4 v19, s[16:19], s70 offen offset:3072 lds
buffer_load_dword v30, off, s[12:15], 0
s_add_u32 s70, s77, 393216
s_add_u32 m0, s78, 57344
s_and_b32 s70, s70, 0x1fffff
buffer_load_dwordx4 v16, s[16:19], s70 offen offset:0 lds
buffer_load_dwordx4 v17, s[16:19], s70 offen offset:1024 lds
buffer_load_dwordx4 v18, s[16:19], s70 offen offset:2048 lds
buffer_load_dwordx4 v19, s[16:19], s70 offen offset:3072 lds
buffer_load_dword v30, off, s[12:15], 0
s_add_u32 s70, s77, 524288
s_add_u32 m0, s78, 65536
s_and_b32 s70, s70, 0x1fffff
buffer_load_dwordx4 v16, s[16:19], s70 offen offset:0 lds
buffer_load_dwordx4 v17, s[16:19], s70 offen offset:1024 lds
buffer_load_dwordx4 v18, s[16:19], s70 offen offset:2048 lds
buffer_load_dwordx4 v19, s[16:19], s70 offen offset:3072 lds
buffer_load_dword v30, off, s[12:15], 0
s_add_u32 s70, s77, 655360
s_add_u32 m0, s78, 73728
s_and_b32 s70, s70, 0x1fffff
buffer_load_dwordx4 v16, s[16:19], s70 offen offset:0 lds
buffer_load_dwordx4 v17, s[16:19], s70 offen offset:1024 lds
buffer_load_dwordx4 v18, s[16:19], s70 offen offset:2048 lds
buffer_load_dwordx4 v19, s[16:19], s70 offen offset:3072 lds
buffer_load_dword v30, off, s[12:15], 0
s_sub_u32 s70, s59, s58
s_lshl_b32 s71, s70, 7
s_add_u32 s71, s71, s60
s_lshl4_add_u32 s70, s70, s60
s_sub_u32 s70, s70, 16
s_lshl_b32 s66, s71, 7
s_add_u32 s66, s66, 253952
s_lshl_b32 s70, s70, 15
s_lshl_b32 s71, s63, 23
s_add_u32 s70, s70, s71
s_add_u32 s64, s70, 1077248
s_mul_i32 s65, s58, -94208
s_add_u32 s35, s34, 16
lw_8:
ds_read_b32 v5, v1 offset:0
s_waitcnt lgkmcnt(0)
v_cmp_gt_i32 vcc, s35, v5
s_cbranch_vccz lwd_9
s_sleep 1
s_sub_u32 s32, s32, 1
s_cmp_gt_i32 s32, 0
s_cbranch_scc1 lw_8
lwd_9:
s_add_u32 s70, s77, 131072
s_add_u32 m0, s78, 40960
s_and_b32 s70, s70, 0x1fffff
buffer_load_dwordx4 v16, s[16:19], s70 offen offset:0 lds
buffer_load_dwordx4 v17, s[16:19], s70 offen offset:1024 lds
buffer_load_dwordx4 v18, s[16:19], s70 offen offset:2048 lds
buffer_load_dwordx4 v19, s[16:19], s70 offen offset:3072 lds
buffer_load_dword v30, off, s[12:15], 0
s_add_u32 s70, s77, 786432
s_add_u32 m0, s78, 81920
s_and_b32 s70, s70, 0x1fffff
buffer_load_dwordx4 v16, s[16:19], s70 offen offset:0 lds
buffer_load_dwordx4 v17, s[16:19], s70 offen offset:1024 lds
buffer_load_dwordx4 v18, s[16:19], s70 offen offset:2048 lds
buffer_load_dwordx4 v19, s[16:19], s70 offen offset:3072 lds
buffer_load_dword v30, off, s[12:15], 0
s_add_u32 s70, s77, 917504
s_add_u32 m0, s78, 90112
s_and_b32 s70, s70, 0x1fffff
buffer_load_dwordx4 v16, s[16:19], s70 offen offset:0 lds
buffer_load_dwordx4 v17, s[16:19], s70 offen offset:1024 lds
buffer_load_dwordx4 v18, s[16:19], s70 offen offset:2048 lds
buffer_load_dwordx4 v19, s[16:19], s70 offen offset:3072 lds
buffer_load_dword v30, off, s[12:15], 0
s_add_u32 s35, s34, 17
lw_11:
ds_read_b32 v5, v1 offset:0
s_waitcnt lgkmcnt(0)
v_cmp_gt_i32 vcc, s35, v5
s_cbranch_vccz lwd_12
s_sleep 1
s_sub_u32 s32, s32, 1
s_cmp_gt_i32 s32, 0
s_cbranch_scc1 lw_11
lwd_12:
s_cmp_gt_u32 s59, s58
s_cbranch_scc0 nokv_10
poll_13:
buffer_load_dword v6, v1, s[24:27], s66 offen sc1
pchk_14:
s_waitcnt vmcnt(0)
v_cmp_eq_u32 vcc, 0, v6
s_cbranch_vccz pdone_15
s_sub_u32 s32, s32, 1
s_cmp_gt_i32 s32, 0
s_cbranch_scc1 poll_13
pdone_15:
s_add_u32 m0, s65, 126976
s_nop 0
buffer_load_dwordx4 v20, s[20:23], s64 offen offset:0 sc1 lds
buffer_load_dwordx4 v20, s[20:23], s64 offen offset:1024 sc1 lds
buffer_load_dwordx4 v20, s[20:23], s64 offen offset:2048 sc1 lds
buffer_load_dwordx4 v20, s[20:23], s64 offen offset:3072 sc1 lds
buffer_load_dword v30, off, s[12:15], 0
s_add_u32 m0, s65, 122880
s_sub_u32 s64, s64, 4096
buffer_load_dwordx4 v20, s[20:23], s64 offen offset:0 sc1 lds
buffer_load_dwordx4 v20, s[20:23], s64 offen offset:1024 sc1 lds
buffer_load_dwordx4 v20, s[20:23], s64 offen offset:2048 sc1 lds
buffer_load_dwordx4 v20, s[20:23], s64 offen offset:3072 sc1 lds
buffer_load_dword v30, off, s[12:15], 0
s_add_u32 m0, s65, 118784
s_sub_u32 s64, s64, 4096
buffer_load_dwordx4 v20, s[20:23], s64 offen offset:0 sc1 lds
buffer_load_dwordx4 v20, s[20:23], s64 offen offset:1024 sc1 lds
buffer_load_dwordx4 v20, s[20:23], s64 offen offset:2048 sc1 lds
buffer_load_dwordx4 v20, s[20:23], s64 offen offset:3072 sc1 lds
buffer_load_dword v30, off, s[12:15], 0
s_add_u32 m0, s65, 114688
s_sub_u32 s64, s64, 4096
buffer_load_dwordx4 v20, s[20:23], s64 offen offset:0 sc1 lds
buffer_load_dwordx4 v20, s[20:23], s64 offen offset:1024 sc1 lds
buffer_load_dwordx4 v20, s[20:23], s64 offen offset:2048 sc1 lds
buffer_load_dwordx4 v20, s[20:23], s64 offen offset:3072 sc1 lds
buffer_load_dword v30, off, s[12:15], 0
s_add_u32 m0, s65, 110592
s_sub_u32 s64, s64, 4096
buffer_load_dwordx4 v20, s[20:23], s64 offen offset:0 sc1 lds
buffer_load_dwordx4 v20, s[20:23], s64 offen offset:1024 sc1 lds
buffer_load_dwordx4 v20, s[20:23], s64 offen offset:2048 sc1 lds
buffer_load_dwordx4 v20, s[20:23], s64 offen offset:3072 sc1 lds
buffer_load_dword v30, off, s[12:15], 0
s_add_u32 m0, s65, 106496
s_sub_u32 s64, s64, 4096
buffer_load_dwordx4 v20, s[20:23], s64 offen offset:0 sc1 lds
buffer_load_dwordx4 v20, s[20:23], s64 offen offset:1024 sc1 lds
buffer_load_dwordx4 v20, s[20:23], s64 offen offset:2048 sc1 lds
buffer_load_dwordx4 v20, s[20:23], s64 offen offset:3072 sc1 lds
buffer_load_dword v30, off, s[12:15], 0
s_add_u32 m0, s65, 102400
s_sub_u32 s64, s64, 4096
buffer_load_dwordx4 v20, s[20:23], s64 offen offset:0 sc1 lds
buffer_load_dwordx4 v20, s[20:23], s64 offen offset:1024 sc1 lds
buffer_load_dwordx4 v20, s[20:23], s64 offen offset:2048 sc1 lds
buffer_load_dwordx4 v20, s[20:23], s64 offen offset:3072 sc1 lds
buffer_load_dword v30, off, s[12:15], 0
s_add_u32 m0, s65, 98304
s_sub_u32 s64, s64, 4096
buffer_load_dwordx4 v20, s[20:23], s64 offen offset:0 sc1 lds
buffer_load_dwordx4 v20, s[20:23], s64 offen offset:1024 sc1 lds
buffer_load_dwordx4 v20, s[20:23], s64 offen offset:2048 sc1 lds
buffer_load_dwordx4 v20, s[20:23], s64 offen offset:3072 sc1 lds
buffer_load_dword v30, off, s[12:15], 0
nokv_10:
s_lshl_b32 s66, s61, 14
s_add_u32 s66, s66, 268288
s_waitcnt vmcnt(0)
v_add_u32 v5, s34, 17
s_mov_b64 exec, 1
ds_write_b32 v3, v5
s_mov_b64 exec, -1
s_add_u32 s35, s34, 18
lw_17:
ds_read_b32 v5, v1 offset:0
s_waitcnt lgkmcnt(0)
v_cmp_gt_i32 vcc, s35, v5
s_cbranch_vccz lwd_18
s_sleep 1
s_sub_u32 s32, s32, 1
s_cmp_gt_i32 s32, 0
s_cbranch_scc1 lw_17
lwd_18:
s_add_u32 s70, s77, 1572864
s_add_u32 m0, s78, 131072
s_and_b32 s70, s70, 0x1fffff
buffer_load_dwordx4 v16, s[16:19], s70 offen offset:0 lds
buffer_load_dwordx4 v17, s[16:19], s70 offen offset:1024 lds
buffer_load_dwordx4 v18, s[16:19], s70 offen offset:2048 lds
buffer_load_dwordx4 v19, s[16:19], s70 offen offset:3072 lds
buffer_load_dword v30, off, s[12:15], 0
s_add_u32 s70, s77, 1703936
s_add_u32 m0, s78, 139264
s_and_b32 s70, s70, 0x1fffff
buffer_load_dwordx4 v16, s[16:19], s70 offen offset:0 lds
buffer_load_dwordx4 v17, s[16:19], s70 offen offset:1024 lds
buffer_load_dwordx4 v18, s[16:19], s70 offen offset:2048 lds
buffer_load_dwordx4 v19, s[16:19], s70 offen offset:3072 lds
buffer_load_dword v30, off, s[12:15], 0
s_add_u32 s70, s77, 1835008
s_add_u32 m0, s78, 147456
s_and_b32 s70, s70, 0x1fffff
buffer_load_dwordx4 v16, s[16:19], s70 offen offset:0 lds
buffer_load_dwordx4 v17, s[16:19], s70 offen offset:1024 lds
buffer_load_dwordx4 v18, s[16:19], s70 offen offset:2048 lds
buffer_load_dwordx4 v19, s[16:19], s70 offen offset:3072 lds
buffer_load_dword v30, off, s[12:15], 0
s_add_u32 s70, s77, 1966080
s_add_u32 m0, s78, 155648
s_and_b32 s70, s70, 0x1fffff
buffer_load_dwordx4 v16, s[16:19], s70 offen offset:0 lds
buffer_load_dwordx4 v17, s[16:19], s70 offen offset:1024 lds
buffer_load_dwordx4 v18, s[16:19], s70 offen offset:2048 lds
buffer_load_dwordx4 v19, s[16:19], s70 offen offset:3072 lds
buffer_load_dword v30, off, s[12:15], 0
s_add_u32 s35, s34, 19
lw_19:
ds_read_b32 v5, v1 offset:0
s_waitcnt lgkmcnt(0)
v_cmp_gt_i32 vcc, s35, v5
s_cbranch_vccz lwd_20
s_sleep 2
s_sub_u32 s32, s32, 1
s_cmp_gt_i32 s32, 0
s_cbranch_scc1 lw_19
lwd_20:
s_add_u32 s70, s77, 1048576
s_add_u32 m0, s78, 98304
s_and_b32 s70, s70, 0x1fffff
buffer_load_dwordx4 v16, s[16:19], s70 offen offset:0 lds
buffer_load_dwordx4 v17, s[16:19], s70 offen offset:1024 lds
buffer_load_dwordx4 v18, s[16:19], s70 offen offset:2048 lds
buffer_load_dwordx4 v19, s[16:19], s70 offen offset:3072 lds
buffer_load_dword v30, off, s[12:15], 0
s_add_u32 s70, s77, 1179648
s_add_u32 m0, s78, 106496
s_and_b32 s70, s70, 0x1fffff
buffer_load_dwordx4 v16, s[16:19], s70 offen offset:0 lds
buffer_load_dwordx4 v17, s[16:19], s70 offen offset:1024 lds
buffer_load_dwordx4 v18, s[16:19], s70 offen offset:2048 lds
buffer_load_dwordx4 v19, s[16:19], s70 offen offset:3072 lds
buffer_load_dword v30, off, s[12:15], 0
s_add_u32 s70, s77, 1310720
s_add_u32 m0, s78, 114688
s_and_b32 s70, s70, 0x1fffff
buffer_load_dwordx4 v16, s[16:19], s70 offen offset:0 lds
buffer_load_dwordx4 v17, s[16:19], s70 offen offset:1024 lds
buffer_load_dwordx4 v18, s[16:19], s70 offen offset:2048 lds
buffer_load_dwordx4 v19, s[16:19], s70 offen offset:3072 lds
buffer_load_dword v30, off, s[12:15], 0
s_add_u32 s70, s77, 1441792
s_add_u32 m0, s78, 122880
s_and_b32 s70, s70, 0x1fffff
buffer_load_dwordx4 v16, s[16:19], s70 offen offset:0 lds
buffer_load_dwordx4 v17, s[16:19], s70 offen offset:1024 lds
buffer_load_dwordx4 v18, s[16:19], s70 offen offset:2048 lds
buffer_load_dwordx4 v19, s[16:19], s70 offen offset:3072 lds
buffer_load_dword v30, off, s[12:15], 0
s_add_u32 s35, s34, 20
lw_21:
ds_read_b32 v5, v1 offset:0
s_waitcnt lgkmcnt(0)
v_cmp_gt_i32 vcc, s35, v5
s_cbranch_vccz lwd_22
s_sleep 2
s_sub_u32 s32, s32, 1
s_cmp_gt_i32 s32, 0
s_cbranch_scc1 lw_21
lwd_22:
s_add_u32 s70, s77, 0
s_add_u32 m0, s78, 32768
s_and_b32 s70, s70, 0x1fffff
buffer_load_dwordx4 v16, s[16:19], s70 offen offset:0 lds
buffer_load_dwordx4 v17, s[16:19], s70 offen offset:1024 lds
buffer_load_dwordx4 v18, s[16:19], s70 offen offset:2048 lds
buffer_load_dwordx4 v19, s[16:19], s70 offen offset:3072 lds
buffer_load_dword v30, off, s[12:15], 0
s_cmp_eq_u32 s58, 0
s_cbranch_scc0 nofo_16
s_add_u32 s35, s34, 21
lw_23:
ds_read_b32 v5, v1 offset:0
s_waitcnt lgkmcnt(0)
v_cmp_gt_i32 vcc, s35, v5
s_cbranch_vccz lwd_24
s_sleep 1
s_sub_u32 s32, s32, 1
s_cmp_gt_i32 s32, 0
s_cbranch_scc1 lw_23
lwd_24:
poll_25:
buffer_load_dword v6, v21, s[24:27], s66 offen sc1
pchk_26:
s_waitcnt vmcnt(0)
v_cmp_eq_u32 vcc, 0, v6
s_cbranch_vccz pdone_27
s_sub_u32 s32, s32, 1
s_cmp_gt_i32 s32, 0
s_cbranch_scc1 poll_25
pdone_27:
nofo_16:
s_waitcnt vmcnt(0)
v_add_u32 v5, s34, 18
s_mov_b64 exec, 1
ds_write_b32 v3, v5
s_mov_b64 exec, -1
s_cmp_eq_u32 s63, 0
s_cbranch_scc0 L_end
v_bfe_u32 v6, v0, 3, 2
v_and_b32 v7, 2, v6
v_xor_b32 v7, v7, v22
v_lshrrev_b32 v23, 5, v0
v_lshl_add_u32 v6, v23, 4, v6
v_mul_u32_u24 v6, 6144, v6
v_lshl_add_u32 v12, v7, 4, v6
v_xor_b32 v6, 64, v12
v_add_u32 v13, 23552, v6
v_add_u32 v14, 47104, v12
v_add_u32 v15, 70656, v6
v_mov_b32 v8, v20
v_mov_b32 v9, v20
v_mov_b32 v10, v20
v_mov_b32 v11, v20
s_mov_b32 s8, s56
s_mov_b32 s9, s57
s_mov_b32 s10, 0x2500000
s_mov_b32 s11, 0x00020000
s_lshl_b32 s70, s59, 18
s_add_u32 s70, s70, 26214400
s_add_u32 s68, s70, s78
s_sub_u32 s69, s70, s78
s_add_u32 s69, s69, 12288
s_mov_b32 s67, 16384
s_lshl_b32 s66, s59, 14
s_add_u32 s66, s66, 274432
s_and_b32 s79, s59, 1
s_mul_i32 s79, s79, 1
s_mul_i32 s70, s60, 1
s_and_b32 s71, s59, 14
s_add_u32 s70, s70, s71
s_and_b32 s70, s70, 15
s_xor_b32 s64, s70, s79
s_mov_b32 s65, 86016
s_add_u32 s35, s34, 22
lw_28:
ds_read_b32 v5, v1 offset:0
s_waitcnt lgkmcnt(0)
v_cmp_gt_i32 vcc, s35, v5
s_cbranch_vccz lwd_29
s_sleep 2
s_sub_u32 s32, s32, 1
s_cmp_gt_i32 s32, 0
s_cbranch_scc1 lw_28
lwd_29:
s_mul_i32 s70, s64, 393216
s_add_u32 m0, s65, s76
s_add_u32 s71, s70, s72
buffer_load_dwordx4 v12, s[12:15], s71 offen offset:0 lds
buffer_load_dwordx4 v13, s[12:15], s71 offen offset:1024 lds
buffer_load_dwordx4 v14, s[12:15], s71 offen offset:2048 lds
buffer_load_dwordx4 v15, s[12:15], s71 offen offset:3072 lds
buffer_load_dword v30, off, s[12:15], 0
s_add_u32 m0, m0, 4096
s_add_u32 s71, s70, s73
buffer_load_dwordx4 v12, s[12:15], s71 offen offset:0 lds
buffer_load_dwordx4 v13, s[12:15], s71 offen offset:1024 lds
buffer_load_dwordx4 v14, s[12:15], s71 offen offset:2048 lds
buffer_load_dwordx4 v15, s[12:15], s71 offen offset:3072 lds
buffer_load_dword v30, off, s[12:15], 0
s_add_u32 m0, m0, 4096
s_add_u32 s71, s70, s74
buffer_load_dwordx4 v12, s[12:15], s71 offen offset:0 lds
buffer_load_dwordx4 v13, s[12:15], s71 offen offset:1024 lds
buffer_load_dwordx4 v14, s[12:15], s71 offen offset:2048 lds
buffer_load_dwordx4 v15, s[12:15], s71 offen offset:3072 lds
buffer_load_dword v30, off, s[12:15], 0
s_and_b32 s79, s59, 1
s_mul_i32 s79, s79, 1
s_mul_i32 s70, s60, 1
s_and_b32 s71, s59, 14
s_add_u32 s70, s70, s71
s_and_b32 s70, s70, 15
s_xor_b32 s64, s70, s79
s_mov_b32 s65, 86016
s_add_u32 s35, s34, 23
lw_30:
ds_read_b32 v5, v1 offset:0
s_waitcnt lgkmcnt(0)
v_cmp_gt_i32 vcc, s35, v5
s_cbranch_vccz lwd_31
s_sleep 1
s_sub_u32 s32, s32, 1
s_cmp_gt_i32 s32, 0
s_cbranch_scc1 lw_30
lwd_31:
poll_32:
buffer_load_dword v6, v21, s[24:27], s66 offen sc1
pchk_33:
s_waitcnt vmcnt(0)
v_cmp_eq_u32 vcc, 0, v6
s_cbranch_vccz pdone_34
s_sub_u32 s32, s32, 1
s_cmp_gt_i32 s32, 0
s_cbranch_scc1 poll_32
pdone_34:
s_mul_i32 s70, s64, s67
s_add_u32 m0, s65, s75
s_add_u32 s71, s70, s68
buffer_load_dwordx4 v8, s[8:11], s71 offen offset:0 sc1 lds
buffer_load_dwordx4 v9, s[8:11], s71 offen offset:1024 sc1 lds
buffer_load_dwordx4 v10, s[8:11], s71 offen offset:2048 sc1 lds
buffer_load_dwordx4 v11, s[8:11], s71 offen offset:3072 sc1 lds
buffer_load_dword v30, off, s[12:15], 0
s_add_u32 m0, m0, 4096
s_add_u32 s71, s70, s69
buffer_load_dwordx4 v8, s[8:11], s71 offen offset:0 sc1 lds
buffer_load_dwordx4 v9, s[8:11], s71 offen offset:1024 sc1 lds
buffer_load_dwordx4 v10, s[8:11], s71 offen offset:2048 sc1 lds
buffer_load_dwordx4 v11, s[8:11], s71 offen offset:3072 sc1 lds
buffer_load_dword v30, off, s[12:15], 0
s_xor_b32 s64, s64, s79
s_add_u32 s64, s64, 1
s_and_b32 s64, s64, 15
s_xor_b32 s64, s64, s79
s_sub_u32 s65, s65, 40960
s_cselect_b32 s65, 86016, s65
s_mul_i32 s70, s64, s67
s_add_u32 m0, s65, s75
s_add_u32 s71, s70, s68
buffer_load_dwordx4 v8, s[8:11], s71 offen offset:0 sc1 lds
buffer_load_dwordx4 v9, s[8:11], s71 offen offset:1024 sc1 lds
buffer_load_dwordx4 v10, s[8:11], s71 offen offset:2048 sc1 lds
buffer_load_dwordx4 v11, s[8:11], s71 offen offset:3072 sc1 lds
buffer_load_dword v30, off, s[12:15], 0
s_add_u32 m0, m0, 4096
s_add_u32 s71, s70, s69
buffer_load_dwordx4 v8, s[8:11], s71 offen offset:0 sc1 lds
buffer_load_dwordx4 v9, s[8:11], s71 offen offset:1024 sc1 lds
buffer_load_dwordx4 v10, s[8:11], s71 offen offset:2048 sc1 lds
buffer_load_dwordx4 v11, s[8:11], s71 offen offset:3072 sc1 lds
buffer_load_dword v30, off, s[12:15], 0
s_mul_i32 s70, s64, 393216
s_add_u32 m0, s65, s76
s_add_u32 s71, s70, s72
buffer_load_dwordx4 v12, s[12:15], s71 offen offset:0 lds
buffer_load_dwordx4 v13, s[12:15], s71 offen offset:1024 lds
buffer_load_dwordx4 v14, s[12:15], s71 offen offset:2048 lds
buffer_load_dwordx4 v15, s[12:15], s71 offen offset:3072 lds
buffer_load_dword v30, off, s[12:15], 0
s_add_u32 m0, m0, 4096
s_add_u32 s71, s70, s73
buffer_load_dwordx4 v12, s[12:15], s71 offen offset:0 lds
buffer_load_dwordx4 v13, s[12:15], s71 offen offset:1024 lds
buffer_load_dwordx4 v14, s[12:15], s71 offen offset:2048 lds
buffer_load_dwordx4 v15, s[12:15], s71 offen offset:3072 lds
buffer_load_dword v30, off, s[12:15], 0
s_add_u32 m0, m0, 4096
s_add_u32 s71, s70, s74
buffer_load_dwordx4 v12, s[12:15], s71 offen offset:0 lds
buffer_load_dwordx4 v13, s[12:15], s71 offen offset:1024 lds
buffer_load_dwordx4 v14, s[12:15], s71 offen offset:2048 lds
buffer_load_dwordx4 v15, s[12:15], s71 offen offset:3072 lds
buffer_load_dword v30, off, s[12:15], 0
s_xor_b32 s64, s64, s79
s_add_u32 s64, s64, 1
s_and_b32 s64, s64, 15
s_xor_b32 s64, s64, s79
s_sub_u32 s65, s65, 40960
s_cselect_b32 s65, 86016, s65
s_mul_i32 s70, s64, s67
s_add_u32 m0, s65, s75
s_add_u32 s71, s70, s68
buffer_load_dwordx4 v8, s[8:11], s71 offen offset:0 sc1 lds
buffer_load_dwordx4 v9, s[8:11], s71 offen offset:1024 sc1 lds
buffer_load_dwordx4 v10, s[8:11], s71 offen offset:2048 sc1 lds
buffer_load_dwordx4 v11, s[8:11], s71 offen offset:3072 sc1 lds
buffer_load_dword v30, off, s[12:15], 0
s_add_u32 m0, m0, 4096
s_add_u32 s71, s70, s69
buffer_load_dwordx4 v8, s[8:11], s71 offen offset:0 sc1 lds
buffer_load_dwordx4 v9, s[8:11], s71 offen offset:1024 sc1 lds
buffer_load_dwordx4 v10, s[8:11], s71 offen offset:2048 sc1 lds
buffer_load_dwordx4 v11, s[8:11], s71 offen offset:3072 sc1 lds
buffer_load_dword v30, off, s[12:15], 0
s_mul_i32 s70, s64, 393216
s_add_u32 m0, s65, s76
s_add_u32 s71, s70, s72
buffer_load_dwordx4 v12, s[12:15], s71 offen offset:0 lds
buffer_load_dwordx4 v13, s[12:15], s71 offen offset:1024 lds
buffer_load_dwordx4 v14, s[12:15], s71 offen offset:2048 lds
buffer_load_dwordx4 v15, s[12:15], s71 offen offset:3072 lds
buffer_load_dword v30, off, s[12:15], 0
s_add_u32 m0, m0, 4096
s_add_u32 s71, s70, s73
buffer_load_dwordx4 v12, s[12:15], s71 offen offset:0 lds
buffer_load_dwordx4 v13, s[12:15], s71 offen offset:1024 lds
buffer_load_dwordx4 v14, s[12:15], s71 offen offset:2048 lds
buffer_load_dwordx4 v15, s[12:15], s71 offen offset:3072 lds
buffer_load_dword v30, off, s[12:15], 0
s_add_u32 m0, m0, 4096
s_add_u32 s71, s70, s74
buffer_load_dwordx4 v12, s[12:15], s71 offen offset:0 lds
buffer_load_dwordx4 v13, s[12:15], s71 offen offset:1024 lds
buffer_load_dwordx4 v14, s[12:15], s71 offen offset:2048 lds
buffer_load_dwordx4 v15, s[12:15], s71 offen offset:3072 lds
buffer_load_dword v30, off, s[12:15], 0
s_xor_b32 s64, s64, s79
s_add_u32 s64, s64, 1
s_and_b32 s64, s64, 15
s_xor_b32 s64, s64, s79
s_sub_u32 s65, s65, 40960
s_cselect_b32 s65, 86016, s65
s_waitcnt vmcnt(50)
v_add_u32 v5, s34, 33
s_mov_b64 exec, 1
ds_write_b32 v3, v5
s_mov_b64 exec, -1
s_mov_b32 s36, s64
s_mov_b32 s37, s65
s_mov_b32 s64, s59
s_mov_b32 s65, 114688
s_mul_i32 s70, s64, 393216
s_add_u32 m0, s65, s76
s_add_u32 s71, s70, s72
buffer_load_dwordx4 v12, s[12:15], s71 offen offset:0 lds
buffer_load_dwordx4 v13, s[12:15], s71 offen offset:1024 lds
buffer_load_dwordx4 v14, s[12:15], s71 offen offset:2048 lds
buffer_load_dwordx4 v15, s[12:15], s71 offen offset:3072 lds
buffer_load_dword v30, off, s[12:15], 0
s_add_u32 m0, m0, 4096
s_add_u32 s71, s70, s73
buffer_load_dwordx4 v12, s[12:15], s71 offen offset:0 lds
buffer_load_dwordx4 v13, s[12:15], s71 offen offset:1024 lds
buffer_load_dwordx4 v14, s[12:15], s71 offen offset:2048 lds
buffer_load_dwordx4 v15, s[12:15], s71 offen offset:3072 lds
buffer_load_dword v30, off, s[12:15], 0
s_add_u32 m0, m0, 4096
s_add_u32 s71, s70, s74
buffer_load_dwordx4 v12, s[12:15], s71 offen offset:0 lds
buffer_load_dwordx4 v13, s[12:15], s71 offen offset:1024 lds
buffer_load_dwordx4 v14, s[12:15], s71 offen offset:2048 lds
buffer_load_dwordx4 v15, s[12:15], s71 offen offset:3072 lds
buffer_load_dword v30, off, s[12:15], 0
s_mov_b32 s64, s36
s_mov_b32 s65, s37
s_waitcnt vmcnt(40)
v_add_u32 v5, s34, 34
s_mov_b64 exec, 1
ds_write_b32 v3, v5
s_mov_b64 exec, -1
s_mov_b32 s63, 1
s_mov_b32 s34, 32
s_add_u32 s24, s24, 1409024
s_addc_u32 s25, s25, 0
s_mov_b32 s26, 1409024
s_mov_b32 s66, 32
s_branch lq_1
lcs_2:
s_add_u32 s35, s34, 1
lw_35:
ds_read_b32 v5, v2 offset:24
s_waitcnt lgkmcnt(0)
v_cmp_gt_i32 vcc, s35, v5
s_cbranch_vccz lwd_36
s_sub_u32 s32, s32, 1
s_cmp_gt_i32 s32, 0
s_cbranch_scc1 lw_35
lwd_36:
s_branch lcb_3
L_f:
v_lshlrev_b32 v4, 4, v0
s_lshl4_add_u32 s78, s59, s60
v_mov_b32 v252, 0
v_mov_b32 v253, 0
v_mov_b32 v254, 0
v_mov_b32 v255, 0
s_lshl_b32 s35, s78, 10
s_cmp_eq_u32 s58, 0
s_cselect_b64 exec, -1, 0
buffer_store_dwordx4 v[252:255], v4, s[24:27], s35 offen offset:0 sc1
s_add_u32 s35, s35, 262144
buffer_store_dwordx4 v[252:255], v4, s[24:27], s35 offen offset:0 sc1
s_mov_b64 exec, -1
s_setprio 3
v_and_b32 v1, 3, v0
v_lshlrev_b32 v1, 2, v1
v_and_b32 v2, 4, v1
s_lshl2_add_u32 s35, s58, 24
v_mov_b32 v3, s35
s_mov_b32 s4, s54
s_mov_b32 s5, s55
s_mov_b32 s6, 0x100
s_mov_b32 s7, 0x00020000
s_add_u32 s70, s60, 4
s_lshr_b32 s70, s70, 3
s_sub_u32 s70, s60, s70
s_lshl4_add_u32 s64, s70, s59
s_and_b32 s70, s60, 7
s_cmp_eq_u32 s70, 3
s_cselect_b32 s65, 1, 0
s_mov_b32 s69, 0x3f803f80
s_barrier
s_cmp_eq_u32 s58, 0
s_cselect_b32 s16, s46, s48
s_cselect_b32 s17, s47, s49
s_mov_b32 s12, s50
s_mov_b32 s13, s51
s_mov_b32 s14, 0x0
s_mov_b32 s15, 0x00020000
s_cmp_eq_u32 s65, 0
s_cselect_b32 s18, 7340032, 0
s_mov_b32 s14, s18
s_lshr_b32 s70, s64, 3
s_and_b32 s71, s64, 7
s_lshl_b32 s66, s70, 10
s_add_u32 s66, s66, s71
s_lshl1_add_u32 s66, s66, s58
s_lshl_b32 s66, s66, 7
s_mul_i32 s71, s71, 917504
s_lshl_b32 s70, s70, 8
s_add_u32 s77, s71, s70
s_mov_b32 s48, s38
s_mov_b32 s49, s39
s_mov_b32 s50, 0x600000
s_mov_b32 s51, 0x00020000
s_mov_b32 s52, 0
s_and_b32 s54, s60, 8
s_add_u32 s54, s54, 3
s_add_u32 s53, s54, s59
s_and_b32 s55, s60, 7
s_lshl1_add_u32 s55, s55, s58
s_mul_i32 s55, s55, 24576
s_lshl_b32 s54, s54, 7
s_add_u32 s56, s54, s55
s_add_u32 s56, s56, 60
s_and_b32 s73, s2, 3
s_lshl_b32 s73, s73, 6
v_mov_b32 v14, 1
s_sub_u32 exec_lo, 1, s58
s_mov_b32 exec_hi, 0
s_waitcnt vmcnt(0)
buffer_atomic_add v14, off, s[4:7], s73 sc1
s_mov_b64 exec, -1
v_mov_b32 v8, s69
v_mov_b32 v9, s69
v_mov_b32 v10, s69
v_mov_b32 v11, s69
v_mov_b32 v12, s69
v_mov_b32 v13, s69
v_mov_b32 v14, s69
v_mov_b32 v15, s69
s_mov_b32 s70, 102400
ftop_39:
v_lshrrev_b32 v6, 4, v0
v_bfe_u32 v7, v0, 2, 2
v_lshl_add_u32 v6, v6, 3, v7
v_bfe_u32 v7, v0, 3, 2
s_lshl_b32 s71, s58, 1
v_xor_b32 v7, s71, v7
v_lshl_add_u32 v7, v7, 5, s70
v_lshl_add_u32 v6, v6, 7, v7
v_lshl_add_u32 v6, v1, 1, v6
v_xor_b32 v7, 32, v6
s_mul_i32 s71, s63, 34
s_add_u32 s35, s71, 1
lw_40:
ds_read_b32 v5, v2 offset:16
s_waitcnt lgkmcnt(0)
v_cmp_gt_i32 vcc, s35, v5
s_cbranch_vccz lwd_41
s_sleep 1
s_sub_u32 s32, s32, 1
s_cmp_gt_i32 s32, 0
s_cbranch_scc1 lw_40
lwd_41:
ds_read_b64_tr_b16 v[24:25], v6 offset:0
ds_read_b64_tr_b16 v[26:27], v6 offset:512
ds_read_b64_tr_b16 v[28:29], v6 offset:4096
ds_read_b64_tr_b16 v[30:31], v6 offset:4608
ds_read_b64_tr_b16 v[32:33], v7 offset:0
ds_read_b64_tr_b16 v[34:35], v7 offset:512
ds_read_b64_tr_b16 v[36:37], v7 offset:4096
ds_read_b64_tr_b16 v[38:39], v7 offset:4608
ds_read_b64_tr_b16 v[40:41], v6 offset:8192
ds_read_b64_tr_b16 v[42:43], v6 offset:8704
ds_read_b64_tr_b16 v[44:45], v6 offset:12288
ds_read_b64_tr_b16 v[46:47], v6 offset:12800
ds_read_b64_tr_b16 v[48:49], v7 offset:8192
ds_read_b64_tr_b16 v[50:51], v7 offset:8704
ds_read_b64_tr_b16 v[52:53], v7 offset:12288
ds_read_b64_tr_b16 v[54:55], v7 offset:12800
s_lshl_b32 s72, s60, 14
s_lshl_b32 s70, s58, 9
s_add_u32 s72, s72, s70
s_lshl_b32 s70, s59, 10
s_add_u32 s71, s72, s70
s_lshl_b32 s76, s59, 14
s_add_u32 s73, s76, 30686208
s_add_u32 s76, s76, 266240
s_waitcnt lgkmcnt(14)
v_mfma_f32_16x16x32_bf16 v[248:251], v[8:11], v[24:27], 0
s_waitcnt lgkmcnt(10)
v_mfma_f32_16x16x32_bf16 v[252:255], v[8:11], v[32:35], 0
v_mfma_f32_16x16x32_bf16 v[248:251], v[12:15], v[28:31], v[248:251]
s_waitcnt lgkmcnt(8)
v_mfma_f32_16x16x32_bf16 v[252:255], v[12:15], v[36:39], v[252:255]
ds_read_b64_tr_b16 v[24:25], v6 offset:16384
ds_read_b64_tr_b16 v[26:27], v6 offset:16896
ds_read_b64_tr_b16 v[28:29], v6 offset:20480
ds_read_b64_tr_b16 v[30:31], v6 offset:20992
ds_read_b64_tr_b16 v[32:33], v7 offset:16384
ds_read_b64_tr_b16 v[34:35], v7 offset:16896
ds_read_b64_tr_b16 v[36:37], v7 offset:20480
ds_read_b64_tr_b16 v[38:39], v7 offset:20992
v_add_u32 v5, s34, 1
s_mov_b64 exec, 1
ds_write_b32 v3, v5
s_mov_b64 exec, -1
s_waitcnt lgkmcnt(14)
v_mfma_f32_16x16x32_bf16 v[16:19], v[8:11], v[40:43], 0
s_waitcnt lgkmcnt(11)
v_mfma_f32_16x16x32_bf16 v[20:23], v[8:11], v[48:51], 0
v_mfma_f32_16x16x32_bf16 v[16:19], v[12:15], v[44:47], v[16:19]
s_waitcnt lgkmcnt(9)
v_mfma_f32_16x16x32_bf16 v[20:23], v[12:15], v[52:55], v[20:23]
v_mov_b32 v249, v252
v_mov_b32 v252, s69
v_mov_b32 v253, s69
v_mov_b32 v254, s69
v_mov_b32 v255, s69
v_mfma_f32_16x16x32_bf16 v[52:55], v[8:11], v[8:11], 0
s_nop 0
v_mfma_f32_16x16x32_bf16 v[48:51], v[8:11], v[252:255], 0
v_mfma_f32_16x16x32_bf16 v[52:55], v[12:15], v[12:15], v[52:55]
v_mfma_f32_16x16x32_bf16 v[48:51], v[12:15], v[252:255], v[48:51]
s_waitcnt lgkmcnt(7)
v_mfma_f32_16x16x32_bf16 v[40:43], v[8:11], v[24:27], 0
s_waitcnt lgkmcnt(3)
v_mfma_f32_16x16x32_bf16 v[44:47], v[8:11], v[32:35], 0
v_mfma_f32_16x16x32_bf16 v[40:43], v[12:15], v[28:31], v[40:43]
s_waitcnt lgkmcnt(1)
v_mfma_f32_16x16x32_bf16 v[44:47], v[12:15], v[36:39], v[44:47]
v_lshlrev_b32 v6, 3, v0
v_and_b32 v7, 48, v0
v_mov_b32_dpp v248, v16 quad_perm:[0,1,2,3] row_mask:0x2 bank_mask:0xf
v_mov_b32_dpp v249, v20 quad_perm:[0,1,2,3] row_mask:0x2 bank_mask:0xf
s_nop 0
v_mov_b32_dpp v248, v48 quad_perm:[0,1,2,3] row_mask:0x8 bank_mask:0xf
v_mov_b32_dpp v249, v52 quad_perm:[0,1,2,3] row_mask:0x8 bank_mask:0xf
s_nop 0
v_mov_b32_dpp v248, v40 quad_perm:[0,1,2,3] row_mask:0x4 bank_mask:0xf
v_mov_b32_dpp v249, v44 quad_perm:[0,1,2,3] row_mask:0x4 bank_mask:0xf
v_max_u32 v248, 1, v248
v_max_u32 v249, 1, v249
s_cmp_eq_u32 s63, 0
s_cbranch_scc1 fst_37
fsb_38:
buffer_store_dwordx2 v[248:249], v6, s[24:27], s71 offen sc1
s_lshl4_add_u32 s70, s58, s60
s_add_u32 s70, s70, s34
s_cmp_eq_u32 s70, 51
s_cbranch_scc1 fxt_42
fxb_43:
s_add_u32 s73, s72, 4096
s_add_u32 s74, s72, 8192
s_add_u32 s75, s72, 12288
v_lshrrev_b32 v7, 2, v0
v_lshlrev_b32 v7, 7, v7
v_lshl_add_u32 v7, v1, 2, v7
v_lshrrev_b32 v8, 5, v0
v_lshrrev_b32 v9, 4, v0
v_xor_b32 v10, v8, v9
v_and_b32 v10, 1, v10
v_lshl_add_u32 v8, v10, 1, v8
v_and_b32 v10, 15, v0
v_lshlrev_b32 v8, 7, v8
v_lshl_add_u32 v8, v10, 3, v8
v_add_u32 v8, 1280, v8
s_mul_i32 s70, s58, 384
s_lshl_b32 s71, s63, 10
s_add_u32 s70, s70, s71
s_add_u32 s70, s70, 2304
v_lshl_add_u32 v9, v9, 7, s70
v_lshl_add_u32 v9, v10, 2, v9
s_cmp_eq_u32 s63, 0
s_cbranch_scc1 fg_44
fg_45:
poll_46:
buffer_load_dwordx4 v[12:15], v7, s[24:27], s76 offen sc1
pchk_47:
s_waitcnt vmcnt(0)
v_min3_u32 v10, v12, v13, v14
v_min_u32 v10, v10, v15
v_cmp_eq_u32 vcc, 0, v10
s_cbranch_vccz pdone_48
s_sub_u32 s32, s32, 1
s_cmp_gt_i32 s32, 0
s_cbranch_scc1 poll_46
pdone_48:
s_lshr_b32 s70, s33, 7
s_sub_u32 s70, s70, s59
s_mul_i32 s70, s70, s63
s_cmp_eq_u32 s70, 0
s_cbranch_scc0 fng_49
s_lshl1_add_u32 s70, s34, -32
s_add_u32 s35, s70, 15
lw_50:
ds_read_b32 v5, v2 offset:16
s_waitcnt lgkmcnt(0)
v_cmp_gt_i32 vcc, s35, v5
s_cbranch_vccz lwd_51
s_sleep 4
s_sub_u32 s32, s32, 1
s_cmp_gt_i32 s32, 0
s_cbranch_scc1 lw_50
lwd_51:
poll_52:
buffer_load_dwordx2 v[24:25], v6, s[24:27], s72 offen offset:0 sc1
buffer_load_dwordx2 v[26:27], v6, s[24:27], s72 offen offset:1024 sc1
buffer_load_dwordx2 v[28:29], v6, s[24:27], s72 offen offset:2048 sc1
buffer_load_dwordx2 v[30:31], v6, s[24:27], s72 offen offset:3072 sc1
buffer_load_dwordx2 v[32:33], v6, s[24:27], s73 offen offset:0 sc1
buffer_load_dwordx2 v[34:35], v6, s[24:27], s73 offen offset:1024 sc1
buffer_load_dwordx2 v[36:37], v6, s[24:27], s73 offen offset:2048 sc1
buffer_load_dwordx2 v[38:39], v6, s[24:27], s73 offen offset:3072 sc1
buffer_load_dwordx2 v[40:41], v6, s[24:27], s74 offen offset:0 sc1
buffer_load_dwordx2 v[42:43], v6, s[24:27], s74 offen offset:1024 sc1
buffer_load_dwordx2 v[44:45], v6, s[24:27], s74 offen offset:2048 sc1
buffer_load_dwordx2 v[46:47], v6, s[24:27], s74 offen offset:3072 sc1
buffer_load_dwordx2 v[48:49], v6, s[24:27], s75 offen offset:0 sc1
buffer_load_dwordx2 v[50:51], v6, s[24:27], s75 offen offset:1024 sc1
buffer_load_dwordx2 v[52:53], v6, s[24:27], s75 offen offset:2048 sc1
buffer_load_dwordx2 v[54:55], v6, s[24:27], s75 offen offset:3072 sc1
pchk_53:
s_waitcnt vmcnt(14)
v_min3_u32 v10, v24, v25, v26
s_waitcnt vmcnt(13)
v_min3_u32 v10, v10, v27, v28
s_waitcnt vmcnt(12)
v_min3_u32 v10, v10, v29, v30
s_waitcnt vmcnt(11)
v_min3_u32 v10, v10, v31, v32
s_waitcnt vmcnt(10)
v_min3_u32 v10, v10, v33, v34
s_waitcnt vmcnt(9)
v_min3_u32 v10, v10, v35, v36
s_waitcnt vmcnt(8)
v_min3_u32 v10, v10, v37, v38
s_waitcnt vmcnt(7)
v_min3_u32 v10, v10, v39, v40
s_waitcnt vmcnt(6)
v_min3_u32 v10, v10, v41, v42
s_waitcnt vmcnt(5)
v_min3_u32 v10, v10, v43, v44
s_waitcnt vmcnt(4)
v_min3_u32 v10, v10, v45, v46
s_waitcnt vmcnt(3)
v_min3_u32 v10, v10, v47, v48
s_waitcnt vmcnt(2)
v_min3_u32 v10, v10, v49, v50
s_waitcnt vmcnt(1)
v_min3_u32 v10, v10, v51, v52
s_waitcnt vmcnt(0)
v_min3_u32 v10, v10, v53, v54
v_min_u32 v10, v10, v55
v_cmp_eq_u32 vcc, 0, v10
s_cbranch_vccz pdone_54
s_sub_u32 s32, s32, 1
s_cmp_gt_i32 s32, 0
s_cbranch_scc1 poll_52
pdone_54:
v_add_f32 v24, v24, v40
v_add_f32 v25, v25, v41
v_add_f32 v26, v26, v42
v_add_f32 v27, v27, v43
v_add_f32 v28, v28, v44
v_add_f32 v29, v29, v45
v_add_f32 v30, v30, v46
v_add_f32 v31, v31, v47
v_add_f32 v32, v32, v48
v_add_f32 v33, v33, v49
v_add_f32 v34, v34, v50
v_add_f32 v35, v35, v51
v_add_f32 v36, v36, v52
v_add_f32 v37, v37, v53
v_add_f32 v38, v38, v54
v_add_f32 v39, v39, v55
v_add_f32 v24, v24, v32
v_add_f32 v25, v25, v33
v_add_f32 v26, v26, v34
v_add_f32 v27, v27, v35
v_add_f32 v28, v28, v36
v_add_f32 v29, v29, v37
v_add_f32 v30, v30, v38
v_add_f32 v31, v31, v39
v_add_f32 v24, v24, v28
v_add_f32 v25, v25, v29
v_add_f32 v26, v26, v30
v_add_f32 v27, v27, v31
v_add_f32 v24, v24, v26
v_add_f32 v25, v25, v27
s_mov_b32 exec_hi, 0xffff
ds_write2_b32 v9, v24, v25 offset1:16
s_mov_b32 exec_hi, -1
v_mul_f32 v5, 0xba800000, v24
v_mul_f32 v25, 0x3a800000, v25
v_fma_f32 v25, -v5, v5, v25
v_max_f32 v25, 0, v25
v_add_f32 v25, 0x3727c5ac, v25
v_rsq_f32 v24, v25
s_nop 0
v_mul_f32 v25, v5, v24
s_lshl_b32 s70, s59, 7
s_sub_u32 s70, s33, s70
v_lshlrev_b32 v10, 1, v0
v_sub_u32 v10, s70, v10
v_readlane_b32 s70, v24, 48
v_readlane_b32 s71, v25, 48
v_cmp_eq_u32 vcc, 0, v10
s_mov_b64 exec, vcc
v_mov_b32 v12, s70
v_mov_b32 v13, s71
s_mov_b64 exec, -1
v_cmp_eq_u32 vcc, 1, v10
s_mov_b64 exec, vcc
v_mov_b32 v14, s70
v_mov_b32 v15, s71
s_mov_b64 exec, -1
fng_49:
ds_write2_b32 v8, v12, v14 offset1:1
ds_write2_b32 v8, v13, v15 offset0:128 offset1:129
s_add_u32 s71, s34, s63
v_add_u32 v5, s71, 2
s_mov_b64 exec, 1
ds_write_b32 v3, v5
s_mov_b64 exec, -1
s_setprio 0
s_cmp_eq_u32 s63, 0
s_cbranch_scc1 fnw_55
fnw_56:
s_and_b32 s70, s64, 7
s_lshl_b32 s70, s70, 7
s_add_u32 s73, s70, 276480
s_lshl1_add_u32 s72, s70, 272384
s_lshr_b32 s71, s64, 3
s_lshl_b32 s76, s71, 13
s_add_u32 s76, s76, 1048576
s_lshl2_add_u32 s74, s70, s76
s_lshl_b32 s70, s58, 8
s_add_u32 s74, s74, s70
s_add_u32 s75, s74, 4096
s_lshl4_add_u32 s76, s70, s76
v_and_b32 v251, 15, v0
v_lshlrev_b32 v6, 14, v251
v_lshrrev_b32 v252, 4, v0
v_lshl_add_u32 v7, v252, 5, v6
v_lshlrev_b32 v251, 4, v251
s_lshl_b32 s70, s58, 3
v_lshl_add_u32 v253, v252, 1, s70
v_add_u32 v253, v253, v251
v_lshlrev_b32 v254, 5, v252
v_lshl_add_u32 v254, v2, 2, v254
v_and_b32 v255, 7, v0
v_lshl_add_u32 v255, v255, 2, v252
v_lshlrev_b32 v255, 3, v255
s_add_u32 s35, s34, 22
lw_57:
ds_read_b32 v5, v1 offset:0
s_waitcnt lgkmcnt(0)
v_cmp_gt_i32 vcc, s35, v5
s_cbranch_vccz lwd_58
s_sleep 4
s_sub_u32 s32, s32, 1
s_cmp_gt_i32 s32, 0
s_cbranch_scc1 lw_57
lwd_58:
s_setprio 3
s_add_u32 s35, s34, 24
lw_59:
ds_read_b32 v5, v1 offset:0
s_waitcnt lgkmcnt(0)
v_cmp_gt_i32 vcc, s35, v5
s_cbranch_vccz lwd_60
s_sleep 2
s_sub_u32 s32, s32, 1
s_cmp_gt_i32 s32, 0
s_cbranch_scc1 lw_59
lwd_60:
s_mul_i32 s79, s63, 64
s_sub_u32 s79, 32, s79
s_add_u32 s35, s79, 3
tw_61:
ds_read_b32 v5, v2 offset:16
s_waitcnt lgkmcnt(0)
v_cmp_gt_i32 vcc, s35, v5
s_cbranch_vccz twd_62
v_readfirstlane_b32 s54, v5
s_sub_u32 s55, s35, s54
s_cmp_lt_i32 s55, 2
s_cbranch_scc1 tws_63
s_add_u32 s54, s54, 2
s_or_b32 s54, s54, 1
s_cmp_eq_u32 s54, s52
s_cbranch_scc1 tws_63
s_bitcmp1_b32 s54, 4
s_cbranch_scc1 tws_63
s_mov_b32 s52, s54
s_add_u32 s54, s54, s53
s_and_b32 s54, s54, 15
s_mul_i32 s54, s54, 393216
s_add_u32 s54, s54, s56
s_buffer_load_dwordx2 s[46:47], s[48:51], s54 offset:4096
s_buffer_load_dwordx2 s[46:47], s[48:51], s54 offset:10240
s_buffer_load_dwordx2 s[46:47], s[48:51], s54 offset:16384
s_buffer_load_dwordx2 s[46:47], s[48:51], s54 offset:22528
tws_63:
s_sleep 4
s_sub_u32 s32, s32, 1
s_cmp_gt_i32 s32, 0
s_cbranch_scc1 tw_61
twd_62:
s_cmp_eq_u32 s65, 0
s_cbranch_scc0 fnd_65
poll_66:
buffer_load_dwordx2 v[248:249], v6, s[24:27], s73 offen sc1
buffer_load_dwordx4 v[8:11], v7, s[24:27], s72 offen offset:0 sc1
buffer_load_dwordx4 v[12:15], v7, s[24:27], s72 offen offset:16 sc1
buffer_load_dwordx4 v[16:19], v7, s[24:27], s72 offen offset:128 sc1
buffer_load_dwordx4 v[20:23], v7, s[24:27], s72 offen offset:144 sc1
pchk_67:
s_waitcnt vmcnt(3)
v_min3_u32 v5, v248, v249, v8
v_min3_u32 v5, v5, v9, v10
s_waitcnt vmcnt(2)
v_min3_u32 v5, v5, v11, v12
v_min3_u32 v5, v5, v13, v14
s_waitcnt vmcnt(1)
v_min3_u32 v5, v5, v15, v16
v_min3_u32 v5, v5, v17, v18
s_waitcnt vmcnt(0)
v_min3_u32 v5, v5, v19, v20
v_min3_u32 v5, v5, v21, v22
v_min_u32 v5, v5, v23
v_cmp_eq_u32 vcc, 0, v5
s_cbranch_vccz pdone_68
s_sub_u32 s32, s32, 1
s_cmp_gt_i32 s32, 0
s_cbranch_scc1 poll_66
pdone_68:
v_mfma_f32_16x16x32_bf16 v[24:27], v[8:11], v[56:59], 0
v_mov_b32 v250, v248
v_mfma_f32_16x16x32_bf16 v[28:31], v[8:11], v[60:63], 0
s_nop 0
v_max_f32_dpp v250, v250, v250 row_ror:1 row_mask:0xf bank_mask:0xf
v_mfma_f32_16x16x32_bf16 v[32:35], v[8:11], v[64:67], 0
s_nop 0
v_max_f32_dpp v250, v250, v250 row_ror:2 row_mask:0xf bank_mask:0xf
v_mfma_f32_16x16x32_bf16 v[36:39], v[8:11], v[68:71], 0
s_nop 0
v_max_f32_dpp v250, v250, v250 row_ror:4 row_mask:0xf bank_mask:0xf
v_mfma_f32_16x16x32_bf16 v[40:43], v[8:11], v[72:75], 0
s_nop 0
v_max_f32_dpp v250, v250, v250 row_ror:8 row_mask:0xf bank_mask:0xf
v_mfma_f32_16x16x32_bf16 v[44:47], v[8:11], v[76:79], 0
v_cmp_eq_f32 vcc, v250, v248
v_mfma_f32_16x16x32_bf16 v[48:51], v[8:11], v[80:83], 0
s_ff1_i32_b64 s68, vcc
v_mfma_f32_16x16x32_bf16 v[52:55], v[8:11], v[84:87], 0
s_and_b32 s68, s68, 15
v_mfma_f32_16x16x32_bf16 v[24:27], v[12:15], v[88:91], v[24:27]
v_readlane_b32 s33, v249, s68
v_mfma_f32_16x16x32_bf16 v[28:31], v[12:15], v[92:95], v[28:31]
v_readlane_b32 s67, v248, s68
v_mfma_f32_16x16x32_bf16 v[32:35], v[12:15], v[96:99], v[32:35]
v_add_u32 v5, s34, 4
v_mfma_f32_16x16x32_bf16 v[36:39], v[12:15], v[100:103], v[36:39]
v_mov_b32 v250, s33
v_mfma_f32_16x16x32_bf16 v[40:43], v[12:15], v[104:107], v[40:43]
s_mov_b64 exec, 1
ds_write2_b32 v3, v5, v250 offset1:2
s_mov_b64 exec, -1
v_mfma_f32_16x16x32_bf16 v[44:47], v[12:15], v[108:111], v[44:47]
s_sub_u32 s33, s33, 1
v_mfma_f32_16x16x32_bf16 v[48:51], v[12:15], v[112:115], v[48:51]
s_and_b32 s33, s33, 2047
v_mfma_f32_16x16x32_bf16 v[52:55], v[12:15], v[116:119], v[52:55]
v_mfma_f32_16x16x32_bf16 v[24:27], v[16:19], v[120:123], v[24:27]
v_mfma_f32_16x16x32_bf16 v[28:31], v[16:19], v[124:127], v[28:31]
v_mfma_f32_16x16x32_bf16 v[32:35], v[16:19], v[128:131], v[32:35]
v_mfma_f32_16x16x32_bf16 v[36:39], v[16:19], v[132:135], v[36:39]
v_mfma_f32_16x16x32_bf16 v[40:43], v[16:19], v[136:139], v[40:43]
v_mfma_f32_16x16x32_bf16 v[44:47], v[16:19], v[140:143], v[44:47]
v_mfma_f32_16x16x32_bf16 v[48:51], v[16:19], v[144:147], v[48:51]
v_mfma_f32_16x16x32_bf16 v[52:55], v[16:19], v[148:151], v[52:55]
v_mfma_f32_16x16x32_bf16 v[24:27], v[20:23], v[152:155], v[24:27]
s_and_b32 s70, s68, 12
s_lshl_b32 s70, s70, 2
s_bitcmp1_b32 s68, 1
v_mfma_f32_16x16x32_bf16 v[28:31], v[20:23], v[156:159], v[28:31]
v_mfma_f32_16x16x32_bf16 v[32:35], v[20:23], v[160:163], v[32:35]
v_mfma_f32_16x16x32_bf16 v[36:39], v[20:23], v[164:167], v[36:39]
v_mfma_f32_16x16x32_bf16 v[40:43], v[20:23], v[168:171], v[40:43]
v_mfma_f32_16x16x32_bf16 v[44:47], v[20:23], v[172:175], v[44:47]
v_mfma_f32_16x16x32_bf16 v[48:51], v[20:23], v[176:179], v[48:51]
v_mfma_f32_16x16x32_bf16 v[52:55], v[20:23], v[180:183], v[52:55]
s_cbranch_scc1 fsel_71
fsel_69:
s_bitcmp1_b32 s68, 0
s_cbranch_scc1 fsel_70
v_max_u32 v8, 1, v24
v_max_u32 v9, 1, v28
v_max_u32 v10, 1, v32
v_max_u32 v11, 1, v36
v_max_u32 v12, 1, v40
v_max_u32 v13, 1, v44
v_max_u32 v14, 1, v48
v_max_u32 v15, 1, v52
s_branch fsel_73
fsel_70:
v_max_u32 v8, 1, v25
v_max_u32 v9, 1, v29
v_max_u32 v10, 1, v33
v_max_u32 v11, 1, v37
v_max_u32 v12, 1, v41
v_max_u32 v13, 1, v45
v_max_u32 v14, 1, v49
v_max_u32 v15, 1, v53
s_branch fsel_73
fsel_71:
s_bitcmp1_b32 s68, 0
s_cbranch_scc1 fsel_72
v_max_u32 v8, 1, v26
v_max_u32 v9, 1, v30
v_max_u32 v10, 1, v34
v_max_u32 v11, 1, v38
v_max_u32 v12, 1, v42
v_max_u32 v13, 1, v46
v_max_u32 v14, 1, v50
v_max_u32 v15, 1, v54
s_branch fsel_73
fsel_72:
v_max_u32 v8, 1, v27
v_max_u32 v9, 1, v31
v_max_u32 v10, 1, v35
v_max_u32 v11, 1, v39
v_max_u32 v12, 1, v43
v_max_u32 v13, 1, v47
v_max_u32 v14, 1, v51
v_max_u32 v15, 1, v55
fsel_73:
s_bfm_b64 exec, 16, s70
buffer_store_dwordx4 v[8:11], v251, s[24:27], s74 offen sc1
buffer_store_dwordx4 v[12:15], v251, s[24:27], s75 offen sc1
s_mov_b64 exec, -1
s_and_b32 s70, s64, 7
s_lshl1_add_u32 s70, s70, s58
s_mul_i32 s70, s70, 28
s_add_u32 s70, s70, s71
s_lshl_b32 s70, s70, 8
s_add_u32 s70, s70, 1277952
s_waitcnt vmcnt(0)
s_mul_i32 s79, s63, 64
s_sub_u32 s79, 32, s79
s_add_u32 s35, s79, 7
tw_74:
ds_read_b32 v5, v2 offset:16
s_waitcnt lgkmcnt(0)
v_cmp_gt_i32 vcc, s35, v5
s_cbranch_vccz twd_75
v_readfirstlane_b32 s54, v5
s_sub_u32 s55, s35, s54
s_cmp_lt_i32 s55, 2
s_cbranch_scc1 tws_76
s_add_u32 s54, s54, 2
s_or_b32 s54, s54, 1
s_cmp_eq_u32 s54, s52
s_cbranch_scc1 tws_76
s_bitcmp1_b32 s54, 4
s_cbranch_scc1 tws_76
s_mov_b32 s52, s54
s_add_u32 s54, s54, s53
s_and_b32 s54, s54, 15
s_mul_i32 s54, s54, 393216
s_add_u32 s54, s54, s56
s_buffer_load_dwordx2 s[46:47], s[48:51], s54 offset:4096
s_buffer_load_dwordx2 s[46:47], s[48:51], s54 offset:10240
s_buffer_load_dwordx2 s[46:47], s[48:51], s54 offset:16384
s_buffer_load_dwordx2 s[46:47], s[48:51], s54 offset:22528
tws_76:
s_sleep 4
s_sub_u32 s32, s32, 1
s_cmp_gt_i32 s32, 0
s_cbranch_scc1 tw_74
twd_75:
poll_77:
buffer_load_dwordx4 v[24:27], v4, s[24:27], s76 offen offset:0 sc1
buffer_load_dwordx4 v[28:31], v4, s[24:27], s76 offen offset:1024 sc1
buffer_load_dwordx4 v[32:35], v4, s[24:27], s76 offen offset:2048 sc1
buffer_load_dwordx4 v[36:39], v4, s[24:27], s76 offen offset:3072 sc1
pchk_78:
s_waitcnt vmcnt(3)
v_min3_u32 v5, v24, v25, v26
s_waitcnt vmcnt(2)
v_min3_u32 v5, v5, v27, v28
v_min3_u32 v5, v5, v29, v30
s_waitcnt vmcnt(1)
v_min3_u32 v5, v5, v31, v32
v_min3_u32 v5, v5, v33, v34
s_waitcnt vmcnt(0)
v_min3_u32 v5, v5, v35, v36
v_min3_u32 v5, v5, v37, v38
v_min_u32 v5, v5, v39
v_cmp_eq_u32 vcc, 0, v5
s_cbranch_vccz pdone_79
s_sub_u32 s32, s32, 1
s_cmp_gt_i32 s32, 0
s_cbranch_scc1 poll_77
pdone_79:
v_add_f32 v24, v24, v32
v_add_f32 v25, v25, v33
v_add_f32 v26, v26, v34
v_add_f32 v27, v27, v35
v_add_f32 v28, v28, v36
v_add_f32 v29, v29, v37
v_add_f32 v30, v30, v38
v_add_f32 v31, v31, v39
v_add_f32 v24, v24, v28
v_add_f32 v25, v25, v29
v_add_f32 v26, v26, v30
v_add_f32 v27, v27, v31
s_nop 0
v_permlane32_swap_b32 v24, v26
v_permlane32_swap_b32 v25, v27
v_add_f32 v24, v24, v26
v_add_f32 v25, v25, v27
s_nop 1
v_permlane16_swap_b32 v24, v25
v_mul_f32 v26, 0xbfb8aa3b, v24
v_exp_f32 v26, v26
v_mul_f32 v24, v24, v25
v_add_f32 v26, 1.0, v26
v_rcp_f32 v26, v26
v_add_u32 v5, s34, 5
v_mul_f32 v24, v24, v26
v_cvt_pk_bf16_f32 v24, v24, v24
ds_write_b16 v253, v24 offset:512
s_mov_b64 exec, 1
ds_write_b32 v3, v5
s_mov_b64 exec, -1
s_add_u32 s35, s34, 5
poll_80:
ds_read_b32 v5, v2 offset:24
ds_read_b128 v[8:11], v254 offset:512
ds_read_b128 v[12:15], v254 offset:640
pchk_81:
s_waitcnt lgkmcnt(2)
v_cmp_gt_i32 vcc, s35, v5
s_cbranch_vccz pdone_82
s_sleep 1
s_sub_u32 s32, s32, 1
s_cmp_gt_i32 s32, 0
s_cbranch_scc1 poll_80
pdone_82:
s_waitcnt lgkmcnt(1)
v_mfma_f32_16x16x32_bf16 v[24:27], v[8:11], v[184:187], 0
v_mfma_f32_16x16x32_bf16 v[28:31], v[8:11], v[188:191], 0
v_mfma_f32_16x16x32_bf16 v[32:35], v[8:11], v[192:195], 0
v_mfma_f32_16x16x32_bf16 v[36:39], v[8:11], v[196:199], 0
v_mfma_f32_16x16x32_bf16 v[40:43], v[8:11], v[200:203], 0
v_mfma_f32_16x16x32_bf16 v[44:47], v[8:11], v[204:207], 0
v_mfma_f32_16x16x32_bf16 v[48:51], v[8:11], v[208:211], 0
v_mfma_f32_16x16x32_bf16 v[52:55], v[8:11], v[212:215], 0
s_waitcnt lgkmcnt(0)
v_mfma_f32_16x16x32_bf16 v[24:27], v[12:15], v[216:219], v[24:27]
v_mfma_f32_16x16x32_bf16 v[28:31], v[12:15], v[220:223], v[28:31]
v_mfma_f32_16x16x32_bf16 v[32:35], v[12:15], v[224:227], v[32:35]
v_mfma_f32_16x16x32_bf16 v[36:39], v[12:15], v[228:231], v[36:39]
v_mfma_f32_16x16x32_bf16 v[40:43], v[12:15], v[232:235], v[40:43]
v_mfma_f32_16x16x32_bf16 v[44:47], v[12:15], v[236:239], v[44:47]
v_mfma_f32_16x16x32_bf16 v[48:51], v[12:15], v[240:243], v[48:51]
v_mfma_f32_16x16x32_bf16 v[52:55], v[12:15], v[244:247], v[52:55]
s_nop 0
v_add_f32_dpp v16, v25, v24 row_ror:8 row_mask:0x1 bank_mask:0xf
v_add_f32_dpp v17, v29, v28 row_ror:8 row_mask:0x1 bank_mask:0xf
s_nop 0
v_add_f32_dpp v16, v33, v32 row_ror:8 row_mask:0x2 bank_mask:0xf
v_add_f32_dpp v17, v37, v36 row_ror:8 row_mask:0x2 bank_mask:0xf
s_nop 0
v_add_f32_dpp v16, v41, v40 row_ror:8 row_mask:0x4 bank_mask:0xf
v_add_f32_dpp v17, v45, v44 row_ror:8 row_mask:0x4 bank_mask:0xf
s_nop 0
v_add_f32_dpp v16, v49, v48 row_ror:8 row_mask:0x8 bank_mask:0xf
v_add_f32_dpp v17, v53, v52 row_ror:8 row_mask:0x8 bank_mask:0xf
v_max_u32 v16, 1, v16
v_max_u32 v17, 1, v17
s_mov_b32 exec_lo, 0x00ff00ff
s_mov_b32 exec_hi, 0x00ff00ff
buffer_store_dwordx2 v[16:17], v255, s[24:27], s70 offen sc1
s_mov_b64 exec, -1
fnd_64:
s_sub_u32 s70, s60, 3
s_mul_i32 s70, s70, s63
s_or_b32 s70, s70, s58
s_cbranch_scc1 fnr_83
s_mul_i32 s72, s59, 7168
s_add_u32 s72, s72, 1277952
s_add_u32 s73, s72, 4096
s_lshl_b32 s70, s68, 6
s_add_u32 s70, s70, s59
s_lshl_b32 s70, s70, 8
s_add_u32 s76, s70, 262144
v_mov_b32 v12, s67
v_mul_f32 v12, 0xbfb8aa3b, v12
v_exp_f32 v12, v12
v_lshl_add_u32 v6, v252, 2, v251
v_add_f32 v12, 1.0, v12
v_rcp_f32 v12, v12
v_lshrrev_b32 v7, 1, v6
s_lshl4_add_u32 s70, s33, s59
s_lshl_b32 s70, s70, 7
v_and_b32 v8, 0x46, v7
v_lshl_add_u32 v8, v1, 2, v8
v_and_b32 v9, 4, v0
v_lshl_add_u32 v8, v9, 1, v8
s_waitcnt vmcnt(0)
s_cmp_gt_u32 s65, s63
s_cbranch_scc1 fpre_85
fpre_86:
s_mul_i32 s79, s63, 64
s_sub_u32 s79, 32, s79
s_add_u32 s35, s79, 11
tw_87:
ds_read_b32 v5, v2 offset:16
s_waitcnt lgkmcnt(0)
v_cmp_gt_i32 vcc, s35, v5
s_cbranch_vccz twd_88
v_readfirstlane_b32 s54, v5
s_sub_u32 s55, s35, s54
s_cmp_lt_i32 s55, 2
s_cbranch_scc1 tws_89
s_add_u32 s54, s54, 2
s_or_b32 s54, s54, 1
s_cmp_eq_u32 s54, s52
s_cbranch_scc1 tws_89
s_bitcmp1_b32 s54, 4
s_cbranch_scc1 tws_89
s_mov_b32 s52, s54
s_add_u32 s54, s54, s53
s_and_b32 s54, s54, 15
s_mul_i32 s54, s54, 393216
s_add_u32 s54, s54, s56
s_buffer_load_dwordx2 s[46:47], s[48:51], s54 offset:4096
s_buffer_load_dwordx2 s[46:47], s[48:51], s54 offset:10240
s_buffer_load_dwordx2 s[46:47], s[48:51], s54 offset:16384
s_buffer_load_dwordx2 s[46:47], s[48:51], s54 offset:22528
tws_89:
s_sleep 4
s_sub_u32 s32, s32, 1
s_cmp_gt_i32 s32, 0
s_cbranch_scc1 tw_87
twd_88:
poll_90:
buffer_load_dword v52, v6, s[24:27], s76 offen sc1
buffer_load_dwordx4 v[24:27], v4, s[24:27], s72 offen offset:0 sc1
buffer_load_dwordx4 v[28:31], v4, s[24:27], s72 offen offset:1024 sc1
buffer_load_dwordx4 v[32:35], v4, s[24:27], s72 offen offset:2048 sc1
buffer_load_dwordx4 v[36:39], v4, s[24:27], s72 offen offset:3072 sc1
buffer_load_dwordx4 v[40:43], v4, s[24:27], s73 offen offset:0 sc1
buffer_load_dwordx4 v[44:47], v4, s[24:27], s73 offen offset:1024 sc1
buffer_load_dwordx4 v[48:51], v4, s[24:27], s73 offen offset:2048 sc1
pchk_91:
s_waitcnt vmcnt(6)
v_min3_u32 v5, v24, v25, v26
s_waitcnt vmcnt(5)
v_min3_u32 v5, v5, v27, v28
v_min3_u32 v5, v5, v29, v30
s_waitcnt vmcnt(4)
v_min3_u32 v5, v5, v31, v32
v_min3_u32 v5, v5, v33, v34
s_waitcnt vmcnt(3)
v_min3_u32 v5, v5, v35, v36
v_min3_u32 v5, v5, v37, v38
s_waitcnt vmcnt(2)
v_min3_u32 v5, v5, v39, v40
v_min3_u32 v5, v5, v41, v42
s_waitcnt vmcnt(1)
v_min3_u32 v5, v5, v43, v44
v_min3_u32 v5, v5, v45, v46
s_waitcnt vmcnt(0)
v_min3_u32 v5, v5, v47, v48
v_min3_u32 v5, v5, v49, v50
v_min3_u32 v5, v5, v51, v52
v_cmp_eq_u32 vcc, 0, v5
s_cbranch_vccz pdone_92
s_sub_u32 s32, s32, 1
s_cmp_gt_i32 s32, 0
s_cbranch_scc1 poll_90
pdone_92:
v_add_f32 v24, v24, v40
v_add_f32 v25, v25, v41
v_add_f32 v26, v26, v42
v_add_f32 v27, v27, v43
v_add_f32 v28, v28, v44
v_add_f32 v29, v29, v45
v_add_f32 v30, v30, v46
v_add_f32 v31, v31, v47
v_add_f32 v32, v32, v48
v_add_f32 v33, v33, v49
v_add_f32 v34, v34, v50
v_add_f32 v35, v35, v51
v_add_f32 v24, v24, v32
v_add_f32 v25, v25, v33
v_add_f32 v26, v26, v34
v_add_f32 v27, v27, v35
v_add_f32 v28, v28, v36
v_add_f32 v29, v29, v37
v_add_f32 v30, v30, v38
v_add_f32 v31, v31, v39
v_add_f32 v24, v24, v28
v_add_f32 v25, v25, v29
v_add_f32 v26, v26, v30
v_add_f32 v27, v27, v31
s_nop 0
v_permlane32_swap_b32 v24, v26
v_permlane32_swap_b32 v25, v27
v_add_f32 v24, v24, v26
v_add_f32 v25, v25, v27
s_nop 1
v_permlane16_swap_b32 v24, v25
v_add_f32 v24, v24, v25
v_fma_f32 v24, v24, v12, v52
v_cvt_pk_bf16_f32 v24, v24, v24
s_cmp_eq_u32 s63, 0
s_cbranch_scc1 fl0_84
buffer_store_short v24, v7, s[28:31], s70 offen
s_branch L_end
fl0_84:
ds_write_b16 v8, v24 offset:384
fnr_83:
s_cmp_eq_u32 s63, 0
s_cbranch_scc0 L_end
v_add_u32 v5, s34, 6
s_mov_b64 exec, 1
ds_write_b32 v3, v5
s_mov_b64 exec, -1
s_mul_i32 s79, s63, 64
s_sub_u32 s79, 32, s79
s_add_u32 s35, s79, 11
tw_93:
ds_read_b32 v5, v2 offset:16
s_waitcnt lgkmcnt(0)
v_cmp_gt_i32 vcc, s35, v5
s_cbranch_vccz twd_94
v_readfirstlane_b32 s54, v5
s_sub_u32 s55, s35, s54
s_cmp_lt_i32 s55, 2
s_cbranch_scc1 tws_95
s_add_u32 s54, s54, 2
s_or_b32 s54, s54, 1
s_cmp_eq_u32 s54, s52
s_cbranch_scc1 tws_95
s_bitcmp1_b32 s54, 4
s_cbranch_scc1 tws_95
s_mov_b32 s52, s54
s_add_u32 s54, s54, s53
s_and_b32 s54, s54, 15
s_mul_i32 s54, s54, 393216
s_add_u32 s54, s54, s56
s_buffer_load_dwordx2 s[46:47], s[48:51], s54 offset:4096
s_buffer_load_dwordx2 s[46:47], s[48:51], s54 offset:10240
s_buffer_load_dwordx2 s[46:47], s[48:51], s54 offset:16384
s_buffer_load_dwordx2 s[46:47], s[48:51], s54 offset:22528
tws_95:
s_sleep 4
s_sub_u32 s32, s32, 1
s_cmp_gt_i32 s32, 0
s_cbranch_scc1 tw_93
twd_94:
v_and_b32 v6, 48, v0
s_add_u32 s35, s34, 6
poll_96:
ds_read_b32 v5, v2 offset:24
ds_read_b128 v[8:11], v6 offset:384
ds_read_b128 v[12:15], v6 offset:448
pchk_97:
s_waitcnt lgkmcnt(2)
v_cmp_gt_i32 vcc, s35, v5
s_cbranch_vccz pdone_98
s_sleep 1
s_sub_u32 s32, s32, 1
s_cmp_gt_i32 s32, 0
s_cbranch_scc1 poll_96
pdone_98:
s_mov_b32 s63, 1
s_mov_b32 s34, 32
s_add_u32 s24, s24, 1409024
s_addc_u32 s25, s25, 0
s_mov_b32 s26, 1409024
s_mov_b32 s70, 131072
s_mov_b32 s79, 34
s_branch ftop_39
fxt_42:
v_max_u32 v8, 1, v8
v_max_u32 v9, 1, v9
v_max_u32 v10, 1, v10
v_max_u32 v11, 1, v11
v_max_u32 v12, 1, v12
v_max_u32 v13, 1, v13
v_max_u32 v14, 1, v14
v_max_u32 v15, 1, v15
s_mov_b32 exec_lo, 0x10001
s_mov_b32 exec_hi, 0x10001
buffer_store_dwordx4 v[8:11], v7, s[20:23], s73 offen offset:0 sc1
buffer_store_dwordx4 v[12:15], v7, s[20:23], s73 offen offset:64 sc1
s_mov_b64 exec, -1
s_branch fxb_43
fst_37:
s_lshl1_add_u32 s70, s78, s58
s_lshl_b32 s70, s70, 13
v_bfe_u32 v8, v0, 2, 2
v_lshl_add_u32 v8, v8, 9, v7
v_add_u32 v8, v8, v1
v_lshlrev_b32 v8, 2, v8
buffer_load_dwordx4 v[24:27], v8, s[8:11], s70 offen offset:0
buffer_load_dwordx4 v[28:31], v8, s[8:11], s70 offen offset:256
buffer_load_dwordx4 v[32:35], v8, s[8:11], s70 offen offset:512
buffer_load_dwordx4 v[36:39], v8, s[8:11], s70 offen offset:768
buffer_load_dwordx4 v[40:43], v8, s[8:11], s70 offen offset:1024
buffer_load_dwordx4 v[44:47], v8, s[8:11], s70 offen offset:1280
buffer_load_dwordx4 v[48:51], v8, s[8:11], s70 offen offset:1536
buffer_load_dwordx4 v[52:55], v8, s[8:11], s70 offen offset:1792
v_lshlrev_b32 v9, 4, v1
s_waitcnt vmcnt(7)
v_mfma_f32_16x16x32_bf16 v[16:19], v[24:27], v[252:255], 0
v_mfma_f32_16x16x32_bf16 v[20:23], v[24:27], v[24:27], 0
s_waitcnt vmcnt(6)
v_mfma_f32_16x16x32_bf16 v[16:19], v[28:31], v[252:255], v[16:19]
v_mfma_f32_16x16x32_bf16 v[20:23], v[28:31], v[28:31], v[20:23]
s_waitcnt vmcnt(5)
v_mfma_f32_16x16x32_bf16 v[16:19], v[32:35], v[252:255], v[16:19]
v_mfma_f32_16x16x32_bf16 v[20:23], v[32:35], v[32:35], v[20:23]
s_waitcnt vmcnt(4)
v_mfma_f32_16x16x32_bf16 v[16:19], v[36:39], v[252:255], v[16:19]
v_mfma_f32_16x16x32_bf16 v[20:23], v[36:39], v[36:39], v[20:23]
s_waitcnt vmcnt(3)
v_mfma_f32_16x16x32_bf16 v[16:19], v[40:43], v[252:255], v[16:19]
v_mfma_f32_16x16x32_bf16 v[20:23], v[40:43], v[40:43], v[20:23]
s_waitcnt vmcnt(2)
v_mfma_f32_16x16x32_bf16 v[16:19], v[44:47], v[252:255], v[16:19]
v_mfma_f32_16x16x32_bf16 v[20:23], v[44:47], v[44:47], v[20:23]
s_waitcnt vmcnt(1)
v_mfma_f32_16x16x32_bf16 v[16:19], v[48:51], v[252:255], v[16:19]
v_mfma_f32_16x16x32_bf16 v[20:23], v[48:51], v[48:51], v[20:23]
s_waitcnt vmcnt(0)
v_mfma_f32_16x16x32_bf16 v[16:19], v[52:55], v[252:255], v[16:19]
v_mfma_f32_16x16x32_bf16 v[20:23], v[52:55], v[52:55], v[20:23]
s_nop 6
v_add_f32 v16, v16, v18
v_add_f32 v17, v17, v19
v_add_f32 v16, v16, v17
s_nop 0
v_mov_b32_dpp v17, v20 quad_perm:[0,0,0,0] row_mask:0xf bank_mask:0xf
s_nop 1
v_add_f32_dpp v17, v21, v17 quad_perm:[1,1,1,1] row_mask:0xf bank_mask:0xf
s_nop 1
v_add_f32_dpp v17, v22, v17 quad_perm:[2,2,2,2] row_mask:0xf bank_mask:0xf
s_nop 1
v_add_f32_dpp v17, v23, v17 quad_perm:[3,3,3,3] row_mask:0xf bank_mask:0xf
v_mul_f32 v5, 0xba800000, v16
v_mul_f32 v17, 0x3a800000, v17
v_fma_f32 v17, -v5, v5, v17
v_max_f32 v17, 0, v17
v_add_f32 v17, 0x3727c5ac, v17
v_rsq_f32 v16, v17
s_nop 0
v_mul_f32 v17, v5, v16
v_max_u32 v17, 1, v17
s_lshl_b32 s70, s60, 7
s_add_u32 s70, s70, s76
s_lshl_b32 s73, s58, 5
s_add_u32 s70, s70, s73
v_lshrrev_b32 v7, 1, v7
s_add_u32 s35, s34, 5
tw_99:
ds_read_b32 v5, v2 offset:16
s_waitcnt lgkmcnt(0)
v_cmp_gt_i32 vcc, s35, v5
s_cbranch_vccz twd_100
v_readfirstlane_b32 s54, v5
s_sub_u32 s55, s35, s54
s_cmp_lt_i32 s55, 2
s_cbranch_scc1 tws_101
s_add_u32 s54, s54, 2
s_or_b32 s54, s54, 1
s_cmp_eq_u32 s54, s52
s_cbranch_scc1 tws_101
s_bitcmp1_b32 s54, 4
s_cbranch_scc1 tws_101
s_mov_b32 s52, s54
s_add_u32 s54, s54, s53
s_and_b32 s54, s54, 15
s_mul_i32 s54, s54, 393216
s_add_u32 s54, s54, s56
s_buffer_load_dwordx2 s[46:47], s[48:51], s54 offset:4096
s_buffer_load_dwordx2 s[46:47], s[48:51], s54 offset:10240
s_buffer_load_dwordx2 s[46:47], s[48:51], s54 offset:16384
s_buffer_load_dwordx2 s[46:47], s[48:51], s54 offset:22528
tws_101:
s_sleep 4
s_sub_u32 s32, s32, 1
s_cmp_gt_i32 s32, 0
s_cbranch_scc1 tw_99
twd_100:
poll_102:
buffer_load_dword v12, v9, s[4:7], 0 offen sc1
pchk_103:
s_waitcnt vmcnt(0)
v_cmp_gt_u32 vcc, 64, v12
s_cbranch_vccz pdone_104
s_sleep 16
s_sub_u32 s32, s32, 1
s_cmp_gt_i32 s32, 0
s_cbranch_scc1 poll_102
pdone_104:
s_mov_b32 exec_lo, 0x00100001
s_mov_b32 exec_hi, 0x10000100
buffer_store_dwordx2 v[16:17], v7, s[24:27], s70 offen sc1
s_getreg_b32 s73, hwreg(HW_REG_XCC_ID)
s_mov_b64 exec, 1
v_add_u32 v12, s73, 1
buffer_store_dword v12, off, s[24:27], s70 offset:64 sc1
s_mov_b64 exec, -1
s_branch fsb_38
fg_44:
s_lshl1_add_u32 s35, s2, s58
s_lshl_b32 s35, s35, 12
s_add_u32 s44, s40, s35
s_addc_u32 s45, s41, 0
s_mov_b32 s35, 4
ft_105:
s_load_dwordx2 s[42:43], s[44:45], 60
s_load_dwordx2 s[42:43], s[44:45], 188
s_load_dwordx2 s[42:43], s[44:45], 316
s_load_dwordx2 s[42:43], s[44:45], 444
s_load_dwordx2 s[42:43], s[44:45], 572
s_load_dwordx2 s[42:43], s[44:45], 700
s_load_dwordx2 s[42:43], s[44:45], 828
s_load_dwordx2 s[42:43], s[44:45], 956
s_add_u32 s44, s44, 1024
s_addc_u32 s45, s45, 0
s_sub_u32 s35, s35, 1
s_cmp_eq_u32 s35, 0
s_cbranch_scc0 ft_105
v_lshrrev_b32 v250, 3, v0
v_mul_u32_u24 v250, 16256, v250
v_add_u32 v250, v250, v4
s_add_u32 s35, s66, 131072
buffer_load_dwordx4 v[184:187], v250, s[12:15], s35 offen nt
s_add_u32 s35, s66, 133120
buffer_load_dwordx4 v[188:191], v250, s[12:15], s35 offen nt
s_add_u32 s35, s66, 135168
buffer_load_dwordx4 v[192:195], v250, s[12:15], s35 offen nt
s_add_u32 s35, s66, 137216
buffer_load_dwordx4 v[196:199], v250, s[12:15], s35 offen nt
s_add_u32 s35, s66, 139264
buffer_load_dwordx4 v[200:203], v250, s[12:15], s35 offen nt
s_add_u32 s35, s66, 141312
buffer_load_dwordx4 v[204:207], v250, s[12:15], s35 offen nt
s_add_u32 s35, s66, 143360
buffer_load_dwordx4 v[208:211], v250, s[12:15], s35 offen nt
s_add_u32 s35, s66, 145408
buffer_load_dwordx4 v[212:215], v250, s[12:15], s35 offen nt
v_lshrrev_b32 v250, 3, v0
v_mul_u32_u24 v250, 16256, v250
v_add_u32 v250, v250, v4
s_add_u32 s35, s66, 0
buffer_load_dwordx4 v[152:155], v250, s[12:15], s35 offen nt
s_add_u32 s35, s66, 2048
buffer_load_dwordx4 v[156:159], v250, s[12:15], s35 offen nt
s_add_u32 s35, s66, 4096
buffer_load_dwordx4 v[160:163], v250, s[12:15], s35 offen nt
s_add_u32 s35, s66, 6144
buffer_load_dwordx4 v[164:167], v250, s[12:15], s35 offen nt
s_add_u32 s35, s66, 8192
buffer_load_dwordx4 v[168:171], v250, s[12:15], s35 offen nt
s_add_u32 s35, s66, 10240
buffer_load_dwordx4 v[172:175], v250, s[12:15], s35 offen nt
s_add_u32 s35, s66, 12288
buffer_load_dwordx4 v[176:179], v250, s[12:15], s35 offen nt
s_add_u32 s35, s66, 14336
buffer_load_dwordx4 v[180:183], v250, s[12:15], s35 offen nt
s_add_u32 s35, s34, 10
tw_106:
ds_read_b32 v5, v2 offset:16
s_waitcnt lgkmcnt(0)
v_cmp_gt_i32 vcc, s35, v5
s_cbranch_vccz twd_107
v_readfirstlane_b32 s54, v5
s_sub_u32 s55, s35, s54
s_cmp_lt_i32 s55, 2
s_cbranch_scc1 tws_108
s_add_u32 s54, s54, 2
s_or_b32 s54, s54, 1
s_cmp_eq_u32 s54, s52
s_cbranch_scc1 tws_108
s_bitcmp1_b32 s54, 4
s_cbranch_scc1 tws_108
s_mov_b32 s52, s54
s_add_u32 s54, s54, s53
s_and_b32 s54, s54, 15
s_mul_i32 s54, s54, 393216
s_add_u32 s54, s54, s56
s_buffer_load_dwordx2 s[46:47], s[48:51], s54 offset:4096
s_buffer_load_dwordx2 s[46:47], s[48:51], s54 offset:10240
s_buffer_load_dwordx2 s[46:47], s[48:51], s54 offset:16384
s_buffer_load_dwordx2 s[46:47], s[48:51], s54 offset:22528
tws_108:
s_sleep 4
s_sub_u32 s32, s32, 1
s_cmp_gt_i32 s32, 0
s_cbranch_scc1 tw_106
twd_107:
v_and_b32 v10, 0x7a0, v7
s_getreg_b32 s70, hwreg(HW_REG_XCC_ID)
s_add_u32 s70, s70, 1
poll_109:
buffer_load_dword v12, v10, s[24:27], s76 offen offset:64 sc1
pchk_110:
s_waitcnt vmcnt(0)
v_cmp_eq_u32 vcc, 0, v12
s_cbranch_vccz pdone_111
s_sub_u32 s32, s32, 1
s_cmp_gt_i32 s32, 0
s_cbranch_scc1 poll_109
pdone_111:
v_cmp_eq_u32 vcc, s70, v12
s_cmp_eq_u64 vcc, exec
s_cselect_b32 s70, 1, 0
v_mov_b32 v12, s70
v_mov_b32 v10, 0
s_mov_b64 exec, 1
ds_write_b32 v10, v12 offset:56
s_mov_b64 exec, -1
s_branch fg_45
fnw_55:
s_waitcnt lgkmcnt(0)
v_mov_b32 v252, 0
v_mov_b32 v253, 0
v_mov_b32 v254, 0
v_mov_b32 v255, 0
s_mul_i32 s42, s58, 1409024
s_mul_i32 s35, s78, 2048
s_add_u32 s35, s35, s42
s_add_u32 s35, s35, 524288
buffer_store_dwordx4 v[252:255], v4, s[24:27], s35 offen offset:0 sc1
buffer_store_dwordx4 v[252:255], v4, s[24:27], s35 offen offset:1024 sc1
s_mul_i32 s35, s78, 1408
s_add_u32 s35, s35, s42
s_add_u32 s35, s35, 1048576
buffer_store_dwordx4 v[252:255], v4, s[24:27], s35 offen offset:0 sc1
buffer_store_dwordx4 v[252:255], v4, s[24:27], s35 offen offset:384 sc1
s_lshl_b32 s35, s78, 10
s_add_u32 s35, s35, 1409024
s_cmp_eq_u32 s58, 1
s_cselect_b64 exec, -1, 0
buffer_store_dwordx4 v[252:255], v4, s[24:27], s35 offen offset:0 sc1
s_add_u32 s35, s35, 262144
buffer_store_dwordx4 v[252:255], v4, s[24:27], s35 offen offset:0 sc1
s_mov_b64 exec, -1
s_waitcnt vmcnt(0)
v_add_u32 v5, s34, 3
s_mov_b64 exec, 1
ds_write_b32 v3, v5
s_mov_b64 exec, -1
s_add_u32 s35, s34, 17
tw_112:
ds_read_b32 v5, v2 offset:16
s_waitcnt lgkmcnt(0)
v_cmp_gt_i32 vcc, s35, v5
s_cbranch_vccz twd_113
v_readfirstlane_b32 s54, v5
s_sub_u32 s55, s35, s54
s_cmp_lt_i32 s55, 2
s_cbranch_scc1 tws_114
s_add_u32 s54, s54, 2
s_or_b32 s54, s54, 1
s_cmp_eq_u32 s54, s52
s_cbranch_scc1 tws_114
s_bitcmp1_b32 s54, 4
s_cbranch_scc1 tws_114
s_mov_b32 s52, s54
s_add_u32 s54, s54, s53
s_and_b32 s54, s54, 15
s_mul_i32 s54, s54, 393216
s_add_u32 s54, s54, s56
s_buffer_load_dwordx2 s[46:47], s[48:51], s54 offset:4096
s_buffer_load_dwordx2 s[46:47], s[48:51], s54 offset:10240
s_buffer_load_dwordx2 s[46:47], s[48:51], s54 offset:16384
s_buffer_load_dwordx2 s[46:47], s[48:51], s54 offset:22528
tws_114:
s_sleep 4
s_sub_u32 s32, s32, 1
s_cmp_gt_i32 s32, 0
s_cbranch_scc1 tw_112
twd_113:
v_lshrrev_b32 v250, 4, v0
v_mul_u32_u24 v250, 28416, v250
v_add_u32 v250, v250, v4
s_add_u32 s35, s77, 688128
buffer_load_dwordx4 v[120:123], v250, s[16:19], s35 offen nt
s_add_u32 s35, s77, 695296
buffer_load_dwordx4 v[124:127], v250, s[16:19], s35 offen nt
s_add_u32 s35, s77, 702464
buffer_load_dwordx4 v[128:131], v250, s[16:19], s35 offen nt
s_add_u32 s35, s77, 709632
buffer_load_dwordx4 v[132:135], v250, s[16:19], s35 offen nt
s_add_u32 s35, s77, 802816
buffer_load_dwordx4 v[136:139], v250, s[16:19], s35 offen nt
s_add_u32 s35, s77, 809984
buffer_load_dwordx4 v[140:143], v250, s[16:19], s35 offen nt
s_add_u32 s35, s77, 817152
buffer_load_dwordx4 v[144:147], v250, s[16:19], s35 offen nt
s_add_u32 s35, s77, 824320
buffer_load_dwordx4 v[148:151], v250, s[16:19], s35 offen nt
v_lshrrev_b32 v250, 4, v0
v_mul_u32_u24 v250, 28416, v250
v_add_u32 v250, v250, v4
s_add_u32 s35, s77, 458752
buffer_load_dwordx4 v[88:91], v250, s[16:19], s35 offen nt
s_add_u32 s35, s77, 465920
buffer_load_dwordx4 v[92:95], v250, s[16:19], s35 offen nt
s_add_u32 s35, s77, 473088
buffer_load_dwordx4 v[96:99], v250, s[16:19], s35 offen nt
s_add_u32 s35, s77, 480256
buffer_load_dwordx4 v[100:103], v250, s[16:19], s35 offen nt
s_add_u32 s35, s77, 573440
buffer_load_dwordx4 v[104:107], v250, s[16:19], s35 offen nt
s_add_u32 s35, s77, 580608
buffer_load_dwordx4 v[108:111], v250, s[16:19], s35 offen nt
s_add_u32 s35, s77, 587776
buffer_load_dwordx4 v[112:115], v250, s[16:19], s35 offen nt
s_add_u32 s35, s77, 594944
buffer_load_dwordx4 v[116:119], v250, s[16:19], s35 offen nt
v_lshrrev_b32 v250, 4, v0
v_mul_u32_u24 v250, 28416, v250
v_add_u32 v250, v250, v4
s_add_u32 s35, s77, 229376
buffer_load_dwordx4 v[56:59], v250, s[16:19], s35 offen nt
s_add_u32 s35, s77, 236544
buffer_load_dwordx4 v[60:63], v250, s[16:19], s35 offen nt
s_add_u32 s35, s77, 243712
buffer_load_dwordx4 v[64:67], v250, s[16:19], s35 offen nt
s_add_u32 s35, s77, 250880
buffer_load_dwordx4 v[68:71], v250, s[16:19], s35 offen nt
s_add_u32 s35, s77, 344064
buffer_load_dwordx4 v[72:75], v250, s[16:19], s35 offen nt
s_add_u32 s35, s77, 351232
buffer_load_dwordx4 v[76:79], v250, s[16:19], s35 offen nt
s_add_u32 s35, s77, 358400
buffer_load_dwordx4 v[80:83], v250, s[16:19], s35 offen nt
s_add_u32 s35, s77, 365568
buffer_load_dwordx4 v[84:87], v250, s[16:19], s35 offen nt
v_lshrrev_b32 v250, 4, v0
v_mul_u32_u24 v250, 28416, v250
v_add_u32 v250, v250, v4
s_add_u32 s35, s77, 0
buffer_load_dwordx4 v[24:27], v250, s[16:19], s35 offen nt
s_add_u32 s35, s77, 7168
buffer_load_dwordx4 v[28:31], v250, s[16:19], s35 offen nt
s_add_u32 s35, s77, 14336
buffer_load_dwordx4 v[32:35], v250, s[16:19], s35 offen nt
s_add_u32 s35, s77, 21504
buffer_load_dwordx4 v[36:39], v250, s[16:19], s35 offen nt
s_add_u32 s35, s77, 114688
buffer_load_dwordx4 v[40:43], v250, s[16:19], s35 offen nt
s_add_u32 s35, s77, 121856
buffer_load_dwordx4 v[44:47], v250, s[16:19], s35 offen nt
s_add_u32 s35, s77, 129024
buffer_load_dwordx4 v[48:51], v250, s[16:19], s35 offen nt
s_add_u32 s35, s77, 136192
buffer_load_dwordx4 v[52:55], v250, s[16:19], s35 offen nt
s_waitcnt lgkmcnt(0)
s_mov_b32 s42, 0x05040100
s_mov_b32 s43, 0x07060302
s_cmp_eq_u32 s65, 0
s_cbranch_scc0 fq_115
v_perm_b32 v216, v188, v184, s42
v_perm_b32 v220, v188, v184, s43
v_perm_b32 v224, v189, v185, s42
v_perm_b32 v228, v189, v185, s43
v_perm_b32 v232, v190, v186, s42
v_perm_b32 v236, v190, v186, s43
v_perm_b32 v240, v191, v187, s42
v_perm_b32 v244, v191, v187, s43
v_perm_b32 v217, v196, v192, s42
v_perm_b32 v221, v196, v192, s43
v_perm_b32 v225, v197, v193, s42
v_perm_b32 v229, v197, v193, s43
v_perm_b32 v233, v198, v194, s42
v_perm_b32 v237, v198, v194, s43
v_perm_b32 v241, v199, v195, s42
v_perm_b32 v245, v199, v195, s43
v_perm_b32 v218, v204, v200, s42
v_perm_b32 v222, v204, v200, s43
v_perm_b32 v226, v205, v201, s42
v_perm_b32 v230, v205, v201, s43
v_perm_b32 v234, v206, v202, s42
v_perm_b32 v238, v206, v202, s43
v_perm_b32 v242, v207, v203, s42
v_perm_b32 v246, v207, v203, s43
v_perm_b32 v219, v212, v208, s42
v_perm_b32 v223, v212, v208, s43
v_perm_b32 v227, v213, v209, s42
v_perm_b32 v231, v213, v209, s43
v_perm_b32 v235, v214, v210, s42
v_perm_b32 v239, v214, v210, s43
v_perm_b32 v243, v215, v211, s42
v_perm_b32 v247, v215, v211, s43
v_perm_b32 v184, v156, v152, s42
v_perm_b32 v188, v156, v152, s43
v_perm_b32 v192, v157, v153, s42
v_perm_b32 v196, v157, v153, s43
v_perm_b32 v200, v158, v154, s42
v_perm_b32 v204, v158, v154, s43
v_perm_b32 v208, v159, v155, s42
v_perm_b32 v212, v159, v155, s43
v_perm_b32 v185, v164, v160, s42
v_perm_b32 v189, v164, v160, s43
v_perm_b32 v193, v165, v161, s42
v_perm_b32 v197, v165, v161, s43
v_perm_b32 v201, v166, v162, s42
v_perm_b32 v205, v166, v162, s43
v_perm_b32 v209, v167, v163, s42
v_perm_b32 v213, v167, v163, s43
v_perm_b32 v186, v172, v168, s42
v_perm_b32 v190, v172, v168, s43
v_perm_b32 v194, v173, v169, s42
v_perm_b32 v198, v173, v169, s43
v_perm_b32 v202, v174, v170, s42
v_perm_b32 v206, v174, v170, s43
v_perm_b32 v210, v175, v171, s42
v_perm_b32 v214, v175, v171, s43
v_perm_b32 v187, v180, v176, s42
v_perm_b32 v191, v180, v176, s43
v_perm_b32 v195, v181, v177, s42
v_perm_b32 v199, v181, v177, s43
v_perm_b32 v203, v182, v178, s42
v_perm_b32 v207, v182, v178, s43
v_perm_b32 v211, v183, v179, s42
v_perm_b32 v215, v183, v179, s43
s_waitcnt vmcnt(30)
v_perm_b32 v152, v124, v120, s42
v_perm_b32 v156, v124, v120, s43
v_perm_b32 v160, v125, v121, s42
v_perm_b32 v164, v125, v121, s43
v_perm_b32 v168, v126, v122, s42
v_perm_b32 v172, v126, v122, s43
v_perm_b32 v176, v127, v123, s42
v_perm_b32 v180, v127, v123, s43
s_waitcnt vmcnt(28)
v_perm_b32 v153, v132, v128, s42
v_perm_b32 v157, v132, v128, s43
v_perm_b32 v161, v133, v129, s42
v_perm_b32 v165, v133, v129, s43
v_perm_b32 v169, v134, v130, s42
v_perm_b32 v173, v134, v130, s43
v_perm_b32 v177, v135, v131, s42
v_perm_b32 v181, v135, v131, s43
s_waitcnt vmcnt(26)
v_perm_b32 v154, v140, v136, s42
v_perm_b32 v158, v140, v136, s43
v_perm_b32 v162, v141, v137, s42
v_perm_b32 v166, v141, v137, s43
v_perm_b32 v170, v142, v138, s42
v_perm_b32 v174, v142, v138, s43
v_perm_b32 v178, v143, v139, s42
v_perm_b32 v182, v143, v139, s43
s_waitcnt vmcnt(24)
v_perm_b32 v155, v148, v144, s42
v_perm_b32 v159, v148, v144, s43
v_perm_b32 v163, v149, v145, s42
v_perm_b32 v167, v149, v145, s43
v_perm_b32 v171, v150, v146, s42
v_perm_b32 v175, v150, v146, s43
v_perm_b32 v179, v151, v147, s42
v_perm_b32 v183, v151, v147, s43
s_waitcnt vmcnt(22)
v_perm_b32 v120, v92, v88, s42
v_perm_b32 v124, v92, v88, s43
v_perm_b32 v128, v93, v89, s42
v_perm_b32 v132, v93, v89, s43
v_perm_b32 v136, v94, v90, s42
v_perm_b32 v140, v94, v90, s43
v_perm_b32 v144, v95, v91, s42
v_perm_b32 v148, v95, v91, s43
s_waitcnt vmcnt(20)
v_perm_b32 v121, v100, v96, s42
v_perm_b32 v125, v100, v96, s43
v_perm_b32 v129, v101, v97, s42
v_perm_b32 v133, v101, v97, s43
v_perm_b32 v137, v102, v98, s42
v_perm_b32 v141, v102, v98, s43
v_perm_b32 v145, v103, v99, s42
v_perm_b32 v149, v103, v99, s43
s_waitcnt vmcnt(18)
v_perm_b32 v122, v108, v104, s42
v_perm_b32 v126, v108, v104, s43
v_perm_b32 v130, v109, v105, s42
v_perm_b32 v134, v109, v105, s43
v_perm_b32 v138, v110, v106, s42
v_perm_b32 v142, v110, v106, s43
v_perm_b32 v146, v111, v107, s42
v_perm_b32 v150, v111, v107, s43
s_waitcnt vmcnt(16)
v_perm_b32 v123, v116, v112, s42
v_perm_b32 v127, v116, v112, s43
v_perm_b32 v131, v117, v113, s42
v_perm_b32 v135, v117, v113, s43
v_perm_b32 v139, v118, v114, s42
v_perm_b32 v143, v118, v114, s43
v_perm_b32 v147, v119, v115, s42
v_perm_b32 v151, v119, v115, s43
s_waitcnt vmcnt(14)
v_perm_b32 v88, v60, v56, s42
v_perm_b32 v92, v60, v56, s43
v_perm_b32 v96, v61, v57, s42
v_perm_b32 v100, v61, v57, s43
v_perm_b32 v104, v62, v58, s42
v_perm_b32 v108, v62, v58, s43
v_perm_b32 v112, v63, v59, s42
v_perm_b32 v116, v63, v59, s43
s_waitcnt vmcnt(12)
v_perm_b32 v89, v68, v64, s42
v_perm_b32 v93, v68, v64, s43
v_perm_b32 v97, v69, v65, s42
v_perm_b32 v101, v69, v65, s43
v_perm_b32 v105, v70, v66, s42
v_perm_b32 v109, v70, v66, s43
v_perm_b32 v113, v71, v67, s42
v_perm_b32 v117, v71, v67, s43
s_waitcnt vmcnt(10)
v_perm_b32 v90, v76, v72, s42
v_perm_b32 v94, v76, v72, s43
v_perm_b32 v98, v77, v73, s42
v_perm_b32 v102, v77, v73, s43
v_perm_b32 v106, v78, v74, s42
v_perm_b32 v110, v78, v74, s43
v_perm_b32 v114, v79, v75, s42
v_perm_b32 v118, v79, v75, s43
s_waitcnt vmcnt(8)
v_perm_b32 v91, v84, v80, s42
v_perm_b32 v95, v84, v80, s43
v_perm_b32 v99, v85, v81, s42
v_perm_b32 v103, v85, v81, s43
v_perm_b32 v107, v86, v82, s42
v_perm_b32 v111, v86, v82, s43
v_perm_b32 v115, v87, v83, s42
v_perm_b32 v119, v87, v83, s43
s_waitcnt vmcnt(6)
v_perm_b32 v56, v28, v24, s42
v_perm_b32 v60, v28, v24, s43
v_perm_b32 v64, v29, v25, s42
v_perm_b32 v68, v29, v25, s43
v_perm_b32 v72, v30, v26, s42
v_perm_b32 v76, v30, v26, s43
v_perm_b32 v80, v31, v27, s42
v_perm_b32 v84, v31, v27, s43
s_waitcnt vmcnt(4)
v_perm_b32 v57, v36, v32, s42
v_perm_b32 v61, v36, v32, s43
v_perm_b32 v65, v37, v33, s42
v_perm_b32 v69, v37, v33, s43
v_perm_b32 v73, v38, v34, s42
v_perm_b32 v77, v38, v34, s43
v_perm_b32 v81, v39, v35, s42
v_perm_b32 v85, v39, v35, s43
s_waitcnt vmcnt(2)
v_perm_b32 v58, v44, v40, s42
v_perm_b32 v62, v44, v40, s43
v_perm_b32 v66, v45, v41, s42
v_perm_b32 v70, v45, v41, s43
v_perm_b32 v74, v46, v42, s42
v_perm_b32 v78, v46, v42, s43
v_perm_b32 v82, v47, v43, s42
v_perm_b32 v86, v47, v43, s43
s_waitcnt vmcnt(0)
v_perm_b32 v59, v52, v48, s42
v_perm_b32 v63, v52, v48, s43
v_perm_b32 v67, v53, v49, s42
v_perm_b32 v71, v53, v49, s43
v_perm_b32 v75, v54, v50, s42
v_perm_b32 v79, v54, v50, s43
v_perm_b32 v83, v55, v51, s42
v_perm_b32 v87, v55, v51, s43
fq_115:
s_and_b32 s54, s59, 1
s_lshl_b32 s54, s54, 1
s_sub_u32 s54, s53, s54
s_and_b32 s54, s54, 15
s_mul_i32 s54, s54, 393216
s_add_u32 s54, s54, s56
s_buffer_load_dwordx2 s[46:47], s[48:51], s54 offset:4096
s_buffer_load_dwordx2 s[46:47], s[48:51], s54 offset:10240
s_buffer_load_dwordx2 s[46:47], s[48:51], s54 offset:16384
s_buffer_load_dwordx2 s[46:47], s[48:51], s54 offset:22528
s_buffer_load_dwordx2 s[46:47], s[48:51], s54 offset:2048
s_buffer_load_dwordx2 s[46:47], s[48:51], s54 offset:8192
s_buffer_load_dwordx2 s[46:47], s[48:51], s54 offset:14336
s_buffer_load_dwordx2 s[46:47], s[48:51], s54 offset:20480
s_buffer_load_dwordx2 s[46:47], s[48:51], s54 offset:0
s_buffer_load_dwordx2 s[46:47], s[48:51], s54 offset:6144
s_buffer_load_dwordx2 s[46:47], s[48:51], s54 offset:12288
s_buffer_load_dwordx2 s[46:47], s[48:51], s54 offset:18432
s_add_u32 s54, s53, 1
s_and_b32 s54, s54, 15
s_mul_i32 s54, s54, 393216
s_add_u32 s54, s54, s56
s_buffer_load_dwordx2 s[46:47], s[48:51], s54 offset:4096
s_buffer_load_dwordx2 s[46:47], s[48:51], s54 offset:10240
s_buffer_load_dwordx2 s[46:47], s[48:51], s54 offset:16384
s_buffer_load_dwordx2 s[46:47], s[48:51], s54 offset:22528
s_buffer_load_dwordx2 s[46:47], s[48:51], s54 offset:2048
s_buffer_load_dwordx2 s[46:47], s[48:51], s54 offset:8192
s_buffer_load_dwordx2 s[46:47], s[48:51], s54 offset:14336
s_buffer_load_dwordx2 s[46:47], s[48:51], s54 offset:20480
s_buffer_load_dwordx2 s[46:47], s[48:51], s54 offset:0
s_buffer_load_dwordx2 s[46:47], s[48:51], s54 offset:6144
s_buffer_load_dwordx2 s[46:47], s[48:51], s54 offset:12288
s_buffer_load_dwordx2 s[46:47], s[48:51], s54 offset:18432
s_add_u32 s54, s53, 3
s_and_b32 s54, s54, 15
s_mul_i32 s54, s54, 393216
s_add_u32 s54, s54, s56
s_buffer_load_dwordx2 s[46:47], s[48:51], s54 offset:4096
s_buffer_load_dwordx2 s[46:47], s[48:51], s54 offset:10240
s_buffer_load_dwordx2 s[46:47], s[48:51], s54 offset:16384
s_buffer_load_dwordx2 s[46:47], s[48:51], s54 offset:22528
s_buffer_load_dwordx2 s[46:47], s[48:51], s54 offset:2048
s_buffer_load_dwordx2 s[46:47], s[48:51], s54 offset:8192
s_buffer_load_dwordx2 s[46:47], s[48:51], s54 offset:14336
s_buffer_load_dwordx2 s[46:47], s[48:51], s54 offset:20480
s_buffer_load_dwordx2 s[46:47], s[48:51], s54 offset:0
s_buffer_load_dwordx2 s[46:47], s[48:51], s54 offset:6144
s_buffer_load_dwordx2 s[46:47], s[48:51], s54 offset:12288
s_buffer_load_dwordx2 s[46:47], s[48:51], s54 offset:18432
s_add_u32 s54, s53, 5
s_and_b32 s54, s54, 15
s_mul_i32 s54, s54, 393216
s_add_u32 s54, s54, s56
s_buffer_load_dwordx2 s[46:47], s[48:51], s54 offset:4096
s_buffer_load_dwordx2 s[46:47], s[48:51], s54 offset:10240
s_buffer_load_dwordx2 s[46:47], s[48:51], s54 offset:16384
s_buffer_load_dwordx2 s[46:47], s[48:51], s54 offset:22528
s_buffer_load_dwordx2 s[46:47], s[48:51], s54 offset:2048
s_buffer_load_dwordx2 s[46:47], s[48:51], s54 offset:8192
s_buffer_load_dwordx2 s[46:47], s[48:51], s54 offset:14336
s_buffer_load_dwordx2 s[46:47], s[48:51], s54 offset:20480
s_buffer_load_dwordx2 s[46:47], s[48:51], s54 offset:0
s_buffer_load_dwordx2 s[46:47], s[48:51], s54 offset:6144
s_buffer_load_dwordx2 s[46:47], s[48:51], s54 offset:12288
s_buffer_load_dwordx2 s[46:47], s[48:51], s54 offset:18432
s_waitcnt lgkmcnt(0)
s_branch fnw_56
fnd_65:
poll_116:
buffer_load_dwordx2 v[248:249], v6, s[24:27], s73 offen sc1
pchk_117:
s_waitcnt vmcnt(0)
v_min_u32 v5, v248, v249
v_cmp_eq_u32 vcc, 0, v5
s_cbranch_vccz pdone_118
s_sleep 1
s_sub_u32 s32, s32, 1
s_cmp_gt_i32 s32, 0
s_cbranch_scc1 poll_116
pdone_118:
v_mov_b32 v250, v248
s_nop 1
v_max_f32_dpp v250, v250, v250 row_ror:1 row_mask:0xf bank_mask:0xf
s_nop 1
v_max_f32_dpp v250, v250, v250 row_ror:2 row_mask:0xf bank_mask:0xf
s_nop 1
v_max_f32_dpp v250, v250, v250 row_ror:4 row_mask:0xf bank_mask:0xf
s_nop 1
v_max_f32_dpp v250, v250, v250 row_ror:8 row_mask:0xf bank_mask:0xf
v_cmp_eq_f32 vcc, v250, v248
s_ff1_i32_b64 s68, vcc
s_and_b32 s68, s68, 15
v_readlane_b32 s33, v249, s68
v_readlane_b32 s67, v248, s68
v_add_u32 v5, s34, 4
v_mov_b32 v250, s33
s_mov_b64 exec, 1
ds_write2_b32 v3, v5, v250 offset1:2
s_mov_b64 exec, -1
s_sub_u32 s33, s33, 1
s_and_b32 s33, s33, 2047
s_branch fnd_64
fpre_85:
poll_119:
buffer_load_dwordx4 v[24:27], v4, s[24:27], s72 offen offset:0 sc1
pchk_120:
s_waitcnt vmcnt(0)
v_min3_u32 v5, v24, v25, v26
v_min_u32 v5, v5, v27
v_cmp_eq_u32 vcc, 0, v5
s_cbranch_vccz pdone_121
s_sleep 8
s_sub_u32 s32, s32, 1
s_cmp_gt_i32 s32, 0
s_cbranch_scc1 poll_119
pdone_121:
s_branch fpre_86
L_m:
s_setprio 2
v_mov_b32 v6, 0
v_mov_b32 v7, 0
v_lshlrev_b32 v8, 3, v0
ds_write_b64 v8, v[6:7]
s_waitcnt lgkmcnt(0)
s_barrier
s_lshr_b32 s64, s58, 1
s_and_b32 s65, s58, 1
v_and_b32 v1, 3, v0
v_lshlrev_b32 v1, 2, v1
v_and_b32 v2, 4, v1
s_lshl2_add_u32 s35, s58, 0
v_mov_b32 v3, s35
s_mov_b32 s4, s44
s_mov_b32 s5, s45
s_mov_b32 s6, 0x800
s_mov_b32 s7, 0x00020000
v_lshrrev_b32 v6, 4, v0
v_lshlrev_b32 v6, 3, v6
s_lshl_b32 s66, s62, 7
buffer_load_dwordx2 v[232:233], v6, s[4:7], s66 offen offset:0
buffer_load_dwordx2 v[234:235], v6, s[4:7], s66 offen offset:32
buffer_load_dwordx2 v[236:237], v6, s[4:7], s66 offen offset:64
buffer_load_dwordx2 v[238:239], v6, s[4:7], s66 offen offset:96
v_and_b32 v6, 31, v0
v_lshrrev_b32 v7, 5, v0
v_lshlrev_b32 v7, 3, v7
v_sub_u32 v6, v6, v7
v_mov_b32 v7, 0xf149f2ca
v_cmp_le_i32 vcc, 0, v6
s_nop 1
v_cndmask_b32 v216, 0, v7, vcc
v_cmp_le_i32 vcc, 1, v6
s_nop 1
v_cndmask_b32 v217, 0, v7, vcc
v_cmp_le_i32 vcc, 2, v6
s_nop 1
v_cndmask_b32 v218, 0, v7, vcc
v_cmp_le_i32 vcc, 3, v6
s_nop 1
v_cndmask_b32 v219, 0, v7, vcc
v_cmp_le_i32 vcc, 16, v6
s_nop 1
v_cndmask_b32 v220, 0, v7, vcc
v_cmp_le_i32 vcc, 17, v6
s_nop 1
v_cndmask_b32 v221, 0, v7, vcc
v_cmp_le_i32 vcc, 18, v6
s_nop 1
v_cndmask_b32 v222, 0, v7, vcc
v_cmp_le_i32 vcc, 19, v6
s_nop 1
v_cndmask_b32 v223, 0, v7, vcc
v_cmp_le_i32 vcc, 4, v6
s_nop 1
v_cndmask_b32 v224, 0, v7, vcc
v_cmp_le_i32 vcc, 5, v6
s_nop 1
v_cndmask_b32 v225, 0, v7, vcc
v_cmp_le_i32 vcc, 6, v6
s_nop 1
v_cndmask_b32 v226, 0, v7, vcc
v_cmp_le_i32 vcc, 7, v6
s_nop 1
v_cndmask_b32 v227, 0, v7, vcc
v_cmp_le_i32 vcc, 20, v6
s_nop 1
v_cndmask_b32 v228, 0, v7, vcc
v_cmp_le_i32 vcc, 21, v6
s_nop 1
v_cndmask_b32 v229, 0, v7, vcc
v_cmp_le_i32 vcc, 22, v6
s_nop 1
v_cndmask_b32 v230, 0, v7, vcc
v_cmp_le_i32 vcc, 23, v6
s_nop 1
v_cndmask_b32 v231, 0, v7, vcc
v_lshrrev_b32 v6, 2, v0
v_xor_b32 v6, v6, v0
v_and_b32 v6, 4, v6
v_mov_b32 v7, 0x3f803f80
v_cmp_eq_u32 vcc, 0, v6
s_nop 1
v_cndmask_b32 v212, 0, v7, vcc
v_cndmask_b32 v213, 0, v7, vcc
v_cndmask_b32 v214, 0, v7, vcc
v_cndmask_b32 v215, 0, v7, vcc
L_mtop:
v_lshrrev_b32 v10, 4, v0
s_cmp_eq_u32 s63, 0
s_cbranch_scc0 mq_122
v_bfe_u32 v11, v0, 1, 3
v_xor_b32 v11, v11, v10
v_lshlrev_b32 v11, 4, v11
v_and_b32 v12, 15, v0
v_lshl_add_u32 v6, v12, 7, v11
v_xor_b32 v7, 64, v6
s_branch mq_123
mq_122:
v_lshlrev_b32 v6, 4, v0
v_add_u32 v7, 1024, v6
mq_123:
s_lshl_b32 s66, s65, 13
s_add_u32 s66, s66, 86016
v_add_u32 v6, s66, v6
v_add_u32 v7, s66, v7
v_bfe_u32 v11, v0, 2, 2
v_lshl_add_u32 v11, v10, 3, v11
v_bfe_u32 v12, v0, 3, 2
s_lshl_b32 s66, s64, 1
v_xor_b32 v12, s66, v12
v_lshlrev_b32 v12, 5, v12
v_lshl_add_u32 v11, v11, 7, v12
v_and_b32 v12, 3, v0
v_lshl_add_u32 v11, v12, 3, v11
v_add_u32 v8, 102400, v11
v_xor_b32 v9, 32, v8
v_mov_b32 v11, 0xf149f2ca
v_xor_b32 v216, v11, v216
v_xor_b32 v217, v11, v217
v_xor_b32 v218, v11, v218
v_xor_b32 v219, v11, v219
v_xor_b32 v220, v11, v220
v_xor_b32 v221, v11, v221
v_xor_b32 v222, v11, v222
v_xor_b32 v223, v11, v223
v_xor_b32 v224, v11, v224
v_xor_b32 v225, v11, v225
v_xor_b32 v226, v11, v226
v_xor_b32 v227, v11, v227
v_xor_b32 v228, v11, v228
v_xor_b32 v229, v11, v229
v_xor_b32 v230, v11, v230
v_xor_b32 v231, v11, v231
v_mov_b32 v16, 0
v_mov_b32 v17, 0
v_mov_b32 v18, 0
v_mov_b32 v19, 0
v_mov_b32 v20, 0
v_mov_b32 v21, 0
v_mov_b32 v22, 0
v_mov_b32 v23, 0
v_mov_b32 v24, 0
v_mov_b32 v25, 0
v_mov_b32 v26, 0
v_mov_b32 v27, 0
v_mov_b32 v28, 0
v_mov_b32 v29, 0
v_mov_b32 v30, 0
v_mov_b32 v31, 0
v_mov_b32 v32, 0
v_mov_b32 v33, 0
v_mov_b32 v34, 0
v_mov_b32 v35, 0
v_mov_b32 v36, 0
v_mov_b32 v37, 0
v_mov_b32 v38, 0
v_mov_b32 v39, 0
v_mov_b32 v40, 0
v_mov_b32 v41, 0
v_mov_b32 v42, 0
v_mov_b32 v43, 0
v_mov_b32 v44, 0
v_mov_b32 v45, 0
v_mov_b32 v46, 0
v_mov_b32 v47, 0
v_mov_b32 v48, 0
v_mov_b32 v49, 0
v_mov_b32 v50, 0
v_mov_b32 v51, 0
v_mov_b32 v52, 0
v_mov_b32 v53, 0
v_mov_b32 v54, 0
v_mov_b32 v55, 0
v_mov_b32 v56, 0
v_mov_b32 v57, 0
v_mov_b32 v58, 0
v_mov_b32 v59, 0
v_mov_b32 v60, 0
v_mov_b32 v61, 0
v_mov_b32 v62, 0
v_mov_b32 v63, 0
v_mov_b32 v64, 0
v_mov_b32 v65, 0
v_mov_b32 v66, 0
v_mov_b32 v67, 0
v_mov_b32 v68, 0
v_mov_b32 v69, 0
v_mov_b32 v70, 0
v_mov_b32 v71, 0
v_mov_b32 v72, 0
v_mov_b32 v73, 0
v_mov_b32 v74, 0
v_mov_b32 v75, 0
v_mov_b32 v76, 0
v_mov_b32 v77, 0
v_mov_b32 v78, 0
v_mov_b32 v79, 0
v_mov_b32 v80, 0
v_mov_b32 v81, 0
v_mov_b32 v82, 0
v_mov_b32 v83, 0
v_mov_b32 v84, 0
v_mov_b32 v85, 0
v_mov_b32 v86, 0
v_mov_b32 v87, 0
v_mov_b32 v88, 0
v_mov_b32 v89, 0
v_mov_b32 v90, 0
v_mov_b32 v91, 0
v_mov_b32 v92, 0
v_mov_b32 v93, 0
v_mov_b32 v94, 0
v_mov_b32 v95, 0
v_mov_b32 v96, 0
v_mov_b32 v97, 0
v_mov_b32 v98, 0
v_mov_b32 v99, 0
v_mov_b32 v100, 0
v_mov_b32 v101, 0
v_mov_b32 v102, 0
v_mov_b32 v103, 0
v_mov_b32 v104, 0
v_mov_b32 v105, 0
v_mov_b32 v106, 0
v_mov_b32 v107, 0
v_mov_b32 v108, 0
v_mov_b32 v109, 0
v_mov_b32 v110, 0
v_mov_b32 v111, 0
v_and_b32 v10, 15, v0
v_lshrrev_b32 v11, 4, v0
s_lshl_b32 s66, s65, 8
s_add_u32 s66, s66, 1280
s_mul_i32 s67, s64, 384
v_lshl_add_u32 v208, v10, 2, s66
v_lshl_add_u32 v209, v11, 4, s66
v_lshl_add_u32 v210, v10, 2, s67
v_lshl_add_u32 v211, v11, 4, s67
v_and_b32 v12, 1, v11
v_lshrrev_b32 v11, 1, v11
v_lshlrev_b32 v11, 9, v11
v_lshl_add_u32 v11, v12, 10, v11
s_lshl_b32 s66, s64, 12
s_lshl_b32 s67, s65, 13
s_add_u32 s66, s66, 131072
s_add_u32 s68, s66, 24576
s_sub_u32 s68, s68, s67
s_add_u32 s67, s66, s67
v_lshl_add_u32 v14, v10, 4, v11
v_and_b32 v12, 3, v0
v_lshl_add_u32 v11, v12, 4, v11
v_bfe_u32 v12, v0, 3, 1
v_lshl_add_u32 v11, v12, 6, v11
v_bfe_u32 v12, v0, 2, 1
v_lshl_add_u32 v12, v12, 8, v11
v_add_u32 v13, s68, v12
v_add_u32 v12, s67, v12
v_add_u32 v15, s68, v14
v_add_u32 v14, s67, v14
s_lshl_b32 s66, s59, 4
s_add_u32 s66, s66, s60
s_lshl_b32 s72, s59, 7
s_add_u32 s72, s72, s60
s_lshl_b32 s72, s72, 7
s_lshl_b32 s66, s66, 15
s_lshl_b32 s67, s63, 23
s_add_u32 s66, s66, s67
s_add_u32 s71, s66, 917504
v_add_u32 v4, s34, 1
s_mov_b32 s66, 15
s_mov_b32 s67, -40960
s_mov_b32 s68, -40960
s_mov_b32 s69, 81920
s_add_u32 s35, s34, 1
lw_124:
ds_read_b32 v5, v2 offset:16
s_waitcnt lgkmcnt(0)
v_cmp_gt_i32 vcc, s35, v5
s_cbranch_vccz lwd_125
s_sub_u32 s32, s32, 1
s_cmp_gt_i32 s32, 0
s_cbranch_scc1 lw_124
lwd_125:
ds_read_b64_tr_b16 v[144:145], v8 offset:8192
ds_read_b64_tr_b16 v[146:147], v8 offset:8704
ds_read_b64_tr_b16 v[148:149], v8 offset:12288
ds_read_b64_tr_b16 v[150:151], v8 offset:12800
ds_read_b128 v[112:115], v6 offset:0
ds_read_b128 v[116:119], v7 offset:0
ds_read_b64_tr_b16 v[152:153], v9 offset:8192
ds_read_b64_tr_b16 v[154:155], v9 offset:8704
ds_read_b64_tr_b16 v[156:157], v9 offset:12288
ds_read_b64_tr_b16 v[158:159], v9 offset:12800
ds_read_b128 v[120:123], v6 offset:2048
ds_read_b128 v[124:127], v7 offset:2048
ds_read_b128 v[128:131], v6 offset:4096
ds_read_b128 v[132:135], v7 offset:4096
ds_read_b128 v[136:139], v6 offset:6144
ds_read_b128 v[140:143], v7 offset:6144
.p2align 6
mqkv_126:
s_waitcnt lgkmcnt(7)
v_mfma_f32_16x16x32_bf16 v[16:19], v[144:147], v[112:115], v[16:19]
ds_read_b64_tr_b16 v[160:161], v8 offset:16384
s_waitcnt lgkmcnt(7)
v_mfma_f32_16x16x32_bf16 v[16:19], v[148:151], v[116:119], v[16:19]
ds_read_b64_tr_b16 v[162:163], v8 offset:16896
v_mfma_f32_16x16x32_bf16 v[20:23], v[152:155], v[112:115], v[20:23]
ds_read_b64_tr_b16 v[164:165], v8 offset:20480
v_mfma_f32_16x16x32_bf16 v[20:23], v[156:159], v[116:119], v[20:23]
ds_read_b64_tr_b16 v[166:167], v8 offset:20992
s_waitcnt lgkmcnt(9)
v_mfma_f32_16x16x32_bf16 v[24:27], v[144:147], v[120:123], v[24:27]
ds_read_b64_tr_b16 v[168:169], v9 offset:16384
s_waitcnt lgkmcnt(9)
v_mfma_f32_16x16x32_bf16 v[24:27], v[148:151], v[124:127], v[24:27]
ds_read_b64_tr_b16 v[170:171], v9 offset:16896
v_mfma_f32_16x16x32_bf16 v[28:31], v[152:155], v[120:123], v[28:31]
ds_read_b64_tr_b16 v[172:173], v9 offset:20480
v_mfma_f32_16x16x32_bf16 v[28:31], v[156:159], v[124:127], v[28:31]
ds_read_b64_tr_b16 v[174:175], v9 offset:20992
s_waitcnt lgkmcnt(11)
v_mfma_f32_16x16x32_bf16 v[32:35], v[144:147], v[128:131], v[32:35]
ds_read_b64_tr_b16 v[176:177], v8 offset:0
s_waitcnt lgkmcnt(11)
v_mfma_f32_16x16x32_bf16 v[32:35], v[148:151], v[132:135], v[32:35]
ds_read_b64_tr_b16 v[178:179], v8 offset:512
v_mfma_f32_16x16x32_bf16 v[36:39], v[152:155], v[128:131], v[36:39]
ds_read_b64_tr_b16 v[180:181], v8 offset:4096
v_mfma_f32_16x16x32_bf16 v[36:39], v[156:159], v[132:135], v[36:39]
ds_read_b64_tr_b16 v[182:183], v8 offset:4608
s_waitcnt lgkmcnt(13)
v_mfma_f32_16x16x32_bf16 v[40:43], v[144:147], v[136:139], v[40:43]
ds_read_b64_tr_b16 v[184:185], v9 offset:0
s_waitcnt lgkmcnt(13)
v_mfma_f32_16x16x32_bf16 v[40:43], v[148:151], v[140:143], v[40:43]
ds_read_b64_tr_b16 v[186:187], v9 offset:512
v_mfma_f32_16x16x32_bf16 v[44:47], v[152:155], v[136:139], v[44:47]
ds_read_b64_tr_b16 v[188:189], v9 offset:4096
v_mfma_f32_16x16x32_bf16 v[44:47], v[156:159], v[140:143], v[44:47]
ds_read_b64_tr_b16 v[190:191], v9 offset:4608
s_waitcnt lgkmcnt(14)
v_mfma_f32_16x16x32_bf16 v[48:51], v[112:115], v[160:163], v[48:51]
s_mov_b64 exec, 1
ds_write_b32 v3, v4
s_mov_b64 exec, -1
s_waitcnt lgkmcnt(13)
v_mfma_f32_16x16x32_bf16 v[48:51], v[116:119], v[164:167], v[48:51]
v_add_u32 v8, s67, v8
v_add_u32 v9, s67, v9
s_waitcnt lgkmcnt(11)
v_mfma_f32_16x16x32_bf16 v[52:55], v[112:115], v[168:171], v[52:55]
v_add_u32 v6, s67, v6
v_add_u32 v7, s67, v7
s_waitcnt lgkmcnt(9)
v_mfma_f32_16x16x32_bf16 v[52:55], v[116:119], v[172:175], v[52:55]
s_mov_b32 s70, s67
s_mov_b32 s67, s68
s_mov_b32 s68, s69
s_mov_b32 s69, s70
v_mfma_f32_16x16x32_bf16 v[56:59], v[120:123], v[160:163], v[56:59]
ds_read_b32 v5, v2 offset:16
v_mfma_f32_16x16x32_bf16 v[56:59], v[124:127], v[164:167], v[56:59]
v_mfma_f32_16x16x32_bf16 v[60:63], v[120:123], v[168:171], v[60:63]
v_mfma_f32_16x16x32_bf16 v[60:63], v[124:127], v[172:175], v[60:63]
v_mfma_f32_16x16x32_bf16 v[64:67], v[128:131], v[160:163], v[64:67]
s_waitcnt lgkmcnt(0)
v_cmp_ge_u32 vcc, v4, v5
s_cbranch_vccnz mspin_127
mback_128:
v_add_u32 v4, 1, v4
v_mfma_f32_16x16x32_bf16 v[64:67], v[132:135], v[164:167], v[64:67]
ds_read_b64_tr_b16 v[144:145], v8 offset:8192
v_mfma_f32_16x16x32_bf16 v[68:71], v[128:131], v[168:171], v[68:71]
ds_read_b64_tr_b16 v[146:147], v8 offset:8704
v_mfma_f32_16x16x32_bf16 v[68:71], v[132:135], v[172:175], v[68:71]
ds_read_b64_tr_b16 v[148:149], v8 offset:12288
v_mfma_f32_16x16x32_bf16 v[72:75], v[136:139], v[160:163], v[72:75]
ds_read_b64_tr_b16 v[150:151], v8 offset:12800
v_mfma_f32_16x16x32_bf16 v[72:75], v[140:143], v[164:167], v[72:75]
ds_read_b64_tr_b16 v[152:153], v9 offset:8192
v_mfma_f32_16x16x32_bf16 v[76:79], v[136:139], v[168:171], v[76:79]
ds_read_b64_tr_b16 v[154:155], v9 offset:8704
v_mfma_f32_16x16x32_bf16 v[76:79], v[140:143], v[172:175], v[76:79]
ds_read_b64_tr_b16 v[156:157], v9 offset:12288
v_mfma_f32_16x16x32_bf16 v[80:83], v[176:179], v[112:115], v[80:83]
ds_read_b64_tr_b16 v[158:159], v9 offset:12800
v_mfma_f32_16x16x32_bf16 v[80:83], v[180:183], v[116:119], v[80:83]
v_mfma_f32_16x16x32_bf16 v[84:87], v[184:187], v[112:115], v[84:87]
v_mfma_f32_16x16x32_bf16 v[84:87], v[188:191], v[116:119], v[84:87]
ds_read_b128 v[112:115], v6 offset:0
ds_read_b128 v[116:119], v7 offset:0
v_mfma_f32_16x16x32_bf16 v[88:91], v[176:179], v[120:123], v[88:91]
v_mfma_f32_16x16x32_bf16 v[88:91], v[180:183], v[124:127], v[88:91]
v_mfma_f32_16x16x32_bf16 v[92:95], v[184:187], v[120:123], v[92:95]
v_mfma_f32_16x16x32_bf16 v[92:95], v[188:191], v[124:127], v[92:95]
ds_read_b128 v[120:123], v6 offset:2048
ds_read_b128 v[124:127], v7 offset:2048
v_mfma_f32_16x16x32_bf16 v[96:99], v[176:179], v[128:131], v[96:99]
v_mfma_f32_16x16x32_bf16 v[96:99], v[180:183], v[132:135], v[96:99]
v_mfma_f32_16x16x32_bf16 v[100:103], v[184:187], v[128:131], v[100:103]
v_mfma_f32_16x16x32_bf16 v[100:103], v[188:191], v[132:135], v[100:103]
ds_read_b128 v[128:131], v6 offset:4096
ds_read_b128 v[132:135], v7 offset:4096
v_mfma_f32_16x16x32_bf16 v[104:107], v[176:179], v[136:139], v[104:107]
v_mfma_f32_16x16x32_bf16 v[104:107], v[180:183], v[140:143], v[104:107]
s_sub_u32 s66, s66, 1
s_cmp_eq_u32 s66, 0
v_mfma_f32_16x16x32_bf16 v[108:111], v[184:187], v[136:139], v[108:111]
v_mfma_f32_16x16x32_bf16 v[108:111], v[188:191], v[140:143], v[108:111]
ds_read_b128 v[136:139], v6 offset:6144
ds_read_b128 v[140:143], v7 offset:6144
s_cbranch_scc0 mqkv_126
s_waitcnt lgkmcnt(7)
v_mfma_f32_16x16x32_bf16 v[16:19], v[144:147], v[112:115], v[16:19]
ds_read_b32 v5, v2 offset:24
s_add_u32 s35, s34, 2
v_mov_b32 v6, 0
ds_read_b64_tr_b16 v[160:161], v8 offset:16384
s_waitcnt lgkmcnt(8)
v_mfma_f32_16x16x32_bf16 v[16:19], v[148:151], v[116:119], v[16:19]
ds_read_b64_tr_b16 v[162:163], v8 offset:16896
v_mfma_f32_16x16x32_bf16 v[20:23], v[152:155], v[112:115], v[20:23]
ds_read_b64_tr_b16 v[164:165], v8 offset:20480
v_mfma_f32_16x16x32_bf16 v[20:23], v[156:159], v[116:119], v[20:23]
ds_read_b64_tr_b16 v[166:167], v8 offset:20992
s_waitcnt lgkmcnt(10)
v_mfma_f32_16x16x32_bf16 v[24:27], v[144:147], v[120:123], v[24:27]
ds_read_b64_tr_b16 v[168:169], v9 offset:16384
s_waitcnt lgkmcnt(10)
v_mfma_f32_16x16x32_bf16 v[24:27], v[148:151], v[124:127], v[24:27]
ds_read_b64_tr_b16 v[170:171], v9 offset:16896
v_mfma_f32_16x16x32_bf16 v[28:31], v[152:155], v[120:123], v[28:31]
ds_read_b64_tr_b16 v[172:173], v9 offset:20480
s_waitcnt lgkmcnt(7)
v_cmp_gt_i32 vcc, s35, v5
s_cbranch_vccnz lspin_129
lback_130:
ds_read2_b32 v[6:7], v6 offset0:8 offset1:14
ds_read_b128 v[200:203], v211 offset:2432
v_mfma_f32_16x16x32_bf16 v[28:31], v[156:159], v[124:127], v[28:31]
ds_read_b64_tr_b16 v[174:175], v9 offset:20992
ds_read_b128 v[204:207], v211 offset:2496
ds_read2_b32 v[192:193], v208 offset0:0 offset1:128
v_mfma_f32_16x16x32_bf16 v[32:35], v[144:147], v[128:131], v[32:35]
ds_read2_b32 v[194:195], v208 offset0:16 offset1:144
v_mfma_f32_16x16x32_bf16 v[32:35], v[148:151], v[132:135], v[32:35]
ds_read2_b32 v[196:197], v208 offset0:32 offset1:160
ds_read2_b32 v[198:199], v208 offset0:48 offset1:176
v_mfma_f32_16x16x32_bf16 v[36:39], v[152:155], v[128:131], v[36:39]
ds_read_b64_tr_b16 v[176:177], v8 offset:0
ds_read_b64_tr_b16 v[178:179], v8 offset:512
v_mfma_f32_16x16x32_bf16 v[36:39], v[156:159], v[132:135], v[36:39]
ds_read_b64_tr_b16 v[180:181], v8 offset:4096
v_mfma_f32_16x16x32_bf16 v[40:43], v[144:147], v[136:139], v[40:43]
ds_read_b64_tr_b16 v[182:183], v8 offset:4608
ds_read_b64_tr_b16 v[184:185], v9 offset:0
v_mfma_f32_16x16x32_bf16 v[40:43], v[148:151], v[140:143], v[40:43]
ds_read_b64_tr_b16 v[186:187], v9 offset:512
ds_read_b64_tr_b16 v[188:189], v9 offset:4096
v_mfma_f32_16x16x32_bf16 v[44:47], v[152:155], v[136:139], v[44:47]
ds_read_b64_tr_b16 v[190:191], v9 offset:4608
v_mfma_f32_16x16x32_bf16 v[44:47], v[156:159], v[140:143], v[44:47]
s_mov_b64 exec, 1
ds_write_b32 v3, v4
s_mov_b64 exec, -1
s_waitcnt lgkmcnt(14)
v_readfirstlane_b32 s33, v6
v_readfirstlane_b32 s57, v7
s_sub_u32 s33, s33, 1
s_lshr_b32 s66, s33, 7
s_mov_b32 s73, -1
v_mfma_f32_16x16x32_bf16 v[48:51], v[112:115], v[160:163], v[48:51]
s_cmp_eq_u32 s66, s59
s_cbranch_scc1 patch_131
pback_132:
v_mfma_f32_16x16x32_bf16 v[48:51], v[116:119], v[164:167], v[48:51]
ds_read_b32 v10, v210 offset:2560
ds_read_b32 v11, v210 offset:2624
s_waitcnt lgkmcnt(14)
v_mul_f32 v16, v16, v192
v_mul_f32 v17, v17, v192
v_mul_f32 v18, v18, v192
v_mfma_f32_16x16x32_bf16 v[52:55], v[112:115], v[168:171], v[52:55]
v_mul_f32 v19, v19, v192
v_mul_f32 v20, v20, v192
v_mul_f32 v21, v21, v192
v_mul_f32 v22, v22, v192
v_mul_f32 v23, v23, v192
v_mfma_f32_16x16x32_bf16 v[52:55], v[116:119], v[172:175], v[52:55]
v_fmac_f32 v16, v200, v193
v_fmac_f32 v17, v201, v193
v_fmac_f32 v18, v202, v193
v_fmac_f32 v19, v203, v193
v_fmac_f32 v20, v204, v193
v_mfma_f32_16x16x32_bf16 v[56:59], v[120:123], v[160:163], v[56:59]
v_fmac_f32 v21, v205, v193
v_fmac_f32 v22, v206, v193
v_fmac_f32 v23, v207, v193
v_cvt_pk_bf16_f32 v16, v16, v17
v_cvt_pk_bf16_f32 v17, v18, v19
v_mfma_f32_16x16x32_bf16 v[56:59], v[124:127], v[164:167], v[56:59]
v_cvt_pk_bf16_f32 v18, v20, v21
v_cvt_pk_bf16_f32 v19, v22, v23
buffer_store_dwordx4 v[16:19], v12, s[20:23], s71 offen offset:0 sc1
ds_write_b128 v12, v[16:19] offset:0
ds_read_b128 v[144:147], v209 offset:0
v_mfma_f32_16x16x32_bf16 v[60:63], v[120:123], v[168:171], v[60:63]
ds_read_b128 v[20:23], v209 offset:512
s_waitcnt lgkmcnt(14)
v_mul_f32 v24, v24, v194
v_mul_f32 v25, v25, v194
v_mul_f32 v26, v26, v194
v_mul_f32 v27, v27, v194
v_mfma_f32_16x16x32_bf16 v[60:63], v[124:127], v[172:175], v[60:63]
v_mul_f32 v28, v28, v194
v_mul_f32 v29, v29, v194
v_mul_f32 v30, v30, v194
v_mul_f32 v31, v31, v194
v_fmac_f32 v24, v200, v195
v_mfma_f32_16x16x32_bf16 v[64:67], v[128:131], v[160:163], v[64:67]
v_fmac_f32 v25, v201, v195
v_fmac_f32 v26, v202, v195
v_fmac_f32 v27, v203, v195
v_fmac_f32 v28, v204, v195
v_mfma_f32_16x16x32_bf16 v[64:67], v[132:135], v[164:167], v[64:67]
v_fmac_f32 v29, v205, v195
v_fmac_f32 v30, v206, v195
v_fmac_f32 v31, v207, v195
v_cvt_pk_bf16_f32 v24, v24, v25
v_cvt_pk_bf16_f32 v25, v26, v27
v_mfma_f32_16x16x32_bf16 v[68:71], v[128:131], v[168:171], v[68:71]
v_cvt_pk_bf16_f32 v26, v28, v29
v_cvt_pk_bf16_f32 v27, v30, v31
buffer_store_dwordx4 v[24:27], v12, s[20:23], s71 offen offset:128 sc1
ds_write_b128 v12, v[24:27] offset:128
ds_read_b128 v[148:151], v209 offset:64
v_mfma_f32_16x16x32_bf16 v[68:71], v[132:135], v[172:175], v[68:71]
ds_read_b128 v[28:31], v209 offset:576
v_mul_f32 v32, v32, v196
v_mul_f32 v33, v33, v196
v_mul_f32 v34, v34, v196
v_mul_f32 v35, v35, v196
v_mfma_f32_16x16x32_bf16 v[72:75], v[136:139], v[160:163], v[72:75]
v_mul_f32 v36, v36, v196
v_mul_f32 v37, v37, v196
v_mul_f32 v38, v38, v196
v_mul_f32 v39, v39, v196
v_fmac_f32 v32, v200, v197
v_mfma_f32_16x16x32_bf16 v[72:75], v[140:143], v[164:167], v[72:75]
v_fmac_f32 v33, v201, v197
v_fmac_f32 v34, v202, v197
v_fmac_f32 v35, v203, v197
v_fmac_f32 v36, v204, v197
v_fmac_f32 v37, v205, v197
v_mfma_f32_16x16x32_bf16 v[76:79], v[136:139], v[168:171], v[76:79]
v_fmac_f32 v38, v206, v197
v_fmac_f32 v39, v207, v197
v_cvt_pk_bf16_f32 v32, v32, v33
v_cvt_pk_bf16_f32 v33, v34, v35
v_cvt_pk_bf16_f32 v34, v36, v37
v_mfma_f32_16x16x32_bf16 v[76:79], v[140:143], v[172:175], v[76:79]
v_cvt_pk_bf16_f32 v35, v38, v39
buffer_store_dwordx4 v[32:35], v13, s[20:23], s71 offen offset:0 sc1
ds_write_b128 v13, v[32:35] offset:0
ds_read_b128 v[152:155], v209 offset:128
ds_read_b128 v[36:39], v209 offset:640
v_mul_f32 v40, v40, v198
v_mul_f32 v41, v41, v198
v_mul_f32 v42, v42, v198
v_mul_f32 v43, v43, v198
v_mul_f32 v44, v44, v198
v_mul_f32 v45, v45, v198
v_mul_f32 v46, v46, v198
v_mul_f32 v47, v47, v198
v_fmac_f32 v40, v200, v199
v_fmac_f32 v41, v201, v199
v_fmac_f32 v42, v202, v199
v_fmac_f32 v43, v203, v199
v_fmac_f32 v44, v204, v199
v_fmac_f32 v45, v205, v199
v_fmac_f32 v46, v206, v199
v_fmac_f32 v47, v207, v199
v_cvt_pk_bf16_f32 v40, v40, v41
v_cvt_pk_bf16_f32 v41, v42, v43
v_cvt_pk_bf16_f32 v42, v44, v45
v_cvt_pk_bf16_f32 v43, v46, v47
buffer_store_dwordx4 v[40:43], v13, s[20:23], s71 offen offset:128 sc1
ds_write_b128 v13, v[40:43] offset:128
ds_read_b128 v[156:159], v209 offset:192
ds_read_b128 v[44:47], v209 offset:704
s_cmp_ge_i32 s73, 0
s_cbranch_scc1 patch_133
pback_134:
ds_read_b128 v[160:163], v211 offset:2304
ds_read_b128 v[164:167], v211 offset:2368
s_waitcnt lgkmcnt(12)
v_pk_mul_f32 v[48:49], v[48:49], v[144:145]
v_pk_mul_f32 v[50:51], v[50:51], v[146:147]
s_waitcnt lgkmcnt(11)
v_pk_fma_f32 v[48:49], v[20:21], v[10:11], v[48:49] op_sel:[0,0,0] op_sel_hi:[1,0,1]
v_pk_fma_f32 v[50:51], v[22:23], v[10:11], v[50:51] op_sel:[0,0,0] op_sel_hi:[1,0,1]
s_waitcnt lgkmcnt(9)
v_pk_mul_f32 v[56:57], v[56:57], v[148:149]
v_pk_mul_f32 v[58:59], v[58:59], v[150:151]
s_waitcnt lgkmcnt(8)
v_pk_fma_f32 v[56:57], v[28:29], v[10:11], v[56:57] op_sel:[0,0,0] op_sel_hi:[1,0,1]
v_pk_fma_f32 v[58:59], v[30:31], v[10:11], v[58:59] op_sel:[0,0,0] op_sel_hi:[1,0,1]
v_cvt_pk_bf16_f32 v48, v48, v49
v_cvt_pk_bf16_f32 v49, v50, v51
v_cvt_pk_bf16_f32 v50, v56, v57
v_cvt_pk_bf16_f32 v51, v58, v59
buffer_store_dwordx4 v[48:51], v14, s[20:23], s71 offen offset:2048 sc1
ds_write_b128 v14, v[48:51] offset:2048
v_pk_mul_f32 v[52:53], v[52:53], v[144:145]
v_pk_mul_f32 v[54:55], v[54:55], v[146:147]
v_pk_fma_f32 v[52:53], v[20:21], v[10:11], v[52:53] op_sel:[0,1,0] op_sel_hi:[1,1,1]
v_pk_fma_f32 v[54:55], v[22:23], v[10:11], v[54:55] op_sel:[0,1,0] op_sel_hi:[1,1,1]
v_pk_mul_f32 v[60:61], v[60:61], v[148:149]
v_pk_mul_f32 v[62:63], v[62:63], v[150:151]
v_pk_fma_f32 v[60:61], v[28:29], v[10:11], v[60:61] op_sel:[0,1,0] op_sel_hi:[1,1,1]
v_pk_fma_f32 v[62:63], v[30:31], v[10:11], v[62:63] op_sel:[0,1,0] op_sel_hi:[1,1,1]
v_cvt_pk_bf16_f32 v52, v52, v53
v_cvt_pk_bf16_f32 v53, v54, v55
v_cvt_pk_bf16_f32 v54, v60, v61
v_cvt_pk_bf16_f32 v55, v62, v63
buffer_store_dwordx4 v[52:55], v14, s[20:23], s71 offen offset:2304 sc1
ds_write_b128 v14, v[52:55] offset:2304
s_waitcnt lgkmcnt(8)
v_pk_mul_f32 v[64:65], v[64:65], v[152:153]
v_pk_mul_f32 v[66:67], v[66:67], v[154:155]
s_waitcnt lgkmcnt(7)
v_pk_fma_f32 v[64:65], v[36:37], v[10:11], v[64:65] op_sel:[0,0,0] op_sel_hi:[1,0,1]
v_pk_fma_f32 v[66:67], v[38:39], v[10:11], v[66:67] op_sel:[0,0,0] op_sel_hi:[1,0,1]
s_waitcnt lgkmcnt(5)
v_pk_mul_f32 v[72:73], v[72:73], v[156:157]
v_pk_mul_f32 v[74:75], v[74:75], v[158:159]
s_waitcnt lgkmcnt(4)
v_pk_fma_f32 v[72:73], v[44:45], v[10:11], v[72:73] op_sel:[0,0,0] op_sel_hi:[1,0,1]
v_pk_fma_f32 v[74:75], v[46:47], v[10:11], v[74:75] op_sel:[0,0,0] op_sel_hi:[1,0,1]
v_cvt_pk_bf16_f32 v64, v64, v65
v_cvt_pk_bf16_f32 v65, v66, v67
v_cvt_pk_bf16_f32 v66, v72, v73
v_cvt_pk_bf16_f32 v67, v74, v75
buffer_store_dwordx4 v[64:67], v15, s[20:23], s71 offen offset:2048 sc1
ds_write_b128 v15, v[64:67] offset:2048
v_pk_mul_f32 v[68:69], v[68:69], v[152:153]
v_pk_mul_f32 v[70:71], v[70:71], v[154:155]
v_pk_fma_f32 v[68:69], v[36:37], v[10:11], v[68:69] op_sel:[0,1,0] op_sel_hi:[1,1,1]
v_pk_fma_f32 v[70:71], v[38:39], v[10:11], v[70:71] op_sel:[0,1,0] op_sel_hi:[1,1,1]
v_pk_mul_f32 v[76:77], v[76:77], v[156:157]
v_pk_mul_f32 v[78:79], v[78:79], v[158:159]
v_pk_fma_f32 v[76:77], v[44:45], v[10:11], v[76:77] op_sel:[0,1,0] op_sel_hi:[1,1,1]
v_pk_fma_f32 v[78:79], v[46:47], v[10:11], v[78:79] op_sel:[0,1,0] op_sel_hi:[1,1,1]
v_cvt_pk_bf16_f32 v68, v68, v69
v_cvt_pk_bf16_f32 v69, v70, v71
v_cvt_pk_bf16_f32 v70, v76, v77
v_cvt_pk_bf16_f32 v71, v78, v79
buffer_store_dwordx4 v[68:71], v15, s[20:23], s71 offen offset:2304 sc1
ds_write_b128 v15, v[68:71] offset:2304
v_add_u32 v5, s34, 17
s_mov_b64 exec, 1
ds_write_b32 v3, v5
s_mov_b64 exec, -1
s_mov_b32 s66, 0x3e8293ee
v_mfma_f32_16x16x32_bf16 v[96:99], v[176:179], v[128:131], v[96:99]
v_mul_f32 v192, s66, v192
v_mfma_f32_16x16x32_bf16 v[96:99], v[180:183], v[132:135], v[96:99]
v_mfma_f32_16x16x32_bf16 v[100:103], v[184:187], v[128:131], v[100:103]
v_mul_f32 v193, s66, v193
v_mfma_f32_16x16x32_bf16 v[100:103], v[188:191], v[132:135], v[100:103]
v_mfma_f32_16x16x32_bf16 v[104:107], v[176:179], v[136:139], v[104:107]
v_mul_f32 v194, s66, v194
v_mfma_f32_16x16x32_bf16 v[104:107], v[180:183], v[140:143], v[104:107]
v_mfma_f32_16x16x32_bf16 v[108:111], v[184:187], v[136:139], v[108:111]
v_mul_f32 v195, s66, v195
v_mfma_f32_16x16x32_bf16 v[108:111], v[188:191], v[140:143], v[108:111]
v_mfma_f32_16x16x32_bf16 v[80:83], v[176:179], v[112:115], v[80:83]
v_mul_f32 v196, s66, v196
v_mfma_f32_16x16x32_bf16 v[80:83], v[180:183], v[116:119], v[80:83]
v_mfma_f32_16x16x32_bf16 v[84:87], v[184:187], v[112:115], v[84:87]
v_mul_f32 v197, s66, v197
v_mfma_f32_16x16x32_bf16 v[84:87], v[188:191], v[116:119], v[84:87]
v_mfma_f32_16x16x32_bf16 v[88:91], v[176:179], v[120:123], v[88:91]
v_mul_f32 v198, s66, v198
v_mfma_f32_16x16x32_bf16 v[88:91], v[180:183], v[124:127], v[88:91]
v_mfma_f32_16x16x32_bf16 v[92:95], v[184:187], v[120:123], v[92:95]
v_mul_f32 v199, s66, v199
v_mfma_f32_16x16x32_bf16 v[92:95], v[188:191], v[124:127], v[92:95]
s_cmp_ge_i32 s73, 0
s_cbranch_scc1 patch_135
pback_136:
v_mov_b32 v200, 0
v_mov_b32 v201, 0
v_mov_b32 v202, 0
v_mov_b32 v203, 0
v_mov_b32 v204, 0
v_mov_b32 v205, 0
v_mov_b32 v206, 0
v_mov_b32 v207, 0
v_mov_b32 v208, 0
v_mov_b32 v209, 0
v_mov_b32 v210, 0
v_mov_b32 v211, 0
v_pk_mul_f32 v[96:97], v[96:97], v[196:197] op_sel:[0,0] op_sel_hi:[1,0]
v_pk_mul_f32 v[98:99], v[98:99], v[196:197] op_sel:[0,0] op_sel_hi:[1,0]
v_pk_mul_f32 v[100:101], v[100:101], v[196:197] op_sel:[0,0] op_sel_hi:[1,0]
v_pk_mul_f32 v[102:103], v[102:103], v[196:197] op_sel:[0,0] op_sel_hi:[1,0]
s_waitcnt lgkmcnt(6)
v_pk_fma_f32 v[96:97], v[160:161], v[196:197], v[96:97] op_sel:[0,1,0] op_sel_hi:[1,1,1]
v_pk_fma_f32 v[98:99], v[162:163], v[196:197], v[98:99] op_sel:[0,1,0] op_sel_hi:[1,1,1]
s_waitcnt lgkmcnt(5)
v_pk_fma_f32 v[100:101], v[164:165], v[196:197], v[100:101] op_sel:[0,1,0] op_sel_hi:[1,1,1]
v_pk_fma_f32 v[102:103], v[166:167], v[196:197], v[102:103] op_sel:[0,1,0] op_sel_hi:[1,1,1]
v_cvt_pk_bf16_f32 v96, v96, v97
v_cvt_pk_bf16_f32 v97, v98, v99
v_cvt_pk_bf16_f32 v98, v100, v101
v_cvt_pk_bf16_f32 v99, v102, v103
v_pk_mul_f32 v[104:105], v[104:105], v[198:199] op_sel:[0,0] op_sel_hi:[1,0]
v_pk_mul_f32 v[106:107], v[106:107], v[198:199] op_sel:[0,0] op_sel_hi:[1,0]
v_pk_mul_f32 v[108:109], v[108:109], v[198:199] op_sel:[0,0] op_sel_hi:[1,0]
v_pk_mul_f32 v[110:111], v[110:111], v[198:199] op_sel:[0,0] op_sel_hi:[1,0]
v_pk_fma_f32 v[104:105], v[160:161], v[198:199], v[104:105] op_sel:[0,1,0] op_sel_hi:[1,1,1]
v_pk_fma_f32 v[106:107], v[162:163], v[198:199], v[106:107] op_sel:[0,1,0] op_sel_hi:[1,1,1]
v_pk_fma_f32 v[108:109], v[164:165], v[198:199], v[108:109] op_sel:[0,1,0] op_sel_hi:[1,1,1]
v_pk_fma_f32 v[110:111], v[166:167], v[198:199], v[110:111] op_sel:[0,1,0] op_sel_hi:[1,1,1]
v_cvt_pk_bf16_f32 v104, v104, v105
v_cvt_pk_bf16_f32 v105, v106, v107
v_cvt_pk_bf16_f32 v106, v108, v109
v_cvt_pk_bf16_f32 v107, v110, v111
v_pk_mul_f32 v[80:81], v[80:81], v[192:193] op_sel:[0,0] op_sel_hi:[1,0]
v_pk_mul_f32 v[82:83], v[82:83], v[192:193] op_sel:[0,0] op_sel_hi:[1,0]
v_pk_mul_f32 v[84:85], v[84:85], v[192:193] op_sel:[0,0] op_sel_hi:[1,0]
v_pk_mul_f32 v[86:87], v[86:87], v[192:193] op_sel:[0,0] op_sel_hi:[1,0]
v_pk_fma_f32 v[80:81], v[160:161], v[192:193], v[80:81] op_sel:[0,1,0] op_sel_hi:[1,1,1]
v_pk_fma_f32 v[82:83], v[162:163], v[192:193], v[82:83] op_sel:[0,1,0] op_sel_hi:[1,1,1]
v_pk_fma_f32 v[84:85], v[164:165], v[192:193], v[84:85] op_sel:[0,1,0] op_sel_hi:[1,1,1]
v_pk_fma_f32 v[86:87], v[166:167], v[192:193], v[86:87] op_sel:[0,1,0] op_sel_hi:[1,1,1]
v_cvt_pk_bf16_f32 v80, v80, v81
v_cvt_pk_bf16_f32 v81, v82, v83
v_cvt_pk_bf16_f32 v82, v84, v85
v_cvt_pk_bf16_f32 v83, v86, v87
v_pk_mul_f32 v[88:89], v[88:89], v[194:195] op_sel:[0,0] op_sel_hi:[1,0]
v_pk_mul_f32 v[90:91], v[90:91], v[194:195] op_sel:[0,0] op_sel_hi:[1,0]
v_pk_mul_f32 v[92:93], v[92:93], v[194:195] op_sel:[0,0] op_sel_hi:[1,0]
v_pk_mul_f32 v[94:95], v[94:95], v[194:195] op_sel:[0,0] op_sel_hi:[1,0]
v_pk_fma_f32 v[88:89], v[160:161], v[194:195], v[88:89] op_sel:[0,1,0] op_sel_hi:[1,1,1]
v_pk_fma_f32 v[90:91], v[162:163], v[194:195], v[90:91] op_sel:[0,1,0] op_sel_hi:[1,1,1]
v_pk_fma_f32 v[92:93], v[164:165], v[194:195], v[92:93] op_sel:[0,1,0] op_sel_hi:[1,1,1]
v_pk_fma_f32 v[94:95], v[166:167], v[194:195], v[94:95] op_sel:[0,1,0] op_sel_hi:[1,1,1]
v_cvt_pk_bf16_f32 v88, v88, v89
v_cvt_pk_bf16_f32 v89, v90, v91
v_cvt_pk_bf16_f32 v90, v92, v93
v_cvt_pk_bf16_f32 v91, v94, v95
v_permlane16_swap_b32 v96, v104
v_permlane16_swap_b32 v97, v105
v_permlane16_swap_b32 v98, v106
v_permlane16_swap_b32 v99, v107
v_permlane16_swap_b32 v80, v88
v_permlane16_swap_b32 v81, v89
v_permlane16_swap_b32 v82, v90
v_permlane16_swap_b32 v83, v91
v_mov_b32 v192, 0
v_mov_b32 v193, 0
v_mov_b32 v194, 0
v_mov_b32 v195, 0
v_mov_b32 v196, 0
v_mov_b32 v197, 0
v_mov_b32 v198, 0
v_mov_b32 v199, 0
s_lshl_b32 s69, s64, 12
v_lshl_add_u32 v6, v0, 4, s69
v_add_u32 v7, 131072, v6
s_lshl_b32 s69, s65, 13
s_add_u32 s66, s69, 131072
s_sub_u32 s69, 147456, s69
v_add_u32 v8, s69, v6
ds_read_b128 v[152:155], v8 offset:8192
ds_read_b128 v[156:159], v8 offset:9216
s_mov_b32 s67, 122880
s_min_u32 s69, s59, 1
s_lshl2_add_u32 s68, s69, s65
s_cmp_ge_u32 s59, 2
s_cselect_b32 s69, s65, 0
s_add_u32 s68, s68, s69
ds_read_b128 v[160:163], v8 offset:10240
ds_read_b128 v[164:167], v8 offset:11264
s_waitcnt lgkmcnt(3)
v_mfma_f32_32x32x16_bf16 v[112:127], v[152:155], v[96:99], v[216:231]
s_waitcnt lgkmcnt(2)
v_mfma_f32_32x32x16_bf16 v[112:127], v[156:159], v[104:107], v[112:127]
s_add_u32 s35, s34, 17
lw_137:
ds_read_b32 v5, v1 offset:0
s_waitcnt lgkmcnt(0)
v_cmp_gt_i32 vcc, s35, v5
s_cbranch_vccz lwd_138
s_sub_u32 s32, s32, 1
s_cmp_gt_i32 s32, 0
s_cbranch_scc1 lw_137
lwd_138:
ds_read_b128 v[152:155], v8 offset:0
ds_read_b128 v[156:159], v8 offset:1024
s_add_u32 s70, s72, 270336
s_mov_b64 exec, 1
s_waitcnt vmcnt(0)
buffer_store_dword v7, v3, s[24:27], s70 offen sc1
s_mov_b64 exec, -1
.p2align 3
v_exp_f32 v112, v112
v_exp_f32 v113, v113
v_exp_f32 v114, v114
v_exp_f32 v115, v115
v_exp_f32 v116, v116
v_exp_f32 v117, v117
s_waitcnt lgkmcnt(1)
v_mfma_f32_32x32x16_bf16 v[128:143], v[152:155], v[96:99], 0
v_exp_f32 v118, v118
v_exp_f32 v119, v119
v_cvt_pk_bf16_f32 v144, v112, v113
v_cvt_pk_bf16_f32 v145, v114, v115
s_waitcnt lgkmcnt(0)
v_mfma_f32_32x32x16_bf16 v[128:143], v[156:159], v[104:107], v[128:143]
ds_read_b128 v[152:155], v7 offset:8192
ds_read_b128 v[156:159], v7 offset:9216
v_cvt_pk_bf16_f32 v146, v116, v117
v_cvt_pk_bf16_f32 v147, v118, v119
v_exp_f32 v120, v120
v_exp_f32 v121, v121
v_mfma_f32_32x32x16_bf16 v[16:31], v[160:163], v[144:147], 0
ds_read_b128 v[160:163], v8 offset:2048
v_exp_f32 v122, v122
v_exp_f32 v123, v123
v_exp_f32 v124, v124
v_mfma_f32_16x16x32_bf16 v[32:35], v[212:215], v[144:147], 0
s_cmp_eq_u32 s65, 1
v_exp_f32 v125, v125
v_exp_f32 v126, v126
v_exp_f32 v127, v127
v_cvt_pk_bf16_f32 v148, v120, v121
v_cvt_pk_bf16_f32 v149, v122, v123
v_cvt_pk_bf16_f32 v150, v124, v125
v_cvt_pk_bf16_f32 v151, v126, v127
s_cbranch_scc1 at_139
v_exp_f32 v128, v128
v_exp_f32 v129, v129
v_mfma_f32_32x32x16_bf16 v[16:31], v[164:167], v[148:151], v[16:31]
ds_read_b128 v[164:167], v8 offset:3072
v_exp_f32 v130, v130
v_exp_f32 v131, v131
v_exp_f32 v132, v132
v_mfma_f32_16x16x32_bf16 v[32:35], v[212:215], v[148:151], v[32:35]
v_exp_f32 v133, v133
s_waitcnt lgkmcnt(3)
v_mfma_f32_32x32x16_bf16 v[112:127], v[152:155], v[96:99], 0
v_exp_f32 v134, v134
v_exp_f32 v135, v135
v_cvt_pk_bf16_f32 v144, v128, v129
v_cvt_pk_bf16_f32 v145, v130, v131
s_waitcnt lgkmcnt(2)
v_mfma_f32_32x32x16_bf16 v[112:127], v[156:159], v[104:107], v[112:127]
ds_read_b128 v[152:155], v7 offset:0
ds_read_b128 v[156:159], v7 offset:1024
v_cvt_pk_bf16_f32 v146, v132, v133
v_cvt_pk_bf16_f32 v147, v134, v135
v_exp_f32 v136, v136
v_exp_f32 v137, v137
s_waitcnt lgkmcnt(3)
v_mfma_f32_32x32x16_bf16 v[16:31], v[160:163], v[144:147], v[16:31]
ds_read_b128 v[160:163], v7 offset:10240
v_exp_f32 v138, v138
v_exp_f32 v139, v139
v_exp_f32 v140, v140
v_mfma_f32_16x16x32_bf16 v[32:35], v[212:215], v[144:147], v[32:35]
v_exp_f32 v141, v141
v_exp_f32 v142, v142
v_exp_f32 v143, v143
v_cvt_pk_bf16_f32 v148, v136, v137
v_cvt_pk_bf16_f32 v149, v138, v139
v_cvt_pk_bf16_f32 v150, v140, v141
v_cvt_pk_bf16_f32 v151, v142, v143
v_exp_f32 v112, v112
v_exp_f32 v113, v113
s_waitcnt lgkmcnt(3)
v_mfma_f32_32x32x16_bf16 v[16:31], v[164:167], v[148:151], v[16:31]
ds_read_b128 v[164:167], v7 offset:11264
v_exp_f32 v114, v114
v_exp_f32 v115, v115
v_exp_f32 v116, v116
v_mfma_f32_16x16x32_bf16 v[32:35], v[212:215], v[148:151], v[32:35]
v_exp_f32 v117, v117
s_waitcnt lgkmcnt(3)
v_mfma_f32_32x32x16_bf16 v[128:143], v[152:155], v[96:99], 0
v_exp_f32 v118, v118
v_exp_f32 v119, v119
v_cvt_pk_bf16_f32 v144, v112, v113
v_cvt_pk_bf16_f32 v145, v114, v115
s_waitcnt lgkmcnt(2)
v_mfma_f32_32x32x16_bf16 v[128:143], v[156:159], v[104:107], v[128:143]
v_cvt_pk_bf16_f32 v146, v116, v117
v_cvt_pk_bf16_f32 v147, v118, v119
v_exp_f32 v120, v120
v_exp_f32 v121, v121
s_waitcnt lgkmcnt(1)
v_mfma_f32_32x32x16_bf16 v[16:31], v[160:163], v[144:147], v[16:31]
ds_read_b128 v[160:163], v7 offset:2048
v_exp_f32 v122, v122
v_exp_f32 v123, v123
v_exp_f32 v124, v124
v_mfma_f32_16x16x32_bf16 v[32:35], v[212:215], v[144:147], v[32:35]
v_mov_b32 v8, v7
v_exp_f32 v125, v125
v_exp_f32 v126, v126
v_exp_f32 v127, v127
v_cvt_pk_bf16_f32 v148, v120, v121
v_cvt_pk_bf16_f32 v149, v122, v123
v_cvt_pk_bf16_f32 v150, v124, v125
v_cvt_pk_bf16_f32 v151, v126, v127
.p2align 3
at_139:
v_exp_f32 v128, v128
v_exp_f32 v129, v129
s_waitcnt lgkmcnt(1)
v_mfma_f32_32x32x16_bf16 v[16:31], v[164:167], v[148:151], v[16:31]
ds_read_b128 v[164:167], v8 offset:3072
v_exp_f32 v130, v130
v_exp_f32 v131, v131
v_exp_f32 v132, v132
v_mfma_f32_16x16x32_bf16 v[32:35], v[212:215], v[148:151], v[32:35]
v_exp_f32 v133, v133
v_mfma_f32_32x32x16_bf16 v[112:127], v[152:155], v[80:83], v[216:231]
v_exp_f32 v134, v134
v_exp_f32 v135, v135
v_cvt_pk_bf16_f32 v144, v128, v129
v_cvt_pk_bf16_f32 v145, v130, v131
v_mfma_f32_32x32x16_bf16 v[112:127], v[156:159], v[88:91], v[112:127]
s_sub_u32 s66, s66, 8192
s_cmp_eq_u32 s66, s67
s_cbranch_scc1 cross_146
cback_147:
v_add_u32 v8, s66, v6
ds_read_b128 v[152:155], v8 offset:0
ds_read_b128 v[156:159], v8 offset:1024
v_cvt_pk_bf16_f32 v146, v132, v133
v_cvt_pk_bf16_f32 v147, v134, v135
v_exp_f32 v136, v136
v_exp_f32 v137, v137
s_waitcnt lgkmcnt(3)
v_mfma_f32_32x32x16_bf16 v[16:31], v[160:163], v[144:147], v[16:31]
v_exp_f32 v138, v138
v_exp_f32 v139, v139
v_exp_f32 v140, v140
v_mfma_f32_16x16x32_bf16 v[32:35], v[212:215], v[144:147], v[32:35]
s_cmp_eq_u32 s68, 0
v_exp_f32 v141, v141
v_exp_f32 v142, v142
v_exp_f32 v143, v143
v_cvt_pk_bf16_f32 v148, v136, v137
v_cvt_pk_bf16_f32 v149, v138, v139
v_cvt_pk_bf16_f32 v150, v140, v141
v_cvt_pk_bf16_f32 v151, v142, v143
s_cbranch_scc1 at_143
.p2align 3
at_140:
v_exp_f32 v112, v112
v_exp_f32 v113, v113
s_waitcnt lgkmcnt(2)
v_mfma_f32_32x32x16_bf16 v[16:31], v[164:167], v[148:151], v[16:31]
v_exp_f32 v114, v114
v_exp_f32 v115, v115
v_exp_f32 v116, v116
v_mfma_f32_16x16x32_bf16 v[32:35], v[212:215], v[148:151], v[32:35]
v_exp_f32 v117, v117
s_waitcnt lgkmcnt(1)
v_mfma_f32_32x32x16_bf16 v[128:143], v[152:155], v[96:99], 0
v_exp_f32 v118, v118
v_exp_f32 v119, v119
v_cvt_pk_bf16_f32 v144, v112, v113
v_cvt_pk_bf16_f32 v145, v114, v115
s_waitcnt lgkmcnt(0)
v_mfma_f32_32x32x16_bf16 v[128:143], v[156:159], v[104:107], v[128:143]
v_cvt_pk_bf16_f32 v146, v116, v117
v_cvt_pk_bf16_f32 v147, v118, v119
v_exp_f32 v120, v120
v_exp_f32 v121, v121
v_mfma_f32_32x32x16_bf16 v[192:207], v[160:163], v[144:147], v[192:207]
ds_read_b128 v[160:163], v8 offset:2048
v_exp_f32 v122, v122
v_exp_f32 v123, v123
v_exp_f32 v124, v124
v_mfma_f32_16x16x32_bf16 v[208:211], v[212:215], v[144:147], v[208:211]
v_exp_f32 v125, v125
v_exp_f32 v126, v126
v_exp_f32 v127, v127
v_cvt_pk_bf16_f32 v148, v120, v121
v_cvt_pk_bf16_f32 v149, v122, v123
v_cvt_pk_bf16_f32 v150, v124, v125
v_cvt_pk_bf16_f32 v151, v126, v127
v_exp_f32 v128, v128
v_exp_f32 v129, v129
v_mfma_f32_32x32x16_bf16 v[192:207], v[164:167], v[148:151], v[192:207]
ds_read_b128 v[164:167], v8 offset:3072
v_exp_f32 v130, v130
v_exp_f32 v131, v131
v_exp_f32 v132, v132
v_mfma_f32_16x16x32_bf16 v[208:211], v[212:215], v[148:151], v[208:211]
v_exp_f32 v133, v133
v_mfma_f32_32x32x16_bf16 v[112:127], v[152:155], v[80:83], 0
v_exp_f32 v134, v134
v_exp_f32 v135, v135
v_cvt_pk_bf16_f32 v144, v128, v129
v_cvt_pk_bf16_f32 v145, v130, v131
v_mfma_f32_32x32x16_bf16 v[112:127], v[156:159], v[88:91], v[112:127]
s_sub_u32 s66, s66, 8192
s_cmp_eq_u32 s66, s67
s_cbranch_scc1 cross_148
cback_149:
v_add_u32 v8, s66, v6
ds_read_b128 v[152:155], v8 offset:0
ds_read_b128 v[156:159], v8 offset:1024
v_cvt_pk_bf16_f32 v146, v132, v133
v_cvt_pk_bf16_f32 v147, v134, v135
v_exp_f32 v136, v136
v_exp_f32 v137, v137
s_waitcnt lgkmcnt(3)
v_mfma_f32_32x32x16_bf16 v[16:31], v[160:163], v[144:147], v[16:31]
v_exp_f32 v138, v138
v_exp_f32 v139, v139
v_exp_f32 v140, v140
v_mfma_f32_16x16x32_bf16 v[32:35], v[212:215], v[144:147], v[32:35]
s_sub_u32 s68, s68, 1
s_cmp_eq_u32 s68, 0
v_exp_f32 v141, v141
v_exp_f32 v142, v142
v_exp_f32 v143, v143
v_cvt_pk_bf16_f32 v148, v136, v137
v_cvt_pk_bf16_f32 v149, v138, v139
v_cvt_pk_bf16_f32 v150, v140, v141
v_cvt_pk_bf16_f32 v151, v142, v143
s_cbranch_scc0 at_140
s_cmp_lt_u32 s59, 2
s_cbranch_scc1 at_143
.p2align 3
v_exp_f32 v112, v112
v_exp_f32 v113, v113
s_waitcnt lgkmcnt(2)
v_mfma_f32_32x32x16_bf16 v[16:31], v[164:167], v[148:151], v[16:31]
v_exp_f32 v114, v114
v_exp_f32 v115, v115
v_exp_f32 v116, v116
v_mfma_f32_16x16x32_bf16 v[32:35], v[212:215], v[148:151], v[32:35]
v_exp_f32 v117, v117
s_waitcnt lgkmcnt(1)
v_mfma_f32_32x32x16_bf16 v[128:143], v[152:155], v[96:99], v[216:231]
v_exp_f32 v118, v118
v_exp_f32 v119, v119
v_cvt_pk_bf16_f32 v144, v112, v113
v_cvt_pk_bf16_f32 v145, v114, v115
s_waitcnt lgkmcnt(0)
v_mfma_f32_32x32x16_bf16 v[128:143], v[156:159], v[104:107], v[128:143]
v_cvt_pk_bf16_f32 v146, v116, v117
v_cvt_pk_bf16_f32 v147, v118, v119
v_exp_f32 v120, v120
v_exp_f32 v121, v121
v_mfma_f32_32x32x16_bf16 v[192:207], v[160:163], v[144:147], v[192:207]
ds_read_b128 v[160:163], v8 offset:2048
v_exp_f32 v122, v122
v_exp_f32 v123, v123
v_exp_f32 v124, v124
v_mfma_f32_16x16x32_bf16 v[208:211], v[212:215], v[144:147], v[208:211]
v_exp_f32 v125, v125
v_exp_f32 v126, v126
v_exp_f32 v127, v127
v_cvt_pk_bf16_f32 v148, v120, v121
v_cvt_pk_bf16_f32 v149, v122, v123
v_cvt_pk_bf16_f32 v150, v124, v125
v_cvt_pk_bf16_f32 v151, v126, v127
v_exp_f32 v128, v128
v_exp_f32 v129, v129
v_mfma_f32_32x32x16_bf16 v[192:207], v[164:167], v[148:151], v[192:207]
ds_read_b128 v[164:167], v8 offset:3072
v_exp_f32 v130, v130
v_exp_f32 v131, v131
v_exp_f32 v132, v132
v_mfma_f32_16x16x32_bf16 v[208:211], v[212:215], v[148:151], v[208:211]
v_exp_f32 v133, v133
v_mfma_f32_32x32x16_bf16 v[112:127], v[152:155], v[80:83], 0
v_exp_f32 v134, v134
v_exp_f32 v135, v135
v_cvt_pk_bf16_f32 v144, v128, v129
v_cvt_pk_bf16_f32 v145, v130, v131
v_mfma_f32_32x32x16_bf16 v[112:127], v[156:159], v[88:91], v[112:127]
v_subrev_u32 v8, 8192, v8
ds_read_b128 v[152:155], v8 offset:0
ds_read_b128 v[156:159], v8 offset:1024
v_cvt_pk_bf16_f32 v146, v132, v133
v_cvt_pk_bf16_f32 v147, v134, v135
v_exp_f32 v136, v136
v_exp_f32 v137, v137
s_waitcnt lgkmcnt(3)
v_mfma_f32_32x32x16_bf16 v[16:31], v[160:163], v[144:147], v[16:31]
v_exp_f32 v138, v138
v_exp_f32 v139, v139
v_exp_f32 v140, v140
v_mfma_f32_16x16x32_bf16 v[32:35], v[212:215], v[144:147], v[32:35]
s_cmp_eq_u32 s65, 1
v_exp_f32 v141, v141
v_exp_f32 v142, v142
v_exp_f32 v143, v143
v_cvt_pk_bf16_f32 v148, v136, v137
v_cvt_pk_bf16_f32 v149, v138, v139
v_cvt_pk_bf16_f32 v150, v140, v141
v_cvt_pk_bf16_f32 v151, v142, v143
s_cbranch_scc1 at_142
.p2align 3
v_exp_f32 v112, v112
v_exp_f32 v113, v113
s_waitcnt lgkmcnt(2)
v_mfma_f32_32x32x16_bf16 v[16:31], v[164:167], v[148:151], v[16:31]
v_exp_f32 v114, v114
v_exp_f32 v115, v115
v_exp_f32 v116, v116
v_mfma_f32_16x16x32_bf16 v[32:35], v[212:215], v[148:151], v[32:35]
v_exp_f32 v117, v117
s_waitcnt lgkmcnt(1)
v_mfma_f32_32x32x16_bf16 v[128:143], v[152:155], v[80:83], 0
v_exp_f32 v118, v118
v_exp_f32 v119, v119
v_cvt_pk_bf16_f32 v144, v112, v113
v_cvt_pk_bf16_f32 v145, v114, v115
s_waitcnt lgkmcnt(0)
v_mfma_f32_32x32x16_bf16 v[128:143], v[156:159], v[88:91], v[128:143]
v_subrev_u32 v8, 8192, v8
ds_read_b128 v[152:155], v8 offset:0
ds_read_b128 v[156:159], v8 offset:1024
v_cvt_pk_bf16_f32 v146, v116, v117
v_cvt_pk_bf16_f32 v147, v118, v119
v_exp_f32 v120, v120
v_exp_f32 v121, v121
v_mfma_f32_32x32x16_bf16 v[192:207], v[160:163], v[144:147], v[192:207]
ds_read_b128 v[160:163], v8 offset:10240
v_exp_f32 v122, v122
v_exp_f32 v123, v123
v_exp_f32 v124, v124
v_mfma_f32_16x16x32_bf16 v[208:211], v[212:215], v[144:147], v[208:211]
v_exp_f32 v125, v125
v_exp_f32 v126, v126
v_exp_f32 v127, v127
v_cvt_pk_bf16_f32 v148, v120, v121
v_cvt_pk_bf16_f32 v149, v122, v123
v_cvt_pk_bf16_f32 v150, v124, v125
v_cvt_pk_bf16_f32 v151, v126, v127
v_exp_f32 v128, v128
v_exp_f32 v129, v129
v_mfma_f32_32x32x16_bf16 v[192:207], v[164:167], v[148:151], v[192:207]
ds_read_b128 v[164:167], v8 offset:11264
v_exp_f32 v130, v130
v_exp_f32 v131, v131
v_exp_f32 v132, v132
v_mfma_f32_16x16x32_bf16 v[208:211], v[212:215], v[148:151], v[208:211]
v_exp_f32 v133, v133
s_waitcnt lgkmcnt(3)
v_mfma_f32_32x32x16_bf16 v[112:127], v[152:155], v[80:83], 0
v_exp_f32 v134, v134
v_exp_f32 v135, v135
v_cvt_pk_bf16_f32 v144, v128, v129
v_cvt_pk_bf16_f32 v145, v130, v131
s_waitcnt lgkmcnt(2)
v_mfma_f32_32x32x16_bf16 v[112:127], v[156:159], v[88:91], v[112:127]
v_subrev_u32 v8, 8192, v8
ds_read_b128 v[152:155], v8 offset:0
ds_read_b128 v[156:159], v8 offset:1024
v_cvt_pk_bf16_f32 v146, v132, v133
v_cvt_pk_bf16_f32 v147, v134, v135
v_exp_f32 v136, v136
v_exp_f32 v137, v137
s_waitcnt lgkmcnt(3)
v_mfma_f32_32x32x16_bf16 v[192:207], v[160:163], v[144:147], v[192:207]
ds_read_b128 v[160:163], v8 offset:10240
v_exp_f32 v138, v138
v_exp_f32 v139, v139
v_exp_f32 v140, v140
v_mfma_f32_16x16x32_bf16 v[208:211], v[212:215], v[144:147], v[208:211]
v_exp_f32 v141, v141
v_exp_f32 v142, v142
v_exp_f32 v143, v143
v_cvt_pk_bf16_f32 v148, v136, v137
v_cvt_pk_bf16_f32 v149, v138, v139
v_cvt_pk_bf16_f32 v150, v140, v141
v_cvt_pk_bf16_f32 v151, v142, v143
v_exp_f32 v112, v112
v_exp_f32 v113, v113
s_waitcnt lgkmcnt(3)
v_mfma_f32_32x32x16_bf16 v[192:207], v[164:167], v[148:151], v[192:207]
ds_read_b128 v[164:167], v8 offset:11264
v_exp_f32 v114, v114
v_exp_f32 v115, v115
v_exp_f32 v116, v116
v_mfma_f32_16x16x32_bf16 v[208:211], v[212:215], v[148:151], v[208:211]
v_exp_f32 v117, v117
s_waitcnt lgkmcnt(3)
v_mfma_f32_32x32x16_bf16 v[128:143], v[152:155], v[80:83], v[216:231]
v_exp_f32 v118, v118
v_exp_f32 v119, v119
v_cvt_pk_bf16_f32 v144, v112, v113
v_cvt_pk_bf16_f32 v145, v114, v115
s_waitcnt lgkmcnt(2)
v_mfma_f32_32x32x16_bf16 v[128:143], v[156:159], v[88:91], v[128:143]
v_cvt_pk_bf16_f32 v146, v116, v117
v_cvt_pk_bf16_f32 v147, v118, v119
v_exp_f32 v120, v120
v_exp_f32 v121, v121
s_waitcnt lgkmcnt(1)
v_mfma_f32_32x32x16_bf16 v[192:207], v[160:163], v[144:147], v[192:207]
ds_read_b128 v[160:163], v8 offset:2048
v_exp_f32 v122, v122
v_exp_f32 v123, v123
v_exp_f32 v124, v124
v_mfma_f32_16x16x32_bf16 v[208:211], v[212:215], v[144:147], v[208:211]
v_exp_f32 v125, v125
v_exp_f32 v126, v126
v_exp_f32 v127, v127
v_cvt_pk_bf16_f32 v148, v120, v121
v_cvt_pk_bf16_f32 v149, v122, v123
v_cvt_pk_bf16_f32 v150, v124, v125
v_cvt_pk_bf16_f32 v151, v126, v127
s_branch at_144
.p2align 3
at_143:
v_add_u32 v5, s34, 20
s_mov_b64 exec, 1
ds_write_b32 v3, v5
s_mov_b64 exec, -1
v_exp_f32 v112, v112
v_exp_f32 v113, v113
s_waitcnt lgkmcnt(3)
v_mfma_f32_32x32x16_bf16 v[16:31], v[164:167], v[148:151], v[16:31]
v_exp_f32 v114, v114
v_exp_f32 v115, v115
v_exp_f32 v116, v116
v_mfma_f32_16x16x32_bf16 v[32:35], v[212:215], v[148:151], v[32:35]
v_exp_f32 v117, v117
v_exp_f32 v118, v118
v_exp_f32 v119, v119
v_cvt_pk_bf16_f32 v144, v112, v113
v_cvt_pk_bf16_f32 v145, v114, v115
v_cvt_pk_bf16_f32 v146, v116, v117
v_cvt_pk_bf16_f32 v147, v118, v119
v_exp_f32 v120, v120
v_exp_f32 v121, v121
v_mfma_f32_32x32x16_bf16 v[192:207], v[160:163], v[144:147], v[192:207]
v_exp_f32 v122, v122
v_exp_f32 v123, v123
v_exp_f32 v124, v124
v_mfma_f32_16x16x32_bf16 v[208:211], v[212:215], v[144:147], v[208:211]
v_exp_f32 v125, v125
v_exp_f32 v126, v126
v_exp_f32 v127, v127
v_cvt_pk_bf16_f32 v148, v120, v121
v_cvt_pk_bf16_f32 v149, v122, v123
v_cvt_pk_bf16_f32 v150, v124, v125
v_cvt_pk_bf16_f32 v151, v126, v127
s_branch at_145
.p2align 3
at_142:
v_exp_f32 v112, v112
v_exp_f32 v113, v113
s_waitcnt lgkmcnt(2)
v_mfma_f32_32x32x16_bf16 v[16:31], v[164:167], v[148:151], v[16:31]
v_exp_f32 v114, v114
v_exp_f32 v115, v115
v_exp_f32 v116, v116
v_mfma_f32_16x16x32_bf16 v[32:35], v[212:215], v[148:151], v[32:35]
v_exp_f32 v117, v117
s_waitcnt lgkmcnt(1)
v_mfma_f32_32x32x16_bf16 v[128:143], v[152:155], v[80:83], v[216:231]
v_exp_f32 v118, v118
v_exp_f32 v119, v119
v_cvt_pk_bf16_f32 v144, v112, v113
v_cvt_pk_bf16_f32 v145, v114, v115
s_waitcnt lgkmcnt(0)
v_mfma_f32_32x32x16_bf16 v[128:143], v[156:159], v[88:91], v[128:143]
v_cvt_pk_bf16_f32 v146, v116, v117
v_cvt_pk_bf16_f32 v147, v118, v119
v_exp_f32 v120, v120
v_exp_f32 v121, v121
v_mfma_f32_32x32x16_bf16 v[192:207], v[160:163], v[144:147], v[192:207]
ds_read_b128 v[160:163], v8 offset:2048
v_exp_f32 v122, v122
v_exp_f32 v123, v123
v_exp_f32 v124, v124
v_mfma_f32_16x16x32_bf16 v[208:211], v[212:215], v[144:147], v[208:211]
v_exp_f32 v125, v125
v_exp_f32 v126, v126
v_exp_f32 v127, v127
v_cvt_pk_bf16_f32 v148, v120, v121
v_cvt_pk_bf16_f32 v149, v122, v123
v_cvt_pk_bf16_f32 v150, v124, v125
v_cvt_pk_bf16_f32 v151, v126, v127
.p2align 3
at_144:
v_exp_f32 v128, v128
v_exp_f32 v129, v129
s_waitcnt lgkmcnt(1)
v_mfma_f32_32x32x16_bf16 v[192:207], v[164:167], v[148:151], v[192:207]
ds_read_b128 v[164:167], v8 offset:3072
v_exp_f32 v130, v130
v_exp_f32 v131, v131
v_exp_f32 v132, v132
v_mfma_f32_16x16x32_bf16 v[208:211], v[212:215], v[148:151], v[208:211]
v_exp_f32 v133, v133
v_exp_f32 v134, v134
v_exp_f32 v135, v135
v_cvt_pk_bf16_f32 v144, v128, v129
v_cvt_pk_bf16_f32 v145, v130, v131
v_add_u32 v5, s34, 20
s_mov_b64 exec, 1
ds_write_b32 v3, v5
s_mov_b64 exec, -1
v_cvt_pk_bf16_f32 v146, v132, v133
v_cvt_pk_bf16_f32 v147, v134, v135
v_exp_f32 v136, v136
v_exp_f32 v137, v137
s_waitcnt lgkmcnt(2)
v_mfma_f32_32x32x16_bf16 v[192:207], v[160:163], v[144:147], v[192:207]
v_exp_f32 v138, v138
v_exp_f32 v139, v139
v_exp_f32 v140, v140
v_mfma_f32_16x16x32_bf16 v[208:211], v[212:215], v[144:147], v[208:211]
v_exp_f32 v141, v141
v_exp_f32 v142, v142
v_exp_f32 v143, v143
v_cvt_pk_bf16_f32 v148, v136, v137
v_cvt_pk_bf16_f32 v149, v138, v139
v_cvt_pk_bf16_f32 v150, v140, v141
v_cvt_pk_bf16_f32 v151, v142, v143
at_145:
s_lshl_b32 s66, s59, 18
s_lshl_b32 s67, s63, 22
v_mfma_f32_16x16x32_bf16 v[208:211], v[212:215], v[148:151], v[208:211]
s_add_u32 s66, s66, s67
s_lshl1_add_u32 s67, s60, s64
s_waitcnt lgkmcnt(1)
v_mfma_f32_32x32x16_bf16 v[192:207], v[164:167], v[148:151], v[192:207]
s_lshl_b32 s67, s67, 11
s_add_u32 s66, s66, s67
s_lshl_b32 s68, s65, 16
s_add_u32 s67, s66, 18022400
s_sub_u32 s67, s67, s68
s_add_u32 s66, s66, s68
s_add_u32 s66, s66, 17825792
v_lshlrev_b32 v9, 4, v0
v_subrev_u32 v10, 0x2f800000, v32
v_subrev_u32 v11, 0x2f800000, v208
v_max_u32 v10, v10, v11
v_cmp_lt_u32 vcc, 0x20000000, v10
s_cbranch_vccnz slow_150
sback_151:
s_nop 1
v_rcp_f32 v12, v32
s_nop 1
v_pk_mul_f32 v[16:17], v[16:17], v[12:13] op_sel:[0,0] op_sel_hi:[1,0]
v_pk_mul_f32 v[18:19], v[18:19], v[12:13] op_sel:[0,0] op_sel_hi:[1,0]
v_pk_mul_f32 v[20:21], v[20:21], v[12:13] op_sel:[0,0] op_sel_hi:[1,0]
v_pk_mul_f32 v[22:23], v[22:23], v[12:13] op_sel:[0,0] op_sel_hi:[1,0]
v_pk_mul_f32 v[24:25], v[24:25], v[12:13] op_sel:[0,0] op_sel_hi:[1,0]
v_pk_mul_f32 v[26:27], v[26:27], v[12:13] op_sel:[0,0] op_sel_hi:[1,0]
v_pk_mul_f32 v[28:29], v[28:29], v[12:13] op_sel:[0,0] op_sel_hi:[1,0]
v_pk_mul_f32 v[30:31], v[30:31], v[12:13] op_sel:[0,0] op_sel_hi:[1,0]
v_cvt_pk_bf16_f32 v16, v16, v17
v_cvt_pk_bf16_f32 v17, v18, v19
v_cvt_pk_bf16_f32 v18, v20, v21
v_cvt_pk_bf16_f32 v19, v22, v23
v_cvt_pk_bf16_f32 v20, v24, v25
v_cvt_pk_bf16_f32 v21, v26, v27
v_cvt_pk_bf16_f32 v22, v28, v29
v_cvt_pk_bf16_f32 v23, v30, v31
s_cmp_eq_u32 s57, 0
s_cbranch_scc1 far_152
buffer_store_dwordx4 v[16:19], v9, s[20:23], s67 offen offset:0
buffer_store_dwordx4 v[20:23], v9, s[20:23], s67 offen offset:1024
near_153:
v_rcp_f32 v12, v208
s_nop 0
v_pk_mul_f32 v[192:193], v[192:193], v[12:13] op_sel:[0,0] op_sel_hi:[1,0]
v_pk_mul_f32 v[194:195], v[194:195], v[12:13] op_sel:[0,0] op_sel_hi:[1,0]
v_pk_mul_f32 v[196:197], v[196:197], v[12:13] op_sel:[0,0] op_sel_hi:[1,0]
v_pk_mul_f32 v[198:199], v[198:199], v[12:13] op_sel:[0,0] op_sel_hi:[1,0]
v_pk_mul_f32 v[200:201], v[200:201], v[12:13] op_sel:[0,0] op_sel_hi:[1,0]
v_pk_mul_f32 v[202:203], v[202:203], v[12:13] op_sel:[0,0] op_sel_hi:[1,0]
v_pk_mul_f32 v[204:205], v[204:205], v[12:13] op_sel:[0,0] op_sel_hi:[1,0]
v_pk_mul_f32 v[206:207], v[206:207], v[12:13] op_sel:[0,0] op_sel_hi:[1,0]
v_cvt_pk_bf16_f32 v192, v192, v193
v_cvt_pk_bf16_f32 v193, v194, v195
v_cvt_pk_bf16_f32 v194, v196, v197
v_cvt_pk_bf16_f32 v195, v198, v199
v_cvt_pk_bf16_f32 v196, v200, v201
v_cvt_pk_bf16_f32 v197, v202, v203
v_cvt_pk_bf16_f32 v198, v204, v205
v_cvt_pk_bf16_f32 v199, v206, v207
s_cmp_eq_u32 s57, 0
s_cbranch_scc1 far_154
buffer_store_dwordx4 v[192:195], v9, s[20:23], s66 offen offset:0
buffer_store_dwordx4 v[196:199], v9, s[20:23], s66 offen offset:1024
near_155:
v_bfe_u32 v48, v0, 2, 3
v_lshrrev_b32 v49, 5, v0
v_lshl_add_u32 v48, v49, 4, v48
v_lshlrev_b32 v48, 7, v48
v_bfe_u32 v49, v0, 3, 2
v_lshl_add_u32 v48, v49, 5, v48
v_and_b32 v49, 3, v0
v_lshl_add_u32 v48, v49, 3, v48
v_add_u32 v8, 32768, v48
v_xor_b32 v9, 32, v8
v_xor_b32 v10, 64, v8
v_xor_b32 v11, 96, v8
v_add_u32 v12, 0x10000, v8
v_add_u32 v13, 0x10000, v9
v_add_u32 v14, 0x10000, v10
v_add_u32 v15, 0x10000, v11
v_and_b32 v48, 15, v0
v_lshrrev_b32 v49, 4, v0
s_lshl2_add_u32 s66, s61, s58
s_lshl_b32 s67, s66, 16
s_lshl_b32 s68, s63, 22
s_add_u32 s67, s67, s68
s_add_u32 s67, s67, 17825792
v_lshl_add_u32 v6, v48, 4, s67
v_lshl_add_u32 v6, v49, 9, v6
s_add_u32 s70, s72, 268288
s_add_u32 s35, s34, 3
lw_156:
ds_read_b32 v5, v2 offset:24
s_waitcnt lgkmcnt(0)
v_cmp_gt_i32 vcc, s35, v5
s_cbranch_vccz lwd_157
s_sub_u32 s32, s32, 1
s_cmp_gt_i32 s32, 0
s_cbranch_scc1 lw_156
lwd_157:
s_mov_b64 exec, 1
s_waitcnt vmcnt(0)
s_cmp_eq_u32 s57, 0
s_cbranch_scc1 far_158
buffer_store_dword v212, v3, s[24:27], s70 offen
near_159:
s_mov_b64 exec, -1
v_add_u32 v5, s34, 21
s_mov_b64 exec, 1
ds_write_b32 v3, v5
s_mov_b64 exec, -1
s_cmp_eq_u32 s63, 0
s_cbranch_scc0 mo_160
v_permlane16_swap_b32 v240, v242
v_permlane16_swap_b32 v241, v243
v_permlane16_swap_b32 v244, v246
v_permlane16_swap_b32 v245, v247
v_permlane16_swap_b32 v248, v250
v_permlane16_swap_b32 v249, v251
v_permlane16_swap_b32 v252, v254
v_permlane16_swap_b32 v253, v255
mo_161:
v_lshlrev_b32 v16, 16, v240
v_and_b32 v17, 0xffff0000, v240
v_lshlrev_b32 v18, 16, v241
v_and_b32 v19, 0xffff0000, v241
v_lshlrev_b32 v20, 16, v242
v_and_b32 v21, 0xffff0000, v242
v_lshlrev_b32 v22, 16, v243
v_and_b32 v23, 0xffff0000, v243
v_lshlrev_b32 v24, 16, v244
v_and_b32 v25, 0xffff0000, v244
v_lshlrev_b32 v26, 16, v245
v_and_b32 v27, 0xffff0000, v245
v_lshlrev_b32 v28, 16, v246
v_and_b32 v29, 0xffff0000, v246
v_lshlrev_b32 v30, 16, v247
v_and_b32 v31, 0xffff0000, v247
v_lshlrev_b32 v32, 16, v248
v_and_b32 v33, 0xffff0000, v248
v_lshlrev_b32 v34, 16, v249
v_and_b32 v35, 0xffff0000, v249
v_lshlrev_b32 v36, 16, v250
v_and_b32 v37, 0xffff0000, v250
v_lshlrev_b32 v38, 16, v251
v_and_b32 v39, 0xffff0000, v251
v_lshlrev_b32 v40, 16, v252
v_and_b32 v41, 0xffff0000, v252
v_lshlrev_b32 v42, 16, v253
v_and_b32 v43, 0xffff0000, v253
v_lshlrev_b32 v44, 16, v254
v_and_b32 v45, 0xffff0000, v254
v_lshlrev_b32 v46, 16, v255
v_and_b32 v47, 0xffff0000, v255
s_add_u32 s66, s61, s62
s_and_b32 s66, s66, 15
s_lshl_b32 s66, s66, 12
s_add_u32 s35, s34, 18
lw_162:
ds_read_b32 v5, v2 offset:16
s_waitcnt lgkmcnt(0)
v_cmp_gt_i32 vcc, s35, v5
s_cbranch_vccz lwd_163
s_sub_u32 s32, s32, 1
s_cmp_gt_i32 s32, 0
s_cbranch_scc1 lw_162
lwd_163:
buffer_load_dwordx4 v[80:83], v6, s[20:23], s66 offen offset:0 sc1
buffer_load_dwordx4 v[88:91], v6, s[20:23], s66 offen offset:2048 sc1
buffer_load_dwordx4 v[84:87], v6, s[20:23], s66 offen offset:256 sc1
buffer_load_dwordx4 v[92:95], v6, s[20:23], s66 offen offset:2304 sc1
s_add_u32 s66, s66, 4096
s_and_b32 s66, s66, 0xffff
ds_read_b64_tr_b16 v[48:49], v8 offset:0
ds_read_b64_tr_b16 v[50:51], v8 offset:1024
ds_read_b64_tr_b16 v[52:53], v8 offset:4096
ds_read_b64_tr_b16 v[54:55], v8 offset:5120
buffer_load_dwordx4 v[96:99], v6, s[20:23], s66 offen offset:0 sc1
buffer_load_dwordx4 v[104:107], v6, s[20:23], s66 offen offset:2048 sc1
buffer_load_dwordx4 v[100:103], v6, s[20:23], s66 offen offset:256 sc1
buffer_load_dwordx4 v[108:111], v6, s[20:23], s66 offen offset:2304 sc1
s_add_u32 s66, s66, 4096
s_and_b32 s66, s66, 0xffff
ds_read_b64_tr_b16 v[56:57], v9 offset:0
ds_read_b64_tr_b16 v[58:59], v9 offset:1024
ds_read_b64_tr_b16 v[60:61], v9 offset:4096
ds_read_b64_tr_b16 v[62:63], v9 offset:5120
buffer_load_dwordx4 v[112:115], v6, s[20:23], s66 offen offset:0 sc1
buffer_load_dwordx4 v[120:123], v6, s[20:23], s66 offen offset:2048 sc1
buffer_load_dwordx4 v[116:119], v6, s[20:23], s66 offen offset:256 sc1
buffer_load_dwordx4 v[124:127], v6, s[20:23], s66 offen offset:2304 sc1
s_add_u32 s66, s66, 4096
s_and_b32 s66, s66, 0xffff
ds_read_b64_tr_b16 v[64:65], v10 offset:0
ds_read_b64_tr_b16 v[66:67], v10 offset:1024
ds_read_b64_tr_b16 v[68:69], v10 offset:4096
ds_read_b64_tr_b16 v[70:71], v10 offset:5120
buffer_load_dwordx4 v[128:131], v6, s[20:23], s66 offen offset:0 sc1
buffer_load_dwordx4 v[136:139], v6, s[20:23], s66 offen offset:2048 sc1
buffer_load_dwordx4 v[132:135], v6, s[20:23], s66 offen offset:256 sc1
buffer_load_dwordx4 v[140:143], v6, s[20:23], s66 offen offset:2304 sc1
s_add_u32 s66, s66, 4096
s_and_b32 s66, s66, 0xffff
buffer_load_dwordx4 v[144:147], v6, s[20:23], s66 offen offset:0 sc1
buffer_load_dwordx4 v[152:155], v6, s[20:23], s66 offen offset:2048 sc1
buffer_load_dwordx4 v[148:151], v6, s[20:23], s66 offen offset:256 sc1
buffer_load_dwordx4 v[156:159], v6, s[20:23], s66 offen offset:2304 sc1
s_add_u32 s66, s66, 4096
s_and_b32 s66, s66, 0xffff
buffer_load_dwordx4 v[160:163], v6, s[20:23], s66 offen offset:0 sc1
buffer_load_dwordx4 v[168:171], v6, s[20:23], s66 offen offset:2048 sc1
buffer_load_dwordx4 v[164:167], v6, s[20:23], s66 offen offset:256 sc1
buffer_load_dwordx4 v[172:175], v6, s[20:23], s66 offen offset:2304 sc1
s_add_u32 s66, s66, 4096
s_and_b32 s66, s66, 0xffff
buffer_load_dwordx4 v[176:179], v6, s[20:23], s66 offen offset:0 sc1
buffer_load_dwordx4 v[184:187], v6, s[20:23], s66 offen offset:2048 sc1
buffer_load_dwordx4 v[180:183], v6, s[20:23], s66 offen offset:256 sc1
buffer_load_dwordx4 v[188:191], v6, s[20:23], s66 offen offset:2304 sc1
s_add_u32 s66, s66, 4096
s_and_b32 s66, s66, 0xffff
buffer_load_dwordx4 v[192:195], v6, s[20:23], s66 offen offset:0 sc1
buffer_load_dwordx4 v[200:203], v6, s[20:23], s66 offen offset:2048 sc1
buffer_load_dwordx4 v[196:199], v6, s[20:23], s66 offen offset:256 sc1
buffer_load_dwordx4 v[204:207], v6, s[20:23], s66 offen offset:2304 sc1
s_add_u32 s66, s66, 4096
s_and_b32 s66, s66, 0xffff
.p2align 3
s_waitcnt vmcnt(31) lgkmcnt(10)
v_mfma_f32_16x16x32_bf16 v[16:19], v[48:51], v[80:83], v[16:19]
ds_read_b64_tr_b16 v[72:73], v11 offset:0
s_waitcnt vmcnt(30) lgkmcnt(9)
v_mfma_f32_16x16x32_bf16 v[16:19], v[52:55], v[88:91], v[16:19]
ds_read_b64_tr_b16 v[74:75], v11 offset:1024
s_waitcnt vmcnt(29)
v_mfma_f32_16x16x32_bf16 v[32:35], v[48:51], v[84:87], v[32:35]
ds_read_b64_tr_b16 v[76:77], v11 offset:4096
s_waitcnt vmcnt(28)
v_mfma_f32_16x16x32_bf16 v[32:35], v[52:55], v[92:95], v[32:35]
ds_read_b64_tr_b16 v[78:79], v11 offset:5120
s_waitcnt lgkmcnt(10)
v_mfma_f32_16x16x32_bf16 v[20:23], v[56:59], v[80:83], v[20:23]
ds_read_b64_tr_b16 v[48:49], v8 offset:8192
s_waitcnt lgkmcnt(9)
v_mfma_f32_16x16x32_bf16 v[20:23], v[60:63], v[88:91], v[20:23]
ds_read_b64_tr_b16 v[50:51], v8 offset:9216
v_mfma_f32_16x16x32_bf16 v[36:39], v[56:59], v[84:87], v[36:39]
ds_read_b64_tr_b16 v[52:53], v8 offset:12288
v_mfma_f32_16x16x32_bf16 v[36:39], v[60:63], v[92:95], v[36:39]
ds_read_b64_tr_b16 v[54:55], v8 offset:13312
s_waitcnt lgkmcnt(10)
v_mfma_f32_16x16x32_bf16 v[24:27], v[64:67], v[80:83], v[24:27]
ds_read_b64_tr_b16 v[56:57], v9 offset:8192
s_waitcnt lgkmcnt(9)
v_mfma_f32_16x16x32_bf16 v[24:27], v[68:71], v[88:91], v[24:27]
ds_read_b64_tr_b16 v[58:59], v9 offset:9216
v_mfma_f32_16x16x32_bf16 v[40:43], v[64:67], v[84:87], v[40:43]
ds_read_b64_tr_b16 v[60:61], v9 offset:12288
v_mfma_f32_16x16x32_bf16 v[40:43], v[68:71], v[92:95], v[40:43]
ds_read_b64_tr_b16 v[62:63], v9 offset:13312
s_waitcnt lgkmcnt(10)
v_mfma_f32_16x16x32_bf16 v[28:31], v[72:75], v[80:83], v[28:31]
ds_read_b64_tr_b16 v[64:65], v10 offset:8192
s_waitcnt lgkmcnt(9)
v_mfma_f32_16x16x32_bf16 v[28:31], v[76:79], v[88:91], v[28:31]
ds_read_b64_tr_b16 v[66:67], v10 offset:9216
v_mfma_f32_16x16x32_bf16 v[44:47], v[72:75], v[84:87], v[44:47]
ds_read_b64_tr_b16 v[68:69], v10 offset:12288
v_mfma_f32_16x16x32_bf16 v[44:47], v[76:79], v[92:95], v[44:47]
ds_read_b64_tr_b16 v[70:71], v10 offset:13312
s_waitcnt vmcnt(27) lgkmcnt(10)
v_mfma_f32_16x16x32_bf16 v[16:19], v[48:51], v[96:99], v[16:19]
ds_read_b64_tr_b16 v[72:73], v11 offset:8192
buffer_load_dwordx4 v[80:83], v6, s[20:23], s66 offen offset:0 sc1
s_waitcnt vmcnt(27) lgkmcnt(9)
v_mfma_f32_16x16x32_bf16 v[16:19], v[52:55], v[104:107], v[16:19]
ds_read_b64_tr_b16 v[74:75], v11 offset:9216
buffer_load_dwordx4 v[88:91], v6, s[20:23], s66 offen offset:2048 sc1
s_waitcnt vmcnt(27)
v_mfma_f32_16x16x32_bf16 v[32:35], v[48:51], v[100:103], v[32:35]
ds_read_b64_tr_b16 v[76:77], v11 offset:12288
buffer_load_dwordx4 v[84:87], v6, s[20:23], s66 offen offset:256 sc1
s_waitcnt vmcnt(27)
v_mfma_f32_16x16x32_bf16 v[32:35], v[52:55], v[108:111], v[32:35]
ds_read_b64_tr_b16 v[78:79], v11 offset:13312
buffer_load_dwordx4 v[92:95], v6, s[20:23], s66 offen offset:2304 sc1
s_waitcnt lgkmcnt(10)
v_mfma_f32_16x16x32_bf16 v[20:23], v[56:59], v[96:99], v[20:23]
ds_read_b64_tr_b16 v[48:49], v8 offset:16384
s_add_u32 s66, s66, 4096
s_and_b32 s66, s66, 0xffff
s_waitcnt lgkmcnt(9)
v_mfma_f32_16x16x32_bf16 v[20:23], v[60:63], v[104:107], v[20:23]
ds_read_b64_tr_b16 v[50:51], v8 offset:17408
v_mfma_f32_16x16x32_bf16 v[36:39], v[56:59], v[100:103], v[36:39]
ds_read_b64_tr_b16 v[52:53], v8 offset:20480
v_mfma_f32_16x16x32_bf16 v[36:39], v[60:63], v[108:111], v[36:39]
ds_read_b64_tr_b16 v[54:55], v8 offset:21504
s_waitcnt lgkmcnt(10)
v_mfma_f32_16x16x32_bf16 v[24:27], v[64:67], v[96:99], v[24:27]
ds_read_b64_tr_b16 v[56:57], v9 offset:16384
s_waitcnt lgkmcnt(9)
v_mfma_f32_16x16x32_bf16 v[24:27], v[68:71], v[104:107], v[24:27]
ds_read_b64_tr_b16 v[58:59], v9 offset:17408
v_mfma_f32_16x16x32_bf16 v[40:43], v[64:67], v[100:103], v[40:43]
ds_read_b64_tr_b16 v[60:61], v9 offset:20480
v_mfma_f32_16x16x32_bf16 v[40:43], v[68:71], v[108:111], v[40:43]
ds_read_b64_tr_b16 v[62:63], v9 offset:21504
s_waitcnt lgkmcnt(10)
v_mfma_f32_16x16x32_bf16 v[28:31], v[72:75], v[96:99], v[28:31]
ds_read_b64_tr_b16 v[64:65], v10 offset:16384
s_waitcnt lgkmcnt(9)
v_mfma_f32_16x16x32_bf16 v[28:31], v[76:79], v[104:107], v[28:31]
ds_read_b64_tr_b16 v[66:67], v10 offset:17408
v_mfma_f32_16x16x32_bf16 v[44:47], v[72:75], v[100:103], v[44:47]
ds_read_b64_tr_b16 v[68:69], v10 offset:20480
v_mfma_f32_16x16x32_bf16 v[44:47], v[76:79], v[108:111], v[44:47]
ds_read_b64_tr_b16 v[70:71], v10 offset:21504
s_waitcnt vmcnt(27) lgkmcnt(10)
v_mfma_f32_16x16x32_bf16 v[16:19], v[48:51], v[112:115], v[16:19]
ds_read_b64_tr_b16 v[72:73], v11 offset:16384
buffer_load_dwordx4 v[96:99], v6, s[20:23], s66 offen offset:0 sc1
s_waitcnt vmcnt(27) lgkmcnt(9)
v_mfma_f32_16x16x32_bf16 v[16:19], v[52:55], v[120:123], v[16:19]
ds_read_b64_tr_b16 v[74:75], v11 offset:17408
buffer_load_dwordx4 v[104:107], v6, s[20:23], s66 offen offset:2048 sc1
s_waitcnt vmcnt(27)
v_mfma_f32_16x16x32_bf16 v[32:35], v[48:51], v[116:119], v[32:35]
ds_read_b64_tr_b16 v[76:77], v11 offset:20480
buffer_load_dwordx4 v[100:103], v6, s[20:23], s66 offen offset:256 sc1
s_waitcnt vmcnt(27)
v_mfma_f32_16x16x32_bf16 v[32:35], v[52:55], v[124:127], v[32:35]
ds_read_b64_tr_b16 v[78:79], v11 offset:21504
buffer_load_dwordx4 v[108:111], v6, s[20:23], s66 offen offset:2304 sc1
s_waitcnt lgkmcnt(10)
v_mfma_f32_16x16x32_bf16 v[20:23], v[56:59], v[112:115], v[20:23]
ds_read_b64_tr_b16 v[48:49], v8 offset:24576
s_add_u32 s66, s66, 4096
s_and_b32 s66, s66, 0xffff
s_waitcnt lgkmcnt(9)
v_mfma_f32_16x16x32_bf16 v[20:23], v[60:63], v[120:123], v[20:23]
ds_read_b64_tr_b16 v[50:51], v8 offset:25600
v_mfma_f32_16x16x32_bf16 v[36:39], v[56:59], v[116:119], v[36:39]
ds_read_b64_tr_b16 v[52:53], v8 offset:28672
v_mfma_f32_16x16x32_bf16 v[36:39], v[60:63], v[124:127], v[36:39]
ds_read_b64_tr_b16 v[54:55], v8 offset:29696
s_waitcnt lgkmcnt(10)
v_mfma_f32_16x16x32_bf16 v[24:27], v[64:67], v[112:115], v[24:27]
ds_read_b64_tr_b16 v[56:57], v9 offset:24576
s_waitcnt lgkmcnt(9)
v_mfma_f32_16x16x32_bf16 v[24:27], v[68:71], v[120:123], v[24:27]
ds_read_b64_tr_b16 v[58:59], v9 offset:25600
v_mfma_f32_16x16x32_bf16 v[40:43], v[64:67], v[116:119], v[40:43]
ds_read_b64_tr_b16 v[60:61], v9 offset:28672
v_mfma_f32_16x16x32_bf16 v[40:43], v[68:71], v[124:127], v[40:43]
ds_read_b64_tr_b16 v[62:63], v9 offset:29696
s_waitcnt lgkmcnt(10)
v_mfma_f32_16x16x32_bf16 v[28:31], v[72:75], v[112:115], v[28:31]
ds_read_b64_tr_b16 v[64:65], v10 offset:24576
s_waitcnt lgkmcnt(9)
v_mfma_f32_16x16x32_bf16 v[28:31], v[76:79], v[120:123], v[28:31]
ds_read_b64_tr_b16 v[66:67], v10 offset:25600
v_mfma_f32_16x16x32_bf16 v[44:47], v[72:75], v[116:119], v[44:47]
ds_read_b64_tr_b16 v[68:69], v10 offset:28672
v_mfma_f32_16x16x32_bf16 v[44:47], v[76:79], v[124:127], v[44:47]
ds_read_b64_tr_b16 v[70:71], v10 offset:29696
s_waitcnt vmcnt(27) lgkmcnt(10)
v_mfma_f32_16x16x32_bf16 v[16:19], v[48:51], v[128:131], v[16:19]
ds_read_b64_tr_b16 v[72:73], v11 offset:24576
buffer_load_dwordx4 v[112:115], v6, s[20:23], s66 offen offset:0 sc1
s_waitcnt vmcnt(27) lgkmcnt(9)
v_mfma_f32_16x16x32_bf16 v[16:19], v[52:55], v[136:139], v[16:19]
ds_read_b64_tr_b16 v[74:75], v11 offset:25600
buffer_load_dwordx4 v[120:123], v6, s[20:23], s66 offen offset:2048 sc1
s_waitcnt vmcnt(27)
v_mfma_f32_16x16x32_bf16 v[32:35], v[48:51], v[132:135], v[32:35]
ds_read_b64_tr_b16 v[76:77], v11 offset:28672
buffer_load_dwordx4 v[116:119], v6, s[20:23], s66 offen offset:256 sc1
s_waitcnt vmcnt(27)
v_mfma_f32_16x16x32_bf16 v[32:35], v[52:55], v[140:143], v[32:35]
ds_read_b64_tr_b16 v[78:79], v11 offset:29696
buffer_load_dwordx4 v[124:127], v6, s[20:23], s66 offen offset:2304 sc1
s_waitcnt lgkmcnt(10)
v_mfma_f32_16x16x32_bf16 v[20:23], v[56:59], v[128:131], v[20:23]
ds_read_b64_tr_b16 v[48:49], v8 offset:32768
s_add_u32 s66, s66, 4096
s_and_b32 s66, s66, 0xffff
s_waitcnt lgkmcnt(9)
v_mfma_f32_16x16x32_bf16 v[20:23], v[60:63], v[136:139], v[20:23]
ds_read_b64_tr_b16 v[50:51], v8 offset:33792
v_mfma_f32_16x16x32_bf16 v[36:39], v[56:59], v[132:135], v[36:39]
ds_read_b64_tr_b16 v[52:53], v8 offset:36864
v_mfma_f32_16x16x32_bf16 v[36:39], v[60:63], v[140:143], v[36:39]
ds_read_b64_tr_b16 v[54:55], v8 offset:37888
s_waitcnt lgkmcnt(10)
v_mfma_f32_16x16x32_bf16 v[24:27], v[64:67], v[128:131], v[24:27]
ds_read_b64_tr_b16 v[56:57], v9 offset:32768
s_waitcnt lgkmcnt(9)
v_mfma_f32_16x16x32_bf16 v[24:27], v[68:71], v[136:139], v[24:27]
ds_read_b64_tr_b16 v[58:59], v9 offset:33792
v_mfma_f32_16x16x32_bf16 v[40:43], v[64:67], v[132:135], v[40:43]
ds_read_b64_tr_b16 v[60:61], v9 offset:36864
v_mfma_f32_16x16x32_bf16 v[40:43], v[68:71], v[140:143], v[40:43]
ds_read_b64_tr_b16 v[62:63], v9 offset:37888
s_waitcnt lgkmcnt(10)
v_mfma_f32_16x16x32_bf16 v[28:31], v[72:75], v[128:131], v[28:31]
ds_read_b64_tr_b16 v[64:65], v10 offset:32768
s_waitcnt lgkmcnt(9)
v_mfma_f32_16x16x32_bf16 v[28:31], v[76:79], v[136:139], v[28:31]
ds_read_b64_tr_b16 v[66:67], v10 offset:33792
v_mfma_f32_16x16x32_bf16 v[44:47], v[72:75], v[132:135], v[44:47]
ds_read_b64_tr_b16 v[68:69], v10 offset:36864
v_mfma_f32_16x16x32_bf16 v[44:47], v[76:79], v[140:143], v[44:47]
ds_read_b64_tr_b16 v[70:71], v10 offset:37888
s_waitcnt vmcnt(27) lgkmcnt(10)
v_mfma_f32_16x16x32_bf16 v[16:19], v[48:51], v[144:147], v[16:19]
ds_read_b64_tr_b16 v[72:73], v11 offset:32768
buffer_load_dwordx4 v[128:131], v6, s[20:23], s66 offen offset:0 sc1
s_waitcnt vmcnt(27) lgkmcnt(9)
v_mfma_f32_16x16x32_bf16 v[16:19], v[52:55], v[152:155], v[16:19]
ds_read_b64_tr_b16 v[74:75], v11 offset:33792
buffer_load_dwordx4 v[136:139], v6, s[20:23], s66 offen offset:2048 sc1
s_waitcnt vmcnt(27)
v_mfma_f32_16x16x32_bf16 v[32:35], v[48:51], v[148:151], v[32:35]
ds_read_b64_tr_b16 v[76:77], v11 offset:36864
buffer_load_dwordx4 v[132:135], v6, s[20:23], s66 offen offset:256 sc1
s_waitcnt vmcnt(27)
v_mfma_f32_16x16x32_bf16 v[32:35], v[52:55], v[156:159], v[32:35]
ds_read_b64_tr_b16 v[78:79], v11 offset:37888
buffer_load_dwordx4 v[140:143], v6, s[20:23], s66 offen offset:2304 sc1
s_waitcnt lgkmcnt(10)
v_mfma_f32_16x16x32_bf16 v[20:23], v[56:59], v[144:147], v[20:23]
ds_read_b64_tr_b16 v[48:49], v8 offset:40960
s_add_u32 s66, s66, 4096
s_and_b32 s66, s66, 0xffff
s_waitcnt lgkmcnt(9)
v_mfma_f32_16x16x32_bf16 v[20:23], v[60:63], v[152:155], v[20:23]
ds_read_b64_tr_b16 v[50:51], v8 offset:41984
v_mfma_f32_16x16x32_bf16 v[36:39], v[56:59], v[148:151], v[36:39]
ds_read_b64_tr_b16 v[52:53], v8 offset:45056
v_mfma_f32_16x16x32_bf16 v[36:39], v[60:63], v[156:159], v[36:39]
ds_read_b64_tr_b16 v[54:55], v8 offset:46080
s_waitcnt lgkmcnt(10)
v_mfma_f32_16x16x32_bf16 v[24:27], v[64:67], v[144:147], v[24:27]
ds_read_b64_tr_b16 v[56:57], v9 offset:40960
s_waitcnt lgkmcnt(9)
v_mfma_f32_16x16x32_bf16 v[24:27], v[68:71], v[152:155], v[24:27]
ds_read_b64_tr_b16 v[58:59], v9 offset:41984
v_mfma_f32_16x16x32_bf16 v[40:43], v[64:67], v[148:151], v[40:43]
ds_read_b64_tr_b16 v[60:61], v9 offset:45056
v_mfma_f32_16x16x32_bf16 v[40:43], v[68:71], v[156:159], v[40:43]
ds_read_b64_tr_b16 v[62:63], v9 offset:46080
s_waitcnt lgkmcnt(10)
v_mfma_f32_16x16x32_bf16 v[28:31], v[72:75], v[144:147], v[28:31]
ds_read_b64_tr_b16 v[64:65], v10 offset:40960
s_waitcnt lgkmcnt(9)
v_mfma_f32_16x16x32_bf16 v[28:31], v[76:79], v[152:155], v[28:31]
ds_read_b64_tr_b16 v[66:67], v10 offset:41984
v_mfma_f32_16x16x32_bf16 v[44:47], v[72:75], v[148:151], v[44:47]
ds_read_b64_tr_b16 v[68:69], v10 offset:45056
v_mfma_f32_16x16x32_bf16 v[44:47], v[76:79], v[156:159], v[44:47]
ds_read_b64_tr_b16 v[70:71], v10 offset:46080
s_waitcnt vmcnt(27) lgkmcnt(10)
v_mfma_f32_16x16x32_bf16 v[16:19], v[48:51], v[160:163], v[16:19]
ds_read_b64_tr_b16 v[72:73], v11 offset:40960
buffer_load_dwordx4 v[144:147], v6, s[20:23], s66 offen offset:0 sc1
s_waitcnt vmcnt(27) lgkmcnt(9)
v_mfma_f32_16x16x32_bf16 v[16:19], v[52:55], v[168:171], v[16:19]
ds_read_b64_tr_b16 v[74:75], v11 offset:41984
buffer_load_dwordx4 v[152:155], v6, s[20:23], s66 offen offset:2048 sc1
s_waitcnt vmcnt(27)
v_mfma_f32_16x16x32_bf16 v[32:35], v[48:51], v[164:167], v[32:35]
ds_read_b64_tr_b16 v[76:77], v11 offset:45056
buffer_load_dwordx4 v[148:151], v6, s[20:23], s66 offen offset:256 sc1
s_waitcnt vmcnt(27)
v_mfma_f32_16x16x32_bf16 v[32:35], v[52:55], v[172:175], v[32:35]
ds_read_b64_tr_b16 v[78:79], v11 offset:46080
buffer_load_dwordx4 v[156:159], v6, s[20:23], s66 offen offset:2304 sc1
s_waitcnt lgkmcnt(10)
v_mfma_f32_16x16x32_bf16 v[20:23], v[56:59], v[160:163], v[20:23]
ds_read_b64_tr_b16 v[48:49], v8 offset:49152
s_add_u32 s66, s66, 4096
s_and_b32 s66, s66, 0xffff
s_waitcnt lgkmcnt(9)
v_mfma_f32_16x16x32_bf16 v[20:23], v[60:63], v[168:171], v[20:23]
ds_read_b64_tr_b16 v[50:51], v8 offset:50176
v_mfma_f32_16x16x32_bf16 v[36:39], v[56:59], v[164:167], v[36:39]
ds_read_b64_tr_b16 v[52:53], v8 offset:53248
v_mfma_f32_16x16x32_bf16 v[36:39], v[60:63], v[172:175], v[36:39]
ds_read_b64_tr_b16 v[54:55], v8 offset:54272
s_waitcnt lgkmcnt(10)
v_mfma_f32_16x16x32_bf16 v[24:27], v[64:67], v[160:163], v[24:27]
ds_read_b64_tr_b16 v[56:57], v9 offset:49152
s_waitcnt lgkmcnt(9)
v_mfma_f32_16x16x32_bf16 v[24:27], v[68:71], v[168:171], v[24:27]
ds_read_b64_tr_b16 v[58:59], v9 offset:50176
v_mfma_f32_16x16x32_bf16 v[40:43], v[64:67], v[164:167], v[40:43]
ds_read_b64_tr_b16 v[60:61], v9 offset:53248
v_mfma_f32_16x16x32_bf16 v[40:43], v[68:71], v[172:175], v[40:43]
ds_read_b64_tr_b16 v[62:63], v9 offset:54272
s_waitcnt lgkmcnt(10)
v_mfma_f32_16x16x32_bf16 v[28:31], v[72:75], v[160:163], v[28:31]
ds_read_b64_tr_b16 v[64:65], v10 offset:49152
s_waitcnt lgkmcnt(9)
v_mfma_f32_16x16x32_bf16 v[28:31], v[76:79], v[168:171], v[28:31]
ds_read_b64_tr_b16 v[66:67], v10 offset:50176
v_mfma_f32_16x16x32_bf16 v[44:47], v[72:75], v[164:167], v[44:47]
ds_read_b64_tr_b16 v[68:69], v10 offset:53248
v_mfma_f32_16x16x32_bf16 v[44:47], v[76:79], v[172:175], v[44:47]
ds_read_b64_tr_b16 v[70:71], v10 offset:54272
s_waitcnt vmcnt(27) lgkmcnt(10)
v_mfma_f32_16x16x32_bf16 v[16:19], v[48:51], v[176:179], v[16:19]
ds_read_b64_tr_b16 v[72:73], v11 offset:49152
buffer_load_dwordx4 v[160:163], v6, s[20:23], s66 offen offset:0 sc1
s_waitcnt vmcnt(27) lgkmcnt(9)
v_mfma_f32_16x16x32_bf16 v[16:19], v[52:55], v[184:187], v[16:19]
ds_read_b64_tr_b16 v[74:75], v11 offset:50176
buffer_load_dwordx4 v[168:171], v6, s[20:23], s66 offen offset:2048 sc1
s_waitcnt vmcnt(27)
v_mfma_f32_16x16x32_bf16 v[32:35], v[48:51], v[180:183], v[32:35]
ds_read_b64_tr_b16 v[76:77], v11 offset:53248
buffer_load_dwordx4 v[164:167], v6, s[20:23], s66 offen offset:256 sc1
s_waitcnt vmcnt(27)
v_mfma_f32_16x16x32_bf16 v[32:35], v[52:55], v[188:191], v[32:35]
ds_read_b64_tr_b16 v[78:79], v11 offset:54272
buffer_load_dwordx4 v[172:175], v6, s[20:23], s66 offen offset:2304 sc1
s_waitcnt lgkmcnt(10)
v_mfma_f32_16x16x32_bf16 v[20:23], v[56:59], v[176:179], v[20:23]
ds_read_b64_tr_b16 v[48:49], v8 offset:57344
s_add_u32 s66, s66, 4096
s_and_b32 s66, s66, 0xffff
s_waitcnt lgkmcnt(9)
v_mfma_f32_16x16x32_bf16 v[20:23], v[60:63], v[184:187], v[20:23]
ds_read_b64_tr_b16 v[50:51], v8 offset:58368
v_mfma_f32_16x16x32_bf16 v[36:39], v[56:59], v[180:183], v[36:39]
ds_read_b64_tr_b16 v[52:53], v8 offset:61440
v_mfma_f32_16x16x32_bf16 v[36:39], v[60:63], v[188:191], v[36:39]
ds_read_b64_tr_b16 v[54:55], v8 offset:62464
s_waitcnt lgkmcnt(10)
v_mfma_f32_16x16x32_bf16 v[24:27], v[64:67], v[176:179], v[24:27]
ds_read_b64_tr_b16 v[56:57], v9 offset:57344
s_waitcnt lgkmcnt(9)
v_mfma_f32_16x16x32_bf16 v[24:27], v[68:71], v[184:187], v[24:27]
ds_read_b64_tr_b16 v[58:59], v9 offset:58368
v_mfma_f32_16x16x32_bf16 v[40:43], v[64:67], v[180:183], v[40:43]
ds_read_b64_tr_b16 v[60:61], v9 offset:61440
v_mfma_f32_16x16x32_bf16 v[40:43], v[68:71], v[188:191], v[40:43]
ds_read_b64_tr_b16 v[62:63], v9 offset:62464
s_waitcnt lgkmcnt(10)
v_mfma_f32_16x16x32_bf16 v[28:31], v[72:75], v[176:179], v[28:31]
ds_read_b64_tr_b16 v[64:65], v10 offset:57344
s_waitcnt lgkmcnt(9)
v_mfma_f32_16x16x32_bf16 v[28:31], v[76:79], v[184:187], v[28:31]
ds_read_b64_tr_b16 v[66:67], v10 offset:58368
v_mfma_f32_16x16x32_bf16 v[44:47], v[72:75], v[180:183], v[44:47]
ds_read_b64_tr_b16 v[68:69], v10 offset:61440
v_mfma_f32_16x16x32_bf16 v[44:47], v[76:79], v[188:191], v[44:47]
ds_read_b64_tr_b16 v[70:71], v10 offset:62464
s_waitcnt vmcnt(27) lgkmcnt(10)
v_mfma_f32_16x16x32_bf16 v[16:19], v[48:51], v[192:195], v[16:19]
ds_read_b64_tr_b16 v[72:73], v11 offset:57344
buffer_load_dwordx4 v[176:179], v6, s[20:23], s66 offen offset:0 sc1
s_waitcnt vmcnt(27) lgkmcnt(9)
v_mfma_f32_16x16x32_bf16 v[16:19], v[52:55], v[200:203], v[16:19]
ds_read_b64_tr_b16 v[74:75], v11 offset:58368
buffer_load_dwordx4 v[184:187], v6, s[20:23], s66 offen offset:2048 sc1
s_waitcnt vmcnt(27)
v_mfma_f32_16x16x32_bf16 v[32:35], v[48:51], v[196:199], v[32:35]
ds_read_b64_tr_b16 v[76:77], v11 offset:61440
buffer_load_dwordx4 v[180:183], v6, s[20:23], s66 offen offset:256 sc1
s_waitcnt vmcnt(27)
v_mfma_f32_16x16x32_bf16 v[32:35], v[52:55], v[204:207], v[32:35]
ds_read_b64_tr_b16 v[78:79], v11 offset:62464
buffer_load_dwordx4 v[188:191], v6, s[20:23], s66 offen offset:2304 sc1
s_waitcnt lgkmcnt(10)
v_mfma_f32_16x16x32_bf16 v[20:23], v[56:59], v[192:195], v[20:23]
ds_read_b64_tr_b16 v[48:49], v12 offset:0
s_add_u32 s66, s66, 4096
s_and_b32 s66, s66, 0xffff
s_waitcnt lgkmcnt(9)
v_mfma_f32_16x16x32_bf16 v[20:23], v[60:63], v[200:203], v[20:23]
ds_read_b64_tr_b16 v[50:51], v12 offset:1024
v_mfma_f32_16x16x32_bf16 v[36:39], v[56:59], v[196:199], v[36:39]
ds_read_b64_tr_b16 v[52:53], v12 offset:4096
v_mfma_f32_16x16x32_bf16 v[36:39], v[60:63], v[204:207], v[36:39]
ds_read_b64_tr_b16 v[54:55], v12 offset:5120
s_waitcnt lgkmcnt(10)
v_mfma_f32_16x16x32_bf16 v[24:27], v[64:67], v[192:195], v[24:27]
ds_read_b64_tr_b16 v[56:57], v13 offset:0
s_waitcnt lgkmcnt(9)
v_mfma_f32_16x16x32_bf16 v[24:27], v[68:71], v[200:203], v[24:27]
ds_read_b64_tr_b16 v[58:59], v13 offset:1024
v_mfma_f32_16x16x32_bf16 v[40:43], v[64:67], v[196:199], v[40:43]
ds_read_b64_tr_b16 v[60:61], v13 offset:4096
v_mfma_f32_16x16x32_bf16 v[40:43], v[68:71], v[204:207], v[40:43]
ds_read_b64_tr_b16 v[62:63], v13 offset:5120
s_waitcnt lgkmcnt(10)
v_mfma_f32_16x16x32_bf16 v[28:31], v[72:75], v[192:195], v[28:31]
ds_read_b64_tr_b16 v[64:65], v14 offset:0
s_waitcnt lgkmcnt(9)
v_mfma_f32_16x16x32_bf16 v[28:31], v[76:79], v[200:203], v[28:31]
ds_read_b64_tr_b16 v[66:67], v14 offset:1024
v_mfma_f32_16x16x32_bf16 v[44:47], v[72:75], v[196:199], v[44:47]
ds_read_b64_tr_b16 v[68:69], v14 offset:4096
v_mfma_f32_16x16x32_bf16 v[44:47], v[76:79], v[204:207], v[44:47]
ds_read_b64_tr_b16 v[70:71], v14 offset:5120
s_waitcnt vmcnt(27) lgkmcnt(10)
v_mfma_f32_16x16x32_bf16 v[16:19], v[48:51], v[80:83], v[16:19]
ds_read_b64_tr_b16 v[72:73], v15 offset:0
buffer_load_dwordx4 v[192:195], v6, s[20:23], s66 offen offset:0 sc1
s_waitcnt vmcnt(27) lgkmcnt(9)
v_mfma_f32_16x16x32_bf16 v[16:19], v[52:55], v[88:91], v[16:19]
ds_read_b64_tr_b16 v[74:75], v15 offset:1024
buffer_load_dwordx4 v[200:203], v6, s[20:23], s66 offen offset:2048 sc1
s_waitcnt vmcnt(27)
v_mfma_f32_16x16x32_bf16 v[32:35], v[48:51], v[84:87], v[32:35]
ds_read_b64_tr_b16 v[76:77], v15 offset:4096
buffer_load_dwordx4 v[196:199], v6, s[20:23], s66 offen offset:256 sc1
s_waitcnt vmcnt(27)
v_mfma_f32_16x16x32_bf16 v[32:35], v[52:55], v[92:95], v[32:35]
ds_read_b64_tr_b16 v[78:79], v15 offset:5120
buffer_load_dwordx4 v[204:207], v6, s[20:23], s66 offen offset:2304 sc1
s_waitcnt lgkmcnt(10)
v_mfma_f32_16x16x32_bf16 v[20:23], v[56:59], v[80:83], v[20:23]
ds_read_b64_tr_b16 v[48:49], v12 offset:8192
s_add_u32 s66, s66, 4096
s_and_b32 s66, s66, 0xffff
s_waitcnt lgkmcnt(9)
v_mfma_f32_16x16x32_bf16 v[20:23], v[60:63], v[88:91], v[20:23]
ds_read_b64_tr_b16 v[50:51], v12 offset:9216
v_mfma_f32_16x16x32_bf16 v[36:39], v[56:59], v[84:87], v[36:39]
ds_read_b64_tr_b16 v[52:53], v12 offset:12288
v_mfma_f32_16x16x32_bf16 v[36:39], v[60:63], v[92:95], v[36:39]
ds_read_b64_tr_b16 v[54:55], v12 offset:13312
s_waitcnt lgkmcnt(10)
v_mfma_f32_16x16x32_bf16 v[24:27], v[64:67], v[80:83], v[24:27]
ds_read_b64_tr_b16 v[56:57], v13 offset:8192
s_waitcnt lgkmcnt(9)
v_mfma_f32_16x16x32_bf16 v[24:27], v[68:71], v[88:91], v[24:27]
ds_read_b64_tr_b16 v[58:59], v13 offset:9216
v_mfma_f32_16x16x32_bf16 v[40:43], v[64:67], v[84:87], v[40:43]
ds_read_b64_tr_b16 v[60:61], v13 offset:12288
v_mfma_f32_16x16x32_bf16 v[40:43], v[68:71], v[92:95], v[40:43]
ds_read_b64_tr_b16 v[62:63], v13 offset:13312
s_waitcnt lgkmcnt(10)
v_mfma_f32_16x16x32_bf16 v[28:31], v[72:75], v[80:83], v[28:31]
ds_read_b64_tr_b16 v[64:65], v14 offset:8192
s_waitcnt lgkmcnt(9)
v_mfma_f32_16x16x32_bf16 v[28:31], v[76:79], v[88:91], v[28:31]
ds_read_b64_tr_b16 v[66:67], v14 offset:9216
v_mfma_f32_16x16x32_bf16 v[44:47], v[72:75], v[84:87], v[44:47]
ds_read_b64_tr_b16 v[68:69], v14 offset:12288
v_mfma_f32_16x16x32_bf16 v[44:47], v[76:79], v[92:95], v[44:47]
ds_read_b64_tr_b16 v[70:71], v14 offset:13312
s_waitcnt vmcnt(27) lgkmcnt(10)
v_mfma_f32_16x16x32_bf16 v[16:19], v[48:51], v[96:99], v[16:19]
ds_read_b64_tr_b16 v[72:73], v15 offset:8192
s_waitcnt vmcnt(26) lgkmcnt(9)
v_mfma_f32_16x16x32_bf16 v[16:19], v[52:55], v[104:107], v[16:19]
ds_read_b64_tr_b16 v[74:75], v15 offset:9216
s_waitcnt vmcnt(25)
v_mfma_f32_16x16x32_bf16 v[32:35], v[48:51], v[100:103], v[32:35]
ds_read_b64_tr_b16 v[76:77], v15 offset:12288
s_waitcnt vmcnt(24)
v_mfma_f32_16x16x32_bf16 v[32:35], v[52:55], v[108:111], v[32:35]
ds_read_b64_tr_b16 v[78:79], v15 offset:13312
s_waitcnt lgkmcnt(10)
v_mfma_f32_16x16x32_bf16 v[20:23], v[56:59], v[96:99], v[20:23]
ds_read_b64_tr_b16 v[48:49], v12 offset:16384
s_waitcnt lgkmcnt(9)
v_mfma_f32_16x16x32_bf16 v[20:23], v[60:63], v[104:107], v[20:23]
ds_read_b64_tr_b16 v[50:51], v12 offset:17408
v_mfma_f32_16x16x32_bf16 v[36:39], v[56:59], v[100:103], v[36:39]
ds_read_b64_tr_b16 v[52:53], v12 offset:20480
v_mfma_f32_16x16x32_bf16 v[36:39], v[60:63], v[108:111], v[36:39]
ds_read_b64_tr_b16 v[54:55], v12 offset:21504
s_waitcnt lgkmcnt(10)
v_mfma_f32_16x16x32_bf16 v[24:27], v[64:67], v[96:99], v[24:27]
ds_read_b64_tr_b16 v[56:57], v13 offset:16384
s_waitcnt lgkmcnt(9)
v_mfma_f32_16x16x32_bf16 v[24:27], v[68:71], v[104:107], v[24:27]
ds_read_b64_tr_b16 v[58:59], v13 offset:17408
v_mfma_f32_16x16x32_bf16 v[40:43], v[64:67], v[100:103], v[40:43]
ds_read_b64_tr_b16 v[60:61], v13 offset:20480
v_mfma_f32_16x16x32_bf16 v[40:43], v[68:71], v[108:111], v[40:43]
ds_read_b64_tr_b16 v[62:63], v13 offset:21504
s_waitcnt lgkmcnt(10)
v_mfma_f32_16x16x32_bf16 v[28:31], v[72:75], v[96:99], v[28:31]
ds_read_b64_tr_b16 v[64:65], v14 offset:16384
s_waitcnt lgkmcnt(9)
v_mfma_f32_16x16x32_bf16 v[28:31], v[76:79], v[104:107], v[28:31]
ds_read_b64_tr_b16 v[66:67], v14 offset:17408
v_mfma_f32_16x16x32_bf16 v[44:47], v[72:75], v[100:103], v[44:47]
ds_read_b64_tr_b16 v[68:69], v14 offset:20480
v_mfma_f32_16x16x32_bf16 v[44:47], v[76:79], v[108:111], v[44:47]
ds_read_b64_tr_b16 v[70:71], v14 offset:21504
s_waitcnt vmcnt(23) lgkmcnt(10)
v_mfma_f32_16x16x32_bf16 v[16:19], v[48:51], v[112:115], v[16:19]
ds_read_b64_tr_b16 v[72:73], v15 offset:16384
s_waitcnt vmcnt(22) lgkmcnt(9)
v_mfma_f32_16x16x32_bf16 v[16:19], v[52:55], v[120:123], v[16:19]
ds_read_b64_tr_b16 v[74:75], v15 offset:17408
s_waitcnt vmcnt(21)
v_mfma_f32_16x16x32_bf16 v[32:35], v[48:51], v[116:119], v[32:35]
ds_read_b64_tr_b16 v[76:77], v15 offset:20480
s_waitcnt vmcnt(20)
v_mfma_f32_16x16x32_bf16 v[32:35], v[52:55], v[124:127], v[32:35]
ds_read_b64_tr_b16 v[78:79], v15 offset:21504
s_waitcnt lgkmcnt(10)
v_mfma_f32_16x16x32_bf16 v[20:23], v[56:59], v[112:115], v[20:23]
ds_read_b64_tr_b16 v[48:49], v12 offset:24576
s_waitcnt lgkmcnt(9)
v_mfma_f32_16x16x32_bf16 v[20:23], v[60:63], v[120:123], v[20:23]
ds_read_b64_tr_b16 v[50:51], v12 offset:25600
v_mfma_f32_16x16x32_bf16 v[36:39], v[56:59], v[116:119], v[36:39]
ds_read_b64_tr_b16 v[52:53], v12 offset:28672
v_mfma_f32_16x16x32_bf16 v[36:39], v[60:63], v[124:127], v[36:39]
ds_read_b64_tr_b16 v[54:55], v12 offset:29696
s_waitcnt lgkmcnt(10)
v_mfma_f32_16x16x32_bf16 v[24:27], v[64:67], v[112:115], v[24:27]
ds_read_b64_tr_b16 v[56:57], v13 offset:24576
s_waitcnt lgkmcnt(9)
v_mfma_f32_16x16x32_bf16 v[24:27], v[68:71], v[120:123], v[24:27]
ds_read_b64_tr_b16 v[58:59], v13 offset:25600
v_mfma_f32_16x16x32_bf16 v[40:43], v[64:67], v[116:119], v[40:43]
ds_read_b64_tr_b16 v[60:61], v13 offset:28672
v_mfma_f32_16x16x32_bf16 v[40:43], v[68:71], v[124:127], v[40:43]
ds_read_b64_tr_b16 v[62:63], v13 offset:29696
s_waitcnt lgkmcnt(10)
v_mfma_f32_16x16x32_bf16 v[28:31], v[72:75], v[112:115], v[28:31]
ds_read_b64_tr_b16 v[64:65], v14 offset:24576
s_waitcnt lgkmcnt(9)
v_mfma_f32_16x16x32_bf16 v[28:31], v[76:79], v[120:123], v[28:31]
ds_read_b64_tr_b16 v[66:67], v14 offset:25600
v_mfma_f32_16x16x32_bf16 v[44:47], v[72:75], v[116:119], v[44:47]
ds_read_b64_tr_b16 v[68:69], v14 offset:28672
v_mfma_f32_16x16x32_bf16 v[44:47], v[76:79], v[124:127], v[44:47]
ds_read_b64_tr_b16 v[70:71], v14 offset:29696
s_waitcnt vmcnt(19) lgkmcnt(10)
v_mfma_f32_16x16x32_bf16 v[16:19], v[48:51], v[128:131], v[16:19]
ds_read_b64_tr_b16 v[72:73], v15 offset:24576
s_waitcnt vmcnt(18) lgkmcnt(9)
v_mfma_f32_16x16x32_bf16 v[16:19], v[52:55], v[136:139], v[16:19]
ds_read_b64_tr_b16 v[74:75], v15 offset:25600
s_waitcnt vmcnt(17)
v_mfma_f32_16x16x32_bf16 v[32:35], v[48:51], v[132:135], v[32:35]
ds_read_b64_tr_b16 v[76:77], v15 offset:28672
s_waitcnt vmcnt(16)
v_mfma_f32_16x16x32_bf16 v[32:35], v[52:55], v[140:143], v[32:35]
ds_read_b64_tr_b16 v[78:79], v15 offset:29696
s_waitcnt lgkmcnt(10)
v_mfma_f32_16x16x32_bf16 v[20:23], v[56:59], v[128:131], v[20:23]
ds_read_b64_tr_b16 v[48:49], v12 offset:32768
s_waitcnt lgkmcnt(9)
v_mfma_f32_16x16x32_bf16 v[20:23], v[60:63], v[136:139], v[20:23]
ds_read_b64_tr_b16 v[50:51], v12 offset:33792
v_mfma_f32_16x16x32_bf16 v[36:39], v[56:59], v[132:135], v[36:39]
ds_read_b64_tr_b16 v[52:53], v12 offset:36864
v_mfma_f32_16x16x32_bf16 v[36:39], v[60:63], v[140:143], v[36:39]
ds_read_b64_tr_b16 v[54:55], v12 offset:37888
s_waitcnt lgkmcnt(10)
v_mfma_f32_16x16x32_bf16 v[24:27], v[64:67], v[128:131], v[24:27]
ds_read_b64_tr_b16 v[56:57], v13 offset:32768
s_waitcnt lgkmcnt(9)
v_mfma_f32_16x16x32_bf16 v[24:27], v[68:71], v[136:139], v[24:27]
ds_read_b64_tr_b16 v[58:59], v13 offset:33792
v_mfma_f32_16x16x32_bf16 v[40:43], v[64:67], v[132:135], v[40:43]
ds_read_b64_tr_b16 v[60:61], v13 offset:36864
v_mfma_f32_16x16x32_bf16 v[40:43], v[68:71], v[140:143], v[40:43]
ds_read_b64_tr_b16 v[62:63], v13 offset:37888
s_waitcnt lgkmcnt(10)
v_mfma_f32_16x16x32_bf16 v[28:31], v[72:75], v[128:131], v[28:31]
ds_read_b64_tr_b16 v[64:65], v14 offset:32768
s_waitcnt lgkmcnt(9)
v_mfma_f32_16x16x32_bf16 v[28:31], v[76:79], v[136:139], v[28:31]
ds_read_b64_tr_b16 v[66:67], v14 offset:33792
v_mfma_f32_16x16x32_bf16 v[44:47], v[72:75], v[132:135], v[44:47]
ds_read_b64_tr_b16 v[68:69], v14 offset:36864
v_mfma_f32_16x16x32_bf16 v[44:47], v[76:79], v[140:143], v[44:47]
ds_read_b64_tr_b16 v[70:71], v14 offset:37888
s_waitcnt vmcnt(15) lgkmcnt(10)
v_mfma_f32_16x16x32_bf16 v[16:19], v[48:51], v[144:147], v[16:19]
ds_read_b64_tr_b16 v[72:73], v15 offset:32768
s_waitcnt vmcnt(14) lgkmcnt(9)
v_mfma_f32_16x16x32_bf16 v[16:19], v[52:55], v[152:155], v[16:19]
ds_read_b64_tr_b16 v[74:75], v15 offset:33792
s_waitcnt vmcnt(13)
v_mfma_f32_16x16x32_bf16 v[32:35], v[48:51], v[148:151], v[32:35]
ds_read_b64_tr_b16 v[76:77], v15 offset:36864
s_waitcnt vmcnt(12)
v_mfma_f32_16x16x32_bf16 v[32:35], v[52:55], v[156:159], v[32:35]
ds_read_b64_tr_b16 v[78:79], v15 offset:37888
s_waitcnt lgkmcnt(10)
v_mfma_f32_16x16x32_bf16 v[20:23], v[56:59], v[144:147], v[20:23]
ds_read_b64_tr_b16 v[48:49], v12 offset:40960
s_waitcnt lgkmcnt(9)
v_mfma_f32_16x16x32_bf16 v[20:23], v[60:63], v[152:155], v[20:23]
ds_read_b64_tr_b16 v[50:51], v12 offset:41984
v_mfma_f32_16x16x32_bf16 v[36:39], v[56:59], v[148:151], v[36:39]
ds_read_b64_tr_b16 v[52:53], v12 offset:45056
v_mfma_f32_16x16x32_bf16 v[36:39], v[60:63], v[156:159], v[36:39]
ds_read_b64_tr_b16 v[54:55], v12 offset:46080
s_waitcnt lgkmcnt(10)
v_mfma_f32_16x16x32_bf16 v[24:27], v[64:67], v[144:147], v[24:27]
ds_read_b64_tr_b16 v[56:57], v13 offset:40960
s_waitcnt lgkmcnt(9)
v_mfma_f32_16x16x32_bf16 v[24:27], v[68:71], v[152:155], v[24:27]
ds_read_b64_tr_b16 v[58:59], v13 offset:41984
v_mfma_f32_16x16x32_bf16 v[40:43], v[64:67], v[148:151], v[40:43]
ds_read_b64_tr_b16 v[60:61], v13 offset:45056
v_mfma_f32_16x16x32_bf16 v[40:43], v[68:71], v[156:159], v[40:43]
ds_read_b64_tr_b16 v[62:63], v13 offset:46080
s_waitcnt lgkmcnt(10)
v_mfma_f32_16x16x32_bf16 v[28:31], v[72:75], v[144:147], v[28:31]
ds_read_b64_tr_b16 v[64:65], v14 offset:40960
s_waitcnt lgkmcnt(9)
v_mfma_f32_16x16x32_bf16 v[28:31], v[76:79], v[152:155], v[28:31]
ds_read_b64_tr_b16 v[66:67], v14 offset:41984
v_mfma_f32_16x16x32_bf16 v[44:47], v[72:75], v[148:151], v[44:47]
ds_read_b64_tr_b16 v[68:69], v14 offset:45056
v_mfma_f32_16x16x32_bf16 v[44:47], v[76:79], v[156:159], v[44:47]
ds_read_b64_tr_b16 v[70:71], v14 offset:46080
s_waitcnt vmcnt(11) lgkmcnt(10)
v_mfma_f32_16x16x32_bf16 v[16:19], v[48:51], v[160:163], v[16:19]
ds_read_b64_tr_b16 v[72:73], v15 offset:40960
s_waitcnt vmcnt(10) lgkmcnt(9)
v_mfma_f32_16x16x32_bf16 v[16:19], v[52:55], v[168:171], v[16:19]
ds_read_b64_tr_b16 v[74:75], v15 offset:41984
s_waitcnt vmcnt(9)
v_mfma_f32_16x16x32_bf16 v[32:35], v[48:51], v[164:167], v[32:35]
ds_read_b64_tr_b16 v[76:77], v15 offset:45056
s_waitcnt vmcnt(8)
v_mfma_f32_16x16x32_bf16 v[32:35], v[52:55], v[172:175], v[32:35]
ds_read_b64_tr_b16 v[78:79], v15 offset:46080
s_waitcnt lgkmcnt(10)
v_mfma_f32_16x16x32_bf16 v[20:23], v[56:59], v[160:163], v[20:23]
ds_read_b64_tr_b16 v[48:49], v12 offset:49152
s_waitcnt lgkmcnt(9)
v_mfma_f32_16x16x32_bf16 v[20:23], v[60:63], v[168:171], v[20:23]
ds_read_b64_tr_b16 v[50:51], v12 offset:50176
v_mfma_f32_16x16x32_bf16 v[36:39], v[56:59], v[164:167], v[36:39]
ds_read_b64_tr_b16 v[52:53], v12 offset:53248
v_mfma_f32_16x16x32_bf16 v[36:39], v[60:63], v[172:175], v[36:39]
ds_read_b64_tr_b16 v[54:55], v12 offset:54272
s_waitcnt lgkmcnt(10)
v_mfma_f32_16x16x32_bf16 v[24:27], v[64:67], v[160:163], v[24:27]
ds_read_b64_tr_b16 v[56:57], v13 offset:49152
s_waitcnt lgkmcnt(9)
v_mfma_f32_16x16x32_bf16 v[24:27], v[68:71], v[168:171], v[24:27]
ds_read_b64_tr_b16 v[58:59], v13 offset:50176
v_mfma_f32_16x16x32_bf16 v[40:43], v[64:67], v[164:167], v[40:43]
ds_read_b64_tr_b16 v[60:61], v13 offset:53248
v_mfma_f32_16x16x32_bf16 v[40:43], v[68:71], v[172:175], v[40:43]
ds_read_b64_tr_b16 v[62:63], v13 offset:54272
s_waitcnt lgkmcnt(10)
v_mfma_f32_16x16x32_bf16 v[28:31], v[72:75], v[160:163], v[28:31]
ds_read_b64_tr_b16 v[64:65], v14 offset:49152
s_waitcnt lgkmcnt(9)
v_mfma_f32_16x16x32_bf16 v[28:31], v[76:79], v[168:171], v[28:31]
ds_read_b64_tr_b16 v[66:67], v14 offset:50176
v_mfma_f32_16x16x32_bf16 v[44:47], v[72:75], v[164:167], v[44:47]
ds_read_b64_tr_b16 v[68:69], v14 offset:53248
v_mfma_f32_16x16x32_bf16 v[44:47], v[76:79], v[172:175], v[44:47]
ds_read_b64_tr_b16 v[70:71], v14 offset:54272
s_waitcnt vmcnt(7) lgkmcnt(10)
v_mfma_f32_16x16x32_bf16 v[16:19], v[48:51], v[176:179], v[16:19]
ds_read_b64_tr_b16 v[72:73], v15 offset:49152
s_waitcnt vmcnt(6) lgkmcnt(9)
v_mfma_f32_16x16x32_bf16 v[16:19], v[52:55], v[184:187], v[16:19]
ds_read_b64_tr_b16 v[74:75], v15 offset:50176
s_waitcnt vmcnt(5)
v_mfma_f32_16x16x32_bf16 v[32:35], v[48:51], v[180:183], v[32:35]
ds_read_b64_tr_b16 v[76:77], v15 offset:53248
s_waitcnt vmcnt(4)
v_mfma_f32_16x16x32_bf16 v[32:35], v[52:55], v[188:191], v[32:35]
ds_read_b64_tr_b16 v[78:79], v15 offset:54272
s_waitcnt lgkmcnt(10)
v_mfma_f32_16x16x32_bf16 v[20:23], v[56:59], v[176:179], v[20:23]
ds_read_b64_tr_b16 v[48:49], v12 offset:57344
s_waitcnt lgkmcnt(9)
v_mfma_f32_16x16x32_bf16 v[20:23], v[60:63], v[184:187], v[20:23]
ds_read_b64_tr_b16 v[50:51], v12 offset:58368
v_mfma_f32_16x16x32_bf16 v[36:39], v[56:59], v[180:183], v[36:39]
ds_read_b64_tr_b16 v[52:53], v12 offset:61440
v_mfma_f32_16x16x32_bf16 v[36:39], v[60:63], v[188:191], v[36:39]
ds_read_b64_tr_b16 v[54:55], v12 offset:62464
s_waitcnt lgkmcnt(10)
v_mfma_f32_16x16x32_bf16 v[24:27], v[64:67], v[176:179], v[24:27]
ds_read_b64_tr_b16 v[56:57], v13 offset:57344
s_waitcnt lgkmcnt(9)
v_mfma_f32_16x16x32_bf16 v[24:27], v[68:71], v[184:187], v[24:27]
ds_read_b64_tr_b16 v[58:59], v13 offset:58368
v_mfma_f32_16x16x32_bf16 v[40:43], v[64:67], v[180:183], v[40:43]
ds_read_b64_tr_b16 v[60:61], v13 offset:61440
v_mfma_f32_16x16x32_bf16 v[40:43], v[68:71], v[188:191], v[40:43]
ds_read_b64_tr_b16 v[62:63], v13 offset:62464
s_waitcnt lgkmcnt(10)
v_mfma_f32_16x16x32_bf16 v[28:31], v[72:75], v[176:179], v[28:31]
ds_read_b64_tr_b16 v[64:65], v14 offset:57344
s_waitcnt lgkmcnt(9)
v_mfma_f32_16x16x32_bf16 v[28:31], v[76:79], v[184:187], v[28:31]
ds_read_b64_tr_b16 v[66:67], v14 offset:58368
v_mfma_f32_16x16x32_bf16 v[44:47], v[72:75], v[180:183], v[44:47]
ds_read_b64_tr_b16 v[68:69], v14 offset:61440
v_mfma_f32_16x16x32_bf16 v[44:47], v[76:79], v[188:191], v[44:47]
ds_read_b64_tr_b16 v[70:71], v14 offset:62464
s_waitcnt vmcnt(3) lgkmcnt(10)
v_mfma_f32_16x16x32_bf16 v[16:19], v[48:51], v[192:195], v[16:19]
ds_read_b64_tr_b16 v[72:73], v15 offset:57344
s_waitcnt vmcnt(2) lgkmcnt(9)
v_mfma_f32_16x16x32_bf16 v[16:19], v[52:55], v[200:203], v[16:19]
ds_read_b64_tr_b16 v[74:75], v15 offset:58368
s_waitcnt vmcnt(1)
v_mfma_f32_16x16x32_bf16 v[32:35], v[48:51], v[196:199], v[32:35]
ds_read_b64_tr_b16 v[76:77], v15 offset:61440
s_waitcnt vmcnt(0)
v_mfma_f32_16x16x32_bf16 v[32:35], v[52:55], v[204:207], v[32:35]
ds_read_b64_tr_b16 v[78:79], v15 offset:62464
s_waitcnt lgkmcnt(10)
v_mfma_f32_16x16x32_bf16 v[20:23], v[56:59], v[192:195], v[20:23]
v_add_u32 v5, s34, 22
s_mov_b64 exec, 1
ds_write_b32 v3, v5
s_mov_b64 exec, -1
s_waitcnt lgkmcnt(9)
v_mfma_f32_16x16x32_bf16 v[20:23], v[60:63], v[200:203], v[20:23]
v_mfma_f32_16x16x32_bf16 v[36:39], v[56:59], v[196:199], v[36:39]
v_mfma_f32_16x16x32_bf16 v[36:39], v[60:63], v[204:207], v[36:39]
s_waitcnt lgkmcnt(7)
v_mfma_f32_16x16x32_bf16 v[24:27], v[64:67], v[192:195], v[24:27]
s_waitcnt lgkmcnt(5)
v_mfma_f32_16x16x32_bf16 v[24:27], v[68:71], v[200:203], v[24:27]
v_mfma_f32_16x16x32_bf16 v[40:43], v[64:67], v[196:199], v[40:43]
v_mfma_f32_16x16x32_bf16 v[40:43], v[68:71], v[204:207], v[40:43]
s_waitcnt lgkmcnt(3)
v_mfma_f32_16x16x32_bf16 v[28:31], v[72:75], v[192:195], v[28:31]
s_waitcnt lgkmcnt(1)
v_mfma_f32_16x16x32_bf16 v[28:31], v[76:79], v[200:203], v[28:31]
v_mfma_f32_16x16x32_bf16 v[44:47], v[72:75], v[196:199], v[44:47]
v_mfma_f32_16x16x32_bf16 v[44:47], v[76:79], v[204:207], v[44:47]
s_lshl2_add_u32 s73, s61, s58
s_lshl4_add_u32 s66, s61, s62
s_lshl2_add_u32 s68, s66, s58
s_lshl_b32 s68, s68, 12
s_add_u32 s68, s68, 26214400
s_lshl_b32 s66, s61, 7
s_add_u32 s66, s66, s62
s_lshl_b32 s66, s66, 7
s_add_u32 s66, s66, 274432
s_lshl_b32 s74, s73, 13
s_add_u32 s74, s74, 524288
s_lshl_b32 s67, s62, 9
s_add_u32 s67, s67, s74
v_lshlrev_b32 v6, 4, v0
s_mov_b32 s69, 0x3f803f80
v_mov_b32 v8, 0
v_mov_b32 v9, 0
v_mov_b32 v10, 0
v_mov_b32 v11, 0
v_mov_b32 v12, 0
v_mov_b32 v13, 0
v_mov_b32 v14, 0
v_dot2c_f32_bf16 v11, s69, v232
v_dot2c_f32_bf16 v11, s69, v233
v_dot2c_f32_bf16 v11, s69, v234
v_dot2c_f32_bf16 v11, s69, v235
v_dot2c_f32_bf16 v11, s69, v236
v_dot2c_f32_bf16 v11, s69, v237
v_dot2c_f32_bf16 v11, s69, v238
v_dot2c_f32_bf16 v11, s69, v239
s_cmp_eq_u32 s63, 0
v_cvt_pk_bf16_f32 v240, v16, v17
v_cvt_pk_bf16_f32 v241, v18, v19
v_cvt_pk_bf16_f32 v242, v20, v21
v_cvt_pk_bf16_f32 v243, v22, v23
v_cvt_pk_bf16_f32 v244, v24, v25
v_cvt_pk_bf16_f32 v245, v26, v27
v_cvt_pk_bf16_f32 v246, v28, v29
v_cvt_pk_bf16_f32 v247, v30, v31
v_cvt_pk_bf16_f32 v248, v32, v33
v_cvt_pk_bf16_f32 v249, v34, v35
v_cvt_pk_bf16_f32 v250, v36, v37
v_cvt_pk_bf16_f32 v251, v38, v39
v_cvt_pk_bf16_f32 v252, v40, v41
v_cvt_pk_bf16_f32 v253, v42, v43
v_cvt_pk_bf16_f32 v254, v44, v45
v_cvt_pk_bf16_f32 v255, v46, v47
s_cselect_b64 exec, -1, 0
s_cmp_eq_u32 s57, 0
s_cbranch_scc1 far_164
buffer_store_dwordx4 v[240:243], v6, s[20:23], s68 offen offset:0
buffer_store_dwordx4 v[244:247], v6, s[20:23], s68 offen offset:1024
buffer_store_dwordx4 v[248:251], v6, s[20:23], s68 offen offset:2048
buffer_store_dwordx4 v[252:255], v6, s[20:23], s68 offen offset:3072
near_165:
s_mov_b64 exec, -1
v_dot2c_f32_bf16 v8, s69, v240
v_dot2c_f32_bf16 v9, v240, v240
v_dot2c_f32_bf16 v10, v232, v240
v_dot2c_f32_bf16 v12, s69, v248
v_dot2c_f32_bf16 v13, v248, v248
v_dot2c_f32_bf16 v14, v232, v248
v_dot2c_f32_bf16 v8, s69, v241
v_dot2c_f32_bf16 v9, v241, v241
v_dot2c_f32_bf16 v10, v233, v241
v_dot2c_f32_bf16 v12, s69, v249
v_dot2c_f32_bf16 v13, v249, v249
v_dot2c_f32_bf16 v14, v233, v249
v_dot2c_f32_bf16 v8, s69, v242
v_dot2c_f32_bf16 v9, v242, v242
v_dot2c_f32_bf16 v10, v234, v242
v_dot2c_f32_bf16 v12, s69, v250
v_dot2c_f32_bf16 v13, v250, v250
v_dot2c_f32_bf16 v14, v234, v250
v_dot2c_f32_bf16 v8, s69, v243
v_dot2c_f32_bf16 v9, v243, v243
v_dot2c_f32_bf16 v10, v235, v243
v_dot2c_f32_bf16 v12, s69, v251
v_dot2c_f32_bf16 v13, v251, v251
v_dot2c_f32_bf16 v14, v235, v251
v_dot2c_f32_bf16 v8, s69, v244
v_dot2c_f32_bf16 v9, v244, v244
v_dot2c_f32_bf16 v10, v236, v244
v_dot2c_f32_bf16 v12, s69, v252
v_dot2c_f32_bf16 v13, v252, v252
v_dot2c_f32_bf16 v14, v236, v252
v_dot2c_f32_bf16 v8, s69, v245
v_dot2c_f32_bf16 v9, v245, v245
v_dot2c_f32_bf16 v10, v237, v245
v_dot2c_f32_bf16 v12, s69, v253
v_dot2c_f32_bf16 v13, v253, v253
v_dot2c_f32_bf16 v14, v237, v253
v_dot2c_f32_bf16 v8, s69, v246
v_dot2c_f32_bf16 v9, v246, v246
v_dot2c_f32_bf16 v10, v238, v246
v_dot2c_f32_bf16 v12, s69, v254
v_dot2c_f32_bf16 v13, v254, v254
v_dot2c_f32_bf16 v14, v238, v254
v_dot2c_f32_bf16 v8, s69, v247
v_dot2c_f32_bf16 v9, v247, v247
v_dot2c_f32_bf16 v10, v239, v247
v_dot2c_f32_bf16 v12, s69, v255
v_dot2c_f32_bf16 v13, v255, v255
v_dot2c_f32_bf16 v14, v239, v255
v_mov_b32 v15, v11
v_lshrrev_b32 v7, 5, v0
v_mul_u32_u24 v7, 3584, v7
v_permlane16_swap_b32 v8, v12
v_permlane16_swap_b32 v9, v13
v_permlane16_swap_b32 v10, v14
v_permlane16_swap_b32 v11, v15
v_pk_add_f32 v[8:9], v[8:9], v[12:13]
v_pk_add_f32 v[10:11], v[10:11], v[14:15]
v_mov_b32 v12, v8
v_mov_b32 v13, v9
v_mov_b32 v14, v10
v_mov_b32 v15, v11
v_permlane32_swap_b32 v12, v8
v_permlane32_swap_b32 v13, v9
v_permlane32_swap_b32 v14, v10
v_permlane32_swap_b32 v15, v11
v_pk_add_f32 v[8:9], v[8:9], v[12:13]
v_pk_add_f32 v[10:11], v[10:11], v[14:15]
v_add_u32 v7, v6, v7
v_max_u32 v8, 1, v8
v_max_u32 v9, 1, v9
v_max_u32 v10, 1, v10
v_max_u32 v11, 1, v11
s_mov_b32 exec_hi, 0
s_cmp_eq_u32 s57, 0
s_cbranch_scc1 far_166
buffer_store_dwordx4 v[8:11], v6, s[24:27], s67 offen
near_167:
s_mov_b32 exec_hi, -1
v_lshlrev_b32 v16, 16, v240
v_and_b32 v17, 0xffff0000, v240
v_lshlrev_b32 v18, 16, v241
v_and_b32 v19, 0xffff0000, v241
v_lshlrev_b32 v20, 16, v242
v_and_b32 v21, 0xffff0000, v242
v_lshlrev_b32 v22, 16, v243
v_and_b32 v23, 0xffff0000, v243
v_lshlrev_b32 v24, 16, v244
v_and_b32 v25, 0xffff0000, v244
v_lshlrev_b32 v26, 16, v245
v_and_b32 v27, 0xffff0000, v245
v_lshlrev_b32 v28, 16, v246
v_and_b32 v29, 0xffff0000, v246
v_lshlrev_b32 v30, 16, v247
v_and_b32 v31, 0xffff0000, v247
v_lshlrev_b32 v32, 16, v248
v_and_b32 v33, 0xffff0000, v248
v_lshlrev_b32 v34, 16, v249
v_and_b32 v35, 0xffff0000, v249
v_lshlrev_b32 v36, 16, v250
v_and_b32 v37, 0xffff0000, v250
v_lshlrev_b32 v38, 16, v251
v_and_b32 v39, 0xffff0000, v251
v_lshlrev_b32 v40, 16, v252
v_and_b32 v41, 0xffff0000, v252
v_lshlrev_b32 v42, 16, v253
v_and_b32 v43, 0xffff0000, v253
v_lshlrev_b32 v44, 16, v254
v_and_b32 v45, 0xffff0000, v254
v_lshlrev_b32 v46, 16, v255
v_and_b32 v47, 0xffff0000, v255
v_and_b32 v14, 15, v0
v_lshlrev_b32 v14, 11, v14
v_bfe_u32 v15, v0, 4, 1
v_lshl_add_u32 v14, v15, 5, v14
v_lshrrev_b32 v15, 5, v0
v_lshl_add_u32 v14, v15, 4, v14
s_lshl2_add_u32 s70, s61, s58
s_lshl_b32 s70, s70, 16
s_lshl_b32 s71, s62, 7
s_add_u32 s70, s70, s71
s_add_u32 s71, s70, 0x8000
s_lshl_b32 s67, s62, 6
s_sub_u32 s68, s66, 2048
s_lshl1_add_u32 s69, s67, s68
s_sub_u32 s69, s69, 10240
s_sub_u32 s72, s68, s67
s_add_u32 s72, s72, 4096
s_lshl_b32 s75, s73, 5
s_add_u32 s75, s75, 1
v_and_b32 v15, 48, v0
v_add_u32 v13, s75, v0
v_lshlrev_b32 v4, 1, v15
s_mov_b64 exec, 1
s_waitcnt vmcnt(1)
s_cmp_eq_u32 s57, 0
s_cbranch_scc1 far_168
buffer_store_dword v212, v3, s[24:27], s66 offen
near_169:
s_mov_b64 exec, -1
v_add_u32 v5, s34, 23
s_mov_b64 exec, 1
ds_write_b32 v3, v5
s_mov_b64 exec, -1
s_waitcnt vmcnt(1)
poll_170:
buffer_load_dwordx4 v[80:83], v7, s[24:27], s74 offen offset:0 sc1
buffer_load_dwordx4 v[84:87], v7, s[24:27], s74 offen offset:512 sc1
buffer_load_dwordx4 v[88:91], v7, s[24:27], s74 offen offset:1024 sc1
buffer_load_dwordx4 v[92:95], v7, s[24:27], s74 offen offset:1536 sc1
buffer_load_dwordx4 v[96:99], v7, s[24:27], s74 offen offset:2048 sc1
buffer_load_dwordx4 v[100:103], v7, s[24:27], s74 offen offset:2560 sc1
buffer_load_dwordx4 v[104:107], v7, s[24:27], s74 offen offset:3072 sc1
buffer_load_dwordx4 v[108:111], v7, s[24:27], s74 offen offset:3584 sc1
pchk_171:
s_waitcnt vmcnt(7)
v_min3_u32 v8, v80, v81, v82
s_waitcnt vmcnt(6)
v_min3_u32 v8, v8, v83, v84
v_min3_u32 v8, v8, v85, v86
s_waitcnt vmcnt(5)
v_min3_u32 v8, v8, v87, v88
v_min3_u32 v8, v8, v89, v90
s_waitcnt vmcnt(4)
v_min3_u32 v8, v8, v91, v92
v_min3_u32 v8, v8, v93, v94
s_waitcnt vmcnt(3)
v_min3_u32 v8, v8, v95, v96
v_min3_u32 v8, v8, v97, v98
s_waitcnt vmcnt(2)
v_min3_u32 v8, v8, v99, v100
v_min3_u32 v8, v8, v101, v102
s_waitcnt vmcnt(1)
v_min3_u32 v8, v8, v103, v104
v_min3_u32 v8, v8, v105, v106
s_waitcnt vmcnt(0)
v_min3_u32 v8, v8, v107, v108
v_min3_u32 v8, v8, v109, v110
v_min_u32 v8, v8, v111
v_cmp_eq_u32 vcc, 0, v8
s_cbranch_vccz pdone_172
s_sub_u32 s32, s32, 1
s_cmp_gt_i32 s32, 0
s_cbranch_scc1 poll_170
pdone_172:
v_pk_add_f32 v[80:81], v[80:81], v[96:97]
v_pk_add_f32 v[82:83], v[82:83], v[98:99]
v_pk_add_f32 v[84:85], v[84:85], v[100:101]
v_pk_add_f32 v[86:87], v[86:87], v[102:103]
v_pk_add_f32 v[88:89], v[88:89], v[104:105]
v_pk_add_f32 v[90:91], v[90:91], v[106:107]
v_pk_add_f32 v[92:93], v[92:93], v[108:109]
v_pk_add_f32 v[94:95], v[94:95], v[110:111]
v_pk_add_f32 v[80:81], v[80:81], v[88:89]
v_pk_add_f32 v[82:83], v[82:83], v[90:91]
v_pk_add_f32 v[84:85], v[84:85], v[92:93]
v_pk_add_f32 v[86:87], v[86:87], v[94:95]
v_pk_add_f32 v[80:81], v[80:81], v[84:85]
v_pk_add_f32 v[82:83], v[82:83], v[86:87]
v_mov_b32 v8, v80
v_mov_b32 v9, v81
v_mov_b32 v10, v82
v_mov_b32 v11, v83
v_permlane32_swap_b32 v8, v80
v_permlane32_swap_b32 v9, v81
v_permlane32_swap_b32 v10, v82
v_permlane32_swap_b32 v11, v83
v_pk_add_f32 v[8:9], v[8:9], v[80:81]
v_pk_add_f32 v[10:11], v[10:11], v[82:83]
v_mul_f32 v8, 0xba800000, v8
v_mul_f32 v9, 0x3a800000, v9
v_fma_f32 v9, -v8, v8, v9
v_max_f32 v9, 0, v9
v_add_f32 v12, 0x3727c5ac, v9
v_rsq_f32 v80, v12
v_fma_f32 v10, v8, v11, v10
v_mul_f32 v12, v80, v10
v_max_u32 v12, 1, v12
v_add_u32 v7, s34, v3
v_mov_b32 v6, v12
s_nop 1
v_max_f32_dpp v6, v6, v6 row_ror:1 row_mask:0xf bank_mask:0xf
s_nop 1
v_max_f32_dpp v6, v6, v6 row_ror:2 row_mask:0xf bank_mask:0xf
s_nop 1
v_max_f32_dpp v6, v6, v6 row_ror:4 row_mask:0xf bank_mask:0xf
s_nop 1
v_max_f32_dpp v6, v6, v6 row_ror:8 row_mask:0xf bank_mask:0xf
v_mov_b32 v11, v6
s_nop 1
v_permlane16_swap_b32 v11, v6
v_max_f32 v6, v6, v11
v_cmp_eq_f32 vcc, v6, v12
s_ff1_i32_b64 s66, vcc
s_and_b32 s66, s66, 31
s_mov_b64 exec, 1
ds_write_b32 v7, v6 offset:256
s_mov_b64 exec, -1
v_add_u32 v7, s34, v1
v_mul_f32 v81, v8, v80
v_add_f32 v10, 1.0, v80
v_mov_b32 v82, v80
v_mov_b32 v83, v81
s_and_b32 s67, s66, 15
s_lshl_b32 s67, 0x10001, s67
s_bitcmp0_b32 s66, 4
v_permlane16_swap_b32 v80, v82
v_permlane16_swap_b32 v81, v83
s_cselect_b32 s76, s67, 0
s_cselect_b32 s78, 0, s67
s_cselect_b32 s77, s67, 0
s_cselect_b32 s79, 0, s67
s_add_u32 s75, s75, s66
v_pk_fma_f32 v[48:49], v[16:17], v[80:81], v[80:81] op_sel:[0,0,1] op_sel_hi:[1,0,1]
v_pk_fma_f32 v[50:51], v[18:19], v[80:81], v[80:81] op_sel:[0,0,1] op_sel_hi:[1,0,1]
v_pk_fma_f32 v[52:53], v[20:21], v[80:81], v[80:81] op_sel:[0,0,1] op_sel_hi:[1,0,1]
v_pk_fma_f32 v[54:55], v[22:23], v[80:81], v[80:81] op_sel:[0,0,1] op_sel_hi:[1,0,1]
v_pk_fma_f32 v[56:57], v[24:25], v[80:81], v[80:81] op_sel:[0,0,1] op_sel_hi:[1,0,1]
v_pk_fma_f32 v[58:59], v[26:27], v[80:81], v[80:81] op_sel:[0,0,1] op_sel_hi:[1,0,1]
v_pk_fma_f32 v[60:61], v[28:29], v[80:81], v[80:81] op_sel:[0,0,1] op_sel_hi:[1,0,1]
v_pk_fma_f32 v[62:63], v[30:31], v[80:81], v[80:81] op_sel:[0,0,1] op_sel_hi:[1,0,1]
v_pk_fma_f32 v[64:65], v[32:33], v[82:83], v[82:83] op_sel:[0,0,1] op_sel_hi:[1,0,1]
v_pk_fma_f32 v[66:67], v[34:35], v[82:83], v[82:83] op_sel:[0,0,1] op_sel_hi:[1,0,1]
v_pk_fma_f32 v[68:69], v[36:37], v[82:83], v[82:83] op_sel:[0,0,1] op_sel_hi:[1,0,1]
v_pk_fma_f32 v[70:71], v[38:39], v[82:83], v[82:83] op_sel:[0,0,1] op_sel_hi:[1,0,1]
v_pk_fma_f32 v[72:73], v[40:41], v[82:83], v[82:83] op_sel:[0,0,1] op_sel_hi:[1,0,1]
v_pk_fma_f32 v[74:75], v[42:43], v[82:83], v[82:83] op_sel:[0,0,1] op_sel_hi:[1,0,1]
v_pk_fma_f32 v[76:77], v[44:45], v[82:83], v[82:83] op_sel:[0,0,1] op_sel_hi:[1,0,1]
v_pk_fma_f32 v[78:79], v[46:47], v[82:83], v[82:83] op_sel:[0,0,1] op_sel_hi:[1,0,1]
v_cvt_pk_bf16_f32 v84, v48, v49
v_cvt_pk_bf16_f32 v85, v50, v51
v_cvt_pk_bf16_f32 v86, v52, v53
v_cvt_pk_bf16_f32 v87, v54, v55
v_cvt_pk_bf16_f32 v88, v56, v57
v_cvt_pk_bf16_f32 v89, v58, v59
v_cvt_pk_bf16_f32 v90, v60, v61
v_cvt_pk_bf16_f32 v91, v62, v63
v_cvt_pk_bf16_f32 v92, v64, v65
v_cvt_pk_bf16_f32 v93, v66, v67
v_cvt_pk_bf16_f32 v94, v68, v69
v_cvt_pk_bf16_f32 v95, v70, v71
v_cvt_pk_bf16_f32 v96, v72, v73
v_cvt_pk_bf16_f32 v97, v74, v75
v_cvt_pk_bf16_f32 v98, v76, v77
v_cvt_pk_bf16_f32 v99, v78, v79
ds_read_b32 v11, v7 offset:256
v_max_u32 v84, 1, v84
v_max_u32 v85, 1, v85
v_max_u32 v86, 1, v86
v_max_u32 v87, 1, v87
v_max_u32 v88, 1, v88
v_max_u32 v89, 1, v89
v_max_u32 v90, 1, v90
v_max_u32 v91, 1, v91
v_max_u32 v92, 1, v92
v_max_u32 v93, 1, v93
v_max_u32 v94, 1, v94
v_max_u32 v95, 1, v95
v_max_u32 v96, 1, v96
v_max_u32 v97, 1, v97
v_max_u32 v98, 1, v98
v_max_u32 v99, 1, v99
s_branch pchk_174
poll_173:
ds_read_b32 v11, v7 offset:256
pchk_174:
s_waitcnt lgkmcnt(0)
v_cmp_eq_u32 vcc, 0, v11
s_cbranch_vccz pdone_175
s_sub_u32 s32, s32, 1
s_cmp_gt_i32 s32, 0
s_cbranch_scc1 poll_173
pdone_175:
v_cmp_eq_f32 vcc, v11, v6
s_bfm_b32 s67, s58, 0
s_and_b32 s67, s67, vcc_lo
v_cmp_gt_f32 vcc, v11, v6
s_lshl_b32 s66, 1, s66
s_or_b32 s67, s67, vcc_lo
s_cselect_b64 s[76:77], 0, s[76:77]
s_cselect_b64 s[78:79], 0, s[78:79]
s_cselect_b64 exec, 0, s[66:67]
s_bitcmp0_b32 s62, 0
s_cselect_b64 exec, exec, 0
buffer_store_dwordx2 v[12:13], off, s[24:27], s72 sc1
s_mov_b64 exec, s[76:77]
buffer_store_dwordx4 v[84:87], v4, s[24:27], s68 offen offset:0 sc1
buffer_store_dwordx4 v[88:91], v4, s[24:27], s68 offen offset:16 sc1
s_mov_b64 exec, s[78:79]
buffer_store_dwordx4 v[92:95], v4, s[24:27], s68 offen offset:0 sc1
buffer_store_dwordx4 v[96:99], v4, s[24:27], s68 offen offset:16 sc1
s_mov_b64 exec, -1
v_add_u32 v5, s34, 24
s_mov_b64 exec, 1
ds_write_b32 v3, v5
s_mov_b64 exec, -1
v_pk_add_f32 v[16:17], v[16:17], v[48:49]
v_pk_add_f32 v[18:19], v[18:19], v[50:51]
v_pk_add_f32 v[20:21], v[20:21], v[52:53]
v_pk_add_f32 v[22:23], v[22:23], v[54:55]
v_pk_add_f32 v[24:25], v[24:25], v[56:57]
v_pk_add_f32 v[26:27], v[26:27], v[58:59]
v_pk_add_f32 v[28:29], v[28:29], v[60:61]
v_pk_add_f32 v[30:31], v[30:31], v[62:63]
v_pk_add_f32 v[32:33], v[32:33], v[64:65]
v_pk_add_f32 v[34:35], v[34:35], v[66:67]
v_pk_add_f32 v[36:37], v[36:37], v[68:69]
v_pk_add_f32 v[38:39], v[38:39], v[70:71]
v_pk_add_f32 v[40:41], v[40:41], v[72:73]
v_pk_add_f32 v[42:43], v[42:43], v[74:75]
v_pk_add_f32 v[44:45], v[44:45], v[76:77]
v_pk_add_f32 v[46:47], v[46:47], v[78:79]
v_cvt_pk_bf16_f32 v240, v16, v17
v_cvt_pk_bf16_f32 v241, v18, v19
v_cvt_pk_bf16_f32 v242, v20, v21
v_cvt_pk_bf16_f32 v243, v22, v23
v_cvt_pk_bf16_f32 v244, v24, v25
v_cvt_pk_bf16_f32 v245, v26, v27
v_cvt_pk_bf16_f32 v246, v28, v29
v_cvt_pk_bf16_f32 v247, v30, v31
v_cvt_pk_bf16_f32 v248, v32, v33
v_cvt_pk_bf16_f32 v249, v34, v35
v_cvt_pk_bf16_f32 v250, v36, v37
v_cvt_pk_bf16_f32 v251, v38, v39
v_cvt_pk_bf16_f32 v252, v40, v41
v_cvt_pk_bf16_f32 v253, v42, v43
v_cvt_pk_bf16_f32 v254, v44, v45
v_cvt_pk_bf16_f32 v255, v46, v47
v_max_u32 v16, 1, v16
v_max_u32 v17, 1, v17
v_max_u32 v18, 1, v18
v_max_u32 v19, 1, v19
v_max_u32 v20, 1, v20
v_max_u32 v21, 1, v21
v_max_u32 v22, 1, v22
v_max_u32 v23, 1, v23
v_max_u32 v24, 1, v24
v_max_u32 v25, 1, v25
v_max_u32 v26, 1, v26
v_max_u32 v27, 1, v27
v_max_u32 v28, 1, v28
v_max_u32 v29, 1, v29
v_max_u32 v30, 1, v30
v_max_u32 v31, 1, v31
v_max_u32 v32, 1, v32
v_max_u32 v33, 1, v33
v_max_u32 v34, 1, v34
v_max_u32 v35, 1, v35
v_max_u32 v36, 1, v36
v_max_u32 v37, 1, v37
v_max_u32 v38, 1, v38
v_max_u32 v39, 1, v39
v_max_u32 v40, 1, v40
v_max_u32 v41, 1, v41
v_max_u32 v42, 1, v42
v_max_u32 v43, 1, v43
v_max_u32 v44, 1, v44
v_max_u32 v45, 1, v45
v_max_u32 v46, 1, v46
v_max_u32 v47, 1, v47
s_mov_b64 exec, s[76:77]
buffer_store_dwordx4 v[16:19], v15, s[24:27], s69 offen offset:0 sc1
buffer_store_dwordx4 v[20:23], v15, s[24:27], s69 offen offset:64 sc1
buffer_store_dwordx4 v[24:27], v15, s[24:27], s69 offen offset:128 sc1
buffer_store_dwordx4 v[28:31], v15, s[24:27], s69 offen offset:192 sc1
s_mov_b64 exec, s[78:79]
buffer_store_dwordx4 v[32:35], v15, s[24:27], s69 offen offset:0 sc1
buffer_store_dwordx4 v[36:39], v15, s[24:27], s69 offen offset:64 sc1
buffer_store_dwordx4 v[40:43], v15, s[24:27], s69 offen offset:128 sc1
buffer_store_dwordx4 v[44:47], v15, s[24:27], s69 offen offset:192 sc1
s_mov_b64 exec, -1
s_cmp_eq_u32 s63, 0
s_cbranch_scc0 mout_176
v_mul_f32 v11, v10, v10
v_mov_b32 v12, 0x3727c5ac
v_fma_f32 v11, v11, v9, v12
v_rsq_f32 v11, v11
v_lshrrev_b32 v12, 3, v0
v_lshlrev_b32 v12, 6, v12
v_lshl_add_u32 v12, v0, 3, v12
v_mul_f32 v10, v10, v11
v_mul_f32 v11, v8, v10
s_lshl_b32 s66, s61, 5
s_add_u32 s66, s66, s58
s_lshl_b32 s66, s66, 9
s_add_u32 s66, s66, 1675264
v_max_u32 v11, 1, v11
s_cmp_eq_u32 s62, 8
s_cselect_b32 exec_lo, -1, 0
s_mov_b32 exec_hi, 0
s_cmp_eq_u32 s57, 0
s_cbranch_scc1 far_177
buffer_store_dwordx2 v[10:11], v12, s[24:27], s66 offen
near_178:
s_mov_b64 exec, -1
s_mov_b32 s63, 1
s_mov_b32 s34, 32
s_add_u32 s24, s24, 1409024
s_addc_u32 s25, s25, 0
s_mov_b32 s26, 1409024
s_branch L_mtop
mout_176:
v_permlane16_swap_b32 v240, v242
v_permlane16_swap_b32 v241, v243
v_permlane16_swap_b32 v244, v246
v_permlane16_swap_b32 v245, v247
v_permlane16_swap_b32 v248, v250
v_permlane16_swap_b32 v249, v251
v_permlane16_swap_b32 v252, v254
v_permlane16_swap_b32 v253, v255
s_not_b64 exec, s[76:77]
buffer_store_dwordx4 v[240:243], v14, s[28:31], s70 offen offset:0
buffer_store_dwordx4 v[244:247], v14, s[28:31], s70 offen offset:64
s_not_b64 exec, s[78:79]
buffer_store_dwordx4 v[248:251], v14, s[28:31], s71 offen offset:0
buffer_store_dwordx4 v[252:255], v14, s[28:31], s71 offen offset:64
s_mov_b64 exec, -1
s_or_b32 s66, s76, s78
s_cbranch_scc0 L_end
v_mov_b32 v11, 0
s_add_u32 s35, s34, 4
lw_179:
ds_read_b32 v5, v2 offset:24
s_waitcnt lgkmcnt(0)
v_cmp_gt_i32 vcc, s35, v5
s_cbranch_vccz lwd_180
s_sleep 2
s_sub_u32 s32, s32, 1
s_cmp_gt_i32 s32, 0
s_cbranch_scc1 lw_179
lwd_180:
ds_read_b32 v11, v11 offset:32
s_waitcnt lgkmcnt(0)
v_cmp_eq_u32 vcc, s75, v11
s_cbranch_vccnz L_end
s_mov_b64 exec, s[76:77]
buffer_store_dwordx4 v[240:243], v14, s[28:31], s70 offen offset:0
buffer_store_dwordx4 v[244:247], v14, s[28:31], s70 offen offset:64
s_mov_b64 exec, s[78:79]
buffer_store_dwordx4 v[248:251], v14, s[28:31], s71 offen offset:0
buffer_store_dwordx4 v[252:255], v14, s[28:31], s71 offen offset:64
s_mov_b64 exec, -1
s_branch L_end
mspin_127:
msp_181:
ds_read_b32 v5, v2 offset:16
s_waitcnt lgkmcnt(0)
v_cmp_ge_u32 vcc, v4, v5
s_cbranch_vccz mback_128
s_sub_u32 s32, s32, 1
s_cmp_gt_i32 s32, 0
s_cbranch_scc1 msp_181
s_branch mback_128
lspin_129:
s_add_u32 s35, s34, 2
lw_182:
ds_read_b32 v5, v2 offset:24
s_waitcnt lgkmcnt(0)
v_cmp_gt_i32 vcc, s35, v5
s_cbranch_vccz lwd_183
s_sub_u32 s32, s32, 1
s_cmp_gt_i32 s32, 0
s_cbranch_scc1 lw_182
lwd_183:
s_branch lback_130
patch_131:
s_bfe_u32 s66, s33, 0x20005
s_lshr_b32 s67, s66, 1
s_xor_b32 s66, s66, s67
s_and_b32 s66, s66, 1
s_cmp_eq_u32 s66, s65
s_cbranch_scc0 pback_132
s_bfe_u32 s66, s33, 0x10004
s_lshl1_add_u32 s73, s67, s66
s_and_b32 s66, s33, 15
s_mov_b32 s74, 0x10001
s_mov_b32 s75, s74
s_lshl_b64 s[74:75], s[74:75], s66
s_and_b32 s66, s66, 12
s_lshl_b32 s66, s66, 2
s_bfm_b64 s[76:77], 16, s66
s_nop 7
s_mov_b64 exec, s[74:75]
s_cmp_eq_u32 s73, 0
s_cbranch_scc0 pnx_185
ds_read_b128 v[16:19], v211 offset:3456
ds_read_b128 v[20:23], v211 offset:3520
s_branch pdn_184
pnx_185:
s_cmp_eq_u32 s73, 1
s_cbranch_scc0 pnx_186
ds_read_b128 v[24:27], v211 offset:3456
ds_read_b128 v[28:31], v211 offset:3520
s_branch pdn_184
pnx_186:
s_cmp_eq_u32 s73, 2
s_cbranch_scc0 pnx_187
ds_read_b128 v[32:35], v211 offset:3456
ds_read_b128 v[36:39], v211 offset:3520
s_branch pdn_184
pnx_187:
ds_read_b128 v[40:43], v211 offset:3456
ds_read_b128 v[44:47], v211 offset:3520
pdn_184:
s_mov_b64 exec, -1
s_waitcnt lgkmcnt(0)
s_branch pback_132
patch_133:
s_nop 7
s_nop 7
s_and_b32 s66, s33, 3
s_lshl2_add_u32 s66, s73, s66
s_mov_b64 exec, s[76:77]
s_cmp_eq_u32 s66, 0
s_cbranch_scc0 pnx_190
ds_read_b32 v48, v210 offset:3584
ds_read_b32 v52, v210 offset:3648
s_branch pdn_189
pnx_190:
s_cmp_eq_u32 s66, 1
s_cbranch_scc0 pnx_191
ds_read_b32 v49, v210 offset:3584
ds_read_b32 v53, v210 offset:3648
s_branch pdn_189
pnx_191:
s_cmp_eq_u32 s66, 2
s_cbranch_scc0 pnx_192
ds_read_b32 v50, v210 offset:3584
ds_read_b32 v54, v210 offset:3648
s_branch pdn_189
pnx_192:
s_cmp_eq_u32 s66, 3
s_cbranch_scc0 pnx_193
ds_read_b32 v51, v210 offset:3584
ds_read_b32 v55, v210 offset:3648
s_branch pdn_189
pnx_193:
s_cmp_eq_u32 s66, 4
s_cbranch_scc0 pnx_194
ds_read_b32 v56, v210 offset:3584
ds_read_b32 v60, v210 offset:3648
s_branch pdn_189
pnx_194:
s_cmp_eq_u32 s66, 5
s_cbranch_scc0 pnx_195
ds_read_b32 v57, v210 offset:3584
ds_read_b32 v61, v210 offset:3648
s_branch pdn_189
pnx_195:
s_cmp_eq_u32 s66, 6
s_cbranch_scc0 pnx_196
ds_read_b32 v58, v210 offset:3584
ds_read_b32 v62, v210 offset:3648
s_branch pdn_189
pnx_196:
s_cmp_eq_u32 s66, 7
s_cbranch_scc0 pnx_197
ds_read_b32 v59, v210 offset:3584
ds_read_b32 v63, v210 offset:3648
s_branch pdn_189
pnx_197:
s_cmp_eq_u32 s66, 8
s_cbranch_scc0 pnx_198
ds_read_b32 v64, v210 offset:3584
ds_read_b32 v68, v210 offset:3648
s_branch pdn_189
pnx_198:
s_cmp_eq_u32 s66, 9
s_cbranch_scc0 pnx_199
ds_read_b32 v65, v210 offset:3584
ds_read_b32 v69, v210 offset:3648
s_branch pdn_189
pnx_199:
s_cmp_eq_u32 s66, 10
s_cbranch_scc0 pnx_200
ds_read_b32 v66, v210 offset:3584
ds_read_b32 v70, v210 offset:3648
s_branch pdn_189
pnx_200:
s_cmp_eq_u32 s66, 11
s_cbranch_scc0 pnx_201
ds_read_b32 v67, v210 offset:3584
ds_read_b32 v71, v210 offset:3648
s_branch pdn_189
pnx_201:
s_cmp_eq_u32 s66, 12
s_cbranch_scc0 pnx_202
ds_read_b32 v72, v210 offset:3584
ds_read_b32 v76, v210 offset:3648
s_branch pdn_189
pnx_202:
s_cmp_eq_u32 s66, 13
s_cbranch_scc0 pnx_203
ds_read_b32 v73, v210 offset:3584
ds_read_b32 v77, v210 offset:3648
s_branch pdn_189
pnx_203:
s_cmp_eq_u32 s66, 14
s_cbranch_scc0 pnx_204
ds_read_b32 v74, v210 offset:3584
ds_read_b32 v78, v210 offset:3648
s_branch pdn_189
pnx_204:
ds_read_b32 v75, v210 offset:3584
ds_read_b32 v79, v210 offset:3648
pdn_189:
s_mov_b64 exec, -1
s_waitcnt lgkmcnt(0)
s_branch pback_134
patch_135:
s_nop 7
s_nop 7
s_mov_b64 exec, s[74:75]
s_cmp_eq_u32 s73, 0
s_cbranch_scc0 pnx_207
ds_read_b128 v[80:83], v211 offset:3328
ds_read_b128 v[84:87], v211 offset:3392
s_branch pdn_206
pnx_207:
s_cmp_eq_u32 s73, 1
s_cbranch_scc0 pnx_208
ds_read_b128 v[88:91], v211 offset:3328
ds_read_b128 v[92:95], v211 offset:3392
s_branch pdn_206
pnx_208:
s_cmp_eq_u32 s73, 2
s_cbranch_scc0 pnx_209
ds_read_b128 v[96:99], v211 offset:3328
ds_read_b128 v[100:103], v211 offset:3392
s_branch pdn_206
pnx_209:
ds_read_b128 v[104:107], v211 offset:3328
ds_read_b128 v[108:111], v211 offset:3392
pdn_206:
s_mov_b64 exec, -1
s_waitcnt lgkmcnt(0)
s_branch pback_136
cross_146:
s_cmp_eq_u32 s67, 122880
s_cbranch_scc0 cr2_211
v_add_u32 v5, s34, 18
s_mov_b64 exec, 1
ds_write_b32 v3, v5
s_mov_b64 exec, -1
v_mov_b32 v9, 0xf149f2ca
v_xor_b32 v216, v9, v216
v_xor_b32 v217, v9, v217
v_xor_b32 v218, v9, v218
v_xor_b32 v219, v9, v219
v_xor_b32 v220, v9, v220
v_xor_b32 v221, v9, v221
v_xor_b32 v222, v9, v222
v_xor_b32 v223, v9, v223
v_xor_b32 v224, v9, v224
v_xor_b32 v225, v9, v225
v_xor_b32 v226, v9, v226
v_xor_b32 v227, v9, v227
v_xor_b32 v228, v9, v228
v_xor_b32 v229, v9, v229
v_xor_b32 v230, v9, v230
v_xor_b32 v231, v9, v231
s_mov_b32 s67, 90112
s_cmp_eq_u32 s63, 0
s_cbranch_scc0 cr3_212
v_and_b32 v9, 15, v0
v_lshlrev_b32 v9, 11, v9
v_bfe_u32 v10, v0, 4, 1
v_lshl_add_u32 v9, v10, 5, v9
v_lshrrev_b32 v10, 5, v0
v_lshl_add_u32 v9, v10, 4, v9
s_lshl2_add_u32 s70, s61, s58
s_lshl_b32 s70, s70, 16
s_lshl_b32 s71, s62, 7
s_add_u32 s70, s70, s71
s_add_u32 s71, s70, 0x8000
buffer_load_dwordx4 v[240:243], v9, s[8:11], s70 offen offset:0
buffer_load_dwordx4 v[244:247], v9, s[8:11], s70 offen offset:64
buffer_load_dwordx4 v[248:251], v9, s[8:11], s71 offen offset:0
buffer_load_dwordx4 v[252:255], v9, s[8:11], s71 offen offset:64
cr3_212:
s_cmp_eq_u32 s59, 0
s_cbranch_scc1 cback_147
v_mov_b32 v9, 0
s_add_u32 s35, s34, 17
lw_213:
ds_read_b32 v5, v9 offset:16
s_waitcnt lgkmcnt(0)
v_cmp_gt_i32 vcc, s35, v5
s_cbranch_vccz lwd_214
s_sub_u32 s32, s32, 1
s_cmp_gt_i32 s32, 0
s_cbranch_scc1 lw_213
lwd_214:
s_branch cback_147
cr2_211:
v_add_u32 v5, s34, 19
s_mov_b64 exec, 1
ds_write_b32 v3, v5
s_mov_b64 exec, -1
s_mov_b32 s66, 28672
s_cmp_lt_u32 s59, 2
s_cbranch_scc1 cback_147
s_add_u32 s35, s34, 17
lw_215:
ds_read_b32 v5, v2 offset:16
s_waitcnt lgkmcnt(0)
v_cmp_gt_i32 vcc, s35, v5
s_cbranch_vccz lwd_216
s_sub_u32 s32, s32, 1
s_cmp_gt_i32 s32, 0
s_cbranch_scc1 lw_215
lwd_216:
s_branch cback_147
cross_148:
s_cmp_eq_u32 s67, 122880
s_cbranch_scc0 cr2_217
v_add_u32 v5, s34, 18
s_mov_b64 exec, 1
ds_write_b32 v3, v5
s_mov_b64 exec, -1
v_mov_b32 v9, 0xf149f2ca
v_xor_b32 v216, v9, v216
v_xor_b32 v217, v9, v217
v_xor_b32 v218, v9, v218
v_xor_b32 v219, v9, v219
v_xor_b32 v220, v9, v220
v_xor_b32 v221, v9, v221
v_xor_b32 v222, v9, v222
v_xor_b32 v223, v9, v223
v_xor_b32 v224, v9, v224
v_xor_b32 v225, v9, v225
v_xor_b32 v226, v9, v226
v_xor_b32 v227, v9, v227
v_xor_b32 v228, v9, v228
v_xor_b32 v229, v9, v229
v_xor_b32 v230, v9, v230
v_xor_b32 v231, v9, v231
s_mov_b32 s67, 90112
s_cmp_eq_u32 s63, 0
s_cbranch_scc0 cr3_218
v_and_b32 v9, 15, v0
v_lshlrev_b32 v9, 11, v9
v_bfe_u32 v10, v0, 4, 1
v_lshl_add_u32 v9, v10, 5, v9
v_lshrrev_b32 v10, 5, v0
v_lshl_add_u32 v9, v10, 4, v9
s_lshl2_add_u32 s70, s61, s58
s_lshl_b32 s70, s70, 16
s_lshl_b32 s71, s62, 7
s_add_u32 s70, s70, s71
s_add_u32 s71, s70, 0x8000
buffer_load_dwordx4 v[240:243], v9, s[8:11], s70 offen offset:0
buffer_load_dwordx4 v[244:247], v9, s[8:11], s70 offen offset:64
buffer_load_dwordx4 v[248:251], v9, s[8:11], s71 offen offset:0
buffer_load_dwordx4 v[252:255], v9, s[8:11], s71 offen offset:64
cr3_218:
s_cmp_eq_u32 s59, 0
s_cbranch_scc1 cback_149
v_mov_b32 v9, 0
s_add_u32 s35, s34, 17
lw_219:
ds_read_b32 v5, v9 offset:16
s_waitcnt lgkmcnt(0)
v_cmp_gt_i32 vcc, s35, v5
s_cbranch_vccz lwd_220
s_sub_u32 s32, s32, 1
s_cmp_gt_i32 s32, 0
s_cbranch_scc1 lw_219
lwd_220:
s_branch cback_149
cr2_217:
v_add_u32 v5, s34, 19
s_mov_b64 exec, 1
ds_write_b32 v3, v5
s_mov_b64 exec, -1
s_mov_b32 s66, 28672
s_cmp_lt_u32 s59, 2
s_cbranch_scc1 cback_149
s_add_u32 s35, s34, 17
lw_221:
ds_read_b32 v5, v2 offset:16
s_waitcnt lgkmcnt(0)
v_cmp_gt_i32 vcc, s35, v5
s_cbranch_vccz lwd_222
s_sub_u32 s32, s32, 1
s_cmp_gt_i32 s32, 0
s_cbranch_scc1 lw_221
lwd_222:
s_branch cback_149
slow_150:
s_add_u32 s70, s72, 270336
poll_223:
buffer_load_dword v10, v1, s[24:27], s70 offen sc1
pchk_224:
s_waitcnt vmcnt(0)
v_cmp_eq_u32 vcc, 0, v10
s_cbranch_vccz pdone_225
s_sub_u32 s32, s32, 1
s_cmp_gt_i32 s32, 0
s_cbranch_scc1 poll_223
pdone_225:
s_lshl_b32 s73, s60, 15
s_lshl_b32 s74, s63, 23
s_add_u32 s73, s73, s74
s_add_u32 s73, s73, 1048576
v_mov_b32 v10, 0xf149f2ca
v_mov_b32 v11, 0
v_mov_b32 v192, 0
v_mov_b32 v193, 0
v_mov_b32 v194, 0
v_mov_b32 v195, 0
v_mov_b32 v196, 0
v_mov_b32 v197, 0
v_mov_b32 v198, 0
v_mov_b32 v199, 0
v_mov_b32 v200, 0
v_mov_b32 v201, 0
v_mov_b32 v202, 0
v_mov_b32 v203, 0
v_mov_b32 v204, 0
v_mov_b32 v205, 0
v_mov_b32 v206, 0
v_mov_b32 v207, 0
v_mov_b32 v208, 0
v_mov_b32 v209, 0
v_mov_b32 v210, 0
v_mov_b32 v211, 0
s_lshl2_add_u32 s74, s59, s65
s_mov_b32 s75, 0
sl_226:
s_lshr_b32 s76, s74, 2
s_lshl_b32 s76, s76, 19
s_and_b32 s77, s74, 3
s_lshl_b32 s77, s77, 13
s_add_u32 s76, s76, s77
s_add_u32 s76, s76, s73
buffer_load_dwordx4 v[152:155], v6, s[20:23], s76 offen offset:0 sc1
buffer_load_dwordx4 v[156:159], v6, s[20:23], s76 offen offset:1024 sc1
s_cmp_eq_u32 s75, 0
s_cselect_b32 s76, 0xf149f2ca, 0
s_and_b32 s77, s75, 7
s_cselect_b32 s77, 0, -1
v_xor_b32 v112, s76, v216
v_and_b32 v112, s77, v112
v_xor_b32 v113, s76, v217
v_and_b32 v113, s77, v113
v_xor_b32 v114, s76, v218
v_and_b32 v114, s77, v114
v_xor_b32 v115, s76, v219
v_and_b32 v115, s77, v115
v_xor_b32 v116, s76, v220
v_and_b32 v116, s77, v116
v_xor_b32 v117, s76, v221
v_and_b32 v117, s77, v117
v_xor_b32 v118, s76, v222
v_and_b32 v118, s77, v118
v_xor_b32 v119, s76, v223
v_and_b32 v119, s77, v119
v_xor_b32 v120, s76, v224
v_and_b32 v120, s77, v120
v_xor_b32 v121, s76, v225
v_and_b32 v121, s77, v121
v_xor_b32 v122, s76, v226
v_and_b32 v122, s77, v122
v_xor_b32 v123, s76, v227
v_and_b32 v123, s77, v123
v_xor_b32 v124, s76, v228
v_and_b32 v124, s77, v124
v_xor_b32 v125, s76, v229
v_and_b32 v125, s77, v125
v_xor_b32 v126, s76, v230
v_and_b32 v126, s77, v126
v_xor_b32 v127, s76, v231
v_and_b32 v127, s77, v127
s_waitcnt vmcnt(1)
s_nop 0
v_mfma_f32_32x32x16_bf16 v[112:127], v[152:155], v[80:83], v[112:127]
s_waitcnt vmcnt(0)
v_mfma_f32_32x32x16_bf16 v[112:127], v[156:159], v[88:91], v[112:127]
s_nop 11
v_max3_f32 v10, v10, v112, v113
v_max3_f32 v10, v10, v114, v115
v_max3_f32 v10, v10, v116, v117
v_max3_f32 v10, v10, v118, v119
v_max3_f32 v10, v10, v120, v121
v_max3_f32 v10, v10, v122, v123
v_max3_f32 v10, v10, v124, v125
v_max3_f32 v10, v10, v126, v127
s_add_u32 s75, s75, 1
s_sub_u32 s74, s74, 1
s_cselect_b32 s75, 9, s75
s_cmp_lt_u32 s75, 9
s_cbranch_scc1 sl_226
v_mov_b32 v11, v10
s_nop 1
v_permlane32_swap_b32 v11, v10
v_max_f32 v10, v10, v11
s_lshl2_add_u32 s74, s59, s65
s_mov_b32 s75, 0
sl_227:
s_lshr_b32 s76, s74, 2
s_lshl_b32 s76, s76, 19
s_and_b32 s77, s74, 3
s_lshl_b32 s77, s77, 13
s_add_u32 s76, s76, s77
s_add_u32 s76, s76, s73
buffer_load_dwordx4 v[152:155], v6, s[20:23], s76 offen offset:0 sc1
buffer_load_dwordx4 v[156:159], v6, s[20:23], s76 offen offset:1024 sc1
buffer_load_dwordx4 v[160:163], v6, s[20:23], s76 offen offset:2048 sc1
buffer_load_dwordx4 v[164:167], v6, s[20:23], s76 offen offset:3072 sc1
s_cmp_eq_u32 s75, 0
s_cselect_b32 s76, 0xf149f2ca, 0
s_and_b32 s77, s75, 7
s_cselect_b32 s77, 0, -1
v_xor_b32 v112, s76, v216
v_and_b32 v112, s77, v112
v_sub_f32 v112, v112, v10
v_xor_b32 v113, s76, v217
v_and_b32 v113, s77, v113
v_sub_f32 v113, v113, v10
v_xor_b32 v114, s76, v218
v_and_b32 v114, s77, v114
v_sub_f32 v114, v114, v10
v_xor_b32 v115, s76, v219
v_and_b32 v115, s77, v115
v_sub_f32 v115, v115, v10
v_xor_b32 v116, s76, v220
v_and_b32 v116, s77, v116
v_sub_f32 v116, v116, v10
v_xor_b32 v117, s76, v221
v_and_b32 v117, s77, v117
v_sub_f32 v117, v117, v10
v_xor_b32 v118, s76, v222
v_and_b32 v118, s77, v118
v_sub_f32 v118, v118, v10
v_xor_b32 v119, s76, v223
v_and_b32 v119, s77, v119
v_sub_f32 v119, v119, v10
v_xor_b32 v120, s76, v224
v_and_b32 v120, s77, v120
v_sub_f32 v120, v120, v10
v_xor_b32 v121, s76, v225
v_and_b32 v121, s77, v121
v_sub_f32 v121, v121, v10
v_xor_b32 v122, s76, v226
v_and_b32 v122, s77, v122
v_sub_f32 v122, v122, v10
v_xor_b32 v123, s76, v227
v_and_b32 v123, s77, v123
v_sub_f32 v123, v123, v10
v_xor_b32 v124, s76, v228
v_and_b32 v124, s77, v124
v_sub_f32 v124, v124, v10
v_xor_b32 v125, s76, v229
v_and_b32 v125, s77, v125
v_sub_f32 v125, v125, v10
v_xor_b32 v126, s76, v230
v_and_b32 v126, s77, v126
v_sub_f32 v126, v126, v10
v_xor_b32 v127, s76, v231
v_and_b32 v127, s77, v127
v_sub_f32 v127, v127, v10
s_waitcnt vmcnt(3)
s_nop 0
v_mfma_f32_32x32x16_bf16 v[112:127], v[152:155], v[80:83], v[112:127]
s_waitcnt vmcnt(2)
v_mfma_f32_32x32x16_bf16 v[112:127], v[156:159], v[88:91], v[112:127]
s_nop 11
v_exp_f32 v112, v112
v_exp_f32 v113, v113
v_exp_f32 v114, v114
v_exp_f32 v115, v115
v_exp_f32 v116, v116
v_exp_f32 v117, v117
v_exp_f32 v118, v118
v_exp_f32 v119, v119
v_exp_f32 v120, v120
v_exp_f32 v121, v121
v_exp_f32 v122, v122
v_exp_f32 v123, v123
v_exp_f32 v124, v124
v_exp_f32 v125, v125
v_exp_f32 v126, v126
v_exp_f32 v127, v127
v_cvt_pk_bf16_f32 v144, v112, v113
v_cvt_pk_bf16_f32 v145, v114, v115
v_cvt_pk_bf16_f32 v146, v116, v117
v_cvt_pk_bf16_f32 v147, v118, v119
v_cvt_pk_bf16_f32 v148, v120, v121
v_cvt_pk_bf16_f32 v149, v122, v123
v_cvt_pk_bf16_f32 v150, v124, v125
v_cvt_pk_bf16_f32 v151, v126, v127
s_waitcnt vmcnt(1)
v_mfma_f32_32x32x16_bf16 v[192:207], v[160:163], v[144:147], v[192:207]
v_mfma_f32_16x16x32_bf16 v[208:211], v[212:215], v[144:147], v[208:211]
s_waitcnt vmcnt(0)
v_mfma_f32_32x32x16_bf16 v[192:207], v[164:167], v[148:151], v[192:207]
v_mfma_f32_16x16x32_bf16 v[208:211], v[212:215], v[148:151], v[208:211]
s_add_u32 s75, s75, 1
s_sub_u32 s74, s74, 1
s_cselect_b32 s75, 9, s75
s_cmp_lt_u32 s75, 9
s_cbranch_scc1 sl_227
v_mov_b32 v10, 0xf149f2ca
v_mov_b32 v11, 0
v_mov_b32 v16, 0
v_mov_b32 v17, 0
v_mov_b32 v18, 0
v_mov_b32 v19, 0
v_mov_b32 v20, 0
v_mov_b32 v21, 0
v_mov_b32 v22, 0
v_mov_b32 v23, 0
v_mov_b32 v24, 0
v_mov_b32 v25, 0
v_mov_b32 v26, 0
v_mov_b32 v27, 0
v_mov_b32 v28, 0
v_mov_b32 v29, 0
v_mov_b32 v30, 0
v_mov_b32 v31, 0
v_mov_b32 v32, 0
v_mov_b32 v33, 0
v_mov_b32 v34, 0
v_mov_b32 v35, 0
s_sub_u32 s74, 3, s65
s_lshl2_add_u32 s74, s59, s74
s_mov_b32 s75, 0
sl_228:
s_lshr_b32 s76, s74, 2
s_lshl_b32 s76, s76, 19
s_and_b32 s77, s74, 3
s_lshl_b32 s77, s77, 13
s_add_u32 s76, s76, s77
s_add_u32 s76, s76, s73
buffer_load_dwordx4 v[152:155], v6, s[20:23], s76 offen offset:0 sc1
buffer_load_dwordx4 v[156:159], v6, s[20:23], s76 offen offset:1024 sc1
s_cmp_eq_u32 s75, 0
s_cselect_b32 s76, 0xf149f2ca, 0
s_and_b32 s77, s75, 7
s_cselect_b32 s77, 0, -1
v_xor_b32 v112, s76, v216
v_and_b32 v112, s77, v112
v_xor_b32 v113, s76, v217
v_and_b32 v113, s77, v113
v_xor_b32 v114, s76, v218
v_and_b32 v114, s77, v114
v_xor_b32 v115, s76, v219
v_and_b32 v115, s77, v115
v_xor_b32 v116, s76, v220
v_and_b32 v116, s77, v116
v_xor_b32 v117, s76, v221
v_and_b32 v117, s77, v117
v_xor_b32 v118, s76, v222
v_and_b32 v118, s77, v118
v_xor_b32 v119, s76, v223
v_and_b32 v119, s77, v119
v_xor_b32 v120, s76, v224
v_and_b32 v120, s77, v120
v_xor_b32 v121, s76, v225
v_and_b32 v121, s77, v121
v_xor_b32 v122, s76, v226
v_and_b32 v122, s77, v122
v_xor_b32 v123, s76, v227
v_and_b32 v123, s77, v123
v_xor_b32 v124, s76, v228
v_and_b32 v124, s77, v124
v_xor_b32 v125, s76, v229
v_and_b32 v125, s77, v125
v_xor_b32 v126, s76, v230
v_and_b32 v126, s77, v126
v_xor_b32 v127, s76, v231
v_and_b32 v127, s77, v127
s_waitcnt vmcnt(1)
s_nop 0
v_mfma_f32_32x32x16_bf16 v[112:127], v[152:155], v[96:99], v[112:127]
s_waitcnt vmcnt(0)
v_mfma_f32_32x32x16_bf16 v[112:127], v[156:159], v[104:107], v[112:127]
s_nop 11
v_max3_f32 v10, v10, v112, v113
v_max3_f32 v10, v10, v114, v115
v_max3_f32 v10, v10, v116, v117
v_max3_f32 v10, v10, v118, v119
v_max3_f32 v10, v10, v120, v121
v_max3_f32 v10, v10, v122, v123
v_max3_f32 v10, v10, v124, v125
v_max3_f32 v10, v10, v126, v127
s_add_u32 s75, s75, 1
s_sub_u32 s74, s74, 1
s_cselect_b32 s75, 9, s75
s_cmp_lt_u32 s75, 9
s_cbranch_scc1 sl_228
v_mov_b32 v11, v10
s_nop 1
v_permlane32_swap_b32 v11, v10
v_max_f32 v10, v10, v11
s_sub_u32 s74, 3, s65
s_lshl2_add_u32 s74, s59, s74
s_mov_b32 s75, 0
sl_229:
s_lshr_b32 s76, s74, 2
s_lshl_b32 s76, s76, 19
s_and_b32 s77, s74, 3
s_lshl_b32 s77, s77, 13
s_add_u32 s76, s76, s77
s_add_u32 s76, s76, s73
buffer_load_dwordx4 v[152:155], v6, s[20:23], s76 offen offset:0 sc1
buffer_load_dwordx4 v[156:159], v6, s[20:23], s76 offen offset:1024 sc1
buffer_load_dwordx4 v[160:163], v6, s[20:23], s76 offen offset:2048 sc1
buffer_load_dwordx4 v[164:167], v6, s[20:23], s76 offen offset:3072 sc1
s_cmp_eq_u32 s75, 0
s_cselect_b32 s76, 0xf149f2ca, 0
s_and_b32 s77, s75, 7
s_cselect_b32 s77, 0, -1
v_xor_b32 v112, s76, v216
v_and_b32 v112, s77, v112
v_sub_f32 v112, v112, v10
v_xor_b32 v113, s76, v217
v_and_b32 v113, s77, v113
v_sub_f32 v113, v113, v10
v_xor_b32 v114, s76, v218
v_and_b32 v114, s77, v114
v_sub_f32 v114, v114, v10
v_xor_b32 v115, s76, v219
v_and_b32 v115, s77, v115
v_sub_f32 v115, v115, v10
v_xor_b32 v116, s76, v220
v_and_b32 v116, s77, v116
v_sub_f32 v116, v116, v10
v_xor_b32 v117, s76, v221
v_and_b32 v117, s77, v117
v_sub_f32 v117, v117, v10
v_xor_b32 v118, s76, v222
v_and_b32 v118, s77, v118
v_sub_f32 v118, v118, v10
v_xor_b32 v119, s76, v223
v_and_b32 v119, s77, v119
v_sub_f32 v119, v119, v10
v_xor_b32 v120, s76, v224
v_and_b32 v120, s77, v120
v_sub_f32 v120, v120, v10
v_xor_b32 v121, s76, v225
v_and_b32 v121, s77, v121
v_sub_f32 v121, v121, v10
v_xor_b32 v122, s76, v226
v_and_b32 v122, s77, v122
v_sub_f32 v122, v122, v10
v_xor_b32 v123, s76, v227
v_and_b32 v123, s77, v123
v_sub_f32 v123, v123, v10
v_xor_b32 v124, s76, v228
v_and_b32 v124, s77, v124
v_sub_f32 v124, v124, v10
v_xor_b32 v125, s76, v229
v_and_b32 v125, s77, v125
v_sub_f32 v125, v125, v10
v_xor_b32 v126, s76, v230
v_and_b32 v126, s77, v126
v_sub_f32 v126, v126, v10
v_xor_b32 v127, s76, v231
v_and_b32 v127, s77, v127
v_sub_f32 v127, v127, v10
s_waitcnt vmcnt(3)
s_nop 0
v_mfma_f32_32x32x16_bf16 v[112:127], v[152:155], v[96:99], v[112:127]
s_waitcnt vmcnt(2)
v_mfma_f32_32x32x16_bf16 v[112:127], v[156:159], v[104:107], v[112:127]
s_nop 11
v_exp_f32 v112, v112
v_exp_f32 v113, v113
v_exp_f32 v114, v114
v_exp_f32 v115, v115
v_exp_f32 v116, v116
v_exp_f32 v117, v117
v_exp_f32 v118, v118
v_exp_f32 v119, v119
v_exp_f32 v120, v120
v_exp_f32 v121, v121
v_exp_f32 v122, v122
v_exp_f32 v123, v123
v_exp_f32 v124, v124
v_exp_f32 v125, v125
v_exp_f32 v126, v126
v_exp_f32 v127, v127
v_cvt_pk_bf16_f32 v144, v112, v113
v_cvt_pk_bf16_f32 v145, v114, v115
v_cvt_pk_bf16_f32 v146, v116, v117
v_cvt_pk_bf16_f32 v147, v118, v119
v_cvt_pk_bf16_f32 v148, v120, v121
v_cvt_pk_bf16_f32 v149, v122, v123
v_cvt_pk_bf16_f32 v150, v124, v125
v_cvt_pk_bf16_f32 v151, v126, v127
s_waitcnt vmcnt(1)
v_mfma_f32_32x32x16_bf16 v[16:31], v[160:163], v[144:147], v[16:31]
v_mfma_f32_16x16x32_bf16 v[32:35], v[212:215], v[144:147], v[32:35]
s_waitcnt vmcnt(0)
v_mfma_f32_32x32x16_bf16 v[16:31], v[164:167], v[148:151], v[16:31]
v_mfma_f32_16x16x32_bf16 v[32:35], v[212:215], v[148:151], v[32:35]
s_add_u32 s75, s75, 1
s_sub_u32 s74, s74, 1
s_cselect_b32 s75, 9, s75
s_cmp_lt_u32 s75, 9
s_cbranch_scc1 sl_229
s_branch sback_151
far_152:
buffer_store_dwordx4 v[16:19], v9, s[20:23], s67 offen offset:0 sc1
buffer_store_dwordx4 v[20:23], v9, s[20:23], s67 offen offset:1024 sc1
s_branch near_153
far_154:
buffer_store_dwordx4 v[192:195], v9, s[20:23], s66 offen offset:0 sc1
buffer_store_dwordx4 v[196:199], v9, s[20:23], s66 offen offset:1024 sc1
s_branch near_155
far_158:
buffer_store_dword v212, v3, s[24:27], s70 offen sc1
s_branch near_159
mo_160:
s_lshr_b32 s67, s33, 5
s_cmp_eq_u32 s67, s66
s_cbranch_scc0 mo_161
s_and_b32 s67, s33, 31
v_sub_u32 v48, s67, v48
v_lshlrev_b32 v49, 4, v49
s_lshl_b32 s67, s62, 14
s_add_u32 s67, s67, 30686208
poll_230:
buffer_load_dwordx4 v[56:59], v49, s[20:23], s67 offen offset:0 sc1
buffer_load_dwordx4 v[60:63], v49, s[20:23], s67 offen offset:64 sc1
pchk_231:
s_waitcnt vmcnt(1)
v_min3_u32 v50, v56, v57, v58
s_waitcnt vmcnt(0)
v_min3_u32 v50, v50, v59, v60
v_min3_u32 v50, v50, v61, v62
v_min_u32 v50, v50, v63
v_cmp_eq_u32 vcc, 0, v50
s_cbranch_vccz pdone_232
s_sub_u32 s32, s32, 1
s_cmp_gt_i32 s32, 0
s_cbranch_scc1 poll_230
pdone_232:
v_cmp_eq_u32 vcc, 0, v48
s_nop 1
v_cndmask_b32 v240, v240, v56, vcc
v_cndmask_b32 v241, v241, v57, vcc
v_cndmask_b32 v242, v242, v58, vcc
v_cndmask_b32 v243, v243, v59, vcc
v_cndmask_b32 v244, v244, v60, vcc
v_cndmask_b32 v245, v245, v61, vcc
v_cndmask_b32 v246, v246, v62, vcc
v_cndmask_b32 v247, v247, v63, vcc
v_cmp_eq_u32 vcc, 16, v48
s_nop 1
v_cndmask_b32 v248, v248, v56, vcc
v_cndmask_b32 v249, v249, v57, vcc
v_cndmask_b32 v250, v250, v58, vcc
v_cndmask_b32 v251, v251, v59, vcc
v_cndmask_b32 v252, v252, v60, vcc
v_cndmask_b32 v253, v253, v61, vcc
v_cndmask_b32 v254, v254, v62, vcc
v_cndmask_b32 v255, v255, v63, vcc
s_branch mo_161
far_164:
buffer_store_dwordx4 v[240:243], v6, s[20:23], s68 offen offset:0 sc1
buffer_store_dwordx4 v[244:247], v6, s[20:23], s68 offen offset:1024 sc1
buffer_store_dwordx4 v[248:251], v6, s[20:23], s68 offen offset:2048 sc1
buffer_store_dwordx4 v[252:255], v6, s[20:23], s68 offen offset:3072 sc1
s_branch near_165
far_166:
buffer_store_dwordx4 v[8:11], v6, s[24:27], s67 offen sc1
s_branch near_167
far_168:
buffer_store_dword v212, v3, s[24:27], s66 offen sc1
s_branch near_169
far_177:
buffer_store_dwordx2 v[10:11], v12, s[24:27], s66 offen sc1
s_branch near_178
L_end:
L_fin:
s_endpgm
.section .rodata,"a"
.p2align 6
.amdhsa_kernel interleave_layers__sliding_block__moe_arch_mod__prompt_kernel
  .amdhsa_next_free_vgpr 256
  .amdhsa_next_free_sgpr 102
  .amdhsa_accum_offset 256
  .amdhsa_group_segment_fixed_size 0
  .amdhsa_kernarg_size 88
  .amdhsa_user_sgpr_count 2
  .amdhsa_user_sgpr_kernarg_segment_ptr 1
  .amdhsa_system_sgpr_workgroup_id_x 1
  .amdhsa_float_denorm_mode_32 3
.end_amdhsa_kernel
```

```asm
; @launch grid=(256,1,1) block=(512,1,1) lds=163840
.amdgcn_target "amdgcn-amd-amdhsa--gfx950"
.text
.globl interleave_layers__sliding_block__moe_arch_mod__prompt_kernel
.p2align 8
.type interleave_layers__sliding_block__moe_arch_mod__prompt_kernel,@function
interleave_layers__sliding_block__moe_arch_mod__prompt_kernel:
s_cmp_ge_u32 s2, 256
s_cbranch_scc1 L_fin
s_load_dwordx16 s[36:51], s[0:1], 0
s_load_dwordx4 s[52:55], s[0:1], 64
s_load_dwordx2 s[56:57], s[0:1], 80
v_lshrrev_b32 v1, 6, v0
v_and_b32 v0, 63, v0
s_and_b32 s64, s2, 7
v_readfirstlane_b32 s3, v1
s_lshr_b32 s65, s2, 3
s_and_b32 s66, s65, 7
s_and_b32 s67, s64, 1
s_lshl3_add_u32 s59, s67, s66
s_lshr_b32 s66, s65, 3
s_lshr_b32 s67, s64, 1
s_lshl2_add_u32 s60, s67, s66
s_and_b32 s66, s65, 1
s_lshl1_add_u32 s61, s64, s66
s_lshr_b32 s62, s65, 1
s_mov_b32 s59, s61
s_xor_b32 s60, s62, 0
s_mov_b32 s63, 0
s_mov_b32 s34, 0
s_mov_b32 s32, 200000
s_mov_b32 s33, -1
s_cmp_ge_u32 s3, 4
s_cselect_b32 s66, 3, 1
s_and_b32 s58, s3, s66
s_waitcnt lgkmcnt(0)
s_mov_b32 s8, s36
s_mov_b32 s9, s37
s_mov_b32 s10, 0x400000
s_mov_b32 s11, 0x00020000
s_mov_b32 s12, s38
s_mov_b32 s13, s39
s_mov_b32 s14, 0x600000
s_mov_b32 s15, 0x00020000
s_mov_b32 s16, s40
s_mov_b32 s17, s41
s_mov_b32 s18, 0x200000
s_mov_b32 s19, 0x00020000
s_mov_b32 s20, s56
s_mov_b32 s21, s57
s_mov_b32 s22, 0x2500000
s_mov_b32 s23, 0x00020000
s_add_u32 s24, s56, 30408704
s_addc_u32 s25, s57, 0
s_mov_b32 s26, 2818048
s_mov_b32 s27, 0x00020000
s_mov_b32 s28, s52
s_mov_b32 s29, s53
s_mov_b32 s30, 0x400000
s_mov_b32 s31, 0x00020000
s_cmp_ge_u32 s3, 4
s_cbranch_scc1 L_m
s_cmp_ge_u32 s3, 2
s_cbranch_scc1 L_f
s_setprio 1
v_and_b32 v22, 7, v0
v_lshrrev_b32 v23, 4, v0
v_lshrrev_b32 v6, 3, v0
v_xor_b32 v7, v22, v23
v_lshlrev_b32 v7, 4, v7
v_lshl_add_u32 v8, v6, 11, v7
v_xor_b32 v7, 64, v8
v_add_u32 v9, 15360, v7
v_add_u32 v10, 30720, v8
v_add_u32 v11, 46080, v7
s_lshl_b32 s70, s59, 18
s_lshl_b32 s71, s58, 16
s_add_u32 s68, s70, s71
s_sub_u32 s69, s70, s71
s_add_u32 s69, s69, 196608
s_mov_b32 s67, 128
s_lshl_b32 s75, s58, 13
s_mov_b32 s65, 86016
s_and_b32 s79, s59, 1
s_mul_i32 s70, s60, 1
s_and_b32 s71, s59, 14
s_add_u32 s70, s70, s71
s_and_b32 s70, s70, 15
s_xor_b32 s64, s70, s79
s_mul_i32 s70, s64, s67
s_add_u32 m0, s65, s75
s_add_u32 s71, s70, s68
buffer_load_dwordx4 v8, s[8:11], s71 offen offset:0 lds
buffer_load_dwordx4 v9, s[8:11], s71 offen offset:1024 lds
buffer_load_dwordx4 v10, s[8:11], s71 offen offset:2048 lds
buffer_load_dwordx4 v11, s[8:11], s71 offen offset:3072 lds
s_add_u32 m0, m0, 4096
s_add_u32 s71, s70, s69
buffer_load_dwordx4 v8, s[8:11], s71 offen offset:0 lds
buffer_load_dwordx4 v9, s[8:11], s71 offen offset:1024 lds
buffer_load_dwordx4 v10, s[8:11], s71 offen offset:2048 lds
buffer_load_dwordx4 v11, s[8:11], s71 offen offset:3072 lds
v_and_b32 v7, 2, v6
v_xor_b32 v7, v7, v22
v_mul_u32_u24 v6, 6144, v6
v_lshl_add_u32 v12, v7, 4, v6
v_xor_b32 v6, 64, v12
v_add_u32 v13, 48128, v6
v_add_u32 v14, 96256, v12
v_add_u32 v15, 144384, v6
s_mul_i32 s76, s58, 12288
s_add_u32 s76, s76, 16384
s_lshl_b32 s70, s60, 7
s_cmp_eq_u32 s58, 0
s_mov_b32 s71, 198656
s_cselect_b32 s72, 0, s71
s_mov_b32 s71, 4096
s_cselect_b32 s73, 196608, s71
s_mov_b32 s71, 200704
s_cselect_b32 s74, 2048, s71
s_add_u32 s72, s72, s70
s_add_u32 s73, s73, s70
s_add_u32 s74, s74, s70
s_mul_i32 s70, s64, 393216
s_add_u32 m0, s65, s76
s_add_u32 s71, s70, s72
buffer_load_dwordx4 v12, s[12:15], s71 offen offset:0 lds
buffer_load_dwordx4 v13, s[12:15], s71 offen offset:1024 lds
buffer_load_dwordx4 v14, s[12:15], s71 offen offset:2048 lds
buffer_load_dwordx4 v15, s[12:15], s71 offen offset:3072 lds
s_add_u32 m0, m0, 4096
s_add_u32 s71, s70, s73
buffer_load_dwordx4 v12, s[12:15], s71 offen offset:0 lds
buffer_load_dwordx4 v13, s[12:15], s71 offen offset:1024 lds
buffer_load_dwordx4 v14, s[12:15], s71 offen offset:2048 lds
buffer_load_dwordx4 v15, s[12:15], s71 offen offset:3072 lds
s_add_u32 m0, m0, 4096
s_add_u32 s71, s70, s74
buffer_load_dwordx4 v12, s[12:15], s71 offen offset:0 lds
buffer_load_dwordx4 v13, s[12:15], s71 offen offset:1024 lds
buffer_load_dwordx4 v14, s[12:15], s71 offen offset:2048 lds
buffer_load_dwordx4 v15, s[12:15], s71 offen offset:3072 lds
s_xor_b32 s64, s64, s79
s_add_u32 s64, s64, 1
s_and_b32 s64, s64, 15
s_xor_b32 s64, s64, s79
s_sub_u32 s65, s65, 40960
s_cselect_b32 s65, 86016, s65
v_and_b32 v1, 3, v0
v_lshlrev_b32 v1, 2, v1
v_and_b32 v2, 4, v1
s_lshl2_add_u32 s35, s58, 16
v_mov_b32 v3, s35
v_lshlrev_b32 v20, 4, v0
v_lshrrev_b32 v6, 2, v0
v_lshl_add_u32 v21, v6, 7, v1
v_lshrrev_b32 v6, 3, v0
v_lshlrev_b32 v23, 1, v23
v_xor_b32 v23, v23, v22
v_lshlrev_b32 v23, 4, v23
v_lshl_add_u32 v23, v6, 11, v23
s_lshl_b32 s70, s62, 7
s_lshl_b32 s71, s58, 16
s_add_u32 s70, s70, s71
v_add_u32 v16, s70, v23
v_add_u32 v17, 15360, v16
v_add_u32 v18, 30720, v16
v_add_u32 v19, 46080, v16
s_add_u32 s77, s61, s62
s_lshl_b32 s77, s77, 17
s_lshl_b32 s78, s58, 12
s_mov_b32 s66, -2
s_barrier
.p2align 4
lq_1:
s_add_u32 s35, s66, 1
lw_4:
ds_read_b32 v5, v1 offset:0
s_waitcnt lgkmcnt(0)
v_cmp_gt_i32 vcc, s35, v5
s_cbranch_vccz lwd_5
s_sub_u32 s32, s32, 1
s_cmp_gt_i32 s32, 0
s_cbranch_scc1 lw_4
lwd_5:
s_cmp_eq_u32 s66, 0
s_cbranch_scc1 lcs_2
lcb_3:
s_mul_i32 s70, s64, s67
s_add_u32 m0, s65, s75
s_add_u32 s71, s70, s68
buffer_load_dwordx4 v8, s[8:11], s71 offen offset:0 sc1 lds
buffer_load_dwordx4 v9, s[8:11], s71 offen offset:1024 sc1 lds
buffer_load_dwordx4 v10, s[8:11], s71 offen offset:2048 sc1 lds
buffer_load_dwordx4 v11, s[8:11], s71 offen offset:3072 sc1 lds
buffer_load_dword v30, off, s[12:15], 0
s_add_u32 m0, m0, 4096
s_add_u32 s71, s70, s69
buffer_load_dwordx4 v8, s[8:11], s71 offen offset:0 sc1 lds
buffer_load_dwordx4 v9, s[8:11], s71 offen offset:1024 sc1 lds
buffer_load_dwordx4 v10, s[8:11], s71 offen offset:2048 sc1 lds
buffer_load_dwordx4 v11, s[8:11], s71 offen offset:3072 sc1 lds
buffer_load_dword v30, off, s[12:15], 0
s_mul_i32 s70, s64, 393216
s_add_u32 m0, s65, s76
s_add_u32 s71, s70, s72
buffer_load_dwordx4 v12, s[12:15], s71 offen offset:0 lds
buffer_load_dwordx4 v13, s[12:15], s71 offen offset:1024 lds
buffer_load_dwordx4 v14, s[12:15], s71 offen offset:2048 lds
buffer_load_dwordx4 v15, s[12:15], s71 offen offset:3072 lds
buffer_load_dword v30, off, s[12:15], 0
v_add_u32 v5, s66, 3
s_mov_b64 exec, 1
s_waitcnt vmcnt(15)
ds_write_b32 v3, v5
s_mov_b64 exec, -1
s_mul_i32 s70, s64, 393216
s_add_u32 m0, m0, 4096
s_add_u32 s71, s70, s73
buffer_load_dwordx4 v12, s[12:15], s71 offen offset:0 lds
buffer_load_dwordx4 v13, s[12:15], s71 offen offset:1024 lds
buffer_load_dwordx4 v14, s[12:15], s71 offen offset:2048 lds
buffer_load_dwordx4 v15, s[12:15], s71 offen offset:3072 lds
buffer_load_dword v30, off, s[12:15], 0
s_mul_i32 s70, s64, 393216
s_add_u32 m0, m0, 4096
s_add_u32 s71, s70, s74
buffer_load_dwordx4 v12, s[12:15], s71 offen offset:0 lds
buffer_load_dwordx4 v13, s[12:15], s71 offen offset:1024 lds
buffer_load_dwordx4 v14, s[12:15], s71 offen offset:2048 lds
buffer_load_dwordx4 v15, s[12:15], s71 offen offset:3072 lds
buffer_load_dword v30, off, s[12:15], 0
s_xor_b32 s64, s64, s79
s_add_u32 s64, s64, 1
s_and_b32 s64, s64, 15
s_xor_b32 s64, s64, s79
s_sub_u32 s65, s65, 40960
s_cselect_b32 s65, 86016, s65
s_add_u32 s66, s66, 1
s_and_b32 s70, s66, 31
s_cmp_eq_u32 s70, 13
s_cbranch_scc0 lq_1
s_waitcnt vmcnt(0)
v_add_u32 v5, s34, 16
s_mov_b64 exec, 1
ds_write_b32 v3, v5
s_mov_b64 exec, -1
s_add_u32 s35, s34, 14
lw_6:
ds_read_b32 v5, v1 offset:0
s_waitcnt lgkmcnt(0)
v_cmp_gt_i32 vcc, s35, v5
s_cbranch_vccz lwd_7
s_sleep 1
s_sub_u32 s32, s32, 1
s_cmp_gt_i32 s32, 0
s_cbranch_scc1 lw_6
lwd_7:
s_add_u32 s70, s77, 262144
s_add_u32 m0, s78, 49152
s_and_b32 s70, s70, 0x1fffff
buffer_load_dwordx4 v16, s[16:19], s70 offen offset:0 lds
buffer_load_dwordx4 v17, s[16:19], s70 offen offset:1024 lds
buffer_load_dwordx4 v18, s[16:19], s70 offen offset:2048 lds
buffer_load_dwordx4 v19, s[16:19], s70 offen offset:3072 lds
buffer_load_dword v30, off, s[12:15], 0
s_add_u32 s70, s77, 393216
s_add_u32 m0, s78, 57344
s_and_b32 s70, s70, 0x1fffff
buffer_load_dwordx4 v16, s[16:19], s70 offen offset:0 lds
buffer_load_dwordx4 v17, s[16:19], s70 offen offset:1024 lds
buffer_load_dwordx4 v18, s[16:19], s70 offen offset:2048 lds
buffer_load_dwordx4 v19, s[16:19], s70 offen offset:3072 lds
buffer_load_dword v30, off, s[12:15], 0
s_add_u32 s70, s77, 524288
s_add_u32 m0, s78, 65536
s_and_b32 s70, s70, 0x1fffff
buffer_load_dwordx4 v16, s[16:19], s70 offen offset:0 lds
buffer_load_dwordx4 v17, s[16:19], s70 offen offset:1024 lds
buffer_load_dwordx4 v18, s[16:19], s70 offen offset:2048 lds
buffer_load_dwordx4 v19, s[16:19], s70 offen offset:3072 lds
buffer_load_dword v30, off, s[12:15], 0
s_add_u32 s70, s77, 655360
s_add_u32 m0, s78, 73728
s_and_b32 s70, s70, 0x1fffff
buffer_load_dwordx4 v16, s[16:19], s70 offen offset:0 lds
buffer_load_dwordx4 v17, s[16:19], s70 offen offset:1024 lds
buffer_load_dwordx4 v18, s[16:19], s70 offen offset:2048 lds
buffer_load_dwordx4 v19, s[16:19], s70 offen offset:3072 lds
buffer_load_dword v30, off, s[12:15], 0
s_sub_u32 s70, s59, s58
s_lshl_b32 s71, s70, 7
s_add_u32 s71, s71, s60
s_lshl4_add_u32 s70, s70, s60
s_sub_u32 s70, s70, 16
s_lshl_b32 s66, s71, 7
s_add_u32 s66, s66, 253952
s_lshl_b32 s70, s70, 15
s_lshl_b32 s71, s63, 23
s_add_u32 s70, s70, s71
s_add_u32 s64, s70, 1077248
s_mul_i32 s65, s58, -94208
s_add_u32 s35, s34, 16
lw_8:
ds_read_b32 v5, v1 offset:0
s_waitcnt lgkmcnt(0)
v_cmp_gt_i32 vcc, s35, v5
s_cbranch_vccz lwd_9
s_sleep 1
s_sub_u32 s32, s32, 1
s_cmp_gt_i32 s32, 0
s_cbranch_scc1 lw_8
lwd_9:
s_add_u32 s70, s77, 131072
s_add_u32 m0, s78, 40960
s_and_b32 s70, s70, 0x1fffff
buffer_load_dwordx4 v16, s[16:19], s70 offen offset:0 lds
buffer_load_dwordx4 v17, s[16:19], s70 offen offset:1024 lds
buffer_load_dwordx4 v18, s[16:19], s70 offen offset:2048 lds
buffer_load_dwordx4 v19, s[16:19], s70 offen offset:3072 lds
buffer_load_dword v30, off, s[12:15], 0
s_add_u32 s70, s77, 786432
s_add_u32 m0, s78, 81920
s_and_b32 s70, s70, 0x1fffff
buffer_load_dwordx4 v16, s[16:19], s70 offen offset:0 lds
buffer_load_dwordx4 v17, s[16:19], s70 offen offset:1024 lds
buffer_load_dwordx4 v18, s[16:19], s70 offen offset:2048 lds
buffer_load_dwordx4 v19, s[16:19], s70 offen offset:3072 lds
buffer_load_dword v30, off, s[12:15], 0
s_add_u32 s70, s77, 917504
s_add_u32 m0, s78, 90112
s_and_b32 s70, s70, 0x1fffff
buffer_load_dwordx4 v16, s[16:19], s70 offen offset:0 lds
buffer_load_dwordx4 v17, s[16:19], s70 offen offset:1024 lds
buffer_load_dwordx4 v18, s[16:19], s70 offen offset:2048 lds
buffer_load_dwordx4 v19, s[16:19], s70 offen offset:3072 lds
buffer_load_dword v30, off, s[12:15], 0
s_add_u32 s35, s34, 17
lw_11:
ds_read_b32 v5, v1 offset:0
s_waitcnt lgkmcnt(0)
v_cmp_gt_i32 vcc, s35, v5
s_cbranch_vccz lwd_12
s_sleep 1
s_sub_u32 s32, s32, 1
s_cmp_gt_i32 s32, 0
s_cbranch_scc1 lw_11
lwd_12:
s_cmp_gt_u32 s59, s58
s_cbranch_scc0 nokv_10
poll_13:
buffer_load_dword v6, v1, s[24:27], s66 offen sc1
pchk_14:
s_waitcnt vmcnt(0)
v_cmp_eq_u32 vcc, 0, v6
s_cbranch_vccz pdone_15
s_sub_u32 s32, s32, 1
s_cmp_gt_i32 s32, 0
s_cbranch_scc1 poll_13
pdone_15:
s_add_u32 m0, s65, 126976
s_nop 0
buffer_load_dwordx4 v20, s[20:23], s64 offen offset:0 sc1 lds
buffer_load_dwordx4 v20, s[20:23], s64 offen offset:1024 sc1 lds
buffer_load_dwordx4 v20, s[20:23], s64 offen offset:2048 sc1 lds
buffer_load_dwordx4 v20, s[20:23], s64 offen offset:3072 sc1 lds
buffer_load_dword v30, off, s[12:15], 0
s_add_u32 m0, s65, 122880
s_sub_u32 s64, s64, 4096
buffer_load_dwordx4 v20, s[20:23], s64 offen offset:0 sc1 lds
buffer_load_dwordx4 v20, s[20:23], s64 offen offset:1024 sc1 lds
buffer_load_dwordx4 v20, s[20:23], s64 offen offset:2048 sc1 lds
buffer_load_dwordx4 v20, s[20:23], s64 offen offset:3072 sc1 lds
buffer_load_dword v30, off, s[12:15], 0
s_add_u32 m0, s65, 118784
s_sub_u32 s64, s64, 4096
buffer_load_dwordx4 v20, s[20:23], s64 offen offset:0 sc1 lds
buffer_load_dwordx4 v20, s[20:23], s64 offen offset:1024 sc1 lds
buffer_load_dwordx4 v20, s[20:23], s64 offen offset:2048 sc1 lds
buffer_load_dwordx4 v20, s[20:23], s64 offen offset:3072 sc1 lds
buffer_load_dword v30, off, s[12:15], 0
s_add_u32 m0, s65, 114688
s_sub_u32 s64, s64, 4096
buffer_load_dwordx4 v20, s[20:23], s64 offen offset:0 sc1 lds
buffer_load_dwordx4 v20, s[20:23], s64 offen offset:1024 sc1 lds
buffer_load_dwordx4 v20, s[20:23], s64 offen offset:2048 sc1 lds
buffer_load_dwordx4 v20, s[20:23], s64 offen offset:3072 sc1 lds
buffer_load_dword v30, off, s[12:15], 0
s_add_u32 m0, s65, 110592
s_sub_u32 s64, s64, 4096
buffer_load_dwordx4 v20, s[20:23], s64 offen offset:0 sc1 lds
buffer_load_dwordx4 v20, s[20:23], s64 offen offset:1024 sc1 lds
buffer_load_dwordx4 v20, s[20:23], s64 offen offset:2048 sc1 lds
buffer_load_dwordx4 v20, s[20:23], s64 offen offset:3072 sc1 lds
buffer_load_dword v30, off, s[12:15], 0
s_add_u32 m0, s65, 106496
s_sub_u32 s64, s64, 4096
buffer_load_dwordx4 v20, s[20:23], s64 offen offset:0 sc1 lds
buffer_load_dwordx4 v20, s[20:23], s64 offen offset:1024 sc1 lds
buffer_load_dwordx4 v20, s[20:23], s64 offen offset:2048 sc1 lds
buffer_load_dwordx4 v20, s[20:23], s64 offen offset:3072 sc1 lds
buffer_load_dword v30, off, s[12:15], 0
s_add_u32 m0, s65, 102400
s_sub_u32 s64, s64, 4096
buffer_load_dwordx4 v20, s[20:23], s64 offen offset:0 sc1 lds
buffer_load_dwordx4 v20, s[20:23], s64 offen offset:1024 sc1 lds
buffer_load_dwordx4 v20, s[20:23], s64 offen offset:2048 sc1 lds
buffer_load_dwordx4 v20, s[20:23], s64 offen offset:3072 sc1 lds
buffer_load_dword v30, off, s[12:15], 0
s_add_u32 m0, s65, 98304
s_sub_u32 s64, s64, 4096
buffer_load_dwordx4 v20, s[20:23], s64 offen offset:0 sc1 lds
buffer_load_dwordx4 v20, s[20:23], s64 offen offset:1024 sc1 lds
buffer_load_dwordx4 v20, s[20:23], s64 offen offset:2048 sc1 lds
buffer_load_dwordx4 v20, s[20:23], s64 offen offset:3072 sc1 lds
buffer_load_dword v30, off, s[12:15], 0
nokv_10:
s_lshl_b32 s66, s61, 14
s_add_u32 s66, s66, 268288
s_waitcnt vmcnt(0)
v_add_u32 v5, s34, 17
s_mov_b64 exec, 1
ds_write_b32 v3, v5
s_mov_b64 exec, -1
s_add_u32 s35, s34, 18
lw_17:
ds_read_b32 v5, v1 offset:0
s_waitcnt lgkmcnt(0)
v_cmp_gt_i32 vcc, s35, v5
s_cbranch_vccz lwd_18
s_sleep 1
s_sub_u32 s32, s32, 1
s_cmp_gt_i32 s32, 0
s_cbranch_scc1 lw_17
lwd_18:
s_add_u32 s70, s77, 1572864
s_add_u32 m0, s78, 131072
s_and_b32 s70, s70, 0x1fffff
buffer_load_dwordx4 v16, s[16:19], s70 offen offset:0 lds
buffer_load_dwordx4 v17, s[16:19], s70 offen offset:1024 lds
buffer_load_dwordx4 v18, s[16:19], s70 offen offset:2048 lds
buffer_load_dwordx4 v19, s[16:19], s70 offen offset:3072 lds
buffer_load_dword v30, off, s[12:15], 0
s_add_u32 s70, s77, 1703936
s_add_u32 m0, s78, 139264
s_and_b32 s70, s70, 0x1fffff
buffer_load_dwordx4 v16, s[16:19], s70 offen offset:0 lds
buffer_load_dwordx4 v17, s[16:19], s70 offen offset:1024 lds
buffer_load_dwordx4 v18, s[16:19], s70 offen offset:2048 lds
buffer_load_dwordx4 v19, s[16:19], s70 offen offset:3072 lds
buffer_load_dword v30, off, s[12:15], 0
s_add_u32 s70, s77, 1835008
s_add_u32 m0, s78, 147456
s_and_b32 s70, s70, 0x1fffff
buffer_load_dwordx4 v16, s[16:19], s70 offen offset:0 lds
buffer_load_dwordx4 v17, s[16:19], s70 offen offset:1024 lds
buffer_load_dwordx4 v18, s[16:19], s70 offen offset:2048 lds
buffer_load_dwordx4 v19, s[16:19], s70 offen offset:3072 lds
buffer_load_dword v30, off, s[12:15], 0
s_add_u32 s70, s77, 1966080
s_add_u32 m0, s78, 155648
s_and_b32 s70, s70, 0x1fffff
buffer_load_dwordx4 v16, s[16:19], s70 offen offset:0 lds
buffer_load_dwordx4 v17, s[16:19], s70 offen offset:1024 lds
buffer_load_dwordx4 v18, s[16:19], s70 offen offset:2048 lds
buffer_load_dwordx4 v19, s[16:19], s70 offen offset:3072 lds
buffer_load_dword v30, off, s[12:15], 0
s_add_u32 s35, s34, 19
lw_19:
ds_read_b32 v5, v1 offset:0
s_waitcnt lgkmcnt(0)
v_cmp_gt_i32 vcc, s35, v5
s_cbranch_vccz lwd_20
s_sleep 2
s_sub_u32 s32, s32, 1
s_cmp_gt_i32 s32, 0
s_cbranch_scc1 lw_19
lwd_20:
s_add_u32 s70, s77, 1048576
s_add_u32 m0, s78, 98304
s_and_b32 s70, s70, 0x1fffff
buffer_load_dwordx4 v16, s[16:19], s70 offen offset:0 lds
buffer_load_dwordx4 v17, s[16:19], s70 offen offset:1024 lds
buffer_load_dwordx4 v18, s[16:19], s70 offen offset:2048 lds
buffer_load_dwordx4 v19, s[16:19], s70 offen offset:3072 lds
buffer_load_dword v30, off, s[12:15], 0
s_add_u32 s70, s77, 1179648
s_add_u32 m0, s78, 106496
s_and_b32 s70, s70, 0x1fffff
buffer_load_dwordx4 v16, s[16:19], s70 offen offset:0 lds
buffer_load_dwordx4 v17, s[16:19], s70 offen offset:1024 lds
buffer_load_dwordx4 v18, s[16:19], s70 offen offset:2048 lds
buffer_load_dwordx4 v19, s[16:19], s70 offen offset:3072 lds
buffer_load_dword v30, off, s[12:15], 0
s_add_u32 s70, s77, 1310720
s_add_u32 m0, s78, 114688
s_and_b32 s70, s70, 0x1fffff
buffer_load_dwordx4 v16, s[16:19], s70 offen offset:0 lds
buffer_load_dwordx4 v17, s[16:19], s70 offen offset:1024 lds
buffer_load_dwordx4 v18, s[16:19], s70 offen offset:2048 lds
buffer_load_dwordx4 v19, s[16:19], s70 offen offset:3072 lds
buffer_load_dword v30, off, s[12:15], 0
s_add_u32 s70, s77, 1441792
s_add_u32 m0, s78, 122880
s_and_b32 s70, s70, 0x1fffff
buffer_load_dwordx4 v16, s[16:19], s70 offen offset:0 lds
buffer_load_dwordx4 v17, s[16:19], s70 offen offset:1024 lds
buffer_load_dwordx4 v18, s[16:19], s70 offen offset:2048 lds
buffer_load_dwordx4 v19, s[16:19], s70 offen offset:3072 lds
buffer_load_dword v30, off, s[12:15], 0
s_add_u32 s35, s34, 20
lw_21:
ds_read_b32 v5, v1 offset:0
s_waitcnt lgkmcnt(0)
v_cmp_gt_i32 vcc, s35, v5
s_cbranch_vccz lwd_22
s_sleep 2
s_sub_u32 s32, s32, 1
s_cmp_gt_i32 s32, 0
s_cbranch_scc1 lw_21
lwd_22:
s_add_u32 s70, s77, 0
s_add_u32 m0, s78, 32768
s_and_b32 s70, s70, 0x1fffff
buffer_load_dwordx4 v16, s[16:19], s70 offen offset:0 lds
buffer_load_dwordx4 v17, s[16:19], s70 offen offset:1024 lds
buffer_load_dwordx4 v18, s[16:19], s70 offen offset:2048 lds
buffer_load_dwordx4 v19, s[16:19], s70 offen offset:3072 lds
buffer_load_dword v30, off, s[12:15], 0
s_cmp_eq_u32 s58, 0
s_cbranch_scc0 nofo_16
s_add_u32 s35, s34, 21
lw_23:
ds_read_b32 v5, v1 offset:0
s_waitcnt lgkmcnt(0)
v_cmp_gt_i32 vcc, s35, v5
s_cbranch_vccz lwd_24
s_sleep 1
s_sub_u32 s32, s32, 1
s_cmp_gt_i32 s32, 0
s_cbranch_scc1 lw_23
lwd_24:
poll_25:
buffer_load_dword v6, v21, s[24:27], s66 offen sc1
pchk_26:
s_waitcnt vmcnt(0)
v_cmp_eq_u32 vcc, 0, v6
s_cbranch_vccz pdone_27
s_sub_u32 s32, s32, 1
s_cmp_gt_i32 s32, 0
s_cbranch_scc1 poll_25
pdone_27:
nofo_16:
s_waitcnt vmcnt(0)
v_add_u32 v5, s34, 18
s_mov_b64 exec, 1
ds_write_b32 v3, v5
s_mov_b64 exec, -1
s_cmp_eq_u32 s63, 0
s_cbranch_scc0 L_end
v_bfe_u32 v6, v0, 3, 2
v_and_b32 v7, 2, v6
v_xor_b32 v7, v7, v22
v_lshrrev_b32 v23, 5, v0
v_lshl_add_u32 v6, v23, 4, v6
v_mul_u32_u24 v6, 6144, v6
v_lshl_add_u32 v12, v7, 4, v6
v_xor_b32 v6, 64, v12
v_add_u32 v13, 23552, v6
v_add_u32 v14, 47104, v12
v_add_u32 v15, 70656, v6
v_mov_b32 v8, v20
v_mov_b32 v9, v20
v_mov_b32 v10, v20
v_mov_b32 v11, v20
s_mov_b32 s8, s56
s_mov_b32 s9, s57
s_mov_b32 s10, 0x2500000
s_mov_b32 s11, 0x00020000
s_lshl_b32 s70, s59, 18
s_add_u32 s70, s70, 26214400
s_add_u32 s68, s70, s78
s_sub_u32 s69, s70, s78
s_add_u32 s69, s69, 12288
s_mov_b32 s67, 16384
s_lshl_b32 s66, s59, 14
s_add_u32 s66, s66, 274432
s_and_b32 s79, s59, 1
s_mul_i32 s79, s79, 1
s_mul_i32 s70, s60, 1
s_and_b32 s71, s59, 14
s_add_u32 s70, s70, s71
s_and_b32 s70, s70, 15
s_xor_b32 s64, s70, s79
s_mov_b32 s65, 86016
s_add_u32 s35, s34, 22
lw_28:
ds_read_b32 v5, v1 offset:0
s_waitcnt lgkmcnt(0)
v_cmp_gt_i32 vcc, s35, v5
s_cbranch_vccz lwd_29
s_sleep 2
s_sub_u32 s32, s32, 1
s_cmp_gt_i32 s32, 0
s_cbranch_scc1 lw_28
lwd_29:
s_mul_i32 s70, s64, 393216
s_add_u32 m0, s65, s76
s_add_u32 s71, s70, s72
buffer_load_dwordx4 v12, s[12:15], s71 offen offset:0 lds
buffer_load_dwordx4 v13, s[12:15], s71 offen offset:1024 lds
buffer_load_dwordx4 v14, s[12:15], s71 offen offset:2048 lds
buffer_load_dwordx4 v15, s[12:15], s71 offen offset:3072 lds
buffer_load_dword v30, off, s[12:15], 0
s_add_u32 m0, m0, 4096
s_add_u32 s71, s70, s73
buffer_load_dwordx4 v12, s[12:15], s71 offen offset:0 lds
buffer_load_dwordx4 v13, s[12:15], s71 offen offset:1024 lds
buffer_load_dwordx4 v14, s[12:15], s71 offen offset:2048 lds
buffer_load_dwordx4 v15, s[12:15], s71 offen offset:3072 lds
buffer_load_dword v30, off, s[12:15], 0
s_add_u32 m0, m0, 4096
s_add_u32 s71, s70, s74
buffer_load_dwordx4 v12, s[12:15], s71 offen offset:0 lds
buffer_load_dwordx4 v13, s[12:15], s71 offen offset:1024 lds
buffer_load_dwordx4 v14, s[12:15], s71 offen offset:2048 lds
buffer_load_dwordx4 v15, s[12:15], s71 offen offset:3072 lds
buffer_load_dword v30, off, s[12:15], 0
s_and_b32 s79, s59, 1
s_mul_i32 s79, s79, 1
s_mul_i32 s70, s60, 1
s_and_b32 s71, s59, 14
s_add_u32 s70, s70, s71
s_and_b32 s70, s70, 15
s_xor_b32 s64, s70, s79
s_mov_b32 s65, 86016
s_add_u32 s35, s34, 23
lw_30:
ds_read_b32 v5, v1 offset:0
s_waitcnt lgkmcnt(0)
v_cmp_gt_i32 vcc, s35, v5
s_cbranch_vccz lwd_31
s_sleep 1
s_sub_u32 s32, s32, 1
s_cmp_gt_i32 s32, 0
s_cbranch_scc1 lw_30
lwd_31:
poll_32:
buffer_load_dword v6, v21, s[24:27], s66 offen sc1
pchk_33:
s_waitcnt vmcnt(0)
v_cmp_eq_u32 vcc, 0, v6
s_cbranch_vccz pdone_34
s_sub_u32 s32, s32, 1
s_cmp_gt_i32 s32, 0
s_cbranch_scc1 poll_32
pdone_34:
s_mul_i32 s70, s64, s67
s_add_u32 m0, s65, s75
s_add_u32 s71, s70, s68
buffer_load_dwordx4 v8, s[8:11], s71 offen offset:0 sc1 lds
buffer_load_dwordx4 v9, s[8:11], s71 offen offset:1024 sc1 lds
buffer_load_dwordx4 v10, s[8:11], s71 offen offset:2048 sc1 lds
buffer_load_dwordx4 v11, s[8:11], s71 offen offset:3072 sc1 lds
buffer_load_dword v30, off, s[12:15], 0
s_add_u32 m0, m0, 4096
s_add_u32 s71, s70, s69
buffer_load_dwordx4 v8, s[8:11], s71 offen offset:0 sc1 lds
buffer_load_dwordx4 v9, s[8:11], s71 offen offset:1024 sc1 lds
buffer_load_dwordx4 v10, s[8:11], s71 offen offset:2048 sc1 lds
buffer_load_dwordx4 v11, s[8:11], s71 offen offset:3072 sc1 lds
buffer_load_dword v30, off, s[12:15], 0
s_xor_b32 s64, s64, s79
s_add_u32 s64, s64, 1
s_and_b32 s64, s64, 15
s_xor_b32 s64, s64, s79
s_sub_u32 s65, s65, 40960
s_cselect_b32 s65, 86016, s65
s_mul_i32 s70, s64, s67
s_add_u32 m0, s65, s75
s_add_u32 s71, s70, s68
buffer_load_dwordx4 v8, s[8:11], s71 offen offset:0 sc1 lds
buffer_load_dwordx4 v9, s[8:11], s71 offen offset:1024 sc1 lds
buffer_load_dwordx4 v10, s[8:11], s71 offen offset:2048 sc1 lds
buffer_load_dwordx4 v11, s[8:11], s71 offen offset:3072 sc1 lds
buffer_load_dword v30, off, s[12:15], 0
s_add_u32 m0, m0, 4096
s_add_u32 s71, s70, s69
buffer_load_dwordx4 v8, s[8:11], s71 offen offset:0 sc1 lds
buffer_load_dwordx4 v9, s[8:11], s71 offen offset:1024 sc1 lds
buffer_load_dwordx4 v10, s[8:11], s71 offen offset:2048 sc1 lds
buffer_load_dwordx4 v11, s[8:11], s71 offen offset:3072 sc1 lds
buffer_load_dword v30, off, s[12:15], 0
s_mul_i32 s70, s64, 393216
s_add_u32 m0, s65, s76
s_add_u32 s71, s70, s72
buffer_load_dwordx4 v12, s[12:15], s71 offen offset:0 lds
buffer_load_dwordx4 v13, s[12:15], s71 offen offset:1024 lds
buffer_load_dwordx4 v14, s[12:15], s71 offen offset:2048 lds
buffer_load_dwordx4 v15, s[12:15], s71 offen offset:3072 lds
buffer_load_dword v30, off, s[12:15], 0
s_add_u32 m0, m0, 4096
s_add_u32 s71, s70, s73
buffer_load_dwordx4 v12, s[12:15], s71 offen offset:0 lds
buffer_load_dwordx4 v13, s[12:15], s71 offen offset:1024 lds
buffer_load_dwordx4 v14, s[12:15], s71 offen offset:2048 lds
buffer_load_dwordx4 v15, s[12:15], s71 offen offset:3072 lds
buffer_load_dword v30, off, s[12:15], 0
s_add_u32 m0, m0, 4096
s_add_u32 s71, s70, s74
buffer_load_dwordx4 v12, s[12:15], s71 offen offset:0 lds
buffer_load_dwordx4 v13, s[12:15], s71 offen offset:1024 lds
buffer_load_dwordx4 v14, s[12:15], s71 offen offset:2048 lds
buffer_load_dwordx4 v15, s[12:15], s71 offen offset:3072 lds
buffer_load_dword v30, off, s[12:15], 0
s_xor_b32 s64, s64, s79
s_add_u32 s64, s64, 1
s_and_b32 s64, s64, 15
s_xor_b32 s64, s64, s79
s_sub_u32 s65, s65, 40960
s_cselect_b32 s65, 86016, s65
s_mul_i32 s70, s64, s67
s_add_u32 m0, s65, s75
s_add_u32 s71, s70, s68
buffer_load_dwordx4 v8, s[8:11], s71 offen offset:0 sc1 lds
buffer_load_dwordx4 v9, s[8:11], s71 offen offset:1024 sc1 lds
buffer_load_dwordx4 v10, s[8:11], s71 offen offset:2048 sc1 lds
buffer_load_dwordx4 v11, s[8:11], s71 offen offset:3072 sc1 lds
buffer_load_dword v30, off, s[12:15], 0
s_add_u32 m0, m0, 4096
s_add_u32 s71, s70, s69
buffer_load_dwordx4 v8, s[8:11], s71 offen offset:0 sc1 lds
buffer_load_dwordx4 v9, s[8:11], s71 offen offset:1024 sc1 lds
buffer_load_dwordx4 v10, s[8:11], s71 offen offset:2048 sc1 lds
buffer_load_dwordx4 v11, s[8:11], s71 offen offset:3072 sc1 lds
buffer_load_dword v30, off, s[12:15], 0
s_mul_i32 s70, s64, 393216
s_add_u32 m0, s65, s76
s_add_u32 s71, s70, s72
buffer_load_dwordx4 v12, s[12:15], s71 offen offset:0 lds
buffer_load_dwordx4 v13, s[12:15], s71 offen offset:1024 lds
buffer_load_dwordx4 v14, s[12:15], s71 offen offset:2048 lds
buffer_load_dwordx4 v15, s[12:15], s71 offen offset:3072 lds
buffer_load_dword v30, off, s[12:15], 0
s_add_u32 m0, m0, 4096
s_add_u32 s71, s70, s73
buffer_load_dwordx4 v12, s[12:15], s71 offen offset:0 lds
buffer_load_dwordx4 v13, s[12:15], s71 offen offset:1024 lds
buffer_load_dwordx4 v14, s[12:15], s71 offen offset:2048 lds
buffer_load_dwordx4 v15, s[12:15], s71 offen offset:3072 lds
buffer_load_dword v30, off, s[12:15], 0
s_add_u32 m0, m0, 4096
s_add_u32 s71, s70, s74
buffer_load_dwordx4 v12, s[12:15], s71 offen offset:0 lds
buffer_load_dwordx4 v13, s[12:15], s71 offen offset:1024 lds
buffer_load_dwordx4 v14, s[12:15], s71 offen offset:2048 lds
buffer_load_dwordx4 v15, s[12:15], s71 offen offset:3072 lds
buffer_load_dword v30, off, s[12:15], 0
s_xor_b32 s64, s64, s79
s_add_u32 s64, s64, 1
s_and_b32 s64, s64, 15
s_xor_b32 s64, s64, s79
s_sub_u32 s65, s65, 40960
s_cselect_b32 s65, 86016, s65
s_waitcnt vmcnt(50)
v_add_u32 v5, s34, 33
s_mov_b64 exec, 1
ds_write_b32 v3, v5
s_mov_b64 exec, -1
s_mov_b32 s36, s64
s_mov_b32 s37, s65
s_mov_b32 s64, s59
s_mov_b32 s65, 114688
s_mul_i32 s70, s64, 393216
s_add_u32 m0, s65, s76
s_add_u32 s71, s70, s72
buffer_load_dwordx4 v12, s[12:15], s71 offen offset:0 lds
buffer_load_dwordx4 v13, s[12:15], s71 offen offset:1024 lds
buffer_load_dwordx4 v14, s[12:15], s71 offen offset:2048 lds
buffer_load_dwordx4 v15, s[12:15], s71 offen offset:3072 lds
buffer_load_dword v30, off, s[12:15], 0
s_add_u32 m0, m0, 4096
s_add_u32 s71, s70, s73
buffer_load_dwordx4 v12, s[12:15], s71 offen offset:0 lds
buffer_load_dwordx4 v13, s[12:15], s71 offen offset:1024 lds
buffer_load_dwordx4 v14, s[12:15], s71 offen offset:2048 lds
buffer_load_dwordx4 v15, s[12:15], s71 offen offset:3072 lds
buffer_load_dword v30, off, s[12:15], 0
s_add_u32 m0, m0, 4096
s_add_u32 s71, s70, s74
buffer_load_dwordx4 v12, s[12:15], s71 offen offset:0 lds
buffer_load_dwordx4 v13, s[12:15], s71 offen offset:1024 lds
buffer_load_dwordx4 v14, s[12:15], s71 offen offset:2048 lds
buffer_load_dwordx4 v15, s[12:15], s71 offen offset:3072 lds
buffer_load_dword v30, off, s[12:15], 0
s_mov_b32 s64, s36
s_mov_b32 s65, s37
s_waitcnt vmcnt(40)
v_add_u32 v5, s34, 34
s_mov_b64 exec, 1
ds_write_b32 v3, v5
s_mov_b64 exec, -1
s_mov_b32 s63, 1
s_mov_b32 s34, 32
s_add_u32 s24, s24, 1409024
s_addc_u32 s25, s25, 0
s_mov_b32 s26, 1409024
s_mov_b32 s66, 32
s_branch lq_1
lcs_2:
s_add_u32 s35, s34, 1
lw_35:
ds_read_b32 v5, v2 offset:24
s_waitcnt lgkmcnt(0)
v_cmp_gt_i32 vcc, s35, v5
s_cbranch_vccz lwd_36
s_sub_u32 s32, s32, 1
s_cmp_gt_i32 s32, 0
s_cbranch_scc1 lw_35
lwd_36:
s_branch lcb_3
L_f:
v_lshlrev_b32 v4, 4, v0
s_lshl4_add_u32 s78, s59, s60
v_mov_b32 v252, 0
v_mov_b32 v253, 0
v_mov_b32 v254, 0
v_mov_b32 v255, 0
s_lshl_b32 s35, s78, 10
s_cmp_eq_u32 s58, 0
s_cselect_b64 exec, -1, 0
buffer_store_dwordx4 v[252:255], v4, s[24:27], s35 offen offset:0 sc1
s_add_u32 s35, s35, 262144
buffer_store_dwordx4 v[252:255], v4, s[24:27], s35 offen offset:0 sc1
s_mov_b64 exec, -1
s_setprio 3
v_and_b32 v1, 3, v0
v_lshlrev_b32 v1, 2, v1
v_and_b32 v2, 4, v1
s_lshl2_add_u32 s35, s58, 24
v_mov_b32 v3, s35
s_mov_b32 s4, s54
s_mov_b32 s5, s55
s_mov_b32 s6, 0x100
s_mov_b32 s7, 0x00020000
s_add_u32 s70, s60, 4
s_lshr_b32 s70, s70, 3
s_sub_u32 s70, s60, s70
s_lshl4_add_u32 s64, s70, s59
s_and_b32 s70, s60, 7
s_cmp_eq_u32 s70, 3
s_cselect_b32 s65, 1, 0
s_mov_b32 s69, 0x3f803f80
s_barrier
s_cmp_eq_u32 s58, 0
s_cselect_b32 s16, s46, s48
s_cselect_b32 s17, s47, s49
s_mov_b32 s12, s50
s_mov_b32 s13, s51
s_mov_b32 s14, 0x0
s_mov_b32 s15, 0x00020000
s_cmp_eq_u32 s65, 0
s_cselect_b32 s18, 7340032, 0
s_mov_b32 s14, s18
s_lshr_b32 s70, s64, 3
s_and_b32 s71, s64, 7
s_lshl_b32 s66, s70, 10
s_add_u32 s66, s66, s71
s_lshl1_add_u32 s66, s66, s58
s_lshl_b32 s66, s66, 7
s_mul_i32 s71, s71, 917504
s_lshl_b32 s70, s70, 8
s_add_u32 s77, s71, s70
s_mov_b32 s48, s38
s_mov_b32 s49, s39
s_mov_b32 s50, 0x600000
s_mov_b32 s51, 0x00020000
s_mov_b32 s52, 0
s_and_b32 s54, s60, 8
s_add_u32 s54, s54, 3
s_add_u32 s53, s54, s59
s_and_b32 s55, s60, 7
s_lshl1_add_u32 s55, s55, s58
s_mul_i32 s55, s55, 24576
s_lshl_b32 s54, s54, 7
s_add_u32 s56, s54, s55
s_add_u32 s56, s56, 60
s_and_b32 s73, s2, 3
s_lshl_b32 s73, s73, 6
v_mov_b32 v14, 1
s_sub_u32 exec_lo, 1, s58
s_mov_b32 exec_hi, 0
s_waitcnt vmcnt(0)
buffer_atomic_add v14, off, s[4:7], s73 sc1
s_mov_b64 exec, -1
v_mov_b32 v8, s69
v_mov_b32 v9, s69
v_mov_b32 v10, s69
v_mov_b32 v11, s69
v_mov_b32 v12, s69
v_mov_b32 v13, s69
v_mov_b32 v14, s69
v_mov_b32 v15, s69
s_mov_b32 s70, 102400
ftop_39:
v_lshrrev_b32 v6, 4, v0
v_bfe_u32 v7, v0, 2, 2
v_lshl_add_u32 v6, v6, 3, v7
v_bfe_u32 v7, v0, 3, 2
s_lshl_b32 s71, s58, 1
v_xor_b32 v7, s71, v7
v_lshl_add_u32 v7, v7, 5, s70
v_lshl_add_u32 v6, v6, 7, v7
v_lshl_add_u32 v6, v1, 1, v6
v_xor_b32 v7, 32, v6
s_mul_i32 s71, s63, 34
s_add_u32 s35, s71, 1
lw_40:
ds_read_b32 v5, v2 offset:16
s_waitcnt lgkmcnt(0)
v_cmp_gt_i32 vcc, s35, v5
s_cbranch_vccz lwd_41
s_sleep 1
s_sub_u32 s32, s32, 1
s_cmp_gt_i32 s32, 0
s_cbranch_scc1 lw_40
lwd_41:
ds_read_b64_tr_b16 v[24:25], v6 offset:0
ds_read_b64_tr_b16 v[26:27], v6 offset:512
ds_read_b64_tr_b16 v[28:29], v6 offset:4096
ds_read_b64_tr_b16 v[30:31], v6 offset:4608
ds_read_b64_tr_b16 v[32:33], v7 offset:0
ds_read_b64_tr_b16 v[34:35], v7 offset:512
ds_read_b64_tr_b16 v[36:37], v7 offset:4096
ds_read_b64_tr_b16 v[38:39], v7 offset:4608
ds_read_b64_tr_b16 v[40:41], v6 offset:8192
ds_read_b64_tr_b16 v[42:43], v6 offset:8704
ds_read_b64_tr_b16 v[44:45], v6 offset:12288
ds_read_b64_tr_b16 v[46:47], v6 offset:12800
ds_read_b64_tr_b16 v[48:49], v7 offset:8192
ds_read_b64_tr_b16 v[50:51], v7 offset:8704
ds_read_b64_tr_b16 v[52:53], v7 offset:12288
ds_read_b64_tr_b16 v[54:55], v7 offset:12800
s_lshl_b32 s72, s60, 14
s_lshl_b32 s70, s58, 9
s_add_u32 s72, s72, s70
s_lshl_b32 s70, s59, 10
s_add_u32 s71, s72, s70
s_lshl_b32 s76, s59, 14
s_add_u32 s73, s76, 30686208
s_add_u32 s76, s76, 266240
s_waitcnt lgkmcnt(14)
v_mfma_f32_16x16x32_bf16 v[248:251], v[8:11], v[24:27], 0
s_waitcnt lgkmcnt(10)
v_mfma_f32_16x16x32_bf16 v[252:255], v[8:11], v[32:35], 0
v_mfma_f32_16x16x32_bf16 v[248:251], v[12:15], v[28:31], v[248:251]
s_waitcnt lgkmcnt(8)
v_mfma_f32_16x16x32_bf16 v[252:255], v[12:15], v[36:39], v[252:255]
ds_read_b64_tr_b16 v[24:25], v6 offset:16384
ds_read_b64_tr_b16 v[26:27], v6 offset:16896
ds_read_b64_tr_b16 v[28:29], v6 offset:20480
ds_read_b64_tr_b16 v[30:31], v6 offset:20992
ds_read_b64_tr_b16 v[32:33], v7 offset:16384
ds_read_b64_tr_b16 v[34:35], v7 offset:16896
ds_read_b64_tr_b16 v[36:37], v7 offset:20480
ds_read_b64_tr_b16 v[38:39], v7 offset:20992
v_add_u32 v5, s34, 1
s_mov_b64 exec, 1
ds_write_b32 v3, v5
s_mov_b64 exec, -1
s_waitcnt lgkmcnt(14)
v_mfma_f32_16x16x32_bf16 v[16:19], v[8:11], v[40:43], 0
s_waitcnt lgkmcnt(11)
v_mfma_f32_16x16x32_bf16 v[20:23], v[8:11], v[48:51], 0
v_mfma_f32_16x16x32_bf16 v[16:19], v[12:15], v[44:47], v[16:19]
s_waitcnt lgkmcnt(9)
v_mfma_f32_16x16x32_bf16 v[20:23], v[12:15], v[52:55], v[20:23]
v_mov_b32 v249, v252
v_mov_b32 v252, s69
v_mov_b32 v253, s69
v_mov_b32 v254, s69
v_mov_b32 v255, s69
v_mfma_f32_16x16x32_bf16 v[52:55], v[8:11], v[8:11], 0
s_nop 0
v_mfma_f32_16x16x32_bf16 v[48:51], v[8:11], v[252:255], 0
v_mfma_f32_16x16x32_bf16 v[52:55], v[12:15], v[12:15], v[52:55]
v_mfma_f32_16x16x32_bf16 v[48:51], v[12:15], v[252:255], v[48:51]
s_waitcnt lgkmcnt(7)
v_mfma_f32_16x16x32_bf16 v[40:43], v[8:11], v[24:27], 0
s_waitcnt lgkmcnt(3)
v_mfma_f32_16x16x32_bf16 v[44:47], v[8:11], v[32:35], 0
v_mfma_f32_16x16x32_bf16 v[40:43], v[12:15], v[28:31], v[40:43]
s_waitcnt lgkmcnt(1)
v_mfma_f32_16x16x32_bf16 v[44:47], v[12:15], v[36:39], v[44:47]
v_lshlrev_b32 v6, 3, v0
v_and_b32 v7, 48, v0
v_mov_b32_dpp v248, v16 quad_perm:[0,1,2,3] row_mask:0x2 bank_mask:0xf
v_mov_b32_dpp v249, v20 quad_perm:[0,1,2,3] row_mask:0x2 bank_mask:0xf
s_nop 0
v_mov_b32_dpp v248, v48 quad_perm:[0,1,2,3] row_mask:0x8 bank_mask:0xf
v_mov_b32_dpp v249, v52 quad_perm:[0,1,2,3] row_mask:0x8 bank_mask:0xf
s_nop 0
v_mov_b32_dpp v248, v40 quad_perm:[0,1,2,3] row_mask:0x4 bank_mask:0xf
v_mov_b32_dpp v249, v44 quad_perm:[0,1,2,3] row_mask:0x4 bank_mask:0xf
v_max_u32 v248, 1, v248
v_max_u32 v249, 1, v249
s_cmp_eq_u32 s63, 0
s_cbranch_scc1 fst_37
fsb_38:
buffer_store_dwordx2 v[248:249], v6, s[24:27], s71 offen sc1
s_lshl4_add_u32 s70, s58, s60
s_add_u32 s70, s70, s34
s_cmp_eq_u32 s70, 51
s_cbranch_scc1 fxt_42
fxb_43:
s_add_u32 s73, s72, 4096
s_add_u32 s74, s72, 8192
s_add_u32 s75, s72, 12288
v_lshrrev_b32 v7, 2, v0
v_lshlrev_b32 v7, 7, v7
v_lshl_add_u32 v7, v1, 2, v7
v_lshrrev_b32 v8, 5, v0
v_lshrrev_b32 v9, 4, v0
v_xor_b32 v10, v8, v9
v_and_b32 v10, 1, v10
v_lshl_add_u32 v8, v10, 1, v8
v_and_b32 v10, 15, v0
v_lshlrev_b32 v8, 7, v8
v_lshl_add_u32 v8, v10, 3, v8
v_add_u32 v8, 1280, v8
s_mul_i32 s70, s58, 384
s_lshl_b32 s71, s63, 10
s_add_u32 s70, s70, s71
s_add_u32 s70, s70, 2304
v_lshl_add_u32 v9, v9, 7, s70
v_lshl_add_u32 v9, v10, 2, v9
s_cmp_eq_u32 s63, 0
s_cbranch_scc1 fg_44
fg_45:
poll_46:
buffer_load_dwordx4 v[12:15], v7, s[24:27], s76 offen sc1
pchk_47:
s_waitcnt vmcnt(0)
v_min3_u32 v10, v12, v13, v14
v_min_u32 v10, v10, v15
v_cmp_eq_u32 vcc, 0, v10
s_cbranch_vccz pdone_48
s_sub_u32 s32, s32, 1
s_cmp_gt_i32 s32, 0
s_cbranch_scc1 poll_46
pdone_48:
s_lshr_b32 s70, s33, 7
s_sub_u32 s70, s70, s59
s_mul_i32 s70, s70, s63
s_cmp_eq_u32 s70, 0
s_cbranch_scc0 fng_49
s_lshl1_add_u32 s70, s34, -32
s_add_u32 s35, s70, 15
lw_50:
ds_read_b32 v5, v2 offset:16
s_waitcnt lgkmcnt(0)
v_cmp_gt_i32 vcc, s35, v5
s_cbranch_vccz lwd_51
s_sleep 4
s_sub_u32 s32, s32, 1
s_cmp_gt_i32 s32, 0
s_cbranch_scc1 lw_50
lwd_51:
poll_52:
buffer_load_dwordx2 v[24:25], v6, s[24:27], s72 offen offset:0 sc1
buffer_load_dwordx2 v[26:27], v6, s[24:27], s72 offen offset:1024 sc1
buffer_load_dwordx2 v[28:29], v6, s[24:27], s72 offen offset:2048 sc1
buffer_load_dwordx2 v[30:31], v6, s[24:27], s72 offen offset:3072 sc1
buffer_load_dwordx2 v[32:33], v6, s[24:27], s73 offen offset:0 sc1
buffer_load_dwordx2 v[34:35], v6, s[24:27], s73 offen offset:1024 sc1
buffer_load_dwordx2 v[36:37], v6, s[24:27], s73 offen offset:2048 sc1
buffer_load_dwordx2 v[38:39], v6, s[24:27], s73 offen offset:3072 sc1
buffer_load_dwordx2 v[40:41], v6, s[24:27], s74 offen offset:0 sc1
buffer_load_dwordx2 v[42:43], v6, s[24:27], s74 offen offset:1024 sc1
buffer_load_dwordx2 v[44:45], v6, s[24:27], s74 offen offset:2048 sc1
buffer_load_dwordx2 v[46:47], v6, s[24:27], s74 offen offset:3072 sc1
buffer_load_dwordx2 v[48:49], v6, s[24:27], s75 offen offset:0 sc1
buffer_load_dwordx2 v[50:51], v6, s[24:27], s75 offen offset:1024 sc1
buffer_load_dwordx2 v[52:53], v6, s[24:27], s75 offen offset:2048 sc1
buffer_load_dwordx2 v[54:55], v6, s[24:27], s75 offen offset:3072 sc1
pchk_53:
s_waitcnt vmcnt(14)
v_min3_u32 v10, v24, v25, v26
s_waitcnt vmcnt(13)
v_min3_u32 v10, v10, v27, v28
s_waitcnt vmcnt(12)
v_min3_u32 v10, v10, v29, v30
s_waitcnt vmcnt(11)
v_min3_u32 v10, v10, v31, v32
s_waitcnt vmcnt(10)
v_min3_u32 v10, v10, v33, v34
s_waitcnt vmcnt(9)
v_min3_u32 v10, v10, v35, v36
s_waitcnt vmcnt(8)
v_min3_u32 v10, v10, v37, v38
s_waitcnt vmcnt(7)
v_min3_u32 v10, v10, v39, v40
s_waitcnt vmcnt(6)
v_min3_u32 v10, v10, v41, v42
s_waitcnt vmcnt(5)
v_min3_u32 v10, v10, v43, v44
s_waitcnt vmcnt(4)
v_min3_u32 v10, v10, v45, v46
s_waitcnt vmcnt(3)
v_min3_u32 v10, v10, v47, v48
s_waitcnt vmcnt(2)
v_min3_u32 v10, v10, v49, v50
s_waitcnt vmcnt(1)
v_min3_u32 v10, v10, v51, v52
s_waitcnt vmcnt(0)
v_min3_u32 v10, v10, v53, v54
v_min_u32 v10, v10, v55
v_cmp_eq_u32 vcc, 0, v10
s_cbranch_vccz pdone_54
s_sub_u32 s32, s32, 1
s_cmp_gt_i32 s32, 0
s_cbranch_scc1 poll_52
pdone_54:
v_add_f32 v24, v24, v40
v_add_f32 v25, v25, v41
v_add_f32 v26, v26, v42
v_add_f32 v27, v27, v43
v_add_f32 v28, v28, v44
v_add_f32 v29, v29, v45
v_add_f32 v30, v30, v46
v_add_f32 v31, v31, v47
v_add_f32 v32, v32, v48
v_add_f32 v33, v33, v49
v_add_f32 v34, v34, v50
v_add_f32 v35, v35, v51
v_add_f32 v36, v36, v52
v_add_f32 v37, v37, v53
v_add_f32 v38, v38, v54
v_add_f32 v39, v39, v55
v_add_f32 v24, v24, v32
v_add_f32 v25, v25, v33
v_add_f32 v26, v26, v34
v_add_f32 v27, v27, v35
v_add_f32 v28, v28, v36
v_add_f32 v29, v29, v37
v_add_f32 v30, v30, v38
v_add_f32 v31, v31, v39
v_add_f32 v24, v24, v28
v_add_f32 v25, v25, v29
v_add_f32 v26, v26, v30
v_add_f32 v27, v27, v31
v_add_f32 v24, v24, v26
v_add_f32 v25, v25, v27
s_mov_b32 exec_hi, 0xffff
ds_write2_b32 v9, v24, v25 offset1:16
s_mov_b32 exec_hi, -1
v_mul_f32 v5, 0xba800000, v24
v_mul_f32 v25, 0x3a800000, v25
v_fma_f32 v25, -v5, v5, v25
v_max_f32 v25, 0, v25
v_add_f32 v25, 0x3727c5ac, v25
v_rsq_f32 v24, v25
s_nop 0
v_mul_f32 v25, v5, v24
s_lshl_b32 s70, s59, 7
s_sub_u32 s70, s33, s70
v_lshlrev_b32 v10, 1, v0
v_sub_u32 v10, s70, v10
v_readlane_b32 s70, v24, 48
v_readlane_b32 s71, v25, 48
v_cmp_eq_u32 vcc, 0, v10
s_mov_b64 exec, vcc
v_mov_b32 v12, s70
v_mov_b32 v13, s71
s_mov_b64 exec, -1
v_cmp_eq_u32 vcc, 1, v10
s_mov_b64 exec, vcc
v_mov_b32 v14, s70
v_mov_b32 v15, s71
s_mov_b64 exec, -1
fng_49:
ds_write2_b32 v8, v12, v14 offset1:1
ds_write2_b32 v8, v13, v15 offset0:128 offset1:129
s_add_u32 s71, s34, s63
v_add_u32 v5, s71, 2
s_mov_b64 exec, 1
ds_write_b32 v3, v5
s_mov_b64 exec, -1
s_setprio 0
s_cmp_eq_u32 s63, 0
s_cbranch_scc1 fnw_55
fnw_56:
s_and_b32 s70, s64, 7
s_lshl_b32 s70, s70, 7
s_add_u32 s73, s70, 276480
s_lshl1_add_u32 s72, s70, 272384
s_lshr_b32 s71, s64, 3
s_lshl_b32 s76, s71, 13
s_add_u32 s76, s76, 1048576
s_lshl2_add_u32 s74, s70, s76
s_lshl_b32 s70, s58, 8
s_add_u32 s74, s74, s70
s_add_u32 s75, s74, 4096
s_lshl4_add_u32 s76, s70, s76
v_and_b32 v251, 15, v0
v_lshlrev_b32 v6, 14, v251
v_lshrrev_b32 v252, 4, v0
v_lshl_add_u32 v7, v252, 5, v6
v_lshlrev_b32 v251, 4, v251
s_lshl_b32 s70, s58, 3
v_lshl_add_u32 v253, v252, 1, s70
v_add_u32 v253, v253, v251
v_lshlrev_b32 v254, 5, v252
v_lshl_add_u32 v254, v2, 2, v254
v_and_b32 v255, 7, v0
v_lshl_add_u32 v255, v255, 2, v252
v_lshlrev_b32 v255, 3, v255
s_add_u32 s35, s34, 22
lw_57:
ds_read_b32 v5, v1 offset:0
s_waitcnt lgkmcnt(0)
v_cmp_gt_i32 vcc, s35, v5
s_cbranch_vccz lwd_58
s_sleep 4
s_sub_u32 s32, s32, 1
s_cmp_gt_i32 s32, 0
s_cbranch_scc1 lw_57
lwd_58:
s_setprio 3
s_add_u32 s35, s34, 24
lw_59:
ds_read_b32 v5, v1 offset:0
s_waitcnt lgkmcnt(0)
v_cmp_gt_i32 vcc, s35, v5
s_cbranch_vccz lwd_60
s_sleep 2
s_sub_u32 s32, s32, 1
s_cmp_gt_i32 s32, 0
s_cbranch_scc1 lw_59
lwd_60:
s_mul_i32 s79, s63, 64
s_sub_u32 s79, 32, s79
s_add_u32 s35, s79, 3
tw_61:
ds_read_b32 v5, v2 offset:16
s_waitcnt lgkmcnt(0)
v_cmp_gt_i32 vcc, s35, v5
s_cbranch_vccz twd_62
v_readfirstlane_b32 s54, v5
s_sub_u32 s55, s35, s54
s_cmp_lt_i32 s55, 2
s_cbranch_scc1 tws_63
s_add_u32 s54, s54, 2
s_or_b32 s54, s54, 1
s_cmp_eq_u32 s54, s52
s_cbranch_scc1 tws_63
s_bitcmp1_b32 s54, 4
s_cbranch_scc1 tws_63
s_mov_b32 s52, s54
s_add_u32 s54, s54, s53
s_and_b32 s54, s54, 15
s_mul_i32 s54, s54, 393216
s_add_u32 s54, s54, s56
s_buffer_load_dwordx2 s[46:47], s[48:51], s54 offset:4096
s_buffer_load_dwordx2 s[46:47], s[48:51], s54 offset:10240
s_buffer_load_dwordx2 s[46:47], s[48:51], s54 offset:16384
s_buffer_load_dwordx2 s[46:47], s[48:51], s54 offset:22528
tws_63:
s_sleep 4
s_sub_u32 s32, s32, 1
s_cmp_gt_i32 s32, 0
s_cbranch_scc1 tw_61
twd_62:
s_cmp_eq_u32 s65, 0
s_cbranch_scc0 fnd_65
poll_66:
buffer_load_dwordx2 v[248:249], v6, s[24:27], s73 offen sc1
buffer_load_dwordx4 v[8:11], v7, s[24:27], s72 offen offset:0 sc1
buffer_load_dwordx4 v[12:15], v7, s[24:27], s72 offen offset:16 sc1
buffer_load_dwordx4 v[16:19], v7, s[24:27], s72 offen offset:128 sc1
buffer_load_dwordx4 v[20:23], v7, s[24:27], s72 offen offset:144 sc1
pchk_67:
s_waitcnt vmcnt(3)
v_min3_u32 v5, v248, v249, v8
v_min3_u32 v5, v5, v9, v10
s_waitcnt vmcnt(2)
v_min3_u32 v5, v5, v11, v12
v_min3_u32 v5, v5, v13, v14
s_waitcnt vmcnt(1)
v_min3_u32 v5, v5, v15, v16
v_min3_u32 v5, v5, v17, v18
s_waitcnt vmcnt(0)
v_min3_u32 v5, v5, v19, v20
v_min3_u32 v5, v5, v21, v22
v_min_u32 v5, v5, v23
v_cmp_eq_u32 vcc, 0, v5
s_cbranch_vccz pdone_68
s_sub_u32 s32, s32, 1
s_cmp_gt_i32 s32, 0
s_cbranch_scc1 poll_66
pdone_68:
v_mfma_f32_16x16x32_bf16 v[24:27], v[8:11], v[56:59], 0
v_mov_b32 v250, v248
v_mfma_f32_16x16x32_bf16 v[28:31], v[8:11], v[60:63], 0
s_nop 0
v_max_f32_dpp v250, v250, v250 row_ror:1 row_mask:0xf bank_mask:0xf
v_mfma_f32_16x16x32_bf16 v[32:35], v[8:11], v[64:67], 0
s_nop 0
v_max_f32_dpp v250, v250, v250 row_ror:2 row_mask:0xf bank_mask:0xf
v_mfma_f32_16x16x32_bf16 v[36:39], v[8:11], v[68:71], 0
s_nop 0
v_max_f32_dpp v250, v250, v250 row_ror:4 row_mask:0xf bank_mask:0xf
v_mfma_f32_16x16x32_bf16 v[40:43], v[8:11], v[72:75], 0
s_nop 0
v_max_f32_dpp v250, v250, v250 row_ror:8 row_mask:0xf bank_mask:0xf
v_mfma_f32_16x16x32_bf16 v[44:47], v[8:11], v[76:79], 0
v_cmp_eq_f32 vcc, v250, v248
v_mfma_f32_16x16x32_bf16 v[48:51], v[8:11], v[80:83], 0
s_ff1_i32_b64 s68, vcc
v_mfma_f32_16x16x32_bf16 v[52:55], v[8:11], v[84:87], 0
s_and_b32 s68, s68, 15
v_mfma_f32_16x16x32_bf16 v[24:27], v[12:15], v[88:91], v[24:27]
v_readlane_b32 s33, v249, s68
v_mfma_f32_16x16x32_bf16 v[28:31], v[12:15], v[92:95], v[28:31]
v_readlane_b32 s67, v248, s68
v_mfma_f32_16x16x32_bf16 v[32:35], v[12:15], v[96:99], v[32:35]
v_add_u32 v5, s34, 4
v_mfma_f32_16x16x32_bf16 v[36:39], v[12:15], v[100:103], v[36:39]
v_mov_b32 v250, s33
v_mfma_f32_16x16x32_bf16 v[40:43], v[12:15], v[104:107], v[40:43]
s_mov_b64 exec, 1
ds_write2_b32 v3, v5, v250 offset1:2
s_mov_b64 exec, -1
v_mfma_f32_16x16x32_bf16 v[44:47], v[12:15], v[108:111], v[44:47]
s_sub_u32 s33, s33, 1
v_mfma_f32_16x16x32_bf16 v[48:51], v[12:15], v[112:115], v[48:51]
s_and_b32 s33, s33, 2047
v_mfma_f32_16x16x32_bf16 v[52:55], v[12:15], v[116:119], v[52:55]
v_mfma_f32_16x16x32_bf16 v[24:27], v[16:19], v[120:123], v[24:27]
v_mfma_f32_16x16x32_bf16 v[28:31], v[16:19], v[124:127], v[28:31]
v_mfma_f32_16x16x32_bf16 v[32:35], v[16:19], v[128:131], v[32:35]
v_mfma_f32_16x16x32_bf16 v[36:39], v[16:19], v[132:135], v[36:39]
v_mfma_f32_16x16x32_bf16 v[40:43], v[16:19], v[136:139], v[40:43]
v_mfma_f32_16x16x32_bf16 v[44:47], v[16:19], v[140:143], v[44:47]
v_mfma_f32_16x16x32_bf16 v[48:51], v[16:19], v[144:147], v[48:51]
v_mfma_f32_16x16x32_bf16 v[52:55], v[16:19], v[148:151], v[52:55]
v_mfma_f32_16x16x32_bf16 v[24:27], v[20:23], v[152:155], v[24:27]
s_and_b32 s70, s68, 12
s_lshl_b32 s70, s70, 2
s_bitcmp1_b32 s68, 1
v_mfma_f32_16x16x32_bf16 v[28:31], v[20:23], v[156:159], v[28:31]
v_mfma_f32_16x16x32_bf16 v[32:35], v[20:23], v[160:163], v[32:35]
v_mfma_f32_16x16x32_bf16 v[36:39], v[20:23], v[164:167], v[36:39]
v_mfma_f32_16x16x32_bf16 v[40:43], v[20:23], v[168:171], v[40:43]
v_mfma_f32_16x16x32_bf16 v[44:47], v[20:23], v[172:175], v[44:47]
v_mfma_f32_16x16x32_bf16 v[48:51], v[20:23], v[176:179], v[48:51]
v_mfma_f32_16x16x32_bf16 v[52:55], v[20:23], v[180:183], v[52:55]
s_cbranch_scc1 fsel_71
fsel_69:
s_bitcmp1_b32 s68, 0
s_cbranch_scc1 fsel_70
v_max_u32 v8, 1, v24
v_max_u32 v9, 1, v28
v_max_u32 v10, 1, v32
v_max_u32 v11, 1, v36
v_max_u32 v12, 1, v40
v_max_u32 v13, 1, v44
v_max_u32 v14, 1, v48
v_max_u32 v15, 1, v52
s_branch fsel_73
fsel_70:
v_max_u32 v8, 1, v25
v_max_u32 v9, 1, v29
v_max_u32 v10, 1, v33
v_max_u32 v11, 1, v37
v_max_u32 v12, 1, v41
v_max_u32 v13, 1, v45
v_max_u32 v14, 1, v49
v_max_u32 v15, 1, v53
s_branch fsel_73
fsel_71:
s_bitcmp1_b32 s68, 0
s_cbranch_scc1 fsel_72
v_max_u32 v8, 1, v26
v_max_u32 v9, 1, v30
v_max_u32 v10, 1, v34
v_max_u32 v11, 1, v38
v_max_u32 v12, 1, v42
v_max_u32 v13, 1, v46
v_max_u32 v14, 1, v50
v_max_u32 v15, 1, v54
s_branch fsel_73
fsel_72:
v_max_u32 v8, 1, v27
v_max_u32 v9, 1, v31
v_max_u32 v10, 1, v35
v_max_u32 v11, 1, v39
v_max_u32 v12, 1, v43
v_max_u32 v13, 1, v47
v_max_u32 v14, 1, v51
v_max_u32 v15, 1, v55
fsel_73:
s_bfm_b64 exec, 16, s70
buffer_store_dwordx4 v[8:11], v251, s[24:27], s74 offen sc1
buffer_store_dwordx4 v[12:15], v251, s[24:27], s75 offen sc1
s_mov_b64 exec, -1
s_and_b32 s70, s64, 7
s_lshl1_add_u32 s70, s70, s58
s_mul_i32 s70, s70, 28
s_add_u32 s70, s70, s71
s_lshl_b32 s70, s70, 8
s_add_u32 s70, s70, 1277952
s_waitcnt vmcnt(0)
s_mul_i32 s79, s63, 64
s_sub_u32 s79, 32, s79
s_add_u32 s35, s79, 7
tw_74:
ds_read_b32 v5, v2 offset:16
s_waitcnt lgkmcnt(0)
v_cmp_gt_i32 vcc, s35, v5
s_cbranch_vccz twd_75
v_readfirstlane_b32 s54, v5
s_sub_u32 s55, s35, s54
s_cmp_lt_i32 s55, 2
s_cbranch_scc1 tws_76
s_add_u32 s54, s54, 2
s_or_b32 s54, s54, 1
s_cmp_eq_u32 s54, s52
s_cbranch_scc1 tws_76
s_bitcmp1_b32 s54, 4
s_cbranch_scc1 tws_76
s_mov_b32 s52, s54
s_add_u32 s54, s54, s53
s_and_b32 s54, s54, 15
s_mul_i32 s54, s54, 393216
s_add_u32 s54, s54, s56
s_buffer_load_dwordx2 s[46:47], s[48:51], s54 offset:4096
s_buffer_load_dwordx2 s[46:47], s[48:51], s54 offset:10240
s_buffer_load_dwordx2 s[46:47], s[48:51], s54 offset:16384
s_buffer_load_dwordx2 s[46:47], s[48:51], s54 offset:22528
tws_76:
s_sleep 4
s_sub_u32 s32, s32, 1
s_cmp_gt_i32 s32, 0
s_cbranch_scc1 tw_74
twd_75:
poll_77:
buffer_load_dwordx4 v[24:27], v4, s[24:27], s76 offen offset:0 sc1
buffer_load_dwordx4 v[28:31], v4, s[24:27], s76 offen offset:1024 sc1
buffer_load_dwordx4 v[32:35], v4, s[24:27], s76 offen offset:2048 sc1
buffer_load_dwordx4 v[36:39], v4, s[24:27], s76 offen offset:3072 sc1
pchk_78:
s_waitcnt vmcnt(3)
v_min3_u32 v5, v24, v25, v26
s_waitcnt vmcnt(2)
v_min3_u32 v5, v5, v27, v28
v_min3_u32 v5, v5, v29, v30
s_waitcnt vmcnt(1)
v_min3_u32 v5, v5, v31, v32
v_min3_u32 v5, v5, v33, v34
s_waitcnt vmcnt(0)
v_min3_u32 v5, v5, v35, v36
v_min3_u32 v5, v5, v37, v38
v_min_u32 v5, v5, v39
v_cmp_eq_u32 vcc, 0, v5
s_cbranch_vccz pdone_79
s_sub_u32 s32, s32, 1
s_cmp_gt_i32 s32, 0
s_cbranch_scc1 poll_77
pdone_79:
v_add_f32 v24, v24, v32
v_add_f32 v25, v25, v33
v_add_f32 v26, v26, v34
v_add_f32 v27, v27, v35
v_add_f32 v28, v28, v36
v_add_f32 v29, v29, v37
v_add_f32 v30, v30, v38
v_add_f32 v31, v31, v39
v_add_f32 v24, v24, v28
v_add_f32 v25, v25, v29
v_add_f32 v26, v26, v30
v_add_f32 v27, v27, v31
s_nop 0
v_permlane32_swap_b32 v24, v26
v_permlane32_swap_b32 v25, v27
v_add_f32 v24, v24, v26
v_add_f32 v25, v25, v27
s_nop 1
v_permlane16_swap_b32 v24, v25
v_mul_f32 v26, 0xbfb8aa3b, v24
v_exp_f32 v26, v26
v_mul_f32 v24, v24, v25
v_add_f32 v26, 1.0, v26
v_rcp_f32 v26, v26
v_add_u32 v5, s34, 5
v_mul_f32 v24, v24, v26
v_cvt_pk_bf16_f32 v24, v24, v24
ds_write_b16 v253, v24 offset:512
s_mov_b64 exec, 1
ds_write_b32 v3, v5
s_mov_b64 exec, -1
s_add_u32 s35, s34, 5
poll_80:
ds_read_b32 v5, v2 offset:24
ds_read_b128 v[8:11], v254 offset:512
ds_read_b128 v[12:15], v254 offset:640
pchk_81:
s_waitcnt lgkmcnt(2)
v_cmp_gt_i32 vcc, s35, v5
s_cbranch_vccz pdone_82
s_sleep 1
s_sub_u32 s32, s32, 1
s_cmp_gt_i32 s32, 0
s_cbranch_scc1 poll_80
pdone_82:
s_waitcnt lgkmcnt(1)
v_mfma_f32_16x16x32_bf16 v[24:27], v[8:11], v[184:187], 0
v_mfma_f32_16x16x32_bf16 v[28:31], v[8:11], v[188:191], 0
v_mfma_f32_16x16x32_bf16 v[32:35], v[8:11], v[192:195], 0
v_mfma_f32_16x16x32_bf16 v[36:39], v[8:11], v[196:199], 0
v_mfma_f32_16x16x32_bf16 v[40:43], v[8:11], v[200:203], 0
v_mfma_f32_16x16x32_bf16 v[44:47], v[8:11], v[204:207], 0
v_mfma_f32_16x16x32_bf16 v[48:51], v[8:11], v[208:211], 0
v_mfma_f32_16x16x32_bf16 v[52:55], v[8:11], v[212:215], 0
s_waitcnt lgkmcnt(0)
v_mfma_f32_16x16x32_bf16 v[24:27], v[12:15], v[216:219], v[24:27]
v_mfma_f32_16x16x32_bf16 v[28:31], v[12:15], v[220:223], v[28:31]
v_mfma_f32_16x16x32_bf16 v[32:35], v[12:15], v[224:227], v[32:35]
v_mfma_f32_16x16x32_bf16 v[36:39], v[12:15], v[228:231], v[36:39]
v_mfma_f32_16x16x32_bf16 v[40:43], v[12:15], v[232:235], v[40:43]
v_mfma_f32_16x16x32_bf16 v[44:47], v[12:15], v[236:239], v[44:47]
v_mfma_f32_16x16x32_bf16 v[48:51], v[12:15], v[240:243], v[48:51]
v_mfma_f32_16x16x32_bf16 v[52:55], v[12:15], v[244:247], v[52:55]
s_nop 0
v_add_f32_dpp v16, v25, v24 row_ror:8 row_mask:0x1 bank_mask:0xf
v_add_f32_dpp v17, v29, v28 row_ror:8 row_mask:0x1 bank_mask:0xf
s_nop 0
v_add_f32_dpp v16, v33, v32 row_ror:8 row_mask:0x2 bank_mask:0xf
v_add_f32_dpp v17, v37, v36 row_ror:8 row_mask:0x2 bank_mask:0xf
s_nop 0
v_add_f32_dpp v16, v41, v40 row_ror:8 row_mask:0x4 bank_mask:0xf
v_add_f32_dpp v17, v45, v44 row_ror:8 row_mask:0x4 bank_mask:0xf
s_nop 0
v_add_f32_dpp v16, v49, v48 row_ror:8 row_mask:0x8 bank_mask:0xf
v_add_f32_dpp v17, v53, v52 row_ror:8 row_mask:0x8 bank_mask:0xf
v_max_u32 v16, 1, v16
v_max_u32 v17, 1, v17
s_mov_b32 exec_lo, 0x00ff00ff
s_mov_b32 exec_hi, 0x00ff00ff
buffer_store_dwordx2 v[16:17], v255, s[24:27], s70 offen sc1
s_mov_b64 exec, -1
fnd_64:
s_sub_u32 s70, s60, 3
s_mul_i32 s70, s70, s63
s_or_b32 s70, s70, s58
s_cbranch_scc1 fnr_83
s_mul_i32 s72, s59, 7168
s_add_u32 s72, s72, 1277952
s_add_u32 s73, s72, 4096
s_lshl_b32 s70, s68, 6
s_add_u32 s70, s70, s59
s_lshl_b32 s70, s70, 8
s_add_u32 s76, s70, 262144
v_mov_b32 v12, s67
v_mul_f32 v12, 0xbfb8aa3b, v12
v_exp_f32 v12, v12
v_lshl_add_u32 v6, v252, 2, v251
v_add_f32 v12, 1.0, v12
v_rcp_f32 v12, v12
v_lshrrev_b32 v7, 1, v6
s_lshl4_add_u32 s70, s33, s59
s_lshl_b32 s70, s70, 7
v_and_b32 v8, 0x46, v7
v_lshl_add_u32 v8, v1, 2, v8
v_and_b32 v9, 4, v0
v_lshl_add_u32 v8, v9, 1, v8
s_waitcnt vmcnt(0)
s_cmp_gt_u32 s65, s63
s_cbranch_scc1 fpre_85
fpre_86:
s_mul_i32 s79, s63, 64
s_sub_u32 s79, 32, s79
s_add_u32 s35, s79, 11
tw_87:
ds_read_b32 v5, v2 offset:16
s_waitcnt lgkmcnt(0)
v_cmp_gt_i32 vcc, s35, v5
s_cbranch_vccz twd_88
v_readfirstlane_b32 s54, v5
s_sub_u32 s55, s35, s54
s_cmp_lt_i32 s55, 2
s_cbranch_scc1 tws_89
s_add_u32 s54, s54, 2
s_or_b32 s54, s54, 1
s_cmp_eq_u32 s54, s52
s_cbranch_scc1 tws_89
s_bitcmp1_b32 s54, 4
s_cbranch_scc1 tws_89
s_mov_b32 s52, s54
s_add_u32 s54, s54, s53
s_and_b32 s54, s54, 15
s_mul_i32 s54, s54, 393216
s_add_u32 s54, s54, s56
s_buffer_load_dwordx2 s[46:47], s[48:51], s54 offset:4096
s_buffer_load_dwordx2 s[46:47], s[48:51], s54 offset:10240
s_buffer_load_dwordx2 s[46:47], s[48:51], s54 offset:16384
s_buffer_load_dwordx2 s[46:47], s[48:51], s54 offset:22528
tws_89:
s_sleep 4
s_sub_u32 s32, s32, 1
s_cmp_gt_i32 s32, 0
s_cbranch_scc1 tw_87
twd_88:
poll_90:
buffer_load_dword v52, v6, s[24:27], s76 offen sc1
buffer_load_dwordx4 v[24:27], v4, s[24:27], s72 offen offset:0 sc1
buffer_load_dwordx4 v[28:31], v4, s[24:27], s72 offen offset:1024 sc1
buffer_load_dwordx4 v[32:35], v4, s[24:27], s72 offen offset:2048 sc1
buffer_load_dwordx4 v[36:39], v4, s[24:27], s72 offen offset:3072 sc1
buffer_load_dwordx4 v[40:43], v4, s[24:27], s73 offen offset:0 sc1
buffer_load_dwordx4 v[44:47], v4, s[24:27], s73 offen offset:1024 sc1
buffer_load_dwordx4 v[48:51], v4, s[24:27], s73 offen offset:2048 sc1
pchk_91:
s_waitcnt vmcnt(6)
v_min3_u32 v5, v24, v25, v26
s_waitcnt vmcnt(5)
v_min3_u32 v5, v5, v27, v28
v_min3_u32 v5, v5, v29, v30
s_waitcnt vmcnt(4)
v_min3_u32 v5, v5, v31, v32
v_min3_u32 v5, v5, v33, v34
s_waitcnt vmcnt(3)
v_min3_u32 v5, v5, v35, v36
v_min3_u32 v5, v5, v37, v38
s_waitcnt vmcnt(2)
v_min3_u32 v5, v5, v39, v40
v_min3_u32 v5, v5, v41, v42
s_waitcnt vmcnt(1)
v_min3_u32 v5, v5, v43, v44
v_min3_u32 v5, v5, v45, v46
s_waitcnt vmcnt(0)
v_min3_u32 v5, v5, v47, v48
v_min3_u32 v5, v5, v49, v50
v_min3_u32 v5, v5, v51, v52
v_cmp_eq_u32 vcc, 0, v5
s_cbranch_vccz pdone_92
s_sub_u32 s32, s32, 1
s_cmp_gt_i32 s32, 0
s_cbranch_scc1 poll_90
pdone_92:
v_add_f32 v24, v24, v40
v_add_f32 v25, v25, v41
v_add_f32 v26, v26, v42
v_add_f32 v27, v27, v43
v_add_f32 v28, v28, v44
v_add_f32 v29, v29, v45
v_add_f32 v30, v30, v46
v_add_f32 v31, v31, v47
v_add_f32 v32, v32, v48
v_add_f32 v33, v33, v49
v_add_f32 v34, v34, v50
v_add_f32 v35, v35, v51
v_add_f32 v24, v24, v32
v_add_f32 v25, v25, v33
v_add_f32 v26, v26, v34
v_add_f32 v27, v27, v35
v_add_f32 v28, v28, v36
v_add_f32 v29, v29, v37
v_add_f32 v30, v30, v38
v_add_f32 v31, v31, v39
v_add_f32 v24, v24, v28
v_add_f32 v25, v25, v29
v_add_f32 v26, v26, v30
v_add_f32 v27, v27, v31
s_nop 0
v_permlane32_swap_b32 v24, v26
v_permlane32_swap_b32 v25, v27
v_add_f32 v24, v24, v26
v_add_f32 v25, v25, v27
s_nop 1
v_permlane16_swap_b32 v24, v25
v_add_f32 v24, v24, v25
v_fma_f32 v24, v24, v12, v52
v_cvt_pk_bf16_f32 v24, v24, v24
s_cmp_eq_u32 s63, 0
s_cbranch_scc1 fl0_84
buffer_store_short v24, v7, s[28:31], s70 offen
s_branch L_end
fl0_84:
ds_write_b16 v8, v24 offset:384
fnr_83:
s_cmp_eq_u32 s63, 0
s_cbranch_scc0 L_end
v_add_u32 v5, s34, 6
s_mov_b64 exec, 1
ds_write_b32 v3, v5
s_mov_b64 exec, -1
s_mul_i32 s79, s63, 64
s_sub_u32 s79, 32, s79
s_add_u32 s35, s79, 11
tw_93:
ds_read_b32 v5, v2 offset:16
s_waitcnt lgkmcnt(0)
v_cmp_gt_i32 vcc, s35, v5
s_cbranch_vccz twd_94
v_readfirstlane_b32 s54, v5
s_sub_u32 s55, s35, s54
s_cmp_lt_i32 s55, 2
s_cbranch_scc1 tws_95
s_add_u32 s54, s54, 2
s_or_b32 s54, s54, 1
s_cmp_eq_u32 s54, s52
s_cbranch_scc1 tws_95
s_bitcmp1_b32 s54, 4
s_cbranch_scc1 tws_95
s_mov_b32 s52, s54
s_add_u32 s54, s54, s53
s_and_b32 s54, s54, 15
s_mul_i32 s54, s54, 393216
s_add_u32 s54, s54, s56
s_buffer_load_dwordx2 s[46:47], s[48:51], s54 offset:4096
s_buffer_load_dwordx2 s[46:47], s[48:51], s54 offset:10240
s_buffer_load_dwordx2 s[46:47], s[48:51], s54 offset:16384
s_buffer_load_dwordx2 s[46:47], s[48:51], s54 offset:22528
tws_95:
s_sleep 4
s_sub_u32 s32, s32, 1
s_cmp_gt_i32 s32, 0
s_cbranch_scc1 tw_93
twd_94:
v_and_b32 v6, 48, v0
s_add_u32 s35, s34, 6
poll_96:
ds_read_b32 v5, v2 offset:24
ds_read_b128 v[8:11], v6 offset:384
ds_read_b128 v[12:15], v6 offset:448
pchk_97:
s_waitcnt lgkmcnt(2)
v_cmp_gt_i32 vcc, s35, v5
s_cbranch_vccz pdone_98
s_sleep 1
s_sub_u32 s32, s32, 1
s_cmp_gt_i32 s32, 0
s_cbranch_scc1 poll_96
pdone_98:
s_mov_b32 s63, 1
s_mov_b32 s34, 32
s_add_u32 s24, s24, 1409024
s_addc_u32 s25, s25, 0
s_mov_b32 s26, 1409024
s_mov_b32 s70, 131072
s_mov_b32 s79, 34
s_branch ftop_39
fxt_42:
v_max_u32 v8, 1, v8
v_max_u32 v9, 1, v9
v_max_u32 v10, 1, v10
v_max_u32 v11, 1, v11
v_max_u32 v12, 1, v12
v_max_u32 v13, 1, v13
v_max_u32 v14, 1, v14
v_max_u32 v15, 1, v15
s_mov_b32 exec_lo, 0x10001
s_mov_b32 exec_hi, 0x10001
buffer_store_dwordx4 v[8:11], v7, s[20:23], s73 offen offset:0 sc1
buffer_store_dwordx4 v[12:15], v7, s[20:23], s73 offen offset:64 sc1
s_mov_b64 exec, -1
s_branch fxb_43
fst_37:
s_lshl1_add_u32 s70, s78, s58
s_lshl_b32 s70, s70, 13
v_bfe_u32 v8, v0, 2, 2
v_lshl_add_u32 v8, v8, 9, v7
v_add_u32 v8, v8, v1
v_lshlrev_b32 v8, 2, v8
buffer_load_dwordx4 v[24:27], v8, s[8:11], s70 offen offset:0
buffer_load_dwordx4 v[28:31], v8, s[8:11], s70 offen offset:256
buffer_load_dwordx4 v[32:35], v8, s[8:11], s70 offen offset:512
buffer_load_dwordx4 v[36:39], v8, s[8:11], s70 offen offset:768
buffer_load_dwordx4 v[40:43], v8, s[8:11], s70 offen offset:1024
buffer_load_dwordx4 v[44:47], v8, s[8:11], s70 offen offset:1280
buffer_load_dwordx4 v[48:51], v8, s[8:11], s70 offen offset:1536
buffer_load_dwordx4 v[52:55], v8, s[8:11], s70 offen offset:1792
v_lshlrev_b32 v9, 4, v1
s_waitcnt vmcnt(7)
v_mfma_f32_16x16x32_bf16 v[16:19], v[24:27], v[252:255], 0
v_mfma_f32_16x16x32_bf16 v[20:23], v[24:27], v[24:27], 0
s_waitcnt vmcnt(6)
v_mfma_f32_16x16x32_bf16 v[16:19], v[28:31], v[252:255], v[16:19]
v_mfma_f32_16x16x32_bf16 v[20:23], v[28:31], v[28:31], v[20:23]
s_waitcnt vmcnt(5)
v_mfma_f32_16x16x32_bf16 v[16:19], v[32:35], v[252:255], v[16:19]
v_mfma_f32_16x16x32_bf16 v[20:23], v[32:35], v[32:35], v[20:23]
s_waitcnt vmcnt(4)
v_mfma_f32_16x16x32_bf16 v[16:19], v[36:39], v[252:255], v[16:19]
v_mfma_f32_16x16x32_bf16 v[20:23], v[36:39], v[36:39], v[20:23]
s_waitcnt vmcnt(3)
v_mfma_f32_16x16x32_bf16 v[16:19], v[40:43], v[252:255], v[16:19]
v_mfma_f32_16x16x32_bf16 v[20:23], v[40:43], v[40:43], v[20:23]
s_waitcnt vmcnt(2)
v_mfma_f32_16x16x32_bf16 v[16:19], v[44:47], v[252:255], v[16:19]
v_mfma_f32_16x16x32_bf16 v[20:23], v[44:47], v[44:47], v[20:23]
s_waitcnt vmcnt(1)
v_mfma_f32_16x16x32_bf16 v[16:19], v[48:51], v[252:255], v[16:19]
v_mfma_f32_16x16x32_bf16 v[20:23], v[48:51], v[48:51], v[20:23]
s_waitcnt vmcnt(0)
v_mfma_f32_16x16x32_bf16 v[16:19], v[52:55], v[252:255], v[16:19]
v_mfma_f32_16x16x32_bf16 v[20:23], v[52:55], v[52:55], v[20:23]
s_nop 6
v_add_f32 v16, v16, v18
v_add_f32 v17, v17, v19
v_add_f32 v16, v16, v17
s_nop 0
v_mov_b32_dpp v17, v20 quad_perm:[0,0,0,0] row_mask:0xf bank_mask:0xf
s_nop 1
v_add_f32_dpp v17, v21, v17 quad_perm:[1,1,1,1] row_mask:0xf bank_mask:0xf
s_nop 1
v_add_f32_dpp v17, v22, v17 quad_perm:[2,2,2,2] row_mask:0xf bank_mask:0xf
s_nop 1
v_add_f32_dpp v17, v23, v17 quad_perm:[3,3,3,3] row_mask:0xf bank_mask:0xf
v_mul_f32 v5, 0xba800000, v16
v_mul_f32 v17, 0x3a800000, v17
v_fma_f32 v17, -v5, v5, v17
v_max_f32 v17, 0, v17
v_add_f32 v17, 0x3727c5ac, v17
v_rsq_f32 v16, v17
s_nop 0
v_mul_f32 v17, v5, v16
v_max_u32 v17, 1, v17
s_lshl_b32 s70, s60, 7
s_add_u32 s70, s70, s76
s_lshl_b32 s73, s58, 5
s_add_u32 s70, s70, s73
v_lshrrev_b32 v7, 1, v7
s_add_u32 s35, s34, 5
tw_99:
ds_read_b32 v5, v2 offset:16
s_waitcnt lgkmcnt(0)
v_cmp_gt_i32 vcc, s35, v5
s_cbranch_vccz twd_100
v_readfirstlane_b32 s54, v5
s_sub_u32 s55, s35, s54
s_cmp_lt_i32 s55, 2
s_cbranch_scc1 tws_101
s_add_u32 s54, s54, 2
s_or_b32 s54, s54, 1
s_cmp_eq_u32 s54, s52
s_cbranch_scc1 tws_101
s_bitcmp1_b32 s54, 4
s_cbranch_scc1 tws_101
s_mov_b32 s52, s54
s_add_u32 s54, s54, s53
s_and_b32 s54, s54, 15
s_mul_i32 s54, s54, 393216
s_add_u32 s54, s54, s56
s_buffer_load_dwordx2 s[46:47], s[48:51], s54 offset:4096
s_buffer_load_dwordx2 s[46:47], s[48:51], s54 offset:10240
s_buffer_load_dwordx2 s[46:47], s[48:51], s54 offset:16384
s_buffer_load_dwordx2 s[46:47], s[48:51], s54 offset:22528
tws_101:
s_sleep 4
s_sub_u32 s32, s32, 1
s_cmp_gt_i32 s32, 0
s_cbranch_scc1 tw_99
twd_100:
poll_102:
buffer_load_dword v12, v9, s[4:7], 0 offen sc1
pchk_103:
s_waitcnt vmcnt(0)
v_cmp_gt_u32 vcc, 64, v12
s_cbranch_vccz pdone_104
s_sleep 16
s_sub_u32 s32, s32, 1
s_cmp_gt_i32 s32, 0
s_cbranch_scc1 poll_102
pdone_104:
s_mov_b32 exec_lo, 0x00100001
s_mov_b32 exec_hi, 0x10000100
buffer_store_dwordx2 v[16:17], v7, s[24:27], s70 offen sc1
s_getreg_b32 s73, hwreg(HW_REG_XCC_ID)
s_mov_b64 exec, 1
v_add_u32 v12, s73, 1
buffer_store_dword v12, off, s[24:27], s70 offset:64 sc1
s_mov_b64 exec, -1
s_branch fsb_38
fg_44:
s_lshl1_add_u32 s35, s2, s58
s_lshl_b32 s35, s35, 12
s_add_u32 s44, s40, s35
s_addc_u32 s45, s41, 0
s_mov_b32 s35, 4
ft_105:
s_load_dwordx2 s[42:43], s[44:45], 60
s_load_dwordx2 s[42:43], s[44:45], 188
s_load_dwordx2 s[42:43], s[44:45], 316
s_load_dwordx2 s[42:43], s[44:45], 444
s_load_dwordx2 s[42:43], s[44:45], 572
s_load_dwordx2 s[42:43], s[44:45], 700
s_load_dwordx2 s[42:43], s[44:45], 828
s_load_dwordx2 s[42:43], s[44:45], 956
s_add_u32 s44, s44, 1024
s_addc_u32 s45, s45, 0
s_sub_u32 s35, s35, 1
s_cmp_eq_u32 s35, 0
s_cbranch_scc0 ft_105
v_lshrrev_b32 v250, 3, v0
v_mul_u32_u24 v250, 16256, v250
v_add_u32 v250, v250, v4
s_add_u32 s35, s66, 131072
buffer_load_dwordx4 v[184:187], v250, s[12:15], s35 offen nt
s_add_u32 s35, s66, 133120
buffer_load_dwordx4 v[188:191], v250, s[12:15], s35 offen nt
s_add_u32 s35, s66, 135168
buffer_load_dwordx4 v[192:195], v250, s[12:15], s35 offen nt
s_add_u32 s35, s66, 137216
buffer_load_dwordx4 v[196:199], v250, s[12:15], s35 offen nt
s_add_u32 s35, s66, 139264
buffer_load_dwordx4 v[200:203], v250, s[12:15], s35 offen nt
s_add_u32 s35, s66, 141312
buffer_load_dwordx4 v[204:207], v250, s[12:15], s35 offen nt
s_add_u32 s35, s66, 143360
buffer_load_dwordx4 v[208:211], v250, s[12:15], s35 offen nt
s_add_u32 s35, s66, 145408
buffer_load_dwordx4 v[212:215], v250, s[12:15], s35 offen nt
v_lshrrev_b32 v250, 3, v0
v_mul_u32_u24 v250, 16256, v250
v_add_u32 v250, v250, v4
s_add_u32 s35, s66, 0
buffer_load_dwordx4 v[152:155], v250, s[12:15], s35 offen nt
s_add_u32 s35, s66, 2048
buffer_load_dwordx4 v[156:159], v250, s[12:15], s35 offen nt
s_add_u32 s35, s66, 4096
buffer_load_dwordx4 v[160:163], v250, s[12:15], s35 offen nt
s_add_u32 s35, s66, 6144
buffer_load_dwordx4 v[164:167], v250, s[12:15], s35 offen nt
s_add_u32 s35, s66, 8192
buffer_load_dwordx4 v[168:171], v250, s[12:15], s35 offen nt
s_add_u32 s35, s66, 10240
buffer_load_dwordx4 v[172:175], v250, s[12:15], s35 offen nt
s_add_u32 s35, s66, 12288
buffer_load_dwordx4 v[176:179], v250, s[12:15], s35 offen nt
s_add_u32 s35, s66, 14336
buffer_load_dwordx4 v[180:183], v250, s[12:15], s35 offen nt
s_add_u32 s35, s34, 10
tw_106:
ds_read_b32 v5, v2 offset:16
s_waitcnt lgkmcnt(0)
v_cmp_gt_i32 vcc, s35, v5
s_cbranch_vccz twd_107
v_readfirstlane_b32 s54, v5
s_sub_u32 s55, s35, s54
s_cmp_lt_i32 s55, 2
s_cbranch_scc1 tws_108
s_add_u32 s54, s54, 2
s_or_b32 s54, s54, 1
s_cmp_eq_u32 s54, s52
s_cbranch_scc1 tws_108
s_bitcmp1_b32 s54, 4
s_cbranch_scc1 tws_108
s_mov_b32 s52, s54
s_add_u32 s54, s54, s53
s_and_b32 s54, s54, 15
s_mul_i32 s54, s54, 393216
s_add_u32 s54, s54, s56
s_buffer_load_dwordx2 s[46:47], s[48:51], s54 offset:4096
s_buffer_load_dwordx2 s[46:47], s[48:51], s54 offset:10240
s_buffer_load_dwordx2 s[46:47], s[48:51], s54 offset:16384
s_buffer_load_dwordx2 s[46:47], s[48:51], s54 offset:22528
tws_108:
s_sleep 4
s_sub_u32 s32, s32, 1
s_cmp_gt_i32 s32, 0
s_cbranch_scc1 tw_106
twd_107:
v_and_b32 v10, 0x7a0, v7
s_getreg_b32 s70, hwreg(HW_REG_XCC_ID)
s_add_u32 s70, s70, 1
poll_109:
buffer_load_dword v12, v10, s[24:27], s76 offen offset:64 sc1
pchk_110:
s_waitcnt vmcnt(0)
v_cmp_eq_u32 vcc, 0, v12
s_cbranch_vccz pdone_111
s_sub_u32 s32, s32, 1
s_cmp_gt_i32 s32, 0
s_cbranch_scc1 poll_109
pdone_111:
v_cmp_eq_u32 vcc, s70, v12
s_cmp_eq_u64 vcc, exec
s_cselect_b32 s70, 1, 0
v_mov_b32 v12, s70
v_mov_b32 v10, 0
s_mov_b64 exec, 1
ds_write_b32 v10, v12 offset:56
s_mov_b64 exec, -1
s_branch fg_45
fnw_55:
s_waitcnt lgkmcnt(0)
v_mov_b32 v252, 0
v_mov_b32 v253, 0
v_mov_b32 v254, 0
v_mov_b32 v255, 0
s_mul_i32 s42, s58, 1409024
s_mul_i32 s35, s78, 2048
s_add_u32 s35, s35, s42
s_add_u32 s35, s35, 524288
buffer_store_dwordx4 v[252:255], v4, s[24:27], s35 offen offset:0 sc1
buffer_store_dwordx4 v[252:255], v4, s[24:27], s35 offen offset:1024 sc1
s_mul_i32 s35, s78, 1408
s_add_u32 s35, s35, s42
s_add_u32 s35, s35, 1048576
buffer_store_dwordx4 v[252:255], v4, s[24:27], s35 offen offset:0 sc1
buffer_store_dwordx4 v[252:255], v4, s[24:27], s35 offen offset:384 sc1
s_lshl_b32 s35, s78, 10
s_add_u32 s35, s35, 1409024
s_cmp_eq_u32 s58, 1
s_cselect_b64 exec, -1, 0
buffer_store_dwordx4 v[252:255], v4, s[24:27], s35 offen offset:0 sc1
s_add_u32 s35, s35, 262144
buffer_store_dwordx4 v[252:255], v4, s[24:27], s35 offen offset:0 sc1
s_mov_b64 exec, -1
s_waitcnt vmcnt(0)
v_add_u32 v5, s34, 3
s_mov_b64 exec, 1
ds_write_b32 v3, v5
s_mov_b64 exec, -1
s_add_u32 s35, s34, 17
tw_112:
ds_read_b32 v5, v2 offset:16
s_waitcnt lgkmcnt(0)
v_cmp_gt_i32 vcc, s35, v5
s_cbranch_vccz twd_113
v_readfirstlane_b32 s54, v5
s_sub_u32 s55, s35, s54
s_cmp_lt_i32 s55, 2
s_cbranch_scc1 tws_114
s_add_u32 s54, s54, 2
s_or_b32 s54, s54, 1
s_cmp_eq_u32 s54, s52
s_cbranch_scc1 tws_114
s_bitcmp1_b32 s54, 4
s_cbranch_scc1 tws_114
s_mov_b32 s52, s54
s_add_u32 s54, s54, s53
s_and_b32 s54, s54, 15
s_mul_i32 s54, s54, 393216
s_add_u32 s54, s54, s56
s_buffer_load_dwordx2 s[46:47], s[48:51], s54 offset:4096
s_buffer_load_dwordx2 s[46:47], s[48:51], s54 offset:10240
s_buffer_load_dwordx2 s[46:47], s[48:51], s54 offset:16384
s_buffer_load_dwordx2 s[46:47], s[48:51], s54 offset:22528
tws_114:
s_sleep 4
s_sub_u32 s32, s32, 1
s_cmp_gt_i32 s32, 0
s_cbranch_scc1 tw_112
twd_113:
v_lshrrev_b32 v250, 4, v0
v_mul_u32_u24 v250, 28416, v250
v_add_u32 v250, v250, v4
s_add_u32 s35, s77, 688128
buffer_load_dwordx4 v[120:123], v250, s[16:19], s35 offen nt
s_add_u32 s35, s77, 695296
buffer_load_dwordx4 v[124:127], v250, s[16:19], s35 offen nt
s_add_u32 s35, s77, 702464
buffer_load_dwordx4 v[128:131], v250, s[16:19], s35 offen nt
s_add_u32 s35, s77, 709632
buffer_load_dwordx4 v[132:135], v250, s[16:19], s35 offen nt
s_add_u32 s35, s77, 802816
buffer_load_dwordx4 v[136:139], v250, s[16:19], s35 offen nt
s_add_u32 s35, s77, 809984
buffer_load_dwordx4 v[140:143], v250, s[16:19], s35 offen nt
s_add_u32 s35, s77, 817152
buffer_load_dwordx4 v[144:147], v250, s[16:19], s35 offen nt
s_add_u32 s35, s77, 824320
buffer_load_dwordx4 v[148:151], v250, s[16:19], s35 offen nt
v_lshrrev_b32 v250, 4, v0
v_mul_u32_u24 v250, 28416, v250
v_add_u32 v250, v250, v4
s_add_u32 s35, s77, 458752
buffer_load_dwordx4 v[88:91], v250, s[16:19], s35 offen nt
s_add_u32 s35, s77, 465920
buffer_load_dwordx4 v[92:95], v250, s[16:19], s35 offen nt
s_add_u32 s35, s77, 473088
buffer_load_dwordx4 v[96:99], v250, s[16:19], s35 offen nt
s_add_u32 s35, s77, 480256
buffer_load_dwordx4 v[100:103], v250, s[16:19], s35 offen nt
s_add_u32 s35, s77, 573440
buffer_load_dwordx4 v[104:107], v250, s[16:19], s35 offen nt
s_add_u32 s35, s77, 580608
buffer_load_dwordx4 v[108:111], v250, s[16:19], s35 offen nt
s_add_u32 s35, s77, 587776
buffer_load_dwordx4 v[112:115], v250, s[16:19], s35 offen nt
s_add_u32 s35, s77, 594944
buffer_load_dwordx4 v[116:119], v250, s[16:19], s35 offen nt
v_lshrrev_b32 v250, 4, v0
v_mul_u32_u24 v250, 28416, v250
v_add_u32 v250, v250, v4
s_add_u32 s35, s77, 229376
buffer_load_dwordx4 v[56:59], v250, s[16:19], s35 offen nt
s_add_u32 s35, s77, 236544
buffer_load_dwordx4 v[60:63], v250, s[16:19], s35 offen nt
s_add_u32 s35, s77, 243712
buffer_load_dwordx4 v[64:67], v250, s[16:19], s35 offen nt
s_add_u32 s35, s77, 250880
buffer_load_dwordx4 v[68:71], v250, s[16:19], s35 offen nt
s_add_u32 s35, s77, 344064
buffer_load_dwordx4 v[72:75], v250, s[16:19], s35 offen nt
s_add_u32 s35, s77, 351232
buffer_load_dwordx4 v[76:79], v250, s[16:19], s35 offen nt
s_add_u32 s35, s77, 358400
buffer_load_dwordx4 v[80:83], v250, s[16:19], s35 offen nt
s_add_u32 s35, s77, 365568
buffer_load_dwordx4 v[84:87], v250, s[16:19], s35 offen nt
v_lshrrev_b32 v250, 4, v0
v_mul_u32_u24 v250, 28416, v250
v_add_u32 v250, v250, v4
s_add_u32 s35, s77, 0
buffer_load_dwordx4 v[24:27], v250, s[16:19], s35 offen nt
s_add_u32 s35, s77, 7168
buffer_load_dwordx4 v[28:31], v250, s[16:19], s35 offen nt
s_add_u32 s35, s77, 14336
buffer_load_dwordx4 v[32:35], v250, s[16:19], s35 offen nt
s_add_u32 s35, s77, 21504
buffer_load_dwordx4 v[36:39], v250, s[16:19], s35 offen nt
s_add_u32 s35, s77, 114688
buffer_load_dwordx4 v[40:43], v250, s[16:19], s35 offen nt
s_add_u32 s35, s77, 121856
buffer_load_dwordx4 v[44:47], v250, s[16:19], s35 offen nt
s_add_u32 s35, s77, 129024
buffer_load_dwordx4 v[48:51], v250, s[16:19], s35 offen nt
s_add_u32 s35, s77, 136192
buffer_load_dwordx4 v[52:55], v250, s[16:19], s35 offen nt
s_waitcnt lgkmcnt(0)
s_mov_b32 s42, 0x05040100
s_mov_b32 s43, 0x07060302
s_cmp_eq_u32 s65, 0
s_cbranch_scc0 fq_115
v_perm_b32 v216, v188, v184, s42
v_perm_b32 v220, v188, v184, s43
v_perm_b32 v224, v189, v185, s42
v_perm_b32 v228, v189, v185, s43
v_perm_b32 v232, v190, v186, s42
v_perm_b32 v236, v190, v186, s43
v_perm_b32 v240, v191, v187, s42
v_perm_b32 v244, v191, v187, s43
v_perm_b32 v217, v196, v192, s42
v_perm_b32 v221, v196, v192, s43
v_perm_b32 v225, v197, v193, s42
v_perm_b32 v229, v197, v193, s43
v_perm_b32 v233, v198, v194, s42
v_perm_b32 v237, v198, v194, s43
v_perm_b32 v241, v199, v195, s42
v_perm_b32 v245, v199, v195, s43
v_perm_b32 v218, v204, v200, s42
v_perm_b32 v222, v204, v200, s43
v_perm_b32 v226, v205, v201, s42
v_perm_b32 v230, v205, v201, s43
v_perm_b32 v234, v206, v202, s42
v_perm_b32 v238, v206, v202, s43
v_perm_b32 v242, v207, v203, s42
v_perm_b32 v246, v207, v203, s43
v_perm_b32 v219, v212, v208, s42
v_perm_b32 v223, v212, v208, s43
v_perm_b32 v227, v213, v209, s42
v_perm_b32 v231, v213, v209, s43
v_perm_b32 v235, v214, v210, s42
v_perm_b32 v239, v214, v210, s43
v_perm_b32 v243, v215, v211, s42
v_perm_b32 v247, v215, v211, s43
v_perm_b32 v184, v156, v152, s42
v_perm_b32 v188, v156, v152, s43
v_perm_b32 v192, v157, v153, s42
v_perm_b32 v196, v157, v153, s43
v_perm_b32 v200, v158, v154, s42
v_perm_b32 v204, v158, v154, s43
v_perm_b32 v208, v159, v155, s42
v_perm_b32 v212, v159, v155, s43
v_perm_b32 v185, v164, v160, s42
v_perm_b32 v189, v164, v160, s43
v_perm_b32 v193, v165, v161, s42
v_perm_b32 v197, v165, v161, s43
v_perm_b32 v201, v166, v162, s42
v_perm_b32 v205, v166, v162, s43
v_perm_b32 v209, v167, v163, s42
v_perm_b32 v213, v167, v163, s43
v_perm_b32 v186, v172, v168, s42
v_perm_b32 v190, v172, v168, s43
v_perm_b32 v194, v173, v169, s42
v_perm_b32 v198, v173, v169, s43
v_perm_b32 v202, v174, v170, s42
v_perm_b32 v206, v174, v170, s43
v_perm_b32 v210, v175, v171, s42
v_perm_b32 v214, v175, v171, s43
v_perm_b32 v187, v180, v176, s42
v_perm_b32 v191, v180, v176, s43
v_perm_b32 v195, v181, v177, s42
v_perm_b32 v199, v181, v177, s43
v_perm_b32 v203, v182, v178, s42
v_perm_b32 v207, v182, v178, s43
v_perm_b32 v211, v183, v179, s42
v_perm_b32 v215, v183, v179, s43
s_waitcnt vmcnt(30)
v_perm_b32 v152, v124, v120, s42
v_perm_b32 v156, v124, v120, s43
v_perm_b32 v160, v125, v121, s42
v_perm_b32 v164, v125, v121, s43
v_perm_b32 v168, v126, v122, s42
v_perm_b32 v172, v126, v122, s43
v_perm_b32 v176, v127, v123, s42
v_perm_b32 v180, v127, v123, s43
s_waitcnt vmcnt(28)
v_perm_b32 v153, v132, v128, s42
v_perm_b32 v157, v132, v128, s43
v_perm_b32 v161, v133, v129, s42
v_perm_b32 v165, v133, v129, s43
v_perm_b32 v169, v134, v130, s42
v_perm_b32 v173, v134, v130, s43
v_perm_b32 v177, v135, v131, s42
v_perm_b32 v181, v135, v131, s43
s_waitcnt vmcnt(26)
v_perm_b32 v154, v140, v136, s42
v_perm_b32 v158, v140, v136, s43
v_perm_b32 v162, v141, v137, s42
v_perm_b32 v166, v141, v137, s43
v_perm_b32 v170, v142, v138, s42
v_perm_b32 v174, v142, v138, s43
v_perm_b32 v178, v143, v139, s42
v_perm_b32 v182, v143, v139, s43
s_waitcnt vmcnt(24)
v_perm_b32 v155, v148, v144, s42
v_perm_b32 v159, v148, v144, s43
v_perm_b32 v163, v149, v145, s42
v_perm_b32 v167, v149, v145, s43
v_perm_b32 v171, v150, v146, s42
v_perm_b32 v175, v150, v146, s43
v_perm_b32 v179, v151, v147, s42
v_perm_b32 v183, v151, v147, s43
s_waitcnt vmcnt(22)
v_perm_b32 v120, v92, v88, s42
v_perm_b32 v124, v92, v88, s43
v_perm_b32 v128, v93, v89, s42
v_perm_b32 v132, v93, v89, s43
v_perm_b32 v136, v94, v90, s42
v_perm_b32 v140, v94, v90, s43
v_perm_b32 v144, v95, v91, s42
v_perm_b32 v148, v95, v91, s43
s_waitcnt vmcnt(20)
v_perm_b32 v121, v100, v96, s42
v_perm_b32 v125, v100, v96, s43
v_perm_b32 v129, v101, v97, s42
v_perm_b32 v133, v101, v97, s43
v_perm_b32 v137, v102, v98, s42
v_perm_b32 v141, v102, v98, s43
v_perm_b32 v145, v103, v99, s42
v_perm_b32 v149, v103, v99, s43
s_waitcnt vmcnt(18)
v_perm_b32 v122, v108, v104, s42
v_perm_b32 v126, v108, v104, s43
v_perm_b32 v130, v109, v105, s42
v_perm_b32 v134, v109, v105, s43
v_perm_b32 v138, v110, v106, s42
v_perm_b32 v142, v110, v106, s43
v_perm_b32 v146, v111, v107, s42
v_perm_b32 v150, v111, v107, s43
s_waitcnt vmcnt(16)
v_perm_b32 v123, v116, v112, s42
v_perm_b32 v127, v116, v112, s43
v_perm_b32 v131, v117, v113, s42
v_perm_b32 v135, v117, v113, s43
v_perm_b32 v139, v118, v114, s42
v_perm_b32 v143, v118, v114, s43
v_perm_b32 v147, v119, v115, s42
v_perm_b32 v151, v119, v115, s43
s_waitcnt vmcnt(14)
v_perm_b32 v88, v60, v56, s42
v_perm_b32 v92, v60, v56, s43
v_perm_b32 v96, v61, v57, s42
v_perm_b32 v100, v61, v57, s43
v_perm_b32 v104, v62, v58, s42
v_perm_b32 v108, v62, v58, s43
v_perm_b32 v112, v63, v59, s42
v_perm_b32 v116, v63, v59, s43
s_waitcnt vmcnt(12)
v_perm_b32 v89, v68, v64, s42
v_perm_b32 v93, v68, v64, s43
v_perm_b32 v97, v69, v65, s42
v_perm_b32 v101, v69, v65, s43
v_perm_b32 v105, v70, v66, s42
v_perm_b32 v109, v70, v66, s43
v_perm_b32 v113, v71, v67, s42
v_perm_b32 v117, v71, v67, s43
s_waitcnt vmcnt(10)
v_perm_b32 v90, v76, v72, s42
v_perm_b32 v94, v76, v72, s43
v_perm_b32 v98, v77, v73, s42
v_perm_b32 v102, v77, v73, s43
v_perm_b32 v106, v78, v74, s42
v_perm_b32 v110, v78, v74, s43
v_perm_b32 v114, v79, v75, s42
v_perm_b32 v118, v79, v75, s43
s_waitcnt vmcnt(8)
v_perm_b32 v91, v84, v80, s42
v_perm_b32 v95, v84, v80, s43
v_perm_b32 v99, v85, v81, s42
v_perm_b32 v103, v85, v81, s43
v_perm_b32 v107, v86, v82, s42
v_perm_b32 v111, v86, v82, s43
v_perm_b32 v115, v87, v83, s42
v_perm_b32 v119, v87, v83, s43
s_waitcnt vmcnt(6)
v_perm_b32 v56, v28, v24, s42
v_perm_b32 v60, v28, v24, s43
v_perm_b32 v64, v29, v25, s42
v_perm_b32 v68, v29, v25, s43
v_perm_b32 v72, v30, v26, s42
v_perm_b32 v76, v30, v26, s43
v_perm_b32 v80, v31, v27, s42
v_perm_b32 v84, v31, v27, s43
s_waitcnt vmcnt(4)
v_perm_b32 v57, v36, v32, s42
v_perm_b32 v61, v36, v32, s43
v_perm_b32 v65, v37, v33, s42
v_perm_b32 v69, v37, v33, s43
v_perm_b32 v73, v38, v34, s42
v_perm_b32 v77, v38, v34, s43
v_perm_b32 v81, v39, v35, s42
v_perm_b32 v85, v39, v35, s43
s_waitcnt vmcnt(2)
v_perm_b32 v58, v44, v40, s42
v_perm_b32 v62, v44, v40, s43
v_perm_b32 v66, v45, v41, s42
v_perm_b32 v70, v45, v41, s43
v_perm_b32 v74, v46, v42, s42
v_perm_b32 v78, v46, v42, s43
v_perm_b32 v82, v47, v43, s42
v_perm_b32 v86, v47, v43, s43
s_waitcnt vmcnt(0)
v_perm_b32 v59, v52, v48, s42
v_perm_b32 v63, v52, v48, s43
v_perm_b32 v67, v53, v49, s42
v_perm_b32 v71, v53, v49, s43
v_perm_b32 v75, v54, v50, s42
v_perm_b32 v79, v54, v50, s43
v_perm_b32 v83, v55, v51, s42
v_perm_b32 v87, v55, v51, s43
fq_115:
s_and_b32 s54, s59, 1
s_lshl_b32 s54, s54, 1
s_sub_u32 s54, s53, s54
s_and_b32 s54, s54, 15
s_mul_i32 s54, s54, 393216
s_add_u32 s54, s54, s56
s_buffer_load_dwordx2 s[46:47], s[48:51], s54 offset:4096
s_buffer_load_dwordx2 s[46:47], s[48:51], s54 offset:10240
s_buffer_load_dwordx2 s[46:47], s[48:51], s54 offset:16384
s_buffer_load_dwordx2 s[46:47], s[48:51], s54 offset:22528
s_buffer_load_dwordx2 s[46:47], s[48:51], s54 offset:2048
s_buffer_load_dwordx2 s[46:47], s[48:51], s54 offset:8192
s_buffer_load_dwordx2 s[46:47], s[48:51], s54 offset:14336
s_buffer_load_dwordx2 s[46:47], s[48:51], s54 offset:20480
s_buffer_load_dwordx2 s[46:47], s[48:51], s54 offset:0
s_buffer_load_dwordx2 s[46:47], s[48:51], s54 offset:6144
s_buffer_load_dwordx2 s[46:47], s[48:51], s54 offset:12288
s_buffer_load_dwordx2 s[46:47], s[48:51], s54 offset:18432
s_add_u32 s54, s53, 1
s_and_b32 s54, s54, 15
s_mul_i32 s54, s54, 393216
s_add_u32 s54, s54, s56
s_buffer_load_dwordx2 s[46:47], s[48:51], s54 offset:4096
s_buffer_load_dwordx2 s[46:47], s[48:51], s54 offset:10240
s_buffer_load_dwordx2 s[46:47], s[48:51], s54 offset:16384
s_buffer_load_dwordx2 s[46:47], s[48:51], s54 offset:22528
s_buffer_load_dwordx2 s[46:47], s[48:51], s54 offset:2048
s_buffer_load_dwordx2 s[46:47], s[48:51], s54 offset:8192
s_buffer_load_dwordx2 s[46:47], s[48:51], s54 offset:14336
s_buffer_load_dwordx2 s[46:47], s[48:51], s54 offset:20480
s_buffer_load_dwordx2 s[46:47], s[48:51], s54 offset:0
s_buffer_load_dwordx2 s[46:47], s[48:51], s54 offset:6144
s_buffer_load_dwordx2 s[46:47], s[48:51], s54 offset:12288
s_buffer_load_dwordx2 s[46:47], s[48:51], s54 offset:18432
s_add_u32 s54, s53, 3
s_and_b32 s54, s54, 15
s_mul_i32 s54, s54, 393216
s_add_u32 s54, s54, s56
s_buffer_load_dwordx2 s[46:47], s[48:51], s54 offset:4096
s_buffer_load_dwordx2 s[46:47], s[48:51], s54 offset:10240
s_buffer_load_dwordx2 s[46:47], s[48:51], s54 offset:16384
s_buffer_load_dwordx2 s[46:47], s[48:51], s54 offset:22528
s_buffer_load_dwordx2 s[46:47], s[48:51], s54 offset:2048
s_buffer_load_dwordx2 s[46:47], s[48:51], s54 offset:8192
s_buffer_load_dwordx2 s[46:47], s[48:51], s54 offset:14336
s_buffer_load_dwordx2 s[46:47], s[48:51], s54 offset:20480
s_buffer_load_dwordx2 s[46:47], s[48:51], s54 offset:0
s_buffer_load_dwordx2 s[46:47], s[48:51], s54 offset:6144
s_buffer_load_dwordx2 s[46:47], s[48:51], s54 offset:12288
s_buffer_load_dwordx2 s[46:47], s[48:51], s54 offset:18432
s_add_u32 s54, s53, 5
s_and_b32 s54, s54, 15
s_mul_i32 s54, s54, 393216
s_add_u32 s54, s54, s56
s_buffer_load_dwordx2 s[46:47], s[48:51], s54 offset:4096
s_buffer_load_dwordx2 s[46:47], s[48:51], s54 offset:10240
s_buffer_load_dwordx2 s[46:47], s[48:51], s54 offset:16384
s_buffer_load_dwordx2 s[46:47], s[48:51], s54 offset:22528
s_buffer_load_dwordx2 s[46:47], s[48:51], s54 offset:2048
s_buffer_load_dwordx2 s[46:47], s[48:51], s54 offset:8192
s_buffer_load_dwordx2 s[46:47], s[48:51], s54 offset:14336
s_buffer_load_dwordx2 s[46:47], s[48:51], s54 offset:20480
s_buffer_load_dwordx2 s[46:47], s[48:51], s54 offset:0
s_buffer_load_dwordx2 s[46:47], s[48:51], s54 offset:6144
s_buffer_load_dwordx2 s[46:47], s[48:51], s54 offset:12288
s_buffer_load_dwordx2 s[46:47], s[48:51], s54 offset:18432
s_waitcnt lgkmcnt(0)
s_branch fnw_56
fnd_65:
poll_116:
buffer_load_dwordx2 v[248:249], v6, s[24:27], s73 offen sc1
pchk_117:
s_waitcnt vmcnt(0)
v_min_u32 v5, v248, v249
v_cmp_eq_u32 vcc, 0, v5
s_cbranch_vccz pdone_118
s_sleep 1
s_sub_u32 s32, s32, 1
s_cmp_gt_i32 s32, 0
s_cbranch_scc1 poll_116
pdone_118:
v_mov_b32 v250, v248
s_nop 1
v_max_f32_dpp v250, v250, v250 row_ror:1 row_mask:0xf bank_mask:0xf
s_nop 1
v_max_f32_dpp v250, v250, v250 row_ror:2 row_mask:0xf bank_mask:0xf
s_nop 1
v_max_f32_dpp v250, v250, v250 row_ror:4 row_mask:0xf bank_mask:0xf
s_nop 1
v_max_f32_dpp v250, v250, v250 row_ror:8 row_mask:0xf bank_mask:0xf
v_cmp_eq_f32 vcc, v250, v248
s_ff1_i32_b64 s68, vcc
s_and_b32 s68, s68, 15
v_readlane_b32 s33, v249, s68
v_readlane_b32 s67, v248, s68
v_add_u32 v5, s34, 4
v_mov_b32 v250, s33
s_mov_b64 exec, 1
ds_write2_b32 v3, v5, v250 offset1:2
s_mov_b64 exec, -1
s_sub_u32 s33, s33, 1
s_and_b32 s33, s33, 2047
s_branch fnd_64
fpre_85:
poll_119:
buffer_load_dwordx4 v[24:27], v4, s[24:27], s72 offen offset:0 sc1
pchk_120:
s_waitcnt vmcnt(0)
v_min3_u32 v5, v24, v25, v26
v_min_u32 v5, v5, v27
v_cmp_eq_u32 vcc, 0, v5
s_cbranch_vccz pdone_121
s_sleep 8
s_sub_u32 s32, s32, 1
s_cmp_gt_i32 s32, 0
s_cbranch_scc1 poll_119
pdone_121:
s_branch fpre_86
L_m:
s_setprio 2
v_mov_b32 v6, 0
v_mov_b32 v7, 0
v_lshlrev_b32 v8, 3, v0
ds_write_b64 v8, v[6:7]
s_waitcnt lgkmcnt(0)
s_barrier
s_lshr_b32 s64, s58, 1
s_and_b32 s65, s58, 1
v_and_b32 v1, 3, v0
v_lshlrev_b32 v1, 2, v1
v_and_b32 v2, 4, v1
s_lshl2_add_u32 s35, s58, 0
v_mov_b32 v3, s35
s_mov_b32 s4, s44
s_mov_b32 s5, s45
s_mov_b32 s6, 0x800
s_mov_b32 s7, 0x00020000
v_lshrrev_b32 v6, 4, v0
v_lshlrev_b32 v6, 3, v6
s_lshl_b32 s66, s62, 7
buffer_load_dwordx2 v[232:233], v6, s[4:7], s66 offen offset:0
buffer_load_dwordx2 v[234:235], v6, s[4:7], s66 offen offset:32
buffer_load_dwordx2 v[236:237], v6, s[4:7], s66 offen offset:64
buffer_load_dwordx2 v[238:239], v6, s[4:7], s66 offen offset:96
v_and_b32 v6, 31, v0
v_lshrrev_b32 v7, 5, v0
v_lshlrev_b32 v7, 3, v7
v_sub_u32 v6, v6, v7
v_mov_b32 v7, 0xf149f2ca
v_cmp_le_i32 vcc, 0, v6
s_nop 1
v_cndmask_b32 v216, 0, v7, vcc
v_cmp_le_i32 vcc, 1, v6
s_nop 1
v_cndmask_b32 v217, 0, v7, vcc
v_cmp_le_i32 vcc, 2, v6
s_nop 1
v_cndmask_b32 v218, 0, v7, vcc
v_cmp_le_i32 vcc, 3, v6
s_nop 1
v_cndmask_b32 v219, 0, v7, vcc
v_cmp_le_i32 vcc, 16, v6
s_nop 1
v_cndmask_b32 v220, 0, v7, vcc
v_cmp_le_i32 vcc, 17, v6
s_nop 1
v_cndmask_b32 v221, 0, v7, vcc
v_cmp_le_i32 vcc, 18, v6
s_nop 1
v_cndmask_b32 v222, 0, v7, vcc
v_cmp_le_i32 vcc, 19, v6
s_nop 1
v_cndmask_b32 v223, 0, v7, vcc
v_cmp_le_i32 vcc, 4, v6
s_nop 1
v_cndmask_b32 v224, 0, v7, vcc
v_cmp_le_i32 vcc, 5, v6
s_nop 1
v_cndmask_b32 v225, 0, v7, vcc
v_cmp_le_i32 vcc, 6, v6
s_nop 1
v_cndmask_b32 v226, 0, v7, vcc
v_cmp_le_i32 vcc, 7, v6
s_nop 1
v_cndmask_b32 v227, 0, v7, vcc
v_cmp_le_i32 vcc, 20, v6
s_nop 1
v_cndmask_b32 v228, 0, v7, vcc
v_cmp_le_i32 vcc, 21, v6
s_nop 1
v_cndmask_b32 v229, 0, v7, vcc
v_cmp_le_i32 vcc, 22, v6
s_nop 1
v_cndmask_b32 v230, 0, v7, vcc
v_cmp_le_i32 vcc, 23, v6
s_nop 1
v_cndmask_b32 v231, 0, v7, vcc
v_lshrrev_b32 v6, 2, v0
v_xor_b32 v6, v6, v0
v_and_b32 v6, 4, v6
v_mov_b32 v7, 0x3f803f80
v_cmp_eq_u32 vcc, 0, v6
s_nop 1
v_cndmask_b32 v212, 0, v7, vcc
v_cndmask_b32 v213, 0, v7, vcc
v_cndmask_b32 v214, 0, v7, vcc
v_cndmask_b32 v215, 0, v7, vcc
v_lshrrev_b32 v196, 4, v0
s_cmp_eq_u32 0, 0
s_cbranch_scc0 mq_122
v_bfe_u32 v197, v0, 1, 3
v_xor_b32 v197, v197, v196
v_lshlrev_b32 v197, 4, v197
v_and_b32 v198, 15, v0
v_lshl_add_u32 v192, v198, 7, v197
v_xor_b32 v193, 64, v192
s_branch mq_123
mq_122:
v_lshlrev_b32 v192, 4, v0
v_add_u32 v193, 1024, v192
mq_123:
s_lshl_b32 s46, s65, 13
s_add_u32 s46, s46, 86016
v_add_u32 v192, s46, v192
v_add_u32 v193, s46, v193
v_bfe_u32 v197, v0, 2, 2
v_lshl_add_u32 v197, v196, 3, v197
v_bfe_u32 v198, v0, 3, 2
s_lshl_b32 s46, s64, 1
v_xor_b32 v198, s46, v198
v_lshlrev_b32 v198, 5, v198
v_lshl_add_u32 v197, v197, 7, v198
v_and_b32 v198, 3, v0
v_lshl_add_u32 v197, v198, 3, v197
v_add_u32 v194, 102400, v197
v_xor_b32 v195, 32, v194
v_mov_b32 v197, 0xf149f2ca
v_xor_b32 v216, v197, v216
v_xor_b32 v217, v197, v217
v_xor_b32 v218, v197, v218
v_xor_b32 v219, v197, v219
v_xor_b32 v220, v197, v220
v_xor_b32 v221, v197, v221
v_xor_b32 v222, v197, v222
v_xor_b32 v223, v197, v223
v_xor_b32 v224, v197, v224
v_xor_b32 v225, v197, v225
v_xor_b32 v226, v197, v226
v_xor_b32 v227, v197, v227
v_xor_b32 v228, v197, v228
v_xor_b32 v229, v197, v229
v_xor_b32 v230, v197, v230
v_xor_b32 v231, v197, v231
v_and_b32 v196, 15, v0
v_lshrrev_b32 v197, 4, v0
s_lshl_b32 s46, s65, 8
s_add_u32 s46, s46, 1280
s_mul_i32 s47, s64, 384
v_lshl_add_u32 v208, v196, 2, s46
v_lshl_add_u32 v209, v197, 4, s46
v_lshl_add_u32 v210, v196, 2, s47
v_lshl_add_u32 v211, v197, 4, s47
v_and_b32 v198, 1, v197
v_lshrrev_b32 v197, 1, v197
v_lshlrev_b32 v197, 9, v197
v_lshl_add_u32 v197, v198, 10, v197
s_lshl_b32 s46, s64, 12
s_lshl_b32 s47, s65, 13
s_add_u32 s46, s46, 131072
s_add_u32 s48, s46, 24576
s_sub_u32 s48, s48, s47
s_add_u32 s47, s46, s47
v_lshl_add_u32 v200, v196, 4, v197
v_and_b32 v198, 3, v0
v_lshl_add_u32 v197, v198, 4, v197
v_bfe_u32 v198, v0, 3, 1
v_lshl_add_u32 v197, v198, 6, v197
v_bfe_u32 v198, v0, 2, 1
v_lshl_add_u32 v198, v198, 8, v197
v_add_u32 v199, s48, v198
v_add_u32 v198, s47, v198
v_add_u32 v201, s48, v200
v_add_u32 v200, s47, v200
s_lshl_b32 s46, s59, 4
s_add_u32 s46, s46, s60
s_lshl_b32 s50, s59, 7
s_add_u32 s50, s50, s60
s_lshl_b32 s50, s50, 7
s_lshl_b32 s46, s46, 15
s_lshl_b32 s47, 0, 23
s_add_u32 s46, s46, s47
s_add_u32 s49, s46, 917504
L_mtop:
v_mov_b32 v6, v192
v_mov_b32 v7, v193
v_mov_b32 v8, v194
v_mov_b32 v9, v195
v_mov_b32 v12, v198
v_mov_b32 v13, v199
v_mov_b32 v14, v200
v_mov_b32 v15, v201
s_mov_b32 s71, s49
s_mov_b32 s72, s50
v_add_u32 v4, s34, 1
s_mov_b32 s66, 14
s_mov_b32 s67, -40960
s_mov_b32 s68, -40960
s_mov_b32 s69, 81920
s_add_u32 s35, s34, 1
lw_124:
ds_read_b32 v5, v2 offset:16
s_waitcnt lgkmcnt(0)
v_cmp_gt_i32 vcc, s35, v5
s_cbranch_vccz lwd_125
s_sub_u32 s32, s32, 1
s_cmp_gt_i32 s32, 0
s_cbranch_scc1 lw_124
lwd_125:
ds_read_b64_tr_b16 v[144:145], v8 offset:8192
ds_read_b64_tr_b16 v[146:147], v8 offset:8704
ds_read_b64_tr_b16 v[148:149], v8 offset:12288
ds_read_b64_tr_b16 v[150:151], v8 offset:12800
ds_read_b128 v[112:115], v6 offset:0
ds_read_b128 v[116:119], v7 offset:0
ds_read_b64_tr_b16 v[152:153], v9 offset:8192
ds_read_b64_tr_b16 v[154:155], v9 offset:8704
ds_read_b64_tr_b16 v[156:157], v9 offset:12288
ds_read_b64_tr_b16 v[158:159], v9 offset:12800
ds_read_b128 v[120:123], v6 offset:2048
ds_read_b128 v[124:127], v7 offset:2048
ds_read_b128 v[128:131], v6 offset:4096
ds_read_b128 v[132:135], v7 offset:4096
ds_read_b128 v[136:139], v6 offset:6144
ds_read_b128 v[140:143], v7 offset:6144
s_waitcnt lgkmcnt(11)
v_mfma_f32_16x16x32_bf16 v[16:19], v[144:147], v[112:115], 0
ds_read_b64_tr_b16 v[160:161], v8 offset:16384
s_waitcnt lgkmcnt(11)
v_mfma_f32_16x16x32_bf16 v[16:19], v[148:151], v[116:119], v[16:19]
ds_read_b64_tr_b16 v[162:163], v8 offset:16896
s_waitcnt lgkmcnt(10)
v_mfma_f32_16x16x32_bf16 v[20:23], v[152:155], v[112:115], 0
ds_read_b64_tr_b16 v[164:165], v8 offset:20480
s_waitcnt lgkmcnt(9)
v_mfma_f32_16x16x32_bf16 v[20:23], v[156:159], v[116:119], v[20:23]
ds_read_b64_tr_b16 v[166:167], v8 offset:20992
s_waitcnt lgkmcnt(9)
v_mfma_f32_16x16x32_bf16 v[24:27], v[144:147], v[120:123], 0
ds_read_b64_tr_b16 v[168:169], v9 offset:16384
s_waitcnt lgkmcnt(9)
v_mfma_f32_16x16x32_bf16 v[24:27], v[148:151], v[124:127], v[24:27]
ds_read_b64_tr_b16 v[170:171], v9 offset:16896
v_mfma_f32_16x16x32_bf16 v[28:31], v[152:155], v[120:123], 0
ds_read_b64_tr_b16 v[172:173], v9 offset:20480
v_mfma_f32_16x16x32_bf16 v[28:31], v[156:159], v[124:127], v[28:31]
ds_read_b64_tr_b16 v[174:175], v9 offset:20992
s_waitcnt lgkmcnt(11)
v_mfma_f32_16x16x32_bf16 v[32:35], v[144:147], v[128:131], 0
ds_read_b64_tr_b16 v[176:177], v8 offset:0
s_waitcnt lgkmcnt(11)
v_mfma_f32_16x16x32_bf16 v[32:35], v[148:151], v[132:135], v[32:35]
ds_read_b64_tr_b16 v[178:179], v8 offset:512
v_mfma_f32_16x16x32_bf16 v[36:39], v[152:155], v[128:131], 0
ds_read_b64_tr_b16 v[180:181], v8 offset:4096
v_mfma_f32_16x16x32_bf16 v[36:39], v[156:159], v[132:135], v[36:39]
ds_read_b64_tr_b16 v[182:183], v8 offset:4608
s_waitcnt lgkmcnt(13)
v_mfma_f32_16x16x32_bf16 v[40:43], v[144:147], v[136:139], 0
ds_read_b64_tr_b16 v[184:185], v9 offset:0
s_waitcnt lgkmcnt(13)
v_mfma_f32_16x16x32_bf16 v[40:43], v[148:151], v[140:143], v[40:43]
ds_read_b64_tr_b16 v[186:187], v9 offset:512
v_mfma_f32_16x16x32_bf16 v[44:47], v[152:155], v[136:139], 0
ds_read_b64_tr_b16 v[188:189], v9 offset:4096
v_mfma_f32_16x16x32_bf16 v[44:47], v[156:159], v[140:143], v[44:47]
ds_read_b64_tr_b16 v[190:191], v9 offset:4608
s_waitcnt lgkmcnt(14)
v_mfma_f32_16x16x32_bf16 v[48:51], v[112:115], v[160:163], 0
s_mov_b64 exec, 1
ds_write_b32 v3, v4
s_mov_b64 exec, -1
s_waitcnt lgkmcnt(13)
v_mfma_f32_16x16x32_bf16 v[48:51], v[116:119], v[164:167], v[48:51]
v_add_u32 v8, s67, v8
v_add_u32 v9, s67, v9
s_waitcnt lgkmcnt(11)
v_mfma_f32_16x16x32_bf16 v[52:55], v[112:115], v[168:171], 0
v_add_u32 v6, s67, v6
v_add_u32 v7, s67, v7
s_waitcnt lgkmcnt(9)
v_mfma_f32_16x16x32_bf16 v[52:55], v[116:119], v[172:175], v[52:55]
s_mov_b32 s70, s67
s_mov_b32 s67, s68
s_mov_b32 s68, s69
s_mov_b32 s69, s70
v_mfma_f32_16x16x32_bf16 v[56:59], v[120:123], v[160:163], 0
ds_read_b32 v5, v2 offset:16
v_mfma_f32_16x16x32_bf16 v[56:59], v[124:127], v[164:167], v[56:59]
v_mfma_f32_16x16x32_bf16 v[60:63], v[120:123], v[168:171], 0
v_mfma_f32_16x16x32_bf16 v[60:63], v[124:127], v[172:175], v[60:63]
v_mfma_f32_16x16x32_bf16 v[64:67], v[128:131], v[160:163], 0
s_waitcnt lgkmcnt(0)
v_cmp_ge_u32 vcc, v4, v5
s_cbranch_vccnz mspin_129
mback_130:
v_add_u32 v4, 1, v4
v_mfma_f32_16x16x32_bf16 v[64:67], v[132:135], v[164:167], v[64:67]
ds_read_b64_tr_b16 v[144:145], v8 offset:8192
v_mfma_f32_16x16x32_bf16 v[68:71], v[128:131], v[168:171], 0
ds_read_b64_tr_b16 v[146:147], v8 offset:8704
v_mfma_f32_16x16x32_bf16 v[68:71], v[132:135], v[172:175], v[68:71]
ds_read_b64_tr_b16 v[148:149], v8 offset:12288
v_mfma_f32_16x16x32_bf16 v[72:75], v[136:139], v[160:163], 0
ds_read_b64_tr_b16 v[150:151], v8 offset:12800
v_mfma_f32_16x16x32_bf16 v[72:75], v[140:143], v[164:167], v[72:75]
ds_read_b64_tr_b16 v[152:153], v9 offset:8192
v_mfma_f32_16x16x32_bf16 v[76:79], v[136:139], v[168:171], 0
ds_read_b64_tr_b16 v[154:155], v9 offset:8704
v_mfma_f32_16x16x32_bf16 v[76:79], v[140:143], v[172:175], v[76:79]
ds_read_b64_tr_b16 v[156:157], v9 offset:12288
v_mfma_f32_16x16x32_bf16 v[80:83], v[176:179], v[112:115], 0
ds_read_b64_tr_b16 v[158:159], v9 offset:12800
v_mfma_f32_16x16x32_bf16 v[80:83], v[180:183], v[116:119], v[80:83]
v_mfma_f32_16x16x32_bf16 v[84:87], v[184:187], v[112:115], 0
v_mfma_f32_16x16x32_bf16 v[84:87], v[188:191], v[116:119], v[84:87]
ds_read_b128 v[112:115], v6 offset:0
ds_read_b128 v[116:119], v7 offset:0
v_mfma_f32_16x16x32_bf16 v[88:91], v[176:179], v[120:123], 0
v_mfma_f32_16x16x32_bf16 v[88:91], v[180:183], v[124:127], v[88:91]
v_mfma_f32_16x16x32_bf16 v[92:95], v[184:187], v[120:123], 0
v_mfma_f32_16x16x32_bf16 v[92:95], v[188:191], v[124:127], v[92:95]
ds_read_b128 v[120:123], v6 offset:2048
ds_read_b128 v[124:127], v7 offset:2048
v_mfma_f32_16x16x32_bf16 v[96:99], v[176:179], v[128:131], 0
v_mfma_f32_16x16x32_bf16 v[96:99], v[180:183], v[132:135], v[96:99]
v_mfma_f32_16x16x32_bf16 v[100:103], v[184:187], v[128:131], 0
v_mfma_f32_16x16x32_bf16 v[100:103], v[188:191], v[132:135], v[100:103]
ds_read_b128 v[128:131], v6 offset:4096
ds_read_b128 v[132:135], v7 offset:4096
v_mfma_f32_16x16x32_bf16 v[104:107], v[176:179], v[136:139], 0
v_mfma_f32_16x16x32_bf16 v[104:107], v[180:183], v[140:143], v[104:107]
v_mfma_f32_16x16x32_bf16 v[108:111], v[184:187], v[136:139], 0
v_mfma_f32_16x16x32_bf16 v[108:111], v[188:191], v[140:143], v[108:111]
ds_read_b128 v[136:139], v6 offset:6144
ds_read_b128 v[140:143], v7 offset:6144
.p2align 6
mqkv_126:
s_waitcnt lgkmcnt(7)
v_mfma_f32_16x16x32_bf16 v[16:19], v[144:147], v[112:115], v[16:19]
ds_read_b64_tr_b16 v[160:161], v8 offset:16384
s_waitcnt lgkmcnt(7)
v_mfma_f32_16x16x32_bf16 v[16:19], v[148:151], v[116:119], v[16:19]
ds_read_b64_tr_b16 v[162:163], v8 offset:16896
v_mfma_f32_16x16x32_bf16 v[20:23], v[152:155], v[112:115], v[20:23]
ds_read_b64_tr_b16 v[164:165], v8 offset:20480
v_mfma_f32_16x16x32_bf16 v[20:23], v[156:159], v[116:119], v[20:23]
ds_read_b64_tr_b16 v[166:167], v8 offset:20992
s_waitcnt lgkmcnt(9)
v_mfma_f32_16x16x32_bf16 v[24:27], v[144:147], v[120:123], v[24:27]
ds_read_b64_tr_b16 v[168:169], v9 offset:16384
s_waitcnt lgkmcnt(9)
v_mfma_f32_16x16x32_bf16 v[24:27], v[148:151], v[124:127], v[24:27]
ds_read_b64_tr_b16 v[170:171], v9 offset:16896
v_mfma_f32_16x16x32_bf16 v[28:31], v[152:155], v[120:123], v[28:31]
ds_read_b64_tr_b16 v[172:173], v9 offset:20480
v_mfma_f32_16x16x32_bf16 v[28:31], v[156:159], v[124:127], v[28:31]
ds_read_b64_tr_b16 v[174:175], v9 offset:20992
s_waitcnt lgkmcnt(11)
v_mfma_f32_16x16x32_bf16 v[32:35], v[144:147], v[128:131], v[32:35]
ds_read_b64_tr_b16 v[176:177], v8 offset:0
s_waitcnt lgkmcnt(11)
v_mfma_f32_16x16x32_bf16 v[32:35], v[148:151], v[132:135], v[32:35]
ds_read_b64_tr_b16 v[178:179], v8 offset:512
v_mfma_f32_16x16x32_bf16 v[36:39], v[152:155], v[128:131], v[36:39]
ds_read_b64_tr_b16 v[180:181], v8 offset:4096
v_mfma_f32_16x16x32_bf16 v[36:39], v[156:159], v[132:135], v[36:39]
ds_read_b64_tr_b16 v[182:183], v8 offset:4608
s_waitcnt lgkmcnt(13)
v_mfma_f32_16x16x32_bf16 v[40:43], v[144:147], v[136:139], v[40:43]
ds_read_b64_tr_b16 v[184:185], v9 offset:0
s_waitcnt lgkmcnt(13)
v_mfma_f32_16x16x32_bf16 v[40:43], v[148:151], v[140:143], v[40:43]
ds_read_b64_tr_b16 v[186:187], v9 offset:512
v_mfma_f32_16x16x32_bf16 v[44:47], v[152:155], v[136:139], v[44:47]
ds_read_b64_tr_b16 v[188:189], v9 offset:4096
v_mfma_f32_16x16x32_bf16 v[44:47], v[156:159], v[140:143], v[44:47]
ds_read_b64_tr_b16 v[190:191], v9 offset:4608
s_waitcnt lgkmcnt(14)
v_mfma_f32_16x16x32_bf16 v[48:51], v[112:115], v[160:163], v[48:51]
s_mov_b64 exec, 1
ds_write_b32 v3, v4
s_mov_b64 exec, -1
s_waitcnt lgkmcnt(13)
v_mfma_f32_16x16x32_bf16 v[48:51], v[116:119], v[164:167], v[48:51]
v_add_u32 v8, s67, v8
v_add_u32 v9, s67, v9
s_waitcnt lgkmcnt(11)
v_mfma_f32_16x16x32_bf16 v[52:55], v[112:115], v[168:171], v[52:55]
v_add_u32 v6, s67, v6
v_add_u32 v7, s67, v7
s_waitcnt lgkmcnt(9)
v_mfma_f32_16x16x32_bf16 v[52:55], v[116:119], v[172:175], v[52:55]
s_mov_b32 s70, s67
s_mov_b32 s67, s68
s_mov_b32 s68, s69
s_mov_b32 s69, s70
v_mfma_f32_16x16x32_bf16 v[56:59], v[120:123], v[160:163], v[56:59]
ds_read_b32 v5, v2 offset:16
v_mfma_f32_16x16x32_bf16 v[56:59], v[124:127], v[164:167], v[56:59]
v_mfma_f32_16x16x32_bf16 v[60:63], v[120:123], v[168:171], v[60:63]
v_mfma_f32_16x16x32_bf16 v[60:63], v[124:127], v[172:175], v[60:63]
v_mfma_f32_16x16x32_bf16 v[64:67], v[128:131], v[160:163], v[64:67]
s_waitcnt lgkmcnt(0)
v_cmp_ge_u32 vcc, v4, v5
s_cbranch_vccnz mspin_127
mback_128:
v_add_u32 v4, 1, v4
v_mfma_f32_16x16x32_bf16 v[64:67], v[132:135], v[164:167], v[64:67]
ds_read_b64_tr_b16 v[144:145], v8 offset:8192
v_mfma_f32_16x16x32_bf16 v[68:71], v[128:131], v[168:171], v[68:71]
ds_read_b64_tr_b16 v[146:147], v8 offset:8704
v_mfma_f32_16x16x32_bf16 v[68:71], v[132:135], v[172:175], v[68:71]
ds_read_b64_tr_b16 v[148:149], v8 offset:12288
v_mfma_f32_16x16x32_bf16 v[72:75], v[136:139], v[160:163], v[72:75]
ds_read_b64_tr_b16 v[150:151], v8 offset:12800
v_mfma_f32_16x16x32_bf16 v[72:75], v[140:143], v[164:167], v[72:75]
ds_read_b64_tr_b16 v[152:153], v9 offset:8192
v_mfma_f32_16x16x32_bf16 v[76:79], v[136:139], v[168:171], v[76:79]
ds_read_b64_tr_b16 v[154:155], v9 offset:8704
v_mfma_f32_16x16x32_bf16 v[76:79], v[140:143], v[172:175], v[76:79]
ds_read_b64_tr_b16 v[156:157], v9 offset:12288
v_mfma_f32_16x16x32_bf16 v[80:83], v[176:179], v[112:115], v[80:83]
ds_read_b64_tr_b16 v[158:159], v9 offset:12800
v_mfma_f32_16x16x32_bf16 v[80:83], v[180:183], v[116:119], v[80:83]
v_mfma_f32_16x16x32_bf16 v[84:87], v[184:187], v[112:115], v[84:87]
v_mfma_f32_16x16x32_bf16 v[84:87], v[188:191], v[116:119], v[84:87]
ds_read_b128 v[112:115], v6 offset:0
ds_read_b128 v[116:119], v7 offset:0
v_mfma_f32_16x16x32_bf16 v[88:91], v[176:179], v[120:123], v[88:91]
v_mfma_f32_16x16x32_bf16 v[88:91], v[180:183], v[124:127], v[88:91]
v_mfma_f32_16x16x32_bf16 v[92:95], v[184:187], v[120:123], v[92:95]
v_mfma_f32_16x16x32_bf16 v[92:95], v[188:191], v[124:127], v[92:95]
ds_read_b128 v[120:123], v6 offset:2048
ds_read_b128 v[124:127], v7 offset:2048
v_mfma_f32_16x16x32_bf16 v[96:99], v[176:179], v[128:131], v[96:99]
v_mfma_f32_16x16x32_bf16 v[96:99], v[180:183], v[132:135], v[96:99]
v_mfma_f32_16x16x32_bf16 v[100:103], v[184:187], v[128:131], v[100:103]
v_mfma_f32_16x16x32_bf16 v[100:103], v[188:191], v[132:135], v[100:103]
ds_read_b128 v[128:131], v6 offset:4096
ds_read_b128 v[132:135], v7 offset:4096
v_mfma_f32_16x16x32_bf16 v[104:107], v[176:179], v[136:139], v[104:107]
v_mfma_f32_16x16x32_bf16 v[104:107], v[180:183], v[140:143], v[104:107]
s_sub_u32 s66, s66, 1
s_cmp_eq_u32 s66, 0
v_mfma_f32_16x16x32_bf16 v[108:111], v[184:187], v[136:139], v[108:111]
v_mfma_f32_16x16x32_bf16 v[108:111], v[188:191], v[140:143], v[108:111]
ds_read_b128 v[136:139], v6 offset:6144
ds_read_b128 v[140:143], v7 offset:6144
s_cbranch_scc0 mqkv_126
s_waitcnt lgkmcnt(7)
v_mfma_f32_16x16x32_bf16 v[16:19], v[144:147], v[112:115], v[16:19]
ds_read_b32 v5, v2 offset:24
s_add_u32 s35, s34, 2
v_mov_b32 v6, 0
ds_read_b64_tr_b16 v[160:161], v8 offset:16384
s_waitcnt lgkmcnt(8)
v_mfma_f32_16x16x32_bf16 v[16:19], v[148:151], v[116:119], v[16:19]
ds_read_b64_tr_b16 v[162:163], v8 offset:16896
v_mfma_f32_16x16x32_bf16 v[20:23], v[152:155], v[112:115], v[20:23]
ds_read_b64_tr_b16 v[164:165], v8 offset:20480
v_mfma_f32_16x16x32_bf16 v[20:23], v[156:159], v[116:119], v[20:23]
ds_read_b64_tr_b16 v[166:167], v8 offset:20992
s_waitcnt lgkmcnt(10)
v_mfma_f32_16x16x32_bf16 v[24:27], v[144:147], v[120:123], v[24:27]
ds_read_b64_tr_b16 v[168:169], v9 offset:16384
s_waitcnt lgkmcnt(10)
v_mfma_f32_16x16x32_bf16 v[24:27], v[148:151], v[124:127], v[24:27]
ds_read_b64_tr_b16 v[170:171], v9 offset:16896
v_mfma_f32_16x16x32_bf16 v[28:31], v[152:155], v[120:123], v[28:31]
ds_read_b64_tr_b16 v[172:173], v9 offset:20480
s_waitcnt lgkmcnt(7)
v_cmp_gt_i32 vcc, s35, v5
s_cbranch_vccnz lspin_131
lback_132:
ds_read2_b32 v[6:7], v6 offset0:8 offset1:14
ds_read_b128 v[200:203], v211 offset:2432
v_mfma_f32_16x16x32_bf16 v[28:31], v[156:159], v[124:127], v[28:31]
ds_read_b64_tr_b16 v[174:175], v9 offset:20992
ds_read_b128 v[204:207], v211 offset:2496
ds_read2_b32 v[192:193], v208 offset0:0 offset1:128
v_mfma_f32_16x16x32_bf16 v[32:35], v[144:147], v[128:131], v[32:35]
ds_read2_b32 v[194:195], v208 offset0:16 offset1:144
v_mfma_f32_16x16x32_bf16 v[32:35], v[148:151], v[132:135], v[32:35]
ds_read2_b32 v[196:197], v208 offset0:32 offset1:160
ds_read2_b32 v[198:199], v208 offset0:48 offset1:176
v_mfma_f32_16x16x32_bf16 v[36:39], v[152:155], v[128:131], v[36:39]
ds_read_b64_tr_b16 v[176:177], v8 offset:0
ds_read_b64_tr_b16 v[178:179], v8 offset:512
v_mfma_f32_16x16x32_bf16 v[36:39], v[156:159], v[132:135], v[36:39]
ds_read_b64_tr_b16 v[180:181], v8 offset:4096
v_mfma_f32_16x16x32_bf16 v[40:43], v[144:147], v[136:139], v[40:43]
ds_read_b64_tr_b16 v[182:183], v8 offset:4608
ds_read_b64_tr_b16 v[184:185], v9 offset:0
v_mfma_f32_16x16x32_bf16 v[40:43], v[148:151], v[140:143], v[40:43]
ds_read_b64_tr_b16 v[186:187], v9 offset:512
ds_read_b64_tr_b16 v[188:189], v9 offset:4096
v_mfma_f32_16x16x32_bf16 v[44:47], v[152:155], v[136:139], v[44:47]
ds_read_b64_tr_b16 v[190:191], v9 offset:4608
v_mfma_f32_16x16x32_bf16 v[44:47], v[156:159], v[140:143], v[44:47]
s_mov_b64 exec, 1
ds_write_b32 v3, v4
s_mov_b64 exec, -1
s_waitcnt lgkmcnt(14)
v_readfirstlane_b32 s33, v6
v_readfirstlane_b32 s57, v7
s_sub_u32 s33, s33, 1
s_lshr_b32 s66, s33, 7
s_mov_b32 s73, -1
v_mfma_f32_16x16x32_bf16 v[48:51], v[112:115], v[160:163], v[48:51]
s_cmp_eq_u32 s66, s59
s_cbranch_scc1 patch_133
pback_134:
v_mfma_f32_16x16x32_bf16 v[48:51], v[116:119], v[164:167], v[48:51]
ds_read_b32 v10, v210 offset:2560
ds_read_b32 v11, v210 offset:2624
s_waitcnt lgkmcnt(14)
v_mul_f32 v16, v16, v192
v_mul_f32 v17, v17, v192
v_mul_f32 v18, v18, v192
v_mfma_f32_16x16x32_bf16 v[52:55], v[112:115], v[168:171], v[52:55]
v_mul_f32 v19, v19, v192
v_mul_f32 v20, v20, v192
v_mul_f32 v21, v21, v192
v_mul_f32 v22, v22, v192
v_mul_f32 v23, v23, v192
v_mfma_f32_16x16x32_bf16 v[52:55], v[116:119], v[172:175], v[52:55]
v_fmac_f32 v16, v200, v193
v_fmac_f32 v17, v201, v193
v_fmac_f32 v18, v202, v193
v_fmac_f32 v19, v203, v193
v_fmac_f32 v20, v204, v193
v_mfma_f32_16x16x32_bf16 v[56:59], v[120:123], v[160:163], v[56:59]
v_fmac_f32 v21, v205, v193
v_fmac_f32 v22, v206, v193
v_fmac_f32 v23, v207, v193
v_cvt_pk_bf16_f32 v16, v16, v17
v_cvt_pk_bf16_f32 v17, v18, v19
v_mfma_f32_16x16x32_bf16 v[56:59], v[124:127], v[164:167], v[56:59]
v_cvt_pk_bf16_f32 v18, v20, v21
v_cvt_pk_bf16_f32 v19, v22, v23
buffer_store_dwordx4 v[16:19], v12, s[20:23], s71 offen offset:0 sc1
ds_write_b128 v12, v[16:19] offset:0
ds_read_b128 v[144:147], v209 offset:0
v_mfma_f32_16x16x32_bf16 v[60:63], v[120:123], v[168:171], v[60:63]
ds_read_b128 v[20:23], v209 offset:512
s_waitcnt lgkmcnt(14)
v_mul_f32 v24, v24, v194
v_mul_f32 v25, v25, v194
v_mul_f32 v26, v26, v194
v_mul_f32 v27, v27, v194
v_mfma_f32_16x16x32_bf16 v[60:63], v[124:127], v[172:175], v[60:63]
v_mul_f32 v28, v28, v194
v_mul_f32 v29, v29, v194
v_mul_f32 v30, v30, v194
v_mul_f32 v31, v31, v194
v_fmac_f32 v24, v200, v195
v_mfma_f32_16x16x32_bf16 v[64:67], v[128:131], v[160:163], v[64:67]
v_fmac_f32 v25, v201, v195
v_fmac_f32 v26, v202, v195
v_fmac_f32 v27, v203, v195
v_fmac_f32 v28, v204, v195
v_mfma_f32_16x16x32_bf16 v[64:67], v[132:135], v[164:167], v[64:67]
v_fmac_f32 v29, v205, v195
v_fmac_f32 v30, v206, v195
v_fmac_f32 v31, v207, v195
v_cvt_pk_bf16_f32 v24, v24, v25
v_cvt_pk_bf16_f32 v25, v26, v27
v_mfma_f32_16x16x32_bf16 v[68:71], v[128:131], v[168:171], v[68:71]
v_cvt_pk_bf16_f32 v26, v28, v29
v_cvt_pk_bf16_f32 v27, v30, v31
buffer_store_dwordx4 v[24:27], v12, s[20:23], s71 offen offset:128 sc1
ds_write_b128 v12, v[24:27] offset:128
ds_read_b128 v[148:151], v209 offset:64
v_mfma_f32_16x16x32_bf16 v[68:71], v[132:135], v[172:175], v[68:71]
ds_read_b128 v[28:31], v209 offset:576
v_mul_f32 v32, v32, v196
v_mul_f32 v33, v33, v196
v_mul_f32 v34, v34, v196
v_mul_f32 v35, v35, v196
v_mfma_f32_16x16x32_bf16 v[72:75], v[136:139], v[160:163], v[72:75]
v_mul_f32 v36, v36, v196
v_mul_f32 v37, v37, v196
v_mul_f32 v38, v38, v196
v_mul_f32 v39, v39, v196
v_fmac_f32 v32, v200, v197
v_mfma_f32_16x16x32_bf16 v[72:75], v[140:143], v[164:167], v[72:75]
v_fmac_f32 v33, v201, v197
v_fmac_f32 v34, v202, v197
v_fmac_f32 v35, v203, v197
v_fmac_f32 v36, v204, v197
v_fmac_f32 v37, v205, v197
v_mfma_f32_16x16x32_bf16 v[76:79], v[136:139], v[168:171], v[76:79]
v_fmac_f32 v38, v206, v197
v_fmac_f32 v39, v207, v197
v_cvt_pk_bf16_f32 v32, v32, v33
v_cvt_pk_bf16_f32 v33, v34, v35
v_cvt_pk_bf16_f32 v34, v36, v37
v_mfma_f32_16x16x32_bf16 v[76:79], v[140:143], v[172:175], v[76:79]
v_cvt_pk_bf16_f32 v35, v38, v39
buffer_store_dwordx4 v[32:35], v13, s[20:23], s71 offen offset:0 sc1
ds_write_b128 v13, v[32:35] offset:0
ds_read_b128 v[152:155], v209 offset:128
ds_read_b128 v[36:39], v209 offset:640
v_mul_f32 v40, v40, v198
v_mul_f32 v41, v41, v198
v_mul_f32 v42, v42, v198
v_mul_f32 v43, v43, v198
v_mul_f32 v44, v44, v198
v_mul_f32 v45, v45, v198
v_mul_f32 v46, v46, v198
v_mul_f32 v47, v47, v198
v_fmac_f32 v40, v200, v199
v_fmac_f32 v41, v201, v199
v_fmac_f32 v42, v202, v199
v_fmac_f32 v43, v203, v199
v_fmac_f32 v44, v204, v199
v_fmac_f32 v45, v205, v199
v_fmac_f32 v46, v206, v199
v_fmac_f32 v47, v207, v199
v_cvt_pk_bf16_f32 v40, v40, v41
v_cvt_pk_bf16_f32 v41, v42, v43
v_cvt_pk_bf16_f32 v42, v44, v45
v_cvt_pk_bf16_f32 v43, v46, v47
buffer_store_dwordx4 v[40:43], v13, s[20:23], s71 offen offset:128 sc1
ds_write_b128 v13, v[40:43] offset:128
ds_read_b128 v[156:159], v209 offset:192
ds_read_b128 v[44:47], v209 offset:704
s_cmp_ge_i32 s73, 0
s_cbranch_scc1 patch_135
pback_136:
ds_read_b128 v[160:163], v211 offset:2304
ds_read_b128 v[164:167], v211 offset:2368
s_waitcnt lgkmcnt(12)
v_pk_mul_f32 v[48:49], v[48:49], v[144:145]
v_pk_mul_f32 v[50:51], v[50:51], v[146:147]
s_waitcnt lgkmcnt(11)
v_pk_fma_f32 v[48:49], v[20:21], v[10:11], v[48:49] op_sel:[0,0,0] op_sel_hi:[1,0,1]
v_pk_fma_f32 v[50:51], v[22:23], v[10:11], v[50:51] op_sel:[0,0,0] op_sel_hi:[1,0,1]
s_waitcnt lgkmcnt(9)
v_pk_mul_f32 v[56:57], v[56:57], v[148:149]
v_pk_mul_f32 v[58:59], v[58:59], v[150:151]
s_waitcnt lgkmcnt(8)
v_pk_fma_f32 v[56:57], v[28:29], v[10:11], v[56:57] op_sel:[0,0,0] op_sel_hi:[1,0,1]
v_pk_fma_f32 v[58:59], v[30:31], v[10:11], v[58:59] op_sel:[0,0,0] op_sel_hi:[1,0,1]
v_cvt_pk_bf16_f32 v48, v48, v49
v_cvt_pk_bf16_f32 v49, v50, v51
v_cvt_pk_bf16_f32 v50, v56, v57
v_cvt_pk_bf16_f32 v51, v58, v59
buffer_store_dwordx4 v[48:51], v14, s[20:23], s71 offen offset:2048 sc1
ds_write_b128 v14, v[48:51] offset:2048
v_pk_mul_f32 v[52:53], v[52:53], v[144:145]
v_pk_mul_f32 v[54:55], v[54:55], v[146:147]
v_pk_fma_f32 v[52:53], v[20:21], v[10:11], v[52:53] op_sel:[0,1,0] op_sel_hi:[1,1,1]
v_pk_fma_f32 v[54:55], v[22:23], v[10:11], v[54:55] op_sel:[0,1,0] op_sel_hi:[1,1,1]
v_pk_mul_f32 v[60:61], v[60:61], v[148:149]
v_pk_mul_f32 v[62:63], v[62:63], v[150:151]
v_pk_fma_f32 v[60:61], v[28:29], v[10:11], v[60:61] op_sel:[0,1,0] op_sel_hi:[1,1,1]
v_pk_fma_f32 v[62:63], v[30:31], v[10:11], v[62:63] op_sel:[0,1,0] op_sel_hi:[1,1,1]
v_cvt_pk_bf16_f32 v52, v52, v53
v_cvt_pk_bf16_f32 v53, v54, v55
v_cvt_pk_bf16_f32 v54, v60, v61
v_cvt_pk_bf16_f32 v55, v62, v63
buffer_store_dwordx4 v[52:55], v14, s[20:23], s71 offen offset:2304 sc1
ds_write_b128 v14, v[52:55] offset:2304
s_waitcnt lgkmcnt(8)
v_pk_mul_f32 v[64:65], v[64:65], v[152:153]
v_pk_mul_f32 v[66:67], v[66:67], v[154:155]
s_waitcnt lgkmcnt(7)
v_pk_fma_f32 v[64:65], v[36:37], v[10:11], v[64:65] op_sel:[0,0,0] op_sel_hi:[1,0,1]
v_pk_fma_f32 v[66:67], v[38:39], v[10:11], v[66:67] op_sel:[0,0,0] op_sel_hi:[1,0,1]
s_waitcnt lgkmcnt(5)
v_pk_mul_f32 v[72:73], v[72:73], v[156:157]
v_pk_mul_f32 v[74:75], v[74:75], v[158:159]
s_waitcnt lgkmcnt(4)
v_pk_fma_f32 v[72:73], v[44:45], v[10:11], v[72:73] op_sel:[0,0,0] op_sel_hi:[1,0,1]
v_pk_fma_f32 v[74:75], v[46:47], v[10:11], v[74:75] op_sel:[0,0,0] op_sel_hi:[1,0,1]
v_cvt_pk_bf16_f32 v64, v64, v65
v_cvt_pk_bf16_f32 v65, v66, v67
v_cvt_pk_bf16_f32 v66, v72, v73
v_cvt_pk_bf16_f32 v67, v74, v75
buffer_store_dwordx4 v[64:67], v15, s[20:23], s71 offen offset:2048 sc1
ds_write_b128 v15, v[64:67] offset:2048
v_pk_mul_f32 v[68:69], v[68:69], v[152:153]
v_pk_mul_f32 v[70:71], v[70:71], v[154:155]
v_pk_fma_f32 v[68:69], v[36:37], v[10:11], v[68:69] op_sel:[0,1,0] op_sel_hi:[1,1,1]
v_pk_fma_f32 v[70:71], v[38:39], v[10:11], v[70:71] op_sel:[0,1,0] op_sel_hi:[1,1,1]
v_pk_mul_f32 v[76:77], v[76:77], v[156:157]
v_pk_mul_f32 v[78:79], v[78:79], v[158:159]
v_pk_fma_f32 v[76:77], v[44:45], v[10:11], v[76:77] op_sel:[0,1,0] op_sel_hi:[1,1,1]
v_pk_fma_f32 v[78:79], v[46:47], v[10:11], v[78:79] op_sel:[0,1,0] op_sel_hi:[1,1,1]
v_cvt_pk_bf16_f32 v68, v68, v69
v_cvt_pk_bf16_f32 v69, v70, v71
v_cvt_pk_bf16_f32 v70, v76, v77
v_cvt_pk_bf16_f32 v71, v78, v79
buffer_store_dwordx4 v[68:71], v15, s[20:23], s71 offen offset:2304 sc1
ds_write_b128 v15, v[68:71] offset:2304
v_add_u32 v5, s34, 17
s_mov_b64 exec, 1
ds_write_b32 v3, v5
s_mov_b64 exec, -1
s_mov_b32 s66, 0x3e8293ee
v_mfma_f32_16x16x32_bf16 v[96:99], v[176:179], v[128:131], v[96:99]
v_mul_f32 v192, s66, v192
v_mfma_f32_16x16x32_bf16 v[96:99], v[180:183], v[132:135], v[96:99]
v_mfma_f32_16x16x32_bf16 v[100:103], v[184:187], v[128:131], v[100:103]
v_mul_f32 v193, s66, v193
v_mfma_f32_16x16x32_bf16 v[100:103], v[188:191], v[132:135], v[100:103]
v_mfma_f32_16x16x32_bf16 v[104:107], v[176:179], v[136:139], v[104:107]
v_mul_f32 v194, s66, v194
v_mfma_f32_16x16x32_bf16 v[104:107], v[180:183], v[140:143], v[104:107]
v_mfma_f32_16x16x32_bf16 v[108:111], v[184:187], v[136:139], v[108:111]
v_mul_f32 v195, s66, v195
v_mfma_f32_16x16x32_bf16 v[108:111], v[188:191], v[140:143], v[108:111]
v_mfma_f32_16x16x32_bf16 v[80:83], v[176:179], v[112:115], v[80:83]
v_mul_f32 v196, s66, v196
v_mfma_f32_16x16x32_bf16 v[80:83], v[180:183], v[116:119], v[80:83]
v_mfma_f32_16x16x32_bf16 v[84:87], v[184:187], v[112:115], v[84:87]
v_mul_f32 v197, s66, v197
v_mfma_f32_16x16x32_bf16 v[84:87], v[188:191], v[116:119], v[84:87]
v_mfma_f32_16x16x32_bf16 v[88:91], v[176:179], v[120:123], v[88:91]
v_mul_f32 v198, s66, v198
v_mfma_f32_16x16x32_bf16 v[88:91], v[180:183], v[124:127], v[88:91]
v_mfma_f32_16x16x32_bf16 v[92:95], v[184:187], v[120:123], v[92:95]
v_mul_f32 v199, s66, v199
v_mfma_f32_16x16x32_bf16 v[92:95], v[188:191], v[124:127], v[92:95]
s_cmp_ge_i32 s73, 0
s_cbranch_scc1 patch_137
pback_138:
v_mov_b32 v200, 0
v_mov_b32 v201, 0
v_mov_b32 v202, 0
v_mov_b32 v203, 0
v_mov_b32 v204, 0
v_mov_b32 v205, 0
v_mov_b32 v206, 0
v_mov_b32 v207, 0
v_mov_b32 v208, 0
v_mov_b32 v209, 0
v_mov_b32 v210, 0
v_mov_b32 v211, 0
v_pk_mul_f32 v[96:97], v[96:97], v[196:197] op_sel:[0,0] op_sel_hi:[1,0]
v_pk_mul_f32 v[98:99], v[98:99], v[196:197] op_sel:[0,0] op_sel_hi:[1,0]
v_pk_mul_f32 v[100:101], v[100:101], v[196:197] op_sel:[0,0] op_sel_hi:[1,0]
v_pk_mul_f32 v[102:103], v[102:103], v[196:197] op_sel:[0,0] op_sel_hi:[1,0]
s_waitcnt lgkmcnt(6)
v_pk_fma_f32 v[96:97], v[160:161], v[196:197], v[96:97] op_sel:[0,1,0] op_sel_hi:[1,1,1]
v_pk_fma_f32 v[98:99], v[162:163], v[196:197], v[98:99] op_sel:[0,1,0] op_sel_hi:[1,1,1]
s_waitcnt lgkmcnt(5)
v_pk_fma_f32 v[100:101], v[164:165], v[196:197], v[100:101] op_sel:[0,1,0] op_sel_hi:[1,1,1]
v_pk_fma_f32 v[102:103], v[166:167], v[196:197], v[102:103] op_sel:[0,1,0] op_sel_hi:[1,1,1]
v_cvt_pk_bf16_f32 v96, v96, v97
v_cvt_pk_bf16_f32 v97, v98, v99
v_cvt_pk_bf16_f32 v98, v100, v101
v_cvt_pk_bf16_f32 v99, v102, v103
v_pk_mul_f32 v[104:105], v[104:105], v[198:199] op_sel:[0,0] op_sel_hi:[1,0]
v_pk_mul_f32 v[106:107], v[106:107], v[198:199] op_sel:[0,0] op_sel_hi:[1,0]
v_pk_mul_f32 v[108:109], v[108:109], v[198:199] op_sel:[0,0] op_sel_hi:[1,0]
v_pk_mul_f32 v[110:111], v[110:111], v[198:199] op_sel:[0,0] op_sel_hi:[1,0]
v_pk_fma_f32 v[104:105], v[160:161], v[198:199], v[104:105] op_sel:[0,1,0] op_sel_hi:[1,1,1]
v_pk_fma_f32 v[106:107], v[162:163], v[198:199], v[106:107] op_sel:[0,1,0] op_sel_hi:[1,1,1]
v_pk_fma_f32 v[108:109], v[164:165], v[198:199], v[108:109] op_sel:[0,1,0] op_sel_hi:[1,1,1]
v_pk_fma_f32 v[110:111], v[166:167], v[198:199], v[110:111] op_sel:[0,1,0] op_sel_hi:[1,1,1]
v_cvt_pk_bf16_f32 v104, v104, v105
v_cvt_pk_bf16_f32 v105, v106, v107
v_cvt_pk_bf16_f32 v106, v108, v109
v_cvt_pk_bf16_f32 v107, v110, v111
v_pk_mul_f32 v[80:81], v[80:81], v[192:193] op_sel:[0,0] op_sel_hi:[1,0]
v_pk_mul_f32 v[82:83], v[82:83], v[192:193] op_sel:[0,0] op_sel_hi:[1,0]
v_pk_mul_f32 v[84:85], v[84:85], v[192:193] op_sel:[0,0] op_sel_hi:[1,0]
v_pk_mul_f32 v[86:87], v[86:87], v[192:193] op_sel:[0,0] op_sel_hi:[1,0]
v_pk_fma_f32 v[80:81], v[160:161], v[192:193], v[80:81] op_sel:[0,1,0] op_sel_hi:[1,1,1]
v_pk_fma_f32 v[82:83], v[162:163], v[192:193], v[82:83] op_sel:[0,1,0] op_sel_hi:[1,1,1]
v_pk_fma_f32 v[84:85], v[164:165], v[192:193], v[84:85] op_sel:[0,1,0] op_sel_hi:[1,1,1]
v_pk_fma_f32 v[86:87], v[166:167], v[192:193], v[86:87] op_sel:[0,1,0] op_sel_hi:[1,1,1]
v_cvt_pk_bf16_f32 v80, v80, v81
v_cvt_pk_bf16_f32 v81, v82, v83
v_cvt_pk_bf16_f32 v82, v84, v85
v_cvt_pk_bf16_f32 v83, v86, v87
v_pk_mul_f32 v[88:89], v[88:89], v[194:195] op_sel:[0,0] op_sel_hi:[1,0]
v_pk_mul_f32 v[90:91], v[90:91], v[194:195] op_sel:[0,0] op_sel_hi:[1,0]
v_pk_mul_f32 v[92:93], v[92:93], v[194:195] op_sel:[0,0] op_sel_hi:[1,0]
v_pk_mul_f32 v[94:95], v[94:95], v[194:195] op_sel:[0,0] op_sel_hi:[1,0]
v_pk_fma_f32 v[88:89], v[160:161], v[194:195], v[88:89] op_sel:[0,1,0] op_sel_hi:[1,1,1]
v_pk_fma_f32 v[90:91], v[162:163], v[194:195], v[90:91] op_sel:[0,1,0] op_sel_hi:[1,1,1]
v_pk_fma_f32 v[92:93], v[164:165], v[194:195], v[92:93] op_sel:[0,1,0] op_sel_hi:[1,1,1]
v_pk_fma_f32 v[94:95], v[166:167], v[194:195], v[94:95] op_sel:[0,1,0] op_sel_hi:[1,1,1]
v_cvt_pk_bf16_f32 v88, v88, v89
v_cvt_pk_bf16_f32 v89, v90, v91
v_cvt_pk_bf16_f32 v90, v92, v93
v_cvt_pk_bf16_f32 v91, v94, v95
v_permlane16_swap_b32 v96, v104
v_permlane16_swap_b32 v97, v105
v_permlane16_swap_b32 v98, v106
v_permlane16_swap_b32 v99, v107
v_permlane16_swap_b32 v80, v88
v_permlane16_swap_b32 v81, v89
v_permlane16_swap_b32 v82, v90
v_permlane16_swap_b32 v83, v91
v_mov_b32 v192, 0
v_mov_b32 v193, 0
v_mov_b32 v194, 0
v_mov_b32 v195, 0
v_mov_b32 v196, 0
v_mov_b32 v197, 0
v_mov_b32 v198, 0
v_mov_b32 v199, 0
s_lshl_b32 s69, s64, 12
v_lshl_add_u32 v6, v0, 4, s69
v_add_u32 v7, 131072, v6
s_lshl_b32 s69, s65, 13
s_add_u32 s66, s69, 131072
s_sub_u32 s69, 147456, s69
v_add_u32 v8, s69, v6
ds_read_b128 v[152:155], v8 offset:8192
ds_read_b128 v[156:159], v8 offset:9216
s_mov_b32 s67, 122880
s_min_u32 s69, s59, 1
s_lshl2_add_u32 s68, s69, s65
s_cmp_ge_u32 s59, 2
s_cselect_b32 s69, s65, 0
s_add_u32 s68, s68, s69
ds_read_b128 v[160:163], v8 offset:10240
ds_read_b128 v[164:167], v8 offset:11264
s_waitcnt lgkmcnt(3)
v_mfma_f32_32x32x16_bf16 v[112:127], v[152:155], v[96:99], v[216:231]
s_waitcnt lgkmcnt(2)
v_mfma_f32_32x32x16_bf16 v[112:127], v[156:159], v[104:107], v[112:127]
s_add_u32 s35, s34, 17
lw_139:
ds_read_b32 v5, v1 offset:0
s_waitcnt lgkmcnt(0)
v_cmp_gt_i32 vcc, s35, v5
s_cbranch_vccz lwd_140
s_sub_u32 s32, s32, 1
s_cmp_gt_i32 s32, 0
s_cbranch_scc1 lw_139
lwd_140:
ds_read_b128 v[152:155], v8 offset:0
ds_read_b128 v[156:159], v8 offset:1024
s_add_u32 s70, s72, 270336
s_mov_b64 exec, 1
s_waitcnt vmcnt(0)
buffer_store_dword v7, v3, s[24:27], s70 offen sc1
s_mov_b64 exec, -1
.p2align 3
v_exp_f32 v112, v112
v_exp_f32 v113, v113
v_exp_f32 v114, v114
v_exp_f32 v115, v115
v_exp_f32 v116, v116
v_exp_f32 v117, v117
s_waitcnt lgkmcnt(1)
v_mfma_f32_32x32x16_bf16 v[128:143], v[152:155], v[96:99], 0
v_exp_f32 v118, v118
v_exp_f32 v119, v119
v_cvt_pk_bf16_f32 v144, v112, v113
v_cvt_pk_bf16_f32 v145, v114, v115
s_waitcnt lgkmcnt(0)
v_mfma_f32_32x32x16_bf16 v[128:143], v[156:159], v[104:107], v[128:143]
ds_read_b128 v[152:155], v7 offset:8192
ds_read_b128 v[156:159], v7 offset:9216
v_cvt_pk_bf16_f32 v146, v116, v117
v_cvt_pk_bf16_f32 v147, v118, v119
v_exp_f32 v120, v120
v_exp_f32 v121, v121
v_mfma_f32_32x32x16_bf16 v[16:31], v[160:163], v[144:147], 0
ds_read_b128 v[160:163], v8 offset:2048
v_exp_f32 v122, v122
v_exp_f32 v123, v123
v_exp_f32 v124, v124
v_mfma_f32_16x16x32_bf16 v[32:35], v[212:215], v[144:147], 0
s_cmp_eq_u32 s65, 1
v_exp_f32 v125, v125
v_exp_f32 v126, v126
v_exp_f32 v127, v127
v_cvt_pk_bf16_f32 v148, v120, v121
v_cvt_pk_bf16_f32 v149, v122, v123
v_cvt_pk_bf16_f32 v150, v124, v125
v_cvt_pk_bf16_f32 v151, v126, v127
s_cbranch_scc1 at_141
v_exp_f32 v128, v128
v_exp_f32 v129, v129
v_mfma_f32_32x32x16_bf16 v[16:31], v[164:167], v[148:151], v[16:31]
ds_read_b128 v[164:167], v8 offset:3072
v_exp_f32 v130, v130
v_exp_f32 v131, v131
v_exp_f32 v132, v132
v_mfma_f32_16x16x32_bf16 v[32:35], v[212:215], v[148:151], v[32:35]
v_exp_f32 v133, v133
s_waitcnt lgkmcnt(3)
v_mfma_f32_32x32x16_bf16 v[112:127], v[152:155], v[96:99], 0
v_exp_f32 v134, v134
v_exp_f32 v135, v135
v_cvt_pk_bf16_f32 v144, v128, v129
v_cvt_pk_bf16_f32 v145, v130, v131
s_waitcnt lgkmcnt(2)
v_mfma_f32_32x32x16_bf16 v[112:127], v[156:159], v[104:107], v[112:127]
ds_read_b128 v[152:155], v7 offset:0
ds_read_b128 v[156:159], v7 offset:1024
v_cvt_pk_bf16_f32 v146, v132, v133
v_cvt_pk_bf16_f32 v147, v134, v135
v_exp_f32 v136, v136
v_exp_f32 v137, v137
s_waitcnt lgkmcnt(3)
v_mfma_f32_32x32x16_bf16 v[16:31], v[160:163], v[144:147], v[16:31]
ds_read_b128 v[160:163], v7 offset:10240
v_exp_f32 v138, v138
v_exp_f32 v139, v139
v_exp_f32 v140, v140
v_mfma_f32_16x16x32_bf16 v[32:35], v[212:215], v[144:147], v[32:35]
v_exp_f32 v141, v141
v_exp_f32 v142, v142
v_exp_f32 v143, v143
v_cvt_pk_bf16_f32 v148, v136, v137
v_cvt_pk_bf16_f32 v149, v138, v139
v_cvt_pk_bf16_f32 v150, v140, v141
v_cvt_pk_bf16_f32 v151, v142, v143
v_exp_f32 v112, v112
v_exp_f32 v113, v113
s_waitcnt lgkmcnt(3)
v_mfma_f32_32x32x16_bf16 v[16:31], v[164:167], v[148:151], v[16:31]
ds_read_b128 v[164:167], v7 offset:11264
v_exp_f32 v114, v114
v_exp_f32 v115, v115
v_exp_f32 v116, v116
v_mfma_f32_16x16x32_bf16 v[32:35], v[212:215], v[148:151], v[32:35]
v_exp_f32 v117, v117
s_waitcnt lgkmcnt(3)
v_mfma_f32_32x32x16_bf16 v[128:143], v[152:155], v[96:99], 0
v_exp_f32 v118, v118
v_exp_f32 v119, v119
v_cvt_pk_bf16_f32 v144, v112, v113
v_cvt_pk_bf16_f32 v145, v114, v115
s_waitcnt lgkmcnt(2)
v_mfma_f32_32x32x16_bf16 v[128:143], v[156:159], v[104:107], v[128:143]
v_cvt_pk_bf16_f32 v146, v116, v117
v_cvt_pk_bf16_f32 v147, v118, v119
v_exp_f32 v120, v120
v_exp_f32 v121, v121
s_waitcnt lgkmcnt(1)
v_mfma_f32_32x32x16_bf16 v[16:31], v[160:163], v[144:147], v[16:31]
ds_read_b128 v[160:163], v7 offset:2048
v_exp_f32 v122, v122
v_exp_f32 v123, v123
v_exp_f32 v124, v124
v_mfma_f32_16x16x32_bf16 v[32:35], v[212:215], v[144:147], v[32:35]
v_mov_b32 v8, v7
v_exp_f32 v125, v125
v_exp_f32 v126, v126
v_exp_f32 v127, v127
v_cvt_pk_bf16_f32 v148, v120, v121
v_cvt_pk_bf16_f32 v149, v122, v123
v_cvt_pk_bf16_f32 v150, v124, v125
v_cvt_pk_bf16_f32 v151, v126, v127
.p2align 3
at_141:
v_exp_f32 v128, v128
v_exp_f32 v129, v129
s_waitcnt lgkmcnt(1)
v_mfma_f32_32x32x16_bf16 v[16:31], v[164:167], v[148:151], v[16:31]
ds_read_b128 v[164:167], v8 offset:3072
v_exp_f32 v130, v130
v_exp_f32 v131, v131
v_exp_f32 v132, v132
v_mfma_f32_16x16x32_bf16 v[32:35], v[212:215], v[148:151], v[32:35]
v_exp_f32 v133, v133
v_mfma_f32_32x32x16_bf16 v[112:127], v[152:155], v[80:83], v[216:231]
v_exp_f32 v134, v134
v_exp_f32 v135, v135
v_cvt_pk_bf16_f32 v144, v128, v129
v_cvt_pk_bf16_f32 v145, v130, v131
v_mfma_f32_32x32x16_bf16 v[112:127], v[156:159], v[88:91], v[112:127]
s_sub_u32 s66, s66, 8192
s_cmp_eq_u32 s66, s67
s_cbranch_scc1 cross_148
cback_149:
v_add_u32 v8, s66, v6
ds_read_b128 v[152:155], v8 offset:0
ds_read_b128 v[156:159], v8 offset:1024
v_cvt_pk_bf16_f32 v146, v132, v133
v_cvt_pk_bf16_f32 v147, v134, v135
v_exp_f32 v136, v136
v_exp_f32 v137, v137
s_waitcnt lgkmcnt(3)
v_mfma_f32_32x32x16_bf16 v[16:31], v[160:163], v[144:147], v[16:31]
v_exp_f32 v138, v138
v_exp_f32 v139, v139
v_exp_f32 v140, v140
v_mfma_f32_16x16x32_bf16 v[32:35], v[212:215], v[144:147], v[32:35]
s_cmp_eq_u32 s68, 0
v_exp_f32 v141, v141
v_exp_f32 v142, v142
v_exp_f32 v143, v143
v_cvt_pk_bf16_f32 v148, v136, v137
v_cvt_pk_bf16_f32 v149, v138, v139
v_cvt_pk_bf16_f32 v150, v140, v141
v_cvt_pk_bf16_f32 v151, v142, v143
s_cbranch_scc1 at_145
.p2align 3
at_142:
v_exp_f32 v112, v112
v_exp_f32 v113, v113
s_waitcnt lgkmcnt(2)
v_mfma_f32_32x32x16_bf16 v[16:31], v[164:167], v[148:151], v[16:31]
v_exp_f32 v114, v114
v_exp_f32 v115, v115
v_exp_f32 v116, v116
v_mfma_f32_16x16x32_bf16 v[32:35], v[212:215], v[148:151], v[32:35]
v_exp_f32 v117, v117
s_waitcnt lgkmcnt(1)
v_mfma_f32_32x32x16_bf16 v[128:143], v[152:155], v[96:99], 0
v_exp_f32 v118, v118
v_exp_f32 v119, v119
v_cvt_pk_bf16_f32 v144, v112, v113
v_cvt_pk_bf16_f32 v145, v114, v115
s_waitcnt lgkmcnt(0)
v_mfma_f32_32x32x16_bf16 v[128:143], v[156:159], v[104:107], v[128:143]
v_cvt_pk_bf16_f32 v146, v116, v117
v_cvt_pk_bf16_f32 v147, v118, v119
v_exp_f32 v120, v120
v_exp_f32 v121, v121
v_mfma_f32_32x32x16_bf16 v[192:207], v[160:163], v[144:147], v[192:207]
ds_read_b128 v[160:163], v8 offset:2048
v_exp_f32 v122, v122
v_exp_f32 v123, v123
v_exp_f32 v124, v124
v_mfma_f32_16x16x32_bf16 v[208:211], v[212:215], v[144:147], v[208:211]
v_exp_f32 v125, v125
v_exp_f32 v126, v126
v_exp_f32 v127, v127
v_cvt_pk_bf16_f32 v148, v120, v121
v_cvt_pk_bf16_f32 v149, v122, v123
v_cvt_pk_bf16_f32 v150, v124, v125
v_cvt_pk_bf16_f32 v151, v126, v127
v_exp_f32 v128, v128
v_exp_f32 v129, v129
v_mfma_f32_32x32x16_bf16 v[192:207], v[164:167], v[148:151], v[192:207]
ds_read_b128 v[164:167], v8 offset:3072
v_exp_f32 v130, v130
v_exp_f32 v131, v131
v_exp_f32 v132, v132
v_mfma_f32_16x16x32_bf16 v[208:211], v[212:215], v[148:151], v[208:211]
v_exp_f32 v133, v133
v_mfma_f32_32x32x16_bf16 v[112:127], v[152:155], v[80:83], 0
v_exp_f32 v134, v134
v_exp_f32 v135, v135
v_cvt_pk_bf16_f32 v144, v128, v129
v_cvt_pk_bf16_f32 v145, v130, v131
v_mfma_f32_32x32x16_bf16 v[112:127], v[156:159], v[88:91], v[112:127]
s_sub_u32 s66, s66, 8192
s_cmp_eq_u32 s66, s67
s_cbranch_scc1 cross_150
cback_151:
v_add_u32 v8, s66, v6
ds_read_b128 v[152:155], v8 offset:0
ds_read_b128 v[156:159], v8 offset:1024
v_cvt_pk_bf16_f32 v146, v132, v133
v_cvt_pk_bf16_f32 v147, v134, v135
v_exp_f32 v136, v136
v_exp_f32 v137, v137
s_waitcnt lgkmcnt(3)
v_mfma_f32_32x32x16_bf16 v[16:31], v[160:163], v[144:147], v[16:31]
v_exp_f32 v138, v138
v_exp_f32 v139, v139
v_exp_f32 v140, v140
v_mfma_f32_16x16x32_bf16 v[32:35], v[212:215], v[144:147], v[32:35]
s_sub_u32 s68, s68, 1
s_cmp_eq_u32 s68, 0
v_exp_f32 v141, v141
v_exp_f32 v142, v142
v_exp_f32 v143, v143
v_cvt_pk_bf16_f32 v148, v136, v137
v_cvt_pk_bf16_f32 v149, v138, v139
v_cvt_pk_bf16_f32 v150, v140, v141
v_cvt_pk_bf16_f32 v151, v142, v143
s_cbranch_scc0 at_142
s_cmp_lt_u32 s59, 2
s_cbranch_scc1 at_145
.p2align 3
v_exp_f32 v112, v112
v_exp_f32 v113, v113
s_waitcnt lgkmcnt(2)
v_mfma_f32_32x32x16_bf16 v[16:31], v[164:167], v[148:151], v[16:31]
v_exp_f32 v114, v114
v_exp_f32 v115, v115
v_exp_f32 v116, v116
v_mfma_f32_16x16x32_bf16 v[32:35], v[212:215], v[148:151], v[32:35]
v_exp_f32 v117, v117
s_waitcnt lgkmcnt(1)
v_mfma_f32_32x32x16_bf16 v[128:143], v[152:155], v[96:99], v[216:231]
v_exp_f32 v118, v118
v_exp_f32 v119, v119
v_cvt_pk_bf16_f32 v144, v112, v113
v_cvt_pk_bf16_f32 v145, v114, v115
s_waitcnt lgkmcnt(0)
v_mfma_f32_32x32x16_bf16 v[128:143], v[156:159], v[104:107], v[128:143]
v_cvt_pk_bf16_f32 v146, v116, v117
v_cvt_pk_bf16_f32 v147, v118, v119
v_exp_f32 v120, v120
v_exp_f32 v121, v121
v_mfma_f32_32x32x16_bf16 v[192:207], v[160:163], v[144:147], v[192:207]
ds_read_b128 v[160:163], v8 offset:2048
v_exp_f32 v122, v122
v_exp_f32 v123, v123
v_exp_f32 v124, v124
v_mfma_f32_16x16x32_bf16 v[208:211], v[212:215], v[144:147], v[208:211]
v_exp_f32 v125, v125
v_exp_f32 v126, v126
v_exp_f32 v127, v127
v_cvt_pk_bf16_f32 v148, v120, v121
v_cvt_pk_bf16_f32 v149, v122, v123
v_cvt_pk_bf16_f32 v150, v124, v125
v_cvt_pk_bf16_f32 v151, v126, v127
v_exp_f32 v128, v128
v_exp_f32 v129, v129
v_mfma_f32_32x32x16_bf16 v[192:207], v[164:167], v[148:151], v[192:207]
ds_read_b128 v[164:167], v8 offset:3072
v_exp_f32 v130, v130
v_exp_f32 v131, v131
v_exp_f32 v132, v132
v_mfma_f32_16x16x32_bf16 v[208:211], v[212:215], v[148:151], v[208:211]
v_exp_f32 v133, v133
v_mfma_f32_32x32x16_bf16 v[112:127], v[152:155], v[80:83], 0
v_exp_f32 v134, v134
v_exp_f32 v135, v135
v_cvt_pk_bf16_f32 v144, v128, v129
v_cvt_pk_bf16_f32 v145, v130, v131
v_mfma_f32_32x32x16_bf16 v[112:127], v[156:159], v[88:91], v[112:127]
v_subrev_u32 v8, 8192, v8
ds_read_b128 v[152:155], v8 offset:0
ds_read_b128 v[156:159], v8 offset:1024
v_cvt_pk_bf16_f32 v146, v132, v133
v_cvt_pk_bf16_f32 v147, v134, v135
v_exp_f32 v136, v136
v_exp_f32 v137, v137
s_waitcnt lgkmcnt(3)
v_mfma_f32_32x32x16_bf16 v[16:31], v[160:163], v[144:147], v[16:31]
v_exp_f32 v138, v138
v_exp_f32 v139, v139
v_exp_f32 v140, v140
v_mfma_f32_16x16x32_bf16 v[32:35], v[212:215], v[144:147], v[32:35]
s_cmp_eq_u32 s65, 1
v_exp_f32 v141, v141
v_exp_f32 v142, v142
v_exp_f32 v143, v143
v_cvt_pk_bf16_f32 v148, v136, v137
v_cvt_pk_bf16_f32 v149, v138, v139
v_cvt_pk_bf16_f32 v150, v140, v141
v_cvt_pk_bf16_f32 v151, v142, v143
s_cbranch_scc1 at_144
.p2align 3
v_exp_f32 v112, v112
v_exp_f32 v113, v113
s_waitcnt lgkmcnt(2)
v_mfma_f32_32x32x16_bf16 v[16:31], v[164:167], v[148:151], v[16:31]
v_exp_f32 v114, v114
v_exp_f32 v115, v115
v_exp_f32 v116, v116
v_mfma_f32_16x16x32_bf16 v[32:35], v[212:215], v[148:151], v[32:35]
v_exp_f32 v117, v117
s_waitcnt lgkmcnt(1)
v_mfma_f32_32x32x16_bf16 v[128:143], v[152:155], v[80:83], 0
v_exp_f32 v118, v118
v_exp_f32 v119, v119
v_cvt_pk_bf16_f32 v144, v112, v113
v_cvt_pk_bf16_f32 v145, v114, v115
s_waitcnt lgkmcnt(0)
v_mfma_f32_32x32x16_bf16 v[128:143], v[156:159], v[88:91], v[128:143]
v_subrev_u32 v8, 8192, v8
ds_read_b128 v[152:155], v8 offset:0
ds_read_b128 v[156:159], v8 offset:1024
v_cvt_pk_bf16_f32 v146, v116, v117
v_cvt_pk_bf16_f32 v147, v118, v119
v_exp_f32 v120, v120
v_exp_f32 v121, v121
v_mfma_f32_32x32x16_bf16 v[192:207], v[160:163], v[144:147], v[192:207]
ds_read_b128 v[160:163], v8 offset:10240
v_exp_f32 v122, v122
v_exp_f32 v123, v123
v_exp_f32 v124, v124
v_mfma_f32_16x16x32_bf16 v[208:211], v[212:215], v[144:147], v[208:211]
v_exp_f32 v125, v125
v_exp_f32 v126, v126
v_exp_f32 v127, v127
v_cvt_pk_bf16_f32 v148, v120, v121
v_cvt_pk_bf16_f32 v149, v122, v123
v_cvt_pk_bf16_f32 v150, v124, v125
v_cvt_pk_bf16_f32 v151, v126, v127
v_exp_f32 v128, v128
v_exp_f32 v129, v129
v_mfma_f32_32x32x16_bf16 v[192:207], v[164:167], v[148:151], v[192:207]
ds_read_b128 v[164:167], v8 offset:11264
v_exp_f32 v130, v130
v_exp_f32 v131, v131
v_exp_f32 v132, v132
v_mfma_f32_16x16x32_bf16 v[208:211], v[212:215], v[148:151], v[208:211]
v_exp_f32 v133, v133
s_waitcnt lgkmcnt(3)
v_mfma_f32_32x32x16_bf16 v[112:127], v[152:155], v[80:83], 0
v_exp_f32 v134, v134
v_exp_f32 v135, v135
v_cvt_pk_bf16_f32 v144, v128, v129
v_cvt_pk_bf16_f32 v145, v130, v131
s_waitcnt lgkmcnt(2)
v_mfma_f32_32x32x16_bf16 v[112:127], v[156:159], v[88:91], v[112:127]
v_subrev_u32 v8, 8192, v8
ds_read_b128 v[152:155], v8 offset:0
ds_read_b128 v[156:159], v8 offset:1024
v_cvt_pk_bf16_f32 v146, v132, v133
v_cvt_pk_bf16_f32 v147, v134, v135
v_exp_f32 v136, v136
v_exp_f32 v137, v137
s_waitcnt lgkmcnt(3)
v_mfma_f32_32x32x16_bf16 v[192:207], v[160:163], v[144:147], v[192:207]
ds_read_b128 v[160:163], v8 offset:10240
v_exp_f32 v138, v138
v_exp_f32 v139, v139
v_exp_f32 v140, v140
v_mfma_f32_16x16x32_bf16 v[208:211], v[212:215], v[144:147], v[208:211]
v_exp_f32 v141, v141
v_exp_f32 v142, v142
v_exp_f32 v143, v143
v_cvt_pk_bf16_f32 v148, v136, v137
v_cvt_pk_bf16_f32 v149, v138, v139
v_cvt_pk_bf16_f32 v150, v140, v141
v_cvt_pk_bf16_f32 v151, v142, v143
v_exp_f32 v112, v112
v_exp_f32 v113, v113
s_waitcnt lgkmcnt(3)
v_mfma_f32_32x32x16_bf16 v[192:207], v[164:167], v[148:151], v[192:207]
ds_read_b128 v[164:167], v8 offset:11264
v_exp_f32 v114, v114
v_exp_f32 v115, v115
v_exp_f32 v116, v116
v_mfma_f32_16x16x32_bf16 v[208:211], v[212:215], v[148:151], v[208:211]
v_exp_f32 v117, v117
s_waitcnt lgkmcnt(3)
v_mfma_f32_32x32x16_bf16 v[128:143], v[152:155], v[80:83], v[216:231]
v_exp_f32 v118, v118
v_exp_f32 v119, v119
v_cvt_pk_bf16_f32 v144, v112, v113
v_cvt_pk_bf16_f32 v145, v114, v115
s_waitcnt lgkmcnt(2)
v_mfma_f32_32x32x16_bf16 v[128:143], v[156:159], v[88:91], v[128:143]
v_cvt_pk_bf16_f32 v146, v116, v117
v_cvt_pk_bf16_f32 v147, v118, v119
v_exp_f32 v120, v120
v_exp_f32 v121, v121
s_waitcnt lgkmcnt(1)
v_mfma_f32_32x32x16_bf16 v[192:207], v[160:163], v[144:147], v[192:207]
ds_read_b128 v[160:163], v8 offset:2048
v_exp_f32 v122, v122
v_exp_f32 v123, v123
v_exp_f32 v124, v124
v_mfma_f32_16x16x32_bf16 v[208:211], v[212:215], v[144:147], v[208:211]
v_exp_f32 v125, v125
v_exp_f32 v126, v126
v_exp_f32 v127, v127
v_cvt_pk_bf16_f32 v148, v120, v121
v_cvt_pk_bf16_f32 v149, v122, v123
v_cvt_pk_bf16_f32 v150, v124, v125
v_cvt_pk_bf16_f32 v151, v126, v127
s_branch at_146
.p2align 3
at_145:
v_add_u32 v5, s34, 20
s_mov_b64 exec, 1
ds_write_b32 v3, v5
s_mov_b64 exec, -1
v_exp_f32 v112, v112
v_exp_f32 v113, v113
s_waitcnt lgkmcnt(3)
v_mfma_f32_32x32x16_bf16 v[16:31], v[164:167], v[148:151], v[16:31]
v_exp_f32 v114, v114
v_exp_f32 v115, v115
v_exp_f32 v116, v116
v_mfma_f32_16x16x32_bf16 v[32:35], v[212:215], v[148:151], v[32:35]
v_exp_f32 v117, v117
v_exp_f32 v118, v118
v_exp_f32 v119, v119
v_cvt_pk_bf16_f32 v144, v112, v113
v_cvt_pk_bf16_f32 v145, v114, v115
v_cvt_pk_bf16_f32 v146, v116, v117
v_cvt_pk_bf16_f32 v147, v118, v119
v_exp_f32 v120, v120
v_exp_f32 v121, v121
v_mfma_f32_32x32x16_bf16 v[192:207], v[160:163], v[144:147], v[192:207]
v_exp_f32 v122, v122
v_exp_f32 v123, v123
v_exp_f32 v124, v124
v_mfma_f32_16x16x32_bf16 v[208:211], v[212:215], v[144:147], v[208:211]
v_exp_f32 v125, v125
v_exp_f32 v126, v126
v_exp_f32 v127, v127
v_cvt_pk_bf16_f32 v148, v120, v121
v_cvt_pk_bf16_f32 v149, v122, v123
v_cvt_pk_bf16_f32 v150, v124, v125
v_cvt_pk_bf16_f32 v151, v126, v127
s_branch at_147
.p2align 3
at_144:
v_exp_f32 v112, v112
v_exp_f32 v113, v113
s_waitcnt lgkmcnt(2)
v_mfma_f32_32x32x16_bf16 v[16:31], v[164:167], v[148:151], v[16:31]
v_exp_f32 v114, v114
v_exp_f32 v115, v115
v_exp_f32 v116, v116
v_mfma_f32_16x16x32_bf16 v[32:35], v[212:215], v[148:151], v[32:35]
v_exp_f32 v117, v117
s_waitcnt lgkmcnt(1)
v_mfma_f32_32x32x16_bf16 v[128:143], v[152:155], v[80:83], v[216:231]
v_exp_f32 v118, v118
v_exp_f32 v119, v119
v_cvt_pk_bf16_f32 v144, v112, v113
v_cvt_pk_bf16_f32 v145, v114, v115
s_waitcnt lgkmcnt(0)
v_mfma_f32_32x32x16_bf16 v[128:143], v[156:159], v[88:91], v[128:143]
v_cvt_pk_bf16_f32 v146, v116, v117
v_cvt_pk_bf16_f32 v147, v118, v119
v_exp_f32 v120, v120
v_exp_f32 v121, v121
v_mfma_f32_32x32x16_bf16 v[192:207], v[160:163], v[144:147], v[192:207]
ds_read_b128 v[160:163], v8 offset:2048
v_exp_f32 v122, v122
v_exp_f32 v123, v123
v_exp_f32 v124, v124
v_mfma_f32_16x16x32_bf16 v[208:211], v[212:215], v[144:147], v[208:211]
v_exp_f32 v125, v125
v_exp_f32 v126, v126
v_exp_f32 v127, v127
v_cvt_pk_bf16_f32 v148, v120, v121
v_cvt_pk_bf16_f32 v149, v122, v123
v_cvt_pk_bf16_f32 v150, v124, v125
v_cvt_pk_bf16_f32 v151, v126, v127
.p2align 3
at_146:
v_exp_f32 v128, v128
v_exp_f32 v129, v129
s_waitcnt lgkmcnt(1)
v_mfma_f32_32x32x16_bf16 v[192:207], v[164:167], v[148:151], v[192:207]
ds_read_b128 v[164:167], v8 offset:3072
v_exp_f32 v130, v130
v_exp_f32 v131, v131
v_exp_f32 v132, v132
v_mfma_f32_16x16x32_bf16 v[208:211], v[212:215], v[148:151], v[208:211]
v_exp_f32 v133, v133
v_exp_f32 v134, v134
v_exp_f32 v135, v135
v_cvt_pk_bf16_f32 v144, v128, v129
v_cvt_pk_bf16_f32 v145, v130, v131
v_add_u32 v5, s34, 20
s_mov_b64 exec, 1
ds_write_b32 v3, v5
s_mov_b64 exec, -1
v_cvt_pk_bf16_f32 v146, v132, v133
v_cvt_pk_bf16_f32 v147, v134, v135
v_exp_f32 v136, v136
v_exp_f32 v137, v137
s_waitcnt lgkmcnt(2)
v_mfma_f32_32x32x16_bf16 v[192:207], v[160:163], v[144:147], v[192:207]
v_exp_f32 v138, v138
v_exp_f32 v139, v139
v_exp_f32 v140, v140
v_mfma_f32_16x16x32_bf16 v[208:211], v[212:215], v[144:147], v[208:211]
v_exp_f32 v141, v141
v_exp_f32 v142, v142
v_exp_f32 v143, v143
v_cvt_pk_bf16_f32 v148, v136, v137
v_cvt_pk_bf16_f32 v149, v138, v139
v_cvt_pk_bf16_f32 v150, v140, v141
v_cvt_pk_bf16_f32 v151, v142, v143
at_147:
s_lshl_b32 s66, s59, 18
s_lshl_b32 s67, s63, 22
v_mfma_f32_16x16x32_bf16 v[208:211], v[212:215], v[148:151], v[208:211]
s_add_u32 s66, s66, s67
s_lshl1_add_u32 s67, s60, s64
s_waitcnt lgkmcnt(1)
v_mfma_f32_32x32x16_bf16 v[192:207], v[164:167], v[148:151], v[192:207]
s_lshl_b32 s67, s67, 11
s_add_u32 s66, s66, s67
s_lshl_b32 s68, s65, 16
s_add_u32 s67, s66, 18022400
s_sub_u32 s67, s67, s68
s_add_u32 s66, s66, s68
s_add_u32 s66, s66, 17825792
v_lshlrev_b32 v9, 4, v0
v_subrev_u32 v10, 0x2f800000, v32
v_subrev_u32 v11, 0x2f800000, v208
v_max_u32 v10, v10, v11
v_cmp_lt_u32 vcc, 0x20000000, v10
s_cbranch_vccnz slow_152
sback_153:
s_nop 1
v_rcp_f32 v12, v32
s_nop 1
v_pk_mul_f32 v[16:17], v[16:17], v[12:13] op_sel:[0,0] op_sel_hi:[1,0]
v_pk_mul_f32 v[18:19], v[18:19], v[12:13] op_sel:[0,0] op_sel_hi:[1,0]
v_pk_mul_f32 v[20:21], v[20:21], v[12:13] op_sel:[0,0] op_sel_hi:[1,0]
v_pk_mul_f32 v[22:23], v[22:23], v[12:13] op_sel:[0,0] op_sel_hi:[1,0]
v_pk_mul_f32 v[24:25], v[24:25], v[12:13] op_sel:[0,0] op_sel_hi:[1,0]
v_pk_mul_f32 v[26:27], v[26:27], v[12:13] op_sel:[0,0] op_sel_hi:[1,0]
v_pk_mul_f32 v[28:29], v[28:29], v[12:13] op_sel:[0,0] op_sel_hi:[1,0]
v_pk_mul_f32 v[30:31], v[30:31], v[12:13] op_sel:[0,0] op_sel_hi:[1,0]
v_cvt_pk_bf16_f32 v16, v16, v17
v_cvt_pk_bf16_f32 v17, v18, v19
v_cvt_pk_bf16_f32 v18, v20, v21
v_cvt_pk_bf16_f32 v19, v22, v23
v_cvt_pk_bf16_f32 v20, v24, v25
v_cvt_pk_bf16_f32 v21, v26, v27
v_cvt_pk_bf16_f32 v22, v28, v29
v_cvt_pk_bf16_f32 v23, v30, v31
s_cmp_eq_u32 s57, 0
s_cbranch_scc1 far_154
buffer_store_dwordx4 v[16:19], v9, s[20:23], s67 offen offset:0
buffer_store_dwordx4 v[20:23], v9, s[20:23], s67 offen offset:1024
near_155:
v_rcp_f32 v12, v208
s_nop 0
v_pk_mul_f32 v[192:193], v[192:193], v[12:13] op_sel:[0,0] op_sel_hi:[1,0]
v_pk_mul_f32 v[194:195], v[194:195], v[12:13] op_sel:[0,0] op_sel_hi:[1,0]
v_pk_mul_f32 v[196:197], v[196:197], v[12:13] op_sel:[0,0] op_sel_hi:[1,0]
v_pk_mul_f32 v[198:199], v[198:199], v[12:13] op_sel:[0,0] op_sel_hi:[1,0]
v_pk_mul_f32 v[200:201], v[200:201], v[12:13] op_sel:[0,0] op_sel_hi:[1,0]
v_pk_mul_f32 v[202:203], v[202:203], v[12:13] op_sel:[0,0] op_sel_hi:[1,0]
v_pk_mul_f32 v[204:205], v[204:205], v[12:13] op_sel:[0,0] op_sel_hi:[1,0]
v_pk_mul_f32 v[206:207], v[206:207], v[12:13] op_sel:[0,0] op_sel_hi:[1,0]
v_cvt_pk_bf16_f32 v192, v192, v193
v_cvt_pk_bf16_f32 v193, v194, v195
v_cvt_pk_bf16_f32 v194, v196, v197
v_cvt_pk_bf16_f32 v195, v198, v199
v_cvt_pk_bf16_f32 v196, v200, v201
v_cvt_pk_bf16_f32 v197, v202, v203
v_cvt_pk_bf16_f32 v198, v204, v205
v_cvt_pk_bf16_f32 v199, v206, v207
s_cmp_eq_u32 s57, 0
s_cbranch_scc1 far_156
buffer_store_dwordx4 v[192:195], v9, s[20:23], s66 offen offset:0
buffer_store_dwordx4 v[196:199], v9, s[20:23], s66 offen offset:1024
near_157:
v_bfe_u32 v48, v0, 2, 3
v_lshrrev_b32 v49, 5, v0
v_lshl_add_u32 v48, v49, 4, v48
v_lshlrev_b32 v48, 7, v48
v_bfe_u32 v49, v0, 3, 2
v_lshl_add_u32 v48, v49, 5, v48
v_and_b32 v49, 3, v0
v_lshl_add_u32 v48, v49, 3, v48
v_add_u32 v8, 32768, v48
v_xor_b32 v9, 32, v8
v_xor_b32 v10, 64, v8
v_xor_b32 v11, 96, v8
v_add_u32 v12, 0x10000, v8
v_add_u32 v13, 0x10000, v9
v_add_u32 v14, 0x10000, v10
v_add_u32 v15, 0x10000, v11
v_and_b32 v48, 15, v0
v_lshrrev_b32 v49, 4, v0
s_lshl2_add_u32 s66, s61, s58
s_lshl_b32 s67, s66, 16
s_lshl_b32 s68, s63, 22
s_add_u32 s67, s67, s68
s_add_u32 s67, s67, 17825792
v_lshl_add_u32 v6, v48, 4, s67
v_lshl_add_u32 v6, v49, 9, v6
s_add_u32 s70, s72, 268288
s_add_u32 s35, s34, 3
lw_158:
ds_read_b32 v5, v2 offset:24
s_waitcnt lgkmcnt(0)
v_cmp_gt_i32 vcc, s35, v5
s_cbranch_vccz lwd_159
s_sub_u32 s32, s32, 1
s_cmp_gt_i32 s32, 0
s_cbranch_scc1 lw_158
lwd_159:
s_mov_b64 exec, 1
s_waitcnt vmcnt(0)
s_cmp_eq_u32 s57, 0
s_cbranch_scc1 far_160
buffer_store_dword v212, v3, s[24:27], s70 offen
near_161:
s_mov_b64 exec, -1
v_add_u32 v5, s34, 21
s_mov_b64 exec, 1
ds_write_b32 v3, v5
s_mov_b64 exec, -1
s_cmp_eq_u32 s63, 0
s_cbranch_scc0 mo_162
v_permlane16_swap_b32 v240, v242
v_permlane16_swap_b32 v241, v243
v_permlane16_swap_b32 v244, v246
v_permlane16_swap_b32 v245, v247
v_permlane16_swap_b32 v248, v250
v_permlane16_swap_b32 v249, v251
v_permlane16_swap_b32 v252, v254
v_permlane16_swap_b32 v253, v255
mo_163:
v_lshlrev_b32 v16, 16, v240
v_and_b32 v17, 0xffff0000, v240
v_lshlrev_b32 v18, 16, v241
v_and_b32 v19, 0xffff0000, v241
v_lshlrev_b32 v20, 16, v242
v_and_b32 v21, 0xffff0000, v242
v_lshlrev_b32 v22, 16, v243
v_and_b32 v23, 0xffff0000, v243
v_lshlrev_b32 v24, 16, v244
v_and_b32 v25, 0xffff0000, v244
v_lshlrev_b32 v26, 16, v245
v_and_b32 v27, 0xffff0000, v245
v_lshlrev_b32 v28, 16, v246
v_and_b32 v29, 0xffff0000, v246
v_lshlrev_b32 v30, 16, v247
v_and_b32 v31, 0xffff0000, v247
v_lshlrev_b32 v32, 16, v248
v_and_b32 v33, 0xffff0000, v248
v_lshlrev_b32 v34, 16, v249
v_and_b32 v35, 0xffff0000, v249
v_lshlrev_b32 v36, 16, v250
v_and_b32 v37, 0xffff0000, v250
v_lshlrev_b32 v38, 16, v251
v_and_b32 v39, 0xffff0000, v251
v_lshlrev_b32 v40, 16, v252
v_and_b32 v41, 0xffff0000, v252
v_lshlrev_b32 v42, 16, v253
v_and_b32 v43, 0xffff0000, v253
v_lshlrev_b32 v44, 16, v254
v_and_b32 v45, 0xffff0000, v254
v_lshlrev_b32 v46, 16, v255
v_and_b32 v47, 0xffff0000, v255
s_add_u32 s66, s61, s62
s_and_b32 s66, s66, 15
s_lshl_b32 s66, s66, 12
s_add_u32 s35, s34, 18
lw_164:
ds_read_b32 v5, v2 offset:16
s_waitcnt lgkmcnt(0)
v_cmp_gt_i32 vcc, s35, v5
s_cbranch_vccz lwd_165
s_sub_u32 s32, s32, 1
s_cmp_gt_i32 s32, 0
s_cbranch_scc1 lw_164
lwd_165:
buffer_load_dwordx4 v[80:83], v6, s[20:23], s66 offen offset:0 sc1
buffer_load_dwordx4 v[88:91], v6, s[20:23], s66 offen offset:2048 sc1
buffer_load_dwordx4 v[84:87], v6, s[20:23], s66 offen offset:256 sc1
buffer_load_dwordx4 v[92:95], v6, s[20:23], s66 offen offset:2304 sc1
s_add_u32 s66, s66, 4096
s_and_b32 s66, s66, 0xffff
ds_read_b64_tr_b16 v[48:49], v8 offset:0
ds_read_b64_tr_b16 v[50:51], v8 offset:1024
ds_read_b64_tr_b16 v[52:53], v8 offset:4096
ds_read_b64_tr_b16 v[54:55], v8 offset:5120
buffer_load_dwordx4 v[96:99], v6, s[20:23], s66 offen offset:0 sc1
buffer_load_dwordx4 v[104:107], v6, s[20:23], s66 offen offset:2048 sc1
buffer_load_dwordx4 v[100:103], v6, s[20:23], s66 offen offset:256 sc1
buffer_load_dwordx4 v[108:111], v6, s[20:23], s66 offen offset:2304 sc1
s_add_u32 s66, s66, 4096
s_and_b32 s66, s66, 0xffff
ds_read_b64_tr_b16 v[56:57], v9 offset:0
ds_read_b64_tr_b16 v[58:59], v9 offset:1024
ds_read_b64_tr_b16 v[60:61], v9 offset:4096
ds_read_b64_tr_b16 v[62:63], v9 offset:5120
buffer_load_dwordx4 v[112:115], v6, s[20:23], s66 offen offset:0 sc1
buffer_load_dwordx4 v[120:123], v6, s[20:23], s66 offen offset:2048 sc1
buffer_load_dwordx4 v[116:119], v6, s[20:23], s66 offen offset:256 sc1
buffer_load_dwordx4 v[124:127], v6, s[20:23], s66 offen offset:2304 sc1
s_add_u32 s66, s66, 4096
s_and_b32 s66, s66, 0xffff
ds_read_b64_tr_b16 v[64:65], v10 offset:0
ds_read_b64_tr_b16 v[66:67], v10 offset:1024
ds_read_b64_tr_b16 v[68:69], v10 offset:4096
ds_read_b64_tr_b16 v[70:71], v10 offset:5120
buffer_load_dwordx4 v[128:131], v6, s[20:23], s66 offen offset:0 sc1
buffer_load_dwordx4 v[136:139], v6, s[20:23], s66 offen offset:2048 sc1
buffer_load_dwordx4 v[132:135], v6, s[20:23], s66 offen offset:256 sc1
buffer_load_dwordx4 v[140:143], v6, s[20:23], s66 offen offset:2304 sc1
s_add_u32 s66, s66, 4096
s_and_b32 s66, s66, 0xffff
buffer_load_dwordx4 v[144:147], v6, s[20:23], s66 offen offset:0 sc1
buffer_load_dwordx4 v[152:155], v6, s[20:23], s66 offen offset:2048 sc1
buffer_load_dwordx4 v[148:151], v6, s[20:23], s66 offen offset:256 sc1
buffer_load_dwordx4 v[156:159], v6, s[20:23], s66 offen offset:2304 sc1
s_add_u32 s66, s66, 4096
s_and_b32 s66, s66, 0xffff
buffer_load_dwordx4 v[160:163], v6, s[20:23], s66 offen offset:0 sc1
buffer_load_dwordx4 v[168:171], v6, s[20:23], s66 offen offset:2048 sc1
buffer_load_dwordx4 v[164:167], v6, s[20:23], s66 offen offset:256 sc1
buffer_load_dwordx4 v[172:175], v6, s[20:23], s66 offen offset:2304 sc1
s_add_u32 s66, s66, 4096
s_and_b32 s66, s66, 0xffff
buffer_load_dwordx4 v[176:179], v6, s[20:23], s66 offen offset:0 sc1
buffer_load_dwordx4 v[184:187], v6, s[20:23], s66 offen offset:2048 sc1
buffer_load_dwordx4 v[180:183], v6, s[20:23], s66 offen offset:256 sc1
buffer_load_dwordx4 v[188:191], v6, s[20:23], s66 offen offset:2304 sc1
s_add_u32 s66, s66, 4096
s_and_b32 s66, s66, 0xffff
buffer_load_dwordx4 v[192:195], v6, s[20:23], s66 offen offset:0 sc1
buffer_load_dwordx4 v[200:203], v6, s[20:23], s66 offen offset:2048 sc1
buffer_load_dwordx4 v[196:199], v6, s[20:23], s66 offen offset:256 sc1
buffer_load_dwordx4 v[204:207], v6, s[20:23], s66 offen offset:2304 sc1
s_add_u32 s66, s66, 4096
s_and_b32 s66, s66, 0xffff
.p2align 3
s_waitcnt vmcnt(31) lgkmcnt(10)
v_mfma_f32_16x16x32_bf16 v[16:19], v[48:51], v[80:83], v[16:19]
ds_read_b64_tr_b16 v[72:73], v11 offset:0
s_waitcnt vmcnt(30) lgkmcnt(9)
v_mfma_f32_16x16x32_bf16 v[16:19], v[52:55], v[88:91], v[16:19]
ds_read_b64_tr_b16 v[74:75], v11 offset:1024
s_waitcnt vmcnt(29)
v_mfma_f32_16x16x32_bf16 v[32:35], v[48:51], v[84:87], v[32:35]
ds_read_b64_tr_b16 v[76:77], v11 offset:4096
s_waitcnt vmcnt(28)
v_mfma_f32_16x16x32_bf16 v[32:35], v[52:55], v[92:95], v[32:35]
ds_read_b64_tr_b16 v[78:79], v11 offset:5120
s_waitcnt lgkmcnt(10)
v_mfma_f32_16x16x32_bf16 v[20:23], v[56:59], v[80:83], v[20:23]
ds_read_b64_tr_b16 v[48:49], v8 offset:8192
s_waitcnt lgkmcnt(9)
v_mfma_f32_16x16x32_bf16 v[20:23], v[60:63], v[88:91], v[20:23]
ds_read_b64_tr_b16 v[50:51], v8 offset:9216
v_mfma_f32_16x16x32_bf16 v[36:39], v[56:59], v[84:87], v[36:39]
ds_read_b64_tr_b16 v[52:53], v8 offset:12288
v_mfma_f32_16x16x32_bf16 v[36:39], v[60:63], v[92:95], v[36:39]
ds_read_b64_tr_b16 v[54:55], v8 offset:13312
s_waitcnt lgkmcnt(10)
v_mfma_f32_16x16x32_bf16 v[24:27], v[64:67], v[80:83], v[24:27]
ds_read_b64_tr_b16 v[56:57], v9 offset:8192
s_waitcnt lgkmcnt(9)
v_mfma_f32_16x16x32_bf16 v[24:27], v[68:71], v[88:91], v[24:27]
ds_read_b64_tr_b16 v[58:59], v9 offset:9216
v_mfma_f32_16x16x32_bf16 v[40:43], v[64:67], v[84:87], v[40:43]
ds_read_b64_tr_b16 v[60:61], v9 offset:12288
v_mfma_f32_16x16x32_bf16 v[40:43], v[68:71], v[92:95], v[40:43]
ds_read_b64_tr_b16 v[62:63], v9 offset:13312
s_waitcnt lgkmcnt(10)
v_mfma_f32_16x16x32_bf16 v[28:31], v[72:75], v[80:83], v[28:31]
ds_read_b64_tr_b16 v[64:65], v10 offset:8192
s_waitcnt lgkmcnt(9)
v_mfma_f32_16x16x32_bf16 v[28:31], v[76:79], v[88:91], v[28:31]
ds_read_b64_tr_b16 v[66:67], v10 offset:9216
v_mfma_f32_16x16x32_bf16 v[44:47], v[72:75], v[84:87], v[44:47]
ds_read_b64_tr_b16 v[68:69], v10 offset:12288
v_mfma_f32_16x16x32_bf16 v[44:47], v[76:79], v[92:95], v[44:47]
ds_read_b64_tr_b16 v[70:71], v10 offset:13312
s_waitcnt vmcnt(27) lgkmcnt(10)
v_mfma_f32_16x16x32_bf16 v[16:19], v[48:51], v[96:99], v[16:19]
ds_read_b64_tr_b16 v[72:73], v11 offset:8192
buffer_load_dwordx4 v[80:83], v6, s[20:23], s66 offen offset:0 sc1
s_waitcnt vmcnt(27) lgkmcnt(9)
v_mfma_f32_16x16x32_bf16 v[16:19], v[52:55], v[104:107], v[16:19]
ds_read_b64_tr_b16 v[74:75], v11 offset:9216
buffer_load_dwordx4 v[88:91], v6, s[20:23], s66 offen offset:2048 sc1
s_waitcnt vmcnt(27)
v_mfma_f32_16x16x32_bf16 v[32:35], v[48:51], v[100:103], v[32:35]
ds_read_b64_tr_b16 v[76:77], v11 offset:12288
buffer_load_dwordx4 v[84:87], v6, s[20:23], s66 offen offset:256 sc1
s_waitcnt vmcnt(27)
v_mfma_f32_16x16x32_bf16 v[32:35], v[52:55], v[108:111], v[32:35]
ds_read_b64_tr_b16 v[78:79], v11 offset:13312
buffer_load_dwordx4 v[92:95], v6, s[20:23], s66 offen offset:2304 sc1
s_waitcnt lgkmcnt(10)
v_mfma_f32_16x16x32_bf16 v[20:23], v[56:59], v[96:99], v[20:23]
ds_read_b64_tr_b16 v[48:49], v8 offset:16384
s_add_u32 s66, s66, 4096
s_and_b32 s66, s66, 0xffff
s_waitcnt lgkmcnt(9)
v_mfma_f32_16x16x32_bf16 v[20:23], v[60:63], v[104:107], v[20:23]
ds_read_b64_tr_b16 v[50:51], v8 offset:17408
v_mfma_f32_16x16x32_bf16 v[36:39], v[56:59], v[100:103], v[36:39]
ds_read_b64_tr_b16 v[52:53], v8 offset:20480
v_mfma_f32_16x16x32_bf16 v[36:39], v[60:63], v[108:111], v[36:39]
ds_read_b64_tr_b16 v[54:55], v8 offset:21504
s_waitcnt lgkmcnt(10)
v_mfma_f32_16x16x32_bf16 v[24:27], v[64:67], v[96:99], v[24:27]
ds_read_b64_tr_b16 v[56:57], v9 offset:16384
s_waitcnt lgkmcnt(9)
v_mfma_f32_16x16x32_bf16 v[24:27], v[68:71], v[104:107], v[24:27]
ds_read_b64_tr_b16 v[58:59], v9 offset:17408
v_mfma_f32_16x16x32_bf16 v[40:43], v[64:67], v[100:103], v[40:43]
ds_read_b64_tr_b16 v[60:61], v9 offset:20480
v_mfma_f32_16x16x32_bf16 v[40:43], v[68:71], v[108:111], v[40:43]
ds_read_b64_tr_b16 v[62:63], v9 offset:21504
s_waitcnt lgkmcnt(10)
v_mfma_f32_16x16x32_bf16 v[28:31], v[72:75], v[96:99], v[28:31]
ds_read_b64_tr_b16 v[64:65], v10 offset:16384
s_waitcnt lgkmcnt(9)
v_mfma_f32_16x16x32_bf16 v[28:31], v[76:79], v[104:107], v[28:31]
ds_read_b64_tr_b16 v[66:67], v10 offset:17408
v_mfma_f32_16x16x32_bf16 v[44:47], v[72:75], v[100:103], v[44:47]
ds_read_b64_tr_b16 v[68:69], v10 offset:20480
v_mfma_f32_16x16x32_bf16 v[44:47], v[76:79], v[108:111], v[44:47]
ds_read_b64_tr_b16 v[70:71], v10 offset:21504
s_waitcnt vmcnt(27) lgkmcnt(10)
v_mfma_f32_16x16x32_bf16 v[16:19], v[48:51], v[112:115], v[16:19]
ds_read_b64_tr_b16 v[72:73], v11 offset:16384
buffer_load_dwordx4 v[96:99], v6, s[20:23], s66 offen offset:0 sc1
s_waitcnt vmcnt(27) lgkmcnt(9)
v_mfma_f32_16x16x32_bf16 v[16:19], v[52:55], v[120:123], v[16:19]
ds_read_b64_tr_b16 v[74:75], v11 offset:17408
buffer_load_dwordx4 v[104:107], v6, s[20:23], s66 offen offset:2048 sc1
s_waitcnt vmcnt(27)
v_mfma_f32_16x16x32_bf16 v[32:35], v[48:51], v[116:119], v[32:35]
ds_read_b64_tr_b16 v[76:77], v11 offset:20480
buffer_load_dwordx4 v[100:103], v6, s[20:23], s66 offen offset:256 sc1
s_waitcnt vmcnt(27)
v_mfma_f32_16x16x32_bf16 v[32:35], v[52:55], v[124:127], v[32:35]
ds_read_b64_tr_b16 v[78:79], v11 offset:21504
buffer_load_dwordx4 v[108:111], v6, s[20:23], s66 offen offset:2304 sc1
s_waitcnt lgkmcnt(10)
v_mfma_f32_16x16x32_bf16 v[20:23], v[56:59], v[112:115], v[20:23]
ds_read_b64_tr_b16 v[48:49], v8 offset:24576
s_add_u32 s66, s66, 4096
s_and_b32 s66, s66, 0xffff
s_waitcnt lgkmcnt(9)
v_mfma_f32_16x16x32_bf16 v[20:23], v[60:63], v[120:123], v[20:23]
ds_read_b64_tr_b16 v[50:51], v8 offset:25600
v_mfma_f32_16x16x32_bf16 v[36:39], v[56:59], v[116:119], v[36:39]
ds_read_b64_tr_b16 v[52:53], v8 offset:28672
v_mfma_f32_16x16x32_bf16 v[36:39], v[60:63], v[124:127], v[36:39]
ds_read_b64_tr_b16 v[54:55], v8 offset:29696
s_waitcnt lgkmcnt(10)
v_mfma_f32_16x16x32_bf16 v[24:27], v[64:67], v[112:115], v[24:27]
ds_read_b64_tr_b16 v[56:57], v9 offset:24576
s_waitcnt lgkmcnt(9)
v_mfma_f32_16x16x32_bf16 v[24:27], v[68:71], v[120:123], v[24:27]
ds_read_b64_tr_b16 v[58:59], v9 offset:25600
v_mfma_f32_16x16x32_bf16 v[40:43], v[64:67], v[116:119], v[40:43]
ds_read_b64_tr_b16 v[60:61], v9 offset:28672
v_mfma_f32_16x16x32_bf16 v[40:43], v[68:71], v[124:127], v[40:43]
ds_read_b64_tr_b16 v[62:63], v9 offset:29696
s_waitcnt lgkmcnt(10)
v_mfma_f32_16x16x32_bf16 v[28:31], v[72:75], v[112:115], v[28:31]
ds_read_b64_tr_b16 v[64:65], v10 offset:24576
s_waitcnt lgkmcnt(9)
v_mfma_f32_16x16x32_bf16 v[28:31], v[76:79], v[120:123], v[28:31]
ds_read_b64_tr_b16 v[66:67], v10 offset:25600
v_mfma_f32_16x16x32_bf16 v[44:47], v[72:75], v[116:119], v[44:47]
ds_read_b64_tr_b16 v[68:69], v10 offset:28672
v_mfma_f32_16x16x32_bf16 v[44:47], v[76:79], v[124:127], v[44:47]
ds_read_b64_tr_b16 v[70:71], v10 offset:29696
s_waitcnt vmcnt(27) lgkmcnt(10)
v_mfma_f32_16x16x32_bf16 v[16:19], v[48:51], v[128:131], v[16:19]
ds_read_b64_tr_b16 v[72:73], v11 offset:24576
buffer_load_dwordx4 v[112:115], v6, s[20:23], s66 offen offset:0 sc1
s_waitcnt vmcnt(27) lgkmcnt(9)
v_mfma_f32_16x16x32_bf16 v[16:19], v[52:55], v[136:139], v[16:19]
ds_read_b64_tr_b16 v[74:75], v11 offset:25600
buffer_load_dwordx4 v[120:123], v6, s[20:23], s66 offen offset:2048 sc1
s_waitcnt vmcnt(27)
v_mfma_f32_16x16x32_bf16 v[32:35], v[48:51], v[132:135], v[32:35]
ds_read_b64_tr_b16 v[76:77], v11 offset:28672
buffer_load_dwordx4 v[116:119], v6, s[20:23], s66 offen offset:256 sc1
s_waitcnt vmcnt(27)
v_mfma_f32_16x16x32_bf16 v[32:35], v[52:55], v[140:143], v[32:35]
ds_read_b64_tr_b16 v[78:79], v11 offset:29696
buffer_load_dwordx4 v[124:127], v6, s[20:23], s66 offen offset:2304 sc1
s_waitcnt lgkmcnt(10)
v_mfma_f32_16x16x32_bf16 v[20:23], v[56:59], v[128:131], v[20:23]
ds_read_b64_tr_b16 v[48:49], v8 offset:32768
s_add_u32 s66, s66, 4096
s_and_b32 s66, s66, 0xffff
s_waitcnt lgkmcnt(9)
v_mfma_f32_16x16x32_bf16 v[20:23], v[60:63], v[136:139], v[20:23]
ds_read_b64_tr_b16 v[50:51], v8 offset:33792
v_mfma_f32_16x16x32_bf16 v[36:39], v[56:59], v[132:135], v[36:39]
ds_read_b64_tr_b16 v[52:53], v8 offset:36864
v_mfma_f32_16x16x32_bf16 v[36:39], v[60:63], v[140:143], v[36:39]
ds_read_b64_tr_b16 v[54:55], v8 offset:37888
s_waitcnt lgkmcnt(10)
v_mfma_f32_16x16x32_bf16 v[24:27], v[64:67], v[128:131], v[24:27]
ds_read_b64_tr_b16 v[56:57], v9 offset:32768
s_waitcnt lgkmcnt(9)
v_mfma_f32_16x16x32_bf16 v[24:27], v[68:71], v[136:139], v[24:27]
ds_read_b64_tr_b16 v[58:59], v9 offset:33792
v_mfma_f32_16x16x32_bf16 v[40:43], v[64:67], v[132:135], v[40:43]
ds_read_b64_tr_b16 v[60:61], v9 offset:36864
v_mfma_f32_16x16x32_bf16 v[40:43], v[68:71], v[140:143], v[40:43]
ds_read_b64_tr_b16 v[62:63], v9 offset:37888
s_waitcnt lgkmcnt(10)
v_mfma_f32_16x16x32_bf16 v[28:31], v[72:75], v[128:131], v[28:31]
ds_read_b64_tr_b16 v[64:65], v10 offset:32768
s_waitcnt lgkmcnt(9)
v_mfma_f32_16x16x32_bf16 v[28:31], v[76:79], v[136:139], v[28:31]
ds_read_b64_tr_b16 v[66:67], v10 offset:33792
v_mfma_f32_16x16x32_bf16 v[44:47], v[72:75], v[132:135], v[44:47]
ds_read_b64_tr_b16 v[68:69], v10 offset:36864
v_mfma_f32_16x16x32_bf16 v[44:47], v[76:79], v[140:143], v[44:47]
ds_read_b64_tr_b16 v[70:71], v10 offset:37888
s_waitcnt vmcnt(27) lgkmcnt(10)
v_mfma_f32_16x16x32_bf16 v[16:19], v[48:51], v[144:147], v[16:19]
ds_read_b64_tr_b16 v[72:73], v11 offset:32768
buffer_load_dwordx4 v[128:131], v6, s[20:23], s66 offen offset:0 sc1
s_waitcnt vmcnt(27) lgkmcnt(9)
v_mfma_f32_16x16x32_bf16 v[16:19], v[52:55], v[152:155], v[16:19]
ds_read_b64_tr_b16 v[74:75], v11 offset:33792
buffer_load_dwordx4 v[136:139], v6, s[20:23], s66 offen offset:2048 sc1
s_waitcnt vmcnt(27)
v_mfma_f32_16x16x32_bf16 v[32:35], v[48:51], v[148:151], v[32:35]
ds_read_b64_tr_b16 v[76:77], v11 offset:36864
buffer_load_dwordx4 v[132:135], v6, s[20:23], s66 offen offset:256 sc1
s_waitcnt vmcnt(27)
v_mfma_f32_16x16x32_bf16 v[32:35], v[52:55], v[156:159], v[32:35]
ds_read_b64_tr_b16 v[78:79], v11 offset:37888
buffer_load_dwordx4 v[140:143], v6, s[20:23], s66 offen offset:2304 sc1
s_waitcnt lgkmcnt(10)
v_mfma_f32_16x16x32_bf16 v[20:23], v[56:59], v[144:147], v[20:23]
ds_read_b64_tr_b16 v[48:49], v8 offset:40960
s_add_u32 s66, s66, 4096
s_and_b32 s66, s66, 0xffff
s_waitcnt lgkmcnt(9)
v_mfma_f32_16x16x32_bf16 v[20:23], v[60:63], v[152:155], v[20:23]
ds_read_b64_tr_b16 v[50:51], v8 offset:41984
v_mfma_f32_16x16x32_bf16 v[36:39], v[56:59], v[148:151], v[36:39]
ds_read_b64_tr_b16 v[52:53], v8 offset:45056
v_mfma_f32_16x16x32_bf16 v[36:39], v[60:63], v[156:159], v[36:39]
ds_read_b64_tr_b16 v[54:55], v8 offset:46080
s_waitcnt lgkmcnt(10)
v_mfma_f32_16x16x32_bf16 v[24:27], v[64:67], v[144:147], v[24:27]
ds_read_b64_tr_b16 v[56:57], v9 offset:40960
s_waitcnt lgkmcnt(9)
v_mfma_f32_16x16x32_bf16 v[24:27], v[68:71], v[152:155], v[24:27]
ds_read_b64_tr_b16 v[58:59], v9 offset:41984
v_mfma_f32_16x16x32_bf16 v[40:43], v[64:67], v[148:151], v[40:43]
ds_read_b64_tr_b16 v[60:61], v9 offset:45056
v_mfma_f32_16x16x32_bf16 v[40:43], v[68:71], v[156:159], v[40:43]
ds_read_b64_tr_b16 v[62:63], v9 offset:46080
s_waitcnt lgkmcnt(10)
v_mfma_f32_16x16x32_bf16 v[28:31], v[72:75], v[144:147], v[28:31]
ds_read_b64_tr_b16 v[64:65], v10 offset:40960
s_waitcnt lgkmcnt(9)
v_mfma_f32_16x16x32_bf16 v[28:31], v[76:79], v[152:155], v[28:31]
ds_read_b64_tr_b16 v[66:67], v10 offset:41984
v_mfma_f32_16x16x32_bf16 v[44:47], v[72:75], v[148:151], v[44:47]
ds_read_b64_tr_b16 v[68:69], v10 offset:45056
v_mfma_f32_16x16x32_bf16 v[44:47], v[76:79], v[156:159], v[44:47]
ds_read_b64_tr_b16 v[70:71], v10 offset:46080
s_waitcnt vmcnt(27) lgkmcnt(10)
v_mfma_f32_16x16x32_bf16 v[16:19], v[48:51], v[160:163], v[16:19]
ds_read_b64_tr_b16 v[72:73], v11 offset:40960
buffer_load_dwordx4 v[144:147], v6, s[20:23], s66 offen offset:0 sc1
s_waitcnt vmcnt(27) lgkmcnt(9)
v_mfma_f32_16x16x32_bf16 v[16:19], v[52:55], v[168:171], v[16:19]
ds_read_b64_tr_b16 v[74:75], v11 offset:41984
buffer_load_dwordx4 v[152:155], v6, s[20:23], s66 offen offset:2048 sc1
s_waitcnt vmcnt(27)
v_mfma_f32_16x16x32_bf16 v[32:35], v[48:51], v[164:167], v[32:35]
ds_read_b64_tr_b16 v[76:77], v11 offset:45056
buffer_load_dwordx4 v[148:151], v6, s[20:23], s66 offen offset:256 sc1
s_waitcnt vmcnt(27)
v_mfma_f32_16x16x32_bf16 v[32:35], v[52:55], v[172:175], v[32:35]
ds_read_b64_tr_b16 v[78:79], v11 offset:46080
buffer_load_dwordx4 v[156:159], v6, s[20:23], s66 offen offset:2304 sc1
s_waitcnt lgkmcnt(10)
v_mfma_f32_16x16x32_bf16 v[20:23], v[56:59], v[160:163], v[20:23]
ds_read_b64_tr_b16 v[48:49], v8 offset:49152
s_add_u32 s66, s66, 4096
s_and_b32 s66, s66, 0xffff
s_waitcnt lgkmcnt(9)
v_mfma_f32_16x16x32_bf16 v[20:23], v[60:63], v[168:171], v[20:23]
ds_read_b64_tr_b16 v[50:51], v8 offset:50176
v_mfma_f32_16x16x32_bf16 v[36:39], v[56:59], v[164:167], v[36:39]
ds_read_b64_tr_b16 v[52:53], v8 offset:53248
v_mfma_f32_16x16x32_bf16 v[36:39], v[60:63], v[172:175], v[36:39]
ds_read_b64_tr_b16 v[54:55], v8 offset:54272
s_waitcnt lgkmcnt(10)
v_mfma_f32_16x16x32_bf16 v[24:27], v[64:67], v[160:163], v[24:27]
ds_read_b64_tr_b16 v[56:57], v9 offset:49152
s_waitcnt lgkmcnt(9)
v_mfma_f32_16x16x32_bf16 v[24:27], v[68:71], v[168:171], v[24:27]
ds_read_b64_tr_b16 v[58:59], v9 offset:50176
v_mfma_f32_16x16x32_bf16 v[40:43], v[64:67], v[164:167], v[40:43]
ds_read_b64_tr_b16 v[60:61], v9 offset:53248
v_mfma_f32_16x16x32_bf16 v[40:43], v[68:71], v[172:175], v[40:43]
ds_read_b64_tr_b16 v[62:63], v9 offset:54272
s_waitcnt lgkmcnt(10)
v_mfma_f32_16x16x32_bf16 v[28:31], v[72:75], v[160:163], v[28:31]
ds_read_b64_tr_b16 v[64:65], v10 offset:49152
s_waitcnt lgkmcnt(9)
v_mfma_f32_16x16x32_bf16 v[28:31], v[76:79], v[168:171], v[28:31]
ds_read_b64_tr_b16 v[66:67], v10 offset:50176
v_mfma_f32_16x16x32_bf16 v[44:47], v[72:75], v[164:167], v[44:47]
ds_read_b64_tr_b16 v[68:69], v10 offset:53248
v_mfma_f32_16x16x32_bf16 v[44:47], v[76:79], v[172:175], v[44:47]
ds_read_b64_tr_b16 v[70:71], v10 offset:54272
s_waitcnt vmcnt(27) lgkmcnt(10)
v_mfma_f32_16x16x32_bf16 v[16:19], v[48:51], v[176:179], v[16:19]
ds_read_b64_tr_b16 v[72:73], v11 offset:49152
buffer_load_dwordx4 v[160:163], v6, s[20:23], s66 offen offset:0 sc1
s_waitcnt vmcnt(27) lgkmcnt(9)
v_mfma_f32_16x16x32_bf16 v[16:19], v[52:55], v[184:187], v[16:19]
ds_read_b64_tr_b16 v[74:75], v11 offset:50176
buffer_load_dwordx4 v[168:171], v6, s[20:23], s66 offen offset:2048 sc1
s_waitcnt vmcnt(27)
v_mfma_f32_16x16x32_bf16 v[32:35], v[48:51], v[180:183], v[32:35]
ds_read_b64_tr_b16 v[76:77], v11 offset:53248
buffer_load_dwordx4 v[164:167], v6, s[20:23], s66 offen offset:256 sc1
s_waitcnt vmcnt(27)
v_mfma_f32_16x16x32_bf16 v[32:35], v[52:55], v[188:191], v[32:35]
ds_read_b64_tr_b16 v[78:79], v11 offset:54272
buffer_load_dwordx4 v[172:175], v6, s[20:23], s66 offen offset:2304 sc1
s_waitcnt lgkmcnt(10)
v_mfma_f32_16x16x32_bf16 v[20:23], v[56:59], v[176:179], v[20:23]
ds_read_b64_tr_b16 v[48:49], v8 offset:57344
s_add_u32 s66, s66, 4096
s_and_b32 s66, s66, 0xffff
s_waitcnt lgkmcnt(9)
v_mfma_f32_16x16x32_bf16 v[20:23], v[60:63], v[184:187], v[20:23]
ds_read_b64_tr_b16 v[50:51], v8 offset:58368
v_mfma_f32_16x16x32_bf16 v[36:39], v[56:59], v[180:183], v[36:39]
ds_read_b64_tr_b16 v[52:53], v8 offset:61440
v_mfma_f32_16x16x32_bf16 v[36:39], v[60:63], v[188:191], v[36:39]
ds_read_b64_tr_b16 v[54:55], v8 offset:62464
s_waitcnt lgkmcnt(10)
v_mfma_f32_16x16x32_bf16 v[24:27], v[64:67], v[176:179], v[24:27]
ds_read_b64_tr_b16 v[56:57], v9 offset:57344
s_waitcnt lgkmcnt(9)
v_mfma_f32_16x16x32_bf16 v[24:27], v[68:71], v[184:187], v[24:27]
ds_read_b64_tr_b16 v[58:59], v9 offset:58368
v_mfma_f32_16x16x32_bf16 v[40:43], v[64:67], v[180:183], v[40:43]
ds_read_b64_tr_b16 v[60:61], v9 offset:61440
v_mfma_f32_16x16x32_bf16 v[40:43], v[68:71], v[188:191], v[40:43]
ds_read_b64_tr_b16 v[62:63], v9 offset:62464
s_waitcnt lgkmcnt(10)
v_mfma_f32_16x16x32_bf16 v[28:31], v[72:75], v[176:179], v[28:31]
ds_read_b64_tr_b16 v[64:65], v10 offset:57344
s_waitcnt lgkmcnt(9)
v_mfma_f32_16x16x32_bf16 v[28:31], v[76:79], v[184:187], v[28:31]
ds_read_b64_tr_b16 v[66:67], v10 offset:58368
v_mfma_f32_16x16x32_bf16 v[44:47], v[72:75], v[180:183], v[44:47]
ds_read_b64_tr_b16 v[68:69], v10 offset:61440
v_mfma_f32_16x16x32_bf16 v[44:47], v[76:79], v[188:191], v[44:47]
ds_read_b64_tr_b16 v[70:71], v10 offset:62464
s_waitcnt vmcnt(27) lgkmcnt(10)
v_mfma_f32_16x16x32_bf16 v[16:19], v[48:51], v[192:195], v[16:19]
ds_read_b64_tr_b16 v[72:73], v11 offset:57344
buffer_load_dwordx4 v[176:179], v6, s[20:23], s66 offen offset:0 sc1
s_waitcnt vmcnt(27) lgkmcnt(9)
v_mfma_f32_16x16x32_bf16 v[16:19], v[52:55], v[200:203], v[16:19]
ds_read_b64_tr_b16 v[74:75], v11 offset:58368
buffer_load_dwordx4 v[184:187], v6, s[20:23], s66 offen offset:2048 sc1
s_waitcnt vmcnt(27)
v_mfma_f32_16x16x32_bf16 v[32:35], v[48:51], v[196:199], v[32:35]
ds_read_b64_tr_b16 v[76:77], v11 offset:61440
buffer_load_dwordx4 v[180:183], v6, s[20:23], s66 offen offset:256 sc1
s_waitcnt vmcnt(27)
v_mfma_f32_16x16x32_bf16 v[32:35], v[52:55], v[204:207], v[32:35]
ds_read_b64_tr_b16 v[78:79], v11 offset:62464
buffer_load_dwordx4 v[188:191], v6, s[20:23], s66 offen offset:2304 sc1
s_waitcnt lgkmcnt(10)
v_mfma_f32_16x16x32_bf16 v[20:23], v[56:59], v[192:195], v[20:23]
ds_read_b64_tr_b16 v[48:49], v12 offset:0
s_add_u32 s66, s66, 4096
s_and_b32 s66, s66, 0xffff
s_waitcnt lgkmcnt(9)
v_mfma_f32_16x16x32_bf16 v[20:23], v[60:63], v[200:203], v[20:23]
ds_read_b64_tr_b16 v[50:51], v12 offset:1024
v_mfma_f32_16x16x32_bf16 v[36:39], v[56:59], v[196:199], v[36:39]
ds_read_b64_tr_b16 v[52:53], v12 offset:4096
v_mfma_f32_16x16x32_bf16 v[36:39], v[60:63], v[204:207], v[36:39]
ds_read_b64_tr_b16 v[54:55], v12 offset:5120
s_waitcnt lgkmcnt(10)
v_mfma_f32_16x16x32_bf16 v[24:27], v[64:67], v[192:195], v[24:27]
ds_read_b64_tr_b16 v[56:57], v13 offset:0
s_waitcnt lgkmcnt(9)
v_mfma_f32_16x16x32_bf16 v[24:27], v[68:71], v[200:203], v[24:27]
ds_read_b64_tr_b16 v[58:59], v13 offset:1024
v_mfma_f32_16x16x32_bf16 v[40:43], v[64:67], v[196:199], v[40:43]
ds_read_b64_tr_b16 v[60:61], v13 offset:4096
v_mfma_f32_16x16x32_bf16 v[40:43], v[68:71], v[204:207], v[40:43]
ds_read_b64_tr_b16 v[62:63], v13 offset:5120
s_waitcnt lgkmcnt(10)
v_mfma_f32_16x16x32_bf16 v[28:31], v[72:75], v[192:195], v[28:31]
ds_read_b64_tr_b16 v[64:65], v14 offset:0
s_waitcnt lgkmcnt(9)
v_mfma_f32_16x16x32_bf16 v[28:31], v[76:79], v[200:203], v[28:31]
ds_read_b64_tr_b16 v[66:67], v14 offset:1024
v_mfma_f32_16x16x32_bf16 v[44:47], v[72:75], v[196:199], v[44:47]
ds_read_b64_tr_b16 v[68:69], v14 offset:4096
v_mfma_f32_16x16x32_bf16 v[44:47], v[76:79], v[204:207], v[44:47]
ds_read_b64_tr_b16 v[70:71], v14 offset:5120
s_waitcnt vmcnt(27) lgkmcnt(10)
v_mfma_f32_16x16x32_bf16 v[16:19], v[48:51], v[80:83], v[16:19]
ds_read_b64_tr_b16 v[72:73], v15 offset:0
buffer_load_dwordx4 v[192:195], v6, s[20:23], s66 offen offset:0 sc1
s_waitcnt vmcnt(27) lgkmcnt(9)
v_mfma_f32_16x16x32_bf16 v[16:19], v[52:55], v[88:91], v[16:19]
ds_read_b64_tr_b16 v[74:75], v15 offset:1024
buffer_load_dwordx4 v[200:203], v6, s[20:23], s66 offen offset:2048 sc1
s_waitcnt vmcnt(27)
v_mfma_f32_16x16x32_bf16 v[32:35], v[48:51], v[84:87], v[32:35]
ds_read_b64_tr_b16 v[76:77], v15 offset:4096
buffer_load_dwordx4 v[196:199], v6, s[20:23], s66 offen offset:256 sc1
s_waitcnt vmcnt(27)
v_mfma_f32_16x16x32_bf16 v[32:35], v[52:55], v[92:95], v[32:35]
ds_read_b64_tr_b16 v[78:79], v15 offset:5120
buffer_load_dwordx4 v[204:207], v6, s[20:23], s66 offen offset:2304 sc1
s_waitcnt lgkmcnt(10)
v_mfma_f32_16x16x32_bf16 v[20:23], v[56:59], v[80:83], v[20:23]
ds_read_b64_tr_b16 v[48:49], v12 offset:8192
s_add_u32 s66, s66, 4096
s_and_b32 s66, s66, 0xffff
s_waitcnt lgkmcnt(9)
v_mfma_f32_16x16x32_bf16 v[20:23], v[60:63], v[88:91], v[20:23]
ds_read_b64_tr_b16 v[50:51], v12 offset:9216
v_mfma_f32_16x16x32_bf16 v[36:39], v[56:59], v[84:87], v[36:39]
ds_read_b64_tr_b16 v[52:53], v12 offset:12288
v_mfma_f32_16x16x32_bf16 v[36:39], v[60:63], v[92:95], v[36:39]
ds_read_b64_tr_b16 v[54:55], v12 offset:13312
s_waitcnt lgkmcnt(10)
v_mfma_f32_16x16x32_bf16 v[24:27], v[64:67], v[80:83], v[24:27]
ds_read_b64_tr_b16 v[56:57], v13 offset:8192
s_waitcnt lgkmcnt(9)
v_mfma_f32_16x16x32_bf16 v[24:27], v[68:71], v[88:91], v[24:27]
ds_read_b64_tr_b16 v[58:59], v13 offset:9216
v_mfma_f32_16x16x32_bf16 v[40:43], v[64:67], v[84:87], v[40:43]
ds_read_b64_tr_b16 v[60:61], v13 offset:12288
v_mfma_f32_16x16x32_bf16 v[40:43], v[68:71], v[92:95], v[40:43]
ds_read_b64_tr_b16 v[62:63], v13 offset:13312
s_waitcnt lgkmcnt(10)
v_mfma_f32_16x16x32_bf16 v[28:31], v[72:75], v[80:83], v[28:31]
ds_read_b64_tr_b16 v[64:65], v14 offset:8192
s_waitcnt lgkmcnt(9)
v_mfma_f32_16x16x32_bf16 v[28:31], v[76:79], v[88:91], v[28:31]
ds_read_b64_tr_b16 v[66:67], v14 offset:9216
v_mfma_f32_16x16x32_bf16 v[44:47], v[72:75], v[84:87], v[44:47]
ds_read_b64_tr_b16 v[68:69], v14 offset:12288
v_mfma_f32_16x16x32_bf16 v[44:47], v[76:79], v[92:95], v[44:47]
ds_read_b64_tr_b16 v[70:71], v14 offset:13312
s_waitcnt vmcnt(27) lgkmcnt(10)
v_mfma_f32_16x16x32_bf16 v[16:19], v[48:51], v[96:99], v[16:19]
ds_read_b64_tr_b16 v[72:73], v15 offset:8192
s_waitcnt vmcnt(26) lgkmcnt(9)
v_mfma_f32_16x16x32_bf16 v[16:19], v[52:55], v[104:107], v[16:19]
ds_read_b64_tr_b16 v[74:75], v15 offset:9216
s_waitcnt vmcnt(25)
v_mfma_f32_16x16x32_bf16 v[32:35], v[48:51], v[100:103], v[32:35]
ds_read_b64_tr_b16 v[76:77], v15 offset:12288
s_waitcnt vmcnt(24)
v_mfma_f32_16x16x32_bf16 v[32:35], v[52:55], v[108:111], v[32:35]
ds_read_b64_tr_b16 v[78:79], v15 offset:13312
s_waitcnt lgkmcnt(10)
v_mfma_f32_16x16x32_bf16 v[20:23], v[56:59], v[96:99], v[20:23]
ds_read_b64_tr_b16 v[48:49], v12 offset:16384
s_waitcnt lgkmcnt(9)
v_mfma_f32_16x16x32_bf16 v[20:23], v[60:63], v[104:107], v[20:23]
ds_read_b64_tr_b16 v[50:51], v12 offset:17408
v_mfma_f32_16x16x32_bf16 v[36:39], v[56:59], v[100:103], v[36:39]
ds_read_b64_tr_b16 v[52:53], v12 offset:20480
v_mfma_f32_16x16x32_bf16 v[36:39], v[60:63], v[108:111], v[36:39]
ds_read_b64_tr_b16 v[54:55], v12 offset:21504
s_waitcnt lgkmcnt(10)
v_mfma_f32_16x16x32_bf16 v[24:27], v[64:67], v[96:99], v[24:27]
ds_read_b64_tr_b16 v[56:57], v13 offset:16384
s_waitcnt lgkmcnt(9)
v_mfma_f32_16x16x32_bf16 v[24:27], v[68:71], v[104:107], v[24:27]
ds_read_b64_tr_b16 v[58:59], v13 offset:17408
v_mfma_f32_16x16x32_bf16 v[40:43], v[64:67], v[100:103], v[40:43]
ds_read_b64_tr_b16 v[60:61], v13 offset:20480
v_mfma_f32_16x16x32_bf16 v[40:43], v[68:71], v[108:111], v[40:43]
ds_read_b64_tr_b16 v[62:63], v13 offset:21504
s_waitcnt lgkmcnt(10)
v_mfma_f32_16x16x32_bf16 v[28:31], v[72:75], v[96:99], v[28:31]
ds_read_b64_tr_b16 v[64:65], v14 offset:16384
s_waitcnt lgkmcnt(9)
v_mfma_f32_16x16x32_bf16 v[28:31], v[76:79], v[104:107], v[28:31]
ds_read_b64_tr_b16 v[66:67], v14 offset:17408
v_mfma_f32_16x16x32_bf16 v[44:47], v[72:75], v[100:103], v[44:47]
ds_read_b64_tr_b16 v[68:69], v14 offset:20480
v_mfma_f32_16x16x32_bf16 v[44:47], v[76:79], v[108:111], v[44:47]
ds_read_b64_tr_b16 v[70:71], v14 offset:21504
s_waitcnt vmcnt(23) lgkmcnt(10)
v_mfma_f32_16x16x32_bf16 v[16:19], v[48:51], v[112:115], v[16:19]
ds_read_b64_tr_b16 v[72:73], v15 offset:16384
s_waitcnt vmcnt(22) lgkmcnt(9)
v_mfma_f32_16x16x32_bf16 v[16:19], v[52:55], v[120:123], v[16:19]
ds_read_b64_tr_b16 v[74:75], v15 offset:17408
s_waitcnt vmcnt(21)
v_mfma_f32_16x16x32_bf16 v[32:35], v[48:51], v[116:119], v[32:35]
ds_read_b64_tr_b16 v[76:77], v15 offset:20480
s_waitcnt vmcnt(20)
v_mfma_f32_16x16x32_bf16 v[32:35], v[52:55], v[124:127], v[32:35]
ds_read_b64_tr_b16 v[78:79], v15 offset:21504
s_waitcnt lgkmcnt(10)
v_mfma_f32_16x16x32_bf16 v[20:23], v[56:59], v[112:115], v[20:23]
ds_read_b64_tr_b16 v[48:49], v12 offset:24576
s_waitcnt lgkmcnt(9)
v_mfma_f32_16x16x32_bf16 v[20:23], v[60:63], v[120:123], v[20:23]
ds_read_b64_tr_b16 v[50:51], v12 offset:25600
v_mfma_f32_16x16x32_bf16 v[36:39], v[56:59], v[116:119], v[36:39]
ds_read_b64_tr_b16 v[52:53], v12 offset:28672
v_mfma_f32_16x16x32_bf16 v[36:39], v[60:63], v[124:127], v[36:39]
ds_read_b64_tr_b16 v[54:55], v12 offset:29696
s_waitcnt lgkmcnt(10)
v_mfma_f32_16x16x32_bf16 v[24:27], v[64:67], v[112:115], v[24:27]
ds_read_b64_tr_b16 v[56:57], v13 offset:24576
s_waitcnt lgkmcnt(9)
v_mfma_f32_16x16x32_bf16 v[24:27], v[68:71], v[120:123], v[24:27]
ds_read_b64_tr_b16 v[58:59], v13 offset:25600
v_mfma_f32_16x16x32_bf16 v[40:43], v[64:67], v[116:119], v[40:43]
ds_read_b64_tr_b16 v[60:61], v13 offset:28672
v_mfma_f32_16x16x32_bf16 v[40:43], v[68:71], v[124:127], v[40:43]
ds_read_b64_tr_b16 v[62:63], v13 offset:29696
s_waitcnt lgkmcnt(10)
v_mfma_f32_16x16x32_bf16 v[28:31], v[72:75], v[112:115], v[28:31]
ds_read_b64_tr_b16 v[64:65], v14 offset:24576
s_waitcnt lgkmcnt(9)
v_mfma_f32_16x16x32_bf16 v[28:31], v[76:79], v[120:123], v[28:31]
ds_read_b64_tr_b16 v[66:67], v14 offset:25600
v_mfma_f32_16x16x32_bf16 v[44:47], v[72:75], v[116:119], v[44:47]
ds_read_b64_tr_b16 v[68:69], v14 offset:28672
v_mfma_f32_16x16x32_bf16 v[44:47], v[76:79], v[124:127], v[44:47]
ds_read_b64_tr_b16 v[70:71], v14 offset:29696
s_waitcnt vmcnt(19) lgkmcnt(10)
v_mfma_f32_16x16x32_bf16 v[16:19], v[48:51], v[128:131], v[16:19]
ds_read_b64_tr_b16 v[72:73], v15 offset:24576
s_waitcnt vmcnt(18) lgkmcnt(9)
v_mfma_f32_16x16x32_bf16 v[16:19], v[52:55], v[136:139], v[16:19]
ds_read_b64_tr_b16 v[74:75], v15 offset:25600
s_waitcnt vmcnt(17)
v_mfma_f32_16x16x32_bf16 v[32:35], v[48:51], v[132:135], v[32:35]
ds_read_b64_tr_b16 v[76:77], v15 offset:28672
s_waitcnt vmcnt(16)
v_mfma_f32_16x16x32_bf16 v[32:35], v[52:55], v[140:143], v[32:35]
ds_read_b64_tr_b16 v[78:79], v15 offset:29696
s_waitcnt lgkmcnt(10)
v_mfma_f32_16x16x32_bf16 v[20:23], v[56:59], v[128:131], v[20:23]
ds_read_b64_tr_b16 v[48:49], v12 offset:32768
s_waitcnt lgkmcnt(9)
v_mfma_f32_16x16x32_bf16 v[20:23], v[60:63], v[136:139], v[20:23]
ds_read_b64_tr_b16 v[50:51], v12 offset:33792
v_mfma_f32_16x16x32_bf16 v[36:39], v[56:59], v[132:135], v[36:39]
ds_read_b64_tr_b16 v[52:53], v12 offset:36864
v_mfma_f32_16x16x32_bf16 v[36:39], v[60:63], v[140:143], v[36:39]
ds_read_b64_tr_b16 v[54:55], v12 offset:37888
s_waitcnt lgkmcnt(10)
v_mfma_f32_16x16x32_bf16 v[24:27], v[64:67], v[128:131], v[24:27]
ds_read_b64_tr_b16 v[56:57], v13 offset:32768
s_waitcnt lgkmcnt(9)
v_mfma_f32_16x16x32_bf16 v[24:27], v[68:71], v[136:139], v[24:27]
ds_read_b64_tr_b16 v[58:59], v13 offset:33792
v_mfma_f32_16x16x32_bf16 v[40:43], v[64:67], v[132:135], v[40:43]
ds_read_b64_tr_b16 v[60:61], v13 offset:36864
v_mfma_f32_16x16x32_bf16 v[40:43], v[68:71], v[140:143], v[40:43]
ds_read_b64_tr_b16 v[62:63], v13 offset:37888
s_waitcnt lgkmcnt(10)
v_mfma_f32_16x16x32_bf16 v[28:31], v[72:75], v[128:131], v[28:31]
ds_read_b64_tr_b16 v[64:65], v14 offset:32768
s_waitcnt lgkmcnt(9)
v_mfma_f32_16x16x32_bf16 v[28:31], v[76:79], v[136:139], v[28:31]
ds_read_b64_tr_b16 v[66:67], v14 offset:33792
v_mfma_f32_16x16x32_bf16 v[44:47], v[72:75], v[132:135], v[44:47]
ds_read_b64_tr_b16 v[68:69], v14 offset:36864
v_mfma_f32_16x16x32_bf16 v[44:47], v[76:79], v[140:143], v[44:47]
ds_read_b64_tr_b16 v[70:71], v14 offset:37888
s_waitcnt vmcnt(15) lgkmcnt(10)
v_mfma_f32_16x16x32_bf16 v[16:19], v[48:51], v[144:147], v[16:19]
ds_read_b64_tr_b16 v[72:73], v15 offset:32768
s_waitcnt vmcnt(14) lgkmcnt(9)
v_mfma_f32_16x16x32_bf16 v[16:19], v[52:55], v[152:155], v[16:19]
ds_read_b64_tr_b16 v[74:75], v15 offset:33792
s_waitcnt vmcnt(13)
v_mfma_f32_16x16x32_bf16 v[32:35], v[48:51], v[148:151], v[32:35]
ds_read_b64_tr_b16 v[76:77], v15 offset:36864
s_waitcnt vmcnt(12)
v_mfma_f32_16x16x32_bf16 v[32:35], v[52:55], v[156:159], v[32:35]
ds_read_b64_tr_b16 v[78:79], v15 offset:37888
s_waitcnt lgkmcnt(10)
v_mfma_f32_16x16x32_bf16 v[20:23], v[56:59], v[144:147], v[20:23]
ds_read_b64_tr_b16 v[48:49], v12 offset:40960
s_waitcnt lgkmcnt(9)
v_mfma_f32_16x16x32_bf16 v[20:23], v[60:63], v[152:155], v[20:23]
ds_read_b64_tr_b16 v[50:51], v12 offset:41984
v_mfma_f32_16x16x32_bf16 v[36:39], v[56:59], v[148:151], v[36:39]
ds_read_b64_tr_b16 v[52:53], v12 offset:45056
v_mfma_f32_16x16x32_bf16 v[36:39], v[60:63], v[156:159], v[36:39]
ds_read_b64_tr_b16 v[54:55], v12 offset:46080
s_waitcnt lgkmcnt(10)
v_mfma_f32_16x16x32_bf16 v[24:27], v[64:67], v[144:147], v[24:27]
ds_read_b64_tr_b16 v[56:57], v13 offset:40960
s_waitcnt lgkmcnt(9)
v_mfma_f32_16x16x32_bf16 v[24:27], v[68:71], v[152:155], v[24:27]
ds_read_b64_tr_b16 v[58:59], v13 offset:41984
v_mfma_f32_16x16x32_bf16 v[40:43], v[64:67], v[148:151], v[40:43]
ds_read_b64_tr_b16 v[60:61], v13 offset:45056
v_mfma_f32_16x16x32_bf16 v[40:43], v[68:71], v[156:159], v[40:43]
ds_read_b64_tr_b16 v[62:63], v13 offset:46080
s_waitcnt lgkmcnt(10)
v_mfma_f32_16x16x32_bf16 v[28:31], v[72:75], v[144:147], v[28:31]
ds_read_b64_tr_b16 v[64:65], v14 offset:40960
s_waitcnt lgkmcnt(9)
v_mfma_f32_16x16x32_bf16 v[28:31], v[76:79], v[152:155], v[28:31]
ds_read_b64_tr_b16 v[66:67], v14 offset:41984
v_mfma_f32_16x16x32_bf16 v[44:47], v[72:75], v[148:151], v[44:47]
ds_read_b64_tr_b16 v[68:69], v14 offset:45056
v_mfma_f32_16x16x32_bf16 v[44:47], v[76:79], v[156:159], v[44:47]
ds_read_b64_tr_b16 v[70:71], v14 offset:46080
s_waitcnt vmcnt(11) lgkmcnt(10)
v_mfma_f32_16x16x32_bf16 v[16:19], v[48:51], v[160:163], v[16:19]
ds_read_b64_tr_b16 v[72:73], v15 offset:40960
s_waitcnt vmcnt(10) lgkmcnt(9)
v_mfma_f32_16x16x32_bf16 v[16:19], v[52:55], v[168:171], v[16:19]
ds_read_b64_tr_b16 v[74:75], v15 offset:41984
s_waitcnt vmcnt(9)
v_mfma_f32_16x16x32_bf16 v[32:35], v[48:51], v[164:167], v[32:35]
ds_read_b64_tr_b16 v[76:77], v15 offset:45056
s_waitcnt vmcnt(8)
v_mfma_f32_16x16x32_bf16 v[32:35], v[52:55], v[172:175], v[32:35]
ds_read_b64_tr_b16 v[78:79], v15 offset:46080
s_waitcnt lgkmcnt(10)
v_mfma_f32_16x16x32_bf16 v[20:23], v[56:59], v[160:163], v[20:23]
ds_read_b64_tr_b16 v[48:49], v12 offset:49152
s_waitcnt lgkmcnt(9)
v_mfma_f32_16x16x32_bf16 v[20:23], v[60:63], v[168:171], v[20:23]
ds_read_b64_tr_b16 v[50:51], v12 offset:50176
v_mfma_f32_16x16x32_bf16 v[36:39], v[56:59], v[164:167], v[36:39]
ds_read_b64_tr_b16 v[52:53], v12 offset:53248
v_mfma_f32_16x16x32_bf16 v[36:39], v[60:63], v[172:175], v[36:39]
ds_read_b64_tr_b16 v[54:55], v12 offset:54272
s_waitcnt lgkmcnt(10)
v_mfma_f32_16x16x32_bf16 v[24:27], v[64:67], v[160:163], v[24:27]
ds_read_b64_tr_b16 v[56:57], v13 offset:49152
s_waitcnt lgkmcnt(9)
v_mfma_f32_16x16x32_bf16 v[24:27], v[68:71], v[168:171], v[24:27]
ds_read_b64_tr_b16 v[58:59], v13 offset:50176
v_mfma_f32_16x16x32_bf16 v[40:43], v[64:67], v[164:167], v[40:43]
ds_read_b64_tr_b16 v[60:61], v13 offset:53248
v_mfma_f32_16x16x32_bf16 v[40:43], v[68:71], v[172:175], v[40:43]
ds_read_b64_tr_b16 v[62:63], v13 offset:54272
s_waitcnt lgkmcnt(10)
v_mfma_f32_16x16x32_bf16 v[28:31], v[72:75], v[160:163], v[28:31]
ds_read_b64_tr_b16 v[64:65], v14 offset:49152
s_waitcnt lgkmcnt(9)
v_mfma_f32_16x16x32_bf16 v[28:31], v[76:79], v[168:171], v[28:31]
ds_read_b64_tr_b16 v[66:67], v14 offset:50176
v_mfma_f32_16x16x32_bf16 v[44:47], v[72:75], v[164:167], v[44:47]
ds_read_b64_tr_b16 v[68:69], v14 offset:53248
v_mfma_f32_16x16x32_bf16 v[44:47], v[76:79], v[172:175], v[44:47]
ds_read_b64_tr_b16 v[70:71], v14 offset:54272
s_waitcnt vmcnt(7) lgkmcnt(10)
v_mfma_f32_16x16x32_bf16 v[16:19], v[48:51], v[176:179], v[16:19]
ds_read_b64_tr_b16 v[72:73], v15 offset:49152
s_waitcnt vmcnt(6) lgkmcnt(9)
v_mfma_f32_16x16x32_bf16 v[16:19], v[52:55], v[184:187], v[16:19]
ds_read_b64_tr_b16 v[74:75], v15 offset:50176
s_waitcnt vmcnt(5)
v_mfma_f32_16x16x32_bf16 v[32:35], v[48:51], v[180:183], v[32:35]
ds_read_b64_tr_b16 v[76:77], v15 offset:53248
s_waitcnt vmcnt(4)
v_mfma_f32_16x16x32_bf16 v[32:35], v[52:55], v[188:191], v[32:35]
ds_read_b64_tr_b16 v[78:79], v15 offset:54272
s_waitcnt lgkmcnt(10)
v_mfma_f32_16x16x32_bf16 v[20:23], v[56:59], v[176:179], v[20:23]
ds_read_b64_tr_b16 v[48:49], v12 offset:57344
s_waitcnt lgkmcnt(9)
v_mfma_f32_16x16x32_bf16 v[20:23], v[60:63], v[184:187], v[20:23]
ds_read_b64_tr_b16 v[50:51], v12 offset:58368
v_mfma_f32_16x16x32_bf16 v[36:39], v[56:59], v[180:183], v[36:39]
ds_read_b64_tr_b16 v[52:53], v12 offset:61440
v_mfma_f32_16x16x32_bf16 v[36:39], v[60:63], v[188:191], v[36:39]
ds_read_b64_tr_b16 v[54:55], v12 offset:62464
s_waitcnt lgkmcnt(10)
v_mfma_f32_16x16x32_bf16 v[24:27], v[64:67], v[176:179], v[24:27]
ds_read_b64_tr_b16 v[56:57], v13 offset:57344
s_waitcnt lgkmcnt(9)
v_mfma_f32_16x16x32_bf16 v[24:27], v[68:71], v[184:187], v[24:27]
ds_read_b64_tr_b16 v[58:59], v13 offset:58368
v_mfma_f32_16x16x32_bf16 v[40:43], v[64:67], v[180:183], v[40:43]
ds_read_b64_tr_b16 v[60:61], v13 offset:61440
v_mfma_f32_16x16x32_bf16 v[40:43], v[68:71], v[188:191], v[40:43]
ds_read_b64_tr_b16 v[62:63], v13 offset:62464
s_waitcnt lgkmcnt(10)
v_mfma_f32_16x16x32_bf16 v[28:31], v[72:75], v[176:179], v[28:31]
ds_read_b64_tr_b16 v[64:65], v14 offset:57344
s_waitcnt lgkmcnt(9)
v_mfma_f32_16x16x32_bf16 v[28:31], v[76:79], v[184:187], v[28:31]
ds_read_b64_tr_b16 v[66:67], v14 offset:58368
v_mfma_f32_16x16x32_bf16 v[44:47], v[72:75], v[180:183], v[44:47]
ds_read_b64_tr_b16 v[68:69], v14 offset:61440
v_mfma_f32_16x16x32_bf16 v[44:47], v[76:79], v[188:191], v[44:47]
ds_read_b64_tr_b16 v[70:71], v14 offset:62464
s_waitcnt vmcnt(3) lgkmcnt(10)
v_mfma_f32_16x16x32_bf16 v[16:19], v[48:51], v[192:195], v[16:19]
ds_read_b64_tr_b16 v[72:73], v15 offset:57344
s_waitcnt vmcnt(2) lgkmcnt(9)
v_mfma_f32_16x16x32_bf16 v[16:19], v[52:55], v[200:203], v[16:19]
ds_read_b64_tr_b16 v[74:75], v15 offset:58368
s_waitcnt vmcnt(1)
v_mfma_f32_16x16x32_bf16 v[32:35], v[48:51], v[196:199], v[32:35]
ds_read_b64_tr_b16 v[76:77], v15 offset:61440
s_waitcnt vmcnt(0)
v_mfma_f32_16x16x32_bf16 v[32:35], v[52:55], v[204:207], v[32:35]
ds_read_b64_tr_b16 v[78:79], v15 offset:62464
s_waitcnt lgkmcnt(10)
v_mfma_f32_16x16x32_bf16 v[20:23], v[56:59], v[192:195], v[20:23]
v_add_u32 v5, s34, 22
s_mov_b64 exec, 1
ds_write_b32 v3, v5
s_mov_b64 exec, -1
s_waitcnt lgkmcnt(9)
v_mfma_f32_16x16x32_bf16 v[20:23], v[60:63], v[200:203], v[20:23]
v_mfma_f32_16x16x32_bf16 v[36:39], v[56:59], v[196:199], v[36:39]
v_mfma_f32_16x16x32_bf16 v[36:39], v[60:63], v[204:207], v[36:39]
s_waitcnt lgkmcnt(7)
v_mfma_f32_16x16x32_bf16 v[24:27], v[64:67], v[192:195], v[24:27]
s_waitcnt lgkmcnt(5)
v_mfma_f32_16x16x32_bf16 v[24:27], v[68:71], v[200:203], v[24:27]
v_mfma_f32_16x16x32_bf16 v[40:43], v[64:67], v[196:199], v[40:43]
v_mfma_f32_16x16x32_bf16 v[40:43], v[68:71], v[204:207], v[40:43]
s_waitcnt lgkmcnt(3)
v_mfma_f32_16x16x32_bf16 v[28:31], v[72:75], v[192:195], v[28:31]
s_waitcnt lgkmcnt(1)
v_mfma_f32_16x16x32_bf16 v[28:31], v[76:79], v[200:203], v[28:31]
v_mfma_f32_16x16x32_bf16 v[44:47], v[72:75], v[196:199], v[44:47]
v_mfma_f32_16x16x32_bf16 v[44:47], v[76:79], v[204:207], v[44:47]
s_lshl2_add_u32 s73, s61, s58
s_lshl4_add_u32 s66, s61, s62
s_lshl2_add_u32 s68, s66, s58
s_lshl_b32 s68, s68, 12
s_add_u32 s68, s68, 26214400
s_lshl_b32 s66, s61, 7
s_add_u32 s66, s66, s62
s_lshl_b32 s66, s66, 7
s_add_u32 s66, s66, 274432
s_lshl_b32 s74, s73, 13
s_add_u32 s74, s74, 524288
s_lshl_b32 s67, s62, 9
s_add_u32 s67, s67, s74
v_lshlrev_b32 v6, 4, v0
s_mov_b32 s69, 0x3f803f80
v_mov_b32 v8, 0
v_mov_b32 v9, 0
v_mov_b32 v10, 0
v_mov_b32 v11, 0
v_mov_b32 v12, 0
v_mov_b32 v13, 0
v_mov_b32 v14, 0
v_dot2c_f32_bf16 v11, s69, v232
v_dot2c_f32_bf16 v11, s69, v233
v_dot2c_f32_bf16 v11, s69, v234
v_dot2c_f32_bf16 v11, s69, v235
v_dot2c_f32_bf16 v11, s69, v236
v_dot2c_f32_bf16 v11, s69, v237
v_dot2c_f32_bf16 v11, s69, v238
v_dot2c_f32_bf16 v11, s69, v239
s_cmp_eq_u32 s63, 0
v_cvt_pk_bf16_f32 v240, v16, v17
v_cvt_pk_bf16_f32 v241, v18, v19
v_cvt_pk_bf16_f32 v242, v20, v21
v_cvt_pk_bf16_f32 v243, v22, v23
v_cvt_pk_bf16_f32 v244, v24, v25
v_cvt_pk_bf16_f32 v245, v26, v27
v_cvt_pk_bf16_f32 v246, v28, v29
v_cvt_pk_bf16_f32 v247, v30, v31
v_cvt_pk_bf16_f32 v248, v32, v33
v_cvt_pk_bf16_f32 v249, v34, v35
v_cvt_pk_bf16_f32 v250, v36, v37
v_cvt_pk_bf16_f32 v251, v38, v39
v_cvt_pk_bf16_f32 v252, v40, v41
v_cvt_pk_bf16_f32 v253, v42, v43
v_cvt_pk_bf16_f32 v254, v44, v45
v_cvt_pk_bf16_f32 v255, v46, v47
s_cselect_b64 exec, -1, 0
s_cmp_eq_u32 s57, 0
s_cbranch_scc1 far_166
buffer_store_dwordx4 v[240:243], v6, s[20:23], s68 offen offset:0
buffer_store_dwordx4 v[244:247], v6, s[20:23], s68 offen offset:1024
buffer_store_dwordx4 v[248:251], v6, s[20:23], s68 offen offset:2048
buffer_store_dwordx4 v[252:255], v6, s[20:23], s68 offen offset:3072
near_167:
s_mov_b64 exec, -1
v_dot2c_f32_bf16 v8, s69, v240
v_dot2c_f32_bf16 v9, v240, v240
v_dot2c_f32_bf16 v10, v232, v240
v_dot2c_f32_bf16 v12, s69, v248
v_dot2c_f32_bf16 v13, v248, v248
v_dot2c_f32_bf16 v14, v232, v248
v_dot2c_f32_bf16 v8, s69, v241
v_dot2c_f32_bf16 v9, v241, v241
v_dot2c_f32_bf16 v10, v233, v241
v_dot2c_f32_bf16 v12, s69, v249
v_dot2c_f32_bf16 v13, v249, v249
v_dot2c_f32_bf16 v14, v233, v249
v_dot2c_f32_bf16 v8, s69, v242
v_dot2c_f32_bf16 v9, v242, v242
v_dot2c_f32_bf16 v10, v234, v242
v_dot2c_f32_bf16 v12, s69, v250
v_dot2c_f32_bf16 v13, v250, v250
v_dot2c_f32_bf16 v14, v234, v250
v_dot2c_f32_bf16 v8, s69, v243
v_dot2c_f32_bf16 v9, v243, v243
v_dot2c_f32_bf16 v10, v235, v243
v_dot2c_f32_bf16 v12, s69, v251
v_dot2c_f32_bf16 v13, v251, v251
v_dot2c_f32_bf16 v14, v235, v251
v_dot2c_f32_bf16 v8, s69, v244
v_dot2c_f32_bf16 v9, v244, v244
v_dot2c_f32_bf16 v10, v236, v244
v_dot2c_f32_bf16 v12, s69, v252
v_dot2c_f32_bf16 v13, v252, v252
v_dot2c_f32_bf16 v14, v236, v252
v_dot2c_f32_bf16 v8, s69, v245
v_dot2c_f32_bf16 v9, v245, v245
v_dot2c_f32_bf16 v10, v237, v245
v_dot2c_f32_bf16 v12, s69, v253
v_dot2c_f32_bf16 v13, v253, v253
v_dot2c_f32_bf16 v14, v237, v253
v_dot2c_f32_bf16 v8, s69, v246
v_dot2c_f32_bf16 v9, v246, v246
v_dot2c_f32_bf16 v10, v238, v246
v_dot2c_f32_bf16 v12, s69, v254
v_dot2c_f32_bf16 v13, v254, v254
v_dot2c_f32_bf16 v14, v238, v254
v_dot2c_f32_bf16 v8, s69, v247
v_dot2c_f32_bf16 v9, v247, v247
v_dot2c_f32_bf16 v10, v239, v247
v_dot2c_f32_bf16 v12, s69, v255
v_dot2c_f32_bf16 v13, v255, v255
v_dot2c_f32_bf16 v14, v239, v255
v_mov_b32 v15, v11
v_lshrrev_b32 v7, 5, v0
v_mul_u32_u24 v7, 3584, v7
v_permlane16_swap_b32 v8, v12
v_permlane16_swap_b32 v9, v13
v_permlane16_swap_b32 v10, v14
v_permlane16_swap_b32 v11, v15
v_pk_add_f32 v[8:9], v[8:9], v[12:13]
v_pk_add_f32 v[10:11], v[10:11], v[14:15]
v_mov_b32 v12, v8
v_mov_b32 v13, v9
v_mov_b32 v14, v10
v_mov_b32 v15, v11
v_permlane32_swap_b32 v12, v8
v_permlane32_swap_b32 v13, v9
v_permlane32_swap_b32 v14, v10
v_permlane32_swap_b32 v15, v11
v_pk_add_f32 v[8:9], v[8:9], v[12:13]
v_pk_add_f32 v[10:11], v[10:11], v[14:15]
v_add_u32 v7, v6, v7
v_max_u32 v8, 1, v8
v_max_u32 v9, 1, v9
v_max_u32 v10, 1, v10
v_max_u32 v11, 1, v11
s_mov_b32 exec_hi, 0
s_cmp_eq_u32 s57, 0
s_cbranch_scc1 far_168
buffer_store_dwordx4 v[8:11], v6, s[24:27], s67 offen
near_169:
s_mov_b32 exec_hi, -1
v_lshlrev_b32 v16, 16, v240
v_and_b32 v17, 0xffff0000, v240
v_lshlrev_b32 v18, 16, v241
v_and_b32 v19, 0xffff0000, v241
v_lshlrev_b32 v20, 16, v242
v_and_b32 v21, 0xffff0000, v242
v_lshlrev_b32 v22, 16, v243
v_and_b32 v23, 0xffff0000, v243
v_lshlrev_b32 v24, 16, v244
v_and_b32 v25, 0xffff0000, v244
v_lshlrev_b32 v26, 16, v245
v_and_b32 v27, 0xffff0000, v245
v_lshlrev_b32 v28, 16, v246
v_and_b32 v29, 0xffff0000, v246
v_lshlrev_b32 v30, 16, v247
v_and_b32 v31, 0xffff0000, v247
v_lshlrev_b32 v32, 16, v248
v_and_b32 v33, 0xffff0000, v248
v_lshlrev_b32 v34, 16, v249
v_and_b32 v35, 0xffff0000, v249
v_lshlrev_b32 v36, 16, v250
v_and_b32 v37, 0xffff0000, v250
v_lshlrev_b32 v38, 16, v251
v_and_b32 v39, 0xffff0000, v251
v_lshlrev_b32 v40, 16, v252
v_and_b32 v41, 0xffff0000, v252
v_lshlrev_b32 v42, 16, v253
v_and_b32 v43, 0xffff0000, v253
v_lshlrev_b32 v44, 16, v254
v_and_b32 v45, 0xffff0000, v254
v_lshlrev_b32 v46, 16, v255
v_and_b32 v47, 0xffff0000, v255
v_and_b32 v14, 15, v0
v_lshlrev_b32 v14, 11, v14
v_bfe_u32 v15, v0, 4, 1
v_lshl_add_u32 v14, v15, 5, v14
v_lshrrev_b32 v15, 5, v0
v_lshl_add_u32 v14, v15, 4, v14
s_lshl2_add_u32 s70, s61, s58
s_lshl_b32 s70, s70, 16
s_lshl_b32 s71, s62, 7
s_add_u32 s70, s70, s71
s_add_u32 s71, s70, 0x8000
s_lshl_b32 s67, s62, 6
s_sub_u32 s68, s66, 2048
s_lshl1_add_u32 s69, s67, s68
s_sub_u32 s69, s69, 10240
s_sub_u32 s72, s68, s67
s_add_u32 s72, s72, 4096
s_lshl_b32 s75, s73, 5
s_add_u32 s75, s75, 1
v_and_b32 v15, 48, v0
v_add_u32 v13, s75, v0
v_lshlrev_b32 v4, 1, v15
s_mov_b64 exec, 1
s_waitcnt vmcnt(1)
s_cmp_eq_u32 s57, 0
s_cbranch_scc1 far_170
buffer_store_dword v212, v3, s[24:27], s66 offen
near_171:
s_mov_b64 exec, -1
v_add_u32 v5, s34, 23
s_mov_b64 exec, 1
ds_write_b32 v3, v5
s_mov_b64 exec, -1
s_waitcnt vmcnt(1)
buffer_load_dwordx4 v[80:83], v7, s[24:27], s74 offen offset:0 sc1
buffer_load_dwordx4 v[84:87], v7, s[24:27], s74 offen offset:512 sc1
buffer_load_dwordx4 v[88:91], v7, s[24:27], s74 offen offset:1024 sc1
buffer_load_dwordx4 v[92:95], v7, s[24:27], s74 offen offset:1536 sc1
buffer_load_dwordx4 v[96:99], v7, s[24:27], s74 offen offset:2048 sc1
buffer_load_dwordx4 v[100:103], v7, s[24:27], s74 offen offset:2560 sc1
buffer_load_dwordx4 v[104:107], v7, s[24:27], s74 offen offset:3072 sc1
buffer_load_dwordx4 v[108:111], v7, s[24:27], s74 offen offset:3584 sc1
s_cmp_eq_u32 s63, 0
s_cbranch_scc0 mhz_172
v_lshrrev_b32 v196, 4, v0
s_cmp_eq_u32 1, 0
s_cbranch_scc0 mq_173
v_bfe_u32 v197, v0, 1, 3
v_xor_b32 v197, v197, v196
v_lshlrev_b32 v197, 4, v197
v_and_b32 v198, 15, v0
v_lshl_add_u32 v192, v198, 7, v197
v_xor_b32 v193, 64, v192
s_branch mq_174
mq_173:
v_lshlrev_b32 v192, 4, v0
v_add_u32 v193, 1024, v192
mq_174:
s_lshl_b32 s46, s65, 13
s_add_u32 s46, s46, 86016
v_add_u32 v192, s46, v192
v_add_u32 v193, s46, v193
v_bfe_u32 v197, v0, 2, 2
v_lshl_add_u32 v197, v196, 3, v197
v_bfe_u32 v198, v0, 3, 2
s_lshl_b32 s46, s64, 1
v_xor_b32 v198, s46, v198
v_lshlrev_b32 v198, 5, v198
v_lshl_add_u32 v197, v197, 7, v198
v_and_b32 v198, 3, v0
v_lshl_add_u32 v197, v198, 3, v197
v_add_u32 v194, 102400, v197
v_xor_b32 v195, 32, v194
v_mov_b32 v197, 0xf149f2ca
v_xor_b32 v216, v197, v216
v_xor_b32 v217, v197, v217
v_xor_b32 v218, v197, v218
v_xor_b32 v219, v197, v219
v_xor_b32 v220, v197, v220
v_xor_b32 v221, v197, v221
v_xor_b32 v222, v197, v222
v_xor_b32 v223, v197, v223
v_xor_b32 v224, v197, v224
v_xor_b32 v225, v197, v225
v_xor_b32 v226, v197, v226
v_xor_b32 v227, v197, v227
v_xor_b32 v228, v197, v228
v_xor_b32 v229, v197, v229
v_xor_b32 v230, v197, v230
v_xor_b32 v231, v197, v231
v_and_b32 v196, 15, v0
v_lshrrev_b32 v197, 4, v0
s_lshl_b32 s46, s65, 8
s_add_u32 s46, s46, 1280
s_mul_i32 s47, s64, 384
v_lshl_add_u32 v208, v196, 2, s46
v_lshl_add_u32 v209, v197, 4, s46
v_lshl_add_u32 v210, v196, 2, s47
v_lshl_add_u32 v211, v197, 4, s47
v_and_b32 v198, 1, v197
v_lshrrev_b32 v197, 1, v197
v_lshlrev_b32 v197, 9, v197
v_lshl_add_u32 v197, v198, 10, v197
s_lshl_b32 s46, s64, 12
s_lshl_b32 s47, s65, 13
s_add_u32 s46, s46, 131072
s_add_u32 s48, s46, 24576
s_sub_u32 s48, s48, s47
s_add_u32 s47, s46, s47
v_lshl_add_u32 v200, v196, 4, v197
v_and_b32 v198, 3, v0
v_lshl_add_u32 v197, v198, 4, v197
v_bfe_u32 v198, v0, 3, 1
v_lshl_add_u32 v197, v198, 6, v197
v_bfe_u32 v198, v0, 2, 1
v_lshl_add_u32 v198, v198, 8, v197
v_add_u32 v199, s48, v198
v_add_u32 v198, s47, v198
v_add_u32 v201, s48, v200
v_add_u32 v200, s47, v200
s_lshl_b32 s46, s59, 4
s_add_u32 s46, s46, s60
s_lshl_b32 s50, s59, 7
s_add_u32 s50, s50, s60
s_lshl_b32 s50, s50, 7
s_lshl_b32 s46, s46, 15
s_lshl_b32 s47, 1, 23
s_add_u32 s46, s46, s47
s_add_u32 s49, s46, 917504
mhz_172:
s_branch pchk_176
poll_175:
buffer_load_dwordx4 v[80:83], v7, s[24:27], s74 offen offset:0 sc1
buffer_load_dwordx4 v[84:87], v7, s[24:27], s74 offen offset:512 sc1
buffer_load_dwordx4 v[88:91], v7, s[24:27], s74 offen offset:1024 sc1
buffer_load_dwordx4 v[92:95], v7, s[24:27], s74 offen offset:1536 sc1
buffer_load_dwordx4 v[96:99], v7, s[24:27], s74 offen offset:2048 sc1
buffer_load_dwordx4 v[100:103], v7, s[24:27], s74 offen offset:2560 sc1
buffer_load_dwordx4 v[104:107], v7, s[24:27], s74 offen offset:3072 sc1
buffer_load_dwordx4 v[108:111], v7, s[24:27], s74 offen offset:3584 sc1
pchk_176:
s_waitcnt vmcnt(7)
v_min3_u32 v8, v80, v81, v82
s_waitcnt vmcnt(6)
v_min3_u32 v8, v8, v83, v84
v_min3_u32 v8, v8, v85, v86
s_waitcnt vmcnt(5)
v_min3_u32 v8, v8, v87, v88
v_min3_u32 v8, v8, v89, v90
s_waitcnt vmcnt(4)
v_min3_u32 v8, v8, v91, v92
v_min3_u32 v8, v8, v93, v94
s_waitcnt vmcnt(3)
v_min3_u32 v8, v8, v95, v96
v_min3_u32 v8, v8, v97, v98
s_waitcnt vmcnt(2)
v_min3_u32 v8, v8, v99, v100
v_min3_u32 v8, v8, v101, v102
s_waitcnt vmcnt(1)
v_min3_u32 v8, v8, v103, v104
v_min3_u32 v8, v8, v105, v106
s_waitcnt vmcnt(0)
v_min3_u32 v8, v8, v107, v108
v_min3_u32 v8, v8, v109, v110
v_min_u32 v8, v8, v111
v_cmp_eq_u32 vcc, 0, v8
s_cbranch_vccz pdone_177
s_sub_u32 s32, s32, 1
s_cmp_gt_i32 s32, 0
s_cbranch_scc1 poll_175
pdone_177:
v_pk_add_f32 v[80:81], v[80:81], v[96:97]
v_pk_add_f32 v[82:83], v[82:83], v[98:99]
v_pk_add_f32 v[84:85], v[84:85], v[100:101]
v_pk_add_f32 v[86:87], v[86:87], v[102:103]
v_pk_add_f32 v[88:89], v[88:89], v[104:105]
v_pk_add_f32 v[90:91], v[90:91], v[106:107]
v_pk_add_f32 v[92:93], v[92:93], v[108:109]
v_pk_add_f32 v[94:95], v[94:95], v[110:111]
v_pk_add_f32 v[80:81], v[80:81], v[88:89]
v_pk_add_f32 v[82:83], v[82:83], v[90:91]
v_pk_add_f32 v[84:85], v[84:85], v[92:93]
v_pk_add_f32 v[86:87], v[86:87], v[94:95]
v_pk_add_f32 v[80:81], v[80:81], v[84:85]
v_pk_add_f32 v[82:83], v[82:83], v[86:87]
v_mov_b32 v8, v80
v_mov_b32 v9, v81
v_mov_b32 v10, v82
v_mov_b32 v11, v83
v_permlane32_swap_b32 v8, v80
v_permlane32_swap_b32 v9, v81
v_permlane32_swap_b32 v10, v82
v_permlane32_swap_b32 v11, v83
v_pk_add_f32 v[8:9], v[8:9], v[80:81]
v_pk_add_f32 v[10:11], v[10:11], v[82:83]
v_mul_f32 v8, 0xba800000, v8
v_mul_f32 v9, 0x3a800000, v9
v_fma_f32 v9, -v8, v8, v9
v_max_f32 v9, 0, v9
v_add_f32 v12, 0x3727c5ac, v9
v_rsq_f32 v80, v12
v_fma_f32 v10, v8, v11, v10
v_mul_f32 v12, v80, v10
v_max_u32 v12, 1, v12
v_add_u32 v7, s34, v3
v_mov_b32 v6, v12
s_nop 1
v_max_f32_dpp v6, v6, v6 row_ror:1 row_mask:0xf bank_mask:0xf
s_nop 1
v_max_f32_dpp v6, v6, v6 row_ror:2 row_mask:0xf bank_mask:0xf
s_nop 1
v_max_f32_dpp v6, v6, v6 row_ror:4 row_mask:0xf bank_mask:0xf
s_nop 1
v_max_f32_dpp v6, v6, v6 row_ror:8 row_mask:0xf bank_mask:0xf
v_mov_b32 v11, v6
s_nop 1
v_permlane16_swap_b32 v11, v6
v_max_f32 v6, v6, v11
v_cmp_eq_f32 vcc, v6, v12
s_ff1_i32_b64 s66, vcc
s_and_b32 s66, s66, 31
s_mov_b64 exec, 1
ds_write_b32 v7, v6 offset:256
s_mov_b64 exec, -1
v_add_u32 v7, s34, v1
v_mul_f32 v81, v8, v80
v_add_f32 v10, 1.0, v80
v_mov_b32 v82, v80
v_mov_b32 v83, v81
s_and_b32 s67, s66, 15
s_lshl_b32 s67, 0x10001, s67
s_bitcmp0_b32 s66, 4
v_permlane16_swap_b32 v80, v82
v_permlane16_swap_b32 v81, v83
s_cselect_b32 s76, s67, 0
s_cselect_b32 s78, 0, s67
s_cselect_b32 s77, s67, 0
s_cselect_b32 s79, 0, s67
s_add_u32 s75, s75, s66
v_pk_fma_f32 v[48:49], v[16:17], v[80:81], v[80:81] op_sel:[0,0,1] op_sel_hi:[1,0,1]
v_pk_fma_f32 v[50:51], v[18:19], v[80:81], v[80:81] op_sel:[0,0,1] op_sel_hi:[1,0,1]
v_pk_fma_f32 v[52:53], v[20:21], v[80:81], v[80:81] op_sel:[0,0,1] op_sel_hi:[1,0,1]
v_pk_fma_f32 v[54:55], v[22:23], v[80:81], v[80:81] op_sel:[0,0,1] op_sel_hi:[1,0,1]
v_pk_fma_f32 v[56:57], v[24:25], v[80:81], v[80:81] op_sel:[0,0,1] op_sel_hi:[1,0,1]
v_pk_fma_f32 v[58:59], v[26:27], v[80:81], v[80:81] op_sel:[0,0,1] op_sel_hi:[1,0,1]
v_pk_fma_f32 v[60:61], v[28:29], v[80:81], v[80:81] op_sel:[0,0,1] op_sel_hi:[1,0,1]
v_pk_fma_f32 v[62:63], v[30:31], v[80:81], v[80:81] op_sel:[0,0,1] op_sel_hi:[1,0,1]
v_pk_fma_f32 v[64:65], v[32:33], v[82:83], v[82:83] op_sel:[0,0,1] op_sel_hi:[1,0,1]
v_pk_fma_f32 v[66:67], v[34:35], v[82:83], v[82:83] op_sel:[0,0,1] op_sel_hi:[1,0,1]
v_pk_fma_f32 v[68:69], v[36:37], v[82:83], v[82:83] op_sel:[0,0,1] op_sel_hi:[1,0,1]
v_pk_fma_f32 v[70:71], v[38:39], v[82:83], v[82:83] op_sel:[0,0,1] op_sel_hi:[1,0,1]
v_pk_fma_f32 v[72:73], v[40:41], v[82:83], v[82:83] op_sel:[0,0,1] op_sel_hi:[1,0,1]
v_pk_fma_f32 v[74:75], v[42:43], v[82:83], v[82:83] op_sel:[0,0,1] op_sel_hi:[1,0,1]
v_pk_fma_f32 v[76:77], v[44:45], v[82:83], v[82:83] op_sel:[0,0,1] op_sel_hi:[1,0,1]
v_pk_fma_f32 v[78:79], v[46:47], v[82:83], v[82:83] op_sel:[0,0,1] op_sel_hi:[1,0,1]
v_cvt_pk_bf16_f32 v84, v48, v49
v_cvt_pk_bf16_f32 v85, v50, v51
v_cvt_pk_bf16_f32 v86, v52, v53
v_cvt_pk_bf16_f32 v87, v54, v55
v_cvt_pk_bf16_f32 v88, v56, v57
v_cvt_pk_bf16_f32 v89, v58, v59
v_cvt_pk_bf16_f32 v90, v60, v61
v_cvt_pk_bf16_f32 v91, v62, v63
v_cvt_pk_bf16_f32 v92, v64, v65
v_cvt_pk_bf16_f32 v93, v66, v67
v_cvt_pk_bf16_f32 v94, v68, v69
v_cvt_pk_bf16_f32 v95, v70, v71
v_cvt_pk_bf16_f32 v96, v72, v73
v_cvt_pk_bf16_f32 v97, v74, v75
v_cvt_pk_bf16_f32 v98, v76, v77
v_cvt_pk_bf16_f32 v99, v78, v79
ds_read_b32 v11, v7 offset:256
v_max_u32 v84, 1, v84
v_max_u32 v85, 1, v85
v_max_u32 v86, 1, v86
v_max_u32 v87, 1, v87
v_max_u32 v88, 1, v88
v_max_u32 v89, 1, v89
v_max_u32 v90, 1, v90
v_max_u32 v91, 1, v91
v_max_u32 v92, 1, v92
v_max_u32 v93, 1, v93
v_max_u32 v94, 1, v94
v_max_u32 v95, 1, v95
v_max_u32 v96, 1, v96
v_max_u32 v97, 1, v97
v_max_u32 v98, 1, v98
v_max_u32 v99, 1, v99
s_branch pchk_179
poll_178:
ds_read_b32 v11, v7 offset:256
pchk_179:
s_waitcnt lgkmcnt(0)
v_cmp_eq_u32 vcc, 0, v11
s_cbranch_vccz pdone_180
s_sub_u32 s32, s32, 1
s_cmp_gt_i32 s32, 0
s_cbranch_scc1 poll_178
pdone_180:
v_cmp_eq_f32 vcc, v11, v6
s_bfm_b32 s67, s58, 0
s_and_b32 s67, s67, vcc_lo
v_cmp_gt_f32 vcc, v11, v6
s_lshl_b32 s66, 1, s66
s_or_b32 s67, s67, vcc_lo
s_cselect_b64 s[76:77], 0, s[76:77]
s_cselect_b64 s[78:79], 0, s[78:79]
s_cselect_b64 exec, 0, s[66:67]
s_bitcmp0_b32 s62, 0
s_cselect_b64 exec, exec, 0
buffer_store_dwordx2 v[12:13], off, s[24:27], s72 sc1
s_mov_b64 exec, s[76:77]
buffer_store_dwordx4 v[84:87], v4, s[24:27], s68 offen offset:0 sc1
buffer_store_dwordx4 v[88:91], v4, s[24:27], s68 offen offset:16 sc1
s_mov_b64 exec, s[78:79]
buffer_store_dwordx4 v[92:95], v4, s[24:27], s68 offen offset:0 sc1
buffer_store_dwordx4 v[96:99], v4, s[24:27], s68 offen offset:16 sc1
s_mov_b64 exec, -1
v_add_u32 v5, s34, 24
s_mov_b64 exec, 1
ds_write_b32 v3, v5
s_mov_b64 exec, -1
v_pk_add_f32 v[16:17], v[16:17], v[48:49]
v_pk_add_f32 v[18:19], v[18:19], v[50:51]
v_pk_add_f32 v[20:21], v[20:21], v[52:53]
v_pk_add_f32 v[22:23], v[22:23], v[54:55]
v_pk_add_f32 v[24:25], v[24:25], v[56:57]
v_pk_add_f32 v[26:27], v[26:27], v[58:59]
v_pk_add_f32 v[28:29], v[28:29], v[60:61]
v_pk_add_f32 v[30:31], v[30:31], v[62:63]
v_pk_add_f32 v[32:33], v[32:33], v[64:65]
v_pk_add_f32 v[34:35], v[34:35], v[66:67]
v_pk_add_f32 v[36:37], v[36:37], v[68:69]
v_pk_add_f32 v[38:39], v[38:39], v[70:71]
v_pk_add_f32 v[40:41], v[40:41], v[72:73]
v_pk_add_f32 v[42:43], v[42:43], v[74:75]
v_pk_add_f32 v[44:45], v[44:45], v[76:77]
v_pk_add_f32 v[46:47], v[46:47], v[78:79]
v_cvt_pk_bf16_f32 v240, v16, v17
v_cvt_pk_bf16_f32 v241, v18, v19
v_cvt_pk_bf16_f32 v242, v20, v21
v_cvt_pk_bf16_f32 v243, v22, v23
v_cvt_pk_bf16_f32 v244, v24, v25
v_cvt_pk_bf16_f32 v245, v26, v27
v_cvt_pk_bf16_f32 v246, v28, v29
v_cvt_pk_bf16_f32 v247, v30, v31
v_cvt_pk_bf16_f32 v248, v32, v33
v_cvt_pk_bf16_f32 v249, v34, v35
v_cvt_pk_bf16_f32 v250, v36, v37
v_cvt_pk_bf16_f32 v251, v38, v39
v_cvt_pk_bf16_f32 v252, v40, v41
v_cvt_pk_bf16_f32 v253, v42, v43
v_cvt_pk_bf16_f32 v254, v44, v45
v_cvt_pk_bf16_f32 v255, v46, v47
v_max_u32 v16, 1, v16
v_max_u32 v17, 1, v17
v_max_u32 v18, 1, v18
v_max_u32 v19, 1, v19
v_max_u32 v20, 1, v20
v_max_u32 v21, 1, v21
v_max_u32 v22, 1, v22
v_max_u32 v23, 1, v23
v_max_u32 v24, 1, v24
v_max_u32 v25, 1, v25
v_max_u32 v26, 1, v26
v_max_u32 v27, 1, v27
v_max_u32 v28, 1, v28
v_max_u32 v29, 1, v29
v_max_u32 v30, 1, v30
v_max_u32 v31, 1, v31
v_max_u32 v32, 1, v32
v_max_u32 v33, 1, v33
v_max_u32 v34, 1, v34
v_max_u32 v35, 1, v35
v_max_u32 v36, 1, v36
v_max_u32 v37, 1, v37
v_max_u32 v38, 1, v38
v_max_u32 v39, 1, v39
v_max_u32 v40, 1, v40
v_max_u32 v41, 1, v41
v_max_u32 v42, 1, v42
v_max_u32 v43, 1, v43
v_max_u32 v44, 1, v44
v_max_u32 v45, 1, v45
v_max_u32 v46, 1, v46
v_max_u32 v47, 1, v47
s_mov_b64 exec, s[76:77]
buffer_store_dwordx4 v[16:19], v15, s[24:27], s69 offen offset:0 sc1
buffer_store_dwordx4 v[20:23], v15, s[24:27], s69 offen offset:64 sc1
buffer_store_dwordx4 v[24:27], v15, s[24:27], s69 offen offset:128 sc1
buffer_store_dwordx4 v[28:31], v15, s[24:27], s69 offen offset:192 sc1
s_mov_b64 exec, s[78:79]
buffer_store_dwordx4 v[32:35], v15, s[24:27], s69 offen offset:0 sc1
buffer_store_dwordx4 v[36:39], v15, s[24:27], s69 offen offset:64 sc1
buffer_store_dwordx4 v[40:43], v15, s[24:27], s69 offen offset:128 sc1
buffer_store_dwordx4 v[44:47], v15, s[24:27], s69 offen offset:192 sc1
s_mov_b64 exec, -1
s_cmp_eq_u32 s63, 0
s_cbranch_scc0 mout_181
v_mul_f32 v11, v10, v10
v_mov_b32 v12, 0x3727c5ac
v_fma_f32 v11, v11, v9, v12
v_rsq_f32 v11, v11
v_lshrrev_b32 v12, 3, v0
v_lshlrev_b32 v12, 6, v12
v_lshl_add_u32 v12, v0, 3, v12
v_mul_f32 v10, v10, v11
v_mul_f32 v11, v8, v10
s_lshl_b32 s66, s61, 5
s_add_u32 s66, s66, s58
s_lshl_b32 s66, s66, 9
s_add_u32 s66, s66, 1675264
v_max_u32 v11, 1, v11
s_cmp_eq_u32 s62, 8
s_cselect_b32 exec_lo, -1, 0
s_mov_b32 exec_hi, 0
s_cmp_eq_u32 s57, 0
s_cbranch_scc1 far_182
buffer_store_dwordx2 v[10:11], v12, s[24:27], s66 offen
near_183:
s_mov_b64 exec, -1
s_mov_b32 s63, 1
s_mov_b32 s34, 32
s_add_u32 s24, s24, 1409024
s_addc_u32 s25, s25, 0
s_mov_b32 s26, 1409024
s_branch L_mtop
mout_181:
v_permlane16_swap_b32 v240, v242
v_permlane16_swap_b32 v241, v243
v_permlane16_swap_b32 v244, v246
v_permlane16_swap_b32 v245, v247
v_permlane16_swap_b32 v248, v250
v_permlane16_swap_b32 v249, v251
v_permlane16_swap_b32 v252, v254
v_permlane16_swap_b32 v253, v255
s_not_b64 exec, s[76:77]
buffer_store_dwordx4 v[240:243], v14, s[28:31], s70 offen offset:0
buffer_store_dwordx4 v[244:247], v14, s[28:31], s70 offen offset:64
s_not_b64 exec, s[78:79]
buffer_store_dwordx4 v[248:251], v14, s[28:31], s71 offen offset:0
buffer_store_dwordx4 v[252:255], v14, s[28:31], s71 offen offset:64
s_mov_b64 exec, -1
s_or_b32 s66, s76, s78
s_cbranch_scc0 L_end
v_mov_b32 v11, 0
s_add_u32 s35, s34, 4
lw_184:
ds_read_b32 v5, v2 offset:24
s_waitcnt lgkmcnt(0)
v_cmp_gt_i32 vcc, s35, v5
s_cbranch_vccz lwd_185
s_sleep 2
s_sub_u32 s32, s32, 1
s_cmp_gt_i32 s32, 0
s_cbranch_scc1 lw_184
lwd_185:
ds_read_b32 v11, v11 offset:32
s_waitcnt lgkmcnt(0)
v_cmp_eq_u32 vcc, s75, v11
s_cbranch_vccnz L_end
s_mov_b64 exec, s[76:77]
buffer_store_dwordx4 v[240:243], v14, s[28:31], s70 offen offset:0
buffer_store_dwordx4 v[244:247], v14, s[28:31], s70 offen offset:64
s_mov_b64 exec, s[78:79]
buffer_store_dwordx4 v[248:251], v14, s[28:31], s71 offen offset:0
buffer_store_dwordx4 v[252:255], v14, s[28:31], s71 offen offset:64
s_mov_b64 exec, -1
s_branch L_end
mspin_129:
ds_read_b32 v5, v2 offset:16
s_waitcnt lgkmcnt(0)
v_cmp_ge_u32 vcc, v4, v5
s_cbranch_vccz mback_130
s_sub_u32 s32, s32, 1
s_cmp_gt_i32 s32, 0
s_cbranch_scc1 mspin_129
s_branch mback_130
mspin_127:
msp_186:
ds_read_b32 v5, v2 offset:16
s_waitcnt lgkmcnt(0)
v_cmp_ge_u32 vcc, v4, v5
s_cbranch_vccz mback_128
s_sub_u32 s32, s32, 1
s_cmp_gt_i32 s32, 0
s_cbranch_scc1 msp_186
s_branch mback_128
lspin_131:
s_add_u32 s35, s34, 2
lw_187:
ds_read_b32 v5, v2 offset:24
s_waitcnt lgkmcnt(0)
v_cmp_gt_i32 vcc, s35, v5
s_cbranch_vccz lwd_188
s_sub_u32 s32, s32, 1
s_cmp_gt_i32 s32, 0
s_cbranch_scc1 lw_187
lwd_188:
s_branch lback_132
patch_133:
s_bfe_u32 s66, s33, 0x20005
s_lshr_b32 s67, s66, 1
s_xor_b32 s66, s66, s67
s_and_b32 s66, s66, 1
s_cmp_eq_u32 s66, s65
s_cbranch_scc0 pback_134
s_bfe_u32 s66, s33, 0x10004
s_lshl1_add_u32 s73, s67, s66
s_and_b32 s66, s33, 15
s_mov_b32 s74, 0x10001
s_mov_b32 s75, s74
s_lshl_b64 s[74:75], s[74:75], s66
s_and_b32 s66, s66, 12
s_lshl_b32 s66, s66, 2
s_bfm_b64 s[76:77], 16, s66
s_nop 7
s_mov_b64 exec, s[74:75]
s_cmp_eq_u32 s73, 0
s_cbranch_scc0 pnx_190
ds_read_b128 v[16:19], v211 offset:3456
ds_read_b128 v[20:23], v211 offset:3520
s_branch pdn_189
pnx_190:
s_cmp_eq_u32 s73, 1
s_cbranch_scc0 pnx_191
ds_read_b128 v[24:27], v211 offset:3456
ds_read_b128 v[28:31], v211 offset:3520
s_branch pdn_189
pnx_191:
s_cmp_eq_u32 s73, 2
s_cbranch_scc0 pnx_192
ds_read_b128 v[32:35], v211 offset:3456
ds_read_b128 v[36:39], v211 offset:3520
s_branch pdn_189
pnx_192:
ds_read_b128 v[40:43], v211 offset:3456
ds_read_b128 v[44:47], v211 offset:3520
pdn_189:
s_mov_b64 exec, -1
s_waitcnt lgkmcnt(0)
s_branch pback_134
patch_135:
s_nop 7
s_nop 7
s_and_b32 s66, s33, 3
s_lshl2_add_u32 s66, s73, s66
s_mov_b64 exec, s[76:77]
s_cmp_eq_u32 s66, 0
s_cbranch_scc0 pnx_195
ds_read_b32 v48, v210 offset:3584
ds_read_b32 v52, v210 offset:3648
s_branch pdn_194
pnx_195:
s_cmp_eq_u32 s66, 1
s_cbranch_scc0 pnx_196
ds_read_b32 v49, v210 offset:3584
ds_read_b32 v53, v210 offset:3648
s_branch pdn_194
pnx_196:
s_cmp_eq_u32 s66, 2
s_cbranch_scc0 pnx_197
ds_read_b32 v50, v210 offset:3584
ds_read_b32 v54, v210 offset:3648
s_branch pdn_194
pnx_197:
s_cmp_eq_u32 s66, 3
s_cbranch_scc0 pnx_198
ds_read_b32 v51, v210 offset:3584
ds_read_b32 v55, v210 offset:3648
s_branch pdn_194
pnx_198:
s_cmp_eq_u32 s66, 4
s_cbranch_scc0 pnx_199
ds_read_b32 v56, v210 offset:3584
ds_read_b32 v60, v210 offset:3648
s_branch pdn_194
pnx_199:
s_cmp_eq_u32 s66, 5
s_cbranch_scc0 pnx_200
ds_read_b32 v57, v210 offset:3584
ds_read_b32 v61, v210 offset:3648
s_branch pdn_194
pnx_200:
s_cmp_eq_u32 s66, 6
s_cbranch_scc0 pnx_201
ds_read_b32 v58, v210 offset:3584
ds_read_b32 v62, v210 offset:3648
s_branch pdn_194
pnx_201:
s_cmp_eq_u32 s66, 7
s_cbranch_scc0 pnx_202
ds_read_b32 v59, v210 offset:3584
ds_read_b32 v63, v210 offset:3648
s_branch pdn_194
pnx_202:
s_cmp_eq_u32 s66, 8
s_cbranch_scc0 pnx_203
ds_read_b32 v64, v210 offset:3584
ds_read_b32 v68, v210 offset:3648
s_branch pdn_194
pnx_203:
s_cmp_eq_u32 s66, 9
s_cbranch_scc0 pnx_204
ds_read_b32 v65, v210 offset:3584
ds_read_b32 v69, v210 offset:3648
s_branch pdn_194
pnx_204:
s_cmp_eq_u32 s66, 10
s_cbranch_scc0 pnx_205
ds_read_b32 v66, v210 offset:3584
ds_read_b32 v70, v210 offset:3648
s_branch pdn_194
pnx_205:
s_cmp_eq_u32 s66, 11
s_cbranch_scc0 pnx_206
ds_read_b32 v67, v210 offset:3584
ds_read_b32 v71, v210 offset:3648
s_branch pdn_194
pnx_206:
s_cmp_eq_u32 s66, 12
s_cbranch_scc0 pnx_207
ds_read_b32 v72, v210 offset:3584
ds_read_b32 v76, v210 offset:3648
s_branch pdn_194
pnx_207:
s_cmp_eq_u32 s66, 13
s_cbranch_scc0 pnx_208
ds_read_b32 v73, v210 offset:3584
ds_read_b32 v77, v210 offset:3648
s_branch pdn_194
pnx_208:
s_cmp_eq_u32 s66, 14
s_cbranch_scc0 pnx_209
ds_read_b32 v74, v210 offset:3584
ds_read_b32 v78, v210 offset:3648
s_branch pdn_194
pnx_209:
ds_read_b32 v75, v210 offset:3584
ds_read_b32 v79, v210 offset:3648
pdn_194:
s_mov_b64 exec, -1
s_waitcnt lgkmcnt(0)
s_branch pback_136
patch_137:
s_nop 7
s_nop 7
s_mov_b64 exec, s[74:75]
s_cmp_eq_u32 s73, 0
s_cbranch_scc0 pnx_212
ds_read_b128 v[80:83], v211 offset:3328
ds_read_b128 v[84:87], v211 offset:3392
s_branch pdn_211
pnx_212:
s_cmp_eq_u32 s73, 1
s_cbranch_scc0 pnx_213
ds_read_b128 v[88:91], v211 offset:3328
ds_read_b128 v[92:95], v211 offset:3392
s_branch pdn_211
pnx_213:
s_cmp_eq_u32 s73, 2
s_cbranch_scc0 pnx_214
ds_read_b128 v[96:99], v211 offset:3328
ds_read_b128 v[100:103], v211 offset:3392
s_branch pdn_211
pnx_214:
ds_read_b128 v[104:107], v211 offset:3328
ds_read_b128 v[108:111], v211 offset:3392
pdn_211:
s_mov_b64 exec, -1
s_waitcnt lgkmcnt(0)
s_branch pback_138
cross_148:
s_cmp_eq_u32 s67, 122880
s_cbranch_scc0 cr2_216
v_add_u32 v5, s34, 18
s_mov_b64 exec, 1
ds_write_b32 v3, v5
s_mov_b64 exec, -1
v_mov_b32 v9, 0xf149f2ca
v_xor_b32 v216, v9, v216
v_xor_b32 v217, v9, v217
v_xor_b32 v218, v9, v218
v_xor_b32 v219, v9, v219
v_xor_b32 v220, v9, v220
v_xor_b32 v221, v9, v221
v_xor_b32 v222, v9, v222
v_xor_b32 v223, v9, v223
v_xor_b32 v224, v9, v224
v_xor_b32 v225, v9, v225
v_xor_b32 v226, v9, v226
v_xor_b32 v227, v9, v227
v_xor_b32 v228, v9, v228
v_xor_b32 v229, v9, v229
v_xor_b32 v230, v9, v230
v_xor_b32 v231, v9, v231
s_mov_b32 s67, 90112
s_cmp_eq_u32 s63, 0
s_cbranch_scc0 cr3_217
v_and_b32 v9, 15, v0
v_lshlrev_b32 v9, 11, v9
v_bfe_u32 v10, v0, 4, 1
v_lshl_add_u32 v9, v10, 5, v9
v_lshrrev_b32 v10, 5, v0
v_lshl_add_u32 v9, v10, 4, v9
s_lshl2_add_u32 s70, s61, s58
s_lshl_b32 s70, s70, 16
s_lshl_b32 s71, s62, 7
s_add_u32 s70, s70, s71
s_add_u32 s71, s70, 0x8000
buffer_load_dwordx4 v[240:243], v9, s[8:11], s70 offen offset:0
buffer_load_dwordx4 v[244:247], v9, s[8:11], s70 offen offset:64
buffer_load_dwordx4 v[248:251], v9, s[8:11], s71 offen offset:0
buffer_load_dwordx4 v[252:255], v9, s[8:11], s71 offen offset:64
cr3_217:
s_cmp_eq_u32 s59, 0
s_cbranch_scc1 cback_149
v_mov_b32 v9, 0
s_add_u32 s35, s34, 17
lw_218:
ds_read_b32 v5, v9 offset:16
s_waitcnt lgkmcnt(0)
v_cmp_gt_i32 vcc, s35, v5
s_cbranch_vccz lwd_219
s_sub_u32 s32, s32, 1
s_cmp_gt_i32 s32, 0
s_cbranch_scc1 lw_218
lwd_219:
s_branch cback_149
cr2_216:
v_add_u32 v5, s34, 19
s_mov_b64 exec, 1
ds_write_b32 v3, v5
s_mov_b64 exec, -1
s_mov_b32 s66, 28672
s_cmp_lt_u32 s59, 2
s_cbranch_scc1 cback_149
s_add_u32 s35, s34, 17
lw_220:
ds_read_b32 v5, v2 offset:16
s_waitcnt lgkmcnt(0)
v_cmp_gt_i32 vcc, s35, v5
s_cbranch_vccz lwd_221
s_sub_u32 s32, s32, 1
s_cmp_gt_i32 s32, 0
s_cbranch_scc1 lw_220
lwd_221:
s_branch cback_149
cross_150:
s_cmp_eq_u32 s67, 122880
s_cbranch_scc0 cr2_222
v_add_u32 v5, s34, 18
s_mov_b64 exec, 1
ds_write_b32 v3, v5
s_mov_b64 exec, -1
v_mov_b32 v9, 0xf149f2ca
v_xor_b32 v216, v9, v216
v_xor_b32 v217, v9, v217
v_xor_b32 v218, v9, v218
v_xor_b32 v219, v9, v219
v_xor_b32 v220, v9, v220
v_xor_b32 v221, v9, v221
v_xor_b32 v222, v9, v222
v_xor_b32 v223, v9, v223
v_xor_b32 v224, v9, v224
v_xor_b32 v225, v9, v225
v_xor_b32 v226, v9, v226
v_xor_b32 v227, v9, v227
v_xor_b32 v228, v9, v228
v_xor_b32 v229, v9, v229
v_xor_b32 v230, v9, v230
v_xor_b32 v231, v9, v231
s_mov_b32 s67, 90112
s_cmp_eq_u32 s63, 0
s_cbranch_scc0 cr3_223
v_and_b32 v9, 15, v0
v_lshlrev_b32 v9, 11, v9
v_bfe_u32 v10, v0, 4, 1
v_lshl_add_u32 v9, v10, 5, v9
v_lshrrev_b32 v10, 5, v0
v_lshl_add_u32 v9, v10, 4, v9
s_lshl2_add_u32 s70, s61, s58
s_lshl_b32 s70, s70, 16
s_lshl_b32 s71, s62, 7
s_add_u32 s70, s70, s71
s_add_u32 s71, s70, 0x8000
buffer_load_dwordx4 v[240:243], v9, s[8:11], s70 offen offset:0
buffer_load_dwordx4 v[244:247], v9, s[8:11], s70 offen offset:64
buffer_load_dwordx4 v[248:251], v9, s[8:11], s71 offen offset:0
buffer_load_dwordx4 v[252:255], v9, s[8:11], s71 offen offset:64
cr3_223:
s_cmp_eq_u32 s59, 0
s_cbranch_scc1 cback_151
v_mov_b32 v9, 0
s_add_u32 s35, s34, 17
lw_224:
ds_read_b32 v5, v9 offset:16
s_waitcnt lgkmcnt(0)
v_cmp_gt_i32 vcc, s35, v5
s_cbranch_vccz lwd_225
s_sub_u32 s32, s32, 1
s_cmp_gt_i32 s32, 0
s_cbranch_scc1 lw_224
lwd_225:
s_branch cback_151
cr2_222:
v_add_u32 v5, s34, 19
s_mov_b64 exec, 1
ds_write_b32 v3, v5
s_mov_b64 exec, -1
s_mov_b32 s66, 28672
s_cmp_lt_u32 s59, 2
s_cbranch_scc1 cback_151
s_add_u32 s35, s34, 17
lw_226:
ds_read_b32 v5, v2 offset:16
s_waitcnt lgkmcnt(0)
v_cmp_gt_i32 vcc, s35, v5
s_cbranch_vccz lwd_227
s_sub_u32 s32, s32, 1
s_cmp_gt_i32 s32, 0
s_cbranch_scc1 lw_226
lwd_227:
s_branch cback_151
slow_152:
s_add_u32 s70, s72, 270336
poll_228:
buffer_load_dword v10, v1, s[24:27], s70 offen sc1
pchk_229:
s_waitcnt vmcnt(0)
v_cmp_eq_u32 vcc, 0, v10
s_cbranch_vccz pdone_230
s_sub_u32 s32, s32, 1
s_cmp_gt_i32 s32, 0
s_cbranch_scc1 poll_228
pdone_230:
s_lshl_b32 s73, s60, 15
s_lshl_b32 s74, s63, 23
s_add_u32 s73, s73, s74
s_add_u32 s73, s73, 1048576
v_mov_b32 v10, 0xf149f2ca
v_mov_b32 v11, 0
v_mov_b32 v192, 0
v_mov_b32 v193, 0
v_mov_b32 v194, 0
v_mov_b32 v195, 0
v_mov_b32 v196, 0
v_mov_b32 v197, 0
v_mov_b32 v198, 0
v_mov_b32 v199, 0
v_mov_b32 v200, 0
v_mov_b32 v201, 0
v_mov_b32 v202, 0
v_mov_b32 v203, 0
v_mov_b32 v204, 0
v_mov_b32 v205, 0
v_mov_b32 v206, 0
v_mov_b32 v207, 0
v_mov_b32 v208, 0
v_mov_b32 v209, 0
v_mov_b32 v210, 0
v_mov_b32 v211, 0
s_lshl2_add_u32 s74, s59, s65
s_mov_b32 s75, 0
sl_231:
s_lshr_b32 s76, s74, 2
s_lshl_b32 s76, s76, 19
s_and_b32 s77, s74, 3
s_lshl_b32 s77, s77, 13
s_add_u32 s76, s76, s77
s_add_u32 s76, s76, s73
buffer_load_dwordx4 v[152:155], v6, s[20:23], s76 offen offset:0 sc1
buffer_load_dwordx4 v[156:159], v6, s[20:23], s76 offen offset:1024 sc1
s_cmp_eq_u32 s75, 0
s_cselect_b32 s76, 0xf149f2ca, 0
s_and_b32 s77, s75, 7
s_cselect_b32 s77, 0, -1
v_xor_b32 v112, s76, v216
v_and_b32 v112, s77, v112
v_xor_b32 v113, s76, v217
v_and_b32 v113, s77, v113
v_xor_b32 v114, s76, v218
v_and_b32 v114, s77, v114
v_xor_b32 v115, s76, v219
v_and_b32 v115, s77, v115
v_xor_b32 v116, s76, v220
v_and_b32 v116, s77, v116
v_xor_b32 v117, s76, v221
v_and_b32 v117, s77, v117
v_xor_b32 v118, s76, v222
v_and_b32 v118, s77, v118
v_xor_b32 v119, s76, v223
v_and_b32 v119, s77, v119
v_xor_b32 v120, s76, v224
v_and_b32 v120, s77, v120
v_xor_b32 v121, s76, v225
v_and_b32 v121, s77, v121
v_xor_b32 v122, s76, v226
v_and_b32 v122, s77, v122
v_xor_b32 v123, s76, v227
v_and_b32 v123, s77, v123
v_xor_b32 v124, s76, v228
v_and_b32 v124, s77, v124
v_xor_b32 v125, s76, v229
v_and_b32 v125, s77, v125
v_xor_b32 v126, s76, v230
v_and_b32 v126, s77, v126
v_xor_b32 v127, s76, v231
v_and_b32 v127, s77, v127
s_waitcnt vmcnt(1)
s_nop 0
v_mfma_f32_32x32x16_bf16 v[112:127], v[152:155], v[80:83], v[112:127]
s_waitcnt vmcnt(0)
v_mfma_f32_32x32x16_bf16 v[112:127], v[156:159], v[88:91], v[112:127]
s_nop 11
v_max3_f32 v10, v10, v112, v113
v_max3_f32 v10, v10, v114, v115
v_max3_f32 v10, v10, v116, v117
v_max3_f32 v10, v10, v118, v119
v_max3_f32 v10, v10, v120, v121
v_max3_f32 v10, v10, v122, v123
v_max3_f32 v10, v10, v124, v125
v_max3_f32 v10, v10, v126, v127
s_add_u32 s75, s75, 1
s_sub_u32 s74, s74, 1
s_cselect_b32 s75, 9, s75
s_cmp_lt_u32 s75, 9
s_cbranch_scc1 sl_231
v_mov_b32 v11, v10
s_nop 1
v_permlane32_swap_b32 v11, v10
v_max_f32 v10, v10, v11
s_lshl2_add_u32 s74, s59, s65
s_mov_b32 s75, 0
sl_232:
s_lshr_b32 s76, s74, 2
s_lshl_b32 s76, s76, 19
s_and_b32 s77, s74, 3
s_lshl_b32 s77, s77, 13
s_add_u32 s76, s76, s77
s_add_u32 s76, s76, s73
buffer_load_dwordx4 v[152:155], v6, s[20:23], s76 offen offset:0 sc1
buffer_load_dwordx4 v[156:159], v6, s[20:23], s76 offen offset:1024 sc1
buffer_load_dwordx4 v[160:163], v6, s[20:23], s76 offen offset:2048 sc1
buffer_load_dwordx4 v[164:167], v6, s[20:23], s76 offen offset:3072 sc1
s_cmp_eq_u32 s75, 0
s_cselect_b32 s76, 0xf149f2ca, 0
s_and_b32 s77, s75, 7
s_cselect_b32 s77, 0, -1
v_xor_b32 v112, s76, v216
v_and_b32 v112, s77, v112
v_sub_f32 v112, v112, v10
v_xor_b32 v113, s76, v217
v_and_b32 v113, s77, v113
v_sub_f32 v113, v113, v10
v_xor_b32 v114, s76, v218
v_and_b32 v114, s77, v114
v_sub_f32 v114, v114, v10
v_xor_b32 v115, s76, v219
v_and_b32 v115, s77, v115
v_sub_f32 v115, v115, v10
v_xor_b32 v116, s76, v220
v_and_b32 v116, s77, v116
v_sub_f32 v116, v116, v10
v_xor_b32 v117, s76, v221
v_and_b32 v117, s77, v117
v_sub_f32 v117, v117, v10
v_xor_b32 v118, s76, v222
v_and_b32 v118, s77, v118
v_sub_f32 v118, v118, v10
v_xor_b32 v119, s76, v223
v_and_b32 v119, s77, v119
v_sub_f32 v119, v119, v10
v_xor_b32 v120, s76, v224
v_and_b32 v120, s77, v120
v_sub_f32 v120, v120, v10
v_xor_b32 v121, s76, v225
v_and_b32 v121, s77, v121
v_sub_f32 v121, v121, v10
v_xor_b32 v122, s76, v226
v_and_b32 v122, s77, v122
v_sub_f32 v122, v122, v10
v_xor_b32 v123, s76, v227
v_and_b32 v123, s77, v123
v_sub_f32 v123, v123, v10
v_xor_b32 v124, s76, v228
v_and_b32 v124, s77, v124
v_sub_f32 v124, v124, v10
v_xor_b32 v125, s76, v229
v_and_b32 v125, s77, v125
v_sub_f32 v125, v125, v10
v_xor_b32 v126, s76, v230
v_and_b32 v126, s77, v126
v_sub_f32 v126, v126, v10
v_xor_b32 v127, s76, v231
v_and_b32 v127, s77, v127
v_sub_f32 v127, v127, v10
s_waitcnt vmcnt(3)
s_nop 0
v_mfma_f32_32x32x16_bf16 v[112:127], v[152:155], v[80:83], v[112:127]
s_waitcnt vmcnt(2)
v_mfma_f32_32x32x16_bf16 v[112:127], v[156:159], v[88:91], v[112:127]
s_nop 11
v_exp_f32 v112, v112
v_exp_f32 v113, v113
v_exp_f32 v114, v114
v_exp_f32 v115, v115
v_exp_f32 v116, v116
v_exp_f32 v117, v117
v_exp_f32 v118, v118
v_exp_f32 v119, v119
v_exp_f32 v120, v120
v_exp_f32 v121, v121
v_exp_f32 v122, v122
v_exp_f32 v123, v123
v_exp_f32 v124, v124
v_exp_f32 v125, v125
v_exp_f32 v126, v126
v_exp_f32 v127, v127
v_cvt_pk_bf16_f32 v144, v112, v113
v_cvt_pk_bf16_f32 v145, v114, v115
v_cvt_pk_bf16_f32 v146, v116, v117
v_cvt_pk_bf16_f32 v147, v118, v119
v_cvt_pk_bf16_f32 v148, v120, v121
v_cvt_pk_bf16_f32 v149, v122, v123
v_cvt_pk_bf16_f32 v150, v124, v125
v_cvt_pk_bf16_f32 v151, v126, v127
s_waitcnt vmcnt(1)
v_mfma_f32_32x32x16_bf16 v[192:207], v[160:163], v[144:147], v[192:207]
v_mfma_f32_16x16x32_bf16 v[208:211], v[212:215], v[144:147], v[208:211]
s_waitcnt vmcnt(0)
v_mfma_f32_32x32x16_bf16 v[192:207], v[164:167], v[148:151], v[192:207]
v_mfma_f32_16x16x32_bf16 v[208:211], v[212:215], v[148:151], v[208:211]
s_add_u32 s75, s75, 1
s_sub_u32 s74, s74, 1
s_cselect_b32 s75, 9, s75
s_cmp_lt_u32 s75, 9
s_cbranch_scc1 sl_232
v_mov_b32 v10, 0xf149f2ca
v_mov_b32 v11, 0
v_mov_b32 v16, 0
v_mov_b32 v17, 0
v_mov_b32 v18, 0
v_mov_b32 v19, 0
v_mov_b32 v20, 0
v_mov_b32 v21, 0
v_mov_b32 v22, 0
v_mov_b32 v23, 0
v_mov_b32 v24, 0
v_mov_b32 v25, 0
v_mov_b32 v26, 0
v_mov_b32 v27, 0
v_mov_b32 v28, 0
v_mov_b32 v29, 0
v_mov_b32 v30, 0
v_mov_b32 v31, 0
v_mov_b32 v32, 0
v_mov_b32 v33, 0
v_mov_b32 v34, 0
v_mov_b32 v35, 0
s_sub_u32 s74, 3, s65
s_lshl2_add_u32 s74, s59, s74
s_mov_b32 s75, 0
sl_233:
s_lshr_b32 s76, s74, 2
s_lshl_b32 s76, s76, 19
s_and_b32 s77, s74, 3
s_lshl_b32 s77, s77, 13
s_add_u32 s76, s76, s77
s_add_u32 s76, s76, s73
buffer_load_dwordx4 v[152:155], v6, s[20:23], s76 offen offset:0 sc1
buffer_load_dwordx4 v[156:159], v6, s[20:23], s76 offen offset:1024 sc1
s_cmp_eq_u32 s75, 0
s_cselect_b32 s76, 0xf149f2ca, 0
s_and_b32 s77, s75, 7
s_cselect_b32 s77, 0, -1
v_xor_b32 v112, s76, v216
v_and_b32 v112, s77, v112
v_xor_b32 v113, s76, v217
v_and_b32 v113, s77, v113
v_xor_b32 v114, s76, v218
v_and_b32 v114, s77, v114
v_xor_b32 v115, s76, v219
v_and_b32 v115, s77, v115
v_xor_b32 v116, s76, v220
v_and_b32 v116, s77, v116
v_xor_b32 v117, s76, v221
v_and_b32 v117, s77, v117
v_xor_b32 v118, s76, v222
v_and_b32 v118, s77, v118
v_xor_b32 v119, s76, v223
v_and_b32 v119, s77, v119
v_xor_b32 v120, s76, v224
v_and_b32 v120, s77, v120
v_xor_b32 v121, s76, v225
v_and_b32 v121, s77, v121
v_xor_b32 v122, s76, v226
v_and_b32 v122, s77, v122
v_xor_b32 v123, s76, v227
v_and_b32 v123, s77, v123
v_xor_b32 v124, s76, v228
v_and_b32 v124, s77, v124
v_xor_b32 v125, s76, v229
v_and_b32 v125, s77, v125
v_xor_b32 v126, s76, v230
v_and_b32 v126, s77, v126
v_xor_b32 v127, s76, v231
v_and_b32 v127, s77, v127
s_waitcnt vmcnt(1)
s_nop 0
v_mfma_f32_32x32x16_bf16 v[112:127], v[152:155], v[96:99], v[112:127]
s_waitcnt vmcnt(0)
v_mfma_f32_32x32x16_bf16 v[112:127], v[156:159], v[104:107], v[112:127]
s_nop 11
v_max3_f32 v10, v10, v112, v113
v_max3_f32 v10, v10, v114, v115
v_max3_f32 v10, v10, v116, v117
v_max3_f32 v10, v10, v118, v119
v_max3_f32 v10, v10, v120, v121
v_max3_f32 v10, v10, v122, v123
v_max3_f32 v10, v10, v124, v125
v_max3_f32 v10, v10, v126, v127
s_add_u32 s75, s75, 1
s_sub_u32 s74, s74, 1
s_cselect_b32 s75, 9, s75
s_cmp_lt_u32 s75, 9
s_cbranch_scc1 sl_233
v_mov_b32 v11, v10
s_nop 1
v_permlane32_swap_b32 v11, v10
v_max_f32 v10, v10, v11
s_sub_u32 s74, 3, s65
s_lshl2_add_u32 s74, s59, s74
s_mov_b32 s75, 0
sl_234:
s_lshr_b32 s76, s74, 2
s_lshl_b32 s76, s76, 19
s_and_b32 s77, s74, 3
s_lshl_b32 s77, s77, 13
s_add_u32 s76, s76, s77
s_add_u32 s76, s76, s73
buffer_load_dwordx4 v[152:155], v6, s[20:23], s76 offen offset:0 sc1
buffer_load_dwordx4 v[156:159], v6, s[20:23], s76 offen offset:1024 sc1
buffer_load_dwordx4 v[160:163], v6, s[20:23], s76 offen offset:2048 sc1
buffer_load_dwordx4 v[164:167], v6, s[20:23], s76 offen offset:3072 sc1
s_cmp_eq_u32 s75, 0
s_cselect_b32 s76, 0xf149f2ca, 0
s_and_b32 s77, s75, 7
s_cselect_b32 s77, 0, -1
v_xor_b32 v112, s76, v216
v_and_b32 v112, s77, v112
v_sub_f32 v112, v112, v10
v_xor_b32 v113, s76, v217
v_and_b32 v113, s77, v113
v_sub_f32 v113, v113, v10
v_xor_b32 v114, s76, v218
v_and_b32 v114, s77, v114
v_sub_f32 v114, v114, v10
v_xor_b32 v115, s76, v219
v_and_b32 v115, s77, v115
v_sub_f32 v115, v115, v10
v_xor_b32 v116, s76, v220
v_and_b32 v116, s77, v116
v_sub_f32 v116, v116, v10
v_xor_b32 v117, s76, v221
v_and_b32 v117, s77, v117
v_sub_f32 v117, v117, v10
v_xor_b32 v118, s76, v222
v_and_b32 v118, s77, v118
v_sub_f32 v118, v118, v10
v_xor_b32 v119, s76, v223
v_and_b32 v119, s77, v119
v_sub_f32 v119, v119, v10
v_xor_b32 v120, s76, v224
v_and_b32 v120, s77, v120
v_sub_f32 v120, v120, v10
v_xor_b32 v121, s76, v225
v_and_b32 v121, s77, v121
v_sub_f32 v121, v121, v10
v_xor_b32 v122, s76, v226
v_and_b32 v122, s77, v122
v_sub_f32 v122, v122, v10
v_xor_b32 v123, s76, v227
v_and_b32 v123, s77, v123
v_sub_f32 v123, v123, v10
v_xor_b32 v124, s76, v228
v_and_b32 v124, s77, v124
v_sub_f32 v124, v124, v10
v_xor_b32 v125, s76, v229
v_and_b32 v125, s77, v125
v_sub_f32 v125, v125, v10
v_xor_b32 v126, s76, v230
v_and_b32 v126, s77, v126
v_sub_f32 v126, v126, v10
v_xor_b32 v127, s76, v231
v_and_b32 v127, s77, v127
v_sub_f32 v127, v127, v10
s_waitcnt vmcnt(3)
s_nop 0
v_mfma_f32_32x32x16_bf16 v[112:127], v[152:155], v[96:99], v[112:127]
s_waitcnt vmcnt(2)
v_mfma_f32_32x32x16_bf16 v[112:127], v[156:159], v[104:107], v[112:127]
s_nop 11
v_exp_f32 v112, v112
v_exp_f32 v113, v113
v_exp_f32 v114, v114
v_exp_f32 v115, v115
v_exp_f32 v116, v116
v_exp_f32 v117, v117
v_exp_f32 v118, v118
v_exp_f32 v119, v119
v_exp_f32 v120, v120
v_exp_f32 v121, v121
v_exp_f32 v122, v122
v_exp_f32 v123, v123
v_exp_f32 v124, v124
v_exp_f32 v125, v125
v_exp_f32 v126, v126
v_exp_f32 v127, v127
v_cvt_pk_bf16_f32 v144, v112, v113
v_cvt_pk_bf16_f32 v145, v114, v115
v_cvt_pk_bf16_f32 v146, v116, v117
v_cvt_pk_bf16_f32 v147, v118, v119
v_cvt_pk_bf16_f32 v148, v120, v121
v_cvt_pk_bf16_f32 v149, v122, v123
v_cvt_pk_bf16_f32 v150, v124, v125
v_cvt_pk_bf16_f32 v151, v126, v127
s_waitcnt vmcnt(1)
v_mfma_f32_32x32x16_bf16 v[16:31], v[160:163], v[144:147], v[16:31]
v_mfma_f32_16x16x32_bf16 v[32:35], v[212:215], v[144:147], v[32:35]
s_waitcnt vmcnt(0)
v_mfma_f32_32x32x16_bf16 v[16:31], v[164:167], v[148:151], v[16:31]
v_mfma_f32_16x16x32_bf16 v[32:35], v[212:215], v[148:151], v[32:35]
s_add_u32 s75, s75, 1
s_sub_u32 s74, s74, 1
s_cselect_b32 s75, 9, s75
s_cmp_lt_u32 s75, 9
s_cbranch_scc1 sl_234
s_branch sback_153
far_154:
buffer_store_dwordx4 v[16:19], v9, s[20:23], s67 offen offset:0 sc1
buffer_store_dwordx4 v[20:23], v9, s[20:23], s67 offen offset:1024 sc1
s_branch near_155
far_156:
buffer_store_dwordx4 v[192:195], v9, s[20:23], s66 offen offset:0 sc1
buffer_store_dwordx4 v[196:199], v9, s[20:23], s66 offen offset:1024 sc1
s_branch near_157
far_160:
buffer_store_dword v212, v3, s[24:27], s70 offen sc1
s_branch near_161
mo_162:
s_lshr_b32 s67, s33, 5
s_cmp_eq_u32 s67, s66
s_cbranch_scc0 mo_163
s_and_b32 s67, s33, 31
v_sub_u32 v48, s67, v48
v_lshlrev_b32 v49, 4, v49
s_lshl_b32 s67, s62, 14
s_add_u32 s67, s67, 30686208
poll_235:
buffer_load_dwordx4 v[56:59], v49, s[20:23], s67 offen offset:0 sc1
buffer_load_dwordx4 v[60:63], v49, s[20:23], s67 offen offset:64 sc1
pchk_236:
s_waitcnt vmcnt(1)
v_min3_u32 v50, v56, v57, v58
s_waitcnt vmcnt(0)
v_min3_u32 v50, v50, v59, v60
v_min3_u32 v50, v50, v61, v62
v_min_u32 v50, v50, v63
v_cmp_eq_u32 vcc, 0, v50
s_cbranch_vccz pdone_237
s_sub_u32 s32, s32, 1
s_cmp_gt_i32 s32, 0
s_cbranch_scc1 poll_235
pdone_237:
v_cmp_eq_u32 vcc, 0, v48
s_nop 1
v_cndmask_b32 v240, v240, v56, vcc
v_cndmask_b32 v241, v241, v57, vcc
v_cndmask_b32 v242, v242, v58, vcc
v_cndmask_b32 v243, v243, v59, vcc
v_cndmask_b32 v244, v244, v60, vcc
v_cndmask_b32 v245, v245, v61, vcc
v_cndmask_b32 v246, v246, v62, vcc
v_cndmask_b32 v247, v247, v63, vcc
v_cmp_eq_u32 vcc, 16, v48
s_nop 1
v_cndmask_b32 v248, v248, v56, vcc
v_cndmask_b32 v249, v249, v57, vcc
v_cndmask_b32 v250, v250, v58, vcc
v_cndmask_b32 v251, v251, v59, vcc
v_cndmask_b32 v252, v252, v60, vcc
v_cndmask_b32 v253, v253, v61, vcc
v_cndmask_b32 v254, v254, v62, vcc
v_cndmask_b32 v255, v255, v63, vcc
s_branch mo_163
far_166:
buffer_store_dwordx4 v[240:243], v6, s[20:23], s68 offen offset:0 sc1
buffer_store_dwordx4 v[244:247], v6, s[20:23], s68 offen offset:1024 sc1
buffer_store_dwordx4 v[248:251], v6, s[20:23], s68 offen offset:2048 sc1
buffer_store_dwordx4 v[252:255], v6, s[20:23], s68 offen offset:3072 sc1
s_branch near_167
far_168:
buffer_store_dwordx4 v[8:11], v6, s[24:27], s67 offen sc1
s_branch near_169
far_170:
buffer_store_dword v212, v3, s[24:27], s66 offen sc1
s_branch near_171
far_182:
buffer_store_dwordx2 v[10:11], v12, s[24:27], s66 offen sc1
s_branch near_183
L_end:
L_fin:
s_endpgm
.section .rodata,"a"
.p2align 6
.amdhsa_kernel interleave_layers__sliding_block__moe_arch_mod__prompt_kernel
  .amdhsa_next_free_vgpr 256
  .amdhsa_next_free_sgpr 102
  .amdhsa_accum_offset 256
  .amdhsa_group_segment_fixed_size 0
  .amdhsa_kernarg_size 88
  .amdhsa_user_sgpr_count 2
  .amdhsa_user_sgpr_kernarg_segment_ptr 1
  .amdhsa_system_sgpr_workgroup_id_x 1
  .amdhsa_float_denorm_mode_32 3
.end_amdhsa_kernel
```

```asm
; @launch grid=(256,1,1) block=(512,1,1) lds=163840
.amdgcn_target "amdgcn-amd-amdhsa--gfx950"
.text
.globl interleave_layers__sliding_block__moe_arch_mod__prompt_kernel
.p2align 8
.type interleave_layers__sliding_block__moe_arch_mod__prompt_kernel,@function
interleave_layers__sliding_block__moe_arch_mod__prompt_kernel:
s_cmp_ge_u32 s2, 256
s_cbranch_scc1 L_fin
s_load_dwordx16 s[36:51], s[0:1], 0
s_load_dwordx4 s[52:55], s[0:1], 64
s_load_dwordx2 s[56:57], s[0:1], 80
v_lshrrev_b32 v1, 6, v0
v_and_b32 v0, 63, v0
s_and_b32 s64, s2, 7
v_readfirstlane_b32 s3, v1
s_lshr_b32 s65, s2, 3
s_and_b32 s66, s65, 7
s_and_b32 s67, s64, 1
s_lshl3_add_u32 s59, s67, s66
s_lshr_b32 s66, s65, 3
s_lshr_b32 s67, s64, 1
s_lshl2_add_u32 s60, s67, s66
s_and_b32 s66, s65, 1
s_lshl1_add_u32 s61, s64, s66
s_lshr_b32 s62, s65, 1
s_mov_b32 s59, s61
s_xor_b32 s60, s62, 0
s_mov_b32 s63, 0
s_mov_b32 s34, 0
s_mov_b32 s32, 200000
s_mov_b32 s33, -1
s_cmp_ge_u32 s3, 4
s_cselect_b32 s66, 3, 1
s_and_b32 s58, s3, s66
s_waitcnt lgkmcnt(0)
s_mov_b32 s8, s36
s_mov_b32 s9, s37
s_mov_b32 s10, 0x400000
s_mov_b32 s11, 0x00020000
s_mov_b32 s12, s38
s_mov_b32 s13, s39
s_mov_b32 s14, 0x600000
s_mov_b32 s15, 0x00020000
s_mov_b32 s16, s40
s_mov_b32 s17, s41
s_mov_b32 s18, 0x200000
s_mov_b32 s19, 0x00020000
s_mov_b32 s20, s56
s_mov_b32 s21, s57
s_mov_b32 s22, 0x2500000
s_mov_b32 s23, 0x00020000
s_add_u32 s24, s56, 30408704
s_addc_u32 s25, s57, 0
s_mov_b32 s26, 2818048
s_mov_b32 s27, 0x00020000
s_mov_b32 s28, s52
s_mov_b32 s29, s53
s_mov_b32 s30, 0x400000
s_mov_b32 s31, 0x00020000
s_cmp_ge_u32 s3, 4
s_cbranch_scc1 L_m
s_cmp_ge_u32 s3, 2
s_cbranch_scc1 L_f
s_setprio 1
v_and_b32 v22, 7, v0
v_lshrrev_b32 v23, 4, v0
v_lshrrev_b32 v6, 3, v0
v_xor_b32 v7, v22, v23
v_lshlrev_b32 v7, 4, v7
v_lshl_add_u32 v8, v6, 11, v7
v_xor_b32 v7, 64, v8
v_add_u32 v9, 15360, v7
v_add_u32 v10, 30720, v8
v_add_u32 v11, 46080, v7
s_lshl_b32 s70, s59, 18
s_lshl_b32 s71, s58, 16
s_add_u32 s68, s70, s71
s_sub_u32 s69, s70, s71
s_add_u32 s69, s69, 196608
s_mov_b32 s67, 128
s_lshl_b32 s75, s58, 13
s_mov_b32 s65, 86016
s_and_b32 s79, s59, 1
s_mul_i32 s70, s60, 1
s_and_b32 s71, s59, 14
s_add_u32 s70, s70, s71
s_and_b32 s70, s70, 15
s_xor_b32 s64, s70, s79
s_mul_i32 s70, s64, s67
s_add_u32 m0, s65, s75
s_add_u32 s71, s70, s68
buffer_load_dwordx4 v8, s[8:11], s71 offen offset:0 lds
buffer_load_dwordx4 v9, s[8:11], s71 offen offset:1024 lds
buffer_load_dwordx4 v10, s[8:11], s71 offen offset:2048 lds
buffer_load_dwordx4 v11, s[8:11], s71 offen offset:3072 lds
s_add_u32 m0, m0, 4096
s_add_u32 s71, s70, s69
buffer_load_dwordx4 v8, s[8:11], s71 offen offset:0 lds
buffer_load_dwordx4 v9, s[8:11], s71 offen offset:1024 lds
buffer_load_dwordx4 v10, s[8:11], s71 offen offset:2048 lds
buffer_load_dwordx4 v11, s[8:11], s71 offen offset:3072 lds
v_and_b32 v7, 2, v6
v_xor_b32 v7, v7, v22
v_mul_u32_u24 v6, 6144, v6
v_lshl_add_u32 v12, v7, 4, v6
v_xor_b32 v6, 64, v12
v_add_u32 v13, 48128, v6
v_add_u32 v14, 96256, v12
v_add_u32 v15, 144384, v6
s_mul_i32 s76, s58, 12288
s_add_u32 s76, s76, 16384
s_lshl_b32 s70, s60, 7
s_cmp_eq_u32 s58, 0
s_mov_b32 s71, 198656
s_cselect_b32 s72, 0, s71
s_mov_b32 s71, 4096
s_cselect_b32 s73, 196608, s71
s_mov_b32 s71, 200704
s_cselect_b32 s74, 2048, s71
s_add_u32 s72, s72, s70
s_add_u32 s73, s73, s70
s_add_u32 s74, s74, s70
s_mul_i32 s70, s64, 393216
s_add_u32 m0, s65, s76
s_add_u32 s71, s70, s72
buffer_load_dwordx4 v12, s[12:15], s71 offen offset:0 lds
buffer_load_dwordx4 v13, s[12:15], s71 offen offset:1024 lds
buffer_load_dwordx4 v14, s[12:15], s71 offen offset:2048 lds
buffer_load_dwordx4 v15, s[12:15], s71 offen offset:3072 lds
s_add_u32 m0, m0, 4096
s_add_u32 s71, s70, s73
buffer_load_dwordx4 v12, s[12:15], s71 offen offset:0 lds
buffer_load_dwordx4 v13, s[12:15], s71 offen offset:1024 lds
buffer_load_dwordx4 v14, s[12:15], s71 offen offset:2048 lds
buffer_load_dwordx4 v15, s[12:15], s71 offen offset:3072 lds
s_add_u32 m0, m0, 4096
s_add_u32 s71, s70, s74
buffer_load_dwordx4 v12, s[12:15], s71 offen offset:0 lds
buffer_load_dwordx4 v13, s[12:15], s71 offen offset:1024 lds
buffer_load_dwordx4 v14, s[12:15], s71 offen offset:2048 lds
buffer_load_dwordx4 v15, s[12:15], s71 offen offset:3072 lds
s_xor_b32 s64, s64, s79
s_add_u32 s64, s64, 1
s_and_b32 s64, s64, 15
s_xor_b32 s64, s64, s79
s_sub_u32 s65, s65, 40960
s_cselect_b32 s65, 86016, s65
v_and_b32 v1, 3, v0
v_lshlrev_b32 v1, 2, v1
v_and_b32 v2, 4, v1
s_lshl2_add_u32 s35, s58, 16
v_mov_b32 v3, s35
v_lshlrev_b32 v20, 4, v0
v_lshrrev_b32 v6, 2, v0
v_lshl_add_u32 v21, v6, 7, v1
v_lshrrev_b32 v6, 3, v0
v_lshlrev_b32 v23, 1, v23
v_xor_b32 v23, v23, v22
v_lshlrev_b32 v23, 4, v23
v_lshl_add_u32 v23, v6, 11, v23
s_lshl_b32 s70, s62, 7
s_lshl_b32 s71, s58, 16
s_add_u32 s70, s70, s71
v_add_u32 v16, s70, v23
v_add_u32 v17, 15360, v16
v_add_u32 v18, 30720, v16
v_add_u32 v19, 46080, v16
s_add_u32 s77, s61, s62
s_lshl_b32 s77, s77, 17
s_lshl_b32 s78, s58, 12
s_mov_b32 s66, -2
s_barrier
.p2align 4
lq_1:
s_add_u32 s35, s66, 1
lw_4:
ds_read_b32 v5, v1 offset:0
s_waitcnt lgkmcnt(0)
v_cmp_gt_i32 vcc, s35, v5
s_cbranch_vccz lwd_5
s_sub_u32 s32, s32, 1
s_cmp_gt_i32 s32, 0
s_cbranch_scc1 lw_4
lwd_5:
s_cmp_eq_u32 s66, 0
s_cbranch_scc1 lcs_2
lcb_3:
s_mul_i32 s70, s64, s67
s_add_u32 m0, s65, s75
s_add_u32 s71, s70, s68
buffer_load_dwordx4 v8, s[8:11], s71 offen offset:0 sc1 lds
buffer_load_dwordx4 v9, s[8:11], s71 offen offset:1024 sc1 lds
buffer_load_dwordx4 v10, s[8:11], s71 offen offset:2048 sc1 lds
buffer_load_dwordx4 v11, s[8:11], s71 offen offset:3072 sc1 lds
buffer_load_dword v30, off, s[12:15], 0
s_add_u32 m0, m0, 4096
s_add_u32 s71, s70, s69
buffer_load_dwordx4 v8, s[8:11], s71 offen offset:0 sc1 lds
buffer_load_dwordx4 v9, s[8:11], s71 offen offset:1024 sc1 lds
buffer_load_dwordx4 v10, s[8:11], s71 offen offset:2048 sc1 lds
buffer_load_dwordx4 v11, s[8:11], s71 offen offset:3072 sc1 lds
buffer_load_dword v30, off, s[12:15], 0
s_mul_i32 s70, s64, 393216
s_add_u32 m0, s65, s76
s_add_u32 s71, s70, s72
buffer_load_dwordx4 v12, s[12:15], s71 offen offset:0 lds
buffer_load_dwordx4 v13, s[12:15], s71 offen offset:1024 lds
buffer_load_dwordx4 v14, s[12:15], s71 offen offset:2048 lds
buffer_load_dwordx4 v15, s[12:15], s71 offen offset:3072 lds
buffer_load_dword v30, off, s[12:15], 0
v_add_u32 v5, s66, 3
s_mov_b64 exec, 1
s_waitcnt vmcnt(15)
ds_write_b32 v3, v5
s_mov_b64 exec, -1
s_mul_i32 s70, s64, 393216
s_add_u32 m0, m0, 4096
s_add_u32 s71, s70, s73
buffer_load_dwordx4 v12, s[12:15], s71 offen offset:0 lds
buffer_load_dwordx4 v13, s[12:15], s71 offen offset:1024 lds
buffer_load_dwordx4 v14, s[12:15], s71 offen offset:2048 lds
buffer_load_dwordx4 v15, s[12:15], s71 offen offset:3072 lds
buffer_load_dword v30, off, s[12:15], 0
s_mul_i32 s70, s64, 393216
s_add_u32 m0, m0, 4096
s_add_u32 s71, s70, s74
buffer_load_dwordx4 v12, s[12:15], s71 offen offset:0 lds
buffer_load_dwordx4 v13, s[12:15], s71 offen offset:1024 lds
buffer_load_dwordx4 v14, s[12:15], s71 offen offset:2048 lds
buffer_load_dwordx4 v15, s[12:15], s71 offen offset:3072 lds
buffer_load_dword v30, off, s[12:15], 0
s_xor_b32 s64, s64, s79
s_add_u32 s64, s64, 1
s_and_b32 s64, s64, 15
s_xor_b32 s64, s64, s79
s_sub_u32 s65, s65, 40960
s_cselect_b32 s65, 86016, s65
s_add_u32 s66, s66, 1
s_and_b32 s70, s66, 31
s_cmp_eq_u32 s70, 13
s_cbranch_scc0 lq_1
s_waitcnt vmcnt(0)
v_add_u32 v5, s34, 16
s_mov_b64 exec, 1
ds_write_b32 v3, v5
s_mov_b64 exec, -1
s_add_u32 s35, s34, 14
lw_6:
ds_read_b32 v5, v1 offset:0
s_waitcnt lgkmcnt(0)
v_cmp_gt_i32 vcc, s35, v5
s_cbranch_vccz lwd_7
s_sleep 1
s_sub_u32 s32, s32, 1
s_cmp_gt_i32 s32, 0
s_cbranch_scc1 lw_6
lwd_7:
s_add_u32 s70, s77, 262144
s_add_u32 m0, s78, 49152
s_and_b32 s70, s70, 0x1fffff
buffer_load_dwordx4 v16, s[16:19], s70 offen offset:0 lds
buffer_load_dwordx4 v17, s[16:19], s70 offen offset:1024 lds
buffer_load_dwordx4 v18, s[16:19], s70 offen offset:2048 lds
buffer_load_dwordx4 v19, s[16:19], s70 offen offset:3072 lds
buffer_load_dword v30, off, s[12:15], 0
s_add_u32 s70, s77, 393216
s_add_u32 m0, s78, 57344
s_and_b32 s70, s70, 0x1fffff
buffer_load_dwordx4 v16, s[16:19], s70 offen offset:0 lds
buffer_load_dwordx4 v17, s[16:19], s70 offen offset:1024 lds
buffer_load_dwordx4 v18, s[16:19], s70 offen offset:2048 lds
buffer_load_dwordx4 v19, s[16:19], s70 offen offset:3072 lds
buffer_load_dword v30, off, s[12:15], 0
s_add_u32 s70, s77, 524288
s_add_u32 m0, s78, 65536
s_and_b32 s70, s70, 0x1fffff
buffer_load_dwordx4 v16, s[16:19], s70 offen offset:0 lds
buffer_load_dwordx4 v17, s[16:19], s70 offen offset:1024 lds
buffer_load_dwordx4 v18, s[16:19], s70 offen offset:2048 lds
buffer_load_dwordx4 v19, s[16:19], s70 offen offset:3072 lds
buffer_load_dword v30, off, s[12:15], 0
s_add_u32 s70, s77, 655360
s_add_u32 m0, s78, 73728
s_and_b32 s70, s70, 0x1fffff
buffer_load_dwordx4 v16, s[16:19], s70 offen offset:0 lds
buffer_load_dwordx4 v17, s[16:19], s70 offen offset:1024 lds
buffer_load_dwordx4 v18, s[16:19], s70 offen offset:2048 lds
buffer_load_dwordx4 v19, s[16:19], s70 offen offset:3072 lds
buffer_load_dword v30, off, s[12:15], 0
s_sub_u32 s70, s59, s58
s_lshl_b32 s71, s70, 7
s_add_u32 s71, s71, s60
s_lshl4_add_u32 s70, s70, s60
s_sub_u32 s70, s70, 16
s_lshl_b32 s66, s71, 7
s_add_u32 s66, s66, 253952
s_lshl_b32 s70, s70, 15
s_lshl_b32 s71, s63, 23
s_add_u32 s70, s70, s71
s_add_u32 s64, s70, 1077248
s_mul_i32 s65, s58, -94208
s_add_u32 s35, s34, 16
lw_8:
ds_read_b32 v5, v1 offset:0
s_waitcnt lgkmcnt(0)
v_cmp_gt_i32 vcc, s35, v5
s_cbranch_vccz lwd_9
s_sleep 1
s_sub_u32 s32, s32, 1
s_cmp_gt_i32 s32, 0
s_cbranch_scc1 lw_8
lwd_9:
s_add_u32 s70, s77, 131072
s_add_u32 m0, s78, 40960
s_and_b32 s70, s70, 0x1fffff
buffer_load_dwordx4 v16, s[16:19], s70 offen offset:0 lds
buffer_load_dwordx4 v17, s[16:19], s70 offen offset:1024 lds
buffer_load_dwordx4 v18, s[16:19], s70 offen offset:2048 lds
buffer_load_dwordx4 v19, s[16:19], s70 offen offset:3072 lds
buffer_load_dword v30, off, s[12:15], 0
s_add_u32 s70, s77, 786432
s_add_u32 m0, s78, 81920
s_and_b32 s70, s70, 0x1fffff
buffer_load_dwordx4 v16, s[16:19], s70 offen offset:0 lds
buffer_load_dwordx4 v17, s[16:19], s70 offen offset:1024 lds
buffer_load_dwordx4 v18, s[16:19], s70 offen offset:2048 lds
buffer_load_dwordx4 v19, s[16:19], s70 offen offset:3072 lds
buffer_load_dword v30, off, s[12:15], 0
s_add_u32 s70, s77, 917504
s_add_u32 m0, s78, 90112
s_and_b32 s70, s70, 0x1fffff
buffer_load_dwordx4 v16, s[16:19], s70 offen offset:0 lds
buffer_load_dwordx4 v17, s[16:19], s70 offen offset:1024 lds
buffer_load_dwordx4 v18, s[16:19], s70 offen offset:2048 lds
buffer_load_dwordx4 v19, s[16:19], s70 offen offset:3072 lds
buffer_load_dword v30, off, s[12:15], 0
s_add_u32 s35, s34, 17
lw_11:
ds_read_b32 v5, v1 offset:0
s_waitcnt lgkmcnt(0)
v_cmp_gt_i32 vcc, s35, v5
s_cbranch_vccz lwd_12
s_sleep 1
s_sub_u32 s32, s32, 1
s_cmp_gt_i32 s32, 0
s_cbranch_scc1 lw_11
lwd_12:
s_cmp_gt_u32 s59, s58
s_cbranch_scc0 nokv_10
poll_13:
buffer_load_dword v6, v1, s[24:27], s66 offen sc1
pchk_14:
s_waitcnt vmcnt(0)
v_cmp_eq_u32 vcc, 0, v6
s_cbranch_vccz pdone_15
s_sub_u32 s32, s32, 1
s_cmp_gt_i32 s32, 0
s_cbranch_scc1 poll_13
pdone_15:
s_cmp_eq_u32 s58, 0
s_cbranch_scc1 kd_16
v_mov_b32 v7, 0
s_add_u32 s35, s34, 17
lw_17:
ds_read_b32 v5, v7 offset:16
s_waitcnt lgkmcnt(0)
v_cmp_gt_i32 vcc, s35, v5
s_cbranch_vccz lwd_18
s_sleep 1
s_sub_u32 s32, s32, 1
s_cmp_gt_i32 s32, 0
s_cbranch_scc1 lw_17
lwd_18:
kd_16:
s_add_u32 m0, s65, 126976
s_nop 0
buffer_load_dwordx4 v20, s[20:23], s64 offen offset:0 sc1 lds
buffer_load_dwordx4 v20, s[20:23], s64 offen offset:1024 sc1 lds
buffer_load_dwordx4 v20, s[20:23], s64 offen offset:2048 sc1 lds
buffer_load_dwordx4 v20, s[20:23], s64 offen offset:3072 sc1 lds
buffer_load_dword v30, off, s[12:15], 0
s_add_u32 m0, s65, 122880
s_sub_u32 s64, s64, 4096
buffer_load_dwordx4 v20, s[20:23], s64 offen offset:0 sc1 lds
buffer_load_dwordx4 v20, s[20:23], s64 offen offset:1024 sc1 lds
buffer_load_dwordx4 v20, s[20:23], s64 offen offset:2048 sc1 lds
buffer_load_dwordx4 v20, s[20:23], s64 offen offset:3072 sc1 lds
buffer_load_dword v30, off, s[12:15], 0
s_add_u32 m0, s65, 118784
s_sub_u32 s64, s64, 4096
buffer_load_dwordx4 v20, s[20:23], s64 offen offset:0 sc1 lds
buffer_load_dwordx4 v20, s[20:23], s64 offen offset:1024 sc1 lds
buffer_load_dwordx4 v20, s[20:23], s64 offen offset:2048 sc1 lds
buffer_load_dwordx4 v20, s[20:23], s64 offen offset:3072 sc1 lds
buffer_load_dword v30, off, s[12:15], 0
s_add_u32 m0, s65, 114688
s_sub_u32 s64, s64, 4096
buffer_load_dwordx4 v20, s[20:23], s64 offen offset:0 sc1 lds
buffer_load_dwordx4 v20, s[20:23], s64 offen offset:1024 sc1 lds
buffer_load_dwordx4 v20, s[20:23], s64 offen offset:2048 sc1 lds
buffer_load_dwordx4 v20, s[20:23], s64 offen offset:3072 sc1 lds
buffer_load_dword v30, off, s[12:15], 0
s_add_u32 m0, s65, 110592
s_sub_u32 s64, s64, 4096
buffer_load_dwordx4 v20, s[20:23], s64 offen offset:0 sc1 lds
buffer_load_dwordx4 v20, s[20:23], s64 offen offset:1024 sc1 lds
buffer_load_dwordx4 v20, s[20:23], s64 offen offset:2048 sc1 lds
buffer_load_dwordx4 v20, s[20:23], s64 offen offset:3072 sc1 lds
buffer_load_dword v30, off, s[12:15], 0
s_add_u32 m0, s65, 106496
s_sub_u32 s64, s64, 4096
buffer_load_dwordx4 v20, s[20:23], s64 offen offset:0 sc1 lds
buffer_load_dwordx4 v20, s[20:23], s64 offen offset:1024 sc1 lds
buffer_load_dwordx4 v20, s[20:23], s64 offen offset:2048 sc1 lds
buffer_load_dwordx4 v20, s[20:23], s64 offen offset:3072 sc1 lds
buffer_load_dword v30, off, s[12:15], 0
s_add_u32 m0, s65, 102400
s_sub_u32 s64, s64, 4096
buffer_load_dwordx4 v20, s[20:23], s64 offen offset:0 sc1 lds
buffer_load_dwordx4 v20, s[20:23], s64 offen offset:1024 sc1 lds
buffer_load_dwordx4 v20, s[20:23], s64 offen offset:2048 sc1 lds
buffer_load_dwordx4 v20, s[20:23], s64 offen offset:3072 sc1 lds
buffer_load_dword v30, off, s[12:15], 0
s_add_u32 m0, s65, 98304
s_sub_u32 s64, s64, 4096
buffer_load_dwordx4 v20, s[20:23], s64 offen offset:0 sc1 lds
buffer_load_dwordx4 v20, s[20:23], s64 offen offset:1024 sc1 lds
buffer_load_dwordx4 v20, s[20:23], s64 offen offset:2048 sc1 lds
buffer_load_dwordx4 v20, s[20:23], s64 offen offset:3072 sc1 lds
buffer_load_dword v30, off, s[12:15], 0
v_add_u32 v5, s34, 17
s_mov_b64 exec, 1
ds_write_b32 v3, v5
s_mov_b64 exec, -1
s_waitcnt vmcnt(30)
v_add_u32 v5, s34, 18
s_mov_b64 exec, 1
ds_write_b32 v3, v5
s_mov_b64 exec, -1
nokv_10:
s_lshl_b32 s66, s61, 14
s_add_u32 s66, s66, 268288
s_waitcnt vmcnt(0)
v_add_u32 v5, s34, 21
s_mov_b64 exec, 1
ds_write_b32 v3, v5
s_mov_b64 exec, -1
s_add_u32 s35, s34, 18
lw_20:
ds_read_b32 v5, v1 offset:0
s_waitcnt lgkmcnt(0)
v_cmp_gt_i32 vcc, s35, v5
s_cbranch_vccz lwd_21
s_sleep 1
s_sub_u32 s32, s32, 1
s_cmp_gt_i32 s32, 0
s_cbranch_scc1 lw_20
lwd_21:
s_add_u32 s70, s77, 1572864
s_add_u32 m0, s78, 131072
s_and_b32 s70, s70, 0x1fffff
buffer_load_dwordx4 v16, s[16:19], s70 offen offset:0 lds
buffer_load_dwordx4 v17, s[16:19], s70 offen offset:1024 lds
buffer_load_dwordx4 v18, s[16:19], s70 offen offset:2048 lds
buffer_load_dwordx4 v19, s[16:19], s70 offen offset:3072 lds
buffer_load_dword v30, off, s[12:15], 0
s_add_u32 s70, s77, 1703936
s_add_u32 m0, s78, 139264
s_and_b32 s70, s70, 0x1fffff
buffer_load_dwordx4 v16, s[16:19], s70 offen offset:0 lds
buffer_load_dwordx4 v17, s[16:19], s70 offen offset:1024 lds
buffer_load_dwordx4 v18, s[16:19], s70 offen offset:2048 lds
buffer_load_dwordx4 v19, s[16:19], s70 offen offset:3072 lds
buffer_load_dword v30, off, s[12:15], 0
s_add_u32 s70, s77, 1835008
s_add_u32 m0, s78, 147456
s_and_b32 s70, s70, 0x1fffff
buffer_load_dwordx4 v16, s[16:19], s70 offen offset:0 lds
buffer_load_dwordx4 v17, s[16:19], s70 offen offset:1024 lds
buffer_load_dwordx4 v18, s[16:19], s70 offen offset:2048 lds
buffer_load_dwordx4 v19, s[16:19], s70 offen offset:3072 lds
buffer_load_dword v30, off, s[12:15], 0
s_add_u32 s70, s77, 1966080
s_add_u32 m0, s78, 155648
s_and_b32 s70, s70, 0x1fffff
buffer_load_dwordx4 v16, s[16:19], s70 offen offset:0 lds
buffer_load_dwordx4 v17, s[16:19], s70 offen offset:1024 lds
buffer_load_dwordx4 v18, s[16:19], s70 offen offset:2048 lds
buffer_load_dwordx4 v19, s[16:19], s70 offen offset:3072 lds
buffer_load_dword v30, off, s[12:15], 0
s_add_u32 s35, s34, 19
lw_22:
ds_read_b32 v5, v1 offset:0
s_waitcnt lgkmcnt(0)
v_cmp_gt_i32 vcc, s35, v5
s_cbranch_vccz lwd_23
s_sleep 2
s_sub_u32 s32, s32, 1
s_cmp_gt_i32 s32, 0
s_cbranch_scc1 lw_22
lwd_23:
s_add_u32 s70, s77, 1048576
s_add_u32 m0, s78, 98304
s_and_b32 s70, s70, 0x1fffff
buffer_load_dwordx4 v16, s[16:19], s70 offen offset:0 lds
buffer_load_dwordx4 v17, s[16:19], s70 offen offset:1024 lds
buffer_load_dwordx4 v18, s[16:19], s70 offen offset:2048 lds
buffer_load_dwordx4 v19, s[16:19], s70 offen offset:3072 lds
buffer_load_dword v30, off, s[12:15], 0
s_add_u32 s70, s77, 1179648
s_add_u32 m0, s78, 106496
s_and_b32 s70, s70, 0x1fffff
buffer_load_dwordx4 v16, s[16:19], s70 offen offset:0 lds
buffer_load_dwordx4 v17, s[16:19], s70 offen offset:1024 lds
buffer_load_dwordx4 v18, s[16:19], s70 offen offset:2048 lds
buffer_load_dwordx4 v19, s[16:19], s70 offen offset:3072 lds
buffer_load_dword v30, off, s[12:15], 0
s_add_u32 s70, s77, 1310720
s_add_u32 m0, s78, 114688
s_and_b32 s70, s70, 0x1fffff
buffer_load_dwordx4 v16, s[16:19], s70 offen offset:0 lds
buffer_load_dwordx4 v17, s[16:19], s70 offen offset:1024 lds
buffer_load_dwordx4 v18, s[16:19], s70 offen offset:2048 lds
buffer_load_dwordx4 v19, s[16:19], s70 offen offset:3072 lds
buffer_load_dword v30, off, s[12:15], 0
s_add_u32 s70, s77, 1441792
s_add_u32 m0, s78, 122880
s_and_b32 s70, s70, 0x1fffff
buffer_load_dwordx4 v16, s[16:19], s70 offen offset:0 lds
buffer_load_dwordx4 v17, s[16:19], s70 offen offset:1024 lds
buffer_load_dwordx4 v18, s[16:19], s70 offen offset:2048 lds
buffer_load_dwordx4 v19, s[16:19], s70 offen offset:3072 lds
buffer_load_dword v30, off, s[12:15], 0
s_add_u32 s35, s34, 20
lw_24:
ds_read_b32 v5, v1 offset:0
s_waitcnt lgkmcnt(0)
v_cmp_gt_i32 vcc, s35, v5
s_cbranch_vccz lwd_25
s_sleep 2
s_sub_u32 s32, s32, 1
s_cmp_gt_i32 s32, 0
s_cbranch_scc1 lw_24
lwd_25:
s_add_u32 s70, s77, 0
s_add_u32 m0, s78, 32768
s_and_b32 s70, s70, 0x1fffff
buffer_load_dwordx4 v16, s[16:19], s70 offen offset:0 lds
buffer_load_dwordx4 v17, s[16:19], s70 offen offset:1024 lds
buffer_load_dwordx4 v18, s[16:19], s70 offen offset:2048 lds
buffer_load_dwordx4 v19, s[16:19], s70 offen offset:3072 lds
buffer_load_dword v30, off, s[12:15], 0
s_cmp_eq_u32 s58, 0
s_cbranch_scc0 nofo_19
s_add_u32 s35, s34, 21
lw_26:
ds_read_b32 v5, v1 offset:0
s_waitcnt lgkmcnt(0)
v_cmp_gt_i32 vcc, s35, v5
s_cbranch_vccz lwd_27
s_sleep 1
s_sub_u32 s32, s32, 1
s_cmp_gt_i32 s32, 0
s_cbranch_scc1 lw_26
lwd_27:
poll_28:
buffer_load_dword v6, v21, s[24:27], s66 offen sc1
pchk_29:
s_waitcnt vmcnt(0)
v_cmp_eq_u32 vcc, 0, v6
s_cbranch_vccz pdone_30
s_sub_u32 s32, s32, 1
s_cmp_gt_i32 s32, 0
s_cbranch_scc1 poll_28
pdone_30:
nofo_19:
s_waitcnt vmcnt(0)
v_add_u32 v5, s34, 22
s_mov_b64 exec, 1
ds_write_b32 v3, v5
s_mov_b64 exec, -1
s_cmp_eq_u32 s63, 0
s_cbranch_scc0 L_end
v_bfe_u32 v6, v0, 3, 2
v_and_b32 v7, 2, v6
v_xor_b32 v7, v7, v22
v_lshrrev_b32 v23, 5, v0
v_lshl_add_u32 v6, v23, 4, v6
v_mul_u32_u24 v6, 6144, v6
v_lshl_add_u32 v12, v7, 4, v6
v_xor_b32 v6, 64, v12
v_add_u32 v13, 23552, v6
v_add_u32 v14, 47104, v12
v_add_u32 v15, 70656, v6
v_mov_b32 v8, v20
v_mov_b32 v9, v20
v_mov_b32 v10, v20
v_mov_b32 v11, v20
s_mov_b32 s8, s56
s_mov_b32 s9, s57
s_mov_b32 s10, 0x2500000
s_mov_b32 s11, 0x00020000
s_lshl_b32 s70, s59, 18
s_add_u32 s70, s70, 26214400
s_add_u32 s68, s70, s78
s_sub_u32 s69, s70, s78
s_add_u32 s69, s69, 12288
s_mov_b32 s67, 16384
s_lshl_b32 s66, s59, 14
s_add_u32 s66, s66, 274432
s_and_b32 s79, s59, 1
s_mul_i32 s79, s79, 1
s_mul_i32 s70, s60, 1
s_and_b32 s71, s59, 14
s_add_u32 s70, s70, s71
s_and_b32 s70, s70, 15
s_xor_b32 s64, s70, s79
s_mov_b32 s65, 86016
s_add_u32 s35, s34, 22
lw_31:
ds_read_b32 v5, v1 offset:0
s_waitcnt lgkmcnt(0)
v_cmp_gt_i32 vcc, s35, v5
s_cbranch_vccz lwd_32
s_sleep 2
s_sub_u32 s32, s32, 1
s_cmp_gt_i32 s32, 0
s_cbranch_scc1 lw_31
lwd_32:
s_mul_i32 s70, s64, 393216
s_add_u32 m0, s65, s76
s_add_u32 s71, s70, s72
buffer_load_dwordx4 v12, s[12:15], s71 offen offset:0 lds
buffer_load_dwordx4 v13, s[12:15], s71 offen offset:1024 lds
buffer_load_dwordx4 v14, s[12:15], s71 offen offset:2048 lds
buffer_load_dwordx4 v15, s[12:15], s71 offen offset:3072 lds
buffer_load_dword v30, off, s[12:15], 0
s_add_u32 m0, m0, 4096
s_add_u32 s71, s70, s73
buffer_load_dwordx4 v12, s[12:15], s71 offen offset:0 lds
buffer_load_dwordx4 v13, s[12:15], s71 offen offset:1024 lds
buffer_load_dwordx4 v14, s[12:15], s71 offen offset:2048 lds
buffer_load_dwordx4 v15, s[12:15], s71 offen offset:3072 lds
buffer_load_dword v30, off, s[12:15], 0
s_add_u32 m0, m0, 4096
s_add_u32 s71, s70, s74
buffer_load_dwordx4 v12, s[12:15], s71 offen offset:0 lds
buffer_load_dwordx4 v13, s[12:15], s71 offen offset:1024 lds
buffer_load_dwordx4 v14, s[12:15], s71 offen offset:2048 lds
buffer_load_dwordx4 v15, s[12:15], s71 offen offset:3072 lds
buffer_load_dword v30, off, s[12:15], 0
s_and_b32 s79, s59, 1
s_mul_i32 s79, s79, 1
s_mul_i32 s70, s60, 1
s_and_b32 s71, s59, 14
s_add_u32 s70, s70, s71
s_and_b32 s70, s70, 15
s_xor_b32 s64, s70, s79
s_mov_b32 s65, 86016
s_add_u32 s35, s34, 23
lw_33:
ds_read_b32 v5, v1 offset:0
s_waitcnt lgkmcnt(0)
v_cmp_gt_i32 vcc, s35, v5
s_cbranch_vccz lwd_34
s_sleep 1
s_sub_u32 s32, s32, 1
s_cmp_gt_i32 s32, 0
s_cbranch_scc1 lw_33
lwd_34:
poll_35:
buffer_load_dword v6, v21, s[24:27], s66 offen sc1
pchk_36:
s_waitcnt vmcnt(0)
v_cmp_eq_u32 vcc, 0, v6
s_cbranch_vccz pdone_37
s_sub_u32 s32, s32, 1
s_cmp_gt_i32 s32, 0
s_cbranch_scc1 poll_35
pdone_37:
s_mul_i32 s70, s64, s67
s_add_u32 m0, s65, s75
s_add_u32 s71, s70, s68
buffer_load_dwordx4 v8, s[8:11], s71 offen offset:0 sc1 lds
buffer_load_dwordx4 v9, s[8:11], s71 offen offset:1024 sc1 lds
buffer_load_dwordx4 v10, s[8:11], s71 offen offset:2048 sc1 lds
buffer_load_dwordx4 v11, s[8:11], s71 offen offset:3072 sc1 lds
buffer_load_dword v30, off, s[12:15], 0
s_add_u32 m0, m0, 4096
s_add_u32 s71, s70, s69
buffer_load_dwordx4 v8, s[8:11], s71 offen offset:0 sc1 lds
buffer_load_dwordx4 v9, s[8:11], s71 offen offset:1024 sc1 lds
buffer_load_dwordx4 v10, s[8:11], s71 offen offset:2048 sc1 lds
buffer_load_dwordx4 v11, s[8:11], s71 offen offset:3072 sc1 lds
buffer_load_dword v30, off, s[12:15], 0
s_xor_b32 s64, s64, s79
s_add_u32 s64, s64, 1
s_and_b32 s64, s64, 15
s_xor_b32 s64, s64, s79
s_sub_u32 s65, s65, 40960
s_cselect_b32 s65, 86016, s65
s_mul_i32 s70, s64, s67
s_add_u32 m0, s65, s75
s_add_u32 s71, s70, s68
buffer_load_dwordx4 v8, s[8:11], s71 offen offset:0 sc1 lds
buffer_load_dwordx4 v9, s[8:11], s71 offen offset:1024 sc1 lds
buffer_load_dwordx4 v10, s[8:11], s71 offen offset:2048 sc1 lds
buffer_load_dwordx4 v11, s[8:11], s71 offen offset:3072 sc1 lds
buffer_load_dword v30, off, s[12:15], 0
s_add_u32 m0, m0, 4096
s_add_u32 s71, s70, s69
buffer_load_dwordx4 v8, s[8:11], s71 offen offset:0 sc1 lds
buffer_load_dwordx4 v9, s[8:11], s71 offen offset:1024 sc1 lds
buffer_load_dwordx4 v10, s[8:11], s71 offen offset:2048 sc1 lds
buffer_load_dwordx4 v11, s[8:11], s71 offen offset:3072 sc1 lds
buffer_load_dword v30, off, s[12:15], 0
s_mul_i32 s70, s64, 393216
s_add_u32 m0, s65, s76
s_add_u32 s71, s70, s72
buffer_load_dwordx4 v12, s[12:15], s71 offen offset:0 lds
buffer_load_dwordx4 v13, s[12:15], s71 offen offset:1024 lds
buffer_load_dwordx4 v14, s[12:15], s71 offen offset:2048 lds
buffer_load_dwordx4 v15, s[12:15], s71 offen offset:3072 lds
buffer_load_dword v30, off, s[12:15], 0
s_add_u32 m0, m0, 4096
s_add_u32 s71, s70, s73
buffer_load_dwordx4 v12, s[12:15], s71 offen offset:0 lds
buffer_load_dwordx4 v13, s[12:15], s71 offen offset:1024 lds
buffer_load_dwordx4 v14, s[12:15], s71 offen offset:2048 lds
buffer_load_dwordx4 v15, s[12:15], s71 offen offset:3072 lds
buffer_load_dword v30, off, s[12:15], 0
s_add_u32 m0, m0, 4096
s_add_u32 s71, s70, s74
buffer_load_dwordx4 v12, s[12:15], s71 offen offset:0 lds
buffer_load_dwordx4 v13, s[12:15], s71 offen offset:1024 lds
buffer_load_dwordx4 v14, s[12:15], s71 offen offset:2048 lds
buffer_load_dwordx4 v15, s[12:15], s71 offen offset:3072 lds
buffer_load_dword v30, off, s[12:15], 0
s_xor_b32 s64, s64, s79
s_add_u32 s64, s64, 1
s_and_b32 s64, s64, 15
s_xor_b32 s64, s64, s79
s_sub_u32 s65, s65, 40960
s_cselect_b32 s65, 86016, s65
s_mul_i32 s70, s64, s67
s_add_u32 m0, s65, s75
s_add_u32 s71, s70, s68
buffer_load_dwordx4 v8, s[8:11], s71 offen offset:0 sc1 lds
buffer_load_dwordx4 v9, s[8:11], s71 offen offset:1024 sc1 lds
buffer_load_dwordx4 v10, s[8:11], s71 offen offset:2048 sc1 lds
buffer_load_dwordx4 v11, s[8:11], s71 offen offset:3072 sc1 lds
buffer_load_dword v30, off, s[12:15], 0
s_add_u32 m0, m0, 4096
s_add_u32 s71, s70, s69
buffer_load_dwordx4 v8, s[8:11], s71 offen offset:0 sc1 lds
buffer_load_dwordx4 v9, s[8:11], s71 offen offset:1024 sc1 lds
buffer_load_dwordx4 v10, s[8:11], s71 offen offset:2048 sc1 lds
buffer_load_dwordx4 v11, s[8:11], s71 offen offset:3072 sc1 lds
buffer_load_dword v30, off, s[12:15], 0
s_mul_i32 s70, s64, 393216
s_add_u32 m0, s65, s76
s_add_u32 s71, s70, s72
buffer_load_dwordx4 v12, s[12:15], s71 offen offset:0 lds
buffer_load_dwordx4 v13, s[12:15], s71 offen offset:1024 lds
buffer_load_dwordx4 v14, s[12:15], s71 offen offset:2048 lds
buffer_load_dwordx4 v15, s[12:15], s71 offen offset:3072 lds
buffer_load_dword v30, off, s[12:15], 0
s_add_u32 m0, m0, 4096
s_add_u32 s71, s70, s73
buffer_load_dwordx4 v12, s[12:15], s71 offen offset:0 lds
buffer_load_dwordx4 v13, s[12:15], s71 offen offset:1024 lds
buffer_load_dwordx4 v14, s[12:15], s71 offen offset:2048 lds
buffer_load_dwordx4 v15, s[12:15], s71 offen offset:3072 lds
buffer_load_dword v30, off, s[12:15], 0
s_add_u32 m0, m0, 4096
s_add_u32 s71, s70, s74
buffer_load_dwordx4 v12, s[12:15], s71 offen offset:0 lds
buffer_load_dwordx4 v13, s[12:15], s71 offen offset:1024 lds
buffer_load_dwordx4 v14, s[12:15], s71 offen offset:2048 lds
buffer_load_dwordx4 v15, s[12:15], s71 offen offset:3072 lds
buffer_load_dword v30, off, s[12:15], 0
s_xor_b32 s64, s64, s79
s_add_u32 s64, s64, 1
s_and_b32 s64, s64, 15
s_xor_b32 s64, s64, s79
s_sub_u32 s65, s65, 40960
s_cselect_b32 s65, 86016, s65
s_waitcnt vmcnt(50)
v_add_u32 v5, s34, 33
s_mov_b64 exec, 1
ds_write_b32 v3, v5
s_mov_b64 exec, -1
s_mov_b32 s36, s64
s_mov_b32 s37, s65
s_mov_b32 s64, s59
s_mov_b32 s65, 114688
s_mul_i32 s70, s64, 393216
s_add_u32 m0, s65, s76
s_add_u32 s71, s70, s72
buffer_load_dwordx4 v12, s[12:15], s71 offen offset:0 lds
buffer_load_dwordx4 v13, s[12:15], s71 offen offset:1024 lds
buffer_load_dwordx4 v14, s[12:15], s71 offen offset:2048 lds
buffer_load_dwordx4 v15, s[12:15], s71 offen offset:3072 lds
buffer_load_dword v30, off, s[12:15], 0
s_add_u32 m0, m0, 4096
s_add_u32 s71, s70, s73
buffer_load_dwordx4 v12, s[12:15], s71 offen offset:0 lds
buffer_load_dwordx4 v13, s[12:15], s71 offen offset:1024 lds
buffer_load_dwordx4 v14, s[12:15], s71 offen offset:2048 lds
buffer_load_dwordx4 v15, s[12:15], s71 offen offset:3072 lds
buffer_load_dword v30, off, s[12:15], 0
s_add_u32 m0, m0, 4096
s_add_u32 s71, s70, s74
buffer_load_dwordx4 v12, s[12:15], s71 offen offset:0 lds
buffer_load_dwordx4 v13, s[12:15], s71 offen offset:1024 lds
buffer_load_dwordx4 v14, s[12:15], s71 offen offset:2048 lds
buffer_load_dwordx4 v15, s[12:15], s71 offen offset:3072 lds
buffer_load_dword v30, off, s[12:15], 0
s_mov_b32 s64, s36
s_mov_b32 s65, s37
s_waitcnt vmcnt(40)
v_add_u32 v5, s34, 34
s_mov_b64 exec, 1
ds_write_b32 v3, v5
s_mov_b64 exec, -1
s_mov_b32 s63, 1
s_mov_b32 s34, 32
s_add_u32 s24, s24, 1409024
s_addc_u32 s25, s25, 0
s_mov_b32 s26, 1409024
s_mov_b32 s66, 32
s_branch lq_1
lcs_2:
s_add_u32 s35, s34, 1
lw_38:
ds_read_b32 v5, v2 offset:24
s_waitcnt lgkmcnt(0)
v_cmp_gt_i32 vcc, s35, v5
s_cbranch_vccz lwd_39
s_sub_u32 s32, s32, 1
s_cmp_gt_i32 s32, 0
s_cbranch_scc1 lw_38
lwd_39:
s_branch lcb_3
L_f:
v_lshlrev_b32 v4, 4, v0
s_lshl4_add_u32 s78, s59, s60
v_mov_b32 v252, 0
v_mov_b32 v253, 0
v_mov_b32 v254, 0
v_mov_b32 v255, 0
s_lshl_b32 s35, s78, 10
s_cmp_eq_u32 s58, 0
s_cselect_b64 exec, -1, 0
buffer_store_dwordx4 v[252:255], v4, s[24:27], s35 offen offset:0 sc1
s_add_u32 s35, s35, 262144
buffer_store_dwordx4 v[252:255], v4, s[24:27], s35 offen offset:0 sc1
s_mov_b64 exec, -1
s_setprio 3
v_and_b32 v1, 3, v0
v_lshlrev_b32 v1, 2, v1
v_and_b32 v2, 4, v1
s_lshl2_add_u32 s35, s58, 24
v_mov_b32 v3, s35
s_mov_b32 s4, s54
s_mov_b32 s5, s55
s_mov_b32 s6, 0x100
s_mov_b32 s7, 0x00020000
s_add_u32 s70, s60, 4
s_lshr_b32 s70, s70, 3
s_sub_u32 s70, s60, s70
s_lshl4_add_u32 s64, s70, s59
s_and_b32 s70, s60, 7
s_cmp_eq_u32 s70, 3
s_cselect_b32 s65, 1, 0
s_mov_b32 s69, 0x3f803f80
s_barrier
s_cmp_eq_u32 s58, 0
s_cselect_b32 s16, s46, s48
s_cselect_b32 s17, s47, s49
s_mov_b32 s12, s50
s_mov_b32 s13, s51
s_mov_b32 s14, 0x0
s_mov_b32 s15, 0x00020000
s_cmp_eq_u32 s65, 0
s_cselect_b32 s18, 7340032, 0
s_mov_b32 s14, s18
s_lshr_b32 s70, s64, 3
s_and_b32 s71, s64, 7
s_lshl_b32 s66, s70, 10
s_add_u32 s66, s66, s71
s_lshl1_add_u32 s66, s66, s58
s_lshl_b32 s66, s66, 7
s_mul_i32 s71, s71, 917504
s_lshl_b32 s70, s70, 8
s_add_u32 s77, s71, s70
s_mov_b32 s48, s38
s_mov_b32 s49, s39
s_mov_b32 s50, 0x600000
s_mov_b32 s51, 0x00020000
s_mov_b32 s52, 0
s_and_b32 s54, s60, 8
s_add_u32 s54, s54, 3
s_add_u32 s53, s54, s59
s_and_b32 s55, s60, 7
s_lshl1_add_u32 s55, s55, s58
s_mul_i32 s55, s55, 24576
s_lshl_b32 s54, s54, 7
s_add_u32 s56, s54, s55
s_add_u32 s56, s56, 60
s_and_b32 s73, s2, 3
s_lshl_b32 s73, s73, 6
v_mov_b32 v14, 1
s_sub_u32 exec_lo, 1, s58
s_mov_b32 exec_hi, 0
s_waitcnt vmcnt(0)
buffer_atomic_add v14, off, s[4:7], s73 sc1
s_mov_b64 exec, -1
v_mov_b32 v8, s69
v_mov_b32 v9, s69
v_mov_b32 v10, s69
v_mov_b32 v11, s69
v_mov_b32 v12, s69
v_mov_b32 v13, s69
v_mov_b32 v14, s69
v_mov_b32 v15, s69
s_mov_b32 s70, 102400
ftop_42:
v_lshrrev_b32 v6, 4, v0
v_bfe_u32 v7, v0, 2, 2
v_lshl_add_u32 v6, v6, 3, v7
v_bfe_u32 v7, v0, 3, 2
s_lshl_b32 s71, s58, 1
v_xor_b32 v7, s71, v7
v_lshl_add_u32 v7, v7, 5, s70
v_lshl_add_u32 v6, v6, 7, v7
v_lshl_add_u32 v6, v1, 1, v6
v_xor_b32 v7, 32, v6
s_mul_i32 s71, s63, 34
s_add_u32 s35, s71, 1
lw_43:
ds_read_b32 v5, v2 offset:16
s_waitcnt lgkmcnt(0)
v_cmp_gt_i32 vcc, s35, v5
s_cbranch_vccz lwd_44
s_sleep 1
s_sub_u32 s32, s32, 1
s_cmp_gt_i32 s32, 0
s_cbranch_scc1 lw_43
lwd_44:
ds_read_b64_tr_b16 v[24:25], v6 offset:0
ds_read_b64_tr_b16 v[26:27], v6 offset:512
ds_read_b64_tr_b16 v[28:29], v6 offset:4096
ds_read_b64_tr_b16 v[30:31], v6 offset:4608
ds_read_b64_tr_b16 v[32:33], v7 offset:0
ds_read_b64_tr_b16 v[34:35], v7 offset:512
ds_read_b64_tr_b16 v[36:37], v7 offset:4096
ds_read_b64_tr_b16 v[38:39], v7 offset:4608
ds_read_b64_tr_b16 v[40:41], v6 offset:8192
ds_read_b64_tr_b16 v[42:43], v6 offset:8704
ds_read_b64_tr_b16 v[44:45], v6 offset:12288
ds_read_b64_tr_b16 v[46:47], v6 offset:12800
ds_read_b64_tr_b16 v[48:49], v7 offset:8192
ds_read_b64_tr_b16 v[50:51], v7 offset:8704
ds_read_b64_tr_b16 v[52:53], v7 offset:12288
ds_read_b64_tr_b16 v[54:55], v7 offset:12800
s_lshl_b32 s72, s60, 14
s_lshl_b32 s70, s58, 9
s_add_u32 s72, s72, s70
s_lshl_b32 s70, s59, 10
s_add_u32 s71, s72, s70
s_lshl_b32 s76, s59, 14
s_add_u32 s73, s76, 30686208
s_add_u32 s76, s76, 266240
s_waitcnt lgkmcnt(14)
v_mfma_f32_16x16x32_bf16 v[248:251], v[8:11], v[24:27], 0
s_waitcnt lgkmcnt(10)
v_mfma_f32_16x16x32_bf16 v[252:255], v[8:11], v[32:35], 0
v_mfma_f32_16x16x32_bf16 v[248:251], v[12:15], v[28:31], v[248:251]
s_waitcnt lgkmcnt(8)
v_mfma_f32_16x16x32_bf16 v[252:255], v[12:15], v[36:39], v[252:255]
ds_read_b64_tr_b16 v[24:25], v6 offset:16384
ds_read_b64_tr_b16 v[26:27], v6 offset:16896
ds_read_b64_tr_b16 v[28:29], v6 offset:20480
ds_read_b64_tr_b16 v[30:31], v6 offset:20992
ds_read_b64_tr_b16 v[32:33], v7 offset:16384
ds_read_b64_tr_b16 v[34:35], v7 offset:16896
ds_read_b64_tr_b16 v[36:37], v7 offset:20480
ds_read_b64_tr_b16 v[38:39], v7 offset:20992
v_add_u32 v5, s34, 1
s_mov_b64 exec, 1
ds_write_b32 v3, v5
s_mov_b64 exec, -1
s_waitcnt lgkmcnt(14)
v_mfma_f32_16x16x32_bf16 v[16:19], v[8:11], v[40:43], 0
s_waitcnt lgkmcnt(11)
v_mfma_f32_16x16x32_bf16 v[20:23], v[8:11], v[48:51], 0
v_mfma_f32_16x16x32_bf16 v[16:19], v[12:15], v[44:47], v[16:19]
s_waitcnt lgkmcnt(9)
v_mfma_f32_16x16x32_bf16 v[20:23], v[12:15], v[52:55], v[20:23]
v_mov_b32 v249, v252
v_mov_b32 v252, s69
v_mov_b32 v253, s69
v_mov_b32 v254, s69
v_mov_b32 v255, s69
v_mfma_f32_16x16x32_bf16 v[52:55], v[8:11], v[8:11], 0
s_nop 0
v_mfma_f32_16x16x32_bf16 v[48:51], v[8:11], v[252:255], 0
v_mfma_f32_16x16x32_bf16 v[52:55], v[12:15], v[12:15], v[52:55]
v_mfma_f32_16x16x32_bf16 v[48:51], v[12:15], v[252:255], v[48:51]
s_waitcnt lgkmcnt(7)
v_mfma_f32_16x16x32_bf16 v[40:43], v[8:11], v[24:27], 0
s_waitcnt lgkmcnt(3)
v_mfma_f32_16x16x32_bf16 v[44:47], v[8:11], v[32:35], 0
v_mfma_f32_16x16x32_bf16 v[40:43], v[12:15], v[28:31], v[40:43]
s_waitcnt lgkmcnt(1)
v_mfma_f32_16x16x32_bf16 v[44:47], v[12:15], v[36:39], v[44:47]
v_lshlrev_b32 v6, 3, v0
v_and_b32 v7, 48, v0
v_mov_b32_dpp v248, v16 quad_perm:[0,1,2,3] row_mask:0x2 bank_mask:0xf
v_mov_b32_dpp v249, v20 quad_perm:[0,1,2,3] row_mask:0x2 bank_mask:0xf
s_nop 0
v_mov_b32_dpp v248, v48 quad_perm:[0,1,2,3] row_mask:0x8 bank_mask:0xf
v_mov_b32_dpp v249, v52 quad_perm:[0,1,2,3] row_mask:0x8 bank_mask:0xf
s_nop 0
v_mov_b32_dpp v248, v40 quad_perm:[0,1,2,3] row_mask:0x4 bank_mask:0xf
v_mov_b32_dpp v249, v44 quad_perm:[0,1,2,3] row_mask:0x4 bank_mask:0xf
v_max_u32 v248, 1, v248
v_max_u32 v249, 1, v249
s_cmp_eq_u32 s63, 0
s_cbranch_scc1 fst_40
fsb_41:
buffer_store_dwordx2 v[248:249], v6, s[24:27], s71 offen sc1
s_lshl4_add_u32 s70, s58, s60
s_add_u32 s70, s70, s34
s_cmp_eq_u32 s70, 51
s_cbranch_scc1 fxt_45
fxb_46:
s_add_u32 s73, s72, 4096
s_add_u32 s74, s72, 8192
s_add_u32 s75, s72, 12288
v_lshrrev_b32 v7, 2, v0
v_lshlrev_b32 v7, 7, v7
v_lshl_add_u32 v7, v1, 2, v7
v_lshrrev_b32 v8, 5, v0
v_lshrrev_b32 v9, 4, v0
v_xor_b32 v10, v8, v9
v_and_b32 v10, 1, v10
v_lshl_add_u32 v8, v10, 1, v8
v_and_b32 v10, 15, v0
v_lshlrev_b32 v8, 7, v8
v_lshl_add_u32 v8, v10, 3, v8
v_add_u32 v8, 1280, v8
s_mul_i32 s70, s58, 384
s_lshl_b32 s71, s63, 10
s_add_u32 s70, s70, s71
s_add_u32 s70, s70, 2304
v_lshl_add_u32 v9, v9, 7, s70
v_lshl_add_u32 v9, v10, 2, v9
s_cmp_eq_u32 s63, 0
s_cbranch_scc1 fg_47
fg_48:
poll_49:
buffer_load_dwordx4 v[12:15], v7, s[24:27], s76 offen sc1
pchk_50:
s_waitcnt vmcnt(0)
v_min3_u32 v10, v12, v13, v14
v_min_u32 v10, v10, v15
v_cmp_eq_u32 vcc, 0, v10
s_cbranch_vccz pdone_51
s_sub_u32 s32, s32, 1
s_cmp_gt_i32 s32, 0
s_cbranch_scc1 poll_49
pdone_51:
s_lshr_b32 s70, s33, 7
s_sub_u32 s70, s70, s59
s_mul_i32 s70, s70, s63
s_cmp_eq_u32 s70, 0
s_cbranch_scc0 fng_52
s_lshl1_add_u32 s70, s34, -32
s_add_u32 s35, s70, 15
lw_53:
ds_read_b32 v5, v2 offset:16
s_waitcnt lgkmcnt(0)
v_cmp_gt_i32 vcc, s35, v5
s_cbranch_vccz lwd_54
s_sleep 4
s_sub_u32 s32, s32, 1
s_cmp_gt_i32 s32, 0
s_cbranch_scc1 lw_53
lwd_54:
poll_55:
buffer_load_dwordx2 v[24:25], v6, s[24:27], s72 offen offset:0 sc1
buffer_load_dwordx2 v[26:27], v6, s[24:27], s72 offen offset:1024 sc1
buffer_load_dwordx2 v[28:29], v6, s[24:27], s72 offen offset:2048 sc1
buffer_load_dwordx2 v[30:31], v6, s[24:27], s72 offen offset:3072 sc1
buffer_load_dwordx2 v[32:33], v6, s[24:27], s73 offen offset:0 sc1
buffer_load_dwordx2 v[34:35], v6, s[24:27], s73 offen offset:1024 sc1
buffer_load_dwordx2 v[36:37], v6, s[24:27], s73 offen offset:2048 sc1
buffer_load_dwordx2 v[38:39], v6, s[24:27], s73 offen offset:3072 sc1
buffer_load_dwordx2 v[40:41], v6, s[24:27], s74 offen offset:0 sc1
buffer_load_dwordx2 v[42:43], v6, s[24:27], s74 offen offset:1024 sc1
buffer_load_dwordx2 v[44:45], v6, s[24:27], s74 offen offset:2048 sc1
buffer_load_dwordx2 v[46:47], v6, s[24:27], s74 offen offset:3072 sc1
buffer_load_dwordx2 v[48:49], v6, s[24:27], s75 offen offset:0 sc1
buffer_load_dwordx2 v[50:51], v6, s[24:27], s75 offen offset:1024 sc1
buffer_load_dwordx2 v[52:53], v6, s[24:27], s75 offen offset:2048 sc1
buffer_load_dwordx2 v[54:55], v6, s[24:27], s75 offen offset:3072 sc1
pchk_56:
s_waitcnt vmcnt(14)
v_min3_u32 v10, v24, v25, v26
s_waitcnt vmcnt(13)
v_min3_u32 v10, v10, v27, v28
s_waitcnt vmcnt(12)
v_min3_u32 v10, v10, v29, v30
s_waitcnt vmcnt(11)
v_min3_u32 v10, v10, v31, v32
s_waitcnt vmcnt(10)
v_min3_u32 v10, v10, v33, v34
s_waitcnt vmcnt(9)
v_min3_u32 v10, v10, v35, v36
s_waitcnt vmcnt(8)
v_min3_u32 v10, v10, v37, v38
s_waitcnt vmcnt(7)
v_min3_u32 v10, v10, v39, v40
s_waitcnt vmcnt(6)
v_min3_u32 v10, v10, v41, v42
s_waitcnt vmcnt(5)
v_min3_u32 v10, v10, v43, v44
s_waitcnt vmcnt(4)
v_min3_u32 v10, v10, v45, v46
s_waitcnt vmcnt(3)
v_min3_u32 v10, v10, v47, v48
s_waitcnt vmcnt(2)
v_min3_u32 v10, v10, v49, v50
s_waitcnt vmcnt(1)
v_min3_u32 v10, v10, v51, v52
s_waitcnt vmcnt(0)
v_min3_u32 v10, v10, v53, v54
v_min_u32 v10, v10, v55
v_cmp_eq_u32 vcc, 0, v10
s_cbranch_vccz pdone_57
s_sub_u32 s32, s32, 1
s_cmp_gt_i32 s32, 0
s_cbranch_scc1 poll_55
pdone_57:
v_add_f32 v24, v24, v40
v_add_f32 v25, v25, v41
v_add_f32 v26, v26, v42
v_add_f32 v27, v27, v43
v_add_f32 v28, v28, v44
v_add_f32 v29, v29, v45
v_add_f32 v30, v30, v46
v_add_f32 v31, v31, v47
v_add_f32 v32, v32, v48
v_add_f32 v33, v33, v49
v_add_f32 v34, v34, v50
v_add_f32 v35, v35, v51
v_add_f32 v36, v36, v52
v_add_f32 v37, v37, v53
v_add_f32 v38, v38, v54
v_add_f32 v39, v39, v55
v_add_f32 v24, v24, v32
v_add_f32 v25, v25, v33
v_add_f32 v26, v26, v34
v_add_f32 v27, v27, v35
v_add_f32 v28, v28, v36
v_add_f32 v29, v29, v37
v_add_f32 v30, v30, v38
v_add_f32 v31, v31, v39
v_add_f32 v24, v24, v28
v_add_f32 v25, v25, v29
v_add_f32 v26, v26, v30
v_add_f32 v27, v27, v31
v_add_f32 v24, v24, v26
v_add_f32 v25, v25, v27
s_mov_b32 exec_hi, 0xffff
ds_write2_b32 v9, v24, v25 offset1:16
s_mov_b32 exec_hi, -1
v_mul_f32 v5, 0xba800000, v24
v_mul_f32 v25, 0x3a800000, v25
v_fma_f32 v25, -v5, v5, v25
v_max_f32 v25, 0, v25
v_add_f32 v25, 0x3727c5ac, v25
v_rsq_f32 v24, v25
s_nop 0
v_mul_f32 v25, v5, v24
s_lshl_b32 s70, s59, 7
s_sub_u32 s70, s33, s70
v_lshlrev_b32 v10, 1, v0
v_sub_u32 v10, s70, v10
v_readlane_b32 s70, v24, 48
v_readlane_b32 s71, v25, 48
v_cmp_eq_u32 vcc, 0, v10
s_mov_b64 exec, vcc
v_mov_b32 v12, s70
v_mov_b32 v13, s71
s_mov_b64 exec, -1
v_cmp_eq_u32 vcc, 1, v10
s_mov_b64 exec, vcc
v_mov_b32 v14, s70
v_mov_b32 v15, s71
s_mov_b64 exec, -1
fng_52:
ds_write2_b32 v8, v12, v14 offset1:1
ds_write2_b32 v8, v13, v15 offset0:128 offset1:129
s_add_u32 s71, s34, s63
v_add_u32 v5, s71, 2
s_mov_b64 exec, 1
ds_write_b32 v3, v5
s_mov_b64 exec, -1
s_setprio 0
s_cmp_eq_u32 s63, 0
s_cbranch_scc1 fnw_58
fnw_59:
s_and_b32 s70, s64, 7
s_lshl_b32 s70, s70, 7
s_add_u32 s73, s70, 276480
s_lshl1_add_u32 s72, s70, 272384
s_lshr_b32 s71, s64, 3
s_lshl_b32 s76, s71, 13
s_add_u32 s76, s76, 1048576
s_lshl2_add_u32 s74, s70, s76
s_lshl_b32 s70, s58, 8
s_add_u32 s74, s74, s70
s_add_u32 s75, s74, 4096
s_lshl4_add_u32 s76, s70, s76
v_and_b32 v251, 15, v0
v_lshlrev_b32 v6, 14, v251
v_lshrrev_b32 v252, 4, v0
v_lshl_add_u32 v7, v252, 5, v6
v_lshlrev_b32 v251, 4, v251
s_lshl_b32 s70, s58, 3
v_lshl_add_u32 v253, v252, 1, s70
v_add_u32 v253, v253, v251
v_lshlrev_b32 v254, 5, v252
v_lshl_add_u32 v254, v2, 2, v254
v_and_b32 v255, 7, v0
v_lshl_add_u32 v255, v255, 2, v252
v_lshlrev_b32 v255, 3, v255
s_add_u32 s35, s34, 22
lw_60:
ds_read_b32 v5, v1 offset:0
s_waitcnt lgkmcnt(0)
v_cmp_gt_i32 vcc, s35, v5
s_cbranch_vccz lwd_61
s_sleep 4
s_sub_u32 s32, s32, 1
s_cmp_gt_i32 s32, 0
s_cbranch_scc1 lw_60
lwd_61:
s_setprio 3
s_add_u32 s35, s34, 24
lw_62:
ds_read_b32 v5, v1 offset:0
s_waitcnt lgkmcnt(0)
v_cmp_gt_i32 vcc, s35, v5
s_cbranch_vccz lwd_63
s_sleep 2
s_sub_u32 s32, s32, 1
s_cmp_gt_i32 s32, 0
s_cbranch_scc1 lw_62
lwd_63:
s_mul_i32 s79, s63, 64
s_sub_u32 s79, 32, s79
s_add_u32 s35, s79, 3
tw_64:
ds_read_b32 v5, v2 offset:16
s_waitcnt lgkmcnt(0)
v_cmp_gt_i32 vcc, s35, v5
s_cbranch_vccz twd_65
v_readfirstlane_b32 s54, v5
s_sub_u32 s55, s35, s54
s_cmp_lt_i32 s55, 2
s_cbranch_scc1 tws_66
s_add_u32 s54, s54, 2
s_or_b32 s54, s54, 1
s_cmp_eq_u32 s54, s52
s_cbranch_scc1 tws_66
s_bitcmp1_b32 s54, 4
s_cbranch_scc1 tws_66
s_mov_b32 s52, s54
s_add_u32 s54, s54, s53
s_and_b32 s54, s54, 15
s_mul_i32 s54, s54, 393216
s_add_u32 s54, s54, s56
s_buffer_load_dwordx2 s[46:47], s[48:51], s54 offset:4096
s_buffer_load_dwordx2 s[46:47], s[48:51], s54 offset:10240
s_buffer_load_dwordx2 s[46:47], s[48:51], s54 offset:16384
s_buffer_load_dwordx2 s[46:47], s[48:51], s54 offset:22528
tws_66:
s_sleep 4
s_sub_u32 s32, s32, 1
s_cmp_gt_i32 s32, 0
s_cbranch_scc1 tw_64
twd_65:
s_cmp_eq_u32 s65, 0
s_cbranch_scc0 fnd_68
poll_69:
buffer_load_dwordx2 v[248:249], v6, s[24:27], s73 offen sc1
buffer_load_dwordx4 v[8:11], v7, s[24:27], s72 offen offset:0 sc1
buffer_load_dwordx4 v[12:15], v7, s[24:27], s72 offen offset:16 sc1
buffer_load_dwordx4 v[16:19], v7, s[24:27], s72 offen offset:128 sc1
buffer_load_dwordx4 v[20:23], v7, s[24:27], s72 offen offset:144 sc1
pchk_70:
s_waitcnt vmcnt(3)
v_min3_u32 v5, v248, v249, v8
v_min3_u32 v5, v5, v9, v10
s_waitcnt vmcnt(2)
v_min3_u32 v5, v5, v11, v12
v_min3_u32 v5, v5, v13, v14
s_waitcnt vmcnt(1)
v_min3_u32 v5, v5, v15, v16
v_min3_u32 v5, v5, v17, v18
s_waitcnt vmcnt(0)
v_min3_u32 v5, v5, v19, v20
v_min3_u32 v5, v5, v21, v22
v_min_u32 v5, v5, v23
v_cmp_eq_u32 vcc, 0, v5
s_cbranch_vccz pdone_71
s_sub_u32 s32, s32, 1
s_cmp_gt_i32 s32, 0
s_cbranch_scc1 poll_69
pdone_71:
v_mfma_f32_16x16x32_bf16 v[24:27], v[8:11], v[56:59], 0
v_mov_b32 v250, v248
v_mfma_f32_16x16x32_bf16 v[28:31], v[8:11], v[60:63], 0
s_nop 0
v_max_f32_dpp v250, v250, v250 row_ror:1 row_mask:0xf bank_mask:0xf
v_mfma_f32_16x16x32_bf16 v[32:35], v[8:11], v[64:67], 0
s_nop 0
v_max_f32_dpp v250, v250, v250 row_ror:2 row_mask:0xf bank_mask:0xf
v_mfma_f32_16x16x32_bf16 v[36:39], v[8:11], v[68:71], 0
s_nop 0
v_max_f32_dpp v250, v250, v250 row_ror:4 row_mask:0xf bank_mask:0xf
v_mfma_f32_16x16x32_bf16 v[40:43], v[8:11], v[72:75], 0
s_nop 0
v_max_f32_dpp v250, v250, v250 row_ror:8 row_mask:0xf bank_mask:0xf
v_mfma_f32_16x16x32_bf16 v[44:47], v[8:11], v[76:79], 0
v_cmp_eq_f32 vcc, v250, v248
v_mfma_f32_16x16x32_bf16 v[48:51], v[8:11], v[80:83], 0
s_ff1_i32_b64 s68, vcc
v_mfma_f32_16x16x32_bf16 v[52:55], v[8:11], v[84:87], 0
s_and_b32 s68, s68, 15
v_mfma_f32_16x16x32_bf16 v[24:27], v[12:15], v[88:91], v[24:27]
v_readlane_b32 s33, v249, s68
v_mfma_f32_16x16x32_bf16 v[28:31], v[12:15], v[92:95], v[28:31]
v_readlane_b32 s67, v248, s68
v_mfma_f32_16x16x32_bf16 v[32:35], v[12:15], v[96:99], v[32:35]
v_add_u32 v5, s34, 4
v_mfma_f32_16x16x32_bf16 v[36:39], v[12:15], v[100:103], v[36:39]
v_mov_b32 v250, s33
v_mfma_f32_16x16x32_bf16 v[40:43], v[12:15], v[104:107], v[40:43]
s_mov_b64 exec, 1
ds_write2_b32 v3, v5, v250 offset1:2
s_mov_b64 exec, -1
v_mfma_f32_16x16x32_bf16 v[44:47], v[12:15], v[108:111], v[44:47]
s_sub_u32 s33, s33, 1
v_mfma_f32_16x16x32_bf16 v[48:51], v[12:15], v[112:115], v[48:51]
s_and_b32 s33, s33, 2047
v_mfma_f32_16x16x32_bf16 v[52:55], v[12:15], v[116:119], v[52:55]
v_mfma_f32_16x16x32_bf16 v[24:27], v[16:19], v[120:123], v[24:27]
v_mfma_f32_16x16x32_bf16 v[28:31], v[16:19], v[124:127], v[28:31]
v_mfma_f32_16x16x32_bf16 v[32:35], v[16:19], v[128:131], v[32:35]
v_mfma_f32_16x16x32_bf16 v[36:39], v[16:19], v[132:135], v[36:39]
v_mfma_f32_16x16x32_bf16 v[40:43], v[16:19], v[136:139], v[40:43]
v_mfma_f32_16x16x32_bf16 v[44:47], v[16:19], v[140:143], v[44:47]
v_mfma_f32_16x16x32_bf16 v[48:51], v[16:19], v[144:147], v[48:51]
v_mfma_f32_16x16x32_bf16 v[52:55], v[16:19], v[148:151], v[52:55]
v_mfma_f32_16x16x32_bf16 v[24:27], v[20:23], v[152:155], v[24:27]
s_and_b32 s70, s68, 12
s_lshl_b32 s70, s70, 2
s_bitcmp1_b32 s68, 1
v_mfma_f32_16x16x32_bf16 v[28:31], v[20:23], v[156:159], v[28:31]
v_mfma_f32_16x16x32_bf16 v[32:35], v[20:23], v[160:163], v[32:35]
v_mfma_f32_16x16x32_bf16 v[36:39], v[20:23], v[164:167], v[36:39]
v_mfma_f32_16x16x32_bf16 v[40:43], v[20:23], v[168:171], v[40:43]
v_mfma_f32_16x16x32_bf16 v[44:47], v[20:23], v[172:175], v[44:47]
v_mfma_f32_16x16x32_bf16 v[48:51], v[20:23], v[176:179], v[48:51]
v_mfma_f32_16x16x32_bf16 v[52:55], v[20:23], v[180:183], v[52:55]
s_cbranch_scc1 fsel_74
fsel_72:
s_bitcmp1_b32 s68, 0
s_cbranch_scc1 fsel_73
v_max_u32 v8, 1, v24
v_max_u32 v9, 1, v28
v_max_u32 v10, 1, v32
v_max_u32 v11, 1, v36
v_max_u32 v12, 1, v40
v_max_u32 v13, 1, v44
v_max_u32 v14, 1, v48
v_max_u32 v15, 1, v52
s_branch fsel_76
fsel_73:
v_max_u32 v8, 1, v25
v_max_u32 v9, 1, v29
v_max_u32 v10, 1, v33
v_max_u32 v11, 1, v37
v_max_u32 v12, 1, v41
v_max_u32 v13, 1, v45
v_max_u32 v14, 1, v49
v_max_u32 v15, 1, v53
s_branch fsel_76
fsel_74:
s_bitcmp1_b32 s68, 0
s_cbranch_scc1 fsel_75
v_max_u32 v8, 1, v26
v_max_u32 v9, 1, v30
v_max_u32 v10, 1, v34
v_max_u32 v11, 1, v38
v_max_u32 v12, 1, v42
v_max_u32 v13, 1, v46
v_max_u32 v14, 1, v50
v_max_u32 v15, 1, v54
s_branch fsel_76
fsel_75:
v_max_u32 v8, 1, v27
v_max_u32 v9, 1, v31
v_max_u32 v10, 1, v35
v_max_u32 v11, 1, v39
v_max_u32 v12, 1, v43
v_max_u32 v13, 1, v47
v_max_u32 v14, 1, v51
v_max_u32 v15, 1, v55
fsel_76:
s_bfm_b64 exec, 16, s70
buffer_store_dwordx4 v[8:11], v251, s[24:27], s74 offen sc1
buffer_store_dwordx4 v[12:15], v251, s[24:27], s75 offen sc1
s_mov_b64 exec, -1
s_and_b32 s70, s64, 7
s_lshl1_add_u32 s70, s70, s58
s_mul_i32 s70, s70, 28
s_add_u32 s70, s70, s71
s_lshl_b32 s70, s70, 8
s_add_u32 s70, s70, 1277952
s_waitcnt vmcnt(0)
s_mul_i32 s79, s63, 64
s_sub_u32 s79, 32, s79
s_add_u32 s35, s79, 7
tw_77:
ds_read_b32 v5, v2 offset:16
s_waitcnt lgkmcnt(0)
v_cmp_gt_i32 vcc, s35, v5
s_cbranch_vccz twd_78
v_readfirstlane_b32 s54, v5
s_sub_u32 s55, s35, s54
s_cmp_lt_i32 s55, 2
s_cbranch_scc1 tws_79
s_add_u32 s54, s54, 2
s_or_b32 s54, s54, 1
s_cmp_eq_u32 s54, s52
s_cbranch_scc1 tws_79
s_bitcmp1_b32 s54, 4
s_cbranch_scc1 tws_79
s_mov_b32 s52, s54
s_add_u32 s54, s54, s53
s_and_b32 s54, s54, 15
s_mul_i32 s54, s54, 393216
s_add_u32 s54, s54, s56
s_buffer_load_dwordx2 s[46:47], s[48:51], s54 offset:4096
s_buffer_load_dwordx2 s[46:47], s[48:51], s54 offset:10240
s_buffer_load_dwordx2 s[46:47], s[48:51], s54 offset:16384
s_buffer_load_dwordx2 s[46:47], s[48:51], s54 offset:22528
tws_79:
s_sleep 4
s_sub_u32 s32, s32, 1
s_cmp_gt_i32 s32, 0
s_cbranch_scc1 tw_77
twd_78:
poll_80:
buffer_load_dwordx4 v[24:27], v4, s[24:27], s76 offen offset:0 sc1
buffer_load_dwordx4 v[28:31], v4, s[24:27], s76 offen offset:1024 sc1
buffer_load_dwordx4 v[32:35], v4, s[24:27], s76 offen offset:2048 sc1
buffer_load_dwordx4 v[36:39], v4, s[24:27], s76 offen offset:3072 sc1
pchk_81:
s_waitcnt vmcnt(3)
v_min3_u32 v5, v24, v25, v26
s_waitcnt vmcnt(2)
v_min3_u32 v5, v5, v27, v28
v_min3_u32 v5, v5, v29, v30
s_waitcnt vmcnt(1)
v_min3_u32 v5, v5, v31, v32
v_min3_u32 v5, v5, v33, v34
s_waitcnt vmcnt(0)
v_min3_u32 v5, v5, v35, v36
v_min3_u32 v5, v5, v37, v38
v_min_u32 v5, v5, v39
v_cmp_eq_u32 vcc, 0, v5
s_cbranch_vccz pdone_82
s_sub_u32 s32, s32, 1
s_cmp_gt_i32 s32, 0
s_cbranch_scc1 poll_80
pdone_82:
v_add_f32 v24, v24, v32
v_add_f32 v25, v25, v33
v_add_f32 v26, v26, v34
v_add_f32 v27, v27, v35
v_add_f32 v28, v28, v36
v_add_f32 v29, v29, v37
v_add_f32 v30, v30, v38
v_add_f32 v31, v31, v39
v_add_f32 v24, v24, v28
v_add_f32 v25, v25, v29
v_add_f32 v26, v26, v30
v_add_f32 v27, v27, v31
s_nop 0
v_permlane32_swap_b32 v24, v26
v_permlane32_swap_b32 v25, v27
v_add_f32 v24, v24, v26
v_add_f32 v25, v25, v27
s_nop 1
v_permlane16_swap_b32 v24, v25
v_mul_f32 v26, 0xbfb8aa3b, v24
v_exp_f32 v26, v26
v_mul_f32 v24, v24, v25
v_add_f32 v26, 1.0, v26
v_rcp_f32 v26, v26
v_add_u32 v5, s34, 5
v_mul_f32 v24, v24, v26
v_cvt_pk_bf16_f32 v24, v24, v24
ds_write_b16 v253, v24 offset:512
s_mov_b64 exec, 1
ds_write_b32 v3, v5
s_mov_b64 exec, -1
s_add_u32 s35, s34, 5
poll_83:
ds_read_b32 v5, v2 offset:24
ds_read_b128 v[8:11], v254 offset:512
ds_read_b128 v[12:15], v254 offset:640
pchk_84:
s_waitcnt lgkmcnt(2)
v_cmp_gt_i32 vcc, s35, v5
s_cbranch_vccz pdone_85
s_sleep 1
s_sub_u32 s32, s32, 1
s_cmp_gt_i32 s32, 0
s_cbranch_scc1 poll_83
pdone_85:
s_waitcnt lgkmcnt(1)
v_mfma_f32_16x16x32_bf16 v[24:27], v[8:11], v[184:187], 0
v_mfma_f32_16x16x32_bf16 v[28:31], v[8:11], v[188:191], 0
v_mfma_f32_16x16x32_bf16 v[32:35], v[8:11], v[192:195], 0
v_mfma_f32_16x16x32_bf16 v[36:39], v[8:11], v[196:199], 0
v_mfma_f32_16x16x32_bf16 v[40:43], v[8:11], v[200:203], 0
v_mfma_f32_16x16x32_bf16 v[44:47], v[8:11], v[204:207], 0
v_mfma_f32_16x16x32_bf16 v[48:51], v[8:11], v[208:211], 0
v_mfma_f32_16x16x32_bf16 v[52:55], v[8:11], v[212:215], 0
s_waitcnt lgkmcnt(0)
v_mfma_f32_16x16x32_bf16 v[24:27], v[12:15], v[216:219], v[24:27]
v_mfma_f32_16x16x32_bf16 v[28:31], v[12:15], v[220:223], v[28:31]
v_mfma_f32_16x16x32_bf16 v[32:35], v[12:15], v[224:227], v[32:35]
v_mfma_f32_16x16x32_bf16 v[36:39], v[12:15], v[228:231], v[36:39]
v_mfma_f32_16x16x32_bf16 v[40:43], v[12:15], v[232:235], v[40:43]
v_mfma_f32_16x16x32_bf16 v[44:47], v[12:15], v[236:239], v[44:47]
v_mfma_f32_16x16x32_bf16 v[48:51], v[12:15], v[240:243], v[48:51]
v_mfma_f32_16x16x32_bf16 v[52:55], v[12:15], v[244:247], v[52:55]
s_nop 0
v_add_f32_dpp v16, v25, v24 row_ror:8 row_mask:0x1 bank_mask:0xf
v_add_f32_dpp v17, v29, v28 row_ror:8 row_mask:0x1 bank_mask:0xf
s_nop 0
v_add_f32_dpp v16, v33, v32 row_ror:8 row_mask:0x2 bank_mask:0xf
v_add_f32_dpp v17, v37, v36 row_ror:8 row_mask:0x2 bank_mask:0xf
s_nop 0
v_add_f32_dpp v16, v41, v40 row_ror:8 row_mask:0x4 bank_mask:0xf
v_add_f32_dpp v17, v45, v44 row_ror:8 row_mask:0x4 bank_mask:0xf
s_nop 0
v_add_f32_dpp v16, v49, v48 row_ror:8 row_mask:0x8 bank_mask:0xf
v_add_f32_dpp v17, v53, v52 row_ror:8 row_mask:0x8 bank_mask:0xf
v_max_u32 v16, 1, v16
v_max_u32 v17, 1, v17
s_mov_b32 exec_lo, 0x00ff00ff
s_mov_b32 exec_hi, 0x00ff00ff
buffer_store_dwordx2 v[16:17], v255, s[24:27], s70 offen sc1
s_mov_b64 exec, -1
fnd_67:
s_sub_u32 s70, s60, 3
s_mul_i32 s70, s70, s63
s_or_b32 s70, s70, s58
s_cbranch_scc1 fnr_86
s_mul_i32 s72, s59, 7168
s_add_u32 s72, s72, 1277952
s_add_u32 s73, s72, 4096
s_lshl_b32 s70, s68, 6
s_add_u32 s70, s70, s59
s_lshl_b32 s70, s70, 8
s_add_u32 s76, s70, 262144
v_mov_b32 v12, s67
v_mul_f32 v12, 0xbfb8aa3b, v12
v_exp_f32 v12, v12
v_lshl_add_u32 v6, v252, 2, v251
v_add_f32 v12, 1.0, v12
v_rcp_f32 v12, v12
v_lshrrev_b32 v7, 1, v6
s_lshl4_add_u32 s70, s33, s59
s_lshl_b32 s70, s70, 7
v_and_b32 v8, 0x46, v7
v_lshl_add_u32 v8, v1, 2, v8
v_and_b32 v9, 4, v0
v_lshl_add_u32 v8, v9, 1, v8
s_waitcnt vmcnt(0)
s_cmp_gt_u32 s65, s63
s_cbranch_scc1 fpre_88
fpre_89:
s_mul_i32 s79, s63, 64
s_sub_u32 s79, 32, s79
s_add_u32 s35, s79, 11
tw_90:
ds_read_b32 v5, v2 offset:16
s_waitcnt lgkmcnt(0)
v_cmp_gt_i32 vcc, s35, v5
s_cbranch_vccz twd_91
v_readfirstlane_b32 s54, v5
s_sub_u32 s55, s35, s54
s_cmp_lt_i32 s55, 2
s_cbranch_scc1 tws_92
s_add_u32 s54, s54, 2
s_or_b32 s54, s54, 1
s_cmp_eq_u32 s54, s52
s_cbranch_scc1 tws_92
s_bitcmp1_b32 s54, 4
s_cbranch_scc1 tws_92
s_mov_b32 s52, s54
s_add_u32 s54, s54, s53
s_and_b32 s54, s54, 15
s_mul_i32 s54, s54, 393216
s_add_u32 s54, s54, s56
s_buffer_load_dwordx2 s[46:47], s[48:51], s54 offset:4096
s_buffer_load_dwordx2 s[46:47], s[48:51], s54 offset:10240
s_buffer_load_dwordx2 s[46:47], s[48:51], s54 offset:16384
s_buffer_load_dwordx2 s[46:47], s[48:51], s54 offset:22528
tws_92:
s_sleep 4
s_sub_u32 s32, s32, 1
s_cmp_gt_i32 s32, 0
s_cbranch_scc1 tw_90
twd_91:
poll_93:
buffer_load_dword v52, v6, s[24:27], s76 offen sc1
buffer_load_dwordx4 v[24:27], v4, s[24:27], s72 offen offset:0 sc1
buffer_load_dwordx4 v[28:31], v4, s[24:27], s72 offen offset:1024 sc1
buffer_load_dwordx4 v[32:35], v4, s[24:27], s72 offen offset:2048 sc1
buffer_load_dwordx4 v[36:39], v4, s[24:27], s72 offen offset:3072 sc1
buffer_load_dwordx4 v[40:43], v4, s[24:27], s73 offen offset:0 sc1
buffer_load_dwordx4 v[44:47], v4, s[24:27], s73 offen offset:1024 sc1
buffer_load_dwordx4 v[48:51], v4, s[24:27], s73 offen offset:2048 sc1
pchk_94:
s_waitcnt vmcnt(6)
v_min3_u32 v5, v24, v25, v26
s_waitcnt vmcnt(5)
v_min3_u32 v5, v5, v27, v28
v_min3_u32 v5, v5, v29, v30
s_waitcnt vmcnt(4)
v_min3_u32 v5, v5, v31, v32
v_min3_u32 v5, v5, v33, v34
s_waitcnt vmcnt(3)
v_min3_u32 v5, v5, v35, v36
v_min3_u32 v5, v5, v37, v38
s_waitcnt vmcnt(2)
v_min3_u32 v5, v5, v39, v40
v_min3_u32 v5, v5, v41, v42
s_waitcnt vmcnt(1)
v_min3_u32 v5, v5, v43, v44
v_min3_u32 v5, v5, v45, v46
s_waitcnt vmcnt(0)
v_min3_u32 v5, v5, v47, v48
v_min3_u32 v5, v5, v49, v50
v_min3_u32 v5, v5, v51, v52
v_cmp_eq_u32 vcc, 0, v5
s_cbranch_vccz pdone_95
s_sub_u32 s32, s32, 1
s_cmp_gt_i32 s32, 0
s_cbranch_scc1 poll_93
pdone_95:
v_add_f32 v24, v24, v40
v_add_f32 v25, v25, v41
v_add_f32 v26, v26, v42
v_add_f32 v27, v27, v43
v_add_f32 v28, v28, v44
v_add_f32 v29, v29, v45
v_add_f32 v30, v30, v46
v_add_f32 v31, v31, v47
v_add_f32 v32, v32, v48
v_add_f32 v33, v33, v49
v_add_f32 v34, v34, v50
v_add_f32 v35, v35, v51
v_add_f32 v24, v24, v32
v_add_f32 v25, v25, v33
v_add_f32 v26, v26, v34
v_add_f32 v27, v27, v35
v_add_f32 v28, v28, v36
v_add_f32 v29, v29, v37
v_add_f32 v30, v30, v38
v_add_f32 v31, v31, v39
v_add_f32 v24, v24, v28
v_add_f32 v25, v25, v29
v_add_f32 v26, v26, v30
v_add_f32 v27, v27, v31
s_nop 0
v_permlane32_swap_b32 v24, v26
v_permlane32_swap_b32 v25, v27
v_add_f32 v24, v24, v26
v_add_f32 v25, v25, v27
s_nop 1
v_permlane16_swap_b32 v24, v25
v_add_f32 v24, v24, v25
v_fma_f32 v24, v24, v12, v52
v_cvt_pk_bf16_f32 v24, v24, v24
s_cmp_eq_u32 s63, 0
s_cbranch_scc1 fl0_87
buffer_store_short v24, v7, s[28:31], s70 offen
s_branch L_end
fl0_87:
ds_write_b16 v8, v24 offset:384
fnr_86:
s_cmp_eq_u32 s63, 0
s_cbranch_scc0 L_end
v_add_u32 v5, s34, 6
s_mov_b64 exec, 1
ds_write_b32 v3, v5
s_mov_b64 exec, -1
s_mul_i32 s79, s63, 64
s_sub_u32 s79, 32, s79
s_add_u32 s35, s79, 11
tw_96:
ds_read_b32 v5, v2 offset:16
s_waitcnt lgkmcnt(0)
v_cmp_gt_i32 vcc, s35, v5
s_cbranch_vccz twd_97
v_readfirstlane_b32 s54, v5
s_sub_u32 s55, s35, s54
s_cmp_lt_i32 s55, 2
s_cbranch_scc1 tws_98
s_add_u32 s54, s54, 2
s_or_b32 s54, s54, 1
s_cmp_eq_u32 s54, s52
s_cbranch_scc1 tws_98
s_bitcmp1_b32 s54, 4
s_cbranch_scc1 tws_98
s_mov_b32 s52, s54
s_add_u32 s54, s54, s53
s_and_b32 s54, s54, 15
s_mul_i32 s54, s54, 393216
s_add_u32 s54, s54, s56
s_buffer_load_dwordx2 s[46:47], s[48:51], s54 offset:4096
s_buffer_load_dwordx2 s[46:47], s[48:51], s54 offset:10240
s_buffer_load_dwordx2 s[46:47], s[48:51], s54 offset:16384
s_buffer_load_dwordx2 s[46:47], s[48:51], s54 offset:22528
tws_98:
s_sleep 4
s_sub_u32 s32, s32, 1
s_cmp_gt_i32 s32, 0
s_cbranch_scc1 tw_96
twd_97:
v_and_b32 v6, 48, v0
s_add_u32 s35, s34, 6
poll_99:
ds_read_b32 v5, v2 offset:24
ds_read_b128 v[8:11], v6 offset:384
ds_read_b128 v[12:15], v6 offset:448
pchk_100:
s_waitcnt lgkmcnt(2)
v_cmp_gt_i32 vcc, s35, v5
s_cbranch_vccz pdone_101
s_sleep 1
s_sub_u32 s32, s32, 1
s_cmp_gt_i32 s32, 0
s_cbranch_scc1 poll_99
pdone_101:
s_mov_b32 s63, 1
s_mov_b32 s34, 32
s_add_u32 s24, s24, 1409024
s_addc_u32 s25, s25, 0
s_mov_b32 s26, 1409024
s_mov_b32 s70, 131072
s_mov_b32 s79, 34
s_branch ftop_42
fxt_45:
v_max_u32 v8, 1, v8
v_max_u32 v9, 1, v9
v_max_u32 v10, 1, v10
v_max_u32 v11, 1, v11
v_max_u32 v12, 1, v12
v_max_u32 v13, 1, v13
v_max_u32 v14, 1, v14
v_max_u32 v15, 1, v15
s_mov_b32 exec_lo, 0x10001
s_mov_b32 exec_hi, 0x10001
buffer_store_dwordx4 v[8:11], v7, s[20:23], s73 offen offset:0 sc1
buffer_store_dwordx4 v[12:15], v7, s[20:23], s73 offen offset:64 sc1
s_mov_b64 exec, -1
s_branch fxb_46
fst_40:
s_lshl1_add_u32 s70, s78, s58
s_lshl_b32 s70, s70, 13
v_bfe_u32 v8, v0, 2, 2
v_lshl_add_u32 v8, v8, 9, v7
v_add_u32 v8, v8, v1
v_lshlrev_b32 v8, 2, v8
buffer_load_dwordx4 v[24:27], v8, s[8:11], s70 offen offset:0
buffer_load_dwordx4 v[28:31], v8, s[8:11], s70 offen offset:256
buffer_load_dwordx4 v[32:35], v8, s[8:11], s70 offen offset:512
buffer_load_dwordx4 v[36:39], v8, s[8:11], s70 offen offset:768
buffer_load_dwordx4 v[40:43], v8, s[8:11], s70 offen offset:1024
buffer_load_dwordx4 v[44:47], v8, s[8:11], s70 offen offset:1280
buffer_load_dwordx4 v[48:51], v8, s[8:11], s70 offen offset:1536
buffer_load_dwordx4 v[52:55], v8, s[8:11], s70 offen offset:1792
v_lshlrev_b32 v9, 4, v1
s_waitcnt vmcnt(7)
v_mfma_f32_16x16x32_bf16 v[16:19], v[24:27], v[252:255], 0
v_mfma_f32_16x16x32_bf16 v[20:23], v[24:27], v[24:27], 0
s_waitcnt vmcnt(6)
v_mfma_f32_16x16x32_bf16 v[16:19], v[28:31], v[252:255], v[16:19]
v_mfma_f32_16x16x32_bf16 v[20:23], v[28:31], v[28:31], v[20:23]
s_waitcnt vmcnt(5)
v_mfma_f32_16x16x32_bf16 v[16:19], v[32:35], v[252:255], v[16:19]
v_mfma_f32_16x16x32_bf16 v[20:23], v[32:35], v[32:35], v[20:23]
s_waitcnt vmcnt(4)
v_mfma_f32_16x16x32_bf16 v[16:19], v[36:39], v[252:255], v[16:19]
v_mfma_f32_16x16x32_bf16 v[20:23], v[36:39], v[36:39], v[20:23]
s_waitcnt vmcnt(3)
v_mfma_f32_16x16x32_bf16 v[16:19], v[40:43], v[252:255], v[16:19]
v_mfma_f32_16x16x32_bf16 v[20:23], v[40:43], v[40:43], v[20:23]
s_waitcnt vmcnt(2)
v_mfma_f32_16x16x32_bf16 v[16:19], v[44:47], v[252:255], v[16:19]
v_mfma_f32_16x16x32_bf16 v[20:23], v[44:47], v[44:47], v[20:23]
s_waitcnt vmcnt(1)
v_mfma_f32_16x16x32_bf16 v[16:19], v[48:51], v[252:255], v[16:19]
v_mfma_f32_16x16x32_bf16 v[20:23], v[48:51], v[48:51], v[20:23]
s_waitcnt vmcnt(0)
v_mfma_f32_16x16x32_bf16 v[16:19], v[52:55], v[252:255], v[16:19]
v_mfma_f32_16x16x32_bf16 v[20:23], v[52:55], v[52:55], v[20:23]
s_nop 6
v_add_f32 v16, v16, v18
v_add_f32 v17, v17, v19
v_add_f32 v16, v16, v17
s_nop 0
v_mov_b32_dpp v17, v20 quad_perm:[0,0,0,0] row_mask:0xf bank_mask:0xf
s_nop 1
v_add_f32_dpp v17, v21, v17 quad_perm:[1,1,1,1] row_mask:0xf bank_mask:0xf
s_nop 1
v_add_f32_dpp v17, v22, v17 quad_perm:[2,2,2,2] row_mask:0xf bank_mask:0xf
s_nop 1
v_add_f32_dpp v17, v23, v17 quad_perm:[3,3,3,3] row_mask:0xf bank_mask:0xf
v_mul_f32 v5, 0xba800000, v16
v_mul_f32 v17, 0x3a800000, v17
v_fma_f32 v17, -v5, v5, v17
v_max_f32 v17, 0, v17
v_add_f32 v17, 0x3727c5ac, v17
v_rsq_f32 v16, v17
s_nop 0
v_mul_f32 v17, v5, v16
v_max_u32 v17, 1, v17
s_lshl_b32 s70, s60, 7
s_add_u32 s70, s70, s76
s_lshl_b32 s73, s58, 5
s_add_u32 s70, s70, s73
v_lshrrev_b32 v7, 1, v7
s_add_u32 s35, s34, 5
tw_102:
ds_read_b32 v5, v2 offset:16
s_waitcnt lgkmcnt(0)
v_cmp_gt_i32 vcc, s35, v5
s_cbranch_vccz twd_103
v_readfirstlane_b32 s54, v5
s_sub_u32 s55, s35, s54
s_cmp_lt_i32 s55, 2
s_cbranch_scc1 tws_104
s_add_u32 s54, s54, 2
s_or_b32 s54, s54, 1
s_cmp_eq_u32 s54, s52
s_cbranch_scc1 tws_104
s_bitcmp1_b32 s54, 4
s_cbranch_scc1 tws_104
s_mov_b32 s52, s54
s_add_u32 s54, s54, s53
s_and_b32 s54, s54, 15
s_mul_i32 s54, s54, 393216
s_add_u32 s54, s54, s56
s_buffer_load_dwordx2 s[46:47], s[48:51], s54 offset:4096
s_buffer_load_dwordx2 s[46:47], s[48:51], s54 offset:10240
s_buffer_load_dwordx2 s[46:47], s[48:51], s54 offset:16384
s_buffer_load_dwordx2 s[46:47], s[48:51], s54 offset:22528
tws_104:
s_sleep 4
s_sub_u32 s32, s32, 1
s_cmp_gt_i32 s32, 0
s_cbranch_scc1 tw_102
twd_103:
poll_105:
buffer_load_dword v12, v9, s[4:7], 0 offen sc1
pchk_106:
s_waitcnt vmcnt(0)
v_cmp_gt_u32 vcc, 64, v12
s_cbranch_vccz pdone_107
s_sleep 16
s_sub_u32 s32, s32, 1
s_cmp_gt_i32 s32, 0
s_cbranch_scc1 poll_105
pdone_107:
s_mov_b32 exec_lo, 0x00100001
s_mov_b32 exec_hi, 0x10000100
buffer_store_dwordx2 v[16:17], v7, s[24:27], s70 offen sc1
s_getreg_b32 s73, hwreg(HW_REG_XCC_ID)
s_mov_b64 exec, 1
v_add_u32 v12, s73, 1
buffer_store_dword v12, off, s[24:27], s70 offset:64 sc1
s_mov_b64 exec, -1
s_branch fsb_41
fg_47:
s_lshl1_add_u32 s35, s2, s58
s_lshl_b32 s35, s35, 12
s_add_u32 s44, s40, s35
s_addc_u32 s45, s41, 0
s_mov_b32 s35, 4
ft_108:
s_load_dwordx2 s[42:43], s[44:45], 60
s_load_dwordx2 s[42:43], s[44:45], 188
s_load_dwordx2 s[42:43], s[44:45], 316
s_load_dwordx2 s[42:43], s[44:45], 444
s_load_dwordx2 s[42:43], s[44:45], 572
s_load_dwordx2 s[42:43], s[44:45], 700
s_load_dwordx2 s[42:43], s[44:45], 828
s_load_dwordx2 s[42:43], s[44:45], 956
s_add_u32 s44, s44, 1024
s_addc_u32 s45, s45, 0
s_sub_u32 s35, s35, 1
s_cmp_eq_u32 s35, 0
s_cbranch_scc0 ft_108
v_lshrrev_b32 v250, 3, v0
v_mul_u32_u24 v250, 16256, v250
v_add_u32 v250, v250, v4
s_add_u32 s35, s66, 131072
buffer_load_dwordx4 v[184:187], v250, s[12:15], s35 offen nt
s_add_u32 s35, s66, 133120
buffer_load_dwordx4 v[188:191], v250, s[12:15], s35 offen nt
s_add_u32 s35, s66, 135168
buffer_load_dwordx4 v[192:195], v250, s[12:15], s35 offen nt
s_add_u32 s35, s66, 137216
buffer_load_dwordx4 v[196:199], v250, s[12:15], s35 offen nt
s_add_u32 s35, s66, 139264
buffer_load_dwordx4 v[200:203], v250, s[12:15], s35 offen nt
s_add_u32 s35, s66, 141312
buffer_load_dwordx4 v[204:207], v250, s[12:15], s35 offen nt
s_add_u32 s35, s66, 143360
buffer_load_dwordx4 v[208:211], v250, s[12:15], s35 offen nt
s_add_u32 s35, s66, 145408
buffer_load_dwordx4 v[212:215], v250, s[12:15], s35 offen nt
v_lshrrev_b32 v250, 3, v0
v_mul_u32_u24 v250, 16256, v250
v_add_u32 v250, v250, v4
s_add_u32 s35, s66, 0
buffer_load_dwordx4 v[152:155], v250, s[12:15], s35 offen nt
s_add_u32 s35, s66, 2048
buffer_load_dwordx4 v[156:159], v250, s[12:15], s35 offen nt
s_add_u32 s35, s66, 4096
buffer_load_dwordx4 v[160:163], v250, s[12:15], s35 offen nt
s_add_u32 s35, s66, 6144
buffer_load_dwordx4 v[164:167], v250, s[12:15], s35 offen nt
s_add_u32 s35, s66, 8192
buffer_load_dwordx4 v[168:171], v250, s[12:15], s35 offen nt
s_add_u32 s35, s66, 10240
buffer_load_dwordx4 v[172:175], v250, s[12:15], s35 offen nt
s_add_u32 s35, s66, 12288
buffer_load_dwordx4 v[176:179], v250, s[12:15], s35 offen nt
s_add_u32 s35, s66, 14336
buffer_load_dwordx4 v[180:183], v250, s[12:15], s35 offen nt
s_add_u32 s35, s34, 10
tw_109:
ds_read_b32 v5, v2 offset:16
s_waitcnt lgkmcnt(0)
v_cmp_gt_i32 vcc, s35, v5
s_cbranch_vccz twd_110
v_readfirstlane_b32 s54, v5
s_sub_u32 s55, s35, s54
s_cmp_lt_i32 s55, 2
s_cbranch_scc1 tws_111
s_add_u32 s54, s54, 2
s_or_b32 s54, s54, 1
s_cmp_eq_u32 s54, s52
s_cbranch_scc1 tws_111
s_bitcmp1_b32 s54, 4
s_cbranch_scc1 tws_111
s_mov_b32 s52, s54
s_add_u32 s54, s54, s53
s_and_b32 s54, s54, 15
s_mul_i32 s54, s54, 393216
s_add_u32 s54, s54, s56
s_buffer_load_dwordx2 s[46:47], s[48:51], s54 offset:4096
s_buffer_load_dwordx2 s[46:47], s[48:51], s54 offset:10240
s_buffer_load_dwordx2 s[46:47], s[48:51], s54 offset:16384
s_buffer_load_dwordx2 s[46:47], s[48:51], s54 offset:22528
tws_111:
s_sleep 4
s_sub_u32 s32, s32, 1
s_cmp_gt_i32 s32, 0
s_cbranch_scc1 tw_109
twd_110:
v_and_b32 v10, 0x7a0, v7
s_getreg_b32 s70, hwreg(HW_REG_XCC_ID)
s_add_u32 s70, s70, 1
poll_112:
buffer_load_dword v12, v10, s[24:27], s76 offen offset:64 sc1
pchk_113:
s_waitcnt vmcnt(0)
v_cmp_eq_u32 vcc, 0, v12
s_cbranch_vccz pdone_114
s_sub_u32 s32, s32, 1
s_cmp_gt_i32 s32, 0
s_cbranch_scc1 poll_112
pdone_114:
v_cmp_eq_u32 vcc, s70, v12
s_cmp_eq_u64 vcc, exec
s_cselect_b32 s70, 1, 0
v_mov_b32 v12, s70
v_mov_b32 v10, 0
s_mov_b64 exec, 1
ds_write_b32 v10, v12 offset:56
s_mov_b64 exec, -1
s_branch fg_48
fnw_58:
s_waitcnt lgkmcnt(0)
v_mov_b32 v252, 0
v_mov_b32 v253, 0
v_mov_b32 v254, 0
v_mov_b32 v255, 0
s_mul_i32 s42, s58, 1409024
s_mul_i32 s35, s78, 2048
s_add_u32 s35, s35, s42
s_add_u32 s35, s35, 524288
buffer_store_dwordx4 v[252:255], v4, s[24:27], s35 offen offset:0 sc1
buffer_store_dwordx4 v[252:255], v4, s[24:27], s35 offen offset:1024 sc1
s_mul_i32 s35, s78, 1408
s_add_u32 s35, s35, s42
s_add_u32 s35, s35, 1048576
buffer_store_dwordx4 v[252:255], v4, s[24:27], s35 offen offset:0 sc1
buffer_store_dwordx4 v[252:255], v4, s[24:27], s35 offen offset:384 sc1
s_lshl_b32 s35, s78, 10
s_add_u32 s35, s35, 1409024
s_cmp_eq_u32 s58, 1
s_cselect_b64 exec, -1, 0
buffer_store_dwordx4 v[252:255], v4, s[24:27], s35 offen offset:0 sc1
s_add_u32 s35, s35, 262144
buffer_store_dwordx4 v[252:255], v4, s[24:27], s35 offen offset:0 sc1
s_mov_b64 exec, -1
s_waitcnt vmcnt(0)
v_add_u32 v5, s34, 3
s_mov_b64 exec, 1
ds_write_b32 v3, v5
s_mov_b64 exec, -1
s_add_u32 s35, s34, 17
tw_115:
ds_read_b32 v5, v2 offset:16
s_waitcnt lgkmcnt(0)
v_cmp_gt_i32 vcc, s35, v5
s_cbranch_vccz twd_116
v_readfirstlane_b32 s54, v5
s_sub_u32 s55, s35, s54
s_cmp_lt_i32 s55, 2
s_cbranch_scc1 tws_117
s_add_u32 s54, s54, 2
s_or_b32 s54, s54, 1
s_cmp_eq_u32 s54, s52
s_cbranch_scc1 tws_117
s_bitcmp1_b32 s54, 4
s_cbranch_scc1 tws_117
s_mov_b32 s52, s54
s_add_u32 s54, s54, s53
s_and_b32 s54, s54, 15
s_mul_i32 s54, s54, 393216
s_add_u32 s54, s54, s56
s_buffer_load_dwordx2 s[46:47], s[48:51], s54 offset:4096
s_buffer_load_dwordx2 s[46:47], s[48:51], s54 offset:10240
s_buffer_load_dwordx2 s[46:47], s[48:51], s54 offset:16384
s_buffer_load_dwordx2 s[46:47], s[48:51], s54 offset:22528
tws_117:
s_sleep 4
s_sub_u32 s32, s32, 1
s_cmp_gt_i32 s32, 0
s_cbranch_scc1 tw_115
twd_116:
v_lshrrev_b32 v250, 4, v0
v_mul_u32_u24 v250, 28416, v250
v_add_u32 v250, v250, v4
s_add_u32 s35, s77, 688128
buffer_load_dwordx4 v[120:123], v250, s[16:19], s35 offen nt
s_add_u32 s35, s77, 695296
buffer_load_dwordx4 v[124:127], v250, s[16:19], s35 offen nt
s_add_u32 s35, s77, 702464
buffer_load_dwordx4 v[128:131], v250, s[16:19], s35 offen nt
s_add_u32 s35, s77, 709632
buffer_load_dwordx4 v[132:135], v250, s[16:19], s35 offen nt
s_add_u32 s35, s77, 802816
buffer_load_dwordx4 v[136:139], v250, s[16:19], s35 offen nt
s_add_u32 s35, s77, 809984
buffer_load_dwordx4 v[140:143], v250, s[16:19], s35 offen nt
s_add_u32 s35, s77, 817152
buffer_load_dwordx4 v[144:147], v250, s[16:19], s35 offen nt
s_add_u32 s35, s77, 824320
buffer_load_dwordx4 v[148:151], v250, s[16:19], s35 offen nt
v_lshrrev_b32 v250, 4, v0
v_mul_u32_u24 v250, 28416, v250
v_add_u32 v250, v250, v4
s_add_u32 s35, s77, 458752
buffer_load_dwordx4 v[88:91], v250, s[16:19], s35 offen nt
s_add_u32 s35, s77, 465920
buffer_load_dwordx4 v[92:95], v250, s[16:19], s35 offen nt
s_add_u32 s35, s77, 473088
buffer_load_dwordx4 v[96:99], v250, s[16:19], s35 offen nt
s_add_u32 s35, s77, 480256
buffer_load_dwordx4 v[100:103], v250, s[16:19], s35 offen nt
s_add_u32 s35, s77, 573440
buffer_load_dwordx4 v[104:107], v250, s[16:19], s35 offen nt
s_add_u32 s35, s77, 580608
buffer_load_dwordx4 v[108:111], v250, s[16:19], s35 offen nt
s_add_u32 s35, s77, 587776
buffer_load_dwordx4 v[112:115], v250, s[16:19], s35 offen nt
s_add_u32 s35, s77, 594944
buffer_load_dwordx4 v[116:119], v250, s[16:19], s35 offen nt
v_lshrrev_b32 v250, 4, v0
v_mul_u32_u24 v250, 28416, v250
v_add_u32 v250, v250, v4
s_add_u32 s35, s77, 229376
buffer_load_dwordx4 v[56:59], v250, s[16:19], s35 offen nt
s_add_u32 s35, s77, 236544
buffer_load_dwordx4 v[60:63], v250, s[16:19], s35 offen nt
s_add_u32 s35, s77, 243712
buffer_load_dwordx4 v[64:67], v250, s[16:19], s35 offen nt
s_add_u32 s35, s77, 250880
buffer_load_dwordx4 v[68:71], v250, s[16:19], s35 offen nt
s_add_u32 s35, s77, 344064
buffer_load_dwordx4 v[72:75], v250, s[16:19], s35 offen nt
s_add_u32 s35, s77, 351232
buffer_load_dwordx4 v[76:79], v250, s[16:19], s35 offen nt
s_add_u32 s35, s77, 358400
buffer_load_dwordx4 v[80:83], v250, s[16:19], s35 offen nt
s_add_u32 s35, s77, 365568
buffer_load_dwordx4 v[84:87], v250, s[16:19], s35 offen nt
v_lshrrev_b32 v250, 4, v0
v_mul_u32_u24 v250, 28416, v250
v_add_u32 v250, v250, v4
s_add_u32 s35, s77, 0
buffer_load_dwordx4 v[24:27], v250, s[16:19], s35 offen nt
s_add_u32 s35, s77, 7168
buffer_load_dwordx4 v[28:31], v250, s[16:19], s35 offen nt
s_add_u32 s35, s77, 14336
buffer_load_dwordx4 v[32:35], v250, s[16:19], s35 offen nt
s_add_u32 s35, s77, 21504
buffer_load_dwordx4 v[36:39], v250, s[16:19], s35 offen nt
s_add_u32 s35, s77, 114688
buffer_load_dwordx4 v[40:43], v250, s[16:19], s35 offen nt
s_add_u32 s35, s77, 121856
buffer_load_dwordx4 v[44:47], v250, s[16:19], s35 offen nt
s_add_u32 s35, s77, 129024
buffer_load_dwordx4 v[48:51], v250, s[16:19], s35 offen nt
s_add_u32 s35, s77, 136192
buffer_load_dwordx4 v[52:55], v250, s[16:19], s35 offen nt
s_waitcnt lgkmcnt(0)
s_mov_b32 s42, 0x05040100
s_mov_b32 s43, 0x07060302
s_cmp_eq_u32 s65, 0
s_cbranch_scc0 fq_118
v_perm_b32 v216, v188, v184, s42
v_perm_b32 v220, v188, v184, s43
v_perm_b32 v224, v189, v185, s42
v_perm_b32 v228, v189, v185, s43
v_perm_b32 v232, v190, v186, s42
v_perm_b32 v236, v190, v186, s43
v_perm_b32 v240, v191, v187, s42
v_perm_b32 v244, v191, v187, s43
v_perm_b32 v217, v196, v192, s42
v_perm_b32 v221, v196, v192, s43
v_perm_b32 v225, v197, v193, s42
v_perm_b32 v229, v197, v193, s43
v_perm_b32 v233, v198, v194, s42
v_perm_b32 v237, v198, v194, s43
v_perm_b32 v241, v199, v195, s42
v_perm_b32 v245, v199, v195, s43
v_perm_b32 v218, v204, v200, s42
v_perm_b32 v222, v204, v200, s43
v_perm_b32 v226, v205, v201, s42
v_perm_b32 v230, v205, v201, s43
v_perm_b32 v234, v206, v202, s42
v_perm_b32 v238, v206, v202, s43
v_perm_b32 v242, v207, v203, s42
v_perm_b32 v246, v207, v203, s43
v_perm_b32 v219, v212, v208, s42
v_perm_b32 v223, v212, v208, s43
v_perm_b32 v227, v213, v209, s42
v_perm_b32 v231, v213, v209, s43
v_perm_b32 v235, v214, v210, s42
v_perm_b32 v239, v214, v210, s43
v_perm_b32 v243, v215, v211, s42
v_perm_b32 v247, v215, v211, s43
v_perm_b32 v184, v156, v152, s42
v_perm_b32 v188, v156, v152, s43
v_perm_b32 v192, v157, v153, s42
v_perm_b32 v196, v157, v153, s43
v_perm_b32 v200, v158, v154, s42
v_perm_b32 v204, v158, v154, s43
v_perm_b32 v208, v159, v155, s42
v_perm_b32 v212, v159, v155, s43
v_perm_b32 v185, v164, v160, s42
v_perm_b32 v189, v164, v160, s43
v_perm_b32 v193, v165, v161, s42
v_perm_b32 v197, v165, v161, s43
v_perm_b32 v201, v166, v162, s42
v_perm_b32 v205, v166, v162, s43
v_perm_b32 v209, v167, v163, s42
v_perm_b32 v213, v167, v163, s43
v_perm_b32 v186, v172, v168, s42
v_perm_b32 v190, v172, v168, s43
v_perm_b32 v194, v173, v169, s42
v_perm_b32 v198, v173, v169, s43
v_perm_b32 v202, v174, v170, s42
v_perm_b32 v206, v174, v170, s43
v_perm_b32 v210, v175, v171, s42
v_perm_b32 v214, v175, v171, s43
v_perm_b32 v187, v180, v176, s42
v_perm_b32 v191, v180, v176, s43
v_perm_b32 v195, v181, v177, s42
v_perm_b32 v199, v181, v177, s43
v_perm_b32 v203, v182, v178, s42
v_perm_b32 v207, v182, v178, s43
v_perm_b32 v211, v183, v179, s42
v_perm_b32 v215, v183, v179, s43
s_waitcnt vmcnt(30)
v_perm_b32 v152, v124, v120, s42
v_perm_b32 v156, v124, v120, s43
v_perm_b32 v160, v125, v121, s42
v_perm_b32 v164, v125, v121, s43
v_perm_b32 v168, v126, v122, s42
v_perm_b32 v172, v126, v122, s43
v_perm_b32 v176, v127, v123, s42
v_perm_b32 v180, v127, v123, s43
s_waitcnt vmcnt(28)
v_perm_b32 v153, v132, v128, s42
v_perm_b32 v157, v132, v128, s43
v_perm_b32 v161, v133, v129, s42
v_perm_b32 v165, v133, v129, s43
v_perm_b32 v169, v134, v130, s42
v_perm_b32 v173, v134, v130, s43
v_perm_b32 v177, v135, v131, s42
v_perm_b32 v181, v135, v131, s43
s_waitcnt vmcnt(26)
v_perm_b32 v154, v140, v136, s42
v_perm_b32 v158, v140, v136, s43
v_perm_b32 v162, v141, v137, s42
v_perm_b32 v166, v141, v137, s43
v_perm_b32 v170, v142, v138, s42
v_perm_b32 v174, v142, v138, s43
v_perm_b32 v178, v143, v139, s42
v_perm_b32 v182, v143, v139, s43
s_waitcnt vmcnt(24)
v_perm_b32 v155, v148, v144, s42
v_perm_b32 v159, v148, v144, s43
v_perm_b32 v163, v149, v145, s42
v_perm_b32 v167, v149, v145, s43
v_perm_b32 v171, v150, v146, s42
v_perm_b32 v175, v150, v146, s43
v_perm_b32 v179, v151, v147, s42
v_perm_b32 v183, v151, v147, s43
s_waitcnt vmcnt(22)
v_perm_b32 v120, v92, v88, s42
v_perm_b32 v124, v92, v88, s43
v_perm_b32 v128, v93, v89, s42
v_perm_b32 v132, v93, v89, s43
v_perm_b32 v136, v94, v90, s42
v_perm_b32 v140, v94, v90, s43
v_perm_b32 v144, v95, v91, s42
v_perm_b32 v148, v95, v91, s43
s_waitcnt vmcnt(20)
v_perm_b32 v121, v100, v96, s42
v_perm_b32 v125, v100, v96, s43
v_perm_b32 v129, v101, v97, s42
v_perm_b32 v133, v101, v97, s43
v_perm_b32 v137, v102, v98, s42
v_perm_b32 v141, v102, v98, s43
v_perm_b32 v145, v103, v99, s42
v_perm_b32 v149, v103, v99, s43
s_waitcnt vmcnt(18)
v_perm_b32 v122, v108, v104, s42
v_perm_b32 v126, v108, v104, s43
v_perm_b32 v130, v109, v105, s42
v_perm_b32 v134, v109, v105, s43
v_perm_b32 v138, v110, v106, s42
v_perm_b32 v142, v110, v106, s43
v_perm_b32 v146, v111, v107, s42
v_perm_b32 v150, v111, v107, s43
s_waitcnt vmcnt(16)
v_perm_b32 v123, v116, v112, s42
v_perm_b32 v127, v116, v112, s43
v_perm_b32 v131, v117, v113, s42
v_perm_b32 v135, v117, v113, s43
v_perm_b32 v139, v118, v114, s42
v_perm_b32 v143, v118, v114, s43
v_perm_b32 v147, v119, v115, s42
v_perm_b32 v151, v119, v115, s43
s_waitcnt vmcnt(14)
v_perm_b32 v88, v60, v56, s42
v_perm_b32 v92, v60, v56, s43
v_perm_b32 v96, v61, v57, s42
v_perm_b32 v100, v61, v57, s43
v_perm_b32 v104, v62, v58, s42
v_perm_b32 v108, v62, v58, s43
v_perm_b32 v112, v63, v59, s42
v_perm_b32 v116, v63, v59, s43
s_waitcnt vmcnt(12)
v_perm_b32 v89, v68, v64, s42
v_perm_b32 v93, v68, v64, s43
v_perm_b32 v97, v69, v65, s42
v_perm_b32 v101, v69, v65, s43
v_perm_b32 v105, v70, v66, s42
v_perm_b32 v109, v70, v66, s43
v_perm_b32 v113, v71, v67, s42
v_perm_b32 v117, v71, v67, s43
s_waitcnt vmcnt(10)
v_perm_b32 v90, v76, v72, s42
v_perm_b32 v94, v76, v72, s43
v_perm_b32 v98, v77, v73, s42
v_perm_b32 v102, v77, v73, s43
v_perm_b32 v106, v78, v74, s42
v_perm_b32 v110, v78, v74, s43
v_perm_b32 v114, v79, v75, s42
v_perm_b32 v118, v79, v75, s43
s_waitcnt vmcnt(8)
v_perm_b32 v91, v84, v80, s42
v_perm_b32 v95, v84, v80, s43
v_perm_b32 v99, v85, v81, s42
v_perm_b32 v103, v85, v81, s43
v_perm_b32 v107, v86, v82, s42
v_perm_b32 v111, v86, v82, s43
v_perm_b32 v115, v87, v83, s42
v_perm_b32 v119, v87, v83, s43
s_waitcnt vmcnt(6)
v_perm_b32 v56, v28, v24, s42
v_perm_b32 v60, v28, v24, s43
v_perm_b32 v64, v29, v25, s42
v_perm_b32 v68, v29, v25, s43
v_perm_b32 v72, v30, v26, s42
v_perm_b32 v76, v30, v26, s43
v_perm_b32 v80, v31, v27, s42
v_perm_b32 v84, v31, v27, s43
s_waitcnt vmcnt(4)
v_perm_b32 v57, v36, v32, s42
v_perm_b32 v61, v36, v32, s43
v_perm_b32 v65, v37, v33, s42
v_perm_b32 v69, v37, v33, s43
v_perm_b32 v73, v38, v34, s42
v_perm_b32 v77, v38, v34, s43
v_perm_b32 v81, v39, v35, s42
v_perm_b32 v85, v39, v35, s43
s_waitcnt vmcnt(2)
v_perm_b32 v58, v44, v40, s42
v_perm_b32 v62, v44, v40, s43
v_perm_b32 v66, v45, v41, s42
v_perm_b32 v70, v45, v41, s43
v_perm_b32 v74, v46, v42, s42
v_perm_b32 v78, v46, v42, s43
v_perm_b32 v82, v47, v43, s42
v_perm_b32 v86, v47, v43, s43
s_waitcnt vmcnt(0)
v_perm_b32 v59, v52, v48, s42
v_perm_b32 v63, v52, v48, s43
v_perm_b32 v67, v53, v49, s42
v_perm_b32 v71, v53, v49, s43
v_perm_b32 v75, v54, v50, s42
v_perm_b32 v79, v54, v50, s43
v_perm_b32 v83, v55, v51, s42
v_perm_b32 v87, v55, v51, s43
fq_118:
s_and_b32 s54, s59, 1
s_lshl_b32 s54, s54, 1
s_sub_u32 s54, s53, s54
s_and_b32 s54, s54, 15
s_mul_i32 s54, s54, 393216
s_add_u32 s54, s54, s56
s_buffer_load_dwordx2 s[46:47], s[48:51], s54 offset:4096
s_buffer_load_dwordx2 s[46:47], s[48:51], s54 offset:10240
s_buffer_load_dwordx2 s[46:47], s[48:51], s54 offset:16384
s_buffer_load_dwordx2 s[46:47], s[48:51], s54 offset:22528
s_buffer_load_dwordx2 s[46:47], s[48:51], s54 offset:2048
s_buffer_load_dwordx2 s[46:47], s[48:51], s54 offset:8192
s_buffer_load_dwordx2 s[46:47], s[48:51], s54 offset:14336
s_buffer_load_dwordx2 s[46:47], s[48:51], s54 offset:20480
s_buffer_load_dwordx2 s[46:47], s[48:51], s54 offset:0
s_buffer_load_dwordx2 s[46:47], s[48:51], s54 offset:6144
s_buffer_load_dwordx2 s[46:47], s[48:51], s54 offset:12288
s_buffer_load_dwordx2 s[46:47], s[48:51], s54 offset:18432
s_add_u32 s54, s53, 1
s_and_b32 s54, s54, 15
s_mul_i32 s54, s54, 393216
s_add_u32 s54, s54, s56
s_buffer_load_dwordx2 s[46:47], s[48:51], s54 offset:4096
s_buffer_load_dwordx2 s[46:47], s[48:51], s54 offset:10240
s_buffer_load_dwordx2 s[46:47], s[48:51], s54 offset:16384
s_buffer_load_dwordx2 s[46:47], s[48:51], s54 offset:22528
s_buffer_load_dwordx2 s[46:47], s[48:51], s54 offset:2048
s_buffer_load_dwordx2 s[46:47], s[48:51], s54 offset:8192
s_buffer_load_dwordx2 s[46:47], s[48:51], s54 offset:14336
s_buffer_load_dwordx2 s[46:47], s[48:51], s54 offset:20480
s_buffer_load_dwordx2 s[46:47], s[48:51], s54 offset:0
s_buffer_load_dwordx2 s[46:47], s[48:51], s54 offset:6144
s_buffer_load_dwordx2 s[46:47], s[48:51], s54 offset:12288
s_buffer_load_dwordx2 s[46:47], s[48:51], s54 offset:18432
s_add_u32 s54, s53, 3
s_and_b32 s54, s54, 15
s_mul_i32 s54, s54, 393216
s_add_u32 s54, s54, s56
s_buffer_load_dwordx2 s[46:47], s[48:51], s54 offset:4096
s_buffer_load_dwordx2 s[46:47], s[48:51], s54 offset:10240
s_buffer_load_dwordx2 s[46:47], s[48:51], s54 offset:16384
s_buffer_load_dwordx2 s[46:47], s[48:51], s54 offset:22528
s_buffer_load_dwordx2 s[46:47], s[48:51], s54 offset:2048
s_buffer_load_dwordx2 s[46:47], s[48:51], s54 offset:8192
s_buffer_load_dwordx2 s[46:47], s[48:51], s54 offset:14336
s_buffer_load_dwordx2 s[46:47], s[48:51], s54 offset:20480
s_buffer_load_dwordx2 s[46:47], s[48:51], s54 offset:0
s_buffer_load_dwordx2 s[46:47], s[48:51], s54 offset:6144
s_buffer_load_dwordx2 s[46:47], s[48:51], s54 offset:12288
s_buffer_load_dwordx2 s[46:47], s[48:51], s54 offset:18432
s_add_u32 s54, s53, 5
s_and_b32 s54, s54, 15
s_mul_i32 s54, s54, 393216
s_add_u32 s54, s54, s56
s_buffer_load_dwordx2 s[46:47], s[48:51], s54 offset:4096
s_buffer_load_dwordx2 s[46:47], s[48:51], s54 offset:10240
s_buffer_load_dwordx2 s[46:47], s[48:51], s54 offset:16384
s_buffer_load_dwordx2 s[46:47], s[48:51], s54 offset:22528
s_buffer_load_dwordx2 s[46:47], s[48:51], s54 offset:2048
s_buffer_load_dwordx2 s[46:47], s[48:51], s54 offset:8192
s_buffer_load_dwordx2 s[46:47], s[48:51], s54 offset:14336
s_buffer_load_dwordx2 s[46:47], s[48:51], s54 offset:20480
s_buffer_load_dwordx2 s[46:47], s[48:51], s54 offset:0
s_buffer_load_dwordx2 s[46:47], s[48:51], s54 offset:6144
s_buffer_load_dwordx2 s[46:47], s[48:51], s54 offset:12288
s_buffer_load_dwordx2 s[46:47], s[48:51], s54 offset:18432
s_waitcnt lgkmcnt(0)
s_branch fnw_59
fnd_68:
poll_119:
buffer_load_dwordx2 v[248:249], v6, s[24:27], s73 offen sc1
pchk_120:
s_waitcnt vmcnt(0)
v_min_u32 v5, v248, v249
v_cmp_eq_u32 vcc, 0, v5
s_cbranch_vccz pdone_121
s_sleep 1
s_sub_u32 s32, s32, 1
s_cmp_gt_i32 s32, 0
s_cbranch_scc1 poll_119
pdone_121:
v_mov_b32 v250, v248
s_nop 1
v_max_f32_dpp v250, v250, v250 row_ror:1 row_mask:0xf bank_mask:0xf
s_nop 1
v_max_f32_dpp v250, v250, v250 row_ror:2 row_mask:0xf bank_mask:0xf
s_nop 1
v_max_f32_dpp v250, v250, v250 row_ror:4 row_mask:0xf bank_mask:0xf
s_nop 1
v_max_f32_dpp v250, v250, v250 row_ror:8 row_mask:0xf bank_mask:0xf
v_cmp_eq_f32 vcc, v250, v248
s_ff1_i32_b64 s68, vcc
s_and_b32 s68, s68, 15
v_readlane_b32 s33, v249, s68
v_readlane_b32 s67, v248, s68
v_add_u32 v5, s34, 4
v_mov_b32 v250, s33
s_mov_b64 exec, 1
ds_write2_b32 v3, v5, v250 offset1:2
s_mov_b64 exec, -1
s_sub_u32 s33, s33, 1
s_and_b32 s33, s33, 2047
s_branch fnd_67
fpre_88:
poll_122:
buffer_load_dwordx4 v[24:27], v4, s[24:27], s72 offen offset:0 sc1
pchk_123:
s_waitcnt vmcnt(0)
v_min3_u32 v5, v24, v25, v26
v_min_u32 v5, v5, v27
v_cmp_eq_u32 vcc, 0, v5
s_cbranch_vccz pdone_124
s_sleep 8
s_sub_u32 s32, s32, 1
s_cmp_gt_i32 s32, 0
s_cbranch_scc1 poll_122
pdone_124:
s_branch fpre_89
L_m:
s_setprio 2
v_mov_b32 v6, 0
v_mov_b32 v7, 0
v_lshlrev_b32 v8, 3, v0
ds_write_b64 v8, v[6:7]
s_waitcnt lgkmcnt(0)
s_barrier
s_lshr_b32 s64, s58, 1
s_and_b32 s65, s58, 1
v_and_b32 v1, 3, v0
v_lshlrev_b32 v1, 2, v1
v_and_b32 v2, 4, v1
s_lshl2_add_u32 s35, s58, 0
v_mov_b32 v3, s35
s_mov_b32 s4, s44
s_mov_b32 s5, s45
s_mov_b32 s6, 0x800
s_mov_b32 s7, 0x00020000
v_lshrrev_b32 v6, 4, v0
v_lshlrev_b32 v6, 3, v6
s_lshl_b32 s66, s62, 7
buffer_load_dwordx2 v[232:233], v6, s[4:7], s66 offen offset:0
buffer_load_dwordx2 v[234:235], v6, s[4:7], s66 offen offset:32
buffer_load_dwordx2 v[236:237], v6, s[4:7], s66 offen offset:64
buffer_load_dwordx2 v[238:239], v6, s[4:7], s66 offen offset:96
v_and_b32 v6, 31, v0
v_lshrrev_b32 v7, 5, v0
v_lshlrev_b32 v7, 3, v7
v_sub_u32 v6, v6, v7
v_mov_b32 v7, 0xf149f2ca
v_cmp_le_i32 vcc, 0, v6
s_nop 1
v_cndmask_b32 v216, 0, v7, vcc
v_cmp_le_i32 vcc, 1, v6
s_nop 1
v_cndmask_b32 v217, 0, v7, vcc
v_cmp_le_i32 vcc, 2, v6
s_nop 1
v_cndmask_b32 v218, 0, v7, vcc
v_cmp_le_i32 vcc, 3, v6
s_nop 1
v_cndmask_b32 v219, 0, v7, vcc
v_cmp_le_i32 vcc, 16, v6
s_nop 1
v_cndmask_b32 v220, 0, v7, vcc
v_cmp_le_i32 vcc, 17, v6
s_nop 1
v_cndmask_b32 v221, 0, v7, vcc
v_cmp_le_i32 vcc, 18, v6
s_nop 1
v_cndmask_b32 v222, 0, v7, vcc
v_cmp_le_i32 vcc, 19, v6
s_nop 1
v_cndmask_b32 v223, 0, v7, vcc
v_cmp_le_i32 vcc, 4, v6
s_nop 1
v_cndmask_b32 v224, 0, v7, vcc
v_cmp_le_i32 vcc, 5, v6
s_nop 1
v_cndmask_b32 v225, 0, v7, vcc
v_cmp_le_i32 vcc, 6, v6
s_nop 1
v_cndmask_b32 v226, 0, v7, vcc
v_cmp_le_i32 vcc, 7, v6
s_nop 1
v_cndmask_b32 v227, 0, v7, vcc
v_cmp_le_i32 vcc, 20, v6
s_nop 1
v_cndmask_b32 v228, 0, v7, vcc
v_cmp_le_i32 vcc, 21, v6
s_nop 1
v_cndmask_b32 v229, 0, v7, vcc
v_cmp_le_i32 vcc, 22, v6
s_nop 1
v_cndmask_b32 v230, 0, v7, vcc
v_cmp_le_i32 vcc, 23, v6
s_nop 1
v_cndmask_b32 v231, 0, v7, vcc
v_lshrrev_b32 v6, 2, v0
v_xor_b32 v6, v6, v0
v_and_b32 v6, 4, v6
v_mov_b32 v7, 0x3f803f80
v_cmp_eq_u32 vcc, 0, v6
s_nop 1
v_cndmask_b32 v212, 0, v7, vcc
v_cndmask_b32 v213, 0, v7, vcc
v_cndmask_b32 v214, 0, v7, vcc
v_cndmask_b32 v215, 0, v7, vcc
v_lshrrev_b32 v196, 4, v0
s_cmp_eq_u32 0, 0
s_cbranch_scc0 mq_125
v_bfe_u32 v197, v0, 1, 3
v_xor_b32 v197, v197, v196
v_lshlrev_b32 v197, 4, v197
v_and_b32 v198, 15, v0
v_lshl_add_u32 v192, v198, 7, v197
v_xor_b32 v193, 64, v192
s_branch mq_126
mq_125:
v_lshlrev_b32 v192, 4, v0
v_add_u32 v193, 1024, v192
mq_126:
s_lshl_b32 s46, s65, 13
s_add_u32 s46, s46, 86016
v_add_u32 v192, s46, v192
v_add_u32 v193, s46, v193
v_bfe_u32 v197, v0, 2, 2
v_lshl_add_u32 v197, v196, 3, v197
v_bfe_u32 v198, v0, 3, 2
s_lshl_b32 s46, s64, 1
v_xor_b32 v198, s46, v198
v_lshlrev_b32 v198, 5, v198
v_lshl_add_u32 v197, v197, 7, v198
v_and_b32 v198, 3, v0
v_lshl_add_u32 v197, v198, 3, v197
v_add_u32 v194, 102400, v197
v_xor_b32 v195, 32, v194
v_mov_b32 v197, 0xf149f2ca
v_xor_b32 v216, v197, v216
v_xor_b32 v217, v197, v217
v_xor_b32 v218, v197, v218
v_xor_b32 v219, v197, v219
v_xor_b32 v220, v197, v220
v_xor_b32 v221, v197, v221
v_xor_b32 v222, v197, v222
v_xor_b32 v223, v197, v223
v_xor_b32 v224, v197, v224
v_xor_b32 v225, v197, v225
v_xor_b32 v226, v197, v226
v_xor_b32 v227, v197, v227
v_xor_b32 v228, v197, v228
v_xor_b32 v229, v197, v229
v_xor_b32 v230, v197, v230
v_xor_b32 v231, v197, v231
v_and_b32 v196, 15, v0
v_lshrrev_b32 v197, 4, v0
s_lshl_b32 s46, s65, 8
s_add_u32 s46, s46, 1280
s_mul_i32 s47, s64, 384
v_lshl_add_u32 v208, v196, 2, s46
v_lshl_add_u32 v209, v197, 4, s46
v_lshl_add_u32 v210, v196, 2, s47
v_lshl_add_u32 v211, v197, 4, s47
v_and_b32 v198, 1, v197
v_lshrrev_b32 v197, 1, v197
v_lshlrev_b32 v197, 9, v197
v_lshl_add_u32 v197, v198, 10, v197
s_lshl_b32 s46, s64, 12
s_lshl_b32 s47, s65, 13
s_add_u32 s46, s46, 131072
s_add_u32 s48, s46, 24576
s_sub_u32 s48, s48, s47
s_add_u32 s47, s46, s47
v_lshl_add_u32 v200, v196, 4, v197
v_and_b32 v198, 3, v0
v_lshl_add_u32 v197, v198, 4, v197
v_bfe_u32 v198, v0, 3, 1
v_lshl_add_u32 v197, v198, 6, v197
v_bfe_u32 v198, v0, 2, 1
v_lshl_add_u32 v198, v198, 8, v197
v_add_u32 v199, s48, v198
v_add_u32 v198, s47, v198
v_add_u32 v201, s48, v200
v_add_u32 v200, s47, v200
s_lshl_b32 s46, s59, 4
s_add_u32 s46, s46, s60
s_lshl_b32 s50, s59, 7
s_add_u32 s50, s50, s60
s_lshl_b32 s50, s50, 7
s_lshl_b32 s46, s46, 15
s_lshl_b32 s47, 0, 23
s_add_u32 s46, s46, s47
s_add_u32 s49, s46, 917504
L_mtop:
v_mov_b32 v6, v192
v_mov_b32 v7, v193
v_mov_b32 v8, v194
v_mov_b32 v9, v195
v_mov_b32 v12, v198
v_mov_b32 v13, v199
v_mov_b32 v14, v200
v_mov_b32 v15, v201
s_mov_b32 s71, s49
s_mov_b32 s72, s50
v_add_u32 v4, s34, 1
s_mov_b32 s66, 14
s_mov_b32 s67, -40960
s_mov_b32 s68, -40960
s_mov_b32 s69, 81920
s_add_u32 s35, s34, 1
lw_127:
ds_read_b32 v5, v2 offset:16
s_waitcnt lgkmcnt(0)
v_cmp_gt_i32 vcc, s35, v5
s_cbranch_vccz lwd_128
s_sub_u32 s32, s32, 1
s_cmp_gt_i32 s32, 0
s_cbranch_scc1 lw_127
lwd_128:
ds_read_b64_tr_b16 v[144:145], v8 offset:8192
ds_read_b64_tr_b16 v[146:147], v8 offset:8704
ds_read_b64_tr_b16 v[148:149], v8 offset:12288
ds_read_b64_tr_b16 v[150:151], v8 offset:12800
ds_read_b128 v[112:115], v6 offset:0
ds_read_b128 v[116:119], v7 offset:0
ds_read_b64_tr_b16 v[152:153], v9 offset:8192
ds_read_b64_tr_b16 v[154:155], v9 offset:8704
ds_read_b64_tr_b16 v[156:157], v9 offset:12288
ds_read_b64_tr_b16 v[158:159], v9 offset:12800
ds_read_b128 v[120:123], v6 offset:2048
ds_read_b128 v[124:127], v7 offset:2048
ds_read_b128 v[128:131], v6 offset:4096
ds_read_b128 v[132:135], v7 offset:4096
ds_read_b128 v[136:139], v6 offset:6144
ds_read_b128 v[140:143], v7 offset:6144
s_waitcnt lgkmcnt(11)
v_mfma_f32_16x16x32_bf16 v[16:19], v[144:147], v[112:115], 0
ds_read_b64_tr_b16 v[160:161], v8 offset:16384
s_waitcnt lgkmcnt(11)
v_mfma_f32_16x16x32_bf16 v[16:19], v[148:151], v[116:119], v[16:19]
ds_read_b64_tr_b16 v[162:163], v8 offset:16896
s_waitcnt lgkmcnt(10)
v_mfma_f32_16x16x32_bf16 v[20:23], v[152:155], v[112:115], 0
ds_read_b64_tr_b16 v[164:165], v8 offset:20480
s_waitcnt lgkmcnt(9)
v_mfma_f32_16x16x32_bf16 v[20:23], v[156:159], v[116:119], v[20:23]
ds_read_b64_tr_b16 v[166:167], v8 offset:20992
s_waitcnt lgkmcnt(9)
v_mfma_f32_16x16x32_bf16 v[24:27], v[144:147], v[120:123], 0
ds_read_b64_tr_b16 v[168:169], v9 offset:16384
s_waitcnt lgkmcnt(9)
v_mfma_f32_16x16x32_bf16 v[24:27], v[148:151], v[124:127], v[24:27]
ds_read_b64_tr_b16 v[170:171], v9 offset:16896
v_mfma_f32_16x16x32_bf16 v[28:31], v[152:155], v[120:123], 0
ds_read_b64_tr_b16 v[172:173], v9 offset:20480
v_mfma_f32_16x16x32_bf16 v[28:31], v[156:159], v[124:127], v[28:31]
ds_read_b64_tr_b16 v[174:175], v9 offset:20992
s_waitcnt lgkmcnt(11)
v_mfma_f32_16x16x32_bf16 v[32:35], v[144:147], v[128:131], 0
ds_read_b64_tr_b16 v[176:177], v8 offset:0
s_waitcnt lgkmcnt(11)
v_mfma_f32_16x16x32_bf16 v[32:35], v[148:151], v[132:135], v[32:35]
ds_read_b64_tr_b16 v[178:179], v8 offset:512
v_mfma_f32_16x16x32_bf16 v[36:39], v[152:155], v[128:131], 0
ds_read_b64_tr_b16 v[180:181], v8 offset:4096
v_mfma_f32_16x16x32_bf16 v[36:39], v[156:159], v[132:135], v[36:39]
ds_read_b64_tr_b16 v[182:183], v8 offset:4608
s_waitcnt lgkmcnt(13)
v_mfma_f32_16x16x32_bf16 v[40:43], v[144:147], v[136:139], 0
ds_read_b64_tr_b16 v[184:185], v9 offset:0
s_waitcnt lgkmcnt(13)
v_mfma_f32_16x16x32_bf16 v[40:43], v[148:151], v[140:143], v[40:43]
ds_read_b64_tr_b16 v[186:187], v9 offset:512
v_mfma_f32_16x16x32_bf16 v[44:47], v[152:155], v[136:139], 0
ds_read_b64_tr_b16 v[188:189], v9 offset:4096
v_mfma_f32_16x16x32_bf16 v[44:47], v[156:159], v[140:143], v[44:47]
ds_read_b64_tr_b16 v[190:191], v9 offset:4608
s_waitcnt lgkmcnt(14)
v_mfma_f32_16x16x32_bf16 v[48:51], v[112:115], v[160:163], 0
s_mov_b64 exec, 1
ds_write_b32 v3, v4
s_mov_b64 exec, -1
s_waitcnt lgkmcnt(13)
v_mfma_f32_16x16x32_bf16 v[48:51], v[116:119], v[164:167], v[48:51]
v_add_u32 v8, s67, v8
v_add_u32 v9, s67, v9
s_waitcnt lgkmcnt(11)
v_mfma_f32_16x16x32_bf16 v[52:55], v[112:115], v[168:171], 0
v_add_u32 v6, s67, v6
v_add_u32 v7, s67, v7
s_waitcnt lgkmcnt(9)
v_mfma_f32_16x16x32_bf16 v[52:55], v[116:119], v[172:175], v[52:55]
s_mov_b32 s70, s67
s_mov_b32 s67, s68
s_mov_b32 s68, s69
s_mov_b32 s69, s70
v_mfma_f32_16x16x32_bf16 v[56:59], v[120:123], v[160:163], 0
ds_read_b32 v5, v2 offset:16
v_mfma_f32_16x16x32_bf16 v[56:59], v[124:127], v[164:167], v[56:59]
v_mfma_f32_16x16x32_bf16 v[60:63], v[120:123], v[168:171], 0
v_mfma_f32_16x16x32_bf16 v[60:63], v[124:127], v[172:175], v[60:63]
v_mfma_f32_16x16x32_bf16 v[64:67], v[128:131], v[160:163], 0
s_waitcnt lgkmcnt(0)
v_cmp_ge_u32 vcc, v4, v5
s_cbranch_vccnz mspin_132
mback_133:
v_add_u32 v4, 1, v4
v_mfma_f32_16x16x32_bf16 v[64:67], v[132:135], v[164:167], v[64:67]
ds_read_b64_tr_b16 v[144:145], v8 offset:8192
v_mfma_f32_16x16x32_bf16 v[68:71], v[128:131], v[168:171], 0
ds_read_b64_tr_b16 v[146:147], v8 offset:8704
v_mfma_f32_16x16x32_bf16 v[68:71], v[132:135], v[172:175], v[68:71]
ds_read_b64_tr_b16 v[148:149], v8 offset:12288
v_mfma_f32_16x16x32_bf16 v[72:75], v[136:139], v[160:163], 0
ds_read_b64_tr_b16 v[150:151], v8 offset:12800
v_mfma_f32_16x16x32_bf16 v[72:75], v[140:143], v[164:167], v[72:75]
ds_read_b64_tr_b16 v[152:153], v9 offset:8192
v_mfma_f32_16x16x32_bf16 v[76:79], v[136:139], v[168:171], 0
ds_read_b64_tr_b16 v[154:155], v9 offset:8704
v_mfma_f32_16x16x32_bf16 v[76:79], v[140:143], v[172:175], v[76:79]
ds_read_b64_tr_b16 v[156:157], v9 offset:12288
v_mfma_f32_16x16x32_bf16 v[80:83], v[176:179], v[112:115], 0
ds_read_b64_tr_b16 v[158:159], v9 offset:12800
v_mfma_f32_16x16x32_bf16 v[80:83], v[180:183], v[116:119], v[80:83]
v_mfma_f32_16x16x32_bf16 v[84:87], v[184:187], v[112:115], 0
v_mfma_f32_16x16x32_bf16 v[84:87], v[188:191], v[116:119], v[84:87]
ds_read_b128 v[112:115], v6 offset:0
ds_read_b128 v[116:119], v7 offset:0
v_mfma_f32_16x16x32_bf16 v[88:91], v[176:179], v[120:123], 0
v_mfma_f32_16x16x32_bf16 v[88:91], v[180:183], v[124:127], v[88:91]
v_mfma_f32_16x16x32_bf16 v[92:95], v[184:187], v[120:123], 0
v_mfma_f32_16x16x32_bf16 v[92:95], v[188:191], v[124:127], v[92:95]
ds_read_b128 v[120:123], v6 offset:2048
ds_read_b128 v[124:127], v7 offset:2048
v_mfma_f32_16x16x32_bf16 v[96:99], v[176:179], v[128:131], 0
v_mfma_f32_16x16x32_bf16 v[96:99], v[180:183], v[132:135], v[96:99]
v_mfma_f32_16x16x32_bf16 v[100:103], v[184:187], v[128:131], 0
v_mfma_f32_16x16x32_bf16 v[100:103], v[188:191], v[132:135], v[100:103]
ds_read_b128 v[128:131], v6 offset:4096
ds_read_b128 v[132:135], v7 offset:4096
v_mfma_f32_16x16x32_bf16 v[104:107], v[176:179], v[136:139], 0
v_mfma_f32_16x16x32_bf16 v[104:107], v[180:183], v[140:143], v[104:107]
v_mfma_f32_16x16x32_bf16 v[108:111], v[184:187], v[136:139], 0
v_mfma_f32_16x16x32_bf16 v[108:111], v[188:191], v[140:143], v[108:111]
ds_read_b128 v[136:139], v6 offset:6144
ds_read_b128 v[140:143], v7 offset:6144
.p2align 6
mqkv_129:
s_waitcnt lgkmcnt(7)
v_mfma_f32_16x16x32_bf16 v[16:19], v[144:147], v[112:115], v[16:19]
ds_read_b64_tr_b16 v[160:161], v8 offset:16384
s_waitcnt lgkmcnt(7)
v_mfma_f32_16x16x32_bf16 v[16:19], v[148:151], v[116:119], v[16:19]
ds_read_b64_tr_b16 v[162:163], v8 offset:16896
v_mfma_f32_16x16x32_bf16 v[20:23], v[152:155], v[112:115], v[20:23]
ds_read_b64_tr_b16 v[164:165], v8 offset:20480
v_mfma_f32_16x16x32_bf16 v[20:23], v[156:159], v[116:119], v[20:23]
ds_read_b64_tr_b16 v[166:167], v8 offset:20992
s_waitcnt lgkmcnt(9)
v_mfma_f32_16x16x32_bf16 v[24:27], v[144:147], v[120:123], v[24:27]
ds_read_b64_tr_b16 v[168:169], v9 offset:16384
s_waitcnt lgkmcnt(9)
v_mfma_f32_16x16x32_bf16 v[24:27], v[148:151], v[124:127], v[24:27]
ds_read_b64_tr_b16 v[170:171], v9 offset:16896
v_mfma_f32_16x16x32_bf16 v[28:31], v[152:155], v[120:123], v[28:31]
ds_read_b64_tr_b16 v[172:173], v9 offset:20480
v_mfma_f32_16x16x32_bf16 v[28:31], v[156:159], v[124:127], v[28:31]
ds_read_b64_tr_b16 v[174:175], v9 offset:20992
s_waitcnt lgkmcnt(11)
v_mfma_f32_16x16x32_bf16 v[32:35], v[144:147], v[128:131], v[32:35]
ds_read_b64_tr_b16 v[176:177], v8 offset:0
s_waitcnt lgkmcnt(11)
v_mfma_f32_16x16x32_bf16 v[32:35], v[148:151], v[132:135], v[32:35]
ds_read_b64_tr_b16 v[178:179], v8 offset:512
v_mfma_f32_16x16x32_bf16 v[36:39], v[152:155], v[128:131], v[36:39]
ds_read_b64_tr_b16 v[180:181], v8 offset:4096
v_mfma_f32_16x16x32_bf16 v[36:39], v[156:159], v[132:135], v[36:39]
ds_read_b64_tr_b16 v[182:183], v8 offset:4608
s_waitcnt lgkmcnt(13)
v_mfma_f32_16x16x32_bf16 v[40:43], v[144:147], v[136:139], v[40:43]
ds_read_b64_tr_b16 v[184:185], v9 offset:0
s_waitcnt lgkmcnt(13)
v_mfma_f32_16x16x32_bf16 v[40:43], v[148:151], v[140:143], v[40:43]
ds_read_b64_tr_b16 v[186:187], v9 offset:512
v_mfma_f32_16x16x32_bf16 v[44:47], v[152:155], v[136:139], v[44:47]
ds_read_b64_tr_b16 v[188:189], v9 offset:4096
v_mfma_f32_16x16x32_bf16 v[44:47], v[156:159], v[140:143], v[44:47]
ds_read_b64_tr_b16 v[190:191], v9 offset:4608
s_waitcnt lgkmcnt(14)
v_mfma_f32_16x16x32_bf16 v[48:51], v[112:115], v[160:163], v[48:51]
s_mov_b64 exec, 1
ds_write_b32 v3, v4
s_mov_b64 exec, -1
s_waitcnt lgkmcnt(13)
v_mfma_f32_16x16x32_bf16 v[48:51], v[116:119], v[164:167], v[48:51]
v_add_u32 v8, s67, v8
v_add_u32 v9, s67, v9
s_waitcnt lgkmcnt(11)
v_mfma_f32_16x16x32_bf16 v[52:55], v[112:115], v[168:171], v[52:55]
v_add_u32 v6, s67, v6
v_add_u32 v7, s67, v7
s_waitcnt lgkmcnt(9)
v_mfma_f32_16x16x32_bf16 v[52:55], v[116:119], v[172:175], v[52:55]
s_mov_b32 s70, s67
s_mov_b32 s67, s68
s_mov_b32 s68, s69
s_mov_b32 s69, s70
v_mfma_f32_16x16x32_bf16 v[56:59], v[120:123], v[160:163], v[56:59]
ds_read_b32 v5, v2 offset:16
v_mfma_f32_16x16x32_bf16 v[56:59], v[124:127], v[164:167], v[56:59]
v_mfma_f32_16x16x32_bf16 v[60:63], v[120:123], v[168:171], v[60:63]
v_mfma_f32_16x16x32_bf16 v[60:63], v[124:127], v[172:175], v[60:63]
v_mfma_f32_16x16x32_bf16 v[64:67], v[128:131], v[160:163], v[64:67]
s_waitcnt lgkmcnt(0)
v_cmp_ge_u32 vcc, v4, v5
s_cbranch_vccnz mspin_130
mback_131:
v_add_u32 v4, 1, v4
v_mfma_f32_16x16x32_bf16 v[64:67], v[132:135], v[164:167], v[64:67]
ds_read_b64_tr_b16 v[144:145], v8 offset:8192
v_mfma_f32_16x16x32_bf16 v[68:71], v[128:131], v[168:171], v[68:71]
ds_read_b64_tr_b16 v[146:147], v8 offset:8704
v_mfma_f32_16x16x32_bf16 v[68:71], v[132:135], v[172:175], v[68:71]
ds_read_b64_tr_b16 v[148:149], v8 offset:12288
v_mfma_f32_16x16x32_bf16 v[72:75], v[136:139], v[160:163], v[72:75]
ds_read_b64_tr_b16 v[150:151], v8 offset:12800
v_mfma_f32_16x16x32_bf16 v[72:75], v[140:143], v[164:167], v[72:75]
ds_read_b64_tr_b16 v[152:153], v9 offset:8192
v_mfma_f32_16x16x32_bf16 v[76:79], v[136:139], v[168:171], v[76:79]
ds_read_b64_tr_b16 v[154:155], v9 offset:8704
v_mfma_f32_16x16x32_bf16 v[76:79], v[140:143], v[172:175], v[76:79]
ds_read_b64_tr_b16 v[156:157], v9 offset:12288
v_mfma_f32_16x16x32_bf16 v[80:83], v[176:179], v[112:115], v[80:83]
ds_read_b64_tr_b16 v[158:159], v9 offset:12800
v_mfma_f32_16x16x32_bf16 v[80:83], v[180:183], v[116:119], v[80:83]
v_mfma_f32_16x16x32_bf16 v[84:87], v[184:187], v[112:115], v[84:87]
v_mfma_f32_16x16x32_bf16 v[84:87], v[188:191], v[116:119], v[84:87]
ds_read_b128 v[112:115], v6 offset:0
ds_read_b128 v[116:119], v7 offset:0
v_mfma_f32_16x16x32_bf16 v[88:91], v[176:179], v[120:123], v[88:91]
v_mfma_f32_16x16x32_bf16 v[88:91], v[180:183], v[124:127], v[88:91]
v_mfma_f32_16x16x32_bf16 v[92:95], v[184:187], v[120:123], v[92:95]
v_mfma_f32_16x16x32_bf16 v[92:95], v[188:191], v[124:127], v[92:95]
ds_read_b128 v[120:123], v6 offset:2048
ds_read_b128 v[124:127], v7 offset:2048
v_mfma_f32_16x16x32_bf16 v[96:99], v[176:179], v[128:131], v[96:99]
v_mfma_f32_16x16x32_bf16 v[96:99], v[180:183], v[132:135], v[96:99]
v_mfma_f32_16x16x32_bf16 v[100:103], v[184:187], v[128:131], v[100:103]
v_mfma_f32_16x16x32_bf16 v[100:103], v[188:191], v[132:135], v[100:103]
ds_read_b128 v[128:131], v6 offset:4096
ds_read_b128 v[132:135], v7 offset:4096
v_mfma_f32_16x16x32_bf16 v[104:107], v[176:179], v[136:139], v[104:107]
v_mfma_f32_16x16x32_bf16 v[104:107], v[180:183], v[140:143], v[104:107]
s_sub_u32 s66, s66, 1
s_cmp_eq_u32 s66, 0
v_mfma_f32_16x16x32_bf16 v[108:111], v[184:187], v[136:139], v[108:111]
v_mfma_f32_16x16x32_bf16 v[108:111], v[188:191], v[140:143], v[108:111]
ds_read_b128 v[136:139], v6 offset:6144
ds_read_b128 v[140:143], v7 offset:6144
s_cbranch_scc0 mqkv_129
s_waitcnt lgkmcnt(7)
v_mfma_f32_16x16x32_bf16 v[16:19], v[144:147], v[112:115], v[16:19]
ds_read_b32 v5, v2 offset:24
s_add_u32 s35, s34, 2
v_mov_b32 v6, 0
ds_read_b64_tr_b16 v[160:161], v8 offset:16384
s_waitcnt lgkmcnt(8)
v_mfma_f32_16x16x32_bf16 v[16:19], v[148:151], v[116:119], v[16:19]
ds_read_b64_tr_b16 v[162:163], v8 offset:16896
v_mfma_f32_16x16x32_bf16 v[20:23], v[152:155], v[112:115], v[20:23]
ds_read_b64_tr_b16 v[164:165], v8 offset:20480
v_mfma_f32_16x16x32_bf16 v[20:23], v[156:159], v[116:119], v[20:23]
ds_read_b64_tr_b16 v[166:167], v8 offset:20992
s_waitcnt lgkmcnt(10)
v_mfma_f32_16x16x32_bf16 v[24:27], v[144:147], v[120:123], v[24:27]
ds_read_b64_tr_b16 v[168:169], v9 offset:16384
s_waitcnt lgkmcnt(10)
v_mfma_f32_16x16x32_bf16 v[24:27], v[148:151], v[124:127], v[24:27]
ds_read_b64_tr_b16 v[170:171], v9 offset:16896
v_mfma_f32_16x16x32_bf16 v[28:31], v[152:155], v[120:123], v[28:31]
ds_read_b64_tr_b16 v[172:173], v9 offset:20480
s_waitcnt lgkmcnt(7)
v_cmp_gt_i32 vcc, s35, v5
s_cbranch_vccnz lspin_134
lback_135:
ds_read2_b32 v[6:7], v6 offset0:8 offset1:14
ds_read_b128 v[200:203], v211 offset:2432
v_mfma_f32_16x16x32_bf16 v[28:31], v[156:159], v[124:127], v[28:31]
ds_read_b64_tr_b16 v[174:175], v9 offset:20992
ds_read_b128 v[204:207], v211 offset:2496
ds_read2_b32 v[192:193], v208 offset0:0 offset1:128
v_mfma_f32_16x16x32_bf16 v[32:35], v[144:147], v[128:131], v[32:35]
ds_read2_b32 v[194:195], v208 offset0:16 offset1:144
v_mfma_f32_16x16x32_bf16 v[32:35], v[148:151], v[132:135], v[32:35]
ds_read2_b32 v[196:197], v208 offset0:32 offset1:160
ds_read2_b32 v[198:199], v208 offset0:48 offset1:176
v_mfma_f32_16x16x32_bf16 v[36:39], v[152:155], v[128:131], v[36:39]
ds_read_b64_tr_b16 v[176:177], v8 offset:0
ds_read_b64_tr_b16 v[178:179], v8 offset:512
v_mfma_f32_16x16x32_bf16 v[36:39], v[156:159], v[132:135], v[36:39]
ds_read_b64_tr_b16 v[180:181], v8 offset:4096
v_mfma_f32_16x16x32_bf16 v[40:43], v[144:147], v[136:139], v[40:43]
ds_read_b64_tr_b16 v[182:183], v8 offset:4608
ds_read_b64_tr_b16 v[184:185], v9 offset:0
v_mfma_f32_16x16x32_bf16 v[40:43], v[148:151], v[140:143], v[40:43]
ds_read_b64_tr_b16 v[186:187], v9 offset:512
ds_read_b64_tr_b16 v[188:189], v9 offset:4096
v_mfma_f32_16x16x32_bf16 v[44:47], v[152:155], v[136:139], v[44:47]
ds_read_b64_tr_b16 v[190:191], v9 offset:4608
v_mfma_f32_16x16x32_bf16 v[44:47], v[156:159], v[140:143], v[44:47]
s_mov_b64 exec, 1
ds_write_b32 v3, v4
s_mov_b64 exec, -1
s_waitcnt lgkmcnt(14)
v_readfirstlane_b32 s33, v6
v_readfirstlane_b32 s57, v7
s_sub_u32 s33, s33, 1
s_lshr_b32 s66, s33, 7
s_mov_b32 s73, -1
v_mfma_f32_16x16x32_bf16 v[48:51], v[112:115], v[160:163], v[48:51]
s_cmp_eq_u32 s66, s59
s_cbranch_scc1 patch_136
pback_137:
v_mfma_f32_16x16x32_bf16 v[48:51], v[116:119], v[164:167], v[48:51]
ds_read_b32 v10, v210 offset:2560
ds_read_b32 v11, v210 offset:2624
s_waitcnt lgkmcnt(14)
v_mul_f32 v16, v16, v192
v_mul_f32 v17, v17, v192
v_mul_f32 v18, v18, v192
v_mfma_f32_16x16x32_bf16 v[52:55], v[112:115], v[168:171], v[52:55]
v_mul_f32 v19, v19, v192
v_mul_f32 v20, v20, v192
v_mul_f32 v21, v21, v192
v_mul_f32 v22, v22, v192
v_mul_f32 v23, v23, v192
v_mfma_f32_16x16x32_bf16 v[52:55], v[116:119], v[172:175], v[52:55]
v_fmac_f32 v16, v200, v193
v_fmac_f32 v17, v201, v193
v_fmac_f32 v18, v202, v193
v_fmac_f32 v19, v203, v193
v_fmac_f32 v20, v204, v193
v_mfma_f32_16x16x32_bf16 v[56:59], v[120:123], v[160:163], v[56:59]
v_fmac_f32 v21, v205, v193
v_fmac_f32 v22, v206, v193
v_fmac_f32 v23, v207, v193
v_cvt_pk_bf16_f32 v16, v16, v17
v_cvt_pk_bf16_f32 v17, v18, v19
v_mfma_f32_16x16x32_bf16 v[56:59], v[124:127], v[164:167], v[56:59]
v_cvt_pk_bf16_f32 v18, v20, v21
v_cvt_pk_bf16_f32 v19, v22, v23
buffer_store_dwordx4 v[16:19], v12, s[20:23], s71 offen offset:0 sc1
ds_write_b128 v12, v[16:19] offset:0
ds_read_b128 v[144:147], v209 offset:0
v_mfma_f32_16x16x32_bf16 v[60:63], v[120:123], v[168:171], v[60:63]
ds_read_b128 v[20:23], v209 offset:512
s_waitcnt lgkmcnt(14)
v_mul_f32 v24, v24, v194
v_mul_f32 v25, v25, v194
v_mul_f32 v26, v26, v194
v_mul_f32 v27, v27, v194
v_mfma_f32_16x16x32_bf16 v[60:63], v[124:127], v[172:175], v[60:63]
v_mul_f32 v28, v28, v194
v_mul_f32 v29, v29, v194
v_mul_f32 v30, v30, v194
v_mul_f32 v31, v31, v194
v_fmac_f32 v24, v200, v195
v_mfma_f32_16x16x32_bf16 v[64:67], v[128:131], v[160:163], v[64:67]
v_fmac_f32 v25, v201, v195
v_fmac_f32 v26, v202, v195
v_fmac_f32 v27, v203, v195
v_fmac_f32 v28, v204, v195
v_mfma_f32_16x16x32_bf16 v[64:67], v[132:135], v[164:167], v[64:67]
v_fmac_f32 v29, v205, v195
v_fmac_f32 v30, v206, v195
v_fmac_f32 v31, v207, v195
v_cvt_pk_bf16_f32 v24, v24, v25
v_cvt_pk_bf16_f32 v25, v26, v27
v_mfma_f32_16x16x32_bf16 v[68:71], v[128:131], v[168:171], v[68:71]
v_cvt_pk_bf16_f32 v26, v28, v29
v_cvt_pk_bf16_f32 v27, v30, v31
buffer_store_dwordx4 v[24:27], v12, s[20:23], s71 offen offset:128 sc1
ds_write_b128 v12, v[24:27] offset:128
ds_read_b128 v[148:151], v209 offset:64
v_mfma_f32_16x16x32_bf16 v[68:71], v[132:135], v[172:175], v[68:71]
ds_read_b128 v[28:31], v209 offset:576
v_mul_f32 v32, v32, v196
v_mul_f32 v33, v33, v196
v_mul_f32 v34, v34, v196
v_mul_f32 v35, v35, v196
v_mfma_f32_16x16x32_bf16 v[72:75], v[136:139], v[160:163], v[72:75]
v_mul_f32 v36, v36, v196
v_mul_f32 v37, v37, v196
v_mul_f32 v38, v38, v196
v_mul_f32 v39, v39, v196
v_fmac_f32 v32, v200, v197
v_mfma_f32_16x16x32_bf16 v[72:75], v[140:143], v[164:167], v[72:75]
v_fmac_f32 v33, v201, v197
v_fmac_f32 v34, v202, v197
v_fmac_f32 v35, v203, v197
v_fmac_f32 v36, v204, v197
v_fmac_f32 v37, v205, v197
v_mfma_f32_16x16x32_bf16 v[76:79], v[136:139], v[168:171], v[76:79]
v_fmac_f32 v38, v206, v197
v_fmac_f32 v39, v207, v197
v_cvt_pk_bf16_f32 v32, v32, v33
v_cvt_pk_bf16_f32 v33, v34, v35
v_cvt_pk_bf16_f32 v34, v36, v37
v_mfma_f32_16x16x32_bf16 v[76:79], v[140:143], v[172:175], v[76:79]
v_cvt_pk_bf16_f32 v35, v38, v39
buffer_store_dwordx4 v[32:35], v13, s[20:23], s71 offen offset:0 sc1
ds_write_b128 v13, v[32:35] offset:0
ds_read_b128 v[152:155], v209 offset:128
ds_read_b128 v[36:39], v209 offset:640
v_mul_f32 v40, v40, v198
v_mul_f32 v41, v41, v198
v_mul_f32 v42, v42, v198
v_mul_f32 v43, v43, v198
v_mul_f32 v44, v44, v198
v_mul_f32 v45, v45, v198
v_mul_f32 v46, v46, v198
v_mul_f32 v47, v47, v198
v_fmac_f32 v40, v200, v199
v_fmac_f32 v41, v201, v199
v_fmac_f32 v42, v202, v199
v_fmac_f32 v43, v203, v199
v_fmac_f32 v44, v204, v199
v_fmac_f32 v45, v205, v199
v_fmac_f32 v46, v206, v199
v_fmac_f32 v47, v207, v199
v_cvt_pk_bf16_f32 v40, v40, v41
v_cvt_pk_bf16_f32 v41, v42, v43
v_cvt_pk_bf16_f32 v42, v44, v45
v_cvt_pk_bf16_f32 v43, v46, v47
buffer_store_dwordx4 v[40:43], v13, s[20:23], s71 offen offset:128 sc1
ds_write_b128 v13, v[40:43] offset:128
ds_read_b128 v[156:159], v209 offset:192
ds_read_b128 v[44:47], v209 offset:704
s_cmp_ge_i32 s73, 0
s_cbranch_scc1 patch_138
pback_139:
ds_read_b128 v[160:163], v211 offset:2304
ds_read_b128 v[164:167], v211 offset:2368
s_waitcnt lgkmcnt(12)
v_pk_mul_f32 v[48:49], v[48:49], v[144:145]
v_pk_mul_f32 v[50:51], v[50:51], v[146:147]
s_waitcnt lgkmcnt(11)
v_pk_fma_f32 v[48:49], v[20:21], v[10:11], v[48:49] op_sel:[0,0,0] op_sel_hi:[1,0,1]
v_pk_fma_f32 v[50:51], v[22:23], v[10:11], v[50:51] op_sel:[0,0,0] op_sel_hi:[1,0,1]
s_waitcnt lgkmcnt(9)
v_pk_mul_f32 v[56:57], v[56:57], v[148:149]
v_pk_mul_f32 v[58:59], v[58:59], v[150:151]
s_waitcnt lgkmcnt(8)
v_pk_fma_f32 v[56:57], v[28:29], v[10:11], v[56:57] op_sel:[0,0,0] op_sel_hi:[1,0,1]
v_pk_fma_f32 v[58:59], v[30:31], v[10:11], v[58:59] op_sel:[0,0,0] op_sel_hi:[1,0,1]
v_cvt_pk_bf16_f32 v48, v48, v49
v_cvt_pk_bf16_f32 v49, v50, v51
v_cvt_pk_bf16_f32 v50, v56, v57
v_cvt_pk_bf16_f32 v51, v58, v59
buffer_store_dwordx4 v[48:51], v14, s[20:23], s71 offen offset:2048 sc1
ds_write_b128 v14, v[48:51] offset:2048
v_pk_mul_f32 v[52:53], v[52:53], v[144:145]
v_pk_mul_f32 v[54:55], v[54:55], v[146:147]
v_pk_fma_f32 v[52:53], v[20:21], v[10:11], v[52:53] op_sel:[0,1,0] op_sel_hi:[1,1,1]
v_pk_fma_f32 v[54:55], v[22:23], v[10:11], v[54:55] op_sel:[0,1,0] op_sel_hi:[1,1,1]
v_pk_mul_f32 v[60:61], v[60:61], v[148:149]
v_pk_mul_f32 v[62:63], v[62:63], v[150:151]
v_pk_fma_f32 v[60:61], v[28:29], v[10:11], v[60:61] op_sel:[0,1,0] op_sel_hi:[1,1,1]
v_pk_fma_f32 v[62:63], v[30:31], v[10:11], v[62:63] op_sel:[0,1,0] op_sel_hi:[1,1,1]
v_cvt_pk_bf16_f32 v52, v52, v53
v_cvt_pk_bf16_f32 v53, v54, v55
v_cvt_pk_bf16_f32 v54, v60, v61
v_cvt_pk_bf16_f32 v55, v62, v63
buffer_store_dwordx4 v[52:55], v14, s[20:23], s71 offen offset:2304 sc1
ds_write_b128 v14, v[52:55] offset:2304
s_waitcnt lgkmcnt(8)
v_pk_mul_f32 v[64:65], v[64:65], v[152:153]
v_pk_mul_f32 v[66:67], v[66:67], v[154:155]
s_waitcnt lgkmcnt(7)
v_pk_fma_f32 v[64:65], v[36:37], v[10:11], v[64:65] op_sel:[0,0,0] op_sel_hi:[1,0,1]
v_pk_fma_f32 v[66:67], v[38:39], v[10:11], v[66:67] op_sel:[0,0,0] op_sel_hi:[1,0,1]
s_waitcnt lgkmcnt(5)
v_pk_mul_f32 v[72:73], v[72:73], v[156:157]
v_pk_mul_f32 v[74:75], v[74:75], v[158:159]
s_waitcnt lgkmcnt(4)
v_pk_fma_f32 v[72:73], v[44:45], v[10:11], v[72:73] op_sel:[0,0,0] op_sel_hi:[1,0,1]
v_pk_fma_f32 v[74:75], v[46:47], v[10:11], v[74:75] op_sel:[0,0,0] op_sel_hi:[1,0,1]
v_cvt_pk_bf16_f32 v64, v64, v65
v_cvt_pk_bf16_f32 v65, v66, v67
v_cvt_pk_bf16_f32 v66, v72, v73
v_cvt_pk_bf16_f32 v67, v74, v75
buffer_store_dwordx4 v[64:67], v15, s[20:23], s71 offen offset:2048 sc1
ds_write_b128 v15, v[64:67] offset:2048
v_pk_mul_f32 v[68:69], v[68:69], v[152:153]
v_pk_mul_f32 v[70:71], v[70:71], v[154:155]
v_pk_fma_f32 v[68:69], v[36:37], v[10:11], v[68:69] op_sel:[0,1,0] op_sel_hi:[1,1,1]
v_pk_fma_f32 v[70:71], v[38:39], v[10:11], v[70:71] op_sel:[0,1,0] op_sel_hi:[1,1,1]
v_pk_mul_f32 v[76:77], v[76:77], v[156:157]
v_pk_mul_f32 v[78:79], v[78:79], v[158:159]
v_pk_fma_f32 v[76:77], v[44:45], v[10:11], v[76:77] op_sel:[0,1,0] op_sel_hi:[1,1,1]
v_pk_fma_f32 v[78:79], v[46:47], v[10:11], v[78:79] op_sel:[0,1,0] op_sel_hi:[1,1,1]
v_cvt_pk_bf16_f32 v68, v68, v69
v_cvt_pk_bf16_f32 v69, v70, v71
v_cvt_pk_bf16_f32 v70, v76, v77
v_cvt_pk_bf16_f32 v71, v78, v79
buffer_store_dwordx4 v[68:71], v15, s[20:23], s71 offen offset:2304 sc1
ds_write_b128 v15, v[68:71] offset:2304
v_add_u32 v5, s34, 17
s_mov_b64 exec, 1
ds_write_b32 v3, v5
s_mov_b64 exec, -1
s_mov_b32 s66, 0x3e8293ee
v_mfma_f32_16x16x32_bf16 v[96:99], v[176:179], v[128:131], v[96:99]
v_mul_f32 v192, s66, v192
v_mfma_f32_16x16x32_bf16 v[96:99], v[180:183], v[132:135], v[96:99]
v_mfma_f32_16x16x32_bf16 v[100:103], v[184:187], v[128:131], v[100:103]
v_mul_f32 v193, s66, v193
v_mfma_f32_16x16x32_bf16 v[100:103], v[188:191], v[132:135], v[100:103]
v_mfma_f32_16x16x32_bf16 v[104:107], v[176:179], v[136:139], v[104:107]
v_mul_f32 v194, s66, v194
v_mfma_f32_16x16x32_bf16 v[104:107], v[180:183], v[140:143], v[104:107]
v_mfma_f32_16x16x32_bf16 v[108:111], v[184:187], v[136:139], v[108:111]
v_mul_f32 v195, s66, v195
v_mfma_f32_16x16x32_bf16 v[108:111], v[188:191], v[140:143], v[108:111]
v_mfma_f32_16x16x32_bf16 v[80:83], v[176:179], v[112:115], v[80:83]
v_mul_f32 v196, s66, v196
v_mfma_f32_16x16x32_bf16 v[80:83], v[180:183], v[116:119], v[80:83]
v_mfma_f32_16x16x32_bf16 v[84:87], v[184:187], v[112:115], v[84:87]
v_mul_f32 v197, s66, v197
v_mfma_f32_16x16x32_bf16 v[84:87], v[188:191], v[116:119], v[84:87]
v_mfma_f32_16x16x32_bf16 v[88:91], v[176:179], v[120:123], v[88:91]
v_mul_f32 v198, s66, v198
v_mfma_f32_16x16x32_bf16 v[88:91], v[180:183], v[124:127], v[88:91]
v_mfma_f32_16x16x32_bf16 v[92:95], v[184:187], v[120:123], v[92:95]
v_mul_f32 v199, s66, v199
v_mfma_f32_16x16x32_bf16 v[92:95], v[188:191], v[124:127], v[92:95]
s_cmp_ge_i32 s73, 0
s_cbranch_scc1 patch_140
pback_141:
v_mov_b32 v200, 0
v_mov_b32 v201, 0
v_mov_b32 v202, 0
v_mov_b32 v203, 0
v_mov_b32 v204, 0
v_mov_b32 v205, 0
v_mov_b32 v206, 0
v_mov_b32 v207, 0
v_mov_b32 v208, 0
v_mov_b32 v209, 0
v_mov_b32 v210, 0
v_mov_b32 v211, 0
v_pk_mul_f32 v[96:97], v[96:97], v[196:197] op_sel:[0,0] op_sel_hi:[1,0]
v_pk_mul_f32 v[98:99], v[98:99], v[196:197] op_sel:[0,0] op_sel_hi:[1,0]
v_pk_mul_f32 v[100:101], v[100:101], v[196:197] op_sel:[0,0] op_sel_hi:[1,0]
v_pk_mul_f32 v[102:103], v[102:103], v[196:197] op_sel:[0,0] op_sel_hi:[1,0]
s_waitcnt lgkmcnt(6)
v_pk_fma_f32 v[96:97], v[160:161], v[196:197], v[96:97] op_sel:[0,1,0] op_sel_hi:[1,1,1]
v_pk_fma_f32 v[98:99], v[162:163], v[196:197], v[98:99] op_sel:[0,1,0] op_sel_hi:[1,1,1]
s_waitcnt lgkmcnt(5)
v_pk_fma_f32 v[100:101], v[164:165], v[196:197], v[100:101] op_sel:[0,1,0] op_sel_hi:[1,1,1]
v_pk_fma_f32 v[102:103], v[166:167], v[196:197], v[102:103] op_sel:[0,1,0] op_sel_hi:[1,1,1]
v_cvt_pk_bf16_f32 v96, v96, v97
v_cvt_pk_bf16_f32 v97, v98, v99
v_cvt_pk_bf16_f32 v98, v100, v101
v_cvt_pk_bf16_f32 v99, v102, v103
v_pk_mul_f32 v[104:105], v[104:105], v[198:199] op_sel:[0,0] op_sel_hi:[1,0]
v_pk_mul_f32 v[106:107], v[106:107], v[198:199] op_sel:[0,0] op_sel_hi:[1,0]
v_pk_mul_f32 v[108:109], v[108:109], v[198:199] op_sel:[0,0] op_sel_hi:[1,0]
v_pk_mul_f32 v[110:111], v[110:111], v[198:199] op_sel:[0,0] op_sel_hi:[1,0]
v_pk_fma_f32 v[104:105], v[160:161], v[198:199], v[104:105] op_sel:[0,1,0] op_sel_hi:[1,1,1]
v_pk_fma_f32 v[106:107], v[162:163], v[198:199], v[106:107] op_sel:[0,1,0] op_sel_hi:[1,1,1]
v_pk_fma_f32 v[108:109], v[164:165], v[198:199], v[108:109] op_sel:[0,1,0] op_sel_hi:[1,1,1]
v_pk_fma_f32 v[110:111], v[166:167], v[198:199], v[110:111] op_sel:[0,1,0] op_sel_hi:[1,1,1]
v_cvt_pk_bf16_f32 v104, v104, v105
v_cvt_pk_bf16_f32 v105, v106, v107
v_cvt_pk_bf16_f32 v106, v108, v109
v_cvt_pk_bf16_f32 v107, v110, v111
v_pk_mul_f32 v[80:81], v[80:81], v[192:193] op_sel:[0,0] op_sel_hi:[1,0]
v_pk_mul_f32 v[82:83], v[82:83], v[192:193] op_sel:[0,0] op_sel_hi:[1,0]
v_pk_mul_f32 v[84:85], v[84:85], v[192:193] op_sel:[0,0] op_sel_hi:[1,0]
v_pk_mul_f32 v[86:87], v[86:87], v[192:193] op_sel:[0,0] op_sel_hi:[1,0]
v_pk_fma_f32 v[80:81], v[160:161], v[192:193], v[80:81] op_sel:[0,1,0] op_sel_hi:[1,1,1]
v_pk_fma_f32 v[82:83], v[162:163], v[192:193], v[82:83] op_sel:[0,1,0] op_sel_hi:[1,1,1]
v_pk_fma_f32 v[84:85], v[164:165], v[192:193], v[84:85] op_sel:[0,1,0] op_sel_hi:[1,1,1]
v_pk_fma_f32 v[86:87], v[166:167], v[192:193], v[86:87] op_sel:[0,1,0] op_sel_hi:[1,1,1]
v_cvt_pk_bf16_f32 v80, v80, v81
v_cvt_pk_bf16_f32 v81, v82, v83
v_cvt_pk_bf16_f32 v82, v84, v85
v_cvt_pk_bf16_f32 v83, v86, v87
v_pk_mul_f32 v[88:89], v[88:89], v[194:195] op_sel:[0,0] op_sel_hi:[1,0]
v_pk_mul_f32 v[90:91], v[90:91], v[194:195] op_sel:[0,0] op_sel_hi:[1,0]
v_pk_mul_f32 v[92:93], v[92:93], v[194:195] op_sel:[0,0] op_sel_hi:[1,0]
v_pk_mul_f32 v[94:95], v[94:95], v[194:195] op_sel:[0,0] op_sel_hi:[1,0]
v_pk_fma_f32 v[88:89], v[160:161], v[194:195], v[88:89] op_sel:[0,1,0] op_sel_hi:[1,1,1]
v_pk_fma_f32 v[90:91], v[162:163], v[194:195], v[90:91] op_sel:[0,1,0] op_sel_hi:[1,1,1]
v_pk_fma_f32 v[92:93], v[164:165], v[194:195], v[92:93] op_sel:[0,1,0] op_sel_hi:[1,1,1]
v_pk_fma_f32 v[94:95], v[166:167], v[194:195], v[94:95] op_sel:[0,1,0] op_sel_hi:[1,1,1]
v_cvt_pk_bf16_f32 v88, v88, v89
v_cvt_pk_bf16_f32 v89, v90, v91
v_cvt_pk_bf16_f32 v90, v92, v93
v_cvt_pk_bf16_f32 v91, v94, v95
v_permlane16_swap_b32 v96, v104
v_permlane16_swap_b32 v97, v105
v_permlane16_swap_b32 v98, v106
v_permlane16_swap_b32 v99, v107
v_permlane16_swap_b32 v80, v88
v_permlane16_swap_b32 v81, v89
v_permlane16_swap_b32 v82, v90
v_permlane16_swap_b32 v83, v91
v_mov_b32 v192, 0
v_mov_b32 v193, 0
v_mov_b32 v194, 0
v_mov_b32 v195, 0
v_mov_b32 v196, 0
v_mov_b32 v197, 0
v_mov_b32 v198, 0
v_mov_b32 v199, 0
s_lshl_b32 s69, s64, 12
v_lshl_add_u32 v6, v0, 4, s69
v_add_u32 v7, 131072, v6
s_lshl_b32 s69, s65, 13
s_add_u32 s66, s69, 131072
s_sub_u32 s69, 147456, s69
v_add_u32 v8, s69, v6
ds_read_b128 v[152:155], v8 offset:8192
ds_read_b128 v[156:159], v8 offset:9216
s_mov_b32 s67, 122880
s_min_u32 s69, s59, 1
s_lshl2_add_u32 s68, s69, s65
s_cmp_ge_u32 s59, 2
s_cselect_b32 s69, s65, 0
s_add_u32 s68, s68, s69
ds_read_b128 v[160:163], v8 offset:10240
ds_read_b128 v[164:167], v8 offset:11264
s_waitcnt lgkmcnt(3)
v_mfma_f32_32x32x16_bf16 v[112:127], v[152:155], v[96:99], v[216:231]
s_waitcnt lgkmcnt(2)
v_mfma_f32_32x32x16_bf16 v[112:127], v[156:159], v[104:107], v[112:127]
s_add_u32 s35, s34, 17
lw_142:
ds_read_b32 v5, v1 offset:0
s_waitcnt lgkmcnt(0)
v_cmp_gt_i32 vcc, s35, v5
s_cbranch_vccz lwd_143
s_sub_u32 s32, s32, 1
s_cmp_gt_i32 s32, 0
s_cbranch_scc1 lw_142
lwd_143:
ds_read_b128 v[152:155], v8 offset:0
ds_read_b128 v[156:159], v8 offset:1024
s_add_u32 s70, s72, 270336
s_mov_b64 exec, 1
s_waitcnt vmcnt(0)
buffer_store_dword v7, v3, s[24:27], s70 offen sc1
s_mov_b64 exec, -1
.p2align 3
v_exp_f32 v112, v112
v_exp_f32 v113, v113
v_exp_f32 v114, v114
v_exp_f32 v115, v115
v_exp_f32 v116, v116
v_exp_f32 v117, v117
s_waitcnt lgkmcnt(1)
v_mfma_f32_32x32x16_bf16 v[128:143], v[152:155], v[96:99], 0
v_exp_f32 v118, v118
v_exp_f32 v119, v119
v_cvt_pk_bf16_f32 v144, v112, v113
v_cvt_pk_bf16_f32 v145, v114, v115
s_waitcnt lgkmcnt(0)
v_mfma_f32_32x32x16_bf16 v[128:143], v[156:159], v[104:107], v[128:143]
ds_read_b128 v[152:155], v7 offset:8192
ds_read_b128 v[156:159], v7 offset:9216
v_cvt_pk_bf16_f32 v146, v116, v117
v_cvt_pk_bf16_f32 v147, v118, v119
v_exp_f32 v120, v120
v_exp_f32 v121, v121
v_mfma_f32_32x32x16_bf16 v[16:31], v[160:163], v[144:147], 0
ds_read_b128 v[160:163], v8 offset:2048
v_exp_f32 v122, v122
v_exp_f32 v123, v123
v_exp_f32 v124, v124
v_mfma_f32_16x16x32_bf16 v[32:35], v[212:215], v[144:147], 0
s_cmp_eq_u32 s65, 1
v_exp_f32 v125, v125
v_exp_f32 v126, v126
v_exp_f32 v127, v127
v_cvt_pk_bf16_f32 v148, v120, v121
v_cvt_pk_bf16_f32 v149, v122, v123
v_cvt_pk_bf16_f32 v150, v124, v125
v_cvt_pk_bf16_f32 v151, v126, v127
s_cbranch_scc1 at_144
v_exp_f32 v128, v128
v_exp_f32 v129, v129
v_mfma_f32_32x32x16_bf16 v[16:31], v[164:167], v[148:151], v[16:31]
ds_read_b128 v[164:167], v8 offset:3072
v_exp_f32 v130, v130
v_exp_f32 v131, v131
v_exp_f32 v132, v132
v_mfma_f32_16x16x32_bf16 v[32:35], v[212:215], v[148:151], v[32:35]
v_exp_f32 v133, v133
s_waitcnt lgkmcnt(3)
v_mfma_f32_32x32x16_bf16 v[112:127], v[152:155], v[96:99], 0
v_exp_f32 v134, v134
v_exp_f32 v135, v135
v_cvt_pk_bf16_f32 v144, v128, v129
v_cvt_pk_bf16_f32 v145, v130, v131
s_waitcnt lgkmcnt(2)
v_mfma_f32_32x32x16_bf16 v[112:127], v[156:159], v[104:107], v[112:127]
ds_read_b128 v[152:155], v7 offset:0
ds_read_b128 v[156:159], v7 offset:1024
v_cvt_pk_bf16_f32 v146, v132, v133
v_cvt_pk_bf16_f32 v147, v134, v135
v_exp_f32 v136, v136
v_exp_f32 v137, v137
s_waitcnt lgkmcnt(3)
v_mfma_f32_32x32x16_bf16 v[16:31], v[160:163], v[144:147], v[16:31]
ds_read_b128 v[160:163], v7 offset:10240
v_exp_f32 v138, v138
v_exp_f32 v139, v139
v_exp_f32 v140, v140
v_mfma_f32_16x16x32_bf16 v[32:35], v[212:215], v[144:147], v[32:35]
v_exp_f32 v141, v141
v_exp_f32 v142, v142
v_exp_f32 v143, v143
v_cvt_pk_bf16_f32 v148, v136, v137
v_cvt_pk_bf16_f32 v149, v138, v139
v_cvt_pk_bf16_f32 v150, v140, v141
v_cvt_pk_bf16_f32 v151, v142, v143
v_exp_f32 v112, v112
v_exp_f32 v113, v113
s_waitcnt lgkmcnt(3)
v_mfma_f32_32x32x16_bf16 v[16:31], v[164:167], v[148:151], v[16:31]
ds_read_b128 v[164:167], v7 offset:11264
v_exp_f32 v114, v114
v_exp_f32 v115, v115
v_exp_f32 v116, v116
v_mfma_f32_16x16x32_bf16 v[32:35], v[212:215], v[148:151], v[32:35]
v_exp_f32 v117, v117
s_waitcnt lgkmcnt(3)
v_mfma_f32_32x32x16_bf16 v[128:143], v[152:155], v[96:99], 0
v_exp_f32 v118, v118
v_exp_f32 v119, v119
v_cvt_pk_bf16_f32 v144, v112, v113
v_cvt_pk_bf16_f32 v145, v114, v115
s_waitcnt lgkmcnt(2)
v_mfma_f32_32x32x16_bf16 v[128:143], v[156:159], v[104:107], v[128:143]
v_cvt_pk_bf16_f32 v146, v116, v117
v_cvt_pk_bf16_f32 v147, v118, v119
v_exp_f32 v120, v120
v_exp_f32 v121, v121
s_waitcnt lgkmcnt(1)
v_mfma_f32_32x32x16_bf16 v[16:31], v[160:163], v[144:147], v[16:31]
ds_read_b128 v[160:163], v7 offset:2048
v_exp_f32 v122, v122
v_exp_f32 v123, v123
v_exp_f32 v124, v124
v_mfma_f32_16x16x32_bf16 v[32:35], v[212:215], v[144:147], v[32:35]
v_mov_b32 v8, v7
v_exp_f32 v125, v125
v_exp_f32 v126, v126
v_exp_f32 v127, v127
v_cvt_pk_bf16_f32 v148, v120, v121
v_cvt_pk_bf16_f32 v149, v122, v123
v_cvt_pk_bf16_f32 v150, v124, v125
v_cvt_pk_bf16_f32 v151, v126, v127
.p2align 3
at_144:
v_exp_f32 v128, v128
v_exp_f32 v129, v129
s_waitcnt lgkmcnt(1)
v_mfma_f32_32x32x16_bf16 v[16:31], v[164:167], v[148:151], v[16:31]
ds_read_b128 v[164:167], v8 offset:3072
v_exp_f32 v130, v130
v_exp_f32 v131, v131
v_exp_f32 v132, v132
v_mfma_f32_16x16x32_bf16 v[32:35], v[212:215], v[148:151], v[32:35]
v_exp_f32 v133, v133
v_mfma_f32_32x32x16_bf16 v[112:127], v[152:155], v[80:83], v[216:231]
v_exp_f32 v134, v134
v_exp_f32 v135, v135
v_cvt_pk_bf16_f32 v144, v128, v129
v_cvt_pk_bf16_f32 v145, v130, v131
v_mfma_f32_32x32x16_bf16 v[112:127], v[156:159], v[88:91], v[112:127]
s_sub_u32 s66, s66, 8192
s_cmp_eq_u32 s66, s67
s_cbranch_scc1 cross_151
cback_152:
v_add_u32 v8, s66, v6
ds_read_b128 v[152:155], v8 offset:0
ds_read_b128 v[156:159], v8 offset:1024
v_cvt_pk_bf16_f32 v146, v132, v133
v_cvt_pk_bf16_f32 v147, v134, v135
v_exp_f32 v136, v136
v_exp_f32 v137, v137
s_waitcnt lgkmcnt(3)
v_mfma_f32_32x32x16_bf16 v[16:31], v[160:163], v[144:147], v[16:31]
v_exp_f32 v138, v138
v_exp_f32 v139, v139
v_exp_f32 v140, v140
v_mfma_f32_16x16x32_bf16 v[32:35], v[212:215], v[144:147], v[32:35]
s_cmp_eq_u32 s68, 0
v_exp_f32 v141, v141
v_exp_f32 v142, v142
v_exp_f32 v143, v143
v_cvt_pk_bf16_f32 v148, v136, v137
v_cvt_pk_bf16_f32 v149, v138, v139
v_cvt_pk_bf16_f32 v150, v140, v141
v_cvt_pk_bf16_f32 v151, v142, v143
s_cbranch_scc1 at_148
.p2align 3
at_145:
v_exp_f32 v112, v112
v_exp_f32 v113, v113
s_waitcnt lgkmcnt(2)
v_mfma_f32_32x32x16_bf16 v[16:31], v[164:167], v[148:151], v[16:31]
v_exp_f32 v114, v114
v_exp_f32 v115, v115
v_exp_f32 v116, v116
v_mfma_f32_16x16x32_bf16 v[32:35], v[212:215], v[148:151], v[32:35]
v_exp_f32 v117, v117
s_waitcnt lgkmcnt(1)
v_mfma_f32_32x32x16_bf16 v[128:143], v[152:155], v[96:99], 0
v_exp_f32 v118, v118
v_exp_f32 v119, v119
v_cvt_pk_bf16_f32 v144, v112, v113
v_cvt_pk_bf16_f32 v145, v114, v115
s_waitcnt lgkmcnt(0)
v_mfma_f32_32x32x16_bf16 v[128:143], v[156:159], v[104:107], v[128:143]
v_cvt_pk_bf16_f32 v146, v116, v117
v_cvt_pk_bf16_f32 v147, v118, v119
v_exp_f32 v120, v120
v_exp_f32 v121, v121
v_mfma_f32_32x32x16_bf16 v[192:207], v[160:163], v[144:147], v[192:207]
ds_read_b128 v[160:163], v8 offset:2048
v_exp_f32 v122, v122
v_exp_f32 v123, v123
v_exp_f32 v124, v124
v_mfma_f32_16x16x32_bf16 v[208:211], v[212:215], v[144:147], v[208:211]
v_exp_f32 v125, v125
v_exp_f32 v126, v126
v_exp_f32 v127, v127
v_cvt_pk_bf16_f32 v148, v120, v121
v_cvt_pk_bf16_f32 v149, v122, v123
v_cvt_pk_bf16_f32 v150, v124, v125
v_cvt_pk_bf16_f32 v151, v126, v127
v_exp_f32 v128, v128
v_exp_f32 v129, v129
v_mfma_f32_32x32x16_bf16 v[192:207], v[164:167], v[148:151], v[192:207]
ds_read_b128 v[164:167], v8 offset:3072
v_exp_f32 v130, v130
v_exp_f32 v131, v131
v_exp_f32 v132, v132
v_mfma_f32_16x16x32_bf16 v[208:211], v[212:215], v[148:151], v[208:211]
v_exp_f32 v133, v133
v_mfma_f32_32x32x16_bf16 v[112:127], v[152:155], v[80:83], 0
v_exp_f32 v134, v134
v_exp_f32 v135, v135
v_cvt_pk_bf16_f32 v144, v128, v129
v_cvt_pk_bf16_f32 v145, v130, v131
v_mfma_f32_32x32x16_bf16 v[112:127], v[156:159], v[88:91], v[112:127]
s_sub_u32 s66, s66, 8192
s_cmp_eq_u32 s66, s67
s_cbranch_scc1 cross_153
cback_154:
v_add_u32 v8, s66, v6
ds_read_b128 v[152:155], v8 offset:0
ds_read_b128 v[156:159], v8 offset:1024
v_cvt_pk_bf16_f32 v146, v132, v133
v_cvt_pk_bf16_f32 v147, v134, v135
v_exp_f32 v136, v136
v_exp_f32 v137, v137
s_waitcnt lgkmcnt(3)
v_mfma_f32_32x32x16_bf16 v[16:31], v[160:163], v[144:147], v[16:31]
v_exp_f32 v138, v138
v_exp_f32 v139, v139
v_exp_f32 v140, v140
v_mfma_f32_16x16x32_bf16 v[32:35], v[212:215], v[144:147], v[32:35]
s_sub_u32 s68, s68, 1
s_cmp_eq_u32 s68, 0
v_exp_f32 v141, v141
v_exp_f32 v142, v142
v_exp_f32 v143, v143
v_cvt_pk_bf16_f32 v148, v136, v137
v_cvt_pk_bf16_f32 v149, v138, v139
v_cvt_pk_bf16_f32 v150, v140, v141
v_cvt_pk_bf16_f32 v151, v142, v143
s_cbranch_scc0 at_145
s_cmp_lt_u32 s59, 2
s_cbranch_scc1 at_148
.p2align 3
v_exp_f32 v112, v112
v_exp_f32 v113, v113
s_waitcnt lgkmcnt(2)
v_mfma_f32_32x32x16_bf16 v[16:31], v[164:167], v[148:151], v[16:31]
v_exp_f32 v114, v114
v_exp_f32 v115, v115
v_exp_f32 v116, v116
v_mfma_f32_16x16x32_bf16 v[32:35], v[212:215], v[148:151], v[32:35]
v_exp_f32 v117, v117
s_waitcnt lgkmcnt(1)
v_mfma_f32_32x32x16_bf16 v[128:143], v[152:155], v[96:99], v[216:231]
v_exp_f32 v118, v118
v_exp_f32 v119, v119
v_cvt_pk_bf16_f32 v144, v112, v113
v_cvt_pk_bf16_f32 v145, v114, v115
s_waitcnt lgkmcnt(0)
v_mfma_f32_32x32x16_bf16 v[128:143], v[156:159], v[104:107], v[128:143]
v_cvt_pk_bf16_f32 v146, v116, v117
v_cvt_pk_bf16_f32 v147, v118, v119
v_exp_f32 v120, v120
v_exp_f32 v121, v121
v_mfma_f32_32x32x16_bf16 v[192:207], v[160:163], v[144:147], v[192:207]
ds_read_b128 v[160:163], v8 offset:2048
v_exp_f32 v122, v122
v_exp_f32 v123, v123
v_exp_f32 v124, v124
v_mfma_f32_16x16x32_bf16 v[208:211], v[212:215], v[144:147], v[208:211]
v_exp_f32 v125, v125
v_exp_f32 v126, v126
v_exp_f32 v127, v127
v_cvt_pk_bf16_f32 v148, v120, v121
v_cvt_pk_bf16_f32 v149, v122, v123
v_cvt_pk_bf16_f32 v150, v124, v125
v_cvt_pk_bf16_f32 v151, v126, v127
v_exp_f32 v128, v128
v_exp_f32 v129, v129
v_mfma_f32_32x32x16_bf16 v[192:207], v[164:167], v[148:151], v[192:207]
ds_read_b128 v[164:167], v8 offset:3072
v_exp_f32 v130, v130
v_exp_f32 v131, v131
v_exp_f32 v132, v132
v_mfma_f32_16x16x32_bf16 v[208:211], v[212:215], v[148:151], v[208:211]
v_exp_f32 v133, v133
v_mfma_f32_32x32x16_bf16 v[112:127], v[152:155], v[80:83], 0
v_exp_f32 v134, v134
v_exp_f32 v135, v135
v_cvt_pk_bf16_f32 v144, v128, v129
v_cvt_pk_bf16_f32 v145, v130, v131
v_mfma_f32_32x32x16_bf16 v[112:127], v[156:159], v[88:91], v[112:127]
v_subrev_u32 v8, 8192, v8
ds_read_b128 v[152:155], v8 offset:0
ds_read_b128 v[156:159], v8 offset:1024
v_cvt_pk_bf16_f32 v146, v132, v133
v_cvt_pk_bf16_f32 v147, v134, v135
v_exp_f32 v136, v136
v_exp_f32 v137, v137
s_waitcnt lgkmcnt(3)
v_mfma_f32_32x32x16_bf16 v[16:31], v[160:163], v[144:147], v[16:31]
v_exp_f32 v138, v138
v_exp_f32 v139, v139
v_exp_f32 v140, v140
v_mfma_f32_16x16x32_bf16 v[32:35], v[212:215], v[144:147], v[32:35]
s_cmp_eq_u32 s65, 1
v_exp_f32 v141, v141
v_exp_f32 v142, v142
v_exp_f32 v143, v143
v_cvt_pk_bf16_f32 v148, v136, v137
v_cvt_pk_bf16_f32 v149, v138, v139
v_cvt_pk_bf16_f32 v150, v140, v141
v_cvt_pk_bf16_f32 v151, v142, v143
s_cbranch_scc1 at_147
.p2align 3
v_exp_f32 v112, v112
v_exp_f32 v113, v113
s_waitcnt lgkmcnt(2)
v_mfma_f32_32x32x16_bf16 v[16:31], v[164:167], v[148:151], v[16:31]
v_exp_f32 v114, v114
v_exp_f32 v115, v115
v_exp_f32 v116, v116
v_mfma_f32_16x16x32_bf16 v[32:35], v[212:215], v[148:151], v[32:35]
v_exp_f32 v117, v117
s_waitcnt lgkmcnt(1)
v_mfma_f32_32x32x16_bf16 v[128:143], v[152:155], v[80:83], 0
v_exp_f32 v118, v118
v_exp_f32 v119, v119
v_cvt_pk_bf16_f32 v144, v112, v113
v_cvt_pk_bf16_f32 v145, v114, v115
s_waitcnt lgkmcnt(0)
v_mfma_f32_32x32x16_bf16 v[128:143], v[156:159], v[88:91], v[128:143]
v_subrev_u32 v8, 8192, v8
ds_read_b128 v[152:155], v8 offset:0
ds_read_b128 v[156:159], v8 offset:1024
v_cvt_pk_bf16_f32 v146, v116, v117
v_cvt_pk_bf16_f32 v147, v118, v119
v_exp_f32 v120, v120
v_exp_f32 v121, v121
v_mfma_f32_32x32x16_bf16 v[192:207], v[160:163], v[144:147], v[192:207]
ds_read_b128 v[160:163], v8 offset:10240
v_exp_f32 v122, v122
v_exp_f32 v123, v123
v_exp_f32 v124, v124
v_mfma_f32_16x16x32_bf16 v[208:211], v[212:215], v[144:147], v[208:211]
v_exp_f32 v125, v125
v_exp_f32 v126, v126
v_exp_f32 v127, v127
v_cvt_pk_bf16_f32 v148, v120, v121
v_cvt_pk_bf16_f32 v149, v122, v123
v_cvt_pk_bf16_f32 v150, v124, v125
v_cvt_pk_bf16_f32 v151, v126, v127
v_exp_f32 v128, v128
v_exp_f32 v129, v129
v_mfma_f32_32x32x16_bf16 v[192:207], v[164:167], v[148:151], v[192:207]
ds_read_b128 v[164:167], v8 offset:11264
v_exp_f32 v130, v130
v_exp_f32 v131, v131
v_exp_f32 v132, v132
v_mfma_f32_16x16x32_bf16 v[208:211], v[212:215], v[148:151], v[208:211]
v_exp_f32 v133, v133
s_waitcnt lgkmcnt(3)
v_mfma_f32_32x32x16_bf16 v[112:127], v[152:155], v[80:83], 0
v_exp_f32 v134, v134
v_exp_f32 v135, v135
v_cvt_pk_bf16_f32 v144, v128, v129
v_cvt_pk_bf16_f32 v145, v130, v131
s_waitcnt lgkmcnt(2)
v_mfma_f32_32x32x16_bf16 v[112:127], v[156:159], v[88:91], v[112:127]
v_subrev_u32 v8, 8192, v8
ds_read_b128 v[152:155], v8 offset:0
ds_read_b128 v[156:159], v8 offset:1024
v_cvt_pk_bf16_f32 v146, v132, v133
v_cvt_pk_bf16_f32 v147, v134, v135
v_exp_f32 v136, v136
v_exp_f32 v137, v137
s_waitcnt lgkmcnt(3)
v_mfma_f32_32x32x16_bf16 v[192:207], v[160:163], v[144:147], v[192:207]
ds_read_b128 v[160:163], v8 offset:10240
v_exp_f32 v138, v138
v_exp_f32 v139, v139
v_exp_f32 v140, v140
v_mfma_f32_16x16x32_bf16 v[208:211], v[212:215], v[144:147], v[208:211]
v_exp_f32 v141, v141
v_exp_f32 v142, v142
v_exp_f32 v143, v143
v_cvt_pk_bf16_f32 v148, v136, v137
v_cvt_pk_bf16_f32 v149, v138, v139
v_cvt_pk_bf16_f32 v150, v140, v141
v_cvt_pk_bf16_f32 v151, v142, v143
v_exp_f32 v112, v112
v_exp_f32 v113, v113
s_waitcnt lgkmcnt(3)
v_mfma_f32_32x32x16_bf16 v[192:207], v[164:167], v[148:151], v[192:207]
ds_read_b128 v[164:167], v8 offset:11264
v_exp_f32 v114, v114
v_exp_f32 v115, v115
v_exp_f32 v116, v116
v_mfma_f32_16x16x32_bf16 v[208:211], v[212:215], v[148:151], v[208:211]
v_exp_f32 v117, v117
s_waitcnt lgkmcnt(3)
v_mfma_f32_32x32x16_bf16 v[128:143], v[152:155], v[80:83], v[216:231]
v_exp_f32 v118, v118
v_exp_f32 v119, v119
v_cvt_pk_bf16_f32 v144, v112, v113
v_cvt_pk_bf16_f32 v145, v114, v115
s_waitcnt lgkmcnt(2)
v_mfma_f32_32x32x16_bf16 v[128:143], v[156:159], v[88:91], v[128:143]
v_cvt_pk_bf16_f32 v146, v116, v117
v_cvt_pk_bf16_f32 v147, v118, v119
v_exp_f32 v120, v120
v_exp_f32 v121, v121
s_waitcnt lgkmcnt(1)
v_mfma_f32_32x32x16_bf16 v[192:207], v[160:163], v[144:147], v[192:207]
ds_read_b128 v[160:163], v8 offset:2048
v_exp_f32 v122, v122
v_exp_f32 v123, v123
v_exp_f32 v124, v124
v_mfma_f32_16x16x32_bf16 v[208:211], v[212:215], v[144:147], v[208:211]
v_exp_f32 v125, v125
v_exp_f32 v126, v126
v_exp_f32 v127, v127
v_cvt_pk_bf16_f32 v148, v120, v121
v_cvt_pk_bf16_f32 v149, v122, v123
v_cvt_pk_bf16_f32 v150, v124, v125
v_cvt_pk_bf16_f32 v151, v126, v127
s_branch at_149
.p2align 3
at_148:
v_add_u32 v5, s34, 20
s_mov_b64 exec, 1
ds_write_b32 v3, v5
s_mov_b64 exec, -1
v_exp_f32 v112, v112
v_exp_f32 v113, v113
s_waitcnt lgkmcnt(3)
v_mfma_f32_32x32x16_bf16 v[16:31], v[164:167], v[148:151], v[16:31]
v_exp_f32 v114, v114
v_exp_f32 v115, v115
v_exp_f32 v116, v116
v_mfma_f32_16x16x32_bf16 v[32:35], v[212:215], v[148:151], v[32:35]
v_exp_f32 v117, v117
v_exp_f32 v118, v118
v_exp_f32 v119, v119
v_cvt_pk_bf16_f32 v144, v112, v113
v_cvt_pk_bf16_f32 v145, v114, v115
v_cvt_pk_bf16_f32 v146, v116, v117
v_cvt_pk_bf16_f32 v147, v118, v119
v_exp_f32 v120, v120
v_exp_f32 v121, v121
v_mfma_f32_32x32x16_bf16 v[192:207], v[160:163], v[144:147], v[192:207]
v_exp_f32 v122, v122
v_exp_f32 v123, v123
v_exp_f32 v124, v124
v_mfma_f32_16x16x32_bf16 v[208:211], v[212:215], v[144:147], v[208:211]
v_exp_f32 v125, v125
v_exp_f32 v126, v126
v_exp_f32 v127, v127
v_cvt_pk_bf16_f32 v148, v120, v121
v_cvt_pk_bf16_f32 v149, v122, v123
v_cvt_pk_bf16_f32 v150, v124, v125
v_cvt_pk_bf16_f32 v151, v126, v127
s_branch at_150
.p2align 3
at_147:
v_exp_f32 v112, v112
v_exp_f32 v113, v113
s_waitcnt lgkmcnt(2)
v_mfma_f32_32x32x16_bf16 v[16:31], v[164:167], v[148:151], v[16:31]
v_exp_f32 v114, v114
v_exp_f32 v115, v115
v_exp_f32 v116, v116
v_mfma_f32_16x16x32_bf16 v[32:35], v[212:215], v[148:151], v[32:35]
v_exp_f32 v117, v117
s_waitcnt lgkmcnt(1)
v_mfma_f32_32x32x16_bf16 v[128:143], v[152:155], v[80:83], v[216:231]
v_exp_f32 v118, v118
v_exp_f32 v119, v119
v_cvt_pk_bf16_f32 v144, v112, v113
v_cvt_pk_bf16_f32 v145, v114, v115
s_waitcnt lgkmcnt(0)
v_mfma_f32_32x32x16_bf16 v[128:143], v[156:159], v[88:91], v[128:143]
v_cvt_pk_bf16_f32 v146, v116, v117
v_cvt_pk_bf16_f32 v147, v118, v119
v_exp_f32 v120, v120
v_exp_f32 v121, v121
v_mfma_f32_32x32x16_bf16 v[192:207], v[160:163], v[144:147], v[192:207]
ds_read_b128 v[160:163], v8 offset:2048
v_exp_f32 v122, v122
v_exp_f32 v123, v123
v_exp_f32 v124, v124
v_mfma_f32_16x16x32_bf16 v[208:211], v[212:215], v[144:147], v[208:211]
v_exp_f32 v125, v125
v_exp_f32 v126, v126
v_exp_f32 v127, v127
v_cvt_pk_bf16_f32 v148, v120, v121
v_cvt_pk_bf16_f32 v149, v122, v123
v_cvt_pk_bf16_f32 v150, v124, v125
v_cvt_pk_bf16_f32 v151, v126, v127
.p2align 3
at_149:
v_exp_f32 v128, v128
v_exp_f32 v129, v129
s_waitcnt lgkmcnt(1)
v_mfma_f32_32x32x16_bf16 v[192:207], v[164:167], v[148:151], v[192:207]
ds_read_b128 v[164:167], v8 offset:3072
v_exp_f32 v130, v130
v_exp_f32 v131, v131
v_exp_f32 v132, v132
v_mfma_f32_16x16x32_bf16 v[208:211], v[212:215], v[148:151], v[208:211]
v_exp_f32 v133, v133
v_exp_f32 v134, v134
v_exp_f32 v135, v135
v_cvt_pk_bf16_f32 v144, v128, v129
v_cvt_pk_bf16_f32 v145, v130, v131
v_add_u32 v5, s34, 20
s_mov_b64 exec, 1
ds_write_b32 v3, v5
s_mov_b64 exec, -1
v_cvt_pk_bf16_f32 v146, v132, v133
v_cvt_pk_bf16_f32 v147, v134, v135
v_exp_f32 v136, v136
v_exp_f32 v137, v137
s_waitcnt lgkmcnt(2)
v_mfma_f32_32x32x16_bf16 v[192:207], v[160:163], v[144:147], v[192:207]
v_exp_f32 v138, v138
v_exp_f32 v139, v139
v_exp_f32 v140, v140
v_mfma_f32_16x16x32_bf16 v[208:211], v[212:215], v[144:147], v[208:211]
v_exp_f32 v141, v141
v_exp_f32 v142, v142
v_exp_f32 v143, v143
v_cvt_pk_bf16_f32 v148, v136, v137
v_cvt_pk_bf16_f32 v149, v138, v139
v_cvt_pk_bf16_f32 v150, v140, v141
v_cvt_pk_bf16_f32 v151, v142, v143
at_150:
s_lshl_b32 s66, s59, 18
s_lshl_b32 s67, s63, 22
v_mfma_f32_16x16x32_bf16 v[208:211], v[212:215], v[148:151], v[208:211]
s_add_u32 s66, s66, s67
s_lshl1_add_u32 s67, s60, s64
s_waitcnt lgkmcnt(1)
v_mfma_f32_32x32x16_bf16 v[192:207], v[164:167], v[148:151], v[192:207]
s_lshl_b32 s67, s67, 11
s_add_u32 s66, s66, s67
s_lshl_b32 s68, s65, 16
s_add_u32 s67, s66, 18022400
s_sub_u32 s67, s67, s68
s_add_u32 s66, s66, s68
s_add_u32 s66, s66, 17825792
v_lshlrev_b32 v9, 4, v0
v_subrev_u32 v10, 0x2f800000, v32
v_subrev_u32 v11, 0x2f800000, v208
v_max_u32 v10, v10, v11
v_cmp_lt_u32 vcc, 0x20000000, v10
s_cbranch_vccnz slow_155
sback_156:
s_nop 1
v_rcp_f32 v12, v32
s_nop 1
v_pk_mul_f32 v[16:17], v[16:17], v[12:13] op_sel:[0,0] op_sel_hi:[1,0]
v_pk_mul_f32 v[18:19], v[18:19], v[12:13] op_sel:[0,0] op_sel_hi:[1,0]
v_pk_mul_f32 v[20:21], v[20:21], v[12:13] op_sel:[0,0] op_sel_hi:[1,0]
v_pk_mul_f32 v[22:23], v[22:23], v[12:13] op_sel:[0,0] op_sel_hi:[1,0]
v_pk_mul_f32 v[24:25], v[24:25], v[12:13] op_sel:[0,0] op_sel_hi:[1,0]
v_pk_mul_f32 v[26:27], v[26:27], v[12:13] op_sel:[0,0] op_sel_hi:[1,0]
v_pk_mul_f32 v[28:29], v[28:29], v[12:13] op_sel:[0,0] op_sel_hi:[1,0]
v_pk_mul_f32 v[30:31], v[30:31], v[12:13] op_sel:[0,0] op_sel_hi:[1,0]
v_cvt_pk_bf16_f32 v16, v16, v17
v_cvt_pk_bf16_f32 v17, v18, v19
v_cvt_pk_bf16_f32 v18, v20, v21
v_cvt_pk_bf16_f32 v19, v22, v23
v_cvt_pk_bf16_f32 v20, v24, v25
v_cvt_pk_bf16_f32 v21, v26, v27
v_cvt_pk_bf16_f32 v22, v28, v29
v_cvt_pk_bf16_f32 v23, v30, v31
s_cmp_eq_u32 s57, 0
s_cbranch_scc1 far_157
buffer_store_dwordx4 v[16:19], v9, s[20:23], s67 offen offset:0
buffer_store_dwordx4 v[20:23], v9, s[20:23], s67 offen offset:1024
near_158:
v_rcp_f32 v12, v208
s_nop 0
v_pk_mul_f32 v[192:193], v[192:193], v[12:13] op_sel:[0,0] op_sel_hi:[1,0]
v_pk_mul_f32 v[194:195], v[194:195], v[12:13] op_sel:[0,0] op_sel_hi:[1,0]
v_pk_mul_f32 v[196:197], v[196:197], v[12:13] op_sel:[0,0] op_sel_hi:[1,0]
v_pk_mul_f32 v[198:199], v[198:199], v[12:13] op_sel:[0,0] op_sel_hi:[1,0]
v_pk_mul_f32 v[200:201], v[200:201], v[12:13] op_sel:[0,0] op_sel_hi:[1,0]
v_pk_mul_f32 v[202:203], v[202:203], v[12:13] op_sel:[0,0] op_sel_hi:[1,0]
v_pk_mul_f32 v[204:205], v[204:205], v[12:13] op_sel:[0,0] op_sel_hi:[1,0]
v_pk_mul_f32 v[206:207], v[206:207], v[12:13] op_sel:[0,0] op_sel_hi:[1,0]
v_cvt_pk_bf16_f32 v192, v192, v193
v_cvt_pk_bf16_f32 v193, v194, v195
v_cvt_pk_bf16_f32 v194, v196, v197
v_cvt_pk_bf16_f32 v195, v198, v199
v_cvt_pk_bf16_f32 v196, v200, v201
v_cvt_pk_bf16_f32 v197, v202, v203
v_cvt_pk_bf16_f32 v198, v204, v205
v_cvt_pk_bf16_f32 v199, v206, v207
s_cmp_eq_u32 s57, 0
s_cbranch_scc1 far_159
buffer_store_dwordx4 v[192:195], v9, s[20:23], s66 offen offset:0
buffer_store_dwordx4 v[196:199], v9, s[20:23], s66 offen offset:1024
near_160:
v_bfe_u32 v48, v0, 2, 3
v_lshrrev_b32 v49, 5, v0
v_lshl_add_u32 v48, v49, 4, v48
v_lshlrev_b32 v48, 7, v48
v_bfe_u32 v49, v0, 3, 2
v_lshl_add_u32 v48, v49, 5, v48
v_and_b32 v49, 3, v0
v_lshl_add_u32 v48, v49, 3, v48
v_add_u32 v8, 32768, v48
v_xor_b32 v9, 32, v8
v_xor_b32 v10, 64, v8
v_xor_b32 v11, 96, v8
v_add_u32 v12, 0x10000, v8
v_add_u32 v13, 0x10000, v9
v_add_u32 v14, 0x10000, v10
v_add_u32 v15, 0x10000, v11
v_and_b32 v48, 15, v0
v_lshrrev_b32 v49, 4, v0
s_lshl2_add_u32 s66, s61, s58
s_lshl_b32 s67, s66, 16
s_lshl_b32 s68, s63, 22
s_add_u32 s67, s67, s68
s_add_u32 s67, s67, 17825792
v_lshl_add_u32 v6, v48, 4, s67
v_lshl_add_u32 v6, v49, 9, v6
s_add_u32 s70, s72, 268288
s_add_u32 s35, s34, 3
lw_161:
ds_read_b32 v5, v2 offset:24
s_waitcnt lgkmcnt(0)
v_cmp_gt_i32 vcc, s35, v5
s_cbranch_vccz lwd_162
s_sub_u32 s32, s32, 1
s_cmp_gt_i32 s32, 0
s_cbranch_scc1 lw_161
lwd_162:
s_mov_b64 exec, 1
s_waitcnt vmcnt(0)
s_cmp_eq_u32 s57, 0
s_cbranch_scc1 far_163
buffer_store_dword v212, v3, s[24:27], s70 offen
near_164:
s_mov_b64 exec, -1
v_add_u32 v5, s34, 21
s_mov_b64 exec, 1
ds_write_b32 v3, v5
s_mov_b64 exec, -1
s_cmp_eq_u32 s63, 0
s_cbranch_scc0 mo_165
v_permlane16_swap_b32 v240, v242
v_permlane16_swap_b32 v241, v243
v_permlane16_swap_b32 v244, v246
v_permlane16_swap_b32 v245, v247
v_permlane16_swap_b32 v248, v250
v_permlane16_swap_b32 v249, v251
v_permlane16_swap_b32 v252, v254
v_permlane16_swap_b32 v253, v255
mo_166:
v_lshlrev_b32 v16, 16, v240
v_and_b32 v17, 0xffff0000, v240
v_lshlrev_b32 v18, 16, v241
v_and_b32 v19, 0xffff0000, v241
v_lshlrev_b32 v20, 16, v242
v_and_b32 v21, 0xffff0000, v242
v_lshlrev_b32 v22, 16, v243
v_and_b32 v23, 0xffff0000, v243
v_lshlrev_b32 v24, 16, v244
v_and_b32 v25, 0xffff0000, v244
v_lshlrev_b32 v26, 16, v245
v_and_b32 v27, 0xffff0000, v245
v_lshlrev_b32 v28, 16, v246
v_and_b32 v29, 0xffff0000, v246
v_lshlrev_b32 v30, 16, v247
v_and_b32 v31, 0xffff0000, v247
v_lshlrev_b32 v32, 16, v248
v_and_b32 v33, 0xffff0000, v248
v_lshlrev_b32 v34, 16, v249
v_and_b32 v35, 0xffff0000, v249
v_lshlrev_b32 v36, 16, v250
v_and_b32 v37, 0xffff0000, v250
v_lshlrev_b32 v38, 16, v251
v_and_b32 v39, 0xffff0000, v251
v_lshlrev_b32 v40, 16, v252
v_and_b32 v41, 0xffff0000, v252
v_lshlrev_b32 v42, 16, v253
v_and_b32 v43, 0xffff0000, v253
v_lshlrev_b32 v44, 16, v254
v_and_b32 v45, 0xffff0000, v254
v_lshlrev_b32 v46, 16, v255
v_and_b32 v47, 0xffff0000, v255
s_add_u32 s66, s61, s62
s_and_b32 s66, s66, 15
s_lshl_b32 s66, s66, 12
s_add_u32 s35, s34, 22
lw_167:
ds_read_b32 v5, v2 offset:16
s_waitcnt lgkmcnt(0)
v_cmp_gt_i32 vcc, s35, v5
s_cbranch_vccz lwd_168
s_sub_u32 s32, s32, 1
s_cmp_gt_i32 s32, 0
s_cbranch_scc1 lw_167
lwd_168:
buffer_load_dwordx4 v[80:83], v6, s[20:23], s66 offen offset:0 sc1
buffer_load_dwordx4 v[88:91], v6, s[20:23], s66 offen offset:2048 sc1
buffer_load_dwordx4 v[84:87], v6, s[20:23], s66 offen offset:256 sc1
buffer_load_dwordx4 v[92:95], v6, s[20:23], s66 offen offset:2304 sc1
s_add_u32 s66, s66, 4096
s_and_b32 s66, s66, 0xffff
ds_read_b64_tr_b16 v[48:49], v8 offset:0
ds_read_b64_tr_b16 v[50:51], v8 offset:1024
ds_read_b64_tr_b16 v[52:53], v8 offset:4096
ds_read_b64_tr_b16 v[54:55], v8 offset:5120
buffer_load_dwordx4 v[96:99], v6, s[20:23], s66 offen offset:0 sc1
buffer_load_dwordx4 v[104:107], v6, s[20:23], s66 offen offset:2048 sc1
buffer_load_dwordx4 v[100:103], v6, s[20:23], s66 offen offset:256 sc1
buffer_load_dwordx4 v[108:111], v6, s[20:23], s66 offen offset:2304 sc1
s_add_u32 s66, s66, 4096
s_and_b32 s66, s66, 0xffff
ds_read_b64_tr_b16 v[56:57], v9 offset:0
ds_read_b64_tr_b16 v[58:59], v9 offset:1024
ds_read_b64_tr_b16 v[60:61], v9 offset:4096
ds_read_b64_tr_b16 v[62:63], v9 offset:5120
buffer_load_dwordx4 v[112:115], v6, s[20:23], s66 offen offset:0 sc1
buffer_load_dwordx4 v[120:123], v6, s[20:23], s66 offen offset:2048 sc1
buffer_load_dwordx4 v[116:119], v6, s[20:23], s66 offen offset:256 sc1
buffer_load_dwordx4 v[124:127], v6, s[20:23], s66 offen offset:2304 sc1
s_add_u32 s66, s66, 4096
s_and_b32 s66, s66, 0xffff
ds_read_b64_tr_b16 v[64:65], v10 offset:0
ds_read_b64_tr_b16 v[66:67], v10 offset:1024
ds_read_b64_tr_b16 v[68:69], v10 offset:4096
ds_read_b64_tr_b16 v[70:71], v10 offset:5120
buffer_load_dwordx4 v[128:131], v6, s[20:23], s66 offen offset:0 sc1
buffer_load_dwordx4 v[136:139], v6, s[20:23], s66 offen offset:2048 sc1
buffer_load_dwordx4 v[132:135], v6, s[20:23], s66 offen offset:256 sc1
buffer_load_dwordx4 v[140:143], v6, s[20:23], s66 offen offset:2304 sc1
s_add_u32 s66, s66, 4096
s_and_b32 s66, s66, 0xffff
buffer_load_dwordx4 v[144:147], v6, s[20:23], s66 offen offset:0 sc1
buffer_load_dwordx4 v[152:155], v6, s[20:23], s66 offen offset:2048 sc1
buffer_load_dwordx4 v[148:151], v6, s[20:23], s66 offen offset:256 sc1
buffer_load_dwordx4 v[156:159], v6, s[20:23], s66 offen offset:2304 sc1
s_add_u32 s66, s66, 4096
s_and_b32 s66, s66, 0xffff
buffer_load_dwordx4 v[160:163], v6, s[20:23], s66 offen offset:0 sc1
buffer_load_dwordx4 v[168:171], v6, s[20:23], s66 offen offset:2048 sc1
buffer_load_dwordx4 v[164:167], v6, s[20:23], s66 offen offset:256 sc1
buffer_load_dwordx4 v[172:175], v6, s[20:23], s66 offen offset:2304 sc1
s_add_u32 s66, s66, 4096
s_and_b32 s66, s66, 0xffff
buffer_load_dwordx4 v[176:179], v6, s[20:23], s66 offen offset:0 sc1
buffer_load_dwordx4 v[184:187], v6, s[20:23], s66 offen offset:2048 sc1
buffer_load_dwordx4 v[180:183], v6, s[20:23], s66 offen offset:256 sc1
buffer_load_dwordx4 v[188:191], v6, s[20:23], s66 offen offset:2304 sc1
s_add_u32 s66, s66, 4096
s_and_b32 s66, s66, 0xffff
buffer_load_dwordx4 v[192:195], v6, s[20:23], s66 offen offset:0 sc1
buffer_load_dwordx4 v[200:203], v6, s[20:23], s66 offen offset:2048 sc1
buffer_load_dwordx4 v[196:199], v6, s[20:23], s66 offen offset:256 sc1
buffer_load_dwordx4 v[204:207], v6, s[20:23], s66 offen offset:2304 sc1
s_add_u32 s66, s66, 4096
s_and_b32 s66, s66, 0xffff
.p2align 3
s_waitcnt vmcnt(31) lgkmcnt(10)
v_mfma_f32_16x16x32_bf16 v[16:19], v[48:51], v[80:83], v[16:19]
ds_read_b64_tr_b16 v[72:73], v11 offset:0
s_waitcnt vmcnt(30) lgkmcnt(9)
v_mfma_f32_16x16x32_bf16 v[16:19], v[52:55], v[88:91], v[16:19]
ds_read_b64_tr_b16 v[74:75], v11 offset:1024
s_waitcnt vmcnt(29)
v_mfma_f32_16x16x32_bf16 v[32:35], v[48:51], v[84:87], v[32:35]
ds_read_b64_tr_b16 v[76:77], v11 offset:4096
s_waitcnt vmcnt(28)
v_mfma_f32_16x16x32_bf16 v[32:35], v[52:55], v[92:95], v[32:35]
ds_read_b64_tr_b16 v[78:79], v11 offset:5120
s_waitcnt lgkmcnt(10)
v_mfma_f32_16x16x32_bf16 v[20:23], v[56:59], v[80:83], v[20:23]
ds_read_b64_tr_b16 v[48:49], v8 offset:8192
s_waitcnt lgkmcnt(9)
v_mfma_f32_16x16x32_bf16 v[20:23], v[60:63], v[88:91], v[20:23]
ds_read_b64_tr_b16 v[50:51], v8 offset:9216
v_mfma_f32_16x16x32_bf16 v[36:39], v[56:59], v[84:87], v[36:39]
ds_read_b64_tr_b16 v[52:53], v8 offset:12288
v_mfma_f32_16x16x32_bf16 v[36:39], v[60:63], v[92:95], v[36:39]
ds_read_b64_tr_b16 v[54:55], v8 offset:13312
s_waitcnt lgkmcnt(10)
v_mfma_f32_16x16x32_bf16 v[24:27], v[64:67], v[80:83], v[24:27]
ds_read_b64_tr_b16 v[56:57], v9 offset:8192
s_waitcnt lgkmcnt(9)
v_mfma_f32_16x16x32_bf16 v[24:27], v[68:71], v[88:91], v[24:27]
ds_read_b64_tr_b16 v[58:59], v9 offset:9216
v_mfma_f32_16x16x32_bf16 v[40:43], v[64:67], v[84:87], v[40:43]
ds_read_b64_tr_b16 v[60:61], v9 offset:12288
v_mfma_f32_16x16x32_bf16 v[40:43], v[68:71], v[92:95], v[40:43]
ds_read_b64_tr_b16 v[62:63], v9 offset:13312
s_waitcnt lgkmcnt(10)
v_mfma_f32_16x16x32_bf16 v[28:31], v[72:75], v[80:83], v[28:31]
ds_read_b64_tr_b16 v[64:65], v10 offset:8192
s_waitcnt lgkmcnt(9)
v_mfma_f32_16x16x32_bf16 v[28:31], v[76:79], v[88:91], v[28:31]
ds_read_b64_tr_b16 v[66:67], v10 offset:9216
v_mfma_f32_16x16x32_bf16 v[44:47], v[72:75], v[84:87], v[44:47]
ds_read_b64_tr_b16 v[68:69], v10 offset:12288
v_mfma_f32_16x16x32_bf16 v[44:47], v[76:79], v[92:95], v[44:47]
ds_read_b64_tr_b16 v[70:71], v10 offset:13312
s_waitcnt vmcnt(27) lgkmcnt(10)
v_mfma_f32_16x16x32_bf16 v[16:19], v[48:51], v[96:99], v[16:19]
ds_read_b64_tr_b16 v[72:73], v11 offset:8192
buffer_load_dwordx4 v[80:83], v6, s[20:23], s66 offen offset:0 sc1
s_waitcnt vmcnt(27) lgkmcnt(9)
v_mfma_f32_16x16x32_bf16 v[16:19], v[52:55], v[104:107], v[16:19]
ds_read_b64_tr_b16 v[74:75], v11 offset:9216
buffer_load_dwordx4 v[88:91], v6, s[20:23], s66 offen offset:2048 sc1
s_waitcnt vmcnt(27)
v_mfma_f32_16x16x32_bf16 v[32:35], v[48:51], v[100:103], v[32:35]
ds_read_b64_tr_b16 v[76:77], v11 offset:12288
buffer_load_dwordx4 v[84:87], v6, s[20:23], s66 offen offset:256 sc1
s_waitcnt vmcnt(27)
v_mfma_f32_16x16x32_bf16 v[32:35], v[52:55], v[108:111], v[32:35]
ds_read_b64_tr_b16 v[78:79], v11 offset:13312
buffer_load_dwordx4 v[92:95], v6, s[20:23], s66 offen offset:2304 sc1
s_waitcnt lgkmcnt(10)
v_mfma_f32_16x16x32_bf16 v[20:23], v[56:59], v[96:99], v[20:23]
ds_read_b64_tr_b16 v[48:49], v8 offset:16384
s_add_u32 s66, s66, 4096
s_and_b32 s66, s66, 0xffff
s_waitcnt lgkmcnt(9)
v_mfma_f32_16x16x32_bf16 v[20:23], v[60:63], v[104:107], v[20:23]
ds_read_b64_tr_b16 v[50:51], v8 offset:17408
v_mfma_f32_16x16x32_bf16 v[36:39], v[56:59], v[100:103], v[36:39]
ds_read_b64_tr_b16 v[52:53], v8 offset:20480
v_mfma_f32_16x16x32_bf16 v[36:39], v[60:63], v[108:111], v[36:39]
ds_read_b64_tr_b16 v[54:55], v8 offset:21504
s_waitcnt lgkmcnt(10)
v_mfma_f32_16x16x32_bf16 v[24:27], v[64:67], v[96:99], v[24:27]
ds_read_b64_tr_b16 v[56:57], v9 offset:16384
s_waitcnt lgkmcnt(9)
v_mfma_f32_16x16x32_bf16 v[24:27], v[68:71], v[104:107], v[24:27]
ds_read_b64_tr_b16 v[58:59], v9 offset:17408
v_mfma_f32_16x16x32_bf16 v[40:43], v[64:67], v[100:103], v[40:43]
ds_read_b64_tr_b16 v[60:61], v9 offset:20480
v_mfma_f32_16x16x32_bf16 v[40:43], v[68:71], v[108:111], v[40:43]
ds_read_b64_tr_b16 v[62:63], v9 offset:21504
s_waitcnt lgkmcnt(10)
v_mfma_f32_16x16x32_bf16 v[28:31], v[72:75], v[96:99], v[28:31]
ds_read_b64_tr_b16 v[64:65], v10 offset:16384
s_waitcnt lgkmcnt(9)
v_mfma_f32_16x16x32_bf16 v[28:31], v[76:79], v[104:107], v[28:31]
ds_read_b64_tr_b16 v[66:67], v10 offset:17408
v_mfma_f32_16x16x32_bf16 v[44:47], v[72:75], v[100:103], v[44:47]
ds_read_b64_tr_b16 v[68:69], v10 offset:20480
v_mfma_f32_16x16x32_bf16 v[44:47], v[76:79], v[108:111], v[44:47]
ds_read_b64_tr_b16 v[70:71], v10 offset:21504
s_waitcnt vmcnt(27) lgkmcnt(10)
v_mfma_f32_16x16x32_bf16 v[16:19], v[48:51], v[112:115], v[16:19]
ds_read_b64_tr_b16 v[72:73], v11 offset:16384
buffer_load_dwordx4 v[96:99], v6, s[20:23], s66 offen offset:0 sc1
s_waitcnt vmcnt(27) lgkmcnt(9)
v_mfma_f32_16x16x32_bf16 v[16:19], v[52:55], v[120:123], v[16:19]
ds_read_b64_tr_b16 v[74:75], v11 offset:17408
buffer_load_dwordx4 v[104:107], v6, s[20:23], s66 offen offset:2048 sc1
s_waitcnt vmcnt(27)
v_mfma_f32_16x16x32_bf16 v[32:35], v[48:51], v[116:119], v[32:35]
ds_read_b64_tr_b16 v[76:77], v11 offset:20480
buffer_load_dwordx4 v[100:103], v6, s[20:23], s66 offen offset:256 sc1
s_waitcnt vmcnt(27)
v_mfma_f32_16x16x32_bf16 v[32:35], v[52:55], v[124:127], v[32:35]
ds_read_b64_tr_b16 v[78:79], v11 offset:21504
buffer_load_dwordx4 v[108:111], v6, s[20:23], s66 offen offset:2304 sc1
s_waitcnt lgkmcnt(10)
v_mfma_f32_16x16x32_bf16 v[20:23], v[56:59], v[112:115], v[20:23]
ds_read_b64_tr_b16 v[48:49], v8 offset:24576
s_add_u32 s66, s66, 4096
s_and_b32 s66, s66, 0xffff
s_waitcnt lgkmcnt(9)
v_mfma_f32_16x16x32_bf16 v[20:23], v[60:63], v[120:123], v[20:23]
ds_read_b64_tr_b16 v[50:51], v8 offset:25600
v_mfma_f32_16x16x32_bf16 v[36:39], v[56:59], v[116:119], v[36:39]
ds_read_b64_tr_b16 v[52:53], v8 offset:28672
v_mfma_f32_16x16x32_bf16 v[36:39], v[60:63], v[124:127], v[36:39]
ds_read_b64_tr_b16 v[54:55], v8 offset:29696
s_waitcnt lgkmcnt(10)
v_mfma_f32_16x16x32_bf16 v[24:27], v[64:67], v[112:115], v[24:27]
ds_read_b64_tr_b16 v[56:57], v9 offset:24576
s_waitcnt lgkmcnt(9)
v_mfma_f32_16x16x32_bf16 v[24:27], v[68:71], v[120:123], v[24:27]
ds_read_b64_tr_b16 v[58:59], v9 offset:25600
v_mfma_f32_16x16x32_bf16 v[40:43], v[64:67], v[116:119], v[40:43]
ds_read_b64_tr_b16 v[60:61], v9 offset:28672
v_mfma_f32_16x16x32_bf16 v[40:43], v[68:71], v[124:127], v[40:43]
ds_read_b64_tr_b16 v[62:63], v9 offset:29696
s_waitcnt lgkmcnt(10)
v_mfma_f32_16x16x32_bf16 v[28:31], v[72:75], v[112:115], v[28:31]
ds_read_b64_tr_b16 v[64:65], v10 offset:24576
s_waitcnt lgkmcnt(9)
v_mfma_f32_16x16x32_bf16 v[28:31], v[76:79], v[120:123], v[28:31]
ds_read_b64_tr_b16 v[66:67], v10 offset:25600
v_mfma_f32_16x16x32_bf16 v[44:47], v[72:75], v[116:119], v[44:47]
ds_read_b64_tr_b16 v[68:69], v10 offset:28672
v_mfma_f32_16x16x32_bf16 v[44:47], v[76:79], v[124:127], v[44:47]
ds_read_b64_tr_b16 v[70:71], v10 offset:29696
s_waitcnt vmcnt(27) lgkmcnt(10)
v_mfma_f32_16x16x32_bf16 v[16:19], v[48:51], v[128:131], v[16:19]
ds_read_b64_tr_b16 v[72:73], v11 offset:24576
buffer_load_dwordx4 v[112:115], v6, s[20:23], s66 offen offset:0 sc1
s_waitcnt vmcnt(27) lgkmcnt(9)
v_mfma_f32_16x16x32_bf16 v[16:19], v[52:55], v[136:139], v[16:19]
ds_read_b64_tr_b16 v[74:75], v11 offset:25600
buffer_load_dwordx4 v[120:123], v6, s[20:23], s66 offen offset:2048 sc1
s_waitcnt vmcnt(27)
v_mfma_f32_16x16x32_bf16 v[32:35], v[48:51], v[132:135], v[32:35]
ds_read_b64_tr_b16 v[76:77], v11 offset:28672
buffer_load_dwordx4 v[116:119], v6, s[20:23], s66 offen offset:256 sc1
s_waitcnt vmcnt(27)
v_mfma_f32_16x16x32_bf16 v[32:35], v[52:55], v[140:143], v[32:35]
ds_read_b64_tr_b16 v[78:79], v11 offset:29696
buffer_load_dwordx4 v[124:127], v6, s[20:23], s66 offen offset:2304 sc1
s_waitcnt lgkmcnt(10)
v_mfma_f32_16x16x32_bf16 v[20:23], v[56:59], v[128:131], v[20:23]
ds_read_b64_tr_b16 v[48:49], v8 offset:32768
s_add_u32 s66, s66, 4096
s_and_b32 s66, s66, 0xffff
s_waitcnt lgkmcnt(9)
v_mfma_f32_16x16x32_bf16 v[20:23], v[60:63], v[136:139], v[20:23]
ds_read_b64_tr_b16 v[50:51], v8 offset:33792
v_mfma_f32_16x16x32_bf16 v[36:39], v[56:59], v[132:135], v[36:39]
ds_read_b64_tr_b16 v[52:53], v8 offset:36864
v_mfma_f32_16x16x32_bf16 v[36:39], v[60:63], v[140:143], v[36:39]
ds_read_b64_tr_b16 v[54:55], v8 offset:37888
s_waitcnt lgkmcnt(10)
v_mfma_f32_16x16x32_bf16 v[24:27], v[64:67], v[128:131], v[24:27]
ds_read_b64_tr_b16 v[56:57], v9 offset:32768
s_waitcnt lgkmcnt(9)
v_mfma_f32_16x16x32_bf16 v[24:27], v[68:71], v[136:139], v[24:27]
ds_read_b64_tr_b16 v[58:59], v9 offset:33792
v_mfma_f32_16x16x32_bf16 v[40:43], v[64:67], v[132:135], v[40:43]
ds_read_b64_tr_b16 v[60:61], v9 offset:36864
v_mfma_f32_16x16x32_bf16 v[40:43], v[68:71], v[140:143], v[40:43]
ds_read_b64_tr_b16 v[62:63], v9 offset:37888
s_waitcnt lgkmcnt(10)
v_mfma_f32_16x16x32_bf16 v[28:31], v[72:75], v[128:131], v[28:31]
ds_read_b64_tr_b16 v[64:65], v10 offset:32768
s_waitcnt lgkmcnt(9)
v_mfma_f32_16x16x32_bf16 v[28:31], v[76:79], v[136:139], v[28:31]
ds_read_b64_tr_b16 v[66:67], v10 offset:33792
v_mfma_f32_16x16x32_bf16 v[44:47], v[72:75], v[132:135], v[44:47]
ds_read_b64_tr_b16 v[68:69], v10 offset:36864
v_mfma_f32_16x16x32_bf16 v[44:47], v[76:79], v[140:143], v[44:47]
ds_read_b64_tr_b16 v[70:71], v10 offset:37888
s_waitcnt vmcnt(27) lgkmcnt(10)
v_mfma_f32_16x16x32_bf16 v[16:19], v[48:51], v[144:147], v[16:19]
ds_read_b64_tr_b16 v[72:73], v11 offset:32768
buffer_load_dwordx4 v[128:131], v6, s[20:23], s66 offen offset:0 sc1
s_waitcnt vmcnt(27) lgkmcnt(9)
v_mfma_f32_16x16x32_bf16 v[16:19], v[52:55], v[152:155], v[16:19]
ds_read_b64_tr_b16 v[74:75], v11 offset:33792
buffer_load_dwordx4 v[136:139], v6, s[20:23], s66 offen offset:2048 sc1
s_waitcnt vmcnt(27)
v_mfma_f32_16x16x32_bf16 v[32:35], v[48:51], v[148:151], v[32:35]
ds_read_b64_tr_b16 v[76:77], v11 offset:36864
buffer_load_dwordx4 v[132:135], v6, s[20:23], s66 offen offset:256 sc1
s_waitcnt vmcnt(27)
v_mfma_f32_16x16x32_bf16 v[32:35], v[52:55], v[156:159], v[32:35]
ds_read_b64_tr_b16 v[78:79], v11 offset:37888
buffer_load_dwordx4 v[140:143], v6, s[20:23], s66 offen offset:2304 sc1
s_waitcnt lgkmcnt(10)
v_mfma_f32_16x16x32_bf16 v[20:23], v[56:59], v[144:147], v[20:23]
ds_read_b64_tr_b16 v[48:49], v8 offset:40960
s_add_u32 s66, s66, 4096
s_and_b32 s66, s66, 0xffff
s_waitcnt lgkmcnt(9)
v_mfma_f32_16x16x32_bf16 v[20:23], v[60:63], v[152:155], v[20:23]
ds_read_b64_tr_b16 v[50:51], v8 offset:41984
v_mfma_f32_16x16x32_bf16 v[36:39], v[56:59], v[148:151], v[36:39]
ds_read_b64_tr_b16 v[52:53], v8 offset:45056
v_mfma_f32_16x16x32_bf16 v[36:39], v[60:63], v[156:159], v[36:39]
ds_read_b64_tr_b16 v[54:55], v8 offset:46080
s_waitcnt lgkmcnt(10)
v_mfma_f32_16x16x32_bf16 v[24:27], v[64:67], v[144:147], v[24:27]
ds_read_b64_tr_b16 v[56:57], v9 offset:40960
s_waitcnt lgkmcnt(9)
v_mfma_f32_16x16x32_bf16 v[24:27], v[68:71], v[152:155], v[24:27]
ds_read_b64_tr_b16 v[58:59], v9 offset:41984
v_mfma_f32_16x16x32_bf16 v[40:43], v[64:67], v[148:151], v[40:43]
ds_read_b64_tr_b16 v[60:61], v9 offset:45056
v_mfma_f32_16x16x32_bf16 v[40:43], v[68:71], v[156:159], v[40:43]
ds_read_b64_tr_b16 v[62:63], v9 offset:46080
s_waitcnt lgkmcnt(10)
v_mfma_f32_16x16x32_bf16 v[28:31], v[72:75], v[144:147], v[28:31]
ds_read_b64_tr_b16 v[64:65], v10 offset:40960
s_waitcnt lgkmcnt(9)
v_mfma_f32_16x16x32_bf16 v[28:31], v[76:79], v[152:155], v[28:31]
ds_read_b64_tr_b16 v[66:67], v10 offset:41984
v_mfma_f32_16x16x32_bf16 v[44:47], v[72:75], v[148:151], v[44:47]
ds_read_b64_tr_b16 v[68:69], v10 offset:45056
v_mfma_f32_16x16x32_bf16 v[44:47], v[76:79], v[156:159], v[44:47]
ds_read_b64_tr_b16 v[70:71], v10 offset:46080
s_waitcnt vmcnt(27) lgkmcnt(10)
v_mfma_f32_16x16x32_bf16 v[16:19], v[48:51], v[160:163], v[16:19]
ds_read_b64_tr_b16 v[72:73], v11 offset:40960
buffer_load_dwordx4 v[144:147], v6, s[20:23], s66 offen offset:0 sc1
s_waitcnt vmcnt(27) lgkmcnt(9)
v_mfma_f32_16x16x32_bf16 v[16:19], v[52:55], v[168:171], v[16:19]
ds_read_b64_tr_b16 v[74:75], v11 offset:41984
buffer_load_dwordx4 v[152:155], v6, s[20:23], s66 offen offset:2048 sc1
s_waitcnt vmcnt(27)
v_mfma_f32_16x16x32_bf16 v[32:35], v[48:51], v[164:167], v[32:35]
ds_read_b64_tr_b16 v[76:77], v11 offset:45056
buffer_load_dwordx4 v[148:151], v6, s[20:23], s66 offen offset:256 sc1
s_waitcnt vmcnt(27)
v_mfma_f32_16x16x32_bf16 v[32:35], v[52:55], v[172:175], v[32:35]
ds_read_b64_tr_b16 v[78:79], v11 offset:46080
buffer_load_dwordx4 v[156:159], v6, s[20:23], s66 offen offset:2304 sc1
s_waitcnt lgkmcnt(10)
v_mfma_f32_16x16x32_bf16 v[20:23], v[56:59], v[160:163], v[20:23]
ds_read_b64_tr_b16 v[48:49], v8 offset:49152
s_add_u32 s66, s66, 4096
s_and_b32 s66, s66, 0xffff
s_waitcnt lgkmcnt(9)
v_mfma_f32_16x16x32_bf16 v[20:23], v[60:63], v[168:171], v[20:23]
ds_read_b64_tr_b16 v[50:51], v8 offset:50176
v_mfma_f32_16x16x32_bf16 v[36:39], v[56:59], v[164:167], v[36:39]
ds_read_b64_tr_b16 v[52:53], v8 offset:53248
v_mfma_f32_16x16x32_bf16 v[36:39], v[60:63], v[172:175], v[36:39]
ds_read_b64_tr_b16 v[54:55], v8 offset:54272
s_waitcnt lgkmcnt(10)
v_mfma_f32_16x16x32_bf16 v[24:27], v[64:67], v[160:163], v[24:27]
ds_read_b64_tr_b16 v[56:57], v9 offset:49152
s_waitcnt lgkmcnt(9)
v_mfma_f32_16x16x32_bf16 v[24:27], v[68:71], v[168:171], v[24:27]
ds_read_b64_tr_b16 v[58:59], v9 offset:50176
v_mfma_f32_16x16x32_bf16 v[40:43], v[64:67], v[164:167], v[40:43]
ds_read_b64_tr_b16 v[60:61], v9 offset:53248
v_mfma_f32_16x16x32_bf16 v[40:43], v[68:71], v[172:175], v[40:43]
ds_read_b64_tr_b16 v[62:63], v9 offset:54272
s_waitcnt lgkmcnt(10)
v_mfma_f32_16x16x32_bf16 v[28:31], v[72:75], v[160:163], v[28:31]
ds_read_b64_tr_b16 v[64:65], v10 offset:49152
s_waitcnt lgkmcnt(9)
v_mfma_f32_16x16x32_bf16 v[28:31], v[76:79], v[168:171], v[28:31]
ds_read_b64_tr_b16 v[66:67], v10 offset:50176
v_mfma_f32_16x16x32_bf16 v[44:47], v[72:75], v[164:167], v[44:47]
ds_read_b64_tr_b16 v[68:69], v10 offset:53248
v_mfma_f32_16x16x32_bf16 v[44:47], v[76:79], v[172:175], v[44:47]
ds_read_b64_tr_b16 v[70:71], v10 offset:54272
s_waitcnt vmcnt(27) lgkmcnt(10)
v_mfma_f32_16x16x32_bf16 v[16:19], v[48:51], v[176:179], v[16:19]
ds_read_b64_tr_b16 v[72:73], v11 offset:49152
buffer_load_dwordx4 v[160:163], v6, s[20:23], s66 offen offset:0 sc1
s_waitcnt vmcnt(27) lgkmcnt(9)
v_mfma_f32_16x16x32_bf16 v[16:19], v[52:55], v[184:187], v[16:19]
ds_read_b64_tr_b16 v[74:75], v11 offset:50176
buffer_load_dwordx4 v[168:171], v6, s[20:23], s66 offen offset:2048 sc1
s_waitcnt vmcnt(27)
v_mfma_f32_16x16x32_bf16 v[32:35], v[48:51], v[180:183], v[32:35]
ds_read_b64_tr_b16 v[76:77], v11 offset:53248
buffer_load_dwordx4 v[164:167], v6, s[20:23], s66 offen offset:256 sc1
s_waitcnt vmcnt(27)
v_mfma_f32_16x16x32_bf16 v[32:35], v[52:55], v[188:191], v[32:35]
ds_read_b64_tr_b16 v[78:79], v11 offset:54272
buffer_load_dwordx4 v[172:175], v6, s[20:23], s66 offen offset:2304 sc1
s_waitcnt lgkmcnt(10)
v_mfma_f32_16x16x32_bf16 v[20:23], v[56:59], v[176:179], v[20:23]
ds_read_b64_tr_b16 v[48:49], v8 offset:57344
s_add_u32 s66, s66, 4096
s_and_b32 s66, s66, 0xffff
s_waitcnt lgkmcnt(9)
v_mfma_f32_16x16x32_bf16 v[20:23], v[60:63], v[184:187], v[20:23]
ds_read_b64_tr_b16 v[50:51], v8 offset:58368
v_mfma_f32_16x16x32_bf16 v[36:39], v[56:59], v[180:183], v[36:39]
ds_read_b64_tr_b16 v[52:53], v8 offset:61440
v_mfma_f32_16x16x32_bf16 v[36:39], v[60:63], v[188:191], v[36:39]
ds_read_b64_tr_b16 v[54:55], v8 offset:62464
s_waitcnt lgkmcnt(10)
v_mfma_f32_16x16x32_bf16 v[24:27], v[64:67], v[176:179], v[24:27]
ds_read_b64_tr_b16 v[56:57], v9 offset:57344
s_waitcnt lgkmcnt(9)
v_mfma_f32_16x16x32_bf16 v[24:27], v[68:71], v[184:187], v[24:27]
ds_read_b64_tr_b16 v[58:59], v9 offset:58368
v_mfma_f32_16x16x32_bf16 v[40:43], v[64:67], v[180:183], v[40:43]
ds_read_b64_tr_b16 v[60:61], v9 offset:61440
v_mfma_f32_16x16x32_bf16 v[40:43], v[68:71], v[188:191], v[40:43]
ds_read_b64_tr_b16 v[62:63], v9 offset:62464
s_waitcnt lgkmcnt(10)
v_mfma_f32_16x16x32_bf16 v[28:31], v[72:75], v[176:179], v[28:31]
ds_read_b64_tr_b16 v[64:65], v10 offset:57344
s_waitcnt lgkmcnt(9)
v_mfma_f32_16x16x32_bf16 v[28:31], v[76:79], v[184:187], v[28:31]
ds_read_b64_tr_b16 v[66:67], v10 offset:58368
v_mfma_f32_16x16x32_bf16 v[44:47], v[72:75], v[180:183], v[44:47]
ds_read_b64_tr_b16 v[68:69], v10 offset:61440
v_mfma_f32_16x16x32_bf16 v[44:47], v[76:79], v[188:191], v[44:47]
ds_read_b64_tr_b16 v[70:71], v10 offset:62464
s_waitcnt vmcnt(27) lgkmcnt(10)
v_mfma_f32_16x16x32_bf16 v[16:19], v[48:51], v[192:195], v[16:19]
ds_read_b64_tr_b16 v[72:73], v11 offset:57344
buffer_load_dwordx4 v[176:179], v6, s[20:23], s66 offen offset:0 sc1
s_waitcnt vmcnt(27) lgkmcnt(9)
v_mfma_f32_16x16x32_bf16 v[16:19], v[52:55], v[200:203], v[16:19]
ds_read_b64_tr_b16 v[74:75], v11 offset:58368
buffer_load_dwordx4 v[184:187], v6, s[20:23], s66 offen offset:2048 sc1
s_waitcnt vmcnt(27)
v_mfma_f32_16x16x32_bf16 v[32:35], v[48:51], v[196:199], v[32:35]
ds_read_b64_tr_b16 v[76:77], v11 offset:61440
buffer_load_dwordx4 v[180:183], v6, s[20:23], s66 offen offset:256 sc1
s_waitcnt vmcnt(27)
v_mfma_f32_16x16x32_bf16 v[32:35], v[52:55], v[204:207], v[32:35]
ds_read_b64_tr_b16 v[78:79], v11 offset:62464
buffer_load_dwordx4 v[188:191], v6, s[20:23], s66 offen offset:2304 sc1
s_waitcnt lgkmcnt(10)
v_mfma_f32_16x16x32_bf16 v[20:23], v[56:59], v[192:195], v[20:23]
ds_read_b64_tr_b16 v[48:49], v12 offset:0
s_add_u32 s66, s66, 4096
s_and_b32 s66, s66, 0xffff
s_waitcnt lgkmcnt(9)
v_mfma_f32_16x16x32_bf16 v[20:23], v[60:63], v[200:203], v[20:23]
ds_read_b64_tr_b16 v[50:51], v12 offset:1024
v_mfma_f32_16x16x32_bf16 v[36:39], v[56:59], v[196:199], v[36:39]
ds_read_b64_tr_b16 v[52:53], v12 offset:4096
v_mfma_f32_16x16x32_bf16 v[36:39], v[60:63], v[204:207], v[36:39]
ds_read_b64_tr_b16 v[54:55], v12 offset:5120
s_waitcnt lgkmcnt(10)
v_mfma_f32_16x16x32_bf16 v[24:27], v[64:67], v[192:195], v[24:27]
ds_read_b64_tr_b16 v[56:57], v13 offset:0
s_waitcnt lgkmcnt(9)
v_mfma_f32_16x16x32_bf16 v[24:27], v[68:71], v[200:203], v[24:27]
ds_read_b64_tr_b16 v[58:59], v13 offset:1024
v_mfma_f32_16x16x32_bf16 v[40:43], v[64:67], v[196:199], v[40:43]
ds_read_b64_tr_b16 v[60:61], v13 offset:4096
v_mfma_f32_16x16x32_bf16 v[40:43], v[68:71], v[204:207], v[40:43]
ds_read_b64_tr_b16 v[62:63], v13 offset:5120
s_waitcnt lgkmcnt(10)
v_mfma_f32_16x16x32_bf16 v[28:31], v[72:75], v[192:195], v[28:31]
ds_read_b64_tr_b16 v[64:65], v14 offset:0
s_waitcnt lgkmcnt(9)
v_mfma_f32_16x16x32_bf16 v[28:31], v[76:79], v[200:203], v[28:31]
ds_read_b64_tr_b16 v[66:67], v14 offset:1024
v_mfma_f32_16x16x32_bf16 v[44:47], v[72:75], v[196:199], v[44:47]
ds_read_b64_tr_b16 v[68:69], v14 offset:4096
v_mfma_f32_16x16x32_bf16 v[44:47], v[76:79], v[204:207], v[44:47]
ds_read_b64_tr_b16 v[70:71], v14 offset:5120
s_waitcnt vmcnt(27) lgkmcnt(10)
v_mfma_f32_16x16x32_bf16 v[16:19], v[48:51], v[80:83], v[16:19]
ds_read_b64_tr_b16 v[72:73], v15 offset:0
buffer_load_dwordx4 v[192:195], v6, s[20:23], s66 offen offset:0 sc1
s_waitcnt vmcnt(27) lgkmcnt(9)
v_mfma_f32_16x16x32_bf16 v[16:19], v[52:55], v[88:91], v[16:19]
ds_read_b64_tr_b16 v[74:75], v15 offset:1024
buffer_load_dwordx4 v[200:203], v6, s[20:23], s66 offen offset:2048 sc1
s_waitcnt vmcnt(27)
v_mfma_f32_16x16x32_bf16 v[32:35], v[48:51], v[84:87], v[32:35]
ds_read_b64_tr_b16 v[76:77], v15 offset:4096
buffer_load_dwordx4 v[196:199], v6, s[20:23], s66 offen offset:256 sc1
s_waitcnt vmcnt(27)
v_mfma_f32_16x16x32_bf16 v[32:35], v[52:55], v[92:95], v[32:35]
ds_read_b64_tr_b16 v[78:79], v15 offset:5120
buffer_load_dwordx4 v[204:207], v6, s[20:23], s66 offen offset:2304 sc1
s_waitcnt lgkmcnt(10)
v_mfma_f32_16x16x32_bf16 v[20:23], v[56:59], v[80:83], v[20:23]
ds_read_b64_tr_b16 v[48:49], v12 offset:8192
s_add_u32 s66, s66, 4096
s_and_b32 s66, s66, 0xffff
s_waitcnt lgkmcnt(9)
v_mfma_f32_16x16x32_bf16 v[20:23], v[60:63], v[88:91], v[20:23]
ds_read_b64_tr_b16 v[50:51], v12 offset:9216
v_mfma_f32_16x16x32_bf16 v[36:39], v[56:59], v[84:87], v[36:39]
ds_read_b64_tr_b16 v[52:53], v12 offset:12288
v_mfma_f32_16x16x32_bf16 v[36:39], v[60:63], v[92:95], v[36:39]
ds_read_b64_tr_b16 v[54:55], v12 offset:13312
s_waitcnt lgkmcnt(10)
v_mfma_f32_16x16x32_bf16 v[24:27], v[64:67], v[80:83], v[24:27]
ds_read_b64_tr_b16 v[56:57], v13 offset:8192
s_waitcnt lgkmcnt(9)
v_mfma_f32_16x16x32_bf16 v[24:27], v[68:71], v[88:91], v[24:27]
ds_read_b64_tr_b16 v[58:59], v13 offset:9216
v_mfma_f32_16x16x32_bf16 v[40:43], v[64:67], v[84:87], v[40:43]
ds_read_b64_tr_b16 v[60:61], v13 offset:12288
v_mfma_f32_16x16x32_bf16 v[40:43], v[68:71], v[92:95], v[40:43]
ds_read_b64_tr_b16 v[62:63], v13 offset:13312
s_waitcnt lgkmcnt(10)
v_mfma_f32_16x16x32_bf16 v[28:31], v[72:75], v[80:83], v[28:31]
ds_read_b64_tr_b16 v[64:65], v14 offset:8192
s_waitcnt lgkmcnt(9)
v_mfma_f32_16x16x32_bf16 v[28:31], v[76:79], v[88:91], v[28:31]
ds_read_b64_tr_b16 v[66:67], v14 offset:9216
v_mfma_f32_16x16x32_bf16 v[44:47], v[72:75], v[84:87], v[44:47]
ds_read_b64_tr_b16 v[68:69], v14 offset:12288
v_mfma_f32_16x16x32_bf16 v[44:47], v[76:79], v[92:95], v[44:47]
ds_read_b64_tr_b16 v[70:71], v14 offset:13312
s_waitcnt vmcnt(27) lgkmcnt(10)
v_mfma_f32_16x16x32_bf16 v[16:19], v[48:51], v[96:99], v[16:19]
ds_read_b64_tr_b16 v[72:73], v15 offset:8192
s_waitcnt vmcnt(26) lgkmcnt(9)
v_mfma_f32_16x16x32_bf16 v[16:19], v[52:55], v[104:107], v[16:19]
ds_read_b64_tr_b16 v[74:75], v15 offset:9216
s_waitcnt vmcnt(25)
v_mfma_f32_16x16x32_bf16 v[32:35], v[48:51], v[100:103], v[32:35]
ds_read_b64_tr_b16 v[76:77], v15 offset:12288
s_waitcnt vmcnt(24)
v_mfma_f32_16x16x32_bf16 v[32:35], v[52:55], v[108:111], v[32:35]
ds_read_b64_tr_b16 v[78:79], v15 offset:13312
s_waitcnt lgkmcnt(10)
v_mfma_f32_16x16x32_bf16 v[20:23], v[56:59], v[96:99], v[20:23]
ds_read_b64_tr_b16 v[48:49], v12 offset:16384
s_waitcnt lgkmcnt(9)
v_mfma_f32_16x16x32_bf16 v[20:23], v[60:63], v[104:107], v[20:23]
ds_read_b64_tr_b16 v[50:51], v12 offset:17408
v_mfma_f32_16x16x32_bf16 v[36:39], v[56:59], v[100:103], v[36:39]
ds_read_b64_tr_b16 v[52:53], v12 offset:20480
v_mfma_f32_16x16x32_bf16 v[36:39], v[60:63], v[108:111], v[36:39]
ds_read_b64_tr_b16 v[54:55], v12 offset:21504
s_waitcnt lgkmcnt(10)
v_mfma_f32_16x16x32_bf16 v[24:27], v[64:67], v[96:99], v[24:27]
ds_read_b64_tr_b16 v[56:57], v13 offset:16384
s_waitcnt lgkmcnt(9)
v_mfma_f32_16x16x32_bf16 v[24:27], v[68:71], v[104:107], v[24:27]
ds_read_b64_tr_b16 v[58:59], v13 offset:17408
v_mfma_f32_16x16x32_bf16 v[40:43], v[64:67], v[100:103], v[40:43]
ds_read_b64_tr_b16 v[60:61], v13 offset:20480
v_mfma_f32_16x16x32_bf16 v[40:43], v[68:71], v[108:111], v[40:43]
ds_read_b64_tr_b16 v[62:63], v13 offset:21504
s_waitcnt lgkmcnt(10)
v_mfma_f32_16x16x32_bf16 v[28:31], v[72:75], v[96:99], v[28:31]
ds_read_b64_tr_b16 v[64:65], v14 offset:16384
s_waitcnt lgkmcnt(9)
v_mfma_f32_16x16x32_bf16 v[28:31], v[76:79], v[104:107], v[28:31]
ds_read_b64_tr_b16 v[66:67], v14 offset:17408
v_mfma_f32_16x16x32_bf16 v[44:47], v[72:75], v[100:103], v[44:47]
ds_read_b64_tr_b16 v[68:69], v14 offset:20480
v_mfma_f32_16x16x32_bf16 v[44:47], v[76:79], v[108:111], v[44:47]
ds_read_b64_tr_b16 v[70:71], v14 offset:21504
s_waitcnt vmcnt(23) lgkmcnt(10)
v_mfma_f32_16x16x32_bf16 v[16:19], v[48:51], v[112:115], v[16:19]
ds_read_b64_tr_b16 v[72:73], v15 offset:16384
s_waitcnt vmcnt(22) lgkmcnt(9)
v_mfma_f32_16x16x32_bf16 v[16:19], v[52:55], v[120:123], v[16:19]
ds_read_b64_tr_b16 v[74:75], v15 offset:17408
s_waitcnt vmcnt(21)
v_mfma_f32_16x16x32_bf16 v[32:35], v[48:51], v[116:119], v[32:35]
ds_read_b64_tr_b16 v[76:77], v15 offset:20480
s_waitcnt vmcnt(20)
v_mfma_f32_16x16x32_bf16 v[32:35], v[52:55], v[124:127], v[32:35]
ds_read_b64_tr_b16 v[78:79], v15 offset:21504
s_waitcnt lgkmcnt(10)
v_mfma_f32_16x16x32_bf16 v[20:23], v[56:59], v[112:115], v[20:23]
ds_read_b64_tr_b16 v[48:49], v12 offset:24576
s_waitcnt lgkmcnt(9)
v_mfma_f32_16x16x32_bf16 v[20:23], v[60:63], v[120:123], v[20:23]
ds_read_b64_tr_b16 v[50:51], v12 offset:25600
v_mfma_f32_16x16x32_bf16 v[36:39], v[56:59], v[116:119], v[36:39]
ds_read_b64_tr_b16 v[52:53], v12 offset:28672
v_mfma_f32_16x16x32_bf16 v[36:39], v[60:63], v[124:127], v[36:39]
ds_read_b64_tr_b16 v[54:55], v12 offset:29696
s_waitcnt lgkmcnt(10)
v_mfma_f32_16x16x32_bf16 v[24:27], v[64:67], v[112:115], v[24:27]
ds_read_b64_tr_b16 v[56:57], v13 offset:24576
s_waitcnt lgkmcnt(9)
v_mfma_f32_16x16x32_bf16 v[24:27], v[68:71], v[120:123], v[24:27]
ds_read_b64_tr_b16 v[58:59], v13 offset:25600
v_mfma_f32_16x16x32_bf16 v[40:43], v[64:67], v[116:119], v[40:43]
ds_read_b64_tr_b16 v[60:61], v13 offset:28672
v_mfma_f32_16x16x32_bf16 v[40:43], v[68:71], v[124:127], v[40:43]
ds_read_b64_tr_b16 v[62:63], v13 offset:29696
s_waitcnt lgkmcnt(10)
v_mfma_f32_16x16x32_bf16 v[28:31], v[72:75], v[112:115], v[28:31]
ds_read_b64_tr_b16 v[64:65], v14 offset:24576
s_waitcnt lgkmcnt(9)
v_mfma_f32_16x16x32_bf16 v[28:31], v[76:79], v[120:123], v[28:31]
ds_read_b64_tr_b16 v[66:67], v14 offset:25600
v_mfma_f32_16x16x32_bf16 v[44:47], v[72:75], v[116:119], v[44:47]
ds_read_b64_tr_b16 v[68:69], v14 offset:28672
v_mfma_f32_16x16x32_bf16 v[44:47], v[76:79], v[124:127], v[44:47]
ds_read_b64_tr_b16 v[70:71], v14 offset:29696
s_waitcnt vmcnt(19) lgkmcnt(10)
v_mfma_f32_16x16x32_bf16 v[16:19], v[48:51], v[128:131], v[16:19]
ds_read_b64_tr_b16 v[72:73], v15 offset:24576
s_waitcnt vmcnt(18) lgkmcnt(9)
v_mfma_f32_16x16x32_bf16 v[16:19], v[52:55], v[136:139], v[16:19]
ds_read_b64_tr_b16 v[74:75], v15 offset:25600
s_waitcnt vmcnt(17)
v_mfma_f32_16x16x32_bf16 v[32:35], v[48:51], v[132:135], v[32:35]
ds_read_b64_tr_b16 v[76:77], v15 offset:28672
s_waitcnt vmcnt(16)
v_mfma_f32_16x16x32_bf16 v[32:35], v[52:55], v[140:143], v[32:35]
ds_read_b64_tr_b16 v[78:79], v15 offset:29696
s_waitcnt lgkmcnt(10)
v_mfma_f32_16x16x32_bf16 v[20:23], v[56:59], v[128:131], v[20:23]
ds_read_b64_tr_b16 v[48:49], v12 offset:32768
s_waitcnt lgkmcnt(9)
v_mfma_f32_16x16x32_bf16 v[20:23], v[60:63], v[136:139], v[20:23]
ds_read_b64_tr_b16 v[50:51], v12 offset:33792
v_mfma_f32_16x16x32_bf16 v[36:39], v[56:59], v[132:135], v[36:39]
ds_read_b64_tr_b16 v[52:53], v12 offset:36864
v_mfma_f32_16x16x32_bf16 v[36:39], v[60:63], v[140:143], v[36:39]
ds_read_b64_tr_b16 v[54:55], v12 offset:37888
s_waitcnt lgkmcnt(10)
v_mfma_f32_16x16x32_bf16 v[24:27], v[64:67], v[128:131], v[24:27]
ds_read_b64_tr_b16 v[56:57], v13 offset:32768
s_waitcnt lgkmcnt(9)
v_mfma_f32_16x16x32_bf16 v[24:27], v[68:71], v[136:139], v[24:27]
ds_read_b64_tr_b16 v[58:59], v13 offset:33792
v_mfma_f32_16x16x32_bf16 v[40:43], v[64:67], v[132:135], v[40:43]
ds_read_b64_tr_b16 v[60:61], v13 offset:36864
v_mfma_f32_16x16x32_bf16 v[40:43], v[68:71], v[140:143], v[40:43]
ds_read_b64_tr_b16 v[62:63], v13 offset:37888
s_waitcnt lgkmcnt(10)
v_mfma_f32_16x16x32_bf16 v[28:31], v[72:75], v[128:131], v[28:31]
ds_read_b64_tr_b16 v[64:65], v14 offset:32768
s_waitcnt lgkmcnt(9)
v_mfma_f32_16x16x32_bf16 v[28:31], v[76:79], v[136:139], v[28:31]
ds_read_b64_tr_b16 v[66:67], v14 offset:33792
v_mfma_f32_16x16x32_bf16 v[44:47], v[72:75], v[132:135], v[44:47]
ds_read_b64_tr_b16 v[68:69], v14 offset:36864
v_mfma_f32_16x16x32_bf16 v[44:47], v[76:79], v[140:143], v[44:47]
ds_read_b64_tr_b16 v[70:71], v14 offset:37888
s_waitcnt vmcnt(15) lgkmcnt(10)
v_mfma_f32_16x16x32_bf16 v[16:19], v[48:51], v[144:147], v[16:19]
ds_read_b64_tr_b16 v[72:73], v15 offset:32768
s_waitcnt vmcnt(14) lgkmcnt(9)
v_mfma_f32_16x16x32_bf16 v[16:19], v[52:55], v[152:155], v[16:19]
ds_read_b64_tr_b16 v[74:75], v15 offset:33792
s_waitcnt vmcnt(13)
v_mfma_f32_16x16x32_bf16 v[32:35], v[48:51], v[148:151], v[32:35]
ds_read_b64_tr_b16 v[76:77], v15 offset:36864
s_waitcnt vmcnt(12)
v_mfma_f32_16x16x32_bf16 v[32:35], v[52:55], v[156:159], v[32:35]
ds_read_b64_tr_b16 v[78:79], v15 offset:37888
s_waitcnt lgkmcnt(10)
v_mfma_f32_16x16x32_bf16 v[20:23], v[56:59], v[144:147], v[20:23]
ds_read_b64_tr_b16 v[48:49], v12 offset:40960
s_waitcnt lgkmcnt(9)
v_mfma_f32_16x16x32_bf16 v[20:23], v[60:63], v[152:155], v[20:23]
ds_read_b64_tr_b16 v[50:51], v12 offset:41984
v_mfma_f32_16x16x32_bf16 v[36:39], v[56:59], v[148:151], v[36:39]
ds_read_b64_tr_b16 v[52:53], v12 offset:45056
v_mfma_f32_16x16x32_bf16 v[36:39], v[60:63], v[156:159], v[36:39]
ds_read_b64_tr_b16 v[54:55], v12 offset:46080
s_waitcnt lgkmcnt(10)
v_mfma_f32_16x16x32_bf16 v[24:27], v[64:67], v[144:147], v[24:27]
ds_read_b64_tr_b16 v[56:57], v13 offset:40960
s_waitcnt lgkmcnt(9)
v_mfma_f32_16x16x32_bf16 v[24:27], v[68:71], v[152:155], v[24:27]
ds_read_b64_tr_b16 v[58:59], v13 offset:41984
v_mfma_f32_16x16x32_bf16 v[40:43], v[64:67], v[148:151], v[40:43]
ds_read_b64_tr_b16 v[60:61], v13 offset:45056
v_mfma_f32_16x16x32_bf16 v[40:43], v[68:71], v[156:159], v[40:43]
ds_read_b64_tr_b16 v[62:63], v13 offset:46080
s_waitcnt lgkmcnt(10)
v_mfma_f32_16x16x32_bf16 v[28:31], v[72:75], v[144:147], v[28:31]
ds_read_b64_tr_b16 v[64:65], v14 offset:40960
s_waitcnt lgkmcnt(9)
v_mfma_f32_16x16x32_bf16 v[28:31], v[76:79], v[152:155], v[28:31]
ds_read_b64_tr_b16 v[66:67], v14 offset:41984
v_mfma_f32_16x16x32_bf16 v[44:47], v[72:75], v[148:151], v[44:47]
ds_read_b64_tr_b16 v[68:69], v14 offset:45056
v_mfma_f32_16x16x32_bf16 v[44:47], v[76:79], v[156:159], v[44:47]
ds_read_b64_tr_b16 v[70:71], v14 offset:46080
s_waitcnt vmcnt(11) lgkmcnt(10)
v_mfma_f32_16x16x32_bf16 v[16:19], v[48:51], v[160:163], v[16:19]
ds_read_b64_tr_b16 v[72:73], v15 offset:40960
s_waitcnt vmcnt(10) lgkmcnt(9)
v_mfma_f32_16x16x32_bf16 v[16:19], v[52:55], v[168:171], v[16:19]
ds_read_b64_tr_b16 v[74:75], v15 offset:41984
s_waitcnt vmcnt(9)
v_mfma_f32_16x16x32_bf16 v[32:35], v[48:51], v[164:167], v[32:35]
ds_read_b64_tr_b16 v[76:77], v15 offset:45056
s_waitcnt vmcnt(8)
v_mfma_f32_16x16x32_bf16 v[32:35], v[52:55], v[172:175], v[32:35]
ds_read_b64_tr_b16 v[78:79], v15 offset:46080
s_waitcnt lgkmcnt(10)
v_mfma_f32_16x16x32_bf16 v[20:23], v[56:59], v[160:163], v[20:23]
ds_read_b64_tr_b16 v[48:49], v12 offset:49152
s_waitcnt lgkmcnt(9)
v_mfma_f32_16x16x32_bf16 v[20:23], v[60:63], v[168:171], v[20:23]
ds_read_b64_tr_b16 v[50:51], v12 offset:50176
v_mfma_f32_16x16x32_bf16 v[36:39], v[56:59], v[164:167], v[36:39]
ds_read_b64_tr_b16 v[52:53], v12 offset:53248
v_mfma_f32_16x16x32_bf16 v[36:39], v[60:63], v[172:175], v[36:39]
ds_read_b64_tr_b16 v[54:55], v12 offset:54272
s_waitcnt lgkmcnt(10)
v_mfma_f32_16x16x32_bf16 v[24:27], v[64:67], v[160:163], v[24:27]
ds_read_b64_tr_b16 v[56:57], v13 offset:49152
s_waitcnt lgkmcnt(9)
v_mfma_f32_16x16x32_bf16 v[24:27], v[68:71], v[168:171], v[24:27]
ds_read_b64_tr_b16 v[58:59], v13 offset:50176
v_mfma_f32_16x16x32_bf16 v[40:43], v[64:67], v[164:167], v[40:43]
ds_read_b64_tr_b16 v[60:61], v13 offset:53248
v_mfma_f32_16x16x32_bf16 v[40:43], v[68:71], v[172:175], v[40:43]
ds_read_b64_tr_b16 v[62:63], v13 offset:54272
s_waitcnt lgkmcnt(10)
v_mfma_f32_16x16x32_bf16 v[28:31], v[72:75], v[160:163], v[28:31]
ds_read_b64_tr_b16 v[64:65], v14 offset:49152
s_waitcnt lgkmcnt(9)
v_mfma_f32_16x16x32_bf16 v[28:31], v[76:79], v[168:171], v[28:31]
ds_read_b64_tr_b16 v[66:67], v14 offset:50176
v_mfma_f32_16x16x32_bf16 v[44:47], v[72:75], v[164:167], v[44:47]
ds_read_b64_tr_b16 v[68:69], v14 offset:53248
v_mfma_f32_16x16x32_bf16 v[44:47], v[76:79], v[172:175], v[44:47]
ds_read_b64_tr_b16 v[70:71], v14 offset:54272
s_waitcnt vmcnt(7) lgkmcnt(10)
v_mfma_f32_16x16x32_bf16 v[16:19], v[48:51], v[176:179], v[16:19]
ds_read_b64_tr_b16 v[72:73], v15 offset:49152
s_waitcnt vmcnt(6) lgkmcnt(9)
v_mfma_f32_16x16x32_bf16 v[16:19], v[52:55], v[184:187], v[16:19]
ds_read_b64_tr_b16 v[74:75], v15 offset:50176
s_waitcnt vmcnt(5)
v_mfma_f32_16x16x32_bf16 v[32:35], v[48:51], v[180:183], v[32:35]
ds_read_b64_tr_b16 v[76:77], v15 offset:53248
s_waitcnt vmcnt(4)
v_mfma_f32_16x16x32_bf16 v[32:35], v[52:55], v[188:191], v[32:35]
ds_read_b64_tr_b16 v[78:79], v15 offset:54272
s_waitcnt lgkmcnt(10)
v_mfma_f32_16x16x32_bf16 v[20:23], v[56:59], v[176:179], v[20:23]
ds_read_b64_tr_b16 v[48:49], v12 offset:57344
s_waitcnt lgkmcnt(9)
v_mfma_f32_16x16x32_bf16 v[20:23], v[60:63], v[184:187], v[20:23]
ds_read_b64_tr_b16 v[50:51], v12 offset:58368
v_mfma_f32_16x16x32_bf16 v[36:39], v[56:59], v[180:183], v[36:39]
ds_read_b64_tr_b16 v[52:53], v12 offset:61440
v_mfma_f32_16x16x32_bf16 v[36:39], v[60:63], v[188:191], v[36:39]
ds_read_b64_tr_b16 v[54:55], v12 offset:62464
s_waitcnt lgkmcnt(10)
v_mfma_f32_16x16x32_bf16 v[24:27], v[64:67], v[176:179], v[24:27]
ds_read_b64_tr_b16 v[56:57], v13 offset:57344
s_waitcnt lgkmcnt(9)
v_mfma_f32_16x16x32_bf16 v[24:27], v[68:71], v[184:187], v[24:27]
ds_read_b64_tr_b16 v[58:59], v13 offset:58368
v_mfma_f32_16x16x32_bf16 v[40:43], v[64:67], v[180:183], v[40:43]
ds_read_b64_tr_b16 v[60:61], v13 offset:61440
v_mfma_f32_16x16x32_bf16 v[40:43], v[68:71], v[188:191], v[40:43]
ds_read_b64_tr_b16 v[62:63], v13 offset:62464
s_waitcnt lgkmcnt(10)
v_mfma_f32_16x16x32_bf16 v[28:31], v[72:75], v[176:179], v[28:31]
ds_read_b64_tr_b16 v[64:65], v14 offset:57344
s_waitcnt lgkmcnt(9)
v_mfma_f32_16x16x32_bf16 v[28:31], v[76:79], v[184:187], v[28:31]
ds_read_b64_tr_b16 v[66:67], v14 offset:58368
v_mfma_f32_16x16x32_bf16 v[44:47], v[72:75], v[180:183], v[44:47]
ds_read_b64_tr_b16 v[68:69], v14 offset:61440
v_mfma_f32_16x16x32_bf16 v[44:47], v[76:79], v[188:191], v[44:47]
ds_read_b64_tr_b16 v[70:71], v14 offset:62464
s_waitcnt vmcnt(3) lgkmcnt(10)
v_mfma_f32_16x16x32_bf16 v[16:19], v[48:51], v[192:195], v[16:19]
ds_read_b64_tr_b16 v[72:73], v15 offset:57344
s_waitcnt vmcnt(2) lgkmcnt(9)
v_mfma_f32_16x16x32_bf16 v[16:19], v[52:55], v[200:203], v[16:19]
ds_read_b64_tr_b16 v[74:75], v15 offset:58368
s_waitcnt vmcnt(1)
v_mfma_f32_16x16x32_bf16 v[32:35], v[48:51], v[196:199], v[32:35]
ds_read_b64_tr_b16 v[76:77], v15 offset:61440
s_waitcnt vmcnt(0)
v_mfma_f32_16x16x32_bf16 v[32:35], v[52:55], v[204:207], v[32:35]
ds_read_b64_tr_b16 v[78:79], v15 offset:62464
s_waitcnt lgkmcnt(10)
v_mfma_f32_16x16x32_bf16 v[20:23], v[56:59], v[192:195], v[20:23]
v_add_u32 v5, s34, 22
s_mov_b64 exec, 1
ds_write_b32 v3, v5
s_mov_b64 exec, -1
s_waitcnt lgkmcnt(9)
v_mfma_f32_16x16x32_bf16 v[20:23], v[60:63], v[200:203], v[20:23]
v_mfma_f32_16x16x32_bf16 v[36:39], v[56:59], v[196:199], v[36:39]
v_mfma_f32_16x16x32_bf16 v[36:39], v[60:63], v[204:207], v[36:39]
s_waitcnt lgkmcnt(7)
v_mfma_f32_16x16x32_bf16 v[24:27], v[64:67], v[192:195], v[24:27]
s_waitcnt lgkmcnt(5)
v_mfma_f32_16x16x32_bf16 v[24:27], v[68:71], v[200:203], v[24:27]
v_mfma_f32_16x16x32_bf16 v[40:43], v[64:67], v[196:199], v[40:43]
v_mfma_f32_16x16x32_bf16 v[40:43], v[68:71], v[204:207], v[40:43]
s_waitcnt lgkmcnt(3)
v_mfma_f32_16x16x32_bf16 v[28:31], v[72:75], v[192:195], v[28:31]
s_waitcnt lgkmcnt(1)
v_mfma_f32_16x16x32_bf16 v[28:31], v[76:79], v[200:203], v[28:31]
v_mfma_f32_16x16x32_bf16 v[44:47], v[72:75], v[196:199], v[44:47]
v_mfma_f32_16x16x32_bf16 v[44:47], v[76:79], v[204:207], v[44:47]
s_lshl2_add_u32 s73, s61, s58
s_lshl4_add_u32 s66, s61, s62
s_lshl2_add_u32 s68, s66, s58
s_lshl_b32 s68, s68, 12
s_add_u32 s68, s68, 26214400
s_lshl_b32 s66, s61, 7
s_add_u32 s66, s66, s62
s_lshl_b32 s66, s66, 7
s_add_u32 s66, s66, 274432
s_lshl_b32 s74, s73, 13
s_add_u32 s74, s74, 524288
s_lshl_b32 s67, s62, 9
s_add_u32 s67, s67, s74
v_lshlrev_b32 v6, 4, v0
s_mov_b32 s69, 0x3f803f80
v_mov_b32 v8, 0
v_mov_b32 v9, 0
v_mov_b32 v10, 0
v_mov_b32 v11, 0
v_mov_b32 v12, 0
v_mov_b32 v13, 0
v_mov_b32 v14, 0
v_dot2c_f32_bf16 v11, s69, v232
v_dot2c_f32_bf16 v11, s69, v233
v_dot2c_f32_bf16 v11, s69, v234
v_dot2c_f32_bf16 v11, s69, v235
v_dot2c_f32_bf16 v11, s69, v236
v_dot2c_f32_bf16 v11, s69, v237
v_dot2c_f32_bf16 v11, s69, v238
v_dot2c_f32_bf16 v11, s69, v239
s_cmp_eq_u32 s63, 0
v_cvt_pk_bf16_f32 v240, v16, v17
v_cvt_pk_bf16_f32 v241, v18, v19
v_cvt_pk_bf16_f32 v242, v20, v21
v_cvt_pk_bf16_f32 v243, v22, v23
v_cvt_pk_bf16_f32 v244, v24, v25
v_cvt_pk_bf16_f32 v245, v26, v27
v_cvt_pk_bf16_f32 v246, v28, v29
v_cvt_pk_bf16_f32 v247, v30, v31
v_cvt_pk_bf16_f32 v248, v32, v33
v_cvt_pk_bf16_f32 v249, v34, v35
v_cvt_pk_bf16_f32 v250, v36, v37
v_cvt_pk_bf16_f32 v251, v38, v39
v_cvt_pk_bf16_f32 v252, v40, v41
v_cvt_pk_bf16_f32 v253, v42, v43
v_cvt_pk_bf16_f32 v254, v44, v45
v_cvt_pk_bf16_f32 v255, v46, v47
s_cselect_b64 exec, -1, 0
s_cmp_eq_u32 s57, 0
s_cbranch_scc1 far_169
buffer_store_dwordx4 v[240:243], v6, s[20:23], s68 offen offset:0
buffer_store_dwordx4 v[244:247], v6, s[20:23], s68 offen offset:1024
buffer_store_dwordx4 v[248:251], v6, s[20:23], s68 offen offset:2048
buffer_store_dwordx4 v[252:255], v6, s[20:23], s68 offen offset:3072
near_170:
s_mov_b64 exec, -1
v_dot2c_f32_bf16 v8, s69, v240
v_dot2c_f32_bf16 v9, v240, v240
v_dot2c_f32_bf16 v10, v232, v240
v_dot2c_f32_bf16 v12, s69, v248
v_dot2c_f32_bf16 v13, v248, v248
v_dot2c_f32_bf16 v14, v232, v248
v_dot2c_f32_bf16 v8, s69, v241
v_dot2c_f32_bf16 v9, v241, v241
v_dot2c_f32_bf16 v10, v233, v241
v_dot2c_f32_bf16 v12, s69, v249
v_dot2c_f32_bf16 v13, v249, v249
v_dot2c_f32_bf16 v14, v233, v249
v_dot2c_f32_bf16 v8, s69, v242
v_dot2c_f32_bf16 v9, v242, v242
v_dot2c_f32_bf16 v10, v234, v242
v_dot2c_f32_bf16 v12, s69, v250
v_dot2c_f32_bf16 v13, v250, v250
v_dot2c_f32_bf16 v14, v234, v250
v_dot2c_f32_bf16 v8, s69, v243
v_dot2c_f32_bf16 v9, v243, v243
v_dot2c_f32_bf16 v10, v235, v243
v_dot2c_f32_bf16 v12, s69, v251
v_dot2c_f32_bf16 v13, v251, v251
v_dot2c_f32_bf16 v14, v235, v251
v_dot2c_f32_bf16 v8, s69, v244
v_dot2c_f32_bf16 v9, v244, v244
v_dot2c_f32_bf16 v10, v236, v244
v_dot2c_f32_bf16 v12, s69, v252
v_dot2c_f32_bf16 v13, v252, v252
v_dot2c_f32_bf16 v14, v236, v252
v_dot2c_f32_bf16 v8, s69, v245
v_dot2c_f32_bf16 v9, v245, v245
v_dot2c_f32_bf16 v10, v237, v245
v_dot2c_f32_bf16 v12, s69, v253
v_dot2c_f32_bf16 v13, v253, v253
v_dot2c_f32_bf16 v14, v237, v253
v_dot2c_f32_bf16 v8, s69, v246
v_dot2c_f32_bf16 v9, v246, v246
v_dot2c_f32_bf16 v10, v238, v246
v_dot2c_f32_bf16 v12, s69, v254
v_dot2c_f32_bf16 v13, v254, v254
v_dot2c_f32_bf16 v14, v238, v254
v_dot2c_f32_bf16 v8, s69, v247
v_dot2c_f32_bf16 v9, v247, v247
v_dot2c_f32_bf16 v10, v239, v247
v_dot2c_f32_bf16 v12, s69, v255
v_dot2c_f32_bf16 v13, v255, v255
v_dot2c_f32_bf16 v14, v239, v255
v_mov_b32 v15, v11
v_lshrrev_b32 v7, 5, v0
v_mul_u32_u24 v7, 3584, v7
v_permlane16_swap_b32 v8, v12
v_permlane16_swap_b32 v9, v13
v_permlane16_swap_b32 v10, v14
v_permlane16_swap_b32 v11, v15
v_pk_add_f32 v[8:9], v[8:9], v[12:13]
v_pk_add_f32 v[10:11], v[10:11], v[14:15]
v_mov_b32 v12, v8
v_mov_b32 v13, v9
v_mov_b32 v14, v10
v_mov_b32 v15, v11
v_permlane32_swap_b32 v12, v8
v_permlane32_swap_b32 v13, v9
v_permlane32_swap_b32 v14, v10
v_permlane32_swap_b32 v15, v11
v_pk_add_f32 v[8:9], v[8:9], v[12:13]
v_pk_add_f32 v[10:11], v[10:11], v[14:15]
v_add_u32 v7, v6, v7
v_max_u32 v8, 1, v8
v_max_u32 v9, 1, v9
v_max_u32 v10, 1, v10
v_max_u32 v11, 1, v11
s_mov_b32 exec_hi, 0
s_cmp_eq_u32 s57, 0
s_cbranch_scc1 far_171
buffer_store_dwordx4 v[8:11], v6, s[24:27], s67 offen
near_172:
s_mov_b32 exec_hi, -1
v_lshlrev_b32 v16, 16, v240
v_and_b32 v17, 0xffff0000, v240
v_lshlrev_b32 v18, 16, v241
v_and_b32 v19, 0xffff0000, v241
v_lshlrev_b32 v20, 16, v242
v_and_b32 v21, 0xffff0000, v242
v_lshlrev_b32 v22, 16, v243
v_and_b32 v23, 0xffff0000, v243
v_lshlrev_b32 v24, 16, v244
v_and_b32 v25, 0xffff0000, v244
v_lshlrev_b32 v26, 16, v245
v_and_b32 v27, 0xffff0000, v245
v_lshlrev_b32 v28, 16, v246
v_and_b32 v29, 0xffff0000, v246
v_lshlrev_b32 v30, 16, v247
v_and_b32 v31, 0xffff0000, v247
v_lshlrev_b32 v32, 16, v248
v_and_b32 v33, 0xffff0000, v248
v_lshlrev_b32 v34, 16, v249
v_and_b32 v35, 0xffff0000, v249
v_lshlrev_b32 v36, 16, v250
v_and_b32 v37, 0xffff0000, v250
v_lshlrev_b32 v38, 16, v251
v_and_b32 v39, 0xffff0000, v251
v_lshlrev_b32 v40, 16, v252
v_and_b32 v41, 0xffff0000, v252
v_lshlrev_b32 v42, 16, v253
v_and_b32 v43, 0xffff0000, v253
v_lshlrev_b32 v44, 16, v254
v_and_b32 v45, 0xffff0000, v254
v_lshlrev_b32 v46, 16, v255
v_and_b32 v47, 0xffff0000, v255
v_and_b32 v14, 15, v0
v_lshlrev_b32 v14, 11, v14
v_bfe_u32 v15, v0, 4, 1
v_lshl_add_u32 v14, v15, 5, v14
v_lshrrev_b32 v15, 5, v0
v_lshl_add_u32 v14, v15, 4, v14
s_lshl2_add_u32 s70, s61, s58
s_lshl_b32 s70, s70, 16
s_lshl_b32 s71, s62, 7
s_add_u32 s70, s70, s71
s_add_u32 s71, s70, 0x8000
s_lshl_b32 s67, s62, 6
s_sub_u32 s68, s66, 2048
s_lshl1_add_u32 s69, s67, s68
s_sub_u32 s69, s69, 10240
s_sub_u32 s72, s68, s67
s_add_u32 s72, s72, 4096
s_lshl_b32 s75, s73, 5
s_add_u32 s75, s75, 1
v_and_b32 v15, 48, v0
v_add_u32 v13, s75, v0
v_lshlrev_b32 v4, 1, v15
s_mov_b64 exec, 1
s_waitcnt vmcnt(1)
s_cmp_eq_u32 s57, 0
s_cbranch_scc1 far_173
buffer_store_dword v212, v3, s[24:27], s66 offen
near_174:
s_mov_b64 exec, -1
v_add_u32 v5, s34, 23
s_mov_b64 exec, 1
ds_write_b32 v3, v5
s_mov_b64 exec, -1
s_waitcnt vmcnt(1)
buffer_load_dwordx4 v[80:83], v7, s[24:27], s74 offen offset:0 sc1
buffer_load_dwordx4 v[84:87], v7, s[24:27], s74 offen offset:512 sc1
buffer_load_dwordx4 v[88:91], v7, s[24:27], s74 offen offset:1024 sc1
buffer_load_dwordx4 v[92:95], v7, s[24:27], s74 offen offset:1536 sc1
buffer_load_dwordx4 v[96:99], v7, s[24:27], s74 offen offset:2048 sc1
buffer_load_dwordx4 v[100:103], v7, s[24:27], s74 offen offset:2560 sc1
buffer_load_dwordx4 v[104:107], v7, s[24:27], s74 offen offset:3072 sc1
buffer_load_dwordx4 v[108:111], v7, s[24:27], s74 offen offset:3584 sc1
s_cmp_eq_u32 s63, 0
s_cbranch_scc0 mhz_175
v_lshrrev_b32 v196, 4, v0
s_cmp_eq_u32 1, 0
s_cbranch_scc0 mq_176
v_bfe_u32 v197, v0, 1, 3
v_xor_b32 v197, v197, v196
v_lshlrev_b32 v197, 4, v197
v_and_b32 v198, 15, v0
v_lshl_add_u32 v192, v198, 7, v197
v_xor_b32 v193, 64, v192
s_branch mq_177
mq_176:
v_lshlrev_b32 v192, 4, v0
v_add_u32 v193, 1024, v192
mq_177:
s_lshl_b32 s46, s65, 13
s_add_u32 s46, s46, 86016
v_add_u32 v192, s46, v192
v_add_u32 v193, s46, v193
v_bfe_u32 v197, v0, 2, 2
v_lshl_add_u32 v197, v196, 3, v197
v_bfe_u32 v198, v0, 3, 2
s_lshl_b32 s46, s64, 1
v_xor_b32 v198, s46, v198
v_lshlrev_b32 v198, 5, v198
v_lshl_add_u32 v197, v197, 7, v198
v_and_b32 v198, 3, v0
v_lshl_add_u32 v197, v198, 3, v197
v_add_u32 v194, 102400, v197
v_xor_b32 v195, 32, v194
v_mov_b32 v197, 0xf149f2ca
v_xor_b32 v216, v197, v216
v_xor_b32 v217, v197, v217
v_xor_b32 v218, v197, v218
v_xor_b32 v219, v197, v219
v_xor_b32 v220, v197, v220
v_xor_b32 v221, v197, v221
v_xor_b32 v222, v197, v222
v_xor_b32 v223, v197, v223
v_xor_b32 v224, v197, v224
v_xor_b32 v225, v197, v225
v_xor_b32 v226, v197, v226
v_xor_b32 v227, v197, v227
v_xor_b32 v228, v197, v228
v_xor_b32 v229, v197, v229
v_xor_b32 v230, v197, v230
v_xor_b32 v231, v197, v231
v_and_b32 v196, 15, v0
v_lshrrev_b32 v197, 4, v0
s_lshl_b32 s46, s65, 8
s_add_u32 s46, s46, 1280
s_mul_i32 s47, s64, 384
v_lshl_add_u32 v208, v196, 2, s46
v_lshl_add_u32 v209, v197, 4, s46
v_lshl_add_u32 v210, v196, 2, s47
v_lshl_add_u32 v211, v197, 4, s47
v_and_b32 v198, 1, v197
v_lshrrev_b32 v197, 1, v197
v_lshlrev_b32 v197, 9, v197
v_lshl_add_u32 v197, v198, 10, v197
s_lshl_b32 s46, s64, 12
s_lshl_b32 s47, s65, 13
s_add_u32 s46, s46, 131072
s_add_u32 s48, s46, 24576
s_sub_u32 s48, s48, s47
s_add_u32 s47, s46, s47
v_lshl_add_u32 v200, v196, 4, v197
v_and_b32 v198, 3, v0
v_lshl_add_u32 v197, v198, 4, v197
v_bfe_u32 v198, v0, 3, 1
v_lshl_add_u32 v197, v198, 6, v197
v_bfe_u32 v198, v0, 2, 1
v_lshl_add_u32 v198, v198, 8, v197
v_add_u32 v199, s48, v198
v_add_u32 v198, s47, v198
v_add_u32 v201, s48, v200
v_add_u32 v200, s47, v200
s_lshl_b32 s46, s59, 4
s_add_u32 s46, s46, s60
s_lshl_b32 s50, s59, 7
s_add_u32 s50, s50, s60
s_lshl_b32 s50, s50, 7
s_lshl_b32 s46, s46, 15
s_lshl_b32 s47, 1, 23
s_add_u32 s46, s46, s47
s_add_u32 s49, s46, 917504
mhz_175:
s_branch pchk_179
poll_178:
buffer_load_dwordx4 v[80:83], v7, s[24:27], s74 offen offset:0 sc1
buffer_load_dwordx4 v[84:87], v7, s[24:27], s74 offen offset:512 sc1
buffer_load_dwordx4 v[88:91], v7, s[24:27], s74 offen offset:1024 sc1
buffer_load_dwordx4 v[92:95], v7, s[24:27], s74 offen offset:1536 sc1
buffer_load_dwordx4 v[96:99], v7, s[24:27], s74 offen offset:2048 sc1
buffer_load_dwordx4 v[100:103], v7, s[24:27], s74 offen offset:2560 sc1
buffer_load_dwordx4 v[104:107], v7, s[24:27], s74 offen offset:3072 sc1
buffer_load_dwordx4 v[108:111], v7, s[24:27], s74 offen offset:3584 sc1
pchk_179:
s_waitcnt vmcnt(7)
v_min3_u32 v8, v80, v81, v82
s_waitcnt vmcnt(6)
v_min3_u32 v8, v8, v83, v84
v_min3_u32 v8, v8, v85, v86
s_waitcnt vmcnt(5)
v_min3_u32 v8, v8, v87, v88
v_min3_u32 v8, v8, v89, v90
s_waitcnt vmcnt(4)
v_min3_u32 v8, v8, v91, v92
v_min3_u32 v8, v8, v93, v94
s_waitcnt vmcnt(3)
v_min3_u32 v8, v8, v95, v96
v_min3_u32 v8, v8, v97, v98
s_waitcnt vmcnt(2)
v_min3_u32 v8, v8, v99, v100
v_min3_u32 v8, v8, v101, v102
s_waitcnt vmcnt(1)
v_min3_u32 v8, v8, v103, v104
v_min3_u32 v8, v8, v105, v106
s_waitcnt vmcnt(0)
v_min3_u32 v8, v8, v107, v108
v_min3_u32 v8, v8, v109, v110
v_min_u32 v8, v8, v111
v_cmp_eq_u32 vcc, 0, v8
s_cbranch_vccz pdone_180
s_sub_u32 s32, s32, 1
s_cmp_gt_i32 s32, 0
s_cbranch_scc1 poll_178
pdone_180:
v_pk_add_f32 v[80:81], v[80:81], v[96:97]
v_pk_add_f32 v[82:83], v[82:83], v[98:99]
v_pk_add_f32 v[84:85], v[84:85], v[100:101]
v_pk_add_f32 v[86:87], v[86:87], v[102:103]
v_pk_add_f32 v[88:89], v[88:89], v[104:105]
v_pk_add_f32 v[90:91], v[90:91], v[106:107]
v_pk_add_f32 v[92:93], v[92:93], v[108:109]
v_pk_add_f32 v[94:95], v[94:95], v[110:111]
v_pk_add_f32 v[80:81], v[80:81], v[88:89]
v_pk_add_f32 v[82:83], v[82:83], v[90:91]
v_pk_add_f32 v[84:85], v[84:85], v[92:93]
v_pk_add_f32 v[86:87], v[86:87], v[94:95]
v_pk_add_f32 v[80:81], v[80:81], v[84:85]
v_pk_add_f32 v[82:83], v[82:83], v[86:87]
v_mov_b32 v8, v80
v_mov_b32 v9, v81
v_mov_b32 v10, v82
v_mov_b32 v11, v83
v_permlane32_swap_b32 v8, v80
v_permlane32_swap_b32 v9, v81
v_permlane32_swap_b32 v10, v82
v_permlane32_swap_b32 v11, v83
v_pk_add_f32 v[8:9], v[8:9], v[80:81]
v_pk_add_f32 v[10:11], v[10:11], v[82:83]
v_mul_f32 v8, 0xba800000, v8
v_mul_f32 v9, 0x3a800000, v9
v_fma_f32 v9, -v8, v8, v9
v_max_f32 v9, 0, v9
v_add_f32 v12, 0x3727c5ac, v9
v_rsq_f32 v80, v12
v_fma_f32 v10, v8, v11, v10
v_mul_f32 v12, v80, v10
v_max_u32 v12, 1, v12
v_add_u32 v7, s34, v3
v_mov_b32 v6, v12
s_nop 1
v_max_f32_dpp v6, v6, v6 row_ror:1 row_mask:0xf bank_mask:0xf
s_nop 1
v_max_f32_dpp v6, v6, v6 row_ror:2 row_mask:0xf bank_mask:0xf
s_nop 1
v_max_f32_dpp v6, v6, v6 row_ror:4 row_mask:0xf bank_mask:0xf
s_nop 1
v_max_f32_dpp v6, v6, v6 row_ror:8 row_mask:0xf bank_mask:0xf
v_mov_b32 v11, v6
s_nop 1
v_permlane16_swap_b32 v11, v6
v_max_f32 v6, v6, v11
v_cmp_eq_f32 vcc, v6, v12
s_ff1_i32_b64 s66, vcc
s_and_b32 s66, s66, 31
s_mov_b64 exec, 1
ds_write_b32 v7, v6 offset:256
s_mov_b64 exec, -1
v_add_u32 v7, s34, v1
v_mul_f32 v81, v8, v80
v_add_f32 v10, 1.0, v80
v_mov_b32 v82, v80
v_mov_b32 v83, v81
s_and_b32 s67, s66, 15
s_lshl_b32 s67, 0x10001, s67
s_bitcmp0_b32 s66, 4
v_permlane16_swap_b32 v80, v82
v_permlane16_swap_b32 v81, v83
s_cselect_b32 s76, s67, 0
s_cselect_b32 s78, 0, s67
s_cselect_b32 s77, s67, 0
s_cselect_b32 s79, 0, s67
s_add_u32 s75, s75, s66
v_pk_fma_f32 v[48:49], v[16:17], v[80:81], v[80:81] op_sel:[0,0,1] op_sel_hi:[1,0,1]
v_pk_fma_f32 v[50:51], v[18:19], v[80:81], v[80:81] op_sel:[0,0,1] op_sel_hi:[1,0,1]
v_pk_fma_f32 v[52:53], v[20:21], v[80:81], v[80:81] op_sel:[0,0,1] op_sel_hi:[1,0,1]
v_pk_fma_f32 v[54:55], v[22:23], v[80:81], v[80:81] op_sel:[0,0,1] op_sel_hi:[1,0,1]
v_pk_fma_f32 v[56:57], v[24:25], v[80:81], v[80:81] op_sel:[0,0,1] op_sel_hi:[1,0,1]
v_pk_fma_f32 v[58:59], v[26:27], v[80:81], v[80:81] op_sel:[0,0,1] op_sel_hi:[1,0,1]
v_pk_fma_f32 v[60:61], v[28:29], v[80:81], v[80:81] op_sel:[0,0,1] op_sel_hi:[1,0,1]
v_pk_fma_f32 v[62:63], v[30:31], v[80:81], v[80:81] op_sel:[0,0,1] op_sel_hi:[1,0,1]
v_pk_fma_f32 v[64:65], v[32:33], v[82:83], v[82:83] op_sel:[0,0,1] op_sel_hi:[1,0,1]
v_pk_fma_f32 v[66:67], v[34:35], v[82:83], v[82:83] op_sel:[0,0,1] op_sel_hi:[1,0,1]
v_pk_fma_f32 v[68:69], v[36:37], v[82:83], v[82:83] op_sel:[0,0,1] op_sel_hi:[1,0,1]
v_pk_fma_f32 v[70:71], v[38:39], v[82:83], v[82:83] op_sel:[0,0,1] op_sel_hi:[1,0,1]
v_pk_fma_f32 v[72:73], v[40:41], v[82:83], v[82:83] op_sel:[0,0,1] op_sel_hi:[1,0,1]
v_pk_fma_f32 v[74:75], v[42:43], v[82:83], v[82:83] op_sel:[0,0,1] op_sel_hi:[1,0,1]
v_pk_fma_f32 v[76:77], v[44:45], v[82:83], v[82:83] op_sel:[0,0,1] op_sel_hi:[1,0,1]
v_pk_fma_f32 v[78:79], v[46:47], v[82:83], v[82:83] op_sel:[0,0,1] op_sel_hi:[1,0,1]
v_cvt_pk_bf16_f32 v84, v48, v49
v_cvt_pk_bf16_f32 v85, v50, v51
v_cvt_pk_bf16_f32 v86, v52, v53
v_cvt_pk_bf16_f32 v87, v54, v55
v_cvt_pk_bf16_f32 v88, v56, v57
v_cvt_pk_bf16_f32 v89, v58, v59
v_cvt_pk_bf16_f32 v90, v60, v61
v_cvt_pk_bf16_f32 v91, v62, v63
v_cvt_pk_bf16_f32 v92, v64, v65
v_cvt_pk_bf16_f32 v93, v66, v67
v_cvt_pk_bf16_f32 v94, v68, v69
v_cvt_pk_bf16_f32 v95, v70, v71
v_cvt_pk_bf16_f32 v96, v72, v73
v_cvt_pk_bf16_f32 v97, v74, v75
v_cvt_pk_bf16_f32 v98, v76, v77
v_cvt_pk_bf16_f32 v99, v78, v79
ds_read_b32 v11, v7 offset:256
v_max_u32 v84, 1, v84
v_max_u32 v85, 1, v85
v_max_u32 v86, 1, v86
v_max_u32 v87, 1, v87
v_max_u32 v88, 1, v88
v_max_u32 v89, 1, v89
v_max_u32 v90, 1, v90
v_max_u32 v91, 1, v91
v_max_u32 v92, 1, v92
v_max_u32 v93, 1, v93
v_max_u32 v94, 1, v94
v_max_u32 v95, 1, v95
v_max_u32 v96, 1, v96
v_max_u32 v97, 1, v97
v_max_u32 v98, 1, v98
v_max_u32 v99, 1, v99
s_branch pchk_182
poll_181:
ds_read_b32 v11, v7 offset:256
pchk_182:
s_waitcnt lgkmcnt(0)
v_cmp_eq_u32 vcc, 0, v11
s_cbranch_vccz pdone_183
s_sub_u32 s32, s32, 1
s_cmp_gt_i32 s32, 0
s_cbranch_scc1 poll_181
pdone_183:
v_cmp_eq_f32 vcc, v11, v6
s_bfm_b32 s67, s58, 0
s_and_b32 s67, s67, vcc_lo
v_cmp_gt_f32 vcc, v11, v6
s_lshl_b32 s66, 1, s66
s_or_b32 s67, s67, vcc_lo
s_cselect_b64 s[76:77], 0, s[76:77]
s_cselect_b64 s[78:79], 0, s[78:79]
s_cselect_b64 exec, 0, s[66:67]
s_bitcmp0_b32 s62, 0
s_cselect_b64 exec, exec, 0
buffer_store_dwordx2 v[12:13], off, s[24:27], s72 sc1
s_mov_b64 exec, s[76:77]
buffer_store_dwordx4 v[84:87], v4, s[24:27], s68 offen offset:0 sc1
buffer_store_dwordx4 v[88:91], v4, s[24:27], s68 offen offset:16 sc1
s_mov_b64 exec, s[78:79]
buffer_store_dwordx4 v[92:95], v4, s[24:27], s68 offen offset:0 sc1
buffer_store_dwordx4 v[96:99], v4, s[24:27], s68 offen offset:16 sc1
s_mov_b64 exec, -1
v_add_u32 v5, s34, 24
s_mov_b64 exec, 1
ds_write_b32 v3, v5
s_mov_b64 exec, -1
v_pk_add_f32 v[16:17], v[16:17], v[48:49]
v_pk_add_f32 v[18:19], v[18:19], v[50:51]
v_pk_add_f32 v[20:21], v[20:21], v[52:53]
v_pk_add_f32 v[22:23], v[22:23], v[54:55]
v_pk_add_f32 v[24:25], v[24:25], v[56:57]
v_pk_add_f32 v[26:27], v[26:27], v[58:59]
v_pk_add_f32 v[28:29], v[28:29], v[60:61]
v_pk_add_f32 v[30:31], v[30:31], v[62:63]
v_pk_add_f32 v[32:33], v[32:33], v[64:65]
v_pk_add_f32 v[34:35], v[34:35], v[66:67]
v_pk_add_f32 v[36:37], v[36:37], v[68:69]
v_pk_add_f32 v[38:39], v[38:39], v[70:71]
v_pk_add_f32 v[40:41], v[40:41], v[72:73]
v_pk_add_f32 v[42:43], v[42:43], v[74:75]
v_pk_add_f32 v[44:45], v[44:45], v[76:77]
v_pk_add_f32 v[46:47], v[46:47], v[78:79]
v_cvt_pk_bf16_f32 v240, v16, v17
v_cvt_pk_bf16_f32 v241, v18, v19
v_cvt_pk_bf16_f32 v242, v20, v21
v_cvt_pk_bf16_f32 v243, v22, v23
v_cvt_pk_bf16_f32 v244, v24, v25
v_cvt_pk_bf16_f32 v245, v26, v27
v_cvt_pk_bf16_f32 v246, v28, v29
v_cvt_pk_bf16_f32 v247, v30, v31
v_cvt_pk_bf16_f32 v248, v32, v33
v_cvt_pk_bf16_f32 v249, v34, v35
v_cvt_pk_bf16_f32 v250, v36, v37
v_cvt_pk_bf16_f32 v251, v38, v39
v_cvt_pk_bf16_f32 v252, v40, v41
v_cvt_pk_bf16_f32 v253, v42, v43
v_cvt_pk_bf16_f32 v254, v44, v45
v_cvt_pk_bf16_f32 v255, v46, v47
v_max_u32 v16, 1, v16
v_max_u32 v17, 1, v17
v_max_u32 v18, 1, v18
v_max_u32 v19, 1, v19
v_max_u32 v20, 1, v20
v_max_u32 v21, 1, v21
v_max_u32 v22, 1, v22
v_max_u32 v23, 1, v23
v_max_u32 v24, 1, v24
v_max_u32 v25, 1, v25
v_max_u32 v26, 1, v26
v_max_u32 v27, 1, v27
v_max_u32 v28, 1, v28
v_max_u32 v29, 1, v29
v_max_u32 v30, 1, v30
v_max_u32 v31, 1, v31
v_max_u32 v32, 1, v32
v_max_u32 v33, 1, v33
v_max_u32 v34, 1, v34
v_max_u32 v35, 1, v35
v_max_u32 v36, 1, v36
v_max_u32 v37, 1, v37
v_max_u32 v38, 1, v38
v_max_u32 v39, 1, v39
v_max_u32 v40, 1, v40
v_max_u32 v41, 1, v41
v_max_u32 v42, 1, v42
v_max_u32 v43, 1, v43
v_max_u32 v44, 1, v44
v_max_u32 v45, 1, v45
v_max_u32 v46, 1, v46
v_max_u32 v47, 1, v47
s_mov_b64 exec, s[76:77]
buffer_store_dwordx4 v[16:19], v15, s[24:27], s69 offen offset:0 sc1
buffer_store_dwordx4 v[20:23], v15, s[24:27], s69 offen offset:64 sc1
buffer_store_dwordx4 v[24:27], v15, s[24:27], s69 offen offset:128 sc1
buffer_store_dwordx4 v[28:31], v15, s[24:27], s69 offen offset:192 sc1
s_mov_b64 exec, s[78:79]
buffer_store_dwordx4 v[32:35], v15, s[24:27], s69 offen offset:0 sc1
buffer_store_dwordx4 v[36:39], v15, s[24:27], s69 offen offset:64 sc1
buffer_store_dwordx4 v[40:43], v15, s[24:27], s69 offen offset:128 sc1
buffer_store_dwordx4 v[44:47], v15, s[24:27], s69 offen offset:192 sc1
s_mov_b64 exec, -1
s_cmp_eq_u32 s63, 0
s_cbranch_scc0 mout_184
v_mul_f32 v11, v10, v10
v_mov_b32 v12, 0x3727c5ac
v_fma_f32 v11, v11, v9, v12
v_rsq_f32 v11, v11
v_lshrrev_b32 v12, 3, v0
v_lshlrev_b32 v12, 6, v12
v_lshl_add_u32 v12, v0, 3, v12
v_mul_f32 v10, v10, v11
v_mul_f32 v11, v8, v10
s_lshl_b32 s66, s61, 5
s_add_u32 s66, s66, s58
s_lshl_b32 s66, s66, 9
s_add_u32 s66, s66, 1675264
v_max_u32 v11, 1, v11
s_cmp_eq_u32 s62, 8
s_cselect_b32 exec_lo, -1, 0
s_mov_b32 exec_hi, 0
s_cmp_eq_u32 s57, 0
s_cbranch_scc1 far_185
buffer_store_dwordx2 v[10:11], v12, s[24:27], s66 offen
near_186:
s_mov_b64 exec, -1
s_mov_b32 s63, 1
s_mov_b32 s34, 32
s_add_u32 s24, s24, 1409024
s_addc_u32 s25, s25, 0
s_mov_b32 s26, 1409024
s_branch L_mtop
mout_184:
v_permlane16_swap_b32 v240, v242
v_permlane16_swap_b32 v241, v243
v_permlane16_swap_b32 v244, v246
v_permlane16_swap_b32 v245, v247
v_permlane16_swap_b32 v248, v250
v_permlane16_swap_b32 v249, v251
v_permlane16_swap_b32 v252, v254
v_permlane16_swap_b32 v253, v255
s_not_b64 exec, s[76:77]
buffer_store_dwordx4 v[240:243], v14, s[28:31], s70 offen offset:0
buffer_store_dwordx4 v[244:247], v14, s[28:31], s70 offen offset:64
s_not_b64 exec, s[78:79]
buffer_store_dwordx4 v[248:251], v14, s[28:31], s71 offen offset:0
buffer_store_dwordx4 v[252:255], v14, s[28:31], s71 offen offset:64
s_mov_b64 exec, -1
s_or_b32 s66, s76, s78
s_cbranch_scc0 L_end
v_mov_b32 v11, 0
s_add_u32 s35, s34, 4
lw_187:
ds_read_b32 v5, v2 offset:24
s_waitcnt lgkmcnt(0)
v_cmp_gt_i32 vcc, s35, v5
s_cbranch_vccz lwd_188
s_sleep 2
s_sub_u32 s32, s32, 1
s_cmp_gt_i32 s32, 0
s_cbranch_scc1 lw_187
lwd_188:
ds_read_b32 v11, v11 offset:32
s_waitcnt lgkmcnt(0)
v_cmp_eq_u32 vcc, s75, v11
s_cbranch_vccnz L_end
s_mov_b64 exec, s[76:77]
buffer_store_dwordx4 v[240:243], v14, s[28:31], s70 offen offset:0
buffer_store_dwordx4 v[244:247], v14, s[28:31], s70 offen offset:64
s_mov_b64 exec, s[78:79]
buffer_store_dwordx4 v[248:251], v14, s[28:31], s71 offen offset:0
buffer_store_dwordx4 v[252:255], v14, s[28:31], s71 offen offset:64
s_mov_b64 exec, -1
s_branch L_end
mspin_132:
ds_read_b32 v5, v2 offset:16
s_waitcnt lgkmcnt(0)
v_cmp_ge_u32 vcc, v4, v5
s_cbranch_vccz mback_133
s_sub_u32 s32, s32, 1
s_cmp_gt_i32 s32, 0
s_cbranch_scc1 mspin_132
s_branch mback_133
mspin_130:
msp_189:
ds_read_b32 v5, v2 offset:16
s_waitcnt lgkmcnt(0)
v_cmp_ge_u32 vcc, v4, v5
s_cbranch_vccz mback_131
s_sub_u32 s32, s32, 1
s_cmp_gt_i32 s32, 0
s_cbranch_scc1 msp_189
s_branch mback_131
lspin_134:
s_add_u32 s35, s34, 2
lw_190:
ds_read_b32 v5, v2 offset:24
s_waitcnt lgkmcnt(0)
v_cmp_gt_i32 vcc, s35, v5
s_cbranch_vccz lwd_191
s_sub_u32 s32, s32, 1
s_cmp_gt_i32 s32, 0
s_cbranch_scc1 lw_190
lwd_191:
s_branch lback_135
patch_136:
s_bfe_u32 s66, s33, 0x20005
s_lshr_b32 s67, s66, 1
s_xor_b32 s66, s66, s67
s_and_b32 s66, s66, 1
s_cmp_eq_u32 s66, s65
s_cbranch_scc0 pback_137
s_bfe_u32 s66, s33, 0x10004
s_lshl1_add_u32 s73, s67, s66
s_and_b32 s66, s33, 15
s_mov_b32 s74, 0x10001
s_mov_b32 s75, s74
s_lshl_b64 s[74:75], s[74:75], s66
s_and_b32 s66, s66, 12
s_lshl_b32 s66, s66, 2
s_bfm_b64 s[76:77], 16, s66
s_nop 7
s_mov_b64 exec, s[74:75]
s_cmp_eq_u32 s73, 0
s_cbranch_scc0 pnx_193
ds_read_b128 v[16:19], v211 offset:3456
ds_read_b128 v[20:23], v211 offset:3520
s_branch pdn_192
pnx_193:
s_cmp_eq_u32 s73, 1
s_cbranch_scc0 pnx_194
ds_read_b128 v[24:27], v211 offset:3456
ds_read_b128 v[28:31], v211 offset:3520
s_branch pdn_192
pnx_194:
s_cmp_eq_u32 s73, 2
s_cbranch_scc0 pnx_195
ds_read_b128 v[32:35], v211 offset:3456
ds_read_b128 v[36:39], v211 offset:3520
s_branch pdn_192
pnx_195:
ds_read_b128 v[40:43], v211 offset:3456
ds_read_b128 v[44:47], v211 offset:3520
pdn_192:
s_mov_b64 exec, -1
s_waitcnt lgkmcnt(0)
s_branch pback_137
patch_138:
s_nop 7
s_nop 7
s_and_b32 s66, s33, 3
s_lshl2_add_u32 s66, s73, s66
s_mov_b64 exec, s[76:77]
s_cmp_eq_u32 s66, 0
s_cbranch_scc0 pnx_198
ds_read_b32 v48, v210 offset:3584
ds_read_b32 v52, v210 offset:3648
s_branch pdn_197
pnx_198:
s_cmp_eq_u32 s66, 1
s_cbranch_scc0 pnx_199
ds_read_b32 v49, v210 offset:3584
ds_read_b32 v53, v210 offset:3648
s_branch pdn_197
pnx_199:
s_cmp_eq_u32 s66, 2
s_cbranch_scc0 pnx_200
ds_read_b32 v50, v210 offset:3584
ds_read_b32 v54, v210 offset:3648
s_branch pdn_197
pnx_200:
s_cmp_eq_u32 s66, 3
s_cbranch_scc0 pnx_201
ds_read_b32 v51, v210 offset:3584
ds_read_b32 v55, v210 offset:3648
s_branch pdn_197
pnx_201:
s_cmp_eq_u32 s66, 4
s_cbranch_scc0 pnx_202
ds_read_b32 v56, v210 offset:3584
ds_read_b32 v60, v210 offset:3648
s_branch pdn_197
pnx_202:
s_cmp_eq_u32 s66, 5
s_cbranch_scc0 pnx_203
ds_read_b32 v57, v210 offset:3584
ds_read_b32 v61, v210 offset:3648
s_branch pdn_197
pnx_203:
s_cmp_eq_u32 s66, 6
s_cbranch_scc0 pnx_204
ds_read_b32 v58, v210 offset:3584
ds_read_b32 v62, v210 offset:3648
s_branch pdn_197
pnx_204:
s_cmp_eq_u32 s66, 7
s_cbranch_scc0 pnx_205
ds_read_b32 v59, v210 offset:3584
ds_read_b32 v63, v210 offset:3648
s_branch pdn_197
pnx_205:
s_cmp_eq_u32 s66, 8
s_cbranch_scc0 pnx_206
ds_read_b32 v64, v210 offset:3584
ds_read_b32 v68, v210 offset:3648
s_branch pdn_197
pnx_206:
s_cmp_eq_u32 s66, 9
s_cbranch_scc0 pnx_207
ds_read_b32 v65, v210 offset:3584
ds_read_b32 v69, v210 offset:3648
s_branch pdn_197
pnx_207:
s_cmp_eq_u32 s66, 10
s_cbranch_scc0 pnx_208
ds_read_b32 v66, v210 offset:3584
ds_read_b32 v70, v210 offset:3648
s_branch pdn_197
pnx_208:
s_cmp_eq_u32 s66, 11
s_cbranch_scc0 pnx_209
ds_read_b32 v67, v210 offset:3584
ds_read_b32 v71, v210 offset:3648
s_branch pdn_197
pnx_209:
s_cmp_eq_u32 s66, 12
s_cbranch_scc0 pnx_210
ds_read_b32 v72, v210 offset:3584
ds_read_b32 v76, v210 offset:3648
s_branch pdn_197
pnx_210:
s_cmp_eq_u32 s66, 13
s_cbranch_scc0 pnx_211
ds_read_b32 v73, v210 offset:3584
ds_read_b32 v77, v210 offset:3648
s_branch pdn_197
pnx_211:
s_cmp_eq_u32 s66, 14
s_cbranch_scc0 pnx_212
ds_read_b32 v74, v210 offset:3584
ds_read_b32 v78, v210 offset:3648
s_branch pdn_197
pnx_212:
ds_read_b32 v75, v210 offset:3584
ds_read_b32 v79, v210 offset:3648
pdn_197:
s_mov_b64 exec, -1
s_waitcnt lgkmcnt(0)
s_branch pback_139
patch_140:
s_nop 7
s_nop 7
s_mov_b64 exec, s[74:75]
s_cmp_eq_u32 s73, 0
s_cbranch_scc0 pnx_215
ds_read_b128 v[80:83], v211 offset:3328
ds_read_b128 v[84:87], v211 offset:3392
s_branch pdn_214
pnx_215:
s_cmp_eq_u32 s73, 1
s_cbranch_scc0 pnx_216
ds_read_b128 v[88:91], v211 offset:3328
ds_read_b128 v[92:95], v211 offset:3392
s_branch pdn_214
pnx_216:
s_cmp_eq_u32 s73, 2
s_cbranch_scc0 pnx_217
ds_read_b128 v[96:99], v211 offset:3328
ds_read_b128 v[100:103], v211 offset:3392
s_branch pdn_214
pnx_217:
ds_read_b128 v[104:107], v211 offset:3328
ds_read_b128 v[108:111], v211 offset:3392
pdn_214:
s_mov_b64 exec, -1
s_waitcnt lgkmcnt(0)
s_branch pback_141
cross_151:
s_cmp_eq_u32 s67, 122880
s_cbranch_scc0 cr2_219
v_add_u32 v5, s34, 18
s_mov_b64 exec, 1
ds_write_b32 v3, v5
s_mov_b64 exec, -1
v_mov_b32 v9, 0xf149f2ca
v_xor_b32 v216, v9, v216
v_xor_b32 v217, v9, v217
v_xor_b32 v218, v9, v218
v_xor_b32 v219, v9, v219
v_xor_b32 v220, v9, v220
v_xor_b32 v221, v9, v221
v_xor_b32 v222, v9, v222
v_xor_b32 v223, v9, v223
v_xor_b32 v224, v9, v224
v_xor_b32 v225, v9, v225
v_xor_b32 v226, v9, v226
v_xor_b32 v227, v9, v227
v_xor_b32 v228, v9, v228
v_xor_b32 v229, v9, v229
v_xor_b32 v230, v9, v230
v_xor_b32 v231, v9, v231
s_mov_b32 s67, 114688
s_cmp_eq_u32 s63, 0
s_cbranch_scc0 cr3_220
v_and_b32 v9, 15, v0
v_lshlrev_b32 v9, 11, v9
v_bfe_u32 v10, v0, 4, 1
v_lshl_add_u32 v9, v10, 5, v9
v_lshrrev_b32 v10, 5, v0
v_lshl_add_u32 v9, v10, 4, v9
s_lshl2_add_u32 s70, s61, s58
s_lshl_b32 s70, s70, 16
s_lshl_b32 s71, s62, 7
s_add_u32 s70, s70, s71
s_add_u32 s71, s70, 0x8000
buffer_load_dwordx4 v[240:243], v9, s[8:11], s70 offen offset:0
buffer_load_dwordx4 v[244:247], v9, s[8:11], s70 offen offset:64
buffer_load_dwordx4 v[248:251], v9, s[8:11], s71 offen offset:0
buffer_load_dwordx4 v[252:255], v9, s[8:11], s71 offen offset:64
cr3_220:
s_cmp_eq_u32 s59, 0
s_cbranch_scc1 cback_152
v_mov_b32 v9, 0
s_add_u32 s35, s34, 18
lw_221:
ds_read_b32 v5, v9 offset:16
s_waitcnt lgkmcnt(0)
v_cmp_gt_i32 vcc, s35, v5
s_cbranch_vccz lwd_222
s_sub_u32 s32, s32, 1
s_cmp_gt_i32 s32, 0
s_cbranch_scc1 lw_221
lwd_222:
s_branch cback_152
cr2_219:
s_cmp_eq_u32 s67, 114688
s_cbranch_scc0 cr4_223
s_mov_b32 s67, 90112
s_add_u32 s35, s34, 21
lw_224:
ds_read_b32 v5, v9 offset:16
s_waitcnt lgkmcnt(0)
v_cmp_gt_i32 vcc, s35, v5
s_cbranch_vccz lwd_225
s_sub_u32 s32, s32, 1
s_cmp_gt_i32 s32, 0
s_cbranch_scc1 lw_224
lwd_225:
s_branch cback_152
cr4_223:
v_add_u32 v5, s34, 19
s_mov_b64 exec, 1
ds_write_b32 v3, v5
s_mov_b64 exec, -1
s_mov_b32 s66, 28672
s_cmp_lt_u32 s59, 2
s_cbranch_scc1 cback_152
s_add_u32 s35, s34, 21
lw_226:
ds_read_b32 v5, v2 offset:16
s_waitcnt lgkmcnt(0)
v_cmp_gt_i32 vcc, s35, v5
s_cbranch_vccz lwd_227
s_sub_u32 s32, s32, 1
s_cmp_gt_i32 s32, 0
s_cbranch_scc1 lw_226
lwd_227:
s_branch cback_152
cross_153:
s_cmp_eq_u32 s67, 122880
s_cbranch_scc0 cr2_228
v_add_u32 v5, s34, 18
s_mov_b64 exec, 1
ds_write_b32 v3, v5
s_mov_b64 exec, -1
v_mov_b32 v9, 0xf149f2ca
v_xor_b32 v216, v9, v216
v_xor_b32 v217, v9, v217
v_xor_b32 v218, v9, v218
v_xor_b32 v219, v9, v219
v_xor_b32 v220, v9, v220
v_xor_b32 v221, v9, v221
v_xor_b32 v222, v9, v222
v_xor_b32 v223, v9, v223
v_xor_b32 v224, v9, v224
v_xor_b32 v225, v9, v225
v_xor_b32 v226, v9, v226
v_xor_b32 v227, v9, v227
v_xor_b32 v228, v9, v228
v_xor_b32 v229, v9, v229
v_xor_b32 v230, v9, v230
v_xor_b32 v231, v9, v231
s_mov_b32 s67, 114688
s_cmp_eq_u32 s63, 0
s_cbranch_scc0 cr3_229
v_and_b32 v9, 15, v0
v_lshlrev_b32 v9, 11, v9
v_bfe_u32 v10, v0, 4, 1
v_lshl_add_u32 v9, v10, 5, v9
v_lshrrev_b32 v10, 5, v0
v_lshl_add_u32 v9, v10, 4, v9
s_lshl2_add_u32 s70, s61, s58
s_lshl_b32 s70, s70, 16
s_lshl_b32 s71, s62, 7
s_add_u32 s70, s70, s71
s_add_u32 s71, s70, 0x8000
buffer_load_dwordx4 v[240:243], v9, s[8:11], s70 offen offset:0
buffer_load_dwordx4 v[244:247], v9, s[8:11], s70 offen offset:64
buffer_load_dwordx4 v[248:251], v9, s[8:11], s71 offen offset:0
buffer_load_dwordx4 v[252:255], v9, s[8:11], s71 offen offset:64
cr3_229:
s_cmp_eq_u32 s59, 0
s_cbranch_scc1 cback_154
v_mov_b32 v9, 0
s_add_u32 s35, s34, 18
lw_230:
ds_read_b32 v5, v9 offset:16
s_waitcnt lgkmcnt(0)
v_cmp_gt_i32 vcc, s35, v5
s_cbranch_vccz lwd_231
s_sub_u32 s32, s32, 1
s_cmp_gt_i32 s32, 0
s_cbranch_scc1 lw_230
lwd_231:
s_branch cback_154
cr2_228:
s_cmp_eq_u32 s67, 114688
s_cbranch_scc0 cr4_232
s_mov_b32 s67, 90112
s_add_u32 s35, s34, 21
lw_233:
ds_read_b32 v5, v9 offset:16
s_waitcnt lgkmcnt(0)
v_cmp_gt_i32 vcc, s35, v5
s_cbranch_vccz lwd_234
s_sub_u32 s32, s32, 1
s_cmp_gt_i32 s32, 0
s_cbranch_scc1 lw_233
lwd_234:
s_branch cback_154
cr4_232:
v_add_u32 v5, s34, 19
s_mov_b64 exec, 1
ds_write_b32 v3, v5
s_mov_b64 exec, -1
s_mov_b32 s66, 28672
s_cmp_lt_u32 s59, 2
s_cbranch_scc1 cback_154
s_add_u32 s35, s34, 21
lw_235:
ds_read_b32 v5, v2 offset:16
s_waitcnt lgkmcnt(0)
v_cmp_gt_i32 vcc, s35, v5
s_cbranch_vccz lwd_236
s_sub_u32 s32, s32, 1
s_cmp_gt_i32 s32, 0
s_cbranch_scc1 lw_235
lwd_236:
s_branch cback_154
slow_155:
s_add_u32 s70, s72, 270336
poll_237:
buffer_load_dword v10, v1, s[24:27], s70 offen sc1
pchk_238:
s_waitcnt vmcnt(0)
v_cmp_eq_u32 vcc, 0, v10
s_cbranch_vccz pdone_239
s_sub_u32 s32, s32, 1
s_cmp_gt_i32 s32, 0
s_cbranch_scc1 poll_237
pdone_239:
s_lshl_b32 s73, s60, 15
s_lshl_b32 s74, s63, 23
s_add_u32 s73, s73, s74
s_add_u32 s73, s73, 1048576
v_mov_b32 v10, 0xf149f2ca
v_mov_b32 v11, 0
v_mov_b32 v192, 0
v_mov_b32 v193, 0
v_mov_b32 v194, 0
v_mov_b32 v195, 0
v_mov_b32 v196, 0
v_mov_b32 v197, 0
v_mov_b32 v198, 0
v_mov_b32 v199, 0
v_mov_b32 v200, 0
v_mov_b32 v201, 0
v_mov_b32 v202, 0
v_mov_b32 v203, 0
v_mov_b32 v204, 0
v_mov_b32 v205, 0
v_mov_b32 v206, 0
v_mov_b32 v207, 0
v_mov_b32 v208, 0
v_mov_b32 v209, 0
v_mov_b32 v210, 0
v_mov_b32 v211, 0
s_lshl2_add_u32 s74, s59, s65
s_mov_b32 s75, 0
sl_240:
s_lshr_b32 s76, s74, 2
s_lshl_b32 s76, s76, 19
s_and_b32 s77, s74, 3
s_lshl_b32 s77, s77, 13
s_add_u32 s76, s76, s77
s_add_u32 s76, s76, s73
buffer_load_dwordx4 v[152:155], v6, s[20:23], s76 offen offset:0 sc1
buffer_load_dwordx4 v[156:159], v6, s[20:23], s76 offen offset:1024 sc1
s_cmp_eq_u32 s75, 0
s_cselect_b32 s76, 0xf149f2ca, 0
s_and_b32 s77, s75, 7
s_cselect_b32 s77, 0, -1
v_xor_b32 v112, s76, v216
v_and_b32 v112, s77, v112
v_xor_b32 v113, s76, v217
v_and_b32 v113, s77, v113
v_xor_b32 v114, s76, v218
v_and_b32 v114, s77, v114
v_xor_b32 v115, s76, v219
v_and_b32 v115, s77, v115
v_xor_b32 v116, s76, v220
v_and_b32 v116, s77, v116
v_xor_b32 v117, s76, v221
v_and_b32 v117, s77, v117
v_xor_b32 v118, s76, v222
v_and_b32 v118, s77, v118
v_xor_b32 v119, s76, v223
v_and_b32 v119, s77, v119
v_xor_b32 v120, s76, v224
v_and_b32 v120, s77, v120
v_xor_b32 v121, s76, v225
v_and_b32 v121, s77, v121
v_xor_b32 v122, s76, v226
v_and_b32 v122, s77, v122
v_xor_b32 v123, s76, v227
v_and_b32 v123, s77, v123
v_xor_b32 v124, s76, v228
v_and_b32 v124, s77, v124
v_xor_b32 v125, s76, v229
v_and_b32 v125, s77, v125
v_xor_b32 v126, s76, v230
v_and_b32 v126, s77, v126
v_xor_b32 v127, s76, v231
v_and_b32 v127, s77, v127
s_waitcnt vmcnt(1)
s_nop 0
v_mfma_f32_32x32x16_bf16 v[112:127], v[152:155], v[80:83], v[112:127]
s_waitcnt vmcnt(0)
v_mfma_f32_32x32x16_bf16 v[112:127], v[156:159], v[88:91], v[112:127]
s_nop 11
v_max3_f32 v10, v10, v112, v113
v_max3_f32 v10, v10, v114, v115
v_max3_f32 v10, v10, v116, v117
v_max3_f32 v10, v10, v118, v119
v_max3_f32 v10, v10, v120, v121
v_max3_f32 v10, v10, v122, v123
v_max3_f32 v10, v10, v124, v125
v_max3_f32 v10, v10, v126, v127
s_add_u32 s75, s75, 1
s_sub_u32 s74, s74, 1
s_cselect_b32 s75, 9, s75
s_cmp_lt_u32 s75, 9
s_cbranch_scc1 sl_240
v_mov_b32 v11, v10
s_nop 1
v_permlane32_swap_b32 v11, v10
v_max_f32 v10, v10, v11
s_lshl2_add_u32 s74, s59, s65
s_mov_b32 s75, 0
sl_241:
s_lshr_b32 s76, s74, 2
s_lshl_b32 s76, s76, 19
s_and_b32 s77, s74, 3
s_lshl_b32 s77, s77, 13
s_add_u32 s76, s76, s77
s_add_u32 s76, s76, s73
buffer_load_dwordx4 v[152:155], v6, s[20:23], s76 offen offset:0 sc1
buffer_load_dwordx4 v[156:159], v6, s[20:23], s76 offen offset:1024 sc1
buffer_load_dwordx4 v[160:163], v6, s[20:23], s76 offen offset:2048 sc1
buffer_load_dwordx4 v[164:167], v6, s[20:23], s76 offen offset:3072 sc1
s_cmp_eq_u32 s75, 0
s_cselect_b32 s76, 0xf149f2ca, 0
s_and_b32 s77, s75, 7
s_cselect_b32 s77, 0, -1
v_xor_b32 v112, s76, v216
v_and_b32 v112, s77, v112
v_sub_f32 v112, v112, v10
v_xor_b32 v113, s76, v217
v_and_b32 v113, s77, v113
v_sub_f32 v113, v113, v10
v_xor_b32 v114, s76, v218
v_and_b32 v114, s77, v114
v_sub_f32 v114, v114, v10
v_xor_b32 v115, s76, v219
v_and_b32 v115, s77, v115
v_sub_f32 v115, v115, v10
v_xor_b32 v116, s76, v220
v_and_b32 v116, s77, v116
v_sub_f32 v116, v116, v10
v_xor_b32 v117, s76, v221
v_and_b32 v117, s77, v117
v_sub_f32 v117, v117, v10
v_xor_b32 v118, s76, v222
v_and_b32 v118, s77, v118
v_sub_f32 v118, v118, v10
v_xor_b32 v119, s76, v223
v_and_b32 v119, s77, v119
v_sub_f32 v119, v119, v10
v_xor_b32 v120, s76, v224
v_and_b32 v120, s77, v120
v_sub_f32 v120, v120, v10
v_xor_b32 v121, s76, v225
v_and_b32 v121, s77, v121
v_sub_f32 v121, v121, v10
v_xor_b32 v122, s76, v226
v_and_b32 v122, s77, v122
v_sub_f32 v122, v122, v10
v_xor_b32 v123, s76, v227
v_and_b32 v123, s77, v123
v_sub_f32 v123, v123, v10
v_xor_b32 v124, s76, v228
v_and_b32 v124, s77, v124
v_sub_f32 v124, v124, v10
v_xor_b32 v125, s76, v229
v_and_b32 v125, s77, v125
v_sub_f32 v125, v125, v10
v_xor_b32 v126, s76, v230
v_and_b32 v126, s77, v126
v_sub_f32 v126, v126, v10
v_xor_b32 v127, s76, v231
v_and_b32 v127, s77, v127
v_sub_f32 v127, v127, v10
s_waitcnt vmcnt(3)
s_nop 0
v_mfma_f32_32x32x16_bf16 v[112:127], v[152:155], v[80:83], v[112:127]
s_waitcnt vmcnt(2)
v_mfma_f32_32x32x16_bf16 v[112:127], v[156:159], v[88:91], v[112:127]
s_nop 11
v_exp_f32 v112, v112
v_exp_f32 v113, v113
v_exp_f32 v114, v114
v_exp_f32 v115, v115
v_exp_f32 v116, v116
v_exp_f32 v117, v117
v_exp_f32 v118, v118
v_exp_f32 v119, v119
v_exp_f32 v120, v120
v_exp_f32 v121, v121
v_exp_f32 v122, v122
v_exp_f32 v123, v123
v_exp_f32 v124, v124
v_exp_f32 v125, v125
v_exp_f32 v126, v126
v_exp_f32 v127, v127
v_cvt_pk_bf16_f32 v144, v112, v113
v_cvt_pk_bf16_f32 v145, v114, v115
v_cvt_pk_bf16_f32 v146, v116, v117
v_cvt_pk_bf16_f32 v147, v118, v119
v_cvt_pk_bf16_f32 v148, v120, v121
v_cvt_pk_bf16_f32 v149, v122, v123
v_cvt_pk_bf16_f32 v150, v124, v125
v_cvt_pk_bf16_f32 v151, v126, v127
s_waitcnt vmcnt(1)
v_mfma_f32_32x32x16_bf16 v[192:207], v[160:163], v[144:147], v[192:207]
v_mfma_f32_16x16x32_bf16 v[208:211], v[212:215], v[144:147], v[208:211]
s_waitcnt vmcnt(0)
v_mfma_f32_32x32x16_bf16 v[192:207], v[164:167], v[148:151], v[192:207]
v_mfma_f32_16x16x32_bf16 v[208:211], v[212:215], v[148:151], v[208:211]
s_add_u32 s75, s75, 1
s_sub_u32 s74, s74, 1
s_cselect_b32 s75, 9, s75
s_cmp_lt_u32 s75, 9
s_cbranch_scc1 sl_241
v_mov_b32 v10, 0xf149f2ca
v_mov_b32 v11, 0
v_mov_b32 v16, 0
v_mov_b32 v17, 0
v_mov_b32 v18, 0
v_mov_b32 v19, 0
v_mov_b32 v20, 0
v_mov_b32 v21, 0
v_mov_b32 v22, 0
v_mov_b32 v23, 0
v_mov_b32 v24, 0
v_mov_b32 v25, 0
v_mov_b32 v26, 0
v_mov_b32 v27, 0
v_mov_b32 v28, 0
v_mov_b32 v29, 0
v_mov_b32 v30, 0
v_mov_b32 v31, 0
v_mov_b32 v32, 0
v_mov_b32 v33, 0
v_mov_b32 v34, 0
v_mov_b32 v35, 0
s_sub_u32 s74, 3, s65
s_lshl2_add_u32 s74, s59, s74
s_mov_b32 s75, 0
sl_242:
s_lshr_b32 s76, s74, 2
s_lshl_b32 s76, s76, 19
s_and_b32 s77, s74, 3
s_lshl_b32 s77, s77, 13
s_add_u32 s76, s76, s77
s_add_u32 s76, s76, s73
buffer_load_dwordx4 v[152:155], v6, s[20:23], s76 offen offset:0 sc1
buffer_load_dwordx4 v[156:159], v6, s[20:23], s76 offen offset:1024 sc1
s_cmp_eq_u32 s75, 0
s_cselect_b32 s76, 0xf149f2ca, 0
s_and_b32 s77, s75, 7
s_cselect_b32 s77, 0, -1
v_xor_b32 v112, s76, v216
v_and_b32 v112, s77, v112
v_xor_b32 v113, s76, v217
v_and_b32 v113, s77, v113
v_xor_b32 v114, s76, v218
v_and_b32 v114, s77, v114
v_xor_b32 v115, s76, v219
v_and_b32 v115, s77, v115
v_xor_b32 v116, s76, v220
v_and_b32 v116, s77, v116
v_xor_b32 v117, s76, v221
v_and_b32 v117, s77, v117
v_xor_b32 v118, s76, v222
v_and_b32 v118, s77, v118
v_xor_b32 v119, s76, v223
v_and_b32 v119, s77, v119
v_xor_b32 v120, s76, v224
v_and_b32 v120, s77, v120
v_xor_b32 v121, s76, v225
v_and_b32 v121, s77, v121
v_xor_b32 v122, s76, v226
v_and_b32 v122, s77, v122
v_xor_b32 v123, s76, v227
v_and_b32 v123, s77, v123
v_xor_b32 v124, s76, v228
v_and_b32 v124, s77, v124
v_xor_b32 v125, s76, v229
v_and_b32 v125, s77, v125
v_xor_b32 v126, s76, v230
v_and_b32 v126, s77, v126
v_xor_b32 v127, s76, v231
v_and_b32 v127, s77, v127
s_waitcnt vmcnt(1)
s_nop 0
v_mfma_f32_32x32x16_bf16 v[112:127], v[152:155], v[96:99], v[112:127]
s_waitcnt vmcnt(0)
v_mfma_f32_32x32x16_bf16 v[112:127], v[156:159], v[104:107], v[112:127]
s_nop 11
v_max3_f32 v10, v10, v112, v113
v_max3_f32 v10, v10, v114, v115
v_max3_f32 v10, v10, v116, v117
v_max3_f32 v10, v10, v118, v119
v_max3_f32 v10, v10, v120, v121
v_max3_f32 v10, v10, v122, v123
v_max3_f32 v10, v10, v124, v125
v_max3_f32 v10, v10, v126, v127
s_add_u32 s75, s75, 1
s_sub_u32 s74, s74, 1
s_cselect_b32 s75, 9, s75
s_cmp_lt_u32 s75, 9
s_cbranch_scc1 sl_242
v_mov_b32 v11, v10
s_nop 1
v_permlane32_swap_b32 v11, v10
v_max_f32 v10, v10, v11
s_sub_u32 s74, 3, s65
s_lshl2_add_u32 s74, s59, s74
s_mov_b32 s75, 0
sl_243:
s_lshr_b32 s76, s74, 2
s_lshl_b32 s76, s76, 19
s_and_b32 s77, s74, 3
s_lshl_b32 s77, s77, 13
s_add_u32 s76, s76, s77
s_add_u32 s76, s76, s73
buffer_load_dwordx4 v[152:155], v6, s[20:23], s76 offen offset:0 sc1
buffer_load_dwordx4 v[156:159], v6, s[20:23], s76 offen offset:1024 sc1
buffer_load_dwordx4 v[160:163], v6, s[20:23], s76 offen offset:2048 sc1
buffer_load_dwordx4 v[164:167], v6, s[20:23], s76 offen offset:3072 sc1
s_cmp_eq_u32 s75, 0
s_cselect_b32 s76, 0xf149f2ca, 0
s_and_b32 s77, s75, 7
s_cselect_b32 s77, 0, -1
v_xor_b32 v112, s76, v216
v_and_b32 v112, s77, v112
v_sub_f32 v112, v112, v10
v_xor_b32 v113, s76, v217
v_and_b32 v113, s77, v113
v_sub_f32 v113, v113, v10
v_xor_b32 v114, s76, v218
v_and_b32 v114, s77, v114
v_sub_f32 v114, v114, v10
v_xor_b32 v115, s76, v219
v_and_b32 v115, s77, v115
v_sub_f32 v115, v115, v10
v_xor_b32 v116, s76, v220
v_and_b32 v116, s77, v116
v_sub_f32 v116, v116, v10
v_xor_b32 v117, s76, v221
v_and_b32 v117, s77, v117
v_sub_f32 v117, v117, v10
v_xor_b32 v118, s76, v222
v_and_b32 v118, s77, v118
v_sub_f32 v118, v118, v10
v_xor_b32 v119, s76, v223
v_and_b32 v119, s77, v119
v_sub_f32 v119, v119, v10
v_xor_b32 v120, s76, v224
v_and_b32 v120, s77, v120
v_sub_f32 v120, v120, v10
v_xor_b32 v121, s76, v225
v_and_b32 v121, s77, v121
v_sub_f32 v121, v121, v10
v_xor_b32 v122, s76, v226
v_and_b32 v122, s77, v122
v_sub_f32 v122, v122, v10
v_xor_b32 v123, s76, v227
v_and_b32 v123, s77, v123
v_sub_f32 v123, v123, v10
v_xor_b32 v124, s76, v228
v_and_b32 v124, s77, v124
v_sub_f32 v124, v124, v10
v_xor_b32 v125, s76, v229
v_and_b32 v125, s77, v125
v_sub_f32 v125, v125, v10
v_xor_b32 v126, s76, v230
v_and_b32 v126, s77, v126
v_sub_f32 v126, v126, v10
v_xor_b32 v127, s76, v231
v_and_b32 v127, s77, v127
v_sub_f32 v127, v127, v10
s_waitcnt vmcnt(3)
s_nop 0
v_mfma_f32_32x32x16_bf16 v[112:127], v[152:155], v[96:99], v[112:127]
s_waitcnt vmcnt(2)
v_mfma_f32_32x32x16_bf16 v[112:127], v[156:159], v[104:107], v[112:127]
s_nop 11
v_exp_f32 v112, v112
v_exp_f32 v113, v113
v_exp_f32 v114, v114
v_exp_f32 v115, v115
v_exp_f32 v116, v116
v_exp_f32 v117, v117
v_exp_f32 v118, v118
v_exp_f32 v119, v119
v_exp_f32 v120, v120
v_exp_f32 v121, v121
v_exp_f32 v122, v122
v_exp_f32 v123, v123
v_exp_f32 v124, v124
v_exp_f32 v125, v125
v_exp_f32 v126, v126
v_exp_f32 v127, v127
v_cvt_pk_bf16_f32 v144, v112, v113
v_cvt_pk_bf16_f32 v145, v114, v115
v_cvt_pk_bf16_f32 v146, v116, v117
v_cvt_pk_bf16_f32 v147, v118, v119
v_cvt_pk_bf16_f32 v148, v120, v121
v_cvt_pk_bf16_f32 v149, v122, v123
v_cvt_pk_bf16_f32 v150, v124, v125
v_cvt_pk_bf16_f32 v151, v126, v127
s_waitcnt vmcnt(1)
v_mfma_f32_32x32x16_bf16 v[16:31], v[160:163], v[144:147], v[16:31]
v_mfma_f32_16x16x32_bf16 v[32:35], v[212:215], v[144:147], v[32:35]
s_waitcnt vmcnt(0)
v_mfma_f32_32x32x16_bf16 v[16:31], v[164:167], v[148:151], v[16:31]
v_mfma_f32_16x16x32_bf16 v[32:35], v[212:215], v[148:151], v[32:35]
s_add_u32 s75, s75, 1
s_sub_u32 s74, s74, 1
s_cselect_b32 s75, 9, s75
s_cmp_lt_u32 s75, 9
s_cbranch_scc1 sl_243
s_branch sback_156
far_157:
buffer_store_dwordx4 v[16:19], v9, s[20:23], s67 offen offset:0 sc1
buffer_store_dwordx4 v[20:23], v9, s[20:23], s67 offen offset:1024 sc1
s_branch near_158
far_159:
buffer_store_dwordx4 v[192:195], v9, s[20:23], s66 offen offset:0 sc1
buffer_store_dwordx4 v[196:199], v9, s[20:23], s66 offen offset:1024 sc1
s_branch near_160
far_163:
buffer_store_dword v212, v3, s[24:27], s70 offen sc1
s_branch near_164
mo_165:
s_lshr_b32 s67, s33, 5
s_cmp_eq_u32 s67, s66
s_cbranch_scc0 mo_166
s_and_b32 s67, s33, 31
v_sub_u32 v48, s67, v48
v_lshlrev_b32 v49, 4, v49
s_lshl_b32 s67, s62, 14
s_add_u32 s67, s67, 30686208
poll_244:
buffer_load_dwordx4 v[56:59], v49, s[20:23], s67 offen offset:0 sc1
buffer_load_dwordx4 v[60:63], v49, s[20:23], s67 offen offset:64 sc1
pchk_245:
s_waitcnt vmcnt(1)
v_min3_u32 v50, v56, v57, v58
s_waitcnt vmcnt(0)
v_min3_u32 v50, v50, v59, v60
v_min3_u32 v50, v50, v61, v62
v_min_u32 v50, v50, v63
v_cmp_eq_u32 vcc, 0, v50
s_cbranch_vccz pdone_246
s_sub_u32 s32, s32, 1
s_cmp_gt_i32 s32, 0
s_cbranch_scc1 poll_244
pdone_246:
v_cmp_eq_u32 vcc, 0, v48
s_nop 1
v_cndmask_b32 v240, v240, v56, vcc
v_cndmask_b32 v241, v241, v57, vcc
v_cndmask_b32 v242, v242, v58, vcc
v_cndmask_b32 v243, v243, v59, vcc
v_cndmask_b32 v244, v244, v60, vcc
v_cndmask_b32 v245, v245, v61, vcc
v_cndmask_b32 v246, v246, v62, vcc
v_cndmask_b32 v247, v247, v63, vcc
v_cmp_eq_u32 vcc, 16, v48
s_nop 1
v_cndmask_b32 v248, v248, v56, vcc
v_cndmask_b32 v249, v249, v57, vcc
v_cndmask_b32 v250, v250, v58, vcc
v_cndmask_b32 v251, v251, v59, vcc
v_cndmask_b32 v252, v252, v60, vcc
v_cndmask_b32 v253, v253, v61, vcc
v_cndmask_b32 v254, v254, v62, vcc
v_cndmask_b32 v255, v255, v63, vcc
s_branch mo_166
far_169:
buffer_store_dwordx4 v[240:243], v6, s[20:23], s68 offen offset:0 sc1
buffer_store_dwordx4 v[244:247], v6, s[20:23], s68 offen offset:1024 sc1
buffer_store_dwordx4 v[248:251], v6, s[20:23], s68 offen offset:2048 sc1
buffer_store_dwordx4 v[252:255], v6, s[20:23], s68 offen offset:3072 sc1
s_branch near_170
far_171:
buffer_store_dwordx4 v[8:11], v6, s[24:27], s67 offen sc1
s_branch near_172
far_173:
buffer_store_dword v212, v3, s[24:27], s66 offen sc1
s_branch near_174
far_185:
buffer_store_dwordx2 v[10:11], v12, s[24:27], s66 offen sc1
s_branch near_186
L_end:
L_fin:
s_endpgm
.section .rodata,"a"
.p2align 6
.amdhsa_kernel interleave_layers__sliding_block__moe_arch_mod__prompt_kernel
  .amdhsa_next_free_vgpr 256
  .amdhsa_next_free_sgpr 102
  .amdhsa_accum_offset 256
  .amdhsa_group_segment_fixed_size 0
  .amdhsa_kernarg_size 88
  .amdhsa_user_sgpr_count 2
  .amdhsa_user_sgpr_kernarg_segment_ptr 1
  .amdhsa_system_sgpr_workgroup_id_x 1
  .amdhsa_float_denorm_mode_32 3
.end_amdhsa_kernel
```

```asm
; @launch grid=(256,1,1) block=(512,1,1) lds=163840
.amdgcn_target "amdgcn-amd-amdhsa--gfx950"
.text
.globl interleave_layers__sliding_block__moe_arch_mod__prompt_kernel
.p2align 8
.type interleave_layers__sliding_block__moe_arch_mod__prompt_kernel,@function
interleave_layers__sliding_block__moe_arch_mod__prompt_kernel:
s_cmp_ge_u32 s2, 256
s_cbranch_scc1 L_fin
s_load_dwordx16 s[36:51], s[0:1], 0
s_load_dwordx4 s[52:55], s[0:1], 64
s_load_dwordx2 s[56:57], s[0:1], 80
v_lshrrev_b32 v1, 6, v0
v_and_b32 v0, 63, v0
s_and_b32 s64, s2, 7
v_readfirstlane_b32 s3, v1
s_lshr_b32 s65, s2, 3
s_and_b32 s66, s65, 7
s_and_b32 s67, s64, 1
s_lshl3_add_u32 s59, s67, s66
s_lshr_b32 s66, s65, 3
s_lshr_b32 s67, s64, 1
s_lshl2_add_u32 s60, s67, s66
s_and_b32 s66, s65, 1
s_lshl1_add_u32 s61, s64, s66
s_lshr_b32 s62, s65, 1
s_mov_b32 s59, s61
s_xor_b32 s60, s62, 0
s_mov_b32 s63, 0
s_mov_b32 s34, 0
s_mov_b32 s32, 200000
s_mov_b32 s33, -1
s_cmp_ge_u32 s3, 4
s_cselect_b32 s66, 3, 1
s_and_b32 s58, s3, s66
s_waitcnt lgkmcnt(0)
s_mov_b32 s8, s36
s_mov_b32 s9, s37
s_mov_b32 s10, 0x400000
s_mov_b32 s11, 0x00020000
s_mov_b32 s12, s38
s_mov_b32 s13, s39
s_mov_b32 s14, 0x600000
s_mov_b32 s15, 0x00020000
s_mov_b32 s16, s40
s_mov_b32 s17, s41
s_mov_b32 s18, 0x200000
s_mov_b32 s19, 0x00020000
s_mov_b32 s20, s56
s_mov_b32 s21, s57
s_mov_b32 s22, 0x2500000
s_mov_b32 s23, 0x00020000
s_add_u32 s24, s56, 30408704
s_addc_u32 s25, s57, 0
s_mov_b32 s26, 2818048
s_mov_b32 s27, 0x00020000
s_mov_b32 s28, s52
s_mov_b32 s29, s53
s_mov_b32 s30, 0x400000
s_mov_b32 s31, 0x00020000
s_cmp_ge_u32 s3, 4
s_cbranch_scc1 L_m
s_cmp_ge_u32 s3, 2
s_cbranch_scc1 L_f
s_setprio 1
v_and_b32 v22, 7, v0
v_lshrrev_b32 v23, 4, v0
v_lshrrev_b32 v6, 3, v0
v_xor_b32 v7, v22, v23
v_lshlrev_b32 v7, 4, v7
v_lshl_add_u32 v8, v6, 11, v7
v_xor_b32 v7, 64, v8
v_add_u32 v9, 15360, v7
v_add_u32 v10, 30720, v8
v_add_u32 v11, 46080, v7
s_lshl_b32 s70, s59, 18
s_lshl_b32 s71, s58, 16
s_add_u32 s68, s70, s71
s_sub_u32 s69, s70, s71
s_add_u32 s69, s69, 196608
s_mov_b32 s67, 128
s_lshl_b32 s75, s58, 13
s_mov_b32 s65, 86016
s_and_b32 s79, s59, 1
s_mul_i32 s70, s60, 1
s_and_b32 s71, s59, 14
s_add_u32 s70, s70, s71
s_and_b32 s70, s70, 15
s_xor_b32 s64, s70, s79
s_mul_i32 s70, s64, s67
s_add_u32 m0, s65, s75
s_add_u32 s71, s70, s68
buffer_load_dwordx4 v8, s[8:11], s71 offen offset:0 lds
buffer_load_dwordx4 v9, s[8:11], s71 offen offset:1024 lds
buffer_load_dwordx4 v10, s[8:11], s71 offen offset:2048 lds
buffer_load_dwordx4 v11, s[8:11], s71 offen offset:3072 lds
s_add_u32 m0, m0, 4096
s_add_u32 s71, s70, s69
buffer_load_dwordx4 v8, s[8:11], s71 offen offset:0 lds
buffer_load_dwordx4 v9, s[8:11], s71 offen offset:1024 lds
buffer_load_dwordx4 v10, s[8:11], s71 offen offset:2048 lds
buffer_load_dwordx4 v11, s[8:11], s71 offen offset:3072 lds
v_and_b32 v7, 2, v6
v_xor_b32 v7, v7, v22
v_mul_u32_u24 v6, 6144, v6
v_lshl_add_u32 v12, v7, 4, v6
v_xor_b32 v6, 64, v12
v_add_u32 v13, 48128, v6
v_add_u32 v14, 96256, v12
v_add_u32 v15, 144384, v6
s_mul_i32 s76, s58, 12288
s_add_u32 s76, s76, 16384
s_lshl_b32 s70, s60, 7
s_cmp_eq_u32 s58, 0
s_mov_b32 s71, 198656
s_cselect_b32 s72, 0, s71
s_mov_b32 s71, 4096
s_cselect_b32 s73, 196608, s71
s_mov_b32 s71, 200704
s_cselect_b32 s74, 2048, s71
s_add_u32 s72, s72, s70
s_add_u32 s73, s73, s70
s_add_u32 s74, s74, s70
s_mul_i32 s70, s64, 393216
s_add_u32 m0, s65, s76
s_add_u32 s71, s70, s72
buffer_load_dwordx4 v12, s[12:15], s71 offen offset:0 lds
buffer_load_dwordx4 v13, s[12:15], s71 offen offset:1024 lds
buffer_load_dwordx4 v14, s[12:15], s71 offen offset:2048 lds
buffer_load_dwordx4 v15, s[12:15], s71 offen offset:3072 lds
s_add_u32 m0, m0, 4096
s_add_u32 s71, s70, s73
buffer_load_dwordx4 v12, s[12:15], s71 offen offset:0 lds
buffer_load_dwordx4 v13, s[12:15], s71 offen offset:1024 lds
buffer_load_dwordx4 v14, s[12:15], s71 offen offset:2048 lds
buffer_load_dwordx4 v15, s[12:15], s71 offen offset:3072 lds
s_add_u32 m0, m0, 4096
s_add_u32 s71, s70, s74
buffer_load_dwordx4 v12, s[12:15], s71 offen offset:0 lds
buffer_load_dwordx4 v13, s[12:15], s71 offen offset:1024 lds
buffer_load_dwordx4 v14, s[12:15], s71 offen offset:2048 lds
buffer_load_dwordx4 v15, s[12:15], s71 offen offset:3072 lds
s_xor_b32 s64, s64, s79
s_add_u32 s64, s64, 1
s_and_b32 s64, s64, 15
s_xor_b32 s64, s64, s79
s_sub_u32 s65, s65, 40960
s_cselect_b32 s65, 86016, s65
v_and_b32 v1, 3, v0
v_lshlrev_b32 v1, 2, v1
v_and_b32 v2, 4, v1
s_lshl2_add_u32 s35, s58, 16
v_mov_b32 v3, s35
v_lshlrev_b32 v20, 4, v0
v_lshrrev_b32 v6, 2, v0
v_lshl_add_u32 v21, v6, 7, v1
v_lshrrev_b32 v6, 3, v0
v_lshlrev_b32 v23, 1, v23
v_xor_b32 v23, v23, v22
v_lshlrev_b32 v23, 4, v23
v_lshl_add_u32 v23, v6, 11, v23
s_lshl_b32 s70, s62, 7
s_lshl_b32 s71, s58, 16
s_add_u32 s70, s70, s71
v_add_u32 v16, s70, v23
v_add_u32 v17, 15360, v16
v_add_u32 v18, 30720, v16
v_add_u32 v19, 46080, v16
s_add_u32 s77, s61, s62
s_lshl_b32 s77, s77, 17
s_lshl_b32 s78, s58, 12
s_mov_b32 s66, -2
s_barrier
.p2align 4
lq_1:
s_add_u32 s35, s66, 1
lw_4:
ds_read_b32 v5, v1 offset:0
s_waitcnt lgkmcnt(0)
v_cmp_gt_i32 vcc, s35, v5
s_cbranch_vccz lwd_5
s_sub_u32 s32, s32, 1
s_cmp_gt_i32 s32, 0
s_cbranch_scc1 lw_4
lwd_5:
s_cmp_eq_u32 s66, 0
s_cbranch_scc1 lcs_2
lcb_3:
s_mul_i32 s70, s64, s67
s_add_u32 m0, s65, s75
s_add_u32 s71, s70, s68
buffer_load_dwordx4 v8, s[8:11], s71 offen offset:0 sc1 lds
buffer_load_dwordx4 v9, s[8:11], s71 offen offset:1024 sc1 lds
buffer_load_dwordx4 v10, s[8:11], s71 offen offset:2048 sc1 lds
buffer_load_dwordx4 v11, s[8:11], s71 offen offset:3072 sc1 lds
buffer_load_dword v30, off, s[12:15], 0
s_add_u32 m0, m0, 4096
s_add_u32 s71, s70, s69
buffer_load_dwordx4 v8, s[8:11], s71 offen offset:0 sc1 lds
buffer_load_dwordx4 v9, s[8:11], s71 offen offset:1024 sc1 lds
buffer_load_dwordx4 v10, s[8:11], s71 offen offset:2048 sc1 lds
buffer_load_dwordx4 v11, s[8:11], s71 offen offset:3072 sc1 lds
buffer_load_dword v30, off, s[12:15], 0
s_mul_i32 s70, s64, 393216
s_add_u32 m0, s65, s76
s_add_u32 s71, s70, s72
buffer_load_dwordx4 v12, s[12:15], s71 offen offset:0 lds
buffer_load_dwordx4 v13, s[12:15], s71 offen offset:1024 lds
buffer_load_dwordx4 v14, s[12:15], s71 offen offset:2048 lds
buffer_load_dwordx4 v15, s[12:15], s71 offen offset:3072 lds
buffer_load_dword v30, off, s[12:15], 0
v_add_u32 v5, s66, 3
s_mov_b64 exec, 1
s_waitcnt vmcnt(15)
ds_write_b32 v3, v5
s_mov_b64 exec, -1
s_mul_i32 s70, s64, 393216
s_add_u32 m0, m0, 4096
s_add_u32 s71, s70, s73
buffer_load_dwordx4 v12, s[12:15], s71 offen offset:0 lds
buffer_load_dwordx4 v13, s[12:15], s71 offen offset:1024 lds
buffer_load_dwordx4 v14, s[12:15], s71 offen offset:2048 lds
buffer_load_dwordx4 v15, s[12:15], s71 offen offset:3072 lds
buffer_load_dword v30, off, s[12:15], 0
s_mul_i32 s70, s64, 393216
s_add_u32 m0, m0, 4096
s_add_u32 s71, s70, s74
buffer_load_dwordx4 v12, s[12:15], s71 offen offset:0 lds
buffer_load_dwordx4 v13, s[12:15], s71 offen offset:1024 lds
buffer_load_dwordx4 v14, s[12:15], s71 offen offset:2048 lds
buffer_load_dwordx4 v15, s[12:15], s71 offen offset:3072 lds
buffer_load_dword v30, off, s[12:15], 0
s_xor_b32 s64, s64, s79
s_add_u32 s64, s64, 1
s_and_b32 s64, s64, 15
s_xor_b32 s64, s64, s79
s_sub_u32 s65, s65, 40960
s_cselect_b32 s65, 86016, s65
s_add_u32 s66, s66, 1
s_and_b32 s70, s66, 31
s_cmp_eq_u32 s70, 13
s_cbranch_scc0 lq_1
s_waitcnt vmcnt(0)
v_add_u32 v5, s34, 16
s_mov_b64 exec, 1
ds_write_b32 v3, v5
s_mov_b64 exec, -1
s_add_u32 s35, s34, 14
lw_6:
ds_read_b32 v5, v1 offset:0
s_waitcnt lgkmcnt(0)
v_cmp_gt_i32 vcc, s35, v5
s_cbranch_vccz lwd_7
s_sleep 1
s_sub_u32 s32, s32, 1
s_cmp_gt_i32 s32, 0
s_cbranch_scc1 lw_6
lwd_7:
s_add_u32 s70, s77, 262144
s_add_u32 m0, s78, 49152
s_and_b32 s70, s70, 0x1fffff
buffer_load_dwordx4 v16, s[16:19], s70 offen offset:0 lds
buffer_load_dwordx4 v17, s[16:19], s70 offen offset:1024 lds
buffer_load_dwordx4 v18, s[16:19], s70 offen offset:2048 lds
buffer_load_dwordx4 v19, s[16:19], s70 offen offset:3072 lds
buffer_load_dword v30, off, s[12:15], 0
s_add_u32 s70, s77, 393216
s_add_u32 m0, s78, 57344
s_and_b32 s70, s70, 0x1fffff
buffer_load_dwordx4 v16, s[16:19], s70 offen offset:0 lds
buffer_load_dwordx4 v17, s[16:19], s70 offen offset:1024 lds
buffer_load_dwordx4 v18, s[16:19], s70 offen offset:2048 lds
buffer_load_dwordx4 v19, s[16:19], s70 offen offset:3072 lds
buffer_load_dword v30, off, s[12:15], 0
s_add_u32 s70, s77, 524288
s_add_u32 m0, s78, 65536
s_and_b32 s70, s70, 0x1fffff
buffer_load_dwordx4 v16, s[16:19], s70 offen offset:0 lds
buffer_load_dwordx4 v17, s[16:19], s70 offen offset:1024 lds
buffer_load_dwordx4 v18, s[16:19], s70 offen offset:2048 lds
buffer_load_dwordx4 v19, s[16:19], s70 offen offset:3072 lds
buffer_load_dword v30, off, s[12:15], 0
s_add_u32 s70, s77, 655360
s_add_u32 m0, s78, 73728
s_and_b32 s70, s70, 0x1fffff
buffer_load_dwordx4 v16, s[16:19], s70 offen offset:0 lds
buffer_load_dwordx4 v17, s[16:19], s70 offen offset:1024 lds
buffer_load_dwordx4 v18, s[16:19], s70 offen offset:2048 lds
buffer_load_dwordx4 v19, s[16:19], s70 offen offset:3072 lds
buffer_load_dword v30, off, s[12:15], 0
s_sub_u32 s70, s59, s58
s_lshl_b32 s71, s70, 7
s_add_u32 s71, s71, s60
s_lshl4_add_u32 s70, s70, s60
s_sub_u32 s70, s70, 16
s_lshl_b32 s66, s71, 7
s_add_u32 s66, s66, 253952
s_lshl_b32 s70, s70, 15
s_lshl_b32 s71, s63, 23
s_add_u32 s70, s70, s71
s_add_u32 s64, s70, 1077248
s_mul_i32 s65, s58, -94208
s_add_u32 s35, s34, 16
lw_8:
ds_read_b32 v5, v1 offset:0
s_waitcnt lgkmcnt(0)
v_cmp_gt_i32 vcc, s35, v5
s_cbranch_vccz lwd_9
s_sleep 1
s_sub_u32 s32, s32, 1
s_cmp_gt_i32 s32, 0
s_cbranch_scc1 lw_8
lwd_9:
s_add_u32 s35, s34, 17
lw_11:
ds_read_b32 v5, v1 offset:0
s_waitcnt lgkmcnt(0)
v_cmp_gt_i32 vcc, s35, v5
s_cbranch_vccz lwd_12
s_sleep 1
s_sub_u32 s32, s32, 1
s_cmp_gt_i32 s32, 0
s_cbranch_scc1 lw_11
lwd_12:
s_cmp_gt_u32 s59, s58
s_cbranch_scc0 nokv_10
poll_13:
buffer_load_dword v6, v1, s[24:27], s66 offen sc1
pchk_14:
s_waitcnt vmcnt(0)
v_cmp_eq_u32 vcc, 0, v6
s_cbranch_vccz pdone_15
s_sub_u32 s32, s32, 1
s_cmp_gt_i32 s32, 0
s_cbranch_scc1 poll_13
pdone_15:
s_cmp_eq_u32 s58, 0
s_cbranch_scc1 kd_16
v_mov_b32 v7, 0
s_add_u32 s35, s34, 17
lw_17:
ds_read_b32 v5, v7 offset:16
s_waitcnt lgkmcnt(0)
v_cmp_gt_i32 vcc, s35, v5
s_cbranch_vccz lwd_18
s_sleep 1
s_sub_u32 s32, s32, 1
s_cmp_gt_i32 s32, 0
s_cbranch_scc1 lw_17
lwd_18:
kd_16:
s_add_u32 m0, s65, 126976
s_nop 0
buffer_load_dwordx4 v20, s[20:23], s64 offen offset:0 sc1 lds
buffer_load_dwordx4 v20, s[20:23], s64 offen offset:1024 sc1 lds
buffer_load_dwordx4 v20, s[20:23], s64 offen offset:2048 sc1 lds
buffer_load_dwordx4 v20, s[20:23], s64 offen offset:3072 sc1 lds
buffer_load_dword v30, off, s[12:15], 0
s_add_u32 m0, s65, 122880
s_sub_u32 s64, s64, 4096
buffer_load_dwordx4 v20, s[20:23], s64 offen offset:0 sc1 lds
buffer_load_dwordx4 v20, s[20:23], s64 offen offset:1024 sc1 lds
buffer_load_dwordx4 v20, s[20:23], s64 offen offset:2048 sc1 lds
buffer_load_dwordx4 v20, s[20:23], s64 offen offset:3072 sc1 lds
buffer_load_dword v30, off, s[12:15], 0
s_add_u32 m0, s65, 118784
s_sub_u32 s64, s64, 4096
buffer_load_dwordx4 v20, s[20:23], s64 offen offset:0 sc1 lds
buffer_load_dwordx4 v20, s[20:23], s64 offen offset:1024 sc1 lds
buffer_load_dwordx4 v20, s[20:23], s64 offen offset:2048 sc1 lds
buffer_load_dwordx4 v20, s[20:23], s64 offen offset:3072 sc1 lds
buffer_load_dword v30, off, s[12:15], 0
s_add_u32 m0, s65, 114688
s_sub_u32 s64, s64, 4096
buffer_load_dwordx4 v20, s[20:23], s64 offen offset:0 sc1 lds
buffer_load_dwordx4 v20, s[20:23], s64 offen offset:1024 sc1 lds
buffer_load_dwordx4 v20, s[20:23], s64 offen offset:2048 sc1 lds
buffer_load_dwordx4 v20, s[20:23], s64 offen offset:3072 sc1 lds
buffer_load_dword v30, off, s[12:15], 0
s_add_u32 m0, s65, 110592
s_sub_u32 s64, s64, 4096
buffer_load_dwordx4 v20, s[20:23], s64 offen offset:0 sc1 lds
buffer_load_dwordx4 v20, s[20:23], s64 offen offset:1024 sc1 lds
buffer_load_dwordx4 v20, s[20:23], s64 offen offset:2048 sc1 lds
buffer_load_dwordx4 v20, s[20:23], s64 offen offset:3072 sc1 lds
buffer_load_dword v30, off, s[12:15], 0
s_add_u32 m0, s65, 106496
s_sub_u32 s64, s64, 4096
buffer_load_dwordx4 v20, s[20:23], s64 offen offset:0 sc1 lds
buffer_load_dwordx4 v20, s[20:23], s64 offen offset:1024 sc1 lds
buffer_load_dwordx4 v20, s[20:23], s64 offen offset:2048 sc1 lds
buffer_load_dwordx4 v20, s[20:23], s64 offen offset:3072 sc1 lds
buffer_load_dword v30, off, s[12:15], 0
s_add_u32 m0, s65, 102400
s_sub_u32 s64, s64, 4096
buffer_load_dwordx4 v20, s[20:23], s64 offen offset:0 sc1 lds
buffer_load_dwordx4 v20, s[20:23], s64 offen offset:1024 sc1 lds
buffer_load_dwordx4 v20, s[20:23], s64 offen offset:2048 sc1 lds
buffer_load_dwordx4 v20, s[20:23], s64 offen offset:3072 sc1 lds
buffer_load_dword v30, off, s[12:15], 0
s_add_u32 m0, s65, 98304
s_sub_u32 s64, s64, 4096
buffer_load_dwordx4 v20, s[20:23], s64 offen offset:0 sc1 lds
buffer_load_dwordx4 v20, s[20:23], s64 offen offset:1024 sc1 lds
buffer_load_dwordx4 v20, s[20:23], s64 offen offset:2048 sc1 lds
buffer_load_dwordx4 v20, s[20:23], s64 offen offset:3072 sc1 lds
buffer_load_dword v30, off, s[12:15], 0
v_add_u32 v5, s34, 17
s_mov_b64 exec, 1
ds_write_b32 v3, v5
s_mov_b64 exec, -1
s_waitcnt vmcnt(30)
v_add_u32 v5, s34, 18
s_mov_b64 exec, 1
ds_write_b32 v3, v5
s_mov_b64 exec, -1
nokv_10:
s_lshl_b32 s66, s61, 14
s_add_u32 s66, s66, 268288
s_waitcnt vmcnt(0)
v_add_u32 v5, s34, 21
s_mov_b64 exec, 1
ds_write_b32 v3, v5
s_mov_b64 exec, -1
s_add_u32 s70, s77, 131072
s_add_u32 m0, s78, 40960
s_and_b32 s70, s70, 0x1fffff
buffer_load_dwordx4 v16, s[16:19], s70 offen offset:0 lds
buffer_load_dwordx4 v17, s[16:19], s70 offen offset:1024 lds
buffer_load_dwordx4 v18, s[16:19], s70 offen offset:2048 lds
buffer_load_dwordx4 v19, s[16:19], s70 offen offset:3072 lds
buffer_load_dword v30, off, s[12:15], 0
s_add_u32 s70, s77, 786432
s_add_u32 m0, s78, 81920
s_and_b32 s70, s70, 0x1fffff
buffer_load_dwordx4 v16, s[16:19], s70 offen offset:0 lds
buffer_load_dwordx4 v17, s[16:19], s70 offen offset:1024 lds
buffer_load_dwordx4 v18, s[16:19], s70 offen offset:2048 lds
buffer_load_dwordx4 v19, s[16:19], s70 offen offset:3072 lds
buffer_load_dword v30, off, s[12:15], 0
s_add_u32 s70, s77, 917504
s_add_u32 m0, s78, 90112
s_and_b32 s70, s70, 0x1fffff
buffer_load_dwordx4 v16, s[16:19], s70 offen offset:0 lds
buffer_load_dwordx4 v17, s[16:19], s70 offen offset:1024 lds
buffer_load_dwordx4 v18, s[16:19], s70 offen offset:2048 lds
buffer_load_dwordx4 v19, s[16:19], s70 offen offset:3072 lds
buffer_load_dword v30, off, s[12:15], 0
s_add_u32 s35, s34, 18
lw_20:
ds_read_b32 v5, v1 offset:0
s_waitcnt lgkmcnt(0)
v_cmp_gt_i32 vcc, s35, v5
s_cbranch_vccz lwd_21
s_sleep 1
s_sub_u32 s32, s32, 1
s_cmp_gt_i32 s32, 0
s_cbranch_scc1 lw_20
lwd_21:
s_add_u32 s70, s77, 1572864
s_add_u32 m0, s78, 131072
s_and_b32 s70, s70, 0x1fffff
buffer_load_dwordx4 v16, s[16:19], s70 offen offset:0 lds
buffer_load_dwordx4 v17, s[16:19], s70 offen offset:1024 lds
buffer_load_dwordx4 v18, s[16:19], s70 offen offset:2048 lds
buffer_load_dwordx4 v19, s[16:19], s70 offen offset:3072 lds
buffer_load_dword v30, off, s[12:15], 0
s_add_u32 s70, s77, 1703936
s_add_u32 m0, s78, 139264
s_and_b32 s70, s70, 0x1fffff
buffer_load_dwordx4 v16, s[16:19], s70 offen offset:0 lds
buffer_load_dwordx4 v17, s[16:19], s70 offen offset:1024 lds
buffer_load_dwordx4 v18, s[16:19], s70 offen offset:2048 lds
buffer_load_dwordx4 v19, s[16:19], s70 offen offset:3072 lds
buffer_load_dword v30, off, s[12:15], 0
s_add_u32 s70, s77, 1835008
s_add_u32 m0, s78, 147456
s_and_b32 s70, s70, 0x1fffff
buffer_load_dwordx4 v16, s[16:19], s70 offen offset:0 lds
buffer_load_dwordx4 v17, s[16:19], s70 offen offset:1024 lds
buffer_load_dwordx4 v18, s[16:19], s70 offen offset:2048 lds
buffer_load_dwordx4 v19, s[16:19], s70 offen offset:3072 lds
buffer_load_dword v30, off, s[12:15], 0
s_add_u32 s70, s77, 1966080
s_add_u32 m0, s78, 155648
s_and_b32 s70, s70, 0x1fffff
buffer_load_dwordx4 v16, s[16:19], s70 offen offset:0 lds
buffer_load_dwordx4 v17, s[16:19], s70 offen offset:1024 lds
buffer_load_dwordx4 v18, s[16:19], s70 offen offset:2048 lds
buffer_load_dwordx4 v19, s[16:19], s70 offen offset:3072 lds
buffer_load_dword v30, off, s[12:15], 0
s_add_u32 s35, s34, 19
lw_22:
ds_read_b32 v5, v1 offset:0
s_waitcnt lgkmcnt(0)
v_cmp_gt_i32 vcc, s35, v5
s_cbranch_vccz lwd_23
s_sleep 2
s_sub_u32 s32, s32, 1
s_cmp_gt_i32 s32, 0
s_cbranch_scc1 lw_22
lwd_23:
s_add_u32 s70, s77, 1048576
s_add_u32 m0, s78, 98304
s_and_b32 s70, s70, 0x1fffff
buffer_load_dwordx4 v16, s[16:19], s70 offen offset:0 lds
buffer_load_dwordx4 v17, s[16:19], s70 offen offset:1024 lds
buffer_load_dwordx4 v18, s[16:19], s70 offen offset:2048 lds
buffer_load_dwordx4 v19, s[16:19], s70 offen offset:3072 lds
buffer_load_dword v30, off, s[12:15], 0
s_add_u32 s70, s77, 1179648
s_add_u32 m0, s78, 106496
s_and_b32 s70, s70, 0x1fffff
buffer_load_dwordx4 v16, s[16:19], s70 offen offset:0 lds
buffer_load_dwordx4 v17, s[16:19], s70 offen offset:1024 lds
buffer_load_dwordx4 v18, s[16:19], s70 offen offset:2048 lds
buffer_load_dwordx4 v19, s[16:19], s70 offen offset:3072 lds
buffer_load_dword v30, off, s[12:15], 0
s_add_u32 s70, s77, 1310720
s_add_u32 m0, s78, 114688
s_and_b32 s70, s70, 0x1fffff
buffer_load_dwordx4 v16, s[16:19], s70 offen offset:0 lds
buffer_load_dwordx4 v17, s[16:19], s70 offen offset:1024 lds
buffer_load_dwordx4 v18, s[16:19], s70 offen offset:2048 lds
buffer_load_dwordx4 v19, s[16:19], s70 offen offset:3072 lds
buffer_load_dword v30, off, s[12:15], 0
s_add_u32 s70, s77, 1441792
s_add_u32 m0, s78, 122880
s_and_b32 s70, s70, 0x1fffff
buffer_load_dwordx4 v16, s[16:19], s70 offen offset:0 lds
buffer_load_dwordx4 v17, s[16:19], s70 offen offset:1024 lds
buffer_load_dwordx4 v18, s[16:19], s70 offen offset:2048 lds
buffer_load_dwordx4 v19, s[16:19], s70 offen offset:3072 lds
buffer_load_dword v30, off, s[12:15], 0
s_add_u32 s35, s34, 20
lw_24:
ds_read_b32 v5, v1 offset:0
s_waitcnt lgkmcnt(0)
v_cmp_gt_i32 vcc, s35, v5
s_cbranch_vccz lwd_25
s_sleep 2
s_sub_u32 s32, s32, 1
s_cmp_gt_i32 s32, 0
s_cbranch_scc1 lw_24
lwd_25:
s_add_u32 s70, s77, 0
s_add_u32 m0, s78, 32768
s_and_b32 s70, s70, 0x1fffff
buffer_load_dwordx4 v16, s[16:19], s70 offen offset:0 lds
buffer_load_dwordx4 v17, s[16:19], s70 offen offset:1024 lds
buffer_load_dwordx4 v18, s[16:19], s70 offen offset:2048 lds
buffer_load_dwordx4 v19, s[16:19], s70 offen offset:3072 lds
buffer_load_dword v30, off, s[12:15], 0
s_cmp_eq_u32 s58, 0
s_cbranch_scc0 nofo_19
s_add_u32 s35, s34, 21
lw_26:
ds_read_b32 v5, v1 offset:0
s_waitcnt lgkmcnt(0)
v_cmp_gt_i32 vcc, s35, v5
s_cbranch_vccz lwd_27
s_sleep 1
s_sub_u32 s32, s32, 1
s_cmp_gt_i32 s32, 0
s_cbranch_scc1 lw_26
lwd_27:
poll_28:
buffer_load_dword v6, v21, s[24:27], s66 offen sc1
pchk_29:
s_waitcnt vmcnt(0)
v_cmp_eq_u32 vcc, 0, v6
s_cbranch_vccz pdone_30
s_sub_u32 s32, s32, 1
s_cmp_gt_i32 s32, 0
s_cbranch_scc1 poll_28
pdone_30:
nofo_19:
s_waitcnt vmcnt(0)
v_add_u32 v5, s34, 22
s_mov_b64 exec, 1
ds_write_b32 v3, v5
s_mov_b64 exec, -1
s_cmp_eq_u32 s63, 0
s_cbranch_scc0 L_end
v_bfe_u32 v6, v0, 3, 2
v_and_b32 v7, 2, v6
v_xor_b32 v7, v7, v22
v_lshrrev_b32 v23, 5, v0
v_lshl_add_u32 v6, v23, 4, v6
v_mul_u32_u24 v6, 6144, v6
v_lshl_add_u32 v12, v7, 4, v6
v_xor_b32 v6, 64, v12
v_add_u32 v13, 23552, v6
v_add_u32 v14, 47104, v12
v_add_u32 v15, 70656, v6
v_mov_b32 v8, v20
v_mov_b32 v9, v20
v_mov_b32 v10, v20
v_mov_b32 v11, v20
s_mov_b32 s8, s56
s_mov_b32 s9, s57
s_mov_b32 s10, 0x2500000
s_mov_b32 s11, 0x00020000
s_lshl_b32 s70, s59, 18
s_add_u32 s70, s70, 26214400
s_add_u32 s68, s70, s78
s_sub_u32 s69, s70, s78
s_add_u32 s69, s69, 12288
s_mov_b32 s67, 16384
s_lshl_b32 s66, s59, 14
s_add_u32 s66, s66, 274432
s_and_b32 s79, s59, 1
s_mul_i32 s79, s79, 1
s_mul_i32 s70, s60, 1
s_and_b32 s71, s59, 14
s_add_u32 s70, s70, s71
s_and_b32 s70, s70, 15
s_xor_b32 s64, s70, s79
s_mov_b32 s65, 86016
s_add_u32 s35, s34, 22
lw_31:
ds_read_b32 v5, v1 offset:0
s_waitcnt lgkmcnt(0)
v_cmp_gt_i32 vcc, s35, v5
s_cbranch_vccz lwd_32
s_sleep 2
s_sub_u32 s32, s32, 1
s_cmp_gt_i32 s32, 0
s_cbranch_scc1 lw_31
lwd_32:
s_mul_i32 s70, s64, 393216
s_add_u32 m0, s65, s76
s_add_u32 s71, s70, s72
buffer_load_dwordx4 v12, s[12:15], s71 offen offset:0 lds
buffer_load_dwordx4 v13, s[12:15], s71 offen offset:1024 lds
buffer_load_dwordx4 v14, s[12:15], s71 offen offset:2048 lds
buffer_load_dwordx4 v15, s[12:15], s71 offen offset:3072 lds
buffer_load_dword v30, off, s[12:15], 0
s_add_u32 m0, m0, 4096
s_add_u32 s71, s70, s73
buffer_load_dwordx4 v12, s[12:15], s71 offen offset:0 lds
buffer_load_dwordx4 v13, s[12:15], s71 offen offset:1024 lds
buffer_load_dwordx4 v14, s[12:15], s71 offen offset:2048 lds
buffer_load_dwordx4 v15, s[12:15], s71 offen offset:3072 lds
buffer_load_dword v30, off, s[12:15], 0
s_add_u32 m0, m0, 4096
s_add_u32 s71, s70, s74
buffer_load_dwordx4 v12, s[12:15], s71 offen offset:0 lds
buffer_load_dwordx4 v13, s[12:15], s71 offen offset:1024 lds
buffer_load_dwordx4 v14, s[12:15], s71 offen offset:2048 lds
buffer_load_dwordx4 v15, s[12:15], s71 offen offset:3072 lds
buffer_load_dword v30, off, s[12:15], 0
s_and_b32 s79, s59, 1
s_mul_i32 s79, s79, 1
s_mul_i32 s70, s60, 1
s_and_b32 s71, s59, 14
s_add_u32 s70, s70, s71
s_and_b32 s70, s70, 15
s_xor_b32 s64, s70, s79
s_mov_b32 s65, 86016
s_add_u32 s35, s34, 23
lw_33:
ds_read_b32 v5, v1 offset:0
s_waitcnt lgkmcnt(0)
v_cmp_gt_i32 vcc, s35, v5
s_cbranch_vccz lwd_34
s_sleep 1
s_sub_u32 s32, s32, 1
s_cmp_gt_i32 s32, 0
s_cbranch_scc1 lw_33
lwd_34:
poll_35:
buffer_load_dword v6, v21, s[24:27], s66 offen sc1
pchk_36:
s_waitcnt vmcnt(0)
v_cmp_eq_u32 vcc, 0, v6
s_cbranch_vccz pdone_37
s_sub_u32 s32, s32, 1
s_cmp_gt_i32 s32, 0
s_cbranch_scc1 poll_35
pdone_37:
s_mul_i32 s70, s64, s67
s_add_u32 m0, s65, s75
s_add_u32 s71, s70, s68
buffer_load_dwordx4 v8, s[8:11], s71 offen offset:0 sc1 lds
buffer_load_dwordx4 v9, s[8:11], s71 offen offset:1024 sc1 lds
buffer_load_dwordx4 v10, s[8:11], s71 offen offset:2048 sc1 lds
buffer_load_dwordx4 v11, s[8:11], s71 offen offset:3072 sc1 lds
buffer_load_dword v30, off, s[12:15], 0
s_add_u32 m0, m0, 4096
s_add_u32 s71, s70, s69
buffer_load_dwordx4 v8, s[8:11], s71 offen offset:0 sc1 lds
buffer_load_dwordx4 v9, s[8:11], s71 offen offset:1024 sc1 lds
buffer_load_dwordx4 v10, s[8:11], s71 offen offset:2048 sc1 lds
buffer_load_dwordx4 v11, s[8:11], s71 offen offset:3072 sc1 lds
buffer_load_dword v30, off, s[12:15], 0
s_xor_b32 s64, s64, s79
s_add_u32 s64, s64, 1
s_and_b32 s64, s64, 15
s_xor_b32 s64, s64, s79
s_sub_u32 s65, s65, 40960
s_cselect_b32 s65, 86016, s65
s_mul_i32 s70, s64, s67
s_add_u32 m0, s65, s75
s_add_u32 s71, s70, s68
buffer_load_dwordx4 v8, s[8:11], s71 offen offset:0 sc1 lds
buffer_load_dwordx4 v9, s[8:11], s71 offen offset:1024 sc1 lds
buffer_load_dwordx4 v10, s[8:11], s71 offen offset:2048 sc1 lds
buffer_load_dwordx4 v11, s[8:11], s71 offen offset:3072 sc1 lds
buffer_load_dword v30, off, s[12:15], 0
s_add_u32 m0, m0, 4096
s_add_u32 s71, s70, s69
buffer_load_dwordx4 v8, s[8:11], s71 offen offset:0 sc1 lds
buffer_load_dwordx4 v9, s[8:11], s71 offen offset:1024 sc1 lds
buffer_load_dwordx4 v10, s[8:11], s71 offen offset:2048 sc1 lds
buffer_load_dwordx4 v11, s[8:11], s71 offen offset:3072 sc1 lds
buffer_load_dword v30, off, s[12:15], 0
s_mul_i32 s70, s64, 393216
s_add_u32 m0, s65, s76
s_add_u32 s71, s70, s72
buffer_load_dwordx4 v12, s[12:15], s71 offen offset:0 lds
buffer_load_dwordx4 v13, s[12:15], s71 offen offset:1024 lds
buffer_load_dwordx4 v14, s[12:15], s71 offen offset:2048 lds
buffer_load_dwordx4 v15, s[12:15], s71 offen offset:3072 lds
buffer_load_dword v30, off, s[12:15], 0
s_add_u32 m0, m0, 4096
s_add_u32 s71, s70, s73
buffer_load_dwordx4 v12, s[12:15], s71 offen offset:0 lds
buffer_load_dwordx4 v13, s[12:15], s71 offen offset:1024 lds
buffer_load_dwordx4 v14, s[12:15], s71 offen offset:2048 lds
buffer_load_dwordx4 v15, s[12:15], s71 offen offset:3072 lds
buffer_load_dword v30, off, s[12:15], 0
s_add_u32 m0, m0, 4096
s_add_u32 s71, s70, s74
buffer_load_dwordx4 v12, s[12:15], s71 offen offset:0 lds
buffer_load_dwordx4 v13, s[12:15], s71 offen offset:1024 lds
buffer_load_dwordx4 v14, s[12:15], s71 offen offset:2048 lds
buffer_load_dwordx4 v15, s[12:15], s71 offen offset:3072 lds
buffer_load_dword v30, off, s[12:15], 0
s_xor_b32 s64, s64, s79
s_add_u32 s64, s64, 1
s_and_b32 s64, s64, 15
s_xor_b32 s64, s64, s79
s_sub_u32 s65, s65, 40960
s_cselect_b32 s65, 86016, s65
s_mul_i32 s70, s64, s67
s_add_u32 m0, s65, s75
s_add_u32 s71, s70, s68
buffer_load_dwordx4 v8, s[8:11], s71 offen offset:0 sc1 lds
buffer_load_dwordx4 v9, s[8:11], s71 offen offset:1024 sc1 lds
buffer_load_dwordx4 v10, s[8:11], s71 offen offset:2048 sc1 lds
buffer_load_dwordx4 v11, s[8:11], s71 offen offset:3072 sc1 lds
buffer_load_dword v30, off, s[12:15], 0
s_add_u32 m0, m0, 4096
s_add_u32 s71, s70, s69
buffer_load_dwordx4 v8, s[8:11], s71 offen offset:0 sc1 lds
buffer_load_dwordx4 v9, s[8:11], s71 offen offset:1024 sc1 lds
buffer_load_dwordx4 v10, s[8:11], s71 offen offset:2048 sc1 lds
buffer_load_dwordx4 v11, s[8:11], s71 offen offset:3072 sc1 lds
buffer_load_dword v30, off, s[12:15], 0
s_mul_i32 s70, s64, 393216
s_add_u32 m0, s65, s76
s_add_u32 s71, s70, s72
buffer_load_dwordx4 v12, s[12:15], s71 offen offset:0 lds
buffer_load_dwordx4 v13, s[12:15], s71 offen offset:1024 lds
buffer_load_dwordx4 v14, s[12:15], s71 offen offset:2048 lds
buffer_load_dwordx4 v15, s[12:15], s71 offen offset:3072 lds
buffer_load_dword v30, off, s[12:15], 0
s_add_u32 m0, m0, 4096
s_add_u32 s71, s70, s73
buffer_load_dwordx4 v12, s[12:15], s71 offen offset:0 lds
buffer_load_dwordx4 v13, s[12:15], s71 offen offset:1024 lds
buffer_load_dwordx4 v14, s[12:15], s71 offen offset:2048 lds
buffer_load_dwordx4 v15, s[12:15], s71 offen offset:3072 lds
buffer_load_dword v30, off, s[12:15], 0
s_add_u32 m0, m0, 4096
s_add_u32 s71, s70, s74
buffer_load_dwordx4 v12, s[12:15], s71 offen offset:0 lds
buffer_load_dwordx4 v13, s[12:15], s71 offen offset:1024 lds
buffer_load_dwordx4 v14, s[12:15], s71 offen offset:2048 lds
buffer_load_dwordx4 v15, s[12:15], s71 offen offset:3072 lds
buffer_load_dword v30, off, s[12:15], 0
s_xor_b32 s64, s64, s79
s_add_u32 s64, s64, 1
s_and_b32 s64, s64, 15
s_xor_b32 s64, s64, s79
s_sub_u32 s65, s65, 40960
s_cselect_b32 s65, 86016, s65
s_waitcnt vmcnt(50)
v_add_u32 v5, s34, 33
s_mov_b64 exec, 1
ds_write_b32 v3, v5
s_mov_b64 exec, -1
s_mov_b32 s36, s64
s_mov_b32 s37, s65
s_mov_b32 s64, s59
s_mov_b32 s65, 114688
s_mul_i32 s70, s64, 393216
s_add_u32 m0, s65, s76
s_add_u32 s71, s70, s72
buffer_load_dwordx4 v12, s[12:15], s71 offen offset:0 lds
buffer_load_dwordx4 v13, s[12:15], s71 offen offset:1024 lds
buffer_load_dwordx4 v14, s[12:15], s71 offen offset:2048 lds
buffer_load_dwordx4 v15, s[12:15], s71 offen offset:3072 lds
buffer_load_dword v30, off, s[12:15], 0
s_add_u32 m0, m0, 4096
s_add_u32 s71, s70, s73
buffer_load_dwordx4 v12, s[12:15], s71 offen offset:0 lds
buffer_load_dwordx4 v13, s[12:15], s71 offen offset:1024 lds
buffer_load_dwordx4 v14, s[12:15], s71 offen offset:2048 lds
buffer_load_dwordx4 v15, s[12:15], s71 offen offset:3072 lds
buffer_load_dword v30, off, s[12:15], 0
s_add_u32 m0, m0, 4096
s_add_u32 s71, s70, s74
buffer_load_dwordx4 v12, s[12:15], s71 offen offset:0 lds
buffer_load_dwordx4 v13, s[12:15], s71 offen offset:1024 lds
buffer_load_dwordx4 v14, s[12:15], s71 offen offset:2048 lds
buffer_load_dwordx4 v15, s[12:15], s71 offen offset:3072 lds
buffer_load_dword v30, off, s[12:15], 0
s_mov_b32 s64, s36
s_mov_b32 s65, s37
s_waitcnt vmcnt(40)
v_add_u32 v5, s34, 34
s_mov_b64 exec, 1
ds_write_b32 v3, v5
s_mov_b64 exec, -1
s_mov_b32 s63, 1
s_mov_b32 s34, 32
s_add_u32 s24, s24, 1409024
s_addc_u32 s25, s25, 0
s_mov_b32 s26, 1409024
s_mov_b32 s66, 32
s_branch lq_1
lcs_2:
s_add_u32 s35, s34, 1
lw_38:
ds_read_b32 v5, v2 offset:24
s_waitcnt lgkmcnt(0)
v_cmp_gt_i32 vcc, s35, v5
s_cbranch_vccz lwd_39
s_sub_u32 s32, s32, 1
s_cmp_gt_i32 s32, 0
s_cbranch_scc1 lw_38
lwd_39:
s_branch lcb_3
L_f:
v_lshlrev_b32 v4, 4, v0
s_lshl4_add_u32 s78, s59, s60
v_mov_b32 v252, 0
v_mov_b32 v253, 0
v_mov_b32 v254, 0
v_mov_b32 v255, 0
s_lshl_b32 s35, s78, 10
s_cmp_eq_u32 s58, 0
s_cselect_b64 exec, -1, 0
buffer_store_dwordx4 v[252:255], v4, s[24:27], s35 offen offset:0 sc1
s_add_u32 s35, s35, 262144
buffer_store_dwordx4 v[252:255], v4, s[24:27], s35 offen offset:0 sc1
s_mov_b64 exec, -1
s_setprio 3
v_and_b32 v1, 3, v0
v_lshlrev_b32 v1, 2, v1
v_and_b32 v2, 4, v1
s_lshl2_add_u32 s35, s58, 24
v_mov_b32 v3, s35
s_mov_b32 s4, s54
s_mov_b32 s5, s55
s_mov_b32 s6, 0x100
s_mov_b32 s7, 0x00020000
s_add_u32 s70, s60, 4
s_lshr_b32 s70, s70, 3
s_sub_u32 s70, s60, s70
s_lshl4_add_u32 s64, s70, s59
s_and_b32 s70, s60, 7
s_cmp_eq_u32 s70, 3
s_cselect_b32 s65, 1, 0
s_mov_b32 s69, 0x3f803f80
s_barrier
s_cmp_eq_u32 s58, 0
s_cselect_b32 s16, s46, s48
s_cselect_b32 s17, s47, s49
s_mov_b32 s12, s50
s_mov_b32 s13, s51
s_mov_b32 s14, 0x0
s_mov_b32 s15, 0x00020000
s_cmp_eq_u32 s65, 0
s_cselect_b32 s18, 7340032, 0
s_mov_b32 s14, s18
s_lshr_b32 s70, s64, 3
s_and_b32 s71, s64, 7
s_lshl_b32 s66, s70, 10
s_add_u32 s66, s66, s71
s_lshl1_add_u32 s66, s66, s58
s_lshl_b32 s66, s66, 7
s_mul_i32 s71, s71, 917504
s_lshl_b32 s70, s70, 8
s_add_u32 s77, s71, s70
s_mov_b32 s48, s38
s_mov_b32 s49, s39
s_mov_b32 s50, 0x600000
s_mov_b32 s51, 0x00020000
s_mov_b32 s52, 0
s_and_b32 s54, s60, 8
s_add_u32 s54, s54, 3
s_add_u32 s53, s54, s59
s_and_b32 s55, s60, 7
s_lshl1_add_u32 s55, s55, s58
s_mul_i32 s55, s55, 24576
s_lshl_b32 s54, s54, 7
s_add_u32 s56, s54, s55
s_add_u32 s56, s56, 60
s_and_b32 s73, s2, 3
s_lshl_b32 s73, s73, 6
v_mov_b32 v14, 1
s_sub_u32 exec_lo, 1, s58
s_mov_b32 exec_hi, 0
s_waitcnt vmcnt(0)
buffer_atomic_add v14, off, s[4:7], s73 sc1
s_mov_b64 exec, -1
v_mov_b32 v8, s69
v_mov_b32 v9, s69
v_mov_b32 v10, s69
v_mov_b32 v11, s69
v_mov_b32 v12, s69
v_mov_b32 v13, s69
v_mov_b32 v14, s69
v_mov_b32 v15, s69
s_mov_b32 s70, 102400
ftop_42:
v_lshrrev_b32 v6, 4, v0
v_bfe_u32 v7, v0, 2, 2
v_lshl_add_u32 v6, v6, 3, v7
v_bfe_u32 v7, v0, 3, 2
s_lshl_b32 s71, s58, 1
v_xor_b32 v7, s71, v7
v_lshl_add_u32 v7, v7, 5, s70
v_lshl_add_u32 v6, v6, 7, v7
v_lshl_add_u32 v6, v1, 1, v6
v_xor_b32 v7, 32, v6
s_mul_i32 s71, s63, 34
s_add_u32 s35, s71, 1
lw_43:
ds_read_b32 v5, v2 offset:16
s_waitcnt lgkmcnt(0)
v_cmp_gt_i32 vcc, s35, v5
s_cbranch_vccz lwd_44
s_sleep 1
s_sub_u32 s32, s32, 1
s_cmp_gt_i32 s32, 0
s_cbranch_scc1 lw_43
lwd_44:
ds_read_b64_tr_b16 v[24:25], v6 offset:0
ds_read_b64_tr_b16 v[26:27], v6 offset:512
ds_read_b64_tr_b16 v[28:29], v6 offset:4096
ds_read_b64_tr_b16 v[30:31], v6 offset:4608
ds_read_b64_tr_b16 v[32:33], v7 offset:0
ds_read_b64_tr_b16 v[34:35], v7 offset:512
ds_read_b64_tr_b16 v[36:37], v7 offset:4096
ds_read_b64_tr_b16 v[38:39], v7 offset:4608
ds_read_b64_tr_b16 v[40:41], v6 offset:8192
ds_read_b64_tr_b16 v[42:43], v6 offset:8704
ds_read_b64_tr_b16 v[44:45], v6 offset:12288
ds_read_b64_tr_b16 v[46:47], v6 offset:12800
ds_read_b64_tr_b16 v[48:49], v7 offset:8192
ds_read_b64_tr_b16 v[50:51], v7 offset:8704
ds_read_b64_tr_b16 v[52:53], v7 offset:12288
ds_read_b64_tr_b16 v[54:55], v7 offset:12800
s_lshl_b32 s72, s60, 14
s_lshl_b32 s70, s58, 9
s_add_u32 s72, s72, s70
s_lshl_b32 s70, s59, 10
s_add_u32 s71, s72, s70
s_lshl_b32 s76, s59, 14
s_add_u32 s73, s76, 30686208
s_add_u32 s76, s76, 266240
s_waitcnt lgkmcnt(14)
v_mfma_f32_16x16x32_bf16 v[248:251], v[8:11], v[24:27], 0
s_waitcnt lgkmcnt(10)
v_mfma_f32_16x16x32_bf16 v[252:255], v[8:11], v[32:35], 0
v_mfma_f32_16x16x32_bf16 v[248:251], v[12:15], v[28:31], v[248:251]
s_waitcnt lgkmcnt(8)
v_mfma_f32_16x16x32_bf16 v[252:255], v[12:15], v[36:39], v[252:255]
ds_read_b64_tr_b16 v[24:25], v6 offset:16384
ds_read_b64_tr_b16 v[26:27], v6 offset:16896
ds_read_b64_tr_b16 v[28:29], v6 offset:20480
ds_read_b64_tr_b16 v[30:31], v6 offset:20992
ds_read_b64_tr_b16 v[32:33], v7 offset:16384
ds_read_b64_tr_b16 v[34:35], v7 offset:16896
ds_read_b64_tr_b16 v[36:37], v7 offset:20480
ds_read_b64_tr_b16 v[38:39], v7 offset:20992
v_add_u32 v5, s34, 1
s_mov_b64 exec, 1
ds_write_b32 v3, v5
s_mov_b64 exec, -1
s_waitcnt lgkmcnt(14)
v_mfma_f32_16x16x32_bf16 v[16:19], v[8:11], v[40:43], 0
s_waitcnt lgkmcnt(11)
v_mfma_f32_16x16x32_bf16 v[20:23], v[8:11], v[48:51], 0
v_mfma_f32_16x16x32_bf16 v[16:19], v[12:15], v[44:47], v[16:19]
s_waitcnt lgkmcnt(9)
v_mfma_f32_16x16x32_bf16 v[20:23], v[12:15], v[52:55], v[20:23]
v_mov_b32 v249, v252
v_mov_b32 v252, s69
v_mov_b32 v253, s69
v_mov_b32 v254, s69
v_mov_b32 v255, s69
v_mfma_f32_16x16x32_bf16 v[52:55], v[8:11], v[8:11], 0
s_nop 0
v_mfma_f32_16x16x32_bf16 v[48:51], v[8:11], v[252:255], 0
v_mfma_f32_16x16x32_bf16 v[52:55], v[12:15], v[12:15], v[52:55]
v_mfma_f32_16x16x32_bf16 v[48:51], v[12:15], v[252:255], v[48:51]
s_waitcnt lgkmcnt(7)
v_mfma_f32_16x16x32_bf16 v[40:43], v[8:11], v[24:27], 0
s_waitcnt lgkmcnt(3)
v_mfma_f32_16x16x32_bf16 v[44:47], v[8:11], v[32:35], 0
v_mfma_f32_16x16x32_bf16 v[40:43], v[12:15], v[28:31], v[40:43]
s_waitcnt lgkmcnt(1)
v_mfma_f32_16x16x32_bf16 v[44:47], v[12:15], v[36:39], v[44:47]
v_lshlrev_b32 v6, 3, v0
v_and_b32 v7, 48, v0
v_mov_b32_dpp v248, v16 quad_perm:[0,1,2,3] row_mask:0x2 bank_mask:0xf
v_mov_b32_dpp v249, v20 quad_perm:[0,1,2,3] row_mask:0x2 bank_mask:0xf
s_nop 0
v_mov_b32_dpp v248, v48 quad_perm:[0,1,2,3] row_mask:0x8 bank_mask:0xf
v_mov_b32_dpp v249, v52 quad_perm:[0,1,2,3] row_mask:0x8 bank_mask:0xf
s_nop 0
v_mov_b32_dpp v248, v40 quad_perm:[0,1,2,3] row_mask:0x4 bank_mask:0xf
v_mov_b32_dpp v249, v44 quad_perm:[0,1,2,3] row_mask:0x4 bank_mask:0xf
v_max_u32 v248, 1, v248
v_max_u32 v249, 1, v249
s_cmp_eq_u32 s63, 0
s_cbranch_scc1 fst_40
fsb_41:
buffer_store_dwordx2 v[248:249], v6, s[24:27], s71 offen sc1
s_lshl4_add_u32 s70, s58, s60
s_add_u32 s70, s70, s34
s_cmp_eq_u32 s70, 51
s_cbranch_scc1 fxt_45
fxb_46:
s_add_u32 s73, s72, 4096
s_add_u32 s74, s72, 8192
s_add_u32 s75, s72, 12288
v_lshrrev_b32 v7, 2, v0
v_lshlrev_b32 v7, 7, v7
v_lshl_add_u32 v7, v1, 2, v7
v_lshrrev_b32 v8, 5, v0
v_lshrrev_b32 v9, 4, v0
v_xor_b32 v10, v8, v9
v_and_b32 v10, 1, v10
v_lshl_add_u32 v8, v10, 1, v8
v_and_b32 v10, 15, v0
v_lshlrev_b32 v8, 7, v8
v_lshl_add_u32 v8, v10, 3, v8
v_add_u32 v8, 1280, v8
s_mul_i32 s70, s58, 384
s_lshl_b32 s71, s63, 10
s_add_u32 s70, s70, s71
s_add_u32 s70, s70, 2304
v_lshl_add_u32 v9, v9, 7, s70
v_lshl_add_u32 v9, v10, 2, v9
s_cmp_eq_u32 s63, 0
s_cbranch_scc1 fg_47
fg_48:
poll_49:
buffer_load_dwordx4 v[12:15], v7, s[24:27], s76 offen sc1
pchk_50:
s_waitcnt vmcnt(0)
v_min3_u32 v10, v12, v13, v14
v_min_u32 v10, v10, v15
v_cmp_eq_u32 vcc, 0, v10
s_cbranch_vccz pdone_51
s_sub_u32 s32, s32, 1
s_cmp_gt_i32 s32, 0
s_cbranch_scc1 poll_49
pdone_51:
s_lshr_b32 s70, s33, 7
s_sub_u32 s70, s70, s59
s_mul_i32 s70, s70, s63
s_cmp_eq_u32 s70, 0
s_cbranch_scc0 fng_52
s_lshl1_add_u32 s70, s34, -32
s_add_u32 s35, s70, 15
lw_53:
ds_read_b32 v5, v2 offset:16
s_waitcnt lgkmcnt(0)
v_cmp_gt_i32 vcc, s35, v5
s_cbranch_vccz lwd_54
s_sleep 4
s_sub_u32 s32, s32, 1
s_cmp_gt_i32 s32, 0
s_cbranch_scc1 lw_53
lwd_54:
poll_55:
buffer_load_dwordx2 v[24:25], v6, s[24:27], s72 offen offset:0 sc1
buffer_load_dwordx2 v[26:27], v6, s[24:27], s72 offen offset:1024 sc1
buffer_load_dwordx2 v[28:29], v6, s[24:27], s72 offen offset:2048 sc1
buffer_load_dwordx2 v[30:31], v6, s[24:27], s72 offen offset:3072 sc1
buffer_load_dwordx2 v[32:33], v6, s[24:27], s73 offen offset:0 sc1
buffer_load_dwordx2 v[34:35], v6, s[24:27], s73 offen offset:1024 sc1
buffer_load_dwordx2 v[36:37], v6, s[24:27], s73 offen offset:2048 sc1
buffer_load_dwordx2 v[38:39], v6, s[24:27], s73 offen offset:3072 sc1
buffer_load_dwordx2 v[40:41], v6, s[24:27], s74 offen offset:0 sc1
buffer_load_dwordx2 v[42:43], v6, s[24:27], s74 offen offset:1024 sc1
buffer_load_dwordx2 v[44:45], v6, s[24:27], s74 offen offset:2048 sc1
buffer_load_dwordx2 v[46:47], v6, s[24:27], s74 offen offset:3072 sc1
buffer_load_dwordx2 v[48:49], v6, s[24:27], s75 offen offset:0 sc1
buffer_load_dwordx2 v[50:51], v6, s[24:27], s75 offen offset:1024 sc1
buffer_load_dwordx2 v[52:53], v6, s[24:27], s75 offen offset:2048 sc1
buffer_load_dwordx2 v[54:55], v6, s[24:27], s75 offen offset:3072 sc1
pchk_56:
s_waitcnt vmcnt(14)
v_min3_u32 v10, v24, v25, v26
s_waitcnt vmcnt(13)
v_min3_u32 v10, v10, v27, v28
s_waitcnt vmcnt(12)
v_min3_u32 v10, v10, v29, v30
s_waitcnt vmcnt(11)
v_min3_u32 v10, v10, v31, v32
s_waitcnt vmcnt(10)
v_min3_u32 v10, v10, v33, v34
s_waitcnt vmcnt(9)
v_min3_u32 v10, v10, v35, v36
s_waitcnt vmcnt(8)
v_min3_u32 v10, v10, v37, v38
s_waitcnt vmcnt(7)
v_min3_u32 v10, v10, v39, v40
s_waitcnt vmcnt(6)
v_min3_u32 v10, v10, v41, v42
s_waitcnt vmcnt(5)
v_min3_u32 v10, v10, v43, v44
s_waitcnt vmcnt(4)
v_min3_u32 v10, v10, v45, v46
s_waitcnt vmcnt(3)
v_min3_u32 v10, v10, v47, v48
s_waitcnt vmcnt(2)
v_min3_u32 v10, v10, v49, v50
s_waitcnt vmcnt(1)
v_min3_u32 v10, v10, v51, v52
s_waitcnt vmcnt(0)
v_min3_u32 v10, v10, v53, v54
v_min_u32 v10, v10, v55
v_cmp_eq_u32 vcc, 0, v10
s_cbranch_vccz pdone_57
s_sub_u32 s32, s32, 1
s_cmp_gt_i32 s32, 0
s_cbranch_scc1 poll_55
pdone_57:
v_add_f32 v24, v24, v40
v_add_f32 v25, v25, v41
v_add_f32 v26, v26, v42
v_add_f32 v27, v27, v43
v_add_f32 v28, v28, v44
v_add_f32 v29, v29, v45
v_add_f32 v30, v30, v46
v_add_f32 v31, v31, v47
v_add_f32 v32, v32, v48
v_add_f32 v33, v33, v49
v_add_f32 v34, v34, v50
v_add_f32 v35, v35, v51
v_add_f32 v36, v36, v52
v_add_f32 v37, v37, v53
v_add_f32 v38, v38, v54
v_add_f32 v39, v39, v55
v_add_f32 v24, v24, v32
v_add_f32 v25, v25, v33
v_add_f32 v26, v26, v34
v_add_f32 v27, v27, v35
v_add_f32 v28, v28, v36
v_add_f32 v29, v29, v37
v_add_f32 v30, v30, v38
v_add_f32 v31, v31, v39
v_add_f32 v24, v24, v28
v_add_f32 v25, v25, v29
v_add_f32 v26, v26, v30
v_add_f32 v27, v27, v31
v_add_f32 v24, v24, v26
v_add_f32 v25, v25, v27
s_mov_b32 exec_hi, 0xffff
ds_write2_b32 v9, v24, v25 offset1:16
s_mov_b32 exec_hi, -1
v_mul_f32 v5, 0xba800000, v24
v_mul_f32 v25, 0x3a800000, v25
v_fma_f32 v25, -v5, v5, v25
v_max_f32 v25, 0, v25
v_add_f32 v25, 0x3727c5ac, v25
v_rsq_f32 v24, v25
s_nop 0
v_mul_f32 v25, v5, v24
s_lshl_b32 s70, s59, 7
s_sub_u32 s70, s33, s70
v_lshlrev_b32 v10, 1, v0
v_sub_u32 v10, s70, v10
v_readlane_b32 s70, v24, 48
v_readlane_b32 s71, v25, 48
v_cmp_eq_u32 vcc, 0, v10
s_mov_b64 exec, vcc
v_mov_b32 v12, s70
v_mov_b32 v13, s71
s_mov_b64 exec, -1
v_cmp_eq_u32 vcc, 1, v10
s_mov_b64 exec, vcc
v_mov_b32 v14, s70
v_mov_b32 v15, s71
s_mov_b64 exec, -1
fng_52:
ds_write2_b32 v8, v12, v14 offset1:1
ds_write2_b32 v8, v13, v15 offset0:128 offset1:129
s_add_u32 s71, s34, s63
v_add_u32 v5, s71, 2
s_mov_b64 exec, 1
ds_write_b32 v3, v5
s_mov_b64 exec, -1
s_setprio 0
s_cmp_eq_u32 s63, 0
s_cbranch_scc1 fnw_58
fnw_59:
s_and_b32 s70, s64, 7
s_lshl_b32 s70, s70, 7
s_add_u32 s73, s70, 276480
s_lshl1_add_u32 s72, s70, 272384
s_lshr_b32 s71, s64, 3
s_lshl_b32 s76, s71, 13
s_add_u32 s76, s76, 1048576
s_lshl2_add_u32 s74, s70, s76
s_lshl_b32 s70, s58, 8
s_add_u32 s74, s74, s70
s_add_u32 s75, s74, 4096
s_lshl4_add_u32 s76, s70, s76
v_and_b32 v251, 15, v0
v_lshlrev_b32 v6, 14, v251
v_lshrrev_b32 v252, 4, v0
v_lshl_add_u32 v7, v252, 5, v6
v_lshlrev_b32 v251, 4, v251
s_lshl_b32 s70, s58, 3
v_lshl_add_u32 v253, v252, 1, s70
v_add_u32 v253, v253, v251
v_lshlrev_b32 v254, 5, v252
v_lshl_add_u32 v254, v2, 2, v254
v_and_b32 v255, 7, v0
v_lshl_add_u32 v255, v255, 2, v252
v_lshlrev_b32 v255, 3, v255
s_add_u32 s35, s34, 22
lw_60:
ds_read_b32 v5, v1 offset:0
s_waitcnt lgkmcnt(0)
v_cmp_gt_i32 vcc, s35, v5
s_cbranch_vccz lwd_61
s_sleep 4
s_sub_u32 s32, s32, 1
s_cmp_gt_i32 s32, 0
s_cbranch_scc1 lw_60
lwd_61:
s_setprio 3
s_add_u32 s35, s34, 24
lw_62:
ds_read_b32 v5, v1 offset:0
s_waitcnt lgkmcnt(0)
v_cmp_gt_i32 vcc, s35, v5
s_cbranch_vccz lwd_63
s_sleep 2
s_sub_u32 s32, s32, 1
s_cmp_gt_i32 s32, 0
s_cbranch_scc1 lw_62
lwd_63:
s_mul_i32 s79, s63, 64
s_sub_u32 s79, 32, s79
s_add_u32 s35, s79, 3
tw_64:
ds_read_b32 v5, v2 offset:16
s_waitcnt lgkmcnt(0)
v_cmp_gt_i32 vcc, s35, v5
s_cbranch_vccz twd_65
v_readfirstlane_b32 s54, v5
s_sub_u32 s55, s35, s54
s_cmp_lt_i32 s55, 2
s_cbranch_scc1 tws_66
s_add_u32 s54, s54, 2
s_or_b32 s54, s54, 1
s_cmp_eq_u32 s54, s52
s_cbranch_scc1 tws_66
s_bitcmp1_b32 s54, 4
s_cbranch_scc1 tws_66
s_mov_b32 s52, s54
s_add_u32 s54, s54, s53
s_and_b32 s54, s54, 15
s_mul_i32 s54, s54, 393216
s_add_u32 s54, s54, s56
s_buffer_load_dwordx2 s[46:47], s[48:51], s54 offset:4096
s_buffer_load_dwordx2 s[46:47], s[48:51], s54 offset:10240
s_buffer_load_dwordx2 s[46:47], s[48:51], s54 offset:16384
s_buffer_load_dwordx2 s[46:47], s[48:51], s54 offset:22528
tws_66:
s_sleep 4
s_sub_u32 s32, s32, 1
s_cmp_gt_i32 s32, 0
s_cbranch_scc1 tw_64
twd_65:
s_cmp_eq_u32 s65, 0
s_cbranch_scc0 fnd_68
poll_69:
buffer_load_dwordx2 v[248:249], v6, s[24:27], s73 offen sc1
buffer_load_dwordx4 v[8:11], v7, s[24:27], s72 offen offset:0 sc1
buffer_load_dwordx4 v[12:15], v7, s[24:27], s72 offen offset:16 sc1
buffer_load_dwordx4 v[16:19], v7, s[24:27], s72 offen offset:128 sc1
buffer_load_dwordx4 v[20:23], v7, s[24:27], s72 offen offset:144 sc1
pchk_70:
s_waitcnt vmcnt(3)
v_min3_u32 v5, v248, v249, v8
v_min3_u32 v5, v5, v9, v10
s_waitcnt vmcnt(2)
v_min3_u32 v5, v5, v11, v12
v_min3_u32 v5, v5, v13, v14
s_waitcnt vmcnt(1)
v_min3_u32 v5, v5, v15, v16
v_min3_u32 v5, v5, v17, v18
s_waitcnt vmcnt(0)
v_min3_u32 v5, v5, v19, v20
v_min3_u32 v5, v5, v21, v22
v_min_u32 v5, v5, v23
v_cmp_eq_u32 vcc, 0, v5
s_cbranch_vccz pdone_71
s_sub_u32 s32, s32, 1
s_cmp_gt_i32 s32, 0
s_cbranch_scc1 poll_69
pdone_71:
v_mfma_f32_16x16x32_bf16 v[24:27], v[8:11], v[56:59], 0
v_mov_b32 v250, v248
v_mfma_f32_16x16x32_bf16 v[28:31], v[8:11], v[60:63], 0
s_nop 0
v_max_f32_dpp v250, v250, v250 row_ror:1 row_mask:0xf bank_mask:0xf
v_mfma_f32_16x16x32_bf16 v[32:35], v[8:11], v[64:67], 0
s_nop 0
v_max_f32_dpp v250, v250, v250 row_ror:2 row_mask:0xf bank_mask:0xf
v_mfma_f32_16x16x32_bf16 v[36:39], v[8:11], v[68:71], 0
s_nop 0
v_max_f32_dpp v250, v250, v250 row_ror:4 row_mask:0xf bank_mask:0xf
v_mfma_f32_16x16x32_bf16 v[40:43], v[8:11], v[72:75], 0
s_nop 0
v_max_f32_dpp v250, v250, v250 row_ror:8 row_mask:0xf bank_mask:0xf
v_mfma_f32_16x16x32_bf16 v[44:47], v[8:11], v[76:79], 0
v_cmp_eq_f32 vcc, v250, v248
v_mfma_f32_16x16x32_bf16 v[48:51], v[8:11], v[80:83], 0
s_ff1_i32_b64 s68, vcc
v_mfma_f32_16x16x32_bf16 v[52:55], v[8:11], v[84:87], 0
s_and_b32 s68, s68, 15
v_mfma_f32_16x16x32_bf16 v[24:27], v[12:15], v[88:91], v[24:27]
v_readlane_b32 s33, v249, s68
v_mfma_f32_16x16x32_bf16 v[28:31], v[12:15], v[92:95], v[28:31]
v_readlane_b32 s67, v248, s68
v_mfma_f32_16x16x32_bf16 v[32:35], v[12:15], v[96:99], v[32:35]
v_add_u32 v5, s34, 4
v_mfma_f32_16x16x32_bf16 v[36:39], v[12:15], v[100:103], v[36:39]
v_mov_b32 v250, s33
v_mfma_f32_16x16x32_bf16 v[40:43], v[12:15], v[104:107], v[40:43]
s_mov_b64 exec, 1
ds_write2_b32 v3, v5, v250 offset1:2
s_mov_b64 exec, -1
v_mfma_f32_16x16x32_bf16 v[44:47], v[12:15], v[108:111], v[44:47]
s_sub_u32 s33, s33, 1
v_mfma_f32_16x16x32_bf16 v[48:51], v[12:15], v[112:115], v[48:51]
s_and_b32 s33, s33, 2047
v_mfma_f32_16x16x32_bf16 v[52:55], v[12:15], v[116:119], v[52:55]
v_mfma_f32_16x16x32_bf16 v[24:27], v[16:19], v[120:123], v[24:27]
v_mfma_f32_16x16x32_bf16 v[28:31], v[16:19], v[124:127], v[28:31]
v_mfma_f32_16x16x32_bf16 v[32:35], v[16:19], v[128:131], v[32:35]
v_mfma_f32_16x16x32_bf16 v[36:39], v[16:19], v[132:135], v[36:39]
v_mfma_f32_16x16x32_bf16 v[40:43], v[16:19], v[136:139], v[40:43]
v_mfma_f32_16x16x32_bf16 v[44:47], v[16:19], v[140:143], v[44:47]
v_mfma_f32_16x16x32_bf16 v[48:51], v[16:19], v[144:147], v[48:51]
v_mfma_f32_16x16x32_bf16 v[52:55], v[16:19], v[148:151], v[52:55]
v_mfma_f32_16x16x32_bf16 v[24:27], v[20:23], v[152:155], v[24:27]
s_and_b32 s70, s68, 12
s_lshl_b32 s70, s70, 2
s_bitcmp1_b32 s68, 1
v_mfma_f32_16x16x32_bf16 v[28:31], v[20:23], v[156:159], v[28:31]
v_mfma_f32_16x16x32_bf16 v[32:35], v[20:23], v[160:163], v[32:35]
v_mfma_f32_16x16x32_bf16 v[36:39], v[20:23], v[164:167], v[36:39]
v_mfma_f32_16x16x32_bf16 v[40:43], v[20:23], v[168:171], v[40:43]
v_mfma_f32_16x16x32_bf16 v[44:47], v[20:23], v[172:175], v[44:47]
v_mfma_f32_16x16x32_bf16 v[48:51], v[20:23], v[176:179], v[48:51]
v_mfma_f32_16x16x32_bf16 v[52:55], v[20:23], v[180:183], v[52:55]
s_cbranch_scc1 fsel_74
fsel_72:
s_bitcmp1_b32 s68, 0
s_cbranch_scc1 fsel_73
v_max_u32 v8, 1, v24
v_max_u32 v9, 1, v28
v_max_u32 v10, 1, v32
v_max_u32 v11, 1, v36
v_max_u32 v12, 1, v40
v_max_u32 v13, 1, v44
v_max_u32 v14, 1, v48
v_max_u32 v15, 1, v52
s_branch fsel_76
fsel_73:
v_max_u32 v8, 1, v25
v_max_u32 v9, 1, v29
v_max_u32 v10, 1, v33
v_max_u32 v11, 1, v37
v_max_u32 v12, 1, v41
v_max_u32 v13, 1, v45
v_max_u32 v14, 1, v49
v_max_u32 v15, 1, v53
s_branch fsel_76
fsel_74:
s_bitcmp1_b32 s68, 0
s_cbranch_scc1 fsel_75
v_max_u32 v8, 1, v26
v_max_u32 v9, 1, v30
v_max_u32 v10, 1, v34
v_max_u32 v11, 1, v38
v_max_u32 v12, 1, v42
v_max_u32 v13, 1, v46
v_max_u32 v14, 1, v50
v_max_u32 v15, 1, v54
s_branch fsel_76
fsel_75:
v_max_u32 v8, 1, v27
v_max_u32 v9, 1, v31
v_max_u32 v10, 1, v35
v_max_u32 v11, 1, v39
v_max_u32 v12, 1, v43
v_max_u32 v13, 1, v47
v_max_u32 v14, 1, v51
v_max_u32 v15, 1, v55
fsel_76:
s_bfm_b64 exec, 16, s70
buffer_store_dwordx4 v[8:11], v251, s[24:27], s74 offen sc1
buffer_store_dwordx4 v[12:15], v251, s[24:27], s75 offen sc1
s_mov_b64 exec, -1
s_and_b32 s70, s64, 7
s_lshl1_add_u32 s70, s70, s58
s_mul_i32 s70, s70, 28
s_add_u32 s70, s70, s71
s_lshl_b32 s70, s70, 8
s_add_u32 s70, s70, 1277952
s_waitcnt vmcnt(0)
s_mul_i32 s79, s63, 64
s_sub_u32 s79, 32, s79
s_add_u32 s35, s79, 7
tw_77:
ds_read_b32 v5, v2 offset:16
s_waitcnt lgkmcnt(0)
v_cmp_gt_i32 vcc, s35, v5
s_cbranch_vccz twd_78
v_readfirstlane_b32 s54, v5
s_sub_u32 s55, s35, s54
s_cmp_lt_i32 s55, 2
s_cbranch_scc1 tws_79
s_add_u32 s54, s54, 2
s_or_b32 s54, s54, 1
s_cmp_eq_u32 s54, s52
s_cbranch_scc1 tws_79
s_bitcmp1_b32 s54, 4
s_cbranch_scc1 tws_79
s_mov_b32 s52, s54
s_add_u32 s54, s54, s53
s_and_b32 s54, s54, 15
s_mul_i32 s54, s54, 393216
s_add_u32 s54, s54, s56
s_buffer_load_dwordx2 s[46:47], s[48:51], s54 offset:4096
s_buffer_load_dwordx2 s[46:47], s[48:51], s54 offset:10240
s_buffer_load_dwordx2 s[46:47], s[48:51], s54 offset:16384
s_buffer_load_dwordx2 s[46:47], s[48:51], s54 offset:22528
tws_79:
s_sleep 4
s_sub_u32 s32, s32, 1
s_cmp_gt_i32 s32, 0
s_cbranch_scc1 tw_77
twd_78:
poll_80:
buffer_load_dwordx4 v[24:27], v4, s[24:27], s76 offen offset:0 sc1
buffer_load_dwordx4 v[28:31], v4, s[24:27], s76 offen offset:1024 sc1
buffer_load_dwordx4 v[32:35], v4, s[24:27], s76 offen offset:2048 sc1
buffer_load_dwordx4 v[36:39], v4, s[24:27], s76 offen offset:3072 sc1
pchk_81:
s_waitcnt vmcnt(3)
v_min3_u32 v5, v24, v25, v26
s_waitcnt vmcnt(2)
v_min3_u32 v5, v5, v27, v28
v_min3_u32 v5, v5, v29, v30
s_waitcnt vmcnt(1)
v_min3_u32 v5, v5, v31, v32
v_min3_u32 v5, v5, v33, v34
s_waitcnt vmcnt(0)
v_min3_u32 v5, v5, v35, v36
v_min3_u32 v5, v5, v37, v38
v_min_u32 v5, v5, v39
v_cmp_eq_u32 vcc, 0, v5
s_cbranch_vccz pdone_82
s_sub_u32 s32, s32, 1
s_cmp_gt_i32 s32, 0
s_cbranch_scc1 poll_80
pdone_82:
v_add_f32 v24, v24, v32
v_add_f32 v25, v25, v33
v_add_f32 v26, v26, v34
v_add_f32 v27, v27, v35
v_add_f32 v28, v28, v36
v_add_f32 v29, v29, v37
v_add_f32 v30, v30, v38
v_add_f32 v31, v31, v39
v_add_f32 v24, v24, v28
v_add_f32 v25, v25, v29
v_add_f32 v26, v26, v30
v_add_f32 v27, v27, v31
s_nop 0
v_permlane32_swap_b32 v24, v26
v_permlane32_swap_b32 v25, v27
v_add_f32 v24, v24, v26
v_add_f32 v25, v25, v27
s_nop 1
v_permlane16_swap_b32 v24, v25
v_mul_f32 v26, 0xbfb8aa3b, v24
v_exp_f32 v26, v26
v_mul_f32 v24, v24, v25
v_add_f32 v26, 1.0, v26
v_rcp_f32 v26, v26
v_add_u32 v5, s34, 5
v_mul_f32 v24, v24, v26
v_cvt_pk_bf16_f32 v24, v24, v24
ds_write_b16 v253, v24 offset:512
s_mov_b64 exec, 1
ds_write_b32 v3, v5
s_mov_b64 exec, -1
s_add_u32 s35, s34, 5
poll_83:
ds_read_b32 v5, v2 offset:24
ds_read_b128 v[8:11], v254 offset:512
ds_read_b128 v[12:15], v254 offset:640
pchk_84:
s_waitcnt lgkmcnt(2)
v_cmp_gt_i32 vcc, s35, v5
s_cbranch_vccz pdone_85
s_sleep 1
s_sub_u32 s32, s32, 1
s_cmp_gt_i32 s32, 0
s_cbranch_scc1 poll_83
pdone_85:
s_waitcnt lgkmcnt(1)
v_mfma_f32_16x16x32_bf16 v[24:27], v[8:11], v[184:187], 0
v_mfma_f32_16x16x32_bf16 v[28:31], v[8:11], v[188:191], 0
v_mfma_f32_16x16x32_bf16 v[32:35], v[8:11], v[192:195], 0
v_mfma_f32_16x16x32_bf16 v[36:39], v[8:11], v[196:199], 0
v_mfma_f32_16x16x32_bf16 v[40:43], v[8:11], v[200:203], 0
v_mfma_f32_16x16x32_bf16 v[44:47], v[8:11], v[204:207], 0
v_mfma_f32_16x16x32_bf16 v[48:51], v[8:11], v[208:211], 0
v_mfma_f32_16x16x32_bf16 v[52:55], v[8:11], v[212:215], 0
s_waitcnt lgkmcnt(0)
v_mfma_f32_16x16x32_bf16 v[24:27], v[12:15], v[216:219], v[24:27]
v_mfma_f32_16x16x32_bf16 v[28:31], v[12:15], v[220:223], v[28:31]
v_mfma_f32_16x16x32_bf16 v[32:35], v[12:15], v[224:227], v[32:35]
v_mfma_f32_16x16x32_bf16 v[36:39], v[12:15], v[228:231], v[36:39]
v_mfma_f32_16x16x32_bf16 v[40:43], v[12:15], v[232:235], v[40:43]
v_mfma_f32_16x16x32_bf16 v[44:47], v[12:15], v[236:239], v[44:47]
v_mfma_f32_16x16x32_bf16 v[48:51], v[12:15], v[240:243], v[48:51]
v_mfma_f32_16x16x32_bf16 v[52:55], v[12:15], v[244:247], v[52:55]
s_nop 0
v_add_f32_dpp v16, v25, v24 row_ror:8 row_mask:0x1 bank_mask:0xf
v_add_f32_dpp v17, v29, v28 row_ror:8 row_mask:0x1 bank_mask:0xf
s_nop 0
v_add_f32_dpp v16, v33, v32 row_ror:8 row_mask:0x2 bank_mask:0xf
v_add_f32_dpp v17, v37, v36 row_ror:8 row_mask:0x2 bank_mask:0xf
s_nop 0
v_add_f32_dpp v16, v41, v40 row_ror:8 row_mask:0x4 bank_mask:0xf
v_add_f32_dpp v17, v45, v44 row_ror:8 row_mask:0x4 bank_mask:0xf
s_nop 0
v_add_f32_dpp v16, v49, v48 row_ror:8 row_mask:0x8 bank_mask:0xf
v_add_f32_dpp v17, v53, v52 row_ror:8 row_mask:0x8 bank_mask:0xf
v_max_u32 v16, 1, v16
v_max_u32 v17, 1, v17
s_mov_b32 exec_lo, 0x00ff00ff
s_mov_b32 exec_hi, 0x00ff00ff
buffer_store_dwordx2 v[16:17], v255, s[24:27], s70 offen sc1
s_mov_b64 exec, -1
fnd_67:
s_sub_u32 s70, s60, 3
s_mul_i32 s70, s70, s63
s_or_b32 s70, s70, s58
s_cbranch_scc1 fnr_86
s_mul_i32 s72, s59, 7168
s_add_u32 s72, s72, 1277952
s_add_u32 s73, s72, 4096
s_lshl_b32 s70, s68, 6
s_add_u32 s70, s70, s59
s_lshl_b32 s70, s70, 8
s_add_u32 s76, s70, 262144
v_mov_b32 v12, s67
v_mul_f32 v12, 0xbfb8aa3b, v12
v_exp_f32 v12, v12
v_lshl_add_u32 v6, v252, 2, v251
v_add_f32 v12, 1.0, v12
v_rcp_f32 v12, v12
v_lshrrev_b32 v7, 1, v6
s_lshl4_add_u32 s70, s33, s59
s_lshl_b32 s70, s70, 7
v_and_b32 v8, 0x46, v7
v_lshl_add_u32 v8, v1, 2, v8
v_and_b32 v9, 4, v0
v_lshl_add_u32 v8, v9, 1, v8
s_waitcnt vmcnt(0)
s_cmp_gt_u32 s65, s63
s_cbranch_scc1 fpre_88
fpre_89:
s_mul_i32 s79, s63, 64
s_sub_u32 s79, 32, s79
s_add_u32 s35, s79, 11
tw_90:
ds_read_b32 v5, v2 offset:16
s_waitcnt lgkmcnt(0)
v_cmp_gt_i32 vcc, s35, v5
s_cbranch_vccz twd_91
v_readfirstlane_b32 s54, v5
s_sub_u32 s55, s35, s54
s_cmp_lt_i32 s55, 2
s_cbranch_scc1 tws_92
s_add_u32 s54, s54, 2
s_or_b32 s54, s54, 1
s_cmp_eq_u32 s54, s52
s_cbranch_scc1 tws_92
s_bitcmp1_b32 s54, 4
s_cbranch_scc1 tws_92
s_mov_b32 s52, s54
s_add_u32 s54, s54, s53
s_and_b32 s54, s54, 15
s_mul_i32 s54, s54, 393216
s_add_u32 s54, s54, s56
s_buffer_load_dwordx2 s[46:47], s[48:51], s54 offset:4096
s_buffer_load_dwordx2 s[46:47], s[48:51], s54 offset:10240
s_buffer_load_dwordx2 s[46:47], s[48:51], s54 offset:16384
s_buffer_load_dwordx2 s[46:47], s[48:51], s54 offset:22528
tws_92:
s_sleep 4
s_sub_u32 s32, s32, 1
s_cmp_gt_i32 s32, 0
s_cbranch_scc1 tw_90
twd_91:
poll_93:
buffer_load_dword v52, v6, s[24:27], s76 offen sc1
buffer_load_dwordx4 v[24:27], v4, s[24:27], s72 offen offset:0 sc1
buffer_load_dwordx4 v[28:31], v4, s[24:27], s72 offen offset:1024 sc1
buffer_load_dwordx4 v[32:35], v4, s[24:27], s72 offen offset:2048 sc1
buffer_load_dwordx4 v[36:39], v4, s[24:27], s72 offen offset:3072 sc1
buffer_load_dwordx4 v[40:43], v4, s[24:27], s73 offen offset:0 sc1
buffer_load_dwordx4 v[44:47], v4, s[24:27], s73 offen offset:1024 sc1
buffer_load_dwordx4 v[48:51], v4, s[24:27], s73 offen offset:2048 sc1
pchk_94:
s_waitcnt vmcnt(6)
v_min3_u32 v5, v24, v25, v26
s_waitcnt vmcnt(5)
v_min3_u32 v5, v5, v27, v28
v_min3_u32 v5, v5, v29, v30
s_waitcnt vmcnt(4)
v_min3_u32 v5, v5, v31, v32
v_min3_u32 v5, v5, v33, v34
s_waitcnt vmcnt(3)
v_min3_u32 v5, v5, v35, v36
v_min3_u32 v5, v5, v37, v38
s_waitcnt vmcnt(2)
v_min3_u32 v5, v5, v39, v40
v_min3_u32 v5, v5, v41, v42
s_waitcnt vmcnt(1)
v_min3_u32 v5, v5, v43, v44
v_min3_u32 v5, v5, v45, v46
s_waitcnt vmcnt(0)
v_min3_u32 v5, v5, v47, v48
v_min3_u32 v5, v5, v49, v50
v_min3_u32 v5, v5, v51, v52
v_cmp_eq_u32 vcc, 0, v5
s_cbranch_vccz pdone_95
s_sub_u32 s32, s32, 1
s_cmp_gt_i32 s32, 0
s_cbranch_scc1 poll_93
pdone_95:
v_add_f32 v24, v24, v40
v_add_f32 v25, v25, v41
v_add_f32 v26, v26, v42
v_add_f32 v27, v27, v43
v_add_f32 v28, v28, v44
v_add_f32 v29, v29, v45
v_add_f32 v30, v30, v46
v_add_f32 v31, v31, v47
v_add_f32 v32, v32, v48
v_add_f32 v33, v33, v49
v_add_f32 v34, v34, v50
v_add_f32 v35, v35, v51
v_add_f32 v24, v24, v32
v_add_f32 v25, v25, v33
v_add_f32 v26, v26, v34
v_add_f32 v27, v27, v35
v_add_f32 v28, v28, v36
v_add_f32 v29, v29, v37
v_add_f32 v30, v30, v38
v_add_f32 v31, v31, v39
v_add_f32 v24, v24, v28
v_add_f32 v25, v25, v29
v_add_f32 v26, v26, v30
v_add_f32 v27, v27, v31
s_nop 0
v_permlane32_swap_b32 v24, v26
v_permlane32_swap_b32 v25, v27
v_add_f32 v24, v24, v26
v_add_f32 v25, v25, v27
s_nop 1
v_permlane16_swap_b32 v24, v25
v_add_f32 v24, v24, v25
v_fma_f32 v24, v24, v12, v52
v_cvt_pk_bf16_f32 v24, v24, v24
s_cmp_eq_u32 s63, 0
s_cbranch_scc1 fl0_87
buffer_store_short v24, v7, s[28:31], s70 offen
s_branch L_end
fl0_87:
ds_write_b16 v8, v24 offset:384
fnr_86:
s_cmp_eq_u32 s63, 0
s_cbranch_scc0 L_end
v_add_u32 v5, s34, 6
s_mov_b64 exec, 1
ds_write_b32 v3, v5
s_mov_b64 exec, -1
s_mul_i32 s79, s63, 64
s_sub_u32 s79, 32, s79
s_add_u32 s35, s79, 11
tw_96:
ds_read_b32 v5, v2 offset:16
s_waitcnt lgkmcnt(0)
v_cmp_gt_i32 vcc, s35, v5
s_cbranch_vccz twd_97
v_readfirstlane_b32 s54, v5
s_sub_u32 s55, s35, s54
s_cmp_lt_i32 s55, 2
s_cbranch_scc1 tws_98
s_add_u32 s54, s54, 2
s_or_b32 s54, s54, 1
s_cmp_eq_u32 s54, s52
s_cbranch_scc1 tws_98
s_bitcmp1_b32 s54, 4
s_cbranch_scc1 tws_98
s_mov_b32 s52, s54
s_add_u32 s54, s54, s53
s_and_b32 s54, s54, 15
s_mul_i32 s54, s54, 393216
s_add_u32 s54, s54, s56
s_buffer_load_dwordx2 s[46:47], s[48:51], s54 offset:4096
s_buffer_load_dwordx2 s[46:47], s[48:51], s54 offset:10240
s_buffer_load_dwordx2 s[46:47], s[48:51], s54 offset:16384
s_buffer_load_dwordx2 s[46:47], s[48:51], s54 offset:22528
tws_98:
s_sleep 4
s_sub_u32 s32, s32, 1
s_cmp_gt_i32 s32, 0
s_cbranch_scc1 tw_96
twd_97:
v_and_b32 v6, 48, v0
s_add_u32 s35, s34, 6
poll_99:
ds_read_b32 v5, v2 offset:24
ds_read_b128 v[8:11], v6 offset:384
ds_read_b128 v[12:15], v6 offset:448
pchk_100:
s_waitcnt lgkmcnt(2)
v_cmp_gt_i32 vcc, s35, v5
s_cbranch_vccz pdone_101
s_sleep 1
s_sub_u32 s32, s32, 1
s_cmp_gt_i32 s32, 0
s_cbranch_scc1 poll_99
pdone_101:
s_mov_b32 s63, 1
s_mov_b32 s34, 32
s_add_u32 s24, s24, 1409024
s_addc_u32 s25, s25, 0
s_mov_b32 s26, 1409024
s_mov_b32 s70, 131072
s_mov_b32 s79, 34
s_branch ftop_42
fxt_45:
v_max_u32 v8, 1, v8
v_max_u32 v9, 1, v9
v_max_u32 v10, 1, v10
v_max_u32 v11, 1, v11
v_max_u32 v12, 1, v12
v_max_u32 v13, 1, v13
v_max_u32 v14, 1, v14
v_max_u32 v15, 1, v15
s_mov_b32 exec_lo, 0x10001
s_mov_b32 exec_hi, 0x10001
buffer_store_dwordx4 v[8:11], v7, s[20:23], s73 offen offset:0 sc1
buffer_store_dwordx4 v[12:15], v7, s[20:23], s73 offen offset:64 sc1
s_mov_b64 exec, -1
s_branch fxb_46
fst_40:
s_lshl1_add_u32 s70, s78, s58
s_lshl_b32 s70, s70, 13
v_bfe_u32 v8, v0, 2, 2
v_lshl_add_u32 v8, v8, 9, v7
v_add_u32 v8, v8, v1
v_lshlrev_b32 v8, 2, v8
buffer_load_dwordx4 v[24:27], v8, s[8:11], s70 offen offset:0
buffer_load_dwordx4 v[28:31], v8, s[8:11], s70 offen offset:256
buffer_load_dwordx4 v[32:35], v8, s[8:11], s70 offen offset:512
buffer_load_dwordx4 v[36:39], v8, s[8:11], s70 offen offset:768
buffer_load_dwordx4 v[40:43], v8, s[8:11], s70 offen offset:1024
buffer_load_dwordx4 v[44:47], v8, s[8:11], s70 offen offset:1280
buffer_load_dwordx4 v[48:51], v8, s[8:11], s70 offen offset:1536
buffer_load_dwordx4 v[52:55], v8, s[8:11], s70 offen offset:1792
v_lshlrev_b32 v9, 4, v1
s_waitcnt vmcnt(7)
v_mfma_f32_16x16x32_bf16 v[16:19], v[24:27], v[252:255], 0
v_mfma_f32_16x16x32_bf16 v[20:23], v[24:27], v[24:27], 0
s_waitcnt vmcnt(6)
v_mfma_f32_16x16x32_bf16 v[16:19], v[28:31], v[252:255], v[16:19]
v_mfma_f32_16x16x32_bf16 v[20:23], v[28:31], v[28:31], v[20:23]
s_waitcnt vmcnt(5)
v_mfma_f32_16x16x32_bf16 v[16:19], v[32:35], v[252:255], v[16:19]
v_mfma_f32_16x16x32_bf16 v[20:23], v[32:35], v[32:35], v[20:23]
s_waitcnt vmcnt(4)
v_mfma_f32_16x16x32_bf16 v[16:19], v[36:39], v[252:255], v[16:19]
v_mfma_f32_16x16x32_bf16 v[20:23], v[36:39], v[36:39], v[20:23]
s_waitcnt vmcnt(3)
v_mfma_f32_16x16x32_bf16 v[16:19], v[40:43], v[252:255], v[16:19]
v_mfma_f32_16x16x32_bf16 v[20:23], v[40:43], v[40:43], v[20:23]
s_waitcnt vmcnt(2)
v_mfma_f32_16x16x32_bf16 v[16:19], v[44:47], v[252:255], v[16:19]
v_mfma_f32_16x16x32_bf16 v[20:23], v[44:47], v[44:47], v[20:23]
s_waitcnt vmcnt(1)
v_mfma_f32_16x16x32_bf16 v[16:19], v[48:51], v[252:255], v[16:19]
v_mfma_f32_16x16x32_bf16 v[20:23], v[48:51], v[48:51], v[20:23]
s_waitcnt vmcnt(0)
v_mfma_f32_16x16x32_bf16 v[16:19], v[52:55], v[252:255], v[16:19]
v_mfma_f32_16x16x32_bf16 v[20:23], v[52:55], v[52:55], v[20:23]
s_nop 6
v_add_f32 v16, v16, v18
v_add_f32 v17, v17, v19
v_add_f32 v16, v16, v17
s_nop 0
v_mov_b32_dpp v17, v20 quad_perm:[0,0,0,0] row_mask:0xf bank_mask:0xf
s_nop 1
v_add_f32_dpp v17, v21, v17 quad_perm:[1,1,1,1] row_mask:0xf bank_mask:0xf
s_nop 1
v_add_f32_dpp v17, v22, v17 quad_perm:[2,2,2,2] row_mask:0xf bank_mask:0xf
s_nop 1
v_add_f32_dpp v17, v23, v17 quad_perm:[3,3,3,3] row_mask:0xf bank_mask:0xf
v_mul_f32 v5, 0xba800000, v16
v_mul_f32 v17, 0x3a800000, v17
v_fma_f32 v17, -v5, v5, v17
v_max_f32 v17, 0, v17
v_add_f32 v17, 0x3727c5ac, v17
v_rsq_f32 v16, v17
s_nop 0
v_mul_f32 v17, v5, v16
v_max_u32 v17, 1, v17
s_lshl_b32 s70, s60, 7
s_add_u32 s70, s70, s76
s_lshl_b32 s73, s58, 5
s_add_u32 s70, s70, s73
v_lshrrev_b32 v7, 1, v7
s_add_u32 s35, s34, 5
tw_102:
ds_read_b32 v5, v2 offset:16
s_waitcnt lgkmcnt(0)
v_cmp_gt_i32 vcc, s35, v5
s_cbranch_vccz twd_103
v_readfirstlane_b32 s54, v5
s_sub_u32 s55, s35, s54
s_cmp_lt_i32 s55, 2
s_cbranch_scc1 tws_104
s_add_u32 s54, s54, 2
s_or_b32 s54, s54, 1
s_cmp_eq_u32 s54, s52
s_cbranch_scc1 tws_104
s_bitcmp1_b32 s54, 4
s_cbranch_scc1 tws_104
s_mov_b32 s52, s54
s_add_u32 s54, s54, s53
s_and_b32 s54, s54, 15
s_mul_i32 s54, s54, 393216
s_add_u32 s54, s54, s56
s_buffer_load_dwordx2 s[46:47], s[48:51], s54 offset:4096
s_buffer_load_dwordx2 s[46:47], s[48:51], s54 offset:10240
s_buffer_load_dwordx2 s[46:47], s[48:51], s54 offset:16384
s_buffer_load_dwordx2 s[46:47], s[48:51], s54 offset:22528
tws_104:
s_sleep 4
s_sub_u32 s32, s32, 1
s_cmp_gt_i32 s32, 0
s_cbranch_scc1 tw_102
twd_103:
poll_105:
buffer_load_dword v12, v9, s[4:7], 0 offen sc1
pchk_106:
s_waitcnt vmcnt(0)
v_cmp_gt_u32 vcc, 64, v12
s_cbranch_vccz pdone_107
s_sleep 16
s_sub_u32 s32, s32, 1
s_cmp_gt_i32 s32, 0
s_cbranch_scc1 poll_105
pdone_107:
s_mov_b32 exec_lo, 0x00100001
s_mov_b32 exec_hi, 0x10000100
buffer_store_dwordx2 v[16:17], v7, s[24:27], s70 offen sc1
s_getreg_b32 s73, hwreg(HW_REG_XCC_ID)
s_mov_b64 exec, 1
v_add_u32 v12, s73, 1
buffer_store_dword v12, off, s[24:27], s70 offset:64 sc1
s_mov_b64 exec, -1
s_branch fsb_41
fg_47:
s_lshl1_add_u32 s35, s2, s58
s_lshl_b32 s35, s35, 12
s_add_u32 s44, s40, s35
s_addc_u32 s45, s41, 0
s_mov_b32 s35, 4
ft_108:
s_load_dwordx2 s[42:43], s[44:45], 60
s_load_dwordx2 s[42:43], s[44:45], 188
s_load_dwordx2 s[42:43], s[44:45], 316
s_load_dwordx2 s[42:43], s[44:45], 444
s_load_dwordx2 s[42:43], s[44:45], 572
s_load_dwordx2 s[42:43], s[44:45], 700
s_load_dwordx2 s[42:43], s[44:45], 828
s_load_dwordx2 s[42:43], s[44:45], 956
s_add_u32 s44, s44, 1024
s_addc_u32 s45, s45, 0
s_sub_u32 s35, s35, 1
s_cmp_eq_u32 s35, 0
s_cbranch_scc0 ft_108
v_lshrrev_b32 v250, 3, v0
v_mul_u32_u24 v250, 16256, v250
v_add_u32 v250, v250, v4
s_add_u32 s35, s66, 131072
buffer_load_dwordx4 v[184:187], v250, s[12:15], s35 offen nt
s_add_u32 s35, s66, 133120
buffer_load_dwordx4 v[188:191], v250, s[12:15], s35 offen nt
s_add_u32 s35, s66, 135168
buffer_load_dwordx4 v[192:195], v250, s[12:15], s35 offen nt
s_add_u32 s35, s66, 137216
buffer_load_dwordx4 v[196:199], v250, s[12:15], s35 offen nt
s_add_u32 s35, s66, 139264
buffer_load_dwordx4 v[200:203], v250, s[12:15], s35 offen nt
s_add_u32 s35, s66, 141312
buffer_load_dwordx4 v[204:207], v250, s[12:15], s35 offen nt
s_add_u32 s35, s66, 143360
buffer_load_dwordx4 v[208:211], v250, s[12:15], s35 offen nt
s_add_u32 s35, s66, 145408
buffer_load_dwordx4 v[212:215], v250, s[12:15], s35 offen nt
v_lshrrev_b32 v250, 3, v0
v_mul_u32_u24 v250, 16256, v250
v_add_u32 v250, v250, v4
s_add_u32 s35, s66, 0
buffer_load_dwordx4 v[152:155], v250, s[12:15], s35 offen nt
s_add_u32 s35, s66, 2048
buffer_load_dwordx4 v[156:159], v250, s[12:15], s35 offen nt
s_add_u32 s35, s66, 4096
buffer_load_dwordx4 v[160:163], v250, s[12:15], s35 offen nt
s_add_u32 s35, s66, 6144
buffer_load_dwordx4 v[164:167], v250, s[12:15], s35 offen nt
s_add_u32 s35, s66, 8192
buffer_load_dwordx4 v[168:171], v250, s[12:15], s35 offen nt
s_add_u32 s35, s66, 10240
buffer_load_dwordx4 v[172:175], v250, s[12:15], s35 offen nt
s_add_u32 s35, s66, 12288
buffer_load_dwordx4 v[176:179], v250, s[12:15], s35 offen nt
s_add_u32 s35, s66, 14336
buffer_load_dwordx4 v[180:183], v250, s[12:15], s35 offen nt
s_add_u32 s35, s34, 10
tw_109:
ds_read_b32 v5, v2 offset:16
s_waitcnt lgkmcnt(0)
v_cmp_gt_i32 vcc, s35, v5
s_cbranch_vccz twd_110
v_readfirstlane_b32 s54, v5
s_sub_u32 s55, s35, s54
s_cmp_lt_i32 s55, 2
s_cbranch_scc1 tws_111
s_add_u32 s54, s54, 2
s_or_b32 s54, s54, 1
s_cmp_eq_u32 s54, s52
s_cbranch_scc1 tws_111
s_bitcmp1_b32 s54, 4
s_cbranch_scc1 tws_111
s_mov_b32 s52, s54
s_add_u32 s54, s54, s53
s_and_b32 s54, s54, 15
s_mul_i32 s54, s54, 393216
s_add_u32 s54, s54, s56
s_buffer_load_dwordx2 s[46:47], s[48:51], s54 offset:4096
s_buffer_load_dwordx2 s[46:47], s[48:51], s54 offset:10240
s_buffer_load_dwordx2 s[46:47], s[48:51], s54 offset:16384
s_buffer_load_dwordx2 s[46:47], s[48:51], s54 offset:22528
tws_111:
s_sleep 4
s_sub_u32 s32, s32, 1
s_cmp_gt_i32 s32, 0
s_cbranch_scc1 tw_109
twd_110:
v_and_b32 v10, 0x7a0, v7
s_getreg_b32 s70, hwreg(HW_REG_XCC_ID)
s_add_u32 s70, s70, 1
poll_112:
buffer_load_dword v12, v10, s[24:27], s76 offen offset:64 sc1
pchk_113:
s_waitcnt vmcnt(0)
v_cmp_eq_u32 vcc, 0, v12
s_cbranch_vccz pdone_114
s_sub_u32 s32, s32, 1
s_cmp_gt_i32 s32, 0
s_cbranch_scc1 poll_112
pdone_114:
v_cmp_eq_u32 vcc, s70, v12
s_cmp_eq_u64 vcc, exec
s_cselect_b32 s70, 1, 0
v_mov_b32 v12, s70
v_mov_b32 v10, 0
s_mov_b64 exec, 1
ds_write_b32 v10, v12 offset:56
s_mov_b64 exec, -1
s_branch fg_48
fnw_58:
s_waitcnt lgkmcnt(0)
v_mov_b32 v252, 0
v_mov_b32 v253, 0
v_mov_b32 v254, 0
v_mov_b32 v255, 0
s_mul_i32 s42, s58, 1409024
s_mul_i32 s35, s78, 2048
s_add_u32 s35, s35, s42
s_add_u32 s35, s35, 524288
buffer_store_dwordx4 v[252:255], v4, s[24:27], s35 offen offset:0 sc1
buffer_store_dwordx4 v[252:255], v4, s[24:27], s35 offen offset:1024 sc1
s_mul_i32 s35, s78, 1408
s_add_u32 s35, s35, s42
s_add_u32 s35, s35, 1048576
buffer_store_dwordx4 v[252:255], v4, s[24:27], s35 offen offset:0 sc1
buffer_store_dwordx4 v[252:255], v4, s[24:27], s35 offen offset:384 sc1
s_lshl_b32 s35, s78, 10
s_add_u32 s35, s35, 1409024
s_cmp_eq_u32 s58, 1
s_cselect_b64 exec, -1, 0
buffer_store_dwordx4 v[252:255], v4, s[24:27], s35 offen offset:0 sc1
s_add_u32 s35, s35, 262144
buffer_store_dwordx4 v[252:255], v4, s[24:27], s35 offen offset:0 sc1
s_mov_b64 exec, -1
s_waitcnt vmcnt(0)
v_add_u32 v5, s34, 3
s_mov_b64 exec, 1
ds_write_b32 v3, v5
s_mov_b64 exec, -1
s_add_u32 s35, s34, 17
tw_115:
ds_read_b32 v5, v2 offset:16
s_waitcnt lgkmcnt(0)
v_cmp_gt_i32 vcc, s35, v5
s_cbranch_vccz twd_116
v_readfirstlane_b32 s54, v5
s_sub_u32 s55, s35, s54
s_cmp_lt_i32 s55, 2
s_cbranch_scc1 tws_117
s_add_u32 s54, s54, 2
s_or_b32 s54, s54, 1
s_cmp_eq_u32 s54, s52
s_cbranch_scc1 tws_117
s_bitcmp1_b32 s54, 4
s_cbranch_scc1 tws_117
s_mov_b32 s52, s54
s_add_u32 s54, s54, s53
s_and_b32 s54, s54, 15
s_mul_i32 s54, s54, 393216
s_add_u32 s54, s54, s56
s_buffer_load_dwordx2 s[46:47], s[48:51], s54 offset:4096
s_buffer_load_dwordx2 s[46:47], s[48:51], s54 offset:10240
s_buffer_load_dwordx2 s[46:47], s[48:51], s54 offset:16384
s_buffer_load_dwordx2 s[46:47], s[48:51], s54 offset:22528
tws_117:
s_sleep 4
s_sub_u32 s32, s32, 1
s_cmp_gt_i32 s32, 0
s_cbranch_scc1 tw_115
twd_116:
v_lshrrev_b32 v250, 4, v0
v_mul_u32_u24 v250, 28416, v250
v_add_u32 v250, v250, v4
s_add_u32 s35, s77, 688128
buffer_load_dwordx4 v[120:123], v250, s[16:19], s35 offen nt
s_add_u32 s35, s77, 695296
buffer_load_dwordx4 v[124:127], v250, s[16:19], s35 offen nt
s_add_u32 s35, s77, 702464
buffer_load_dwordx4 v[128:131], v250, s[16:19], s35 offen nt
s_add_u32 s35, s77, 709632
buffer_load_dwordx4 v[132:135], v250, s[16:19], s35 offen nt
s_add_u32 s35, s77, 802816
buffer_load_dwordx4 v[136:139], v250, s[16:19], s35 offen nt
s_add_u32 s35, s77, 809984
buffer_load_dwordx4 v[140:143], v250, s[16:19], s35 offen nt
s_add_u32 s35, s77, 817152
buffer_load_dwordx4 v[144:147], v250, s[16:19], s35 offen nt
s_add_u32 s35, s77, 824320
buffer_load_dwordx4 v[148:151], v250, s[16:19], s35 offen nt
v_lshrrev_b32 v250, 4, v0
v_mul_u32_u24 v250, 28416, v250
v_add_u32 v250, v250, v4
s_add_u32 s35, s77, 458752
buffer_load_dwordx4 v[88:91], v250, s[16:19], s35 offen nt
s_add_u32 s35, s77, 465920
buffer_load_dwordx4 v[92:95], v250, s[16:19], s35 offen nt
s_add_u32 s35, s77, 473088
buffer_load_dwordx4 v[96:99], v250, s[16:19], s35 offen nt
s_add_u32 s35, s77, 480256
buffer_load_dwordx4 v[100:103], v250, s[16:19], s35 offen nt
s_add_u32 s35, s77, 573440
buffer_load_dwordx4 v[104:107], v250, s[16:19], s35 offen nt
s_add_u32 s35, s77, 580608
buffer_load_dwordx4 v[108:111], v250, s[16:19], s35 offen nt
s_add_u32 s35, s77, 587776
buffer_load_dwordx4 v[112:115], v250, s[16:19], s35 offen nt
s_add_u32 s35, s77, 594944
buffer_load_dwordx4 v[116:119], v250, s[16:19], s35 offen nt
v_lshrrev_b32 v250, 4, v0
v_mul_u32_u24 v250, 28416, v250
v_add_u32 v250, v250, v4
s_add_u32 s35, s77, 229376
buffer_load_dwordx4 v[56:59], v250, s[16:19], s35 offen nt
s_add_u32 s35, s77, 236544
buffer_load_dwordx4 v[60:63], v250, s[16:19], s35 offen nt
s_add_u32 s35, s77, 243712
buffer_load_dwordx4 v[64:67], v250, s[16:19], s35 offen nt
s_add_u32 s35, s77, 250880
buffer_load_dwordx4 v[68:71], v250, s[16:19], s35 offen nt
s_add_u32 s35, s77, 344064
buffer_load_dwordx4 v[72:75], v250, s[16:19], s35 offen nt
s_add_u32 s35, s77, 351232
buffer_load_dwordx4 v[76:79], v250, s[16:19], s35 offen nt
s_add_u32 s35, s77, 358400
buffer_load_dwordx4 v[80:83], v250, s[16:19], s35 offen nt
s_add_u32 s35, s77, 365568
buffer_load_dwordx4 v[84:87], v250, s[16:19], s35 offen nt
v_lshrrev_b32 v250, 4, v0
v_mul_u32_u24 v250, 28416, v250
v_add_u32 v250, v250, v4
s_add_u32 s35, s77, 0
buffer_load_dwordx4 v[24:27], v250, s[16:19], s35 offen nt
s_add_u32 s35, s77, 7168
buffer_load_dwordx4 v[28:31], v250, s[16:19], s35 offen nt
s_add_u32 s35, s77, 14336
buffer_load_dwordx4 v[32:35], v250, s[16:19], s35 offen nt
s_add_u32 s35, s77, 21504
buffer_load_dwordx4 v[36:39], v250, s[16:19], s35 offen nt
s_add_u32 s35, s77, 114688
buffer_load_dwordx4 v[40:43], v250, s[16:19], s35 offen nt
s_add_u32 s35, s77, 121856
buffer_load_dwordx4 v[44:47], v250, s[16:19], s35 offen nt
s_add_u32 s35, s77, 129024
buffer_load_dwordx4 v[48:51], v250, s[16:19], s35 offen nt
s_add_u32 s35, s77, 136192
buffer_load_dwordx4 v[52:55], v250, s[16:19], s35 offen nt
s_waitcnt lgkmcnt(0)
s_mov_b32 s42, 0x05040100
s_mov_b32 s43, 0x07060302
s_cmp_eq_u32 s65, 0
s_cbranch_scc0 fq_118
v_perm_b32 v216, v188, v184, s42
v_perm_b32 v220, v188, v184, s43
v_perm_b32 v224, v189, v185, s42
v_perm_b32 v228, v189, v185, s43
v_perm_b32 v232, v190, v186, s42
v_perm_b32 v236, v190, v186, s43
v_perm_b32 v240, v191, v187, s42
v_perm_b32 v244, v191, v187, s43
v_perm_b32 v217, v196, v192, s42
v_perm_b32 v221, v196, v192, s43
v_perm_b32 v225, v197, v193, s42
v_perm_b32 v229, v197, v193, s43
v_perm_b32 v233, v198, v194, s42
v_perm_b32 v237, v198, v194, s43
v_perm_b32 v241, v199, v195, s42
v_perm_b32 v245, v199, v195, s43
v_perm_b32 v218, v204, v200, s42
v_perm_b32 v222, v204, v200, s43
v_perm_b32 v226, v205, v201, s42
v_perm_b32 v230, v205, v201, s43
v_perm_b32 v234, v206, v202, s42
v_perm_b32 v238, v206, v202, s43
v_perm_b32 v242, v207, v203, s42
v_perm_b32 v246, v207, v203, s43
v_perm_b32 v219, v212, v208, s42
v_perm_b32 v223, v212, v208, s43
v_perm_b32 v227, v213, v209, s42
v_perm_b32 v231, v213, v209, s43
v_perm_b32 v235, v214, v210, s42
v_perm_b32 v239, v214, v210, s43
v_perm_b32 v243, v215, v211, s42
v_perm_b32 v247, v215, v211, s43
v_perm_b32 v184, v156, v152, s42
v_perm_b32 v188, v156, v152, s43
v_perm_b32 v192, v157, v153, s42
v_perm_b32 v196, v157, v153, s43
v_perm_b32 v200, v158, v154, s42
v_perm_b32 v204, v158, v154, s43
v_perm_b32 v208, v159, v155, s42
v_perm_b32 v212, v159, v155, s43
v_perm_b32 v185, v164, v160, s42
v_perm_b32 v189, v164, v160, s43
v_perm_b32 v193, v165, v161, s42
v_perm_b32 v197, v165, v161, s43
v_perm_b32 v201, v166, v162, s42
v_perm_b32 v205, v166, v162, s43
v_perm_b32 v209, v167, v163, s42
v_perm_b32 v213, v167, v163, s43
v_perm_b32 v186, v172, v168, s42
v_perm_b32 v190, v172, v168, s43
v_perm_b32 v194, v173, v169, s42
v_perm_b32 v198, v173, v169, s43
v_perm_b32 v202, v174, v170, s42
v_perm_b32 v206, v174, v170, s43
v_perm_b32 v210, v175, v171, s42
v_perm_b32 v214, v175, v171, s43
v_perm_b32 v187, v180, v176, s42
v_perm_b32 v191, v180, v176, s43
v_perm_b32 v195, v181, v177, s42
v_perm_b32 v199, v181, v177, s43
v_perm_b32 v203, v182, v178, s42
v_perm_b32 v207, v182, v178, s43
v_perm_b32 v211, v183, v179, s42
v_perm_b32 v215, v183, v179, s43
s_waitcnt vmcnt(30)
v_perm_b32 v152, v124, v120, s42
v_perm_b32 v156, v124, v120, s43
v_perm_b32 v160, v125, v121, s42
v_perm_b32 v164, v125, v121, s43
v_perm_b32 v168, v126, v122, s42
v_perm_b32 v172, v126, v122, s43
v_perm_b32 v176, v127, v123, s42
v_perm_b32 v180, v127, v123, s43
s_waitcnt vmcnt(28)
v_perm_b32 v153, v132, v128, s42
v_perm_b32 v157, v132, v128, s43
v_perm_b32 v161, v133, v129, s42
v_perm_b32 v165, v133, v129, s43
v_perm_b32 v169, v134, v130, s42
v_perm_b32 v173, v134, v130, s43
v_perm_b32 v177, v135, v131, s42
v_perm_b32 v181, v135, v131, s43
s_waitcnt vmcnt(26)
v_perm_b32 v154, v140, v136, s42
v_perm_b32 v158, v140, v136, s43
v_perm_b32 v162, v141, v137, s42
v_perm_b32 v166, v141, v137, s43
v_perm_b32 v170, v142, v138, s42
v_perm_b32 v174, v142, v138, s43
v_perm_b32 v178, v143, v139, s42
v_perm_b32 v182, v143, v139, s43
s_waitcnt vmcnt(24)
v_perm_b32 v155, v148, v144, s42
v_perm_b32 v159, v148, v144, s43
v_perm_b32 v163, v149, v145, s42
v_perm_b32 v167, v149, v145, s43
v_perm_b32 v171, v150, v146, s42
v_perm_b32 v175, v150, v146, s43
v_perm_b32 v179, v151, v147, s42
v_perm_b32 v183, v151, v147, s43
s_waitcnt vmcnt(22)
v_perm_b32 v120, v92, v88, s42
v_perm_b32 v124, v92, v88, s43
v_perm_b32 v128, v93, v89, s42
v_perm_b32 v132, v93, v89, s43
v_perm_b32 v136, v94, v90, s42
v_perm_b32 v140, v94, v90, s43
v_perm_b32 v144, v95, v91, s42
v_perm_b32 v148, v95, v91, s43
s_waitcnt vmcnt(20)
v_perm_b32 v121, v100, v96, s42
v_perm_b32 v125, v100, v96, s43
v_perm_b32 v129, v101, v97, s42
v_perm_b32 v133, v101, v97, s43
v_perm_b32 v137, v102, v98, s42
v_perm_b32 v141, v102, v98, s43
v_perm_b32 v145, v103, v99, s42
v_perm_b32 v149, v103, v99, s43
s_waitcnt vmcnt(18)
v_perm_b32 v122, v108, v104, s42
v_perm_b32 v126, v108, v104, s43
v_perm_b32 v130, v109, v105, s42
v_perm_b32 v134, v109, v105, s43
v_perm_b32 v138, v110, v106, s42
v_perm_b32 v142, v110, v106, s43
v_perm_b32 v146, v111, v107, s42
v_perm_b32 v150, v111, v107, s43
s_waitcnt vmcnt(16)
v_perm_b32 v123, v116, v112, s42
v_perm_b32 v127, v116, v112, s43
v_perm_b32 v131, v117, v113, s42
v_perm_b32 v135, v117, v113, s43
v_perm_b32 v139, v118, v114, s42
v_perm_b32 v143, v118, v114, s43
v_perm_b32 v147, v119, v115, s42
v_perm_b32 v151, v119, v115, s43
s_waitcnt vmcnt(14)
v_perm_b32 v88, v60, v56, s42
v_perm_b32 v92, v60, v56, s43
v_perm_b32 v96, v61, v57, s42
v_perm_b32 v100, v61, v57, s43
v_perm_b32 v104, v62, v58, s42
v_perm_b32 v108, v62, v58, s43
v_perm_b32 v112, v63, v59, s42
v_perm_b32 v116, v63, v59, s43
s_waitcnt vmcnt(12)
v_perm_b32 v89, v68, v64, s42
v_perm_b32 v93, v68, v64, s43
v_perm_b32 v97, v69, v65, s42
v_perm_b32 v101, v69, v65, s43
v_perm_b32 v105, v70, v66, s42
v_perm_b32 v109, v70, v66, s43
v_perm_b32 v113, v71, v67, s42
v_perm_b32 v117, v71, v67, s43
s_waitcnt vmcnt(10)
v_perm_b32 v90, v76, v72, s42
v_perm_b32 v94, v76, v72, s43
v_perm_b32 v98, v77, v73, s42
v_perm_b32 v102, v77, v73, s43
v_perm_b32 v106, v78, v74, s42
v_perm_b32 v110, v78, v74, s43
v_perm_b32 v114, v79, v75, s42
v_perm_b32 v118, v79, v75, s43
s_waitcnt vmcnt(8)
v_perm_b32 v91, v84, v80, s42
v_perm_b32 v95, v84, v80, s43
v_perm_b32 v99, v85, v81, s42
v_perm_b32 v103, v85, v81, s43
v_perm_b32 v107, v86, v82, s42
v_perm_b32 v111, v86, v82, s43
v_perm_b32 v115, v87, v83, s42
v_perm_b32 v119, v87, v83, s43
s_waitcnt vmcnt(6)
v_perm_b32 v56, v28, v24, s42
v_perm_b32 v60, v28, v24, s43
v_perm_b32 v64, v29, v25, s42
v_perm_b32 v68, v29, v25, s43
v_perm_b32 v72, v30, v26, s42
v_perm_b32 v76, v30, v26, s43
v_perm_b32 v80, v31, v27, s42
v_perm_b32 v84, v31, v27, s43
s_waitcnt vmcnt(4)
v_perm_b32 v57, v36, v32, s42
v_perm_b32 v61, v36, v32, s43
v_perm_b32 v65, v37, v33, s42
v_perm_b32 v69, v37, v33, s43
v_perm_b32 v73, v38, v34, s42
v_perm_b32 v77, v38, v34, s43
v_perm_b32 v81, v39, v35, s42
v_perm_b32 v85, v39, v35, s43
s_waitcnt vmcnt(2)
v_perm_b32 v58, v44, v40, s42
v_perm_b32 v62, v44, v40, s43
v_perm_b32 v66, v45, v41, s42
v_perm_b32 v70, v45, v41, s43
v_perm_b32 v74, v46, v42, s42
v_perm_b32 v78, v46, v42, s43
v_perm_b32 v82, v47, v43, s42
v_perm_b32 v86, v47, v43, s43
s_waitcnt vmcnt(0)
v_perm_b32 v59, v52, v48, s42
v_perm_b32 v63, v52, v48, s43
v_perm_b32 v67, v53, v49, s42
v_perm_b32 v71, v53, v49, s43
v_perm_b32 v75, v54, v50, s42
v_perm_b32 v79, v54, v50, s43
v_perm_b32 v83, v55, v51, s42
v_perm_b32 v87, v55, v51, s43
fq_118:
s_and_b32 s54, s59, 1
s_lshl_b32 s54, s54, 1
s_sub_u32 s54, s53, s54
s_and_b32 s54, s54, 15
s_mul_i32 s54, s54, 393216
s_add_u32 s54, s54, s56
s_buffer_load_dwordx2 s[46:47], s[48:51], s54 offset:4096
s_buffer_load_dwordx2 s[46:47], s[48:51], s54 offset:10240
s_buffer_load_dwordx2 s[46:47], s[48:51], s54 offset:16384
s_buffer_load_dwordx2 s[46:47], s[48:51], s54 offset:22528
s_buffer_load_dwordx2 s[46:47], s[48:51], s54 offset:2048
s_buffer_load_dwordx2 s[46:47], s[48:51], s54 offset:8192
s_buffer_load_dwordx2 s[46:47], s[48:51], s54 offset:14336
s_buffer_load_dwordx2 s[46:47], s[48:51], s54 offset:20480
s_buffer_load_dwordx2 s[46:47], s[48:51], s54 offset:0
s_buffer_load_dwordx2 s[46:47], s[48:51], s54 offset:6144
s_buffer_load_dwordx2 s[46:47], s[48:51], s54 offset:12288
s_buffer_load_dwordx2 s[46:47], s[48:51], s54 offset:18432
s_add_u32 s54, s53, 1
s_and_b32 s54, s54, 15
s_mul_i32 s54, s54, 393216
s_add_u32 s54, s54, s56
s_buffer_load_dwordx2 s[46:47], s[48:51], s54 offset:4096
s_buffer_load_dwordx2 s[46:47], s[48:51], s54 offset:10240
s_buffer_load_dwordx2 s[46:47], s[48:51], s54 offset:16384
s_buffer_load_dwordx2 s[46:47], s[48:51], s54 offset:22528
s_buffer_load_dwordx2 s[46:47], s[48:51], s54 offset:2048
s_buffer_load_dwordx2 s[46:47], s[48:51], s54 offset:8192
s_buffer_load_dwordx2 s[46:47], s[48:51], s54 offset:14336
s_buffer_load_dwordx2 s[46:47], s[48:51], s54 offset:20480
s_buffer_load_dwordx2 s[46:47], s[48:51], s54 offset:0
s_buffer_load_dwordx2 s[46:47], s[48:51], s54 offset:6144
s_buffer_load_dwordx2 s[46:47], s[48:51], s54 offset:12288
s_buffer_load_dwordx2 s[46:47], s[48:51], s54 offset:18432
s_add_u32 s54, s53, 3
s_and_b32 s54, s54, 15
s_mul_i32 s54, s54, 393216
s_add_u32 s54, s54, s56
s_buffer_load_dwordx2 s[46:47], s[48:51], s54 offset:4096
s_buffer_load_dwordx2 s[46:47], s[48:51], s54 offset:10240
s_buffer_load_dwordx2 s[46:47], s[48:51], s54 offset:16384
s_buffer_load_dwordx2 s[46:47], s[48:51], s54 offset:22528
s_buffer_load_dwordx2 s[46:47], s[48:51], s54 offset:2048
s_buffer_load_dwordx2 s[46:47], s[48:51], s54 offset:8192
s_buffer_load_dwordx2 s[46:47], s[48:51], s54 offset:14336
s_buffer_load_dwordx2 s[46:47], s[48:51], s54 offset:20480
s_buffer_load_dwordx2 s[46:47], s[48:51], s54 offset:0
s_buffer_load_dwordx2 s[46:47], s[48:51], s54 offset:6144
s_buffer_load_dwordx2 s[46:47], s[48:51], s54 offset:12288
s_buffer_load_dwordx2 s[46:47], s[48:51], s54 offset:18432
s_add_u32 s54, s53, 5
s_and_b32 s54, s54, 15
s_mul_i32 s54, s54, 393216
s_add_u32 s54, s54, s56
s_buffer_load_dwordx2 s[46:47], s[48:51], s54 offset:4096
s_buffer_load_dwordx2 s[46:47], s[48:51], s54 offset:10240
s_buffer_load_dwordx2 s[46:47], s[48:51], s54 offset:16384
s_buffer_load_dwordx2 s[46:47], s[48:51], s54 offset:22528
s_buffer_load_dwordx2 s[46:47], s[48:51], s54 offset:2048
s_buffer_load_dwordx2 s[46:47], s[48:51], s54 offset:8192
s_buffer_load_dwordx2 s[46:47], s[48:51], s54 offset:14336
s_buffer_load_dwordx2 s[46:47], s[48:51], s54 offset:20480
s_buffer_load_dwordx2 s[46:47], s[48:51], s54 offset:0
s_buffer_load_dwordx2 s[46:47], s[48:51], s54 offset:6144
s_buffer_load_dwordx2 s[46:47], s[48:51], s54 offset:12288
s_buffer_load_dwordx2 s[46:47], s[48:51], s54 offset:18432
s_waitcnt lgkmcnt(0)
s_branch fnw_59
fnd_68:
poll_119:
buffer_load_dwordx2 v[248:249], v6, s[24:27], s73 offen sc1
pchk_120:
s_waitcnt vmcnt(0)
v_min_u32 v5, v248, v249
v_cmp_eq_u32 vcc, 0, v5
s_cbranch_vccz pdone_121
s_sleep 1
s_sub_u32 s32, s32, 1
s_cmp_gt_i32 s32, 0
s_cbranch_scc1 poll_119
pdone_121:
v_mov_b32 v250, v248
s_nop 1
v_max_f32_dpp v250, v250, v250 row_ror:1 row_mask:0xf bank_mask:0xf
s_nop 1
v_max_f32_dpp v250, v250, v250 row_ror:2 row_mask:0xf bank_mask:0xf
s_nop 1
v_max_f32_dpp v250, v250, v250 row_ror:4 row_mask:0xf bank_mask:0xf
s_nop 1
v_max_f32_dpp v250, v250, v250 row_ror:8 row_mask:0xf bank_mask:0xf
v_cmp_eq_f32 vcc, v250, v248
s_ff1_i32_b64 s68, vcc
s_and_b32 s68, s68, 15
v_readlane_b32 s33, v249, s68
v_readlane_b32 s67, v248, s68
v_add_u32 v5, s34, 4
v_mov_b32 v250, s33
s_mov_b64 exec, 1
ds_write2_b32 v3, v5, v250 offset1:2
s_mov_b64 exec, -1
s_sub_u32 s33, s33, 1
s_and_b32 s33, s33, 2047
s_branch fnd_67
fpre_88:
poll_122:
buffer_load_dwordx4 v[24:27], v4, s[24:27], s72 offen offset:0 sc1
pchk_123:
s_waitcnt vmcnt(0)
v_min3_u32 v5, v24, v25, v26
v_min_u32 v5, v5, v27
v_cmp_eq_u32 vcc, 0, v5
s_cbranch_vccz pdone_124
s_sleep 8
s_sub_u32 s32, s32, 1
s_cmp_gt_i32 s32, 0
s_cbranch_scc1 poll_122
pdone_124:
s_branch fpre_89
L_m:
s_setprio 2
v_mov_b32 v6, 0
v_mov_b32 v7, 0
v_lshlrev_b32 v8, 3, v0
ds_write_b64 v8, v[6:7]
s_waitcnt lgkmcnt(0)
s_barrier
s_lshr_b32 s64, s58, 1
s_and_b32 s65, s58, 1
v_and_b32 v1, 3, v0
v_lshlrev_b32 v1, 2, v1
v_and_b32 v2, 4, v1
s_lshl2_add_u32 s35, s58, 0
v_mov_b32 v3, s35
s_mov_b32 s4, s44
s_mov_b32 s5, s45
s_mov_b32 s6, 0x800
s_mov_b32 s7, 0x00020000
v_lshrrev_b32 v6, 4, v0
v_lshlrev_b32 v6, 3, v6
s_lshl_b32 s66, s62, 7
buffer_load_dwordx2 v[232:233], v6, s[4:7], s66 offen offset:0
buffer_load_dwordx2 v[234:235], v6, s[4:7], s66 offen offset:32
buffer_load_dwordx2 v[236:237], v6, s[4:7], s66 offen offset:64
buffer_load_dwordx2 v[238:239], v6, s[4:7], s66 offen offset:96
v_and_b32 v6, 31, v0
v_lshrrev_b32 v7, 5, v0
v_lshlrev_b32 v7, 3, v7
v_sub_u32 v6, v6, v7
v_mov_b32 v7, 0xf149f2ca
v_cmp_le_i32 vcc, 0, v6
s_nop 1
v_cndmask_b32 v216, 0, v7, vcc
v_cmp_le_i32 vcc, 1, v6
s_nop 1
v_cndmask_b32 v217, 0, v7, vcc
v_cmp_le_i32 vcc, 2, v6
s_nop 1
v_cndmask_b32 v218, 0, v7, vcc
v_cmp_le_i32 vcc, 3, v6
s_nop 1
v_cndmask_b32 v219, 0, v7, vcc
v_cmp_le_i32 vcc, 16, v6
s_nop 1
v_cndmask_b32 v220, 0, v7, vcc
v_cmp_le_i32 vcc, 17, v6
s_nop 1
v_cndmask_b32 v221, 0, v7, vcc
v_cmp_le_i32 vcc, 18, v6
s_nop 1
v_cndmask_b32 v222, 0, v7, vcc
v_cmp_le_i32 vcc, 19, v6
s_nop 1
v_cndmask_b32 v223, 0, v7, vcc
v_cmp_le_i32 vcc, 4, v6
s_nop 1
v_cndmask_b32 v224, 0, v7, vcc
v_cmp_le_i32 vcc, 5, v6
s_nop 1
v_cndmask_b32 v225, 0, v7, vcc
v_cmp_le_i32 vcc, 6, v6
s_nop 1
v_cndmask_b32 v226, 0, v7, vcc
v_cmp_le_i32 vcc, 7, v6
s_nop 1
v_cndmask_b32 v227, 0, v7, vcc
v_cmp_le_i32 vcc, 20, v6
s_nop 1
v_cndmask_b32 v228, 0, v7, vcc
v_cmp_le_i32 vcc, 21, v6
s_nop 1
v_cndmask_b32 v229, 0, v7, vcc
v_cmp_le_i32 vcc, 22, v6
s_nop 1
v_cndmask_b32 v230, 0, v7, vcc
v_cmp_le_i32 vcc, 23, v6
s_nop 1
v_cndmask_b32 v231, 0, v7, vcc
v_lshrrev_b32 v6, 2, v0
v_xor_b32 v6, v6, v0
v_and_b32 v6, 4, v6
v_mov_b32 v7, 0x3f803f80
v_cmp_eq_u32 vcc, 0, v6
s_nop 1
v_cndmask_b32 v212, 0, v7, vcc
v_cndmask_b32 v213, 0, v7, vcc
v_cndmask_b32 v214, 0, v7, vcc
v_cndmask_b32 v215, 0, v7, vcc
v_lshrrev_b32 v196, 4, v0
s_cmp_eq_u32 0, 0
s_cbranch_scc0 mq_125
v_bfe_u32 v197, v0, 1, 3
v_xor_b32 v197, v197, v196
v_lshlrev_b32 v197, 4, v197
v_and_b32 v198, 15, v0
v_lshl_add_u32 v192, v198, 7, v197
v_xor_b32 v193, 64, v192
s_branch mq_126
mq_125:
v_lshlrev_b32 v192, 4, v0
v_add_u32 v193, 1024, v192
mq_126:
s_lshl_b32 s46, s65, 13
s_add_u32 s46, s46, 86016
v_add_u32 v192, s46, v192
v_add_u32 v193, s46, v193
v_bfe_u32 v197, v0, 2, 2
v_lshl_add_u32 v197, v196, 3, v197
v_bfe_u32 v198, v0, 3, 2
s_lshl_b32 s46, s64, 1
v_xor_b32 v198, s46, v198
v_lshlrev_b32 v198, 5, v198
v_lshl_add_u32 v197, v197, 7, v198
v_and_b32 v198, 3, v0
v_lshl_add_u32 v197, v198, 3, v197
v_add_u32 v194, 102400, v197
v_xor_b32 v195, 32, v194
v_mov_b32 v197, 0xf149f2ca
v_xor_b32 v216, v197, v216
v_xor_b32 v217, v197, v217
v_xor_b32 v218, v197, v218
v_xor_b32 v219, v197, v219
v_xor_b32 v220, v197, v220
v_xor_b32 v221, v197, v221
v_xor_b32 v222, v197, v222
v_xor_b32 v223, v197, v223
v_xor_b32 v224, v197, v224
v_xor_b32 v225, v197, v225
v_xor_b32 v226, v197, v226
v_xor_b32 v227, v197, v227
v_xor_b32 v228, v197, v228
v_xor_b32 v229, v197, v229
v_xor_b32 v230, v197, v230
v_xor_b32 v231, v197, v231
v_and_b32 v196, 15, v0
v_lshrrev_b32 v197, 4, v0
s_lshl_b32 s46, s65, 8
s_add_u32 s46, s46, 1280
s_mul_i32 s47, s64, 384
v_lshl_add_u32 v208, v196, 2, s46
v_lshl_add_u32 v209, v197, 4, s46
v_lshl_add_u32 v210, v196, 2, s47
v_lshl_add_u32 v211, v197, 4, s47
v_and_b32 v198, 1, v197
v_lshrrev_b32 v197, 1, v197
v_lshlrev_b32 v197, 9, v197
v_lshl_add_u32 v197, v198, 10, v197
s_lshl_b32 s46, s64, 12
s_lshl_b32 s47, s65, 13
s_add_u32 s46, s46, 131072
s_add_u32 s48, s46, 24576
s_sub_u32 s48, s48, s47
s_add_u32 s47, s46, s47
v_lshl_add_u32 v200, v196, 4, v197
v_and_b32 v198, 3, v0
v_lshl_add_u32 v197, v198, 4, v197
v_bfe_u32 v198, v0, 3, 1
v_lshl_add_u32 v197, v198, 6, v197
v_bfe_u32 v198, v0, 2, 1
v_lshl_add_u32 v198, v198, 8, v197
v_add_u32 v199, s48, v198
v_add_u32 v198, s47, v198
v_add_u32 v201, s48, v200
v_add_u32 v200, s47, v200
s_lshl_b32 s46, s59, 4
s_add_u32 s46, s46, s60
s_lshl_b32 s50, s59, 7
s_add_u32 s50, s50, s60
s_lshl_b32 s50, s50, 7
s_lshl_b32 s46, s46, 15
s_lshl_b32 s47, 0, 23
s_add_u32 s46, s46, s47
s_add_u32 s49, s46, 917504
L_mtop:
v_mov_b32 v6, v192
v_mov_b32 v7, v193
v_mov_b32 v8, v194
v_mov_b32 v9, v195
v_mov_b32 v12, v198
v_mov_b32 v13, v199
v_mov_b32 v14, v200
v_mov_b32 v15, v201
s_mov_b32 s71, s49
s_mov_b32 s72, s50
v_add_u32 v4, s34, 1
s_mov_b32 s66, 14
s_mov_b32 s67, -40960
s_mov_b32 s68, -40960
s_mov_b32 s69, 81920
s_add_u32 s35, s34, 1
lw_127:
ds_read_b32 v5, v2 offset:16
s_waitcnt lgkmcnt(0)
v_cmp_gt_i32 vcc, s35, v5
s_cbranch_vccz lwd_128
s_sub_u32 s32, s32, 1
s_cmp_gt_i32 s32, 0
s_cbranch_scc1 lw_127
lwd_128:
ds_read_b64_tr_b16 v[144:145], v8 offset:8192
ds_read_b64_tr_b16 v[146:147], v8 offset:8704
ds_read_b64_tr_b16 v[148:149], v8 offset:12288
ds_read_b64_tr_b16 v[150:151], v8 offset:12800
ds_read_b128 v[112:115], v6 offset:0
ds_read_b128 v[116:119], v7 offset:0
ds_read_b64_tr_b16 v[152:153], v9 offset:8192
ds_read_b64_tr_b16 v[154:155], v9 offset:8704
ds_read_b64_tr_b16 v[156:157], v9 offset:12288
ds_read_b64_tr_b16 v[158:159], v9 offset:12800
ds_read_b128 v[120:123], v6 offset:2048
ds_read_b128 v[124:127], v7 offset:2048
ds_read_b128 v[128:131], v6 offset:4096
ds_read_b128 v[132:135], v7 offset:4096
ds_read_b128 v[136:139], v6 offset:6144
ds_read_b128 v[140:143], v7 offset:6144
s_waitcnt lgkmcnt(11)
v_mfma_f32_16x16x32_bf16 v[16:19], v[144:147], v[112:115], 0
ds_read_b64_tr_b16 v[160:161], v8 offset:16384
s_waitcnt lgkmcnt(11)
v_mfma_f32_16x16x32_bf16 v[16:19], v[148:151], v[116:119], v[16:19]
ds_read_b64_tr_b16 v[162:163], v8 offset:16896
s_waitcnt lgkmcnt(10)
v_mfma_f32_16x16x32_bf16 v[20:23], v[152:155], v[112:115], 0
ds_read_b64_tr_b16 v[164:165], v8 offset:20480
s_waitcnt lgkmcnt(9)
v_mfma_f32_16x16x32_bf16 v[20:23], v[156:159], v[116:119], v[20:23]
ds_read_b64_tr_b16 v[166:167], v8 offset:20992
s_waitcnt lgkmcnt(9)
v_mfma_f32_16x16x32_bf16 v[24:27], v[144:147], v[120:123], 0
ds_read_b64_tr_b16 v[168:169], v9 offset:16384
s_waitcnt lgkmcnt(9)
v_mfma_f32_16x16x32_bf16 v[24:27], v[148:151], v[124:127], v[24:27]
ds_read_b64_tr_b16 v[170:171], v9 offset:16896
v_mfma_f32_16x16x32_bf16 v[28:31], v[152:155], v[120:123], 0
ds_read_b64_tr_b16 v[172:173], v9 offset:20480
v_mfma_f32_16x16x32_bf16 v[28:31], v[156:159], v[124:127], v[28:31]
ds_read_b64_tr_b16 v[174:175], v9 offset:20992
s_waitcnt lgkmcnt(11)
v_mfma_f32_16x16x32_bf16 v[32:35], v[144:147], v[128:131], 0
ds_read_b64_tr_b16 v[176:177], v8 offset:0
s_waitcnt lgkmcnt(11)
v_mfma_f32_16x16x32_bf16 v[32:35], v[148:151], v[132:135], v[32:35]
ds_read_b64_tr_b16 v[178:179], v8 offset:512
v_mfma_f32_16x16x32_bf16 v[36:39], v[152:155], v[128:131], 0
ds_read_b64_tr_b16 v[180:181], v8 offset:4096
v_mfma_f32_16x16x32_bf16 v[36:39], v[156:159], v[132:135], v[36:39]
ds_read_b64_tr_b16 v[182:183], v8 offset:4608
s_waitcnt lgkmcnt(13)
v_mfma_f32_16x16x32_bf16 v[40:43], v[144:147], v[136:139], 0
ds_read_b64_tr_b16 v[184:185], v9 offset:0
s_waitcnt lgkmcnt(13)
v_mfma_f32_16x16x32_bf16 v[40:43], v[148:151], v[140:143], v[40:43]
ds_read_b64_tr_b16 v[186:187], v9 offset:512
v_mfma_f32_16x16x32_bf16 v[44:47], v[152:155], v[136:139], 0
ds_read_b64_tr_b16 v[188:189], v9 offset:4096
v_mfma_f32_16x16x32_bf16 v[44:47], v[156:159], v[140:143], v[44:47]
ds_read_b64_tr_b16 v[190:191], v9 offset:4608
s_waitcnt lgkmcnt(14)
v_mfma_f32_16x16x32_bf16 v[48:51], v[112:115], v[160:163], 0
s_mov_b64 exec, 1
ds_write_b32 v3, v4
s_mov_b64 exec, -1
s_waitcnt lgkmcnt(13)
v_mfma_f32_16x16x32_bf16 v[48:51], v[116:119], v[164:167], v[48:51]
v_add_u32 v8, s67, v8
v_add_u32 v9, s67, v9
s_waitcnt lgkmcnt(11)
v_mfma_f32_16x16x32_bf16 v[52:55], v[112:115], v[168:171], 0
v_add_u32 v6, s67, v6
v_add_u32 v7, s67, v7
s_waitcnt lgkmcnt(9)
v_mfma_f32_16x16x32_bf16 v[52:55], v[116:119], v[172:175], v[52:55]
s_mov_b32 s70, s67
s_mov_b32 s67, s68
s_mov_b32 s68, s69
s_mov_b32 s69, s70
v_mfma_f32_16x16x32_bf16 v[56:59], v[120:123], v[160:163], 0
ds_read_b32 v5, v2 offset:16
v_mfma_f32_16x16x32_bf16 v[56:59], v[124:127], v[164:167], v[56:59]
v_mfma_f32_16x16x32_bf16 v[60:63], v[120:123], v[168:171], 0
v_mfma_f32_16x16x32_bf16 v[60:63], v[124:127], v[172:175], v[60:63]
v_mfma_f32_16x16x32_bf16 v[64:67], v[128:131], v[160:163], 0
s_waitcnt lgkmcnt(0)
v_cmp_ge_u32 vcc, v4, v5
s_cbranch_vccnz mspin_132
mback_133:
v_add_u32 v4, 1, v4
v_mfma_f32_16x16x32_bf16 v[64:67], v[132:135], v[164:167], v[64:67]
ds_read_b64_tr_b16 v[144:145], v8 offset:8192
v_mfma_f32_16x16x32_bf16 v[68:71], v[128:131], v[168:171], 0
ds_read_b64_tr_b16 v[146:147], v8 offset:8704
v_mfma_f32_16x16x32_bf16 v[68:71], v[132:135], v[172:175], v[68:71]
ds_read_b64_tr_b16 v[148:149], v8 offset:12288
v_mfma_f32_16x16x32_bf16 v[72:75], v[136:139], v[160:163], 0
ds_read_b64_tr_b16 v[150:151], v8 offset:12800
v_mfma_f32_16x16x32_bf16 v[72:75], v[140:143], v[164:167], v[72:75]
ds_read_b64_tr_b16 v[152:153], v9 offset:8192
v_mfma_f32_16x16x32_bf16 v[76:79], v[136:139], v[168:171], 0
ds_read_b64_tr_b16 v[154:155], v9 offset:8704
v_mfma_f32_16x16x32_bf16 v[76:79], v[140:143], v[172:175], v[76:79]
ds_read_b64_tr_b16 v[156:157], v9 offset:12288
v_mfma_f32_16x16x32_bf16 v[80:83], v[176:179], v[112:115], 0
ds_read_b64_tr_b16 v[158:159], v9 offset:12800
v_mfma_f32_16x16x32_bf16 v[80:83], v[180:183], v[116:119], v[80:83]
v_mfma_f32_16x16x32_bf16 v[84:87], v[184:187], v[112:115], 0
v_mfma_f32_16x16x32_bf16 v[84:87], v[188:191], v[116:119], v[84:87]
ds_read_b128 v[112:115], v6 offset:0
ds_read_b128 v[116:119], v7 offset:0
v_mfma_f32_16x16x32_bf16 v[88:91], v[176:179], v[120:123], 0
v_mfma_f32_16x16x32_bf16 v[88:91], v[180:183], v[124:127], v[88:91]
v_mfma_f32_16x16x32_bf16 v[92:95], v[184:187], v[120:123], 0
v_mfma_f32_16x16x32_bf16 v[92:95], v[188:191], v[124:127], v[92:95]
ds_read_b128 v[120:123], v6 offset:2048
ds_read_b128 v[124:127], v7 offset:2048
v_mfma_f32_16x16x32_bf16 v[96:99], v[176:179], v[128:131], 0
v_mfma_f32_16x16x32_bf16 v[96:99], v[180:183], v[132:135], v[96:99]
v_mfma_f32_16x16x32_bf16 v[100:103], v[184:187], v[128:131], 0
v_mfma_f32_16x16x32_bf16 v[100:103], v[188:191], v[132:135], v[100:103]
ds_read_b128 v[128:131], v6 offset:4096
ds_read_b128 v[132:135], v7 offset:4096
v_mfma_f32_16x16x32_bf16 v[104:107], v[176:179], v[136:139], 0
v_mfma_f32_16x16x32_bf16 v[104:107], v[180:183], v[140:143], v[104:107]
v_mfma_f32_16x16x32_bf16 v[108:111], v[184:187], v[136:139], 0
v_mfma_f32_16x16x32_bf16 v[108:111], v[188:191], v[140:143], v[108:111]
ds_read_b128 v[136:139], v6 offset:6144
ds_read_b128 v[140:143], v7 offset:6144
.p2align 6
mqkv_129:
s_waitcnt lgkmcnt(7)
v_mfma_f32_16x16x32_bf16 v[16:19], v[144:147], v[112:115], v[16:19]
ds_read_b64_tr_b16 v[160:161], v8 offset:16384
s_waitcnt lgkmcnt(7)
v_mfma_f32_16x16x32_bf16 v[16:19], v[148:151], v[116:119], v[16:19]
ds_read_b64_tr_b16 v[162:163], v8 offset:16896
v_mfma_f32_16x16x32_bf16 v[20:23], v[152:155], v[112:115], v[20:23]
ds_read_b64_tr_b16 v[164:165], v8 offset:20480
v_mfma_f32_16x16x32_bf16 v[20:23], v[156:159], v[116:119], v[20:23]
ds_read_b64_tr_b16 v[166:167], v8 offset:20992
s_waitcnt lgkmcnt(9)
v_mfma_f32_16x16x32_bf16 v[24:27], v[144:147], v[120:123], v[24:27]
ds_read_b64_tr_b16 v[168:169], v9 offset:16384
s_waitcnt lgkmcnt(9)
v_mfma_f32_16x16x32_bf16 v[24:27], v[148:151], v[124:127], v[24:27]
ds_read_b64_tr_b16 v[170:171], v9 offset:16896
v_mfma_f32_16x16x32_bf16 v[28:31], v[152:155], v[120:123], v[28:31]
ds_read_b64_tr_b16 v[172:173], v9 offset:20480
v_mfma_f32_16x16x32_bf16 v[28:31], v[156:159], v[124:127], v[28:31]
ds_read_b64_tr_b16 v[174:175], v9 offset:20992
s_waitcnt lgkmcnt(11)
v_mfma_f32_16x16x32_bf16 v[32:35], v[144:147], v[128:131], v[32:35]
ds_read_b64_tr_b16 v[176:177], v8 offset:0
s_waitcnt lgkmcnt(11)
v_mfma_f32_16x16x32_bf16 v[32:35], v[148:151], v[132:135], v[32:35]
ds_read_b64_tr_b16 v[178:179], v8 offset:512
v_mfma_f32_16x16x32_bf16 v[36:39], v[152:155], v[128:131], v[36:39]
ds_read_b64_tr_b16 v[180:181], v8 offset:4096
v_mfma_f32_16x16x32_bf16 v[36:39], v[156:159], v[132:135], v[36:39]
ds_read_b64_tr_b16 v[182:183], v8 offset:4608
s_waitcnt lgkmcnt(13)
v_mfma_f32_16x16x32_bf16 v[40:43], v[144:147], v[136:139], v[40:43]
ds_read_b64_tr_b16 v[184:185], v9 offset:0
s_waitcnt lgkmcnt(13)
v_mfma_f32_16x16x32_bf16 v[40:43], v[148:151], v[140:143], v[40:43]
ds_read_b64_tr_b16 v[186:187], v9 offset:512
v_mfma_f32_16x16x32_bf16 v[44:47], v[152:155], v[136:139], v[44:47]
ds_read_b64_tr_b16 v[188:189], v9 offset:4096
v_mfma_f32_16x16x32_bf16 v[44:47], v[156:159], v[140:143], v[44:47]
ds_read_b64_tr_b16 v[190:191], v9 offset:4608
s_waitcnt lgkmcnt(14)
v_mfma_f32_16x16x32_bf16 v[48:51], v[112:115], v[160:163], v[48:51]
s_mov_b64 exec, 1
ds_write_b32 v3, v4
s_mov_b64 exec, -1
s_waitcnt lgkmcnt(13)
v_mfma_f32_16x16x32_bf16 v[48:51], v[116:119], v[164:167], v[48:51]
v_add_u32 v8, s67, v8
v_add_u32 v9, s67, v9
s_waitcnt lgkmcnt(11)
v_mfma_f32_16x16x32_bf16 v[52:55], v[112:115], v[168:171], v[52:55]
v_add_u32 v6, s67, v6
v_add_u32 v7, s67, v7
s_waitcnt lgkmcnt(9)
v_mfma_f32_16x16x32_bf16 v[52:55], v[116:119], v[172:175], v[52:55]
s_mov_b32 s70, s67
s_mov_b32 s67, s68
s_mov_b32 s68, s69
s_mov_b32 s69, s70
v_mfma_f32_16x16x32_bf16 v[56:59], v[120:123], v[160:163], v[56:59]
ds_read_b32 v5, v2 offset:16
v_mfma_f32_16x16x32_bf16 v[56:59], v[124:127], v[164:167], v[56:59]
v_mfma_f32_16x16x32_bf16 v[60:63], v[120:123], v[168:171], v[60:63]
v_mfma_f32_16x16x32_bf16 v[60:63], v[124:127], v[172:175], v[60:63]
v_mfma_f32_16x16x32_bf16 v[64:67], v[128:131], v[160:163], v[64:67]
s_waitcnt lgkmcnt(0)
v_cmp_ge_u32 vcc, v4, v5
s_cbranch_vccnz mspin_130
mback_131:
v_add_u32 v4, 1, v4
v_mfma_f32_16x16x32_bf16 v[64:67], v[132:135], v[164:167], v[64:67]
ds_read_b64_tr_b16 v[144:145], v8 offset:8192
v_mfma_f32_16x16x32_bf16 v[68:71], v[128:131], v[168:171], v[68:71]
ds_read_b64_tr_b16 v[146:147], v8 offset:8704
v_mfma_f32_16x16x32_bf16 v[68:71], v[132:135], v[172:175], v[68:71]
ds_read_b64_tr_b16 v[148:149], v8 offset:12288
v_mfma_f32_16x16x32_bf16 v[72:75], v[136:139], v[160:163], v[72:75]
ds_read_b64_tr_b16 v[150:151], v8 offset:12800
v_mfma_f32_16x16x32_bf16 v[72:75], v[140:143], v[164:167], v[72:75]
ds_read_b64_tr_b16 v[152:153], v9 offset:8192
v_mfma_f32_16x16x32_bf16 v[76:79], v[136:139], v[168:171], v[76:79]
ds_read_b64_tr_b16 v[154:155], v9 offset:8704
v_mfma_f32_16x16x32_bf16 v[76:79], v[140:143], v[172:175], v[76:79]
ds_read_b64_tr_b16 v[156:157], v9 offset:12288
v_mfma_f32_16x16x32_bf16 v[80:83], v[176:179], v[112:115], v[80:83]
ds_read_b64_tr_b16 v[158:159], v9 offset:12800
v_mfma_f32_16x16x32_bf16 v[80:83], v[180:183], v[116:119], v[80:83]
v_mfma_f32_16x16x32_bf16 v[84:87], v[184:187], v[112:115], v[84:87]
v_mfma_f32_16x16x32_bf16 v[84:87], v[188:191], v[116:119], v[84:87]
ds_read_b128 v[112:115], v6 offset:0
ds_read_b128 v[116:119], v7 offset:0
v_mfma_f32_16x16x32_bf16 v[88:91], v[176:179], v[120:123], v[88:91]
v_mfma_f32_16x16x32_bf16 v[88:91], v[180:183], v[124:127], v[88:91]
v_mfma_f32_16x16x32_bf16 v[92:95], v[184:187], v[120:123], v[92:95]
v_mfma_f32_16x16x32_bf16 v[92:95], v[188:191], v[124:127], v[92:95]
ds_read_b128 v[120:123], v6 offset:2048
ds_read_b128 v[124:127], v7 offset:2048
v_mfma_f32_16x16x32_bf16 v[96:99], v[176:179], v[128:131], v[96:99]
v_mfma_f32_16x16x32_bf16 v[96:99], v[180:183], v[132:135], v[96:99]
v_mfma_f32_16x16x32_bf16 v[100:103], v[184:187], v[128:131], v[100:103]
v_mfma_f32_16x16x32_bf16 v[100:103], v[188:191], v[132:135], v[100:103]
ds_read_b128 v[128:131], v6 offset:4096
ds_read_b128 v[132:135], v7 offset:4096
v_mfma_f32_16x16x32_bf16 v[104:107], v[176:179], v[136:139], v[104:107]
v_mfma_f32_16x16x32_bf16 v[104:107], v[180:183], v[140:143], v[104:107]
s_sub_u32 s66, s66, 1
s_cmp_eq_u32 s66, 0
v_mfma_f32_16x16x32_bf16 v[108:111], v[184:187], v[136:139], v[108:111]
v_mfma_f32_16x16x32_bf16 v[108:111], v[188:191], v[140:143], v[108:111]
ds_read_b128 v[136:139], v6 offset:6144
ds_read_b128 v[140:143], v7 offset:6144
s_cbranch_scc0 mqkv_129
s_waitcnt lgkmcnt(7)
v_mfma_f32_16x16x32_bf16 v[16:19], v[144:147], v[112:115], v[16:19]
ds_read_b32 v5, v2 offset:24
s_add_u32 s35, s34, 2
v_mov_b32 v6, 0
ds_read_b64_tr_b16 v[160:161], v8 offset:16384
s_waitcnt lgkmcnt(8)
v_mfma_f32_16x16x32_bf16 v[16:19], v[148:151], v[116:119], v[16:19]
ds_read_b64_tr_b16 v[162:163], v8 offset:16896
v_mfma_f32_16x16x32_bf16 v[20:23], v[152:155], v[112:115], v[20:23]
ds_read_b64_tr_b16 v[164:165], v8 offset:20480
v_mfma_f32_16x16x32_bf16 v[20:23], v[156:159], v[116:119], v[20:23]
ds_read_b64_tr_b16 v[166:167], v8 offset:20992
s_waitcnt lgkmcnt(10)
v_mfma_f32_16x16x32_bf16 v[24:27], v[144:147], v[120:123], v[24:27]
ds_read_b64_tr_b16 v[168:169], v9 offset:16384
s_waitcnt lgkmcnt(10)
v_mfma_f32_16x16x32_bf16 v[24:27], v[148:151], v[124:127], v[24:27]
ds_read_b64_tr_b16 v[170:171], v9 offset:16896
v_mfma_f32_16x16x32_bf16 v[28:31], v[152:155], v[120:123], v[28:31]
ds_read_b64_tr_b16 v[172:173], v9 offset:20480
s_waitcnt lgkmcnt(7)
v_cmp_gt_i32 vcc, s35, v5
s_cbranch_vccnz lspin_134
lback_135:
ds_read2_b32 v[6:7], v6 offset0:8 offset1:14
ds_read_b128 v[200:203], v211 offset:2432
v_mfma_f32_16x16x32_bf16 v[28:31], v[156:159], v[124:127], v[28:31]
ds_read_b64_tr_b16 v[174:175], v9 offset:20992
ds_read_b128 v[204:207], v211 offset:2496
ds_read2_b32 v[192:193], v208 offset0:0 offset1:128
v_mfma_f32_16x16x32_bf16 v[32:35], v[144:147], v[128:131], v[32:35]
ds_read2_b32 v[194:195], v208 offset0:16 offset1:144
v_mfma_f32_16x16x32_bf16 v[32:35], v[148:151], v[132:135], v[32:35]
ds_read2_b32 v[196:197], v208 offset0:32 offset1:160
ds_read2_b32 v[198:199], v208 offset0:48 offset1:176
v_mfma_f32_16x16x32_bf16 v[36:39], v[152:155], v[128:131], v[36:39]
ds_read_b64_tr_b16 v[176:177], v8 offset:0
ds_read_b64_tr_b16 v[178:179], v8 offset:512
v_mfma_f32_16x16x32_bf16 v[36:39], v[156:159], v[132:135], v[36:39]
ds_read_b64_tr_b16 v[180:181], v8 offset:4096
v_mfma_f32_16x16x32_bf16 v[40:43], v[144:147], v[136:139], v[40:43]
ds_read_b64_tr_b16 v[182:183], v8 offset:4608
ds_read_b64_tr_b16 v[184:185], v9 offset:0
v_mfma_f32_16x16x32_bf16 v[40:43], v[148:151], v[140:143], v[40:43]
ds_read_b64_tr_b16 v[186:187], v9 offset:512
ds_read_b64_tr_b16 v[188:189], v9 offset:4096
v_mfma_f32_16x16x32_bf16 v[44:47], v[152:155], v[136:139], v[44:47]
ds_read_b64_tr_b16 v[190:191], v9 offset:4608
v_mfma_f32_16x16x32_bf16 v[44:47], v[156:159], v[140:143], v[44:47]
s_mov_b64 exec, 1
ds_write_b32 v3, v4
s_mov_b64 exec, -1
s_waitcnt lgkmcnt(14)
v_readfirstlane_b32 s33, v6
v_readfirstlane_b32 s57, v7
s_sub_u32 s33, s33, 1
s_lshr_b32 s66, s33, 7
s_mov_b32 s73, -1
v_mfma_f32_16x16x32_bf16 v[48:51], v[112:115], v[160:163], v[48:51]
s_cmp_eq_u32 s66, s59
s_cbranch_scc1 patch_136
pback_137:
v_mfma_f32_16x16x32_bf16 v[48:51], v[116:119], v[164:167], v[48:51]
ds_read_b32 v10, v210 offset:2560
ds_read_b32 v11, v210 offset:2624
s_waitcnt lgkmcnt(14)
v_mul_f32 v16, v16, v192
v_mul_f32 v17, v17, v192
v_mul_f32 v18, v18, v192
v_mfma_f32_16x16x32_bf16 v[52:55], v[112:115], v[168:171], v[52:55]
v_mul_f32 v19, v19, v192
v_mul_f32 v20, v20, v192
v_mul_f32 v21, v21, v192
v_mul_f32 v22, v22, v192
v_mul_f32 v23, v23, v192
v_mfma_f32_16x16x32_bf16 v[52:55], v[116:119], v[172:175], v[52:55]
v_fmac_f32 v16, v200, v193
v_fmac_f32 v17, v201, v193
v_fmac_f32 v18, v202, v193
v_fmac_f32 v19, v203, v193
v_fmac_f32 v20, v204, v193
v_mfma_f32_16x16x32_bf16 v[56:59], v[120:123], v[160:163], v[56:59]
v_fmac_f32 v21, v205, v193
v_fmac_f32 v22, v206, v193
v_fmac_f32 v23, v207, v193
v_cvt_pk_bf16_f32 v16, v16, v17
v_cvt_pk_bf16_f32 v17, v18, v19
v_mfma_f32_16x16x32_bf16 v[56:59], v[124:127], v[164:167], v[56:59]
v_cvt_pk_bf16_f32 v18, v20, v21
v_cvt_pk_bf16_f32 v19, v22, v23
buffer_store_dwordx4 v[16:19], v12, s[20:23], s71 offen offset:0 sc1
ds_write_b128 v12, v[16:19] offset:0
ds_read_b128 v[144:147], v209 offset:0
v_mfma_f32_16x16x32_bf16 v[60:63], v[120:123], v[168:171], v[60:63]
ds_read_b128 v[20:23], v209 offset:512
s_waitcnt lgkmcnt(14)
v_mul_f32 v24, v24, v194
v_mul_f32 v25, v25, v194
v_mul_f32 v26, v26, v194
v_mul_f32 v27, v27, v194
v_mfma_f32_16x16x32_bf16 v[60:63], v[124:127], v[172:175], v[60:63]
v_mul_f32 v28, v28, v194
v_mul_f32 v29, v29, v194
v_mul_f32 v30, v30, v194
v_mul_f32 v31, v31, v194
v_fmac_f32 v24, v200, v195
v_mfma_f32_16x16x32_bf16 v[64:67], v[128:131], v[160:163], v[64:67]
v_fmac_f32 v25, v201, v195
v_fmac_f32 v26, v202, v195
v_fmac_f32 v27, v203, v195
v_fmac_f32 v28, v204, v195
v_mfma_f32_16x16x32_bf16 v[64:67], v[132:135], v[164:167], v[64:67]
v_fmac_f32 v29, v205, v195
v_fmac_f32 v30, v206, v195
v_fmac_f32 v31, v207, v195
v_cvt_pk_bf16_f32 v24, v24, v25
v_cvt_pk_bf16_f32 v25, v26, v27
v_mfma_f32_16x16x32_bf16 v[68:71], v[128:131], v[168:171], v[68:71]
v_cvt_pk_bf16_f32 v26, v28, v29
v_cvt_pk_bf16_f32 v27, v30, v31
buffer_store_dwordx4 v[24:27], v12, s[20:23], s71 offen offset:128 sc1
ds_write_b128 v12, v[24:27] offset:128
ds_read_b128 v[148:151], v209 offset:64
v_mfma_f32_16x16x32_bf16 v[68:71], v[132:135], v[172:175], v[68:71]
ds_read_b128 v[28:31], v209 offset:576
v_mul_f32 v32, v32, v196
v_mul_f32 v33, v33, v196
v_mul_f32 v34, v34, v196
v_mul_f32 v35, v35, v196
v_mfma_f32_16x16x32_bf16 v[72:75], v[136:139], v[160:163], v[72:75]
v_mul_f32 v36, v36, v196
v_mul_f32 v37, v37, v196
v_mul_f32 v38, v38, v196
v_mul_f32 v39, v39, v196
v_fmac_f32 v32, v200, v197
v_mfma_f32_16x16x32_bf16 v[72:75], v[140:143], v[164:167], v[72:75]
v_fmac_f32 v33, v201, v197
v_fmac_f32 v34, v202, v197
v_fmac_f32 v35, v203, v197
v_fmac_f32 v36, v204, v197
v_fmac_f32 v37, v205, v197
v_mfma_f32_16x16x32_bf16 v[76:79], v[136:139], v[168:171], v[76:79]
v_fmac_f32 v38, v206, v197
v_fmac_f32 v39, v207, v197
v_cvt_pk_bf16_f32 v32, v32, v33
v_cvt_pk_bf16_f32 v33, v34, v35
v_cvt_pk_bf16_f32 v34, v36, v37
v_mfma_f32_16x16x32_bf16 v[76:79], v[140:143], v[172:175], v[76:79]
v_cvt_pk_bf16_f32 v35, v38, v39
buffer_store_dwordx4 v[32:35], v13, s[20:23], s71 offen offset:0 sc1
ds_write_b128 v13, v[32:35] offset:0
ds_read_b128 v[152:155], v209 offset:128
ds_read_b128 v[36:39], v209 offset:640
v_mul_f32 v40, v40, v198
v_mul_f32 v41, v41, v198
v_mul_f32 v42, v42, v198
v_mul_f32 v43, v43, v198
v_mul_f32 v44, v44, v198
v_mul_f32 v45, v45, v198
v_mul_f32 v46, v46, v198
v_mul_f32 v47, v47, v198
v_fmac_f32 v40, v200, v199
v_fmac_f32 v41, v201, v199
v_fmac_f32 v42, v202, v199
v_fmac_f32 v43, v203, v199
v_fmac_f32 v44, v204, v199
v_fmac_f32 v45, v205, v199
v_fmac_f32 v46, v206, v199
v_fmac_f32 v47, v207, v199
v_cvt_pk_bf16_f32 v40, v40, v41
v_cvt_pk_bf16_f32 v41, v42, v43
v_cvt_pk_bf16_f32 v42, v44, v45
v_cvt_pk_bf16_f32 v43, v46, v47
buffer_store_dwordx4 v[40:43], v13, s[20:23], s71 offen offset:128 sc1
ds_write_b128 v13, v[40:43] offset:128
ds_read_b128 v[156:159], v209 offset:192
ds_read_b128 v[44:47], v209 offset:704
s_cmp_ge_i32 s73, 0
s_cbranch_scc1 patch_138
pback_139:
ds_read_b128 v[160:163], v211 offset:2304
ds_read_b128 v[164:167], v211 offset:2368
s_waitcnt lgkmcnt(12)
v_pk_mul_f32 v[48:49], v[48:49], v[144:145]
v_pk_mul_f32 v[50:51], v[50:51], v[146:147]
s_waitcnt lgkmcnt(11)
v_pk_fma_f32 v[48:49], v[20:21], v[10:11], v[48:49] op_sel:[0,0,0] op_sel_hi:[1,0,1]
v_pk_fma_f32 v[50:51], v[22:23], v[10:11], v[50:51] op_sel:[0,0,0] op_sel_hi:[1,0,1]
s_waitcnt lgkmcnt(9)
v_pk_mul_f32 v[56:57], v[56:57], v[148:149]
v_pk_mul_f32 v[58:59], v[58:59], v[150:151]
s_waitcnt lgkmcnt(8)
v_pk_fma_f32 v[56:57], v[28:29], v[10:11], v[56:57] op_sel:[0,0,0] op_sel_hi:[1,0,1]
v_pk_fma_f32 v[58:59], v[30:31], v[10:11], v[58:59] op_sel:[0,0,0] op_sel_hi:[1,0,1]
v_cvt_pk_bf16_f32 v48, v48, v49
v_cvt_pk_bf16_f32 v49, v50, v51
v_cvt_pk_bf16_f32 v50, v56, v57
v_cvt_pk_bf16_f32 v51, v58, v59
buffer_store_dwordx4 v[48:51], v14, s[20:23], s71 offen offset:2048 sc1
ds_write_b128 v14, v[48:51] offset:2048
v_pk_mul_f32 v[52:53], v[52:53], v[144:145]
v_pk_mul_f32 v[54:55], v[54:55], v[146:147]
v_pk_fma_f32 v[52:53], v[20:21], v[10:11], v[52:53] op_sel:[0,1,0] op_sel_hi:[1,1,1]
v_pk_fma_f32 v[54:55], v[22:23], v[10:11], v[54:55] op_sel:[0,1,0] op_sel_hi:[1,1,1]
v_pk_mul_f32 v[60:61], v[60:61], v[148:149]
v_pk_mul_f32 v[62:63], v[62:63], v[150:151]
v_pk_fma_f32 v[60:61], v[28:29], v[10:11], v[60:61] op_sel:[0,1,0] op_sel_hi:[1,1,1]
v_pk_fma_f32 v[62:63], v[30:31], v[10:11], v[62:63] op_sel:[0,1,0] op_sel_hi:[1,1,1]
v_cvt_pk_bf16_f32 v52, v52, v53
v_cvt_pk_bf16_f32 v53, v54, v55
v_cvt_pk_bf16_f32 v54, v60, v61
v_cvt_pk_bf16_f32 v55, v62, v63
buffer_store_dwordx4 v[52:55], v14, s[20:23], s71 offen offset:2304 sc1
ds_write_b128 v14, v[52:55] offset:2304
s_waitcnt lgkmcnt(8)
v_pk_mul_f32 v[64:65], v[64:65], v[152:153]
v_pk_mul_f32 v[66:67], v[66:67], v[154:155]
s_waitcnt lgkmcnt(7)
v_pk_fma_f32 v[64:65], v[36:37], v[10:11], v[64:65] op_sel:[0,0,0] op_sel_hi:[1,0,1]
v_pk_fma_f32 v[66:67], v[38:39], v[10:11], v[66:67] op_sel:[0,0,0] op_sel_hi:[1,0,1]
s_waitcnt lgkmcnt(5)
v_pk_mul_f32 v[72:73], v[72:73], v[156:157]
v_pk_mul_f32 v[74:75], v[74:75], v[158:159]
s_waitcnt lgkmcnt(4)
v_pk_fma_f32 v[72:73], v[44:45], v[10:11], v[72:73] op_sel:[0,0,0] op_sel_hi:[1,0,1]
v_pk_fma_f32 v[74:75], v[46:47], v[10:11], v[74:75] op_sel:[0,0,0] op_sel_hi:[1,0,1]
v_cvt_pk_bf16_f32 v64, v64, v65
v_cvt_pk_bf16_f32 v65, v66, v67
v_cvt_pk_bf16_f32 v66, v72, v73
v_cvt_pk_bf16_f32 v67, v74, v75
buffer_store_dwordx4 v[64:67], v15, s[20:23], s71 offen offset:2048 sc1
ds_write_b128 v15, v[64:67] offset:2048
v_pk_mul_f32 v[68:69], v[68:69], v[152:153]
v_pk_mul_f32 v[70:71], v[70:71], v[154:155]
v_pk_fma_f32 v[68:69], v[36:37], v[10:11], v[68:69] op_sel:[0,1,0] op_sel_hi:[1,1,1]
v_pk_fma_f32 v[70:71], v[38:39], v[10:11], v[70:71] op_sel:[0,1,0] op_sel_hi:[1,1,1]
v_pk_mul_f32 v[76:77], v[76:77], v[156:157]
v_pk_mul_f32 v[78:79], v[78:79], v[158:159]
v_pk_fma_f32 v[76:77], v[44:45], v[10:11], v[76:77] op_sel:[0,1,0] op_sel_hi:[1,1,1]
v_pk_fma_f32 v[78:79], v[46:47], v[10:11], v[78:79] op_sel:[0,1,0] op_sel_hi:[1,1,1]
v_cvt_pk_bf16_f32 v68, v68, v69
v_cvt_pk_bf16_f32 v69, v70, v71
v_cvt_pk_bf16_f32 v70, v76, v77
v_cvt_pk_bf16_f32 v71, v78, v79
buffer_store_dwordx4 v[68:71], v15, s[20:23], s71 offen offset:2304 sc1
ds_write_b128 v15, v[68:71] offset:2304
v_add_u32 v5, s34, 17
s_mov_b64 exec, 1
ds_write_b32 v3, v5
s_mov_b64 exec, -1
s_mov_b32 s66, 0x3e8293ee
v_mfma_f32_16x16x32_bf16 v[96:99], v[176:179], v[128:131], v[96:99]
v_mul_f32 v192, s66, v192
v_mfma_f32_16x16x32_bf16 v[96:99], v[180:183], v[132:135], v[96:99]
v_mfma_f32_16x16x32_bf16 v[100:103], v[184:187], v[128:131], v[100:103]
v_mul_f32 v193, s66, v193
v_mfma_f32_16x16x32_bf16 v[100:103], v[188:191], v[132:135], v[100:103]
v_mfma_f32_16x16x32_bf16 v[104:107], v[176:179], v[136:139], v[104:107]
v_mul_f32 v194, s66, v194
v_mfma_f32_16x16x32_bf16 v[104:107], v[180:183], v[140:143], v[104:107]
v_mfma_f32_16x16x32_bf16 v[108:111], v[184:187], v[136:139], v[108:111]
v_mul_f32 v195, s66, v195
v_mfma_f32_16x16x32_bf16 v[108:111], v[188:191], v[140:143], v[108:111]
v_mfma_f32_16x16x32_bf16 v[80:83], v[176:179], v[112:115], v[80:83]
v_mul_f32 v196, s66, v196
v_mfma_f32_16x16x32_bf16 v[80:83], v[180:183], v[116:119], v[80:83]
v_mfma_f32_16x16x32_bf16 v[84:87], v[184:187], v[112:115], v[84:87]
v_mul_f32 v197, s66, v197
v_mfma_f32_16x16x32_bf16 v[84:87], v[188:191], v[116:119], v[84:87]
v_mfma_f32_16x16x32_bf16 v[88:91], v[176:179], v[120:123], v[88:91]
v_mul_f32 v198, s66, v198
v_mfma_f32_16x16x32_bf16 v[88:91], v[180:183], v[124:127], v[88:91]
v_mfma_f32_16x16x32_bf16 v[92:95], v[184:187], v[120:123], v[92:95]
v_mul_f32 v199, s66, v199
v_mfma_f32_16x16x32_bf16 v[92:95], v[188:191], v[124:127], v[92:95]
s_cmp_ge_i32 s73, 0
s_cbranch_scc1 patch_140
pback_141:
v_mov_b32 v200, 0
v_mov_b32 v201, 0
v_mov_b32 v202, 0
v_mov_b32 v203, 0
v_mov_b32 v204, 0
v_mov_b32 v205, 0
v_mov_b32 v206, 0
v_mov_b32 v207, 0
v_mov_b32 v208, 0
v_mov_b32 v209, 0
v_mov_b32 v210, 0
v_mov_b32 v211, 0
v_pk_mul_f32 v[96:97], v[96:97], v[196:197] op_sel:[0,0] op_sel_hi:[1,0]
v_pk_mul_f32 v[98:99], v[98:99], v[196:197] op_sel:[0,0] op_sel_hi:[1,0]
v_pk_mul_f32 v[100:101], v[100:101], v[196:197] op_sel:[0,0] op_sel_hi:[1,0]
v_pk_mul_f32 v[102:103], v[102:103], v[196:197] op_sel:[0,0] op_sel_hi:[1,0]
s_waitcnt lgkmcnt(6)
v_pk_fma_f32 v[96:97], v[160:161], v[196:197], v[96:97] op_sel:[0,1,0] op_sel_hi:[1,1,1]
v_pk_fma_f32 v[98:99], v[162:163], v[196:197], v[98:99] op_sel:[0,1,0] op_sel_hi:[1,1,1]
s_waitcnt lgkmcnt(5)
v_pk_fma_f32 v[100:101], v[164:165], v[196:197], v[100:101] op_sel:[0,1,0] op_sel_hi:[1,1,1]
v_pk_fma_f32 v[102:103], v[166:167], v[196:197], v[102:103] op_sel:[0,1,0] op_sel_hi:[1,1,1]
v_cvt_pk_bf16_f32 v96, v96, v97
v_cvt_pk_bf16_f32 v97, v98, v99
v_cvt_pk_bf16_f32 v98, v100, v101
v_cvt_pk_bf16_f32 v99, v102, v103
v_pk_mul_f32 v[104:105], v[104:105], v[198:199] op_sel:[0,0] op_sel_hi:[1,0]
v_pk_mul_f32 v[106:107], v[106:107], v[198:199] op_sel:[0,0] op_sel_hi:[1,0]
v_pk_mul_f32 v[108:109], v[108:109], v[198:199] op_sel:[0,0] op_sel_hi:[1,0]
v_pk_mul_f32 v[110:111], v[110:111], v[198:199] op_sel:[0,0] op_sel_hi:[1,0]
v_pk_fma_f32 v[104:105], v[160:161], v[198:199], v[104:105] op_sel:[0,1,0] op_sel_hi:[1,1,1]
v_pk_fma_f32 v[106:107], v[162:163], v[198:199], v[106:107] op_sel:[0,1,0] op_sel_hi:[1,1,1]
v_pk_fma_f32 v[108:109], v[164:165], v[198:199], v[108:109] op_sel:[0,1,0] op_sel_hi:[1,1,1]
v_pk_fma_f32 v[110:111], v[166:167], v[198:199], v[110:111] op_sel:[0,1,0] op_sel_hi:[1,1,1]
v_cvt_pk_bf16_f32 v104, v104, v105
v_cvt_pk_bf16_f32 v105, v106, v107
v_cvt_pk_bf16_f32 v106, v108, v109
v_cvt_pk_bf16_f32 v107, v110, v111
v_pk_mul_f32 v[80:81], v[80:81], v[192:193] op_sel:[0,0] op_sel_hi:[1,0]
v_pk_mul_f32 v[82:83], v[82:83], v[192:193] op_sel:[0,0] op_sel_hi:[1,0]
v_pk_mul_f32 v[84:85], v[84:85], v[192:193] op_sel:[0,0] op_sel_hi:[1,0]
v_pk_mul_f32 v[86:87], v[86:87], v[192:193] op_sel:[0,0] op_sel_hi:[1,0]
v_pk_fma_f32 v[80:81], v[160:161], v[192:193], v[80:81] op_sel:[0,1,0] op_sel_hi:[1,1,1]
v_pk_fma_f32 v[82:83], v[162:163], v[192:193], v[82:83] op_sel:[0,1,0] op_sel_hi:[1,1,1]
v_pk_fma_f32 v[84:85], v[164:165], v[192:193], v[84:85] op_sel:[0,1,0] op_sel_hi:[1,1,1]
v_pk_fma_f32 v[86:87], v[166:167], v[192:193], v[86:87] op_sel:[0,1,0] op_sel_hi:[1,1,1]
v_cvt_pk_bf16_f32 v80, v80, v81
v_cvt_pk_bf16_f32 v81, v82, v83
v_cvt_pk_bf16_f32 v82, v84, v85
v_cvt_pk_bf16_f32 v83, v86, v87
v_pk_mul_f32 v[88:89], v[88:89], v[194:195] op_sel:[0,0] op_sel_hi:[1,0]
v_pk_mul_f32 v[90:91], v[90:91], v[194:195] op_sel:[0,0] op_sel_hi:[1,0]
v_pk_mul_f32 v[92:93], v[92:93], v[194:195] op_sel:[0,0] op_sel_hi:[1,0]
v_pk_mul_f32 v[94:95], v[94:95], v[194:195] op_sel:[0,0] op_sel_hi:[1,0]
v_pk_fma_f32 v[88:89], v[160:161], v[194:195], v[88:89] op_sel:[0,1,0] op_sel_hi:[1,1,1]
v_pk_fma_f32 v[90:91], v[162:163], v[194:195], v[90:91] op_sel:[0,1,0] op_sel_hi:[1,1,1]
v_pk_fma_f32 v[92:93], v[164:165], v[194:195], v[92:93] op_sel:[0,1,0] op_sel_hi:[1,1,1]
v_pk_fma_f32 v[94:95], v[166:167], v[194:195], v[94:95] op_sel:[0,1,0] op_sel_hi:[1,1,1]
v_cvt_pk_bf16_f32 v88, v88, v89
v_cvt_pk_bf16_f32 v89, v90, v91
v_cvt_pk_bf16_f32 v90, v92, v93
v_cvt_pk_bf16_f32 v91, v94, v95
v_permlane16_swap_b32 v96, v104
v_permlane16_swap_b32 v97, v105
v_permlane16_swap_b32 v98, v106
v_permlane16_swap_b32 v99, v107
v_permlane16_swap_b32 v80, v88
v_permlane16_swap_b32 v81, v89
v_permlane16_swap_b32 v82, v90
v_permlane16_swap_b32 v83, v91
v_mov_b32 v192, 0
v_mov_b32 v193, 0
v_mov_b32 v194, 0
v_mov_b32 v195, 0
v_mov_b32 v196, 0
v_mov_b32 v197, 0
v_mov_b32 v198, 0
v_mov_b32 v199, 0
s_lshl_b32 s69, s64, 12
v_lshl_add_u32 v6, v0, 4, s69
v_add_u32 v7, 131072, v6
s_lshl_b32 s69, s65, 13
s_add_u32 s66, s69, 131072
s_sub_u32 s69, 147456, s69
v_add_u32 v8, s69, v6
ds_read_b128 v[152:155], v8 offset:8192
ds_read_b128 v[156:159], v8 offset:9216
s_mov_b32 s67, 122880
s_min_u32 s69, s59, 1
s_lshl2_add_u32 s68, s69, s65
s_cmp_ge_u32 s59, 2
s_cselect_b32 s69, s65, 0
s_add_u32 s68, s68, s69
ds_read_b128 v[160:163], v8 offset:10240
ds_read_b128 v[164:167], v8 offset:11264
s_waitcnt lgkmcnt(3)
v_mfma_f32_32x32x16_bf16 v[112:127], v[152:155], v[96:99], v[216:231]
s_waitcnt lgkmcnt(2)
v_mfma_f32_32x32x16_bf16 v[112:127], v[156:159], v[104:107], v[112:127]
s_add_u32 s35, s34, 17
lw_142:
ds_read_b32 v5, v1 offset:0
s_waitcnt lgkmcnt(0)
v_cmp_gt_i32 vcc, s35, v5
s_cbranch_vccz lwd_143
s_sub_u32 s32, s32, 1
s_cmp_gt_i32 s32, 0
s_cbranch_scc1 lw_142
lwd_143:
ds_read_b128 v[152:155], v8 offset:0
ds_read_b128 v[156:159], v8 offset:1024
s_add_u32 s70, s72, 270336
s_mov_b64 exec, 1
s_waitcnt vmcnt(0)
buffer_store_dword v7, v3, s[24:27], s70 offen sc1
s_mov_b64 exec, -1
.p2align 3
v_exp_f32 v112, v112
v_exp_f32 v113, v113
v_exp_f32 v114, v114
v_exp_f32 v115, v115
v_exp_f32 v116, v116
v_exp_f32 v117, v117
s_waitcnt lgkmcnt(1)
v_mfma_f32_32x32x16_bf16 v[128:143], v[152:155], v[96:99], 0
v_exp_f32 v118, v118
v_exp_f32 v119, v119
v_cvt_pk_bf16_f32 v144, v112, v113
v_cvt_pk_bf16_f32 v145, v114, v115
s_waitcnt lgkmcnt(0)
v_mfma_f32_32x32x16_bf16 v[128:143], v[156:159], v[104:107], v[128:143]
ds_read_b128 v[152:155], v7 offset:8192
ds_read_b128 v[156:159], v7 offset:9216
v_cvt_pk_bf16_f32 v146, v116, v117
v_cvt_pk_bf16_f32 v147, v118, v119
v_exp_f32 v120, v120
v_exp_f32 v121, v121
v_mfma_f32_32x32x16_bf16 v[16:31], v[160:163], v[144:147], 0
ds_read_b128 v[160:163], v8 offset:2048
v_exp_f32 v122, v122
v_exp_f32 v123, v123
v_exp_f32 v124, v124
v_mfma_f32_16x16x32_bf16 v[32:35], v[212:215], v[144:147], 0
s_cmp_eq_u32 s65, 1
v_exp_f32 v125, v125
v_exp_f32 v126, v126
v_exp_f32 v127, v127
v_cvt_pk_bf16_f32 v148, v120, v121
v_cvt_pk_bf16_f32 v149, v122, v123
v_cvt_pk_bf16_f32 v150, v124, v125
v_cvt_pk_bf16_f32 v151, v126, v127
s_cbranch_scc1 at_144
v_exp_f32 v128, v128
v_exp_f32 v129, v129
v_mfma_f32_32x32x16_bf16 v[16:31], v[164:167], v[148:151], v[16:31]
ds_read_b128 v[164:167], v8 offset:3072
v_exp_f32 v130, v130
v_exp_f32 v131, v131
v_exp_f32 v132, v132
v_mfma_f32_16x16x32_bf16 v[32:35], v[212:215], v[148:151], v[32:35]
v_exp_f32 v133, v133
s_waitcnt lgkmcnt(3)
v_mfma_f32_32x32x16_bf16 v[112:127], v[152:155], v[96:99], 0
v_exp_f32 v134, v134
v_exp_f32 v135, v135
v_cvt_pk_bf16_f32 v144, v128, v129
v_cvt_pk_bf16_f32 v145, v130, v131
s_waitcnt lgkmcnt(2)
v_mfma_f32_32x32x16_bf16 v[112:127], v[156:159], v[104:107], v[112:127]
ds_read_b128 v[152:155], v7 offset:0
ds_read_b128 v[156:159], v7 offset:1024
v_cvt_pk_bf16_f32 v146, v132, v133
v_cvt_pk_bf16_f32 v147, v134, v135
v_exp_f32 v136, v136
v_exp_f32 v137, v137
s_waitcnt lgkmcnt(3)
v_mfma_f32_32x32x16_bf16 v[16:31], v[160:163], v[144:147], v[16:31]
ds_read_b128 v[160:163], v7 offset:10240
v_exp_f32 v138, v138
v_exp_f32 v139, v139
v_exp_f32 v140, v140
v_mfma_f32_16x16x32_bf16 v[32:35], v[212:215], v[144:147], v[32:35]
v_exp_f32 v141, v141
v_exp_f32 v142, v142
v_exp_f32 v143, v143
v_cvt_pk_bf16_f32 v148, v136, v137
v_cvt_pk_bf16_f32 v149, v138, v139
v_cvt_pk_bf16_f32 v150, v140, v141
v_cvt_pk_bf16_f32 v151, v142, v143
v_exp_f32 v112, v112
v_exp_f32 v113, v113
s_waitcnt lgkmcnt(3)
v_mfma_f32_32x32x16_bf16 v[16:31], v[164:167], v[148:151], v[16:31]
ds_read_b128 v[164:167], v7 offset:11264
v_exp_f32 v114, v114
v_exp_f32 v115, v115
v_exp_f32 v116, v116
v_mfma_f32_16x16x32_bf16 v[32:35], v[212:215], v[148:151], v[32:35]
v_exp_f32 v117, v117
s_waitcnt lgkmcnt(3)
v_mfma_f32_32x32x16_bf16 v[128:143], v[152:155], v[96:99], 0
v_exp_f32 v118, v118
v_exp_f32 v119, v119
v_cvt_pk_bf16_f32 v144, v112, v113
v_cvt_pk_bf16_f32 v145, v114, v115
s_waitcnt lgkmcnt(2)
v_mfma_f32_32x32x16_bf16 v[128:143], v[156:159], v[104:107], v[128:143]
v_cvt_pk_bf16_f32 v146, v116, v117
v_cvt_pk_bf16_f32 v147, v118, v119
v_exp_f32 v120, v120
v_exp_f32 v121, v121
s_waitcnt lgkmcnt(1)
v_mfma_f32_32x32x16_bf16 v[16:31], v[160:163], v[144:147], v[16:31]
ds_read_b128 v[160:163], v7 offset:2048
v_exp_f32 v122, v122
v_exp_f32 v123, v123
v_exp_f32 v124, v124
v_mfma_f32_16x16x32_bf16 v[32:35], v[212:215], v[144:147], v[32:35]
v_mov_b32 v8, v7
v_exp_f32 v125, v125
v_exp_f32 v126, v126
v_exp_f32 v127, v127
v_cvt_pk_bf16_f32 v148, v120, v121
v_cvt_pk_bf16_f32 v149, v122, v123
v_cvt_pk_bf16_f32 v150, v124, v125
v_cvt_pk_bf16_f32 v151, v126, v127
.p2align 3
at_144:
v_exp_f32 v128, v128
v_exp_f32 v129, v129
s_waitcnt lgkmcnt(1)
v_mfma_f32_32x32x16_bf16 v[16:31], v[164:167], v[148:151], v[16:31]
ds_read_b128 v[164:167], v8 offset:3072
v_exp_f32 v130, v130
v_exp_f32 v131, v131
v_exp_f32 v132, v132
v_mfma_f32_16x16x32_bf16 v[32:35], v[212:215], v[148:151], v[32:35]
v_exp_f32 v133, v133
v_mfma_f32_32x32x16_bf16 v[112:127], v[152:155], v[80:83], v[216:231]
v_exp_f32 v134, v134
v_exp_f32 v135, v135
v_cvt_pk_bf16_f32 v144, v128, v129
v_cvt_pk_bf16_f32 v145, v130, v131
v_mfma_f32_32x32x16_bf16 v[112:127], v[156:159], v[88:91], v[112:127]
s_sub_u32 s66, s66, 8192
s_cmp_eq_u32 s66, s67
s_cbranch_scc1 cross_151
cback_152:
v_add_u32 v8, s66, v6
ds_read_b128 v[152:155], v8 offset:0
ds_read_b128 v[156:159], v8 offset:1024
v_cvt_pk_bf16_f32 v146, v132, v133
v_cvt_pk_bf16_f32 v147, v134, v135
v_exp_f32 v136, v136
v_exp_f32 v137, v137
s_waitcnt lgkmcnt(3)
v_mfma_f32_32x32x16_bf16 v[16:31], v[160:163], v[144:147], v[16:31]
v_exp_f32 v138, v138
v_exp_f32 v139, v139
v_exp_f32 v140, v140
v_mfma_f32_16x16x32_bf16 v[32:35], v[212:215], v[144:147], v[32:35]
s_cmp_eq_u32 s68, 0
v_exp_f32 v141, v141
v_exp_f32 v142, v142
v_exp_f32 v143, v143
v_cvt_pk_bf16_f32 v148, v136, v137
v_cvt_pk_bf16_f32 v149, v138, v139
v_cvt_pk_bf16_f32 v150, v140, v141
v_cvt_pk_bf16_f32 v151, v142, v143
s_cbranch_scc1 at_148
.p2align 3
at_145:
v_exp_f32 v112, v112
v_exp_f32 v113, v113
s_waitcnt lgkmcnt(2)
v_mfma_f32_32x32x16_bf16 v[16:31], v[164:167], v[148:151], v[16:31]
v_exp_f32 v114, v114
v_exp_f32 v115, v115
v_exp_f32 v116, v116
v_mfma_f32_16x16x32_bf16 v[32:35], v[212:215], v[148:151], v[32:35]
v_exp_f32 v117, v117
s_waitcnt lgkmcnt(1)
v_mfma_f32_32x32x16_bf16 v[128:143], v[152:155], v[96:99], 0
v_exp_f32 v118, v118
v_exp_f32 v119, v119
v_cvt_pk_bf16_f32 v144, v112, v113
v_cvt_pk_bf16_f32 v145, v114, v115
s_waitcnt lgkmcnt(0)
v_mfma_f32_32x32x16_bf16 v[128:143], v[156:159], v[104:107], v[128:143]
v_cvt_pk_bf16_f32 v146, v116, v117
v_cvt_pk_bf16_f32 v147, v118, v119
v_exp_f32 v120, v120
v_exp_f32 v121, v121
v_mfma_f32_32x32x16_bf16 v[192:207], v[160:163], v[144:147], v[192:207]
ds_read_b128 v[160:163], v8 offset:2048
v_exp_f32 v122, v122
v_exp_f32 v123, v123
v_exp_f32 v124, v124
v_mfma_f32_16x16x32_bf16 v[208:211], v[212:215], v[144:147], v[208:211]
ds_read_b32 v5, v2 offset:16
s_add_u32 s35, s34, 21
v_exp_f32 v125, v125
v_exp_f32 v126, v126
v_exp_f32 v127, v127
v_cvt_pk_bf16_f32 v148, v120, v121
v_cvt_pk_bf16_f32 v149, v122, v123
v_cvt_pk_bf16_f32 v150, v124, v125
v_cvt_pk_bf16_f32 v151, v126, v127
v_exp_f32 v128, v128
v_exp_f32 v129, v129
v_mfma_f32_32x32x16_bf16 v[192:207], v[164:167], v[148:151], v[192:207]
ds_read_b128 v[164:167], v8 offset:3072
v_exp_f32 v130, v130
v_exp_f32 v131, v131
v_exp_f32 v132, v132
v_mfma_f32_16x16x32_bf16 v[208:211], v[212:215], v[148:151], v[208:211]
v_exp_f32 v133, v133
v_mfma_f32_32x32x16_bf16 v[112:127], v[152:155], v[80:83], 0
v_exp_f32 v134, v134
v_exp_f32 v135, v135
v_cvt_pk_bf16_f32 v144, v128, v129
v_cvt_pk_bf16_f32 v145, v130, v131
v_mfma_f32_32x32x16_bf16 v[112:127], v[156:159], v[88:91], v[112:127]
s_sub_u32 s66, s66, 8192
s_cmp_eq_u32 s66, s67
s_cbranch_scc1 cross_153
cback_154:
v_add_u32 v8, s66, v6
ds_read_b128 v[152:155], v8 offset:0
ds_read_b128 v[156:159], v8 offset:1024
v_cvt_pk_bf16_f32 v146, v132, v133
v_cvt_pk_bf16_f32 v147, v134, v135
v_exp_f32 v136, v136
v_exp_f32 v137, v137
s_waitcnt lgkmcnt(4)
v_mfma_f32_32x32x16_bf16 v[16:31], v[160:163], v[144:147], v[16:31]
v_exp_f32 v138, v138
v_exp_f32 v139, v139
v_exp_f32 v140, v140
v_mfma_f32_16x16x32_bf16 v[32:35], v[212:215], v[144:147], v[32:35]
s_sub_u32 s68, s68, 1
s_cmp_eq_u32 s68, 0
v_exp_f32 v141, v141
v_exp_f32 v142, v142
v_exp_f32 v143, v143
v_cvt_pk_bf16_f32 v148, v136, v137
v_cvt_pk_bf16_f32 v149, v138, v139
v_cvt_pk_bf16_f32 v150, v140, v141
v_cvt_pk_bf16_f32 v151, v142, v143
s_cbranch_scc0 at_145
s_cmp_lt_u32 s59, 2
s_cbranch_scc1 at_148
.p2align 3
v_exp_f32 v112, v112
v_exp_f32 v113, v113
s_waitcnt lgkmcnt(2)
v_mfma_f32_32x32x16_bf16 v[16:31], v[164:167], v[148:151], v[16:31]
v_exp_f32 v114, v114
v_exp_f32 v115, v115
v_exp_f32 v116, v116
v_mfma_f32_16x16x32_bf16 v[32:35], v[212:215], v[148:151], v[32:35]
v_exp_f32 v117, v117
s_waitcnt lgkmcnt(1)
v_mfma_f32_32x32x16_bf16 v[128:143], v[152:155], v[96:99], v[216:231]
v_exp_f32 v118, v118
v_exp_f32 v119, v119
v_cvt_pk_bf16_f32 v144, v112, v113
v_cvt_pk_bf16_f32 v145, v114, v115
s_waitcnt lgkmcnt(0)
v_mfma_f32_32x32x16_bf16 v[128:143], v[156:159], v[104:107], v[128:143]
v_cvt_pk_bf16_f32 v146, v116, v117
v_cvt_pk_bf16_f32 v147, v118, v119
v_exp_f32 v120, v120
v_exp_f32 v121, v121
v_mfma_f32_32x32x16_bf16 v[192:207], v[160:163], v[144:147], v[192:207]
ds_read_b128 v[160:163], v8 offset:2048
v_exp_f32 v122, v122
v_exp_f32 v123, v123
v_exp_f32 v124, v124
v_mfma_f32_16x16x32_bf16 v[208:211], v[212:215], v[144:147], v[208:211]
v_exp_f32 v125, v125
v_exp_f32 v126, v126
v_exp_f32 v127, v127
v_cvt_pk_bf16_f32 v148, v120, v121
v_cvt_pk_bf16_f32 v149, v122, v123
v_cvt_pk_bf16_f32 v150, v124, v125
v_cvt_pk_bf16_f32 v151, v126, v127
v_exp_f32 v128, v128
v_exp_f32 v129, v129
v_mfma_f32_32x32x16_bf16 v[192:207], v[164:167], v[148:151], v[192:207]
ds_read_b128 v[164:167], v8 offset:3072
v_exp_f32 v130, v130
v_exp_f32 v131, v131
v_exp_f32 v132, v132
v_mfma_f32_16x16x32_bf16 v[208:211], v[212:215], v[148:151], v[208:211]
v_exp_f32 v133, v133
v_mfma_f32_32x32x16_bf16 v[112:127], v[152:155], v[80:83], 0
v_exp_f32 v134, v134
v_exp_f32 v135, v135
v_cvt_pk_bf16_f32 v144, v128, v129
v_cvt_pk_bf16_f32 v145, v130, v131
v_mfma_f32_32x32x16_bf16 v[112:127], v[156:159], v[88:91], v[112:127]
v_subrev_u32 v8, 8192, v8
ds_read_b128 v[152:155], v8 offset:0
ds_read_b128 v[156:159], v8 offset:1024
v_cvt_pk_bf16_f32 v146, v132, v133
v_cvt_pk_bf16_f32 v147, v134, v135
v_exp_f32 v136, v136
v_exp_f32 v137, v137
s_waitcnt lgkmcnt(3)
v_mfma_f32_32x32x16_bf16 v[16:31], v[160:163], v[144:147], v[16:31]
v_exp_f32 v138, v138
v_exp_f32 v139, v139
v_exp_f32 v140, v140
v_mfma_f32_16x16x32_bf16 v[32:35], v[212:215], v[144:147], v[32:35]
s_cmp_eq_u32 s65, 1
v_exp_f32 v141, v141
v_exp_f32 v142, v142
v_exp_f32 v143, v143
v_cvt_pk_bf16_f32 v148, v136, v137
v_cvt_pk_bf16_f32 v149, v138, v139
v_cvt_pk_bf16_f32 v150, v140, v141
v_cvt_pk_bf16_f32 v151, v142, v143
s_cbranch_scc1 at_147
.p2align 3
v_exp_f32 v112, v112
v_exp_f32 v113, v113
s_waitcnt lgkmcnt(2)
v_mfma_f32_32x32x16_bf16 v[16:31], v[164:167], v[148:151], v[16:31]
v_exp_f32 v114, v114
v_exp_f32 v115, v115
v_exp_f32 v116, v116
v_mfma_f32_16x16x32_bf16 v[32:35], v[212:215], v[148:151], v[32:35]
v_exp_f32 v117, v117
s_waitcnt lgkmcnt(1)
v_mfma_f32_32x32x16_bf16 v[128:143], v[152:155], v[80:83], 0
v_exp_f32 v118, v118
v_exp_f32 v119, v119
v_cvt_pk_bf16_f32 v144, v112, v113
v_cvt_pk_bf16_f32 v145, v114, v115
s_waitcnt lgkmcnt(0)
v_mfma_f32_32x32x16_bf16 v[128:143], v[156:159], v[88:91], v[128:143]
v_subrev_u32 v8, 8192, v8
ds_read_b128 v[152:155], v8 offset:0
ds_read_b128 v[156:159], v8 offset:1024
v_cvt_pk_bf16_f32 v146, v116, v117
v_cvt_pk_bf16_f32 v147, v118, v119
v_exp_f32 v120, v120
v_exp_f32 v121, v121
v_mfma_f32_32x32x16_bf16 v[192:207], v[160:163], v[144:147], v[192:207]
ds_read_b128 v[160:163], v8 offset:10240
v_exp_f32 v122, v122
v_exp_f32 v123, v123
v_exp_f32 v124, v124
v_mfma_f32_16x16x32_bf16 v[208:211], v[212:215], v[144:147], v[208:211]
v_exp_f32 v125, v125
v_exp_f32 v126, v126
v_exp_f32 v127, v127
v_cvt_pk_bf16_f32 v148, v120, v121
v_cvt_pk_bf16_f32 v149, v122, v123
v_cvt_pk_bf16_f32 v150, v124, v125
v_cvt_pk_bf16_f32 v151, v126, v127
v_exp_f32 v128, v128
v_exp_f32 v129, v129
v_mfma_f32_32x32x16_bf16 v[192:207], v[164:167], v[148:151], v[192:207]
ds_read_b128 v[164:167], v8 offset:11264
v_exp_f32 v130, v130
v_exp_f32 v131, v131
v_exp_f32 v132, v132
v_mfma_f32_16x16x32_bf16 v[208:211], v[212:215], v[148:151], v[208:211]
v_exp_f32 v133, v133
s_waitcnt lgkmcnt(3)
v_mfma_f32_32x32x16_bf16 v[112:127], v[152:155], v[80:83], 0
v_exp_f32 v134, v134
v_exp_f32 v135, v135
v_cvt_pk_bf16_f32 v144, v128, v129
v_cvt_pk_bf16_f32 v145, v130, v131
s_waitcnt lgkmcnt(2)
v_mfma_f32_32x32x16_bf16 v[112:127], v[156:159], v[88:91], v[112:127]
v_subrev_u32 v8, 8192, v8
ds_read_b128 v[152:155], v8 offset:0
ds_read_b128 v[156:159], v8 offset:1024
v_cvt_pk_bf16_f32 v146, v132, v133
v_cvt_pk_bf16_f32 v147, v134, v135
v_exp_f32 v136, v136
v_exp_f32 v137, v137
s_waitcnt lgkmcnt(3)
v_mfma_f32_32x32x16_bf16 v[192:207], v[160:163], v[144:147], v[192:207]
ds_read_b128 v[160:163], v8 offset:10240
v_exp_f32 v138, v138
v_exp_f32 v139, v139
v_exp_f32 v140, v140
v_mfma_f32_16x16x32_bf16 v[208:211], v[212:215], v[144:147], v[208:211]
v_exp_f32 v141, v141
v_exp_f32 v142, v142
v_exp_f32 v143, v143
v_cvt_pk_bf16_f32 v148, v136, v137
v_cvt_pk_bf16_f32 v149, v138, v139
v_cvt_pk_bf16_f32 v150, v140, v141
v_cvt_pk_bf16_f32 v151, v142, v143
v_exp_f32 v112, v112
v_exp_f32 v113, v113
s_waitcnt lgkmcnt(3)
v_mfma_f32_32x32x16_bf16 v[192:207], v[164:167], v[148:151], v[192:207]
ds_read_b128 v[164:167], v8 offset:11264
v_exp_f32 v114, v114
v_exp_f32 v115, v115
v_exp_f32 v116, v116
v_mfma_f32_16x16x32_bf16 v[208:211], v[212:215], v[148:151], v[208:211]
v_exp_f32 v117, v117
s_waitcnt lgkmcnt(3)
v_mfma_f32_32x32x16_bf16 v[128:143], v[152:155], v[80:83], v[216:231]
v_exp_f32 v118, v118
v_exp_f32 v119, v119
v_cvt_pk_bf16_f32 v144, v112, v113
v_cvt_pk_bf16_f32 v145, v114, v115
s_waitcnt lgkmcnt(2)
v_mfma_f32_32x32x16_bf16 v[128:143], v[156:159], v[88:91], v[128:143]
v_cvt_pk_bf16_f32 v146, v116, v117
v_cvt_pk_bf16_f32 v147, v118, v119
v_exp_f32 v120, v120
v_exp_f32 v121, v121
s_waitcnt lgkmcnt(1)
v_mfma_f32_32x32x16_bf16 v[192:207], v[160:163], v[144:147], v[192:207]
ds_read_b128 v[160:163], v8 offset:2048
v_exp_f32 v122, v122
v_exp_f32 v123, v123
v_exp_f32 v124, v124
v_mfma_f32_16x16x32_bf16 v[208:211], v[212:215], v[144:147], v[208:211]
v_exp_f32 v125, v125
v_exp_f32 v126, v126
v_exp_f32 v127, v127
v_cvt_pk_bf16_f32 v148, v120, v121
v_cvt_pk_bf16_f32 v149, v122, v123
v_cvt_pk_bf16_f32 v150, v124, v125
v_cvt_pk_bf16_f32 v151, v126, v127
s_branch at_149
.p2align 3
at_148:
s_waitcnt lgkmcnt(3)
v_add_u32 v5, s34, 20
s_mov_b64 exec, 1
ds_write_b32 v3, v5
s_mov_b64 exec, -1
v_exp_f32 v112, v112
v_exp_f32 v113, v113
s_waitcnt lgkmcnt(3)
v_mfma_f32_32x32x16_bf16 v[16:31], v[164:167], v[148:151], v[16:31]
v_exp_f32 v114, v114
v_exp_f32 v115, v115
v_exp_f32 v116, v116
v_mfma_f32_16x16x32_bf16 v[32:35], v[212:215], v[148:151], v[32:35]
v_exp_f32 v117, v117
v_exp_f32 v118, v118
v_exp_f32 v119, v119
v_cvt_pk_bf16_f32 v144, v112, v113
v_cvt_pk_bf16_f32 v145, v114, v115
v_cvt_pk_bf16_f32 v146, v116, v117
v_cvt_pk_bf16_f32 v147, v118, v119
v_exp_f32 v120, v120
v_exp_f32 v121, v121
v_mfma_f32_32x32x16_bf16 v[192:207], v[160:163], v[144:147], v[192:207]
v_exp_f32 v122, v122
v_exp_f32 v123, v123
v_exp_f32 v124, v124
v_mfma_f32_16x16x32_bf16 v[208:211], v[212:215], v[144:147], v[208:211]
v_exp_f32 v125, v125
v_exp_f32 v126, v126
v_exp_f32 v127, v127
v_cvt_pk_bf16_f32 v148, v120, v121
v_cvt_pk_bf16_f32 v149, v122, v123
v_cvt_pk_bf16_f32 v150, v124, v125
v_cvt_pk_bf16_f32 v151, v126, v127
s_branch at_150
.p2align 3
at_147:
v_exp_f32 v112, v112
v_exp_f32 v113, v113
s_waitcnt lgkmcnt(2)
v_mfma_f32_32x32x16_bf16 v[16:31], v[164:167], v[148:151], v[16:31]
v_exp_f32 v114, v114
v_exp_f32 v115, v115
v_exp_f32 v116, v116
v_mfma_f32_16x16x32_bf16 v[32:35], v[212:215], v[148:151], v[32:35]
v_exp_f32 v117, v117
s_waitcnt lgkmcnt(1)
v_mfma_f32_32x32x16_bf16 v[128:143], v[152:155], v[80:83], v[216:231]
v_exp_f32 v118, v118
v_exp_f32 v119, v119
v_cvt_pk_bf16_f32 v144, v112, v113
v_cvt_pk_bf16_f32 v145, v114, v115
s_waitcnt lgkmcnt(0)
v_mfma_f32_32x32x16_bf16 v[128:143], v[156:159], v[88:91], v[128:143]
v_cvt_pk_bf16_f32 v146, v116, v117
v_cvt_pk_bf16_f32 v147, v118, v119
v_exp_f32 v120, v120
v_exp_f32 v121, v121
v_mfma_f32_32x32x16_bf16 v[192:207], v[160:163], v[144:147], v[192:207]
ds_read_b128 v[160:163], v8 offset:2048
v_exp_f32 v122, v122
v_exp_f32 v123, v123
v_exp_f32 v124, v124
v_mfma_f32_16x16x32_bf16 v[208:211], v[212:215], v[144:147], v[208:211]
v_exp_f32 v125, v125
v_exp_f32 v126, v126
v_exp_f32 v127, v127
v_cvt_pk_bf16_f32 v148, v120, v121
v_cvt_pk_bf16_f32 v149, v122, v123
v_cvt_pk_bf16_f32 v150, v124, v125
v_cvt_pk_bf16_f32 v151, v126, v127
.p2align 3
at_149:
v_exp_f32 v128, v128
v_exp_f32 v129, v129
s_waitcnt lgkmcnt(1)
v_mfma_f32_32x32x16_bf16 v[192:207], v[164:167], v[148:151], v[192:207]
ds_read_b128 v[164:167], v8 offset:3072
v_exp_f32 v130, v130
v_exp_f32 v131, v131
v_exp_f32 v132, v132
v_mfma_f32_16x16x32_bf16 v[208:211], v[212:215], v[148:151], v[208:211]
v_exp_f32 v133, v133
v_exp_f32 v134, v134
v_exp_f32 v135, v135
v_cvt_pk_bf16_f32 v144, v128, v129
v_cvt_pk_bf16_f32 v145, v130, v131
v_add_u32 v5, s34, 20
s_mov_b64 exec, 1
ds_write_b32 v3, v5
s_mov_b64 exec, -1
v_cvt_pk_bf16_f32 v146, v132, v133
v_cvt_pk_bf16_f32 v147, v134, v135
v_exp_f32 v136, v136
v_exp_f32 v137, v137
s_waitcnt lgkmcnt(2)
v_mfma_f32_32x32x16_bf16 v[192:207], v[160:163], v[144:147], v[192:207]
v_exp_f32 v138, v138
v_exp_f32 v139, v139
v_exp_f32 v140, v140
v_mfma_f32_16x16x32_bf16 v[208:211], v[212:215], v[144:147], v[208:211]
v_exp_f32 v141, v141
v_exp_f32 v142, v142
v_exp_f32 v143, v143
v_cvt_pk_bf16_f32 v148, v136, v137
v_cvt_pk_bf16_f32 v149, v138, v139
v_cvt_pk_bf16_f32 v150, v140, v141
v_cvt_pk_bf16_f32 v151, v142, v143
at_150:
s_lshl_b32 s66, s59, 18
s_lshl_b32 s67, s63, 22
v_mfma_f32_16x16x32_bf16 v[208:211], v[212:215], v[148:151], v[208:211]
s_add_u32 s66, s66, s67
s_lshl1_add_u32 s67, s60, s64
s_waitcnt lgkmcnt(1)
v_mfma_f32_32x32x16_bf16 v[192:207], v[164:167], v[148:151], v[192:207]
s_lshl_b32 s67, s67, 11
s_add_u32 s66, s66, s67
s_lshl_b32 s68, s65, 16
s_add_u32 s67, s66, 18022400
s_sub_u32 s67, s67, s68
s_add_u32 s66, s66, s68
s_add_u32 s66, s66, 17825792
v_lshlrev_b32 v9, 4, v0
v_subrev_u32 v10, 0x2f800000, v32
v_subrev_u32 v11, 0x2f800000, v208
v_max_u32 v10, v10, v11
v_cmp_lt_u32 vcc, 0x20000000, v10
s_cbranch_vccnz slow_155
sback_156:
s_nop 1
v_rcp_f32 v12, v32
s_nop 1
v_pk_mul_f32 v[16:17], v[16:17], v[12:13] op_sel:[0,0] op_sel_hi:[1,0]
v_pk_mul_f32 v[18:19], v[18:19], v[12:13] op_sel:[0,0] op_sel_hi:[1,0]
v_pk_mul_f32 v[20:21], v[20:21], v[12:13] op_sel:[0,0] op_sel_hi:[1,0]
v_pk_mul_f32 v[22:23], v[22:23], v[12:13] op_sel:[0,0] op_sel_hi:[1,0]
v_pk_mul_f32 v[24:25], v[24:25], v[12:13] op_sel:[0,0] op_sel_hi:[1,0]
v_pk_mul_f32 v[26:27], v[26:27], v[12:13] op_sel:[0,0] op_sel_hi:[1,0]
v_pk_mul_f32 v[28:29], v[28:29], v[12:13] op_sel:[0,0] op_sel_hi:[1,0]
v_pk_mul_f32 v[30:31], v[30:31], v[12:13] op_sel:[0,0] op_sel_hi:[1,0]
v_cvt_pk_bf16_f32 v16, v16, v17
v_cvt_pk_bf16_f32 v17, v18, v19
v_cvt_pk_bf16_f32 v18, v20, v21
v_cvt_pk_bf16_f32 v19, v22, v23
v_cvt_pk_bf16_f32 v20, v24, v25
v_cvt_pk_bf16_f32 v21, v26, v27
v_cvt_pk_bf16_f32 v22, v28, v29
v_cvt_pk_bf16_f32 v23, v30, v31
s_cmp_eq_u32 s57, 0
s_cbranch_scc1 far_157
buffer_store_dwordx4 v[16:19], v9, s[20:23], s67 offen offset:0
buffer_store_dwordx4 v[20:23], v9, s[20:23], s67 offen offset:1024
near_158:
v_rcp_f32 v12, v208
s_nop 0
v_pk_mul_f32 v[192:193], v[192:193], v[12:13] op_sel:[0,0] op_sel_hi:[1,0]
v_pk_mul_f32 v[194:195], v[194:195], v[12:13] op_sel:[0,0] op_sel_hi:[1,0]
v_pk_mul_f32 v[196:197], v[196:197], v[12:13] op_sel:[0,0] op_sel_hi:[1,0]
v_pk_mul_f32 v[198:199], v[198:199], v[12:13] op_sel:[0,0] op_sel_hi:[1,0]
v_pk_mul_f32 v[200:201], v[200:201], v[12:13] op_sel:[0,0] op_sel_hi:[1,0]
v_pk_mul_f32 v[202:203], v[202:203], v[12:13] op_sel:[0,0] op_sel_hi:[1,0]
v_pk_mul_f32 v[204:205], v[204:205], v[12:13] op_sel:[0,0] op_sel_hi:[1,0]
v_pk_mul_f32 v[206:207], v[206:207], v[12:13] op_sel:[0,0] op_sel_hi:[1,0]
v_cvt_pk_bf16_f32 v192, v192, v193
v_cvt_pk_bf16_f32 v193, v194, v195
v_cvt_pk_bf16_f32 v194, v196, v197
v_cvt_pk_bf16_f32 v195, v198, v199
v_cvt_pk_bf16_f32 v196, v200, v201
v_cvt_pk_bf16_f32 v197, v202, v203
v_cvt_pk_bf16_f32 v198, v204, v205
v_cvt_pk_bf16_f32 v199, v206, v207
s_cmp_eq_u32 s57, 0
s_cbranch_scc1 far_159
buffer_store_dwordx4 v[192:195], v9, s[20:23], s66 offen offset:0
buffer_store_dwordx4 v[196:199], v9, s[20:23], s66 offen offset:1024
near_160:
v_bfe_u32 v48, v0, 2, 3
v_lshrrev_b32 v49, 5, v0
v_lshl_add_u32 v48, v49, 4, v48
v_lshlrev_b32 v48, 7, v48
v_bfe_u32 v49, v0, 3, 2
v_lshl_add_u32 v48, v49, 5, v48
v_and_b32 v49, 3, v0
v_lshl_add_u32 v48, v49, 3, v48
v_add_u32 v8, 32768, v48
v_xor_b32 v9, 32, v8
v_xor_b32 v10, 64, v8
v_xor_b32 v11, 96, v8
v_add_u32 v12, 0x10000, v8
v_add_u32 v13, 0x10000, v9
v_add_u32 v14, 0x10000, v10
v_add_u32 v15, 0x10000, v11
v_and_b32 v48, 15, v0
v_lshrrev_b32 v49, 4, v0
s_lshl2_add_u32 s66, s61, s58
s_lshl_b32 s67, s66, 16
s_lshl_b32 s68, s63, 22
s_add_u32 s67, s67, s68
s_add_u32 s67, s67, 17825792
v_lshl_add_u32 v6, v48, 4, s67
v_lshl_add_u32 v6, v49, 9, v6
s_add_u32 s70, s72, 268288
s_add_u32 s35, s34, 3
lw_161:
ds_read_b32 v5, v2 offset:24
s_waitcnt lgkmcnt(0)
v_cmp_gt_i32 vcc, s35, v5
s_cbranch_vccz lwd_162
s_sub_u32 s32, s32, 1
s_cmp_gt_i32 s32, 0
s_cbranch_scc1 lw_161
lwd_162:
s_mov_b64 exec, 1
s_waitcnt vmcnt(0)
s_cmp_eq_u32 s57, 0
s_cbranch_scc1 far_163
buffer_store_dword v212, v3, s[24:27], s70 offen
near_164:
s_mov_b64 exec, -1
v_add_u32 v5, s34, 21
s_mov_b64 exec, 1
ds_write_b32 v3, v5
s_mov_b64 exec, -1
s_cmp_eq_u32 s63, 0
s_cbranch_scc0 mo_165
v_permlane16_swap_b32 v240, v242
v_permlane16_swap_b32 v241, v243
v_permlane16_swap_b32 v244, v246
v_permlane16_swap_b32 v245, v247
v_permlane16_swap_b32 v248, v250
v_permlane16_swap_b32 v249, v251
v_permlane16_swap_b32 v252, v254
v_permlane16_swap_b32 v253, v255
mo_166:
v_lshlrev_b32 v16, 16, v240
v_and_b32 v17, 0xffff0000, v240
v_lshlrev_b32 v18, 16, v241
v_and_b32 v19, 0xffff0000, v241
v_lshlrev_b32 v20, 16, v242
v_and_b32 v21, 0xffff0000, v242
v_lshlrev_b32 v22, 16, v243
v_and_b32 v23, 0xffff0000, v243
v_lshlrev_b32 v24, 16, v244
v_and_b32 v25, 0xffff0000, v244
v_lshlrev_b32 v26, 16, v245
v_and_b32 v27, 0xffff0000, v245
v_lshlrev_b32 v28, 16, v246
v_and_b32 v29, 0xffff0000, v246
v_lshlrev_b32 v30, 16, v247
v_and_b32 v31, 0xffff0000, v247
v_lshlrev_b32 v32, 16, v248
v_and_b32 v33, 0xffff0000, v248
v_lshlrev_b32 v34, 16, v249
v_and_b32 v35, 0xffff0000, v249
v_lshlrev_b32 v36, 16, v250
v_and_b32 v37, 0xffff0000, v250
v_lshlrev_b32 v38, 16, v251
v_and_b32 v39, 0xffff0000, v251
v_lshlrev_b32 v40, 16, v252
v_and_b32 v41, 0xffff0000, v252
v_lshlrev_b32 v42, 16, v253
v_and_b32 v43, 0xffff0000, v253
v_lshlrev_b32 v44, 16, v254
v_and_b32 v45, 0xffff0000, v254
v_lshlrev_b32 v46, 16, v255
v_and_b32 v47, 0xffff0000, v255
s_add_u32 s66, s61, s62
s_and_b32 s66, s66, 15
s_lshl_b32 s66, s66, 12
s_add_u32 s35, s34, 22
lw_167:
ds_read_b32 v5, v2 offset:16
s_waitcnt lgkmcnt(0)
v_cmp_gt_i32 vcc, s35, v5
s_cbranch_vccz lwd_168
s_sub_u32 s32, s32, 1
s_cmp_gt_i32 s32, 0
s_cbranch_scc1 lw_167
lwd_168:
buffer_load_dwordx4 v[80:83], v6, s[20:23], s66 offen offset:0 sc1
buffer_load_dwordx4 v[88:91], v6, s[20:23], s66 offen offset:2048 sc1
buffer_load_dwordx4 v[84:87], v6, s[20:23], s66 offen offset:256 sc1
buffer_load_dwordx4 v[92:95], v6, s[20:23], s66 offen offset:2304 sc1
s_add_u32 s66, s66, 4096
s_and_b32 s66, s66, 0xffff
ds_read_b64_tr_b16 v[48:49], v8 offset:0
ds_read_b64_tr_b16 v[50:51], v8 offset:1024
ds_read_b64_tr_b16 v[52:53], v8 offset:4096
ds_read_b64_tr_b16 v[54:55], v8 offset:5120
buffer_load_dwordx4 v[96:99], v6, s[20:23], s66 offen offset:0 sc1
buffer_load_dwordx4 v[104:107], v6, s[20:23], s66 offen offset:2048 sc1
buffer_load_dwordx4 v[100:103], v6, s[20:23], s66 offen offset:256 sc1
buffer_load_dwordx4 v[108:111], v6, s[20:23], s66 offen offset:2304 sc1
s_add_u32 s66, s66, 4096
s_and_b32 s66, s66, 0xffff
ds_read_b64_tr_b16 v[56:57], v9 offset:0
ds_read_b64_tr_b16 v[58:59], v9 offset:1024
ds_read_b64_tr_b16 v[60:61], v9 offset:4096
ds_read_b64_tr_b16 v[62:63], v9 offset:5120
buffer_load_dwordx4 v[112:115], v6, s[20:23], s66 offen offset:0 sc1
buffer_load_dwordx4 v[120:123], v6, s[20:23], s66 offen offset:2048 sc1
buffer_load_dwordx4 v[116:119], v6, s[20:23], s66 offen offset:256 sc1
buffer_load_dwordx4 v[124:127], v6, s[20:23], s66 offen offset:2304 sc1
s_add_u32 s66, s66, 4096
s_and_b32 s66, s66, 0xffff
ds_read_b64_tr_b16 v[64:65], v10 offset:0
ds_read_b64_tr_b16 v[66:67], v10 offset:1024
ds_read_b64_tr_b16 v[68:69], v10 offset:4096
ds_read_b64_tr_b16 v[70:71], v10 offset:5120
buffer_load_dwordx4 v[128:131], v6, s[20:23], s66 offen offset:0 sc1
buffer_load_dwordx4 v[136:139], v6, s[20:23], s66 offen offset:2048 sc1
buffer_load_dwordx4 v[132:135], v6, s[20:23], s66 offen offset:256 sc1
buffer_load_dwordx4 v[140:143], v6, s[20:23], s66 offen offset:2304 sc1
s_add_u32 s66, s66, 4096
s_and_b32 s66, s66, 0xffff
buffer_load_dwordx4 v[144:147], v6, s[20:23], s66 offen offset:0 sc1
buffer_load_dwordx4 v[152:155], v6, s[20:23], s66 offen offset:2048 sc1
buffer_load_dwordx4 v[148:151], v6, s[20:23], s66 offen offset:256 sc1
buffer_load_dwordx4 v[156:159], v6, s[20:23], s66 offen offset:2304 sc1
s_add_u32 s66, s66, 4096
s_and_b32 s66, s66, 0xffff
buffer_load_dwordx4 v[160:163], v6, s[20:23], s66 offen offset:0 sc1
buffer_load_dwordx4 v[168:171], v6, s[20:23], s66 offen offset:2048 sc1
buffer_load_dwordx4 v[164:167], v6, s[20:23], s66 offen offset:256 sc1
buffer_load_dwordx4 v[172:175], v6, s[20:23], s66 offen offset:2304 sc1
s_add_u32 s66, s66, 4096
s_and_b32 s66, s66, 0xffff
buffer_load_dwordx4 v[176:179], v6, s[20:23], s66 offen offset:0 sc1
buffer_load_dwordx4 v[184:187], v6, s[20:23], s66 offen offset:2048 sc1
buffer_load_dwordx4 v[180:183], v6, s[20:23], s66 offen offset:256 sc1
buffer_load_dwordx4 v[188:191], v6, s[20:23], s66 offen offset:2304 sc1
s_add_u32 s66, s66, 4096
s_and_b32 s66, s66, 0xffff
buffer_load_dwordx4 v[192:195], v6, s[20:23], s66 offen offset:0 sc1
buffer_load_dwordx4 v[200:203], v6, s[20:23], s66 offen offset:2048 sc1
buffer_load_dwordx4 v[196:199], v6, s[20:23], s66 offen offset:256 sc1
buffer_load_dwordx4 v[204:207], v6, s[20:23], s66 offen offset:2304 sc1
s_add_u32 s66, s66, 4096
s_and_b32 s66, s66, 0xffff
.p2align 3
s_waitcnt vmcnt(31) lgkmcnt(10)
v_mfma_f32_16x16x32_bf16 v[16:19], v[48:51], v[80:83], v[16:19]
ds_read_b64_tr_b16 v[72:73], v11 offset:0
s_waitcnt vmcnt(30) lgkmcnt(9)
v_mfma_f32_16x16x32_bf16 v[16:19], v[52:55], v[88:91], v[16:19]
ds_read_b64_tr_b16 v[74:75], v11 offset:1024
s_waitcnt vmcnt(29)
v_mfma_f32_16x16x32_bf16 v[32:35], v[48:51], v[84:87], v[32:35]
ds_read_b64_tr_b16 v[76:77], v11 offset:4096
s_waitcnt vmcnt(28)
v_mfma_f32_16x16x32_bf16 v[32:35], v[52:55], v[92:95], v[32:35]
ds_read_b64_tr_b16 v[78:79], v11 offset:5120
s_waitcnt lgkmcnt(10)
v_mfma_f32_16x16x32_bf16 v[20:23], v[56:59], v[80:83], v[20:23]
ds_read_b64_tr_b16 v[48:49], v8 offset:8192
s_waitcnt lgkmcnt(9)
v_mfma_f32_16x16x32_bf16 v[20:23], v[60:63], v[88:91], v[20:23]
ds_read_b64_tr_b16 v[50:51], v8 offset:9216
v_mfma_f32_16x16x32_bf16 v[36:39], v[56:59], v[84:87], v[36:39]
ds_read_b64_tr_b16 v[52:53], v8 offset:12288
v_mfma_f32_16x16x32_bf16 v[36:39], v[60:63], v[92:95], v[36:39]
ds_read_b64_tr_b16 v[54:55], v8 offset:13312
s_waitcnt lgkmcnt(10)
v_mfma_f32_16x16x32_bf16 v[24:27], v[64:67], v[80:83], v[24:27]
ds_read_b64_tr_b16 v[56:57], v9 offset:8192
s_waitcnt lgkmcnt(9)
v_mfma_f32_16x16x32_bf16 v[24:27], v[68:71], v[88:91], v[24:27]
ds_read_b64_tr_b16 v[58:59], v9 offset:9216
v_mfma_f32_16x16x32_bf16 v[40:43], v[64:67], v[84:87], v[40:43]
ds_read_b64_tr_b16 v[60:61], v9 offset:12288
v_mfma_f32_16x16x32_bf16 v[40:43], v[68:71], v[92:95], v[40:43]
ds_read_b64_tr_b16 v[62:63], v9 offset:13312
s_waitcnt lgkmcnt(10)
v_mfma_f32_16x16x32_bf16 v[28:31], v[72:75], v[80:83], v[28:31]
ds_read_b64_tr_b16 v[64:65], v10 offset:8192
s_waitcnt lgkmcnt(9)
v_mfma_f32_16x16x32_bf16 v[28:31], v[76:79], v[88:91], v[28:31]
ds_read_b64_tr_b16 v[66:67], v10 offset:9216
v_mfma_f32_16x16x32_bf16 v[44:47], v[72:75], v[84:87], v[44:47]
ds_read_b64_tr_b16 v[68:69], v10 offset:12288
v_mfma_f32_16x16x32_bf16 v[44:47], v[76:79], v[92:95], v[44:47]
ds_read_b64_tr_b16 v[70:71], v10 offset:13312
s_waitcnt vmcnt(27) lgkmcnt(10)
v_mfma_f32_16x16x32_bf16 v[16:19], v[48:51], v[96:99], v[16:19]
ds_read_b64_tr_b16 v[72:73], v11 offset:8192
buffer_load_dwordx4 v[80:83], v6, s[20:23], s66 offen offset:0 sc1
s_waitcnt vmcnt(27) lgkmcnt(9)
v_mfma_f32_16x16x32_bf16 v[16:19], v[52:55], v[104:107], v[16:19]
ds_read_b64_tr_b16 v[74:75], v11 offset:9216
buffer_load_dwordx4 v[88:91], v6, s[20:23], s66 offen offset:2048 sc1
s_waitcnt vmcnt(27)
v_mfma_f32_16x16x32_bf16 v[32:35], v[48:51], v[100:103], v[32:35]
ds_read_b64_tr_b16 v[76:77], v11 offset:12288
buffer_load_dwordx4 v[84:87], v6, s[20:23], s66 offen offset:256 sc1
s_waitcnt vmcnt(27)
v_mfma_f32_16x16x32_bf16 v[32:35], v[52:55], v[108:111], v[32:35]
ds_read_b64_tr_b16 v[78:79], v11 offset:13312
buffer_load_dwordx4 v[92:95], v6, s[20:23], s66 offen offset:2304 sc1
s_waitcnt lgkmcnt(10)
v_mfma_f32_16x16x32_bf16 v[20:23], v[56:59], v[96:99], v[20:23]
ds_read_b64_tr_b16 v[48:49], v8 offset:16384
s_add_u32 s66, s66, 4096
s_and_b32 s66, s66, 0xffff
s_waitcnt lgkmcnt(9)
v_mfma_f32_16x16x32_bf16 v[20:23], v[60:63], v[104:107], v[20:23]
ds_read_b64_tr_b16 v[50:51], v8 offset:17408
v_mfma_f32_16x16x32_bf16 v[36:39], v[56:59], v[100:103], v[36:39]
ds_read_b64_tr_b16 v[52:53], v8 offset:20480
v_mfma_f32_16x16x32_bf16 v[36:39], v[60:63], v[108:111], v[36:39]
ds_read_b64_tr_b16 v[54:55], v8 offset:21504
s_waitcnt lgkmcnt(10)
v_mfma_f32_16x16x32_bf16 v[24:27], v[64:67], v[96:99], v[24:27]
ds_read_b64_tr_b16 v[56:57], v9 offset:16384
s_waitcnt lgkmcnt(9)
v_mfma_f32_16x16x32_bf16 v[24:27], v[68:71], v[104:107], v[24:27]
ds_read_b64_tr_b16 v[58:59], v9 offset:17408
v_mfma_f32_16x16x32_bf16 v[40:43], v[64:67], v[100:103], v[40:43]
ds_read_b64_tr_b16 v[60:61], v9 offset:20480
v_mfma_f32_16x16x32_bf16 v[40:43], v[68:71], v[108:111], v[40:43]
ds_read_b64_tr_b16 v[62:63], v9 offset:21504
s_waitcnt lgkmcnt(10)
v_mfma_f32_16x16x32_bf16 v[28:31], v[72:75], v[96:99], v[28:31]
ds_read_b64_tr_b16 v[64:65], v10 offset:16384
s_waitcnt lgkmcnt(9)
v_mfma_f32_16x16x32_bf16 v[28:31], v[76:79], v[104:107], v[28:31]
ds_read_b64_tr_b16 v[66:67], v10 offset:17408
v_mfma_f32_16x16x32_bf16 v[44:47], v[72:75], v[100:103], v[44:47]
ds_read_b64_tr_b16 v[68:69], v10 offset:20480
v_mfma_f32_16x16x32_bf16 v[44:47], v[76:79], v[108:111], v[44:47]
ds_read_b64_tr_b16 v[70:71], v10 offset:21504
s_waitcnt vmcnt(27) lgkmcnt(10)
v_mfma_f32_16x16x32_bf16 v[16:19], v[48:51], v[112:115], v[16:19]
ds_read_b64_tr_b16 v[72:73], v11 offset:16384
buffer_load_dwordx4 v[96:99], v6, s[20:23], s66 offen offset:0 sc1
s_waitcnt vmcnt(27) lgkmcnt(9)
v_mfma_f32_16x16x32_bf16 v[16:19], v[52:55], v[120:123], v[16:19]
ds_read_b64_tr_b16 v[74:75], v11 offset:17408
buffer_load_dwordx4 v[104:107], v6, s[20:23], s66 offen offset:2048 sc1
s_waitcnt vmcnt(27)
v_mfma_f32_16x16x32_bf16 v[32:35], v[48:51], v[116:119], v[32:35]
ds_read_b64_tr_b16 v[76:77], v11 offset:20480
buffer_load_dwordx4 v[100:103], v6, s[20:23], s66 offen offset:256 sc1
s_waitcnt vmcnt(27)
v_mfma_f32_16x16x32_bf16 v[32:35], v[52:55], v[124:127], v[32:35]
ds_read_b64_tr_b16 v[78:79], v11 offset:21504
buffer_load_dwordx4 v[108:111], v6, s[20:23], s66 offen offset:2304 sc1
s_waitcnt lgkmcnt(10)
v_mfma_f32_16x16x32_bf16 v[20:23], v[56:59], v[112:115], v[20:23]
ds_read_b64_tr_b16 v[48:49], v8 offset:24576
s_add_u32 s66, s66, 4096
s_and_b32 s66, s66, 0xffff
s_waitcnt lgkmcnt(9)
v_mfma_f32_16x16x32_bf16 v[20:23], v[60:63], v[120:123], v[20:23]
ds_read_b64_tr_b16 v[50:51], v8 offset:25600
v_mfma_f32_16x16x32_bf16 v[36:39], v[56:59], v[116:119], v[36:39]
ds_read_b64_tr_b16 v[52:53], v8 offset:28672
v_mfma_f32_16x16x32_bf16 v[36:39], v[60:63], v[124:127], v[36:39]
ds_read_b64_tr_b16 v[54:55], v8 offset:29696
s_waitcnt lgkmcnt(10)
v_mfma_f32_16x16x32_bf16 v[24:27], v[64:67], v[112:115], v[24:27]
ds_read_b64_tr_b16 v[56:57], v9 offset:24576
s_waitcnt lgkmcnt(9)
v_mfma_f32_16x16x32_bf16 v[24:27], v[68:71], v[120:123], v[24:27]
ds_read_b64_tr_b16 v[58:59], v9 offset:25600
v_mfma_f32_16x16x32_bf16 v[40:43], v[64:67], v[116:119], v[40:43]
ds_read_b64_tr_b16 v[60:61], v9 offset:28672
v_mfma_f32_16x16x32_bf16 v[40:43], v[68:71], v[124:127], v[40:43]
ds_read_b64_tr_b16 v[62:63], v9 offset:29696
s_waitcnt lgkmcnt(10)
v_mfma_f32_16x16x32_bf16 v[28:31], v[72:75], v[112:115], v[28:31]
ds_read_b64_tr_b16 v[64:65], v10 offset:24576
s_waitcnt lgkmcnt(9)
v_mfma_f32_16x16x32_bf16 v[28:31], v[76:79], v[120:123], v[28:31]
ds_read_b64_tr_b16 v[66:67], v10 offset:25600
v_mfma_f32_16x16x32_bf16 v[44:47], v[72:75], v[116:119], v[44:47]
ds_read_b64_tr_b16 v[68:69], v10 offset:28672
v_mfma_f32_16x16x32_bf16 v[44:47], v[76:79], v[124:127], v[44:47]
ds_read_b64_tr_b16 v[70:71], v10 offset:29696
s_waitcnt vmcnt(27) lgkmcnt(10)
v_mfma_f32_16x16x32_bf16 v[16:19], v[48:51], v[128:131], v[16:19]
ds_read_b64_tr_b16 v[72:73], v11 offset:24576
buffer_load_dwordx4 v[112:115], v6, s[20:23], s66 offen offset:0 sc1
s_waitcnt vmcnt(27) lgkmcnt(9)
v_mfma_f32_16x16x32_bf16 v[16:19], v[52:55], v[136:139], v[16:19]
ds_read_b64_tr_b16 v[74:75], v11 offset:25600
buffer_load_dwordx4 v[120:123], v6, s[20:23], s66 offen offset:2048 sc1
s_waitcnt vmcnt(27)
v_mfma_f32_16x16x32_bf16 v[32:35], v[48:51], v[132:135], v[32:35]
ds_read_b64_tr_b16 v[76:77], v11 offset:28672
buffer_load_dwordx4 v[116:119], v6, s[20:23], s66 offen offset:256 sc1
s_waitcnt vmcnt(27)
v_mfma_f32_16x16x32_bf16 v[32:35], v[52:55], v[140:143], v[32:35]
ds_read_b64_tr_b16 v[78:79], v11 offset:29696
buffer_load_dwordx4 v[124:127], v6, s[20:23], s66 offen offset:2304 sc1
s_waitcnt lgkmcnt(10)
v_mfma_f32_16x16x32_bf16 v[20:23], v[56:59], v[128:131], v[20:23]
ds_read_b64_tr_b16 v[48:49], v8 offset:32768
s_add_u32 s66, s66, 4096
s_and_b32 s66, s66, 0xffff
s_waitcnt lgkmcnt(9)
v_mfma_f32_16x16x32_bf16 v[20:23], v[60:63], v[136:139], v[20:23]
ds_read_b64_tr_b16 v[50:51], v8 offset:33792
v_mfma_f32_16x16x32_bf16 v[36:39], v[56:59], v[132:135], v[36:39]
ds_read_b64_tr_b16 v[52:53], v8 offset:36864
v_mfma_f32_16x16x32_bf16 v[36:39], v[60:63], v[140:143], v[36:39]
ds_read_b64_tr_b16 v[54:55], v8 offset:37888
s_waitcnt lgkmcnt(10)
v_mfma_f32_16x16x32_bf16 v[24:27], v[64:67], v[128:131], v[24:27]
ds_read_b64_tr_b16 v[56:57], v9 offset:32768
s_waitcnt lgkmcnt(9)
v_mfma_f32_16x16x32_bf16 v[24:27], v[68:71], v[136:139], v[24:27]
ds_read_b64_tr_b16 v[58:59], v9 offset:33792
v_mfma_f32_16x16x32_bf16 v[40:43], v[64:67], v[132:135], v[40:43]
ds_read_b64_tr_b16 v[60:61], v9 offset:36864
v_mfma_f32_16x16x32_bf16 v[40:43], v[68:71], v[140:143], v[40:43]
ds_read_b64_tr_b16 v[62:63], v9 offset:37888
s_waitcnt lgkmcnt(10)
v_mfma_f32_16x16x32_bf16 v[28:31], v[72:75], v[128:131], v[28:31]
ds_read_b64_tr_b16 v[64:65], v10 offset:32768
s_waitcnt lgkmcnt(9)
v_mfma_f32_16x16x32_bf16 v[28:31], v[76:79], v[136:139], v[28:31]
ds_read_b64_tr_b16 v[66:67], v10 offset:33792
v_mfma_f32_16x16x32_bf16 v[44:47], v[72:75], v[132:135], v[44:47]
ds_read_b64_tr_b16 v[68:69], v10 offset:36864
v_mfma_f32_16x16x32_bf16 v[44:47], v[76:79], v[140:143], v[44:47]
ds_read_b64_tr_b16 v[70:71], v10 offset:37888
s_waitcnt vmcnt(27) lgkmcnt(10)
v_mfma_f32_16x16x32_bf16 v[16:19], v[48:51], v[144:147], v[16:19]
ds_read_b64_tr_b16 v[72:73], v11 offset:32768
buffer_load_dwordx4 v[128:131], v6, s[20:23], s66 offen offset:0 sc1
s_waitcnt vmcnt(27) lgkmcnt(9)
v_mfma_f32_16x16x32_bf16 v[16:19], v[52:55], v[152:155], v[16:19]
ds_read_b64_tr_b16 v[74:75], v11 offset:33792
buffer_load_dwordx4 v[136:139], v6, s[20:23], s66 offen offset:2048 sc1
s_waitcnt vmcnt(27)
v_mfma_f32_16x16x32_bf16 v[32:35], v[48:51], v[148:151], v[32:35]
ds_read_b64_tr_b16 v[76:77], v11 offset:36864
buffer_load_dwordx4 v[132:135], v6, s[20:23], s66 offen offset:256 sc1
s_waitcnt vmcnt(27)
v_mfma_f32_16x16x32_bf16 v[32:35], v[52:55], v[156:159], v[32:35]
ds_read_b64_tr_b16 v[78:79], v11 offset:37888
buffer_load_dwordx4 v[140:143], v6, s[20:23], s66 offen offset:2304 sc1
s_waitcnt lgkmcnt(10)
v_mfma_f32_16x16x32_bf16 v[20:23], v[56:59], v[144:147], v[20:23]
ds_read_b64_tr_b16 v[48:49], v8 offset:40960
s_add_u32 s66, s66, 4096
s_and_b32 s66, s66, 0xffff
s_waitcnt lgkmcnt(9)
v_mfma_f32_16x16x32_bf16 v[20:23], v[60:63], v[152:155], v[20:23]
ds_read_b64_tr_b16 v[50:51], v8 offset:41984
v_mfma_f32_16x16x32_bf16 v[36:39], v[56:59], v[148:151], v[36:39]
ds_read_b64_tr_b16 v[52:53], v8 offset:45056
v_mfma_f32_16x16x32_bf16 v[36:39], v[60:63], v[156:159], v[36:39]
ds_read_b64_tr_b16 v[54:55], v8 offset:46080
s_waitcnt lgkmcnt(10)
v_mfma_f32_16x16x32_bf16 v[24:27], v[64:67], v[144:147], v[24:27]
ds_read_b64_tr_b16 v[56:57], v9 offset:40960
s_waitcnt lgkmcnt(9)
v_mfma_f32_16x16x32_bf16 v[24:27], v[68:71], v[152:155], v[24:27]
ds_read_b64_tr_b16 v[58:59], v9 offset:41984
v_mfma_f32_16x16x32_bf16 v[40:43], v[64:67], v[148:151], v[40:43]
ds_read_b64_tr_b16 v[60:61], v9 offset:45056
v_mfma_f32_16x16x32_bf16 v[40:43], v[68:71], v[156:159], v[40:43]
ds_read_b64_tr_b16 v[62:63], v9 offset:46080
s_waitcnt lgkmcnt(10)
v_mfma_f32_16x16x32_bf16 v[28:31], v[72:75], v[144:147], v[28:31]
ds_read_b64_tr_b16 v[64:65], v10 offset:40960
s_waitcnt lgkmcnt(9)
v_mfma_f32_16x16x32_bf16 v[28:31], v[76:79], v[152:155], v[28:31]
ds_read_b64_tr_b16 v[66:67], v10 offset:41984
v_mfma_f32_16x16x32_bf16 v[44:47], v[72:75], v[148:151], v[44:47]
ds_read_b64_tr_b16 v[68:69], v10 offset:45056
v_mfma_f32_16x16x32_bf16 v[44:47], v[76:79], v[156:159], v[44:47]
ds_read_b64_tr_b16 v[70:71], v10 offset:46080
s_waitcnt vmcnt(27) lgkmcnt(10)
v_mfma_f32_16x16x32_bf16 v[16:19], v[48:51], v[160:163], v[16:19]
ds_read_b64_tr_b16 v[72:73], v11 offset:40960
buffer_load_dwordx4 v[144:147], v6, s[20:23], s66 offen offset:0 sc1
s_waitcnt vmcnt(27) lgkmcnt(9)
v_mfma_f32_16x16x32_bf16 v[16:19], v[52:55], v[168:171], v[16:19]
ds_read_b64_tr_b16 v[74:75], v11 offset:41984
buffer_load_dwordx4 v[152:155], v6, s[20:23], s66 offen offset:2048 sc1
s_waitcnt vmcnt(27)
v_mfma_f32_16x16x32_bf16 v[32:35], v[48:51], v[164:167], v[32:35]
ds_read_b64_tr_b16 v[76:77], v11 offset:45056
buffer_load_dwordx4 v[148:151], v6, s[20:23], s66 offen offset:256 sc1
s_waitcnt vmcnt(27)
v_mfma_f32_16x16x32_bf16 v[32:35], v[52:55], v[172:175], v[32:35]
ds_read_b64_tr_b16 v[78:79], v11 offset:46080
buffer_load_dwordx4 v[156:159], v6, s[20:23], s66 offen offset:2304 sc1
s_waitcnt lgkmcnt(10)
v_mfma_f32_16x16x32_bf16 v[20:23], v[56:59], v[160:163], v[20:23]
ds_read_b64_tr_b16 v[48:49], v8 offset:49152
s_add_u32 s66, s66, 4096
s_and_b32 s66, s66, 0xffff
s_waitcnt lgkmcnt(9)
v_mfma_f32_16x16x32_bf16 v[20:23], v[60:63], v[168:171], v[20:23]
ds_read_b64_tr_b16 v[50:51], v8 offset:50176
v_mfma_f32_16x16x32_bf16 v[36:39], v[56:59], v[164:167], v[36:39]
ds_read_b64_tr_b16 v[52:53], v8 offset:53248
v_mfma_f32_16x16x32_bf16 v[36:39], v[60:63], v[172:175], v[36:39]
ds_read_b64_tr_b16 v[54:55], v8 offset:54272
s_waitcnt lgkmcnt(10)
v_mfma_f32_16x16x32_bf16 v[24:27], v[64:67], v[160:163], v[24:27]
ds_read_b64_tr_b16 v[56:57], v9 offset:49152
s_waitcnt lgkmcnt(9)
v_mfma_f32_16x16x32_bf16 v[24:27], v[68:71], v[168:171], v[24:27]
ds_read_b64_tr_b16 v[58:59], v9 offset:50176
v_mfma_f32_16x16x32_bf16 v[40:43], v[64:67], v[164:167], v[40:43]
ds_read_b64_tr_b16 v[60:61], v9 offset:53248
v_mfma_f32_16x16x32_bf16 v[40:43], v[68:71], v[172:175], v[40:43]
ds_read_b64_tr_b16 v[62:63], v9 offset:54272
s_waitcnt lgkmcnt(10)
v_mfma_f32_16x16x32_bf16 v[28:31], v[72:75], v[160:163], v[28:31]
ds_read_b64_tr_b16 v[64:65], v10 offset:49152
s_waitcnt lgkmcnt(9)
v_mfma_f32_16x16x32_bf16 v[28:31], v[76:79], v[168:171], v[28:31]
ds_read_b64_tr_b16 v[66:67], v10 offset:50176
v_mfma_f32_16x16x32_bf16 v[44:47], v[72:75], v[164:167], v[44:47]
ds_read_b64_tr_b16 v[68:69], v10 offset:53248
v_mfma_f32_16x16x32_bf16 v[44:47], v[76:79], v[172:175], v[44:47]
ds_read_b64_tr_b16 v[70:71], v10 offset:54272
s_waitcnt vmcnt(27) lgkmcnt(10)
v_mfma_f32_16x16x32_bf16 v[16:19], v[48:51], v[176:179], v[16:19]
ds_read_b64_tr_b16 v[72:73], v11 offset:49152
buffer_load_dwordx4 v[160:163], v6, s[20:23], s66 offen offset:0 sc1
s_waitcnt vmcnt(27) lgkmcnt(9)
v_mfma_f32_16x16x32_bf16 v[16:19], v[52:55], v[184:187], v[16:19]
ds_read_b64_tr_b16 v[74:75], v11 offset:50176
buffer_load_dwordx4 v[168:171], v6, s[20:23], s66 offen offset:2048 sc1
s_waitcnt vmcnt(27)
v_mfma_f32_16x16x32_bf16 v[32:35], v[48:51], v[180:183], v[32:35]
ds_read_b64_tr_b16 v[76:77], v11 offset:53248
buffer_load_dwordx4 v[164:167], v6, s[20:23], s66 offen offset:256 sc1
s_waitcnt vmcnt(27)
v_mfma_f32_16x16x32_bf16 v[32:35], v[52:55], v[188:191], v[32:35]
ds_read_b64_tr_b16 v[78:79], v11 offset:54272
buffer_load_dwordx4 v[172:175], v6, s[20:23], s66 offen offset:2304 sc1
s_waitcnt lgkmcnt(10)
v_mfma_f32_16x16x32_bf16 v[20:23], v[56:59], v[176:179], v[20:23]
ds_read_b64_tr_b16 v[48:49], v8 offset:57344
s_add_u32 s66, s66, 4096
s_and_b32 s66, s66, 0xffff
s_waitcnt lgkmcnt(9)
v_mfma_f32_16x16x32_bf16 v[20:23], v[60:63], v[184:187], v[20:23]
ds_read_b64_tr_b16 v[50:51], v8 offset:58368
v_mfma_f32_16x16x32_bf16 v[36:39], v[56:59], v[180:183], v[36:39]
ds_read_b64_tr_b16 v[52:53], v8 offset:61440
v_mfma_f32_16x16x32_bf16 v[36:39], v[60:63], v[188:191], v[36:39]
ds_read_b64_tr_b16 v[54:55], v8 offset:62464
s_waitcnt lgkmcnt(10)
v_mfma_f32_16x16x32_bf16 v[24:27], v[64:67], v[176:179], v[24:27]
ds_read_b64_tr_b16 v[56:57], v9 offset:57344
s_waitcnt lgkmcnt(9)
v_mfma_f32_16x16x32_bf16 v[24:27], v[68:71], v[184:187], v[24:27]
ds_read_b64_tr_b16 v[58:59], v9 offset:58368
v_mfma_f32_16x16x32_bf16 v[40:43], v[64:67], v[180:183], v[40:43]
ds_read_b64_tr_b16 v[60:61], v9 offset:61440
v_mfma_f32_16x16x32_bf16 v[40:43], v[68:71], v[188:191], v[40:43]
ds_read_b64_tr_b16 v[62:63], v9 offset:62464
s_waitcnt lgkmcnt(10)
v_mfma_f32_16x16x32_bf16 v[28:31], v[72:75], v[176:179], v[28:31]
ds_read_b64_tr_b16 v[64:65], v10 offset:57344
s_waitcnt lgkmcnt(9)
v_mfma_f32_16x16x32_bf16 v[28:31], v[76:79], v[184:187], v[28:31]
ds_read_b64_tr_b16 v[66:67], v10 offset:58368
v_mfma_f32_16x16x32_bf16 v[44:47], v[72:75], v[180:183], v[44:47]
ds_read_b64_tr_b16 v[68:69], v10 offset:61440
v_mfma_f32_16x16x32_bf16 v[44:47], v[76:79], v[188:191], v[44:47]
ds_read_b64_tr_b16 v[70:71], v10 offset:62464
s_waitcnt vmcnt(27) lgkmcnt(10)
v_mfma_f32_16x16x32_bf16 v[16:19], v[48:51], v[192:195], v[16:19]
ds_read_b64_tr_b16 v[72:73], v11 offset:57344
buffer_load_dwordx4 v[176:179], v6, s[20:23], s66 offen offset:0 sc1
s_waitcnt vmcnt(27) lgkmcnt(9)
v_mfma_f32_16x16x32_bf16 v[16:19], v[52:55], v[200:203], v[16:19]
ds_read_b64_tr_b16 v[74:75], v11 offset:58368
buffer_load_dwordx4 v[184:187], v6, s[20:23], s66 offen offset:2048 sc1
s_waitcnt vmcnt(27)
v_mfma_f32_16x16x32_bf16 v[32:35], v[48:51], v[196:199], v[32:35]
ds_read_b64_tr_b16 v[76:77], v11 offset:61440
buffer_load_dwordx4 v[180:183], v6, s[20:23], s66 offen offset:256 sc1
s_waitcnt vmcnt(27)
v_mfma_f32_16x16x32_bf16 v[32:35], v[52:55], v[204:207], v[32:35]
ds_read_b64_tr_b16 v[78:79], v11 offset:62464
buffer_load_dwordx4 v[188:191], v6, s[20:23], s66 offen offset:2304 sc1
s_waitcnt lgkmcnt(10)
v_mfma_f32_16x16x32_bf16 v[20:23], v[56:59], v[192:195], v[20:23]
ds_read_b64_tr_b16 v[48:49], v12 offset:0
s_add_u32 s66, s66, 4096
s_and_b32 s66, s66, 0xffff
s_waitcnt lgkmcnt(9)
v_mfma_f32_16x16x32_bf16 v[20:23], v[60:63], v[200:203], v[20:23]
ds_read_b64_tr_b16 v[50:51], v12 offset:1024
v_mfma_f32_16x16x32_bf16 v[36:39], v[56:59], v[196:199], v[36:39]
ds_read_b64_tr_b16 v[52:53], v12 offset:4096
v_mfma_f32_16x16x32_bf16 v[36:39], v[60:63], v[204:207], v[36:39]
ds_read_b64_tr_b16 v[54:55], v12 offset:5120
s_waitcnt lgkmcnt(10)
v_mfma_f32_16x16x32_bf16 v[24:27], v[64:67], v[192:195], v[24:27]
ds_read_b64_tr_b16 v[56:57], v13 offset:0
s_waitcnt lgkmcnt(9)
v_mfma_f32_16x16x32_bf16 v[24:27], v[68:71], v[200:203], v[24:27]
ds_read_b64_tr_b16 v[58:59], v13 offset:1024
v_mfma_f32_16x16x32_bf16 v[40:43], v[64:67], v[196:199], v[40:43]
ds_read_b64_tr_b16 v[60:61], v13 offset:4096
v_mfma_f32_16x16x32_bf16 v[40:43], v[68:71], v[204:207], v[40:43]
ds_read_b64_tr_b16 v[62:63], v13 offset:5120
s_waitcnt lgkmcnt(10)
v_mfma_f32_16x16x32_bf16 v[28:31], v[72:75], v[192:195], v[28:31]
ds_read_b64_tr_b16 v[64:65], v14 offset:0
s_waitcnt lgkmcnt(9)
v_mfma_f32_16x16x32_bf16 v[28:31], v[76:79], v[200:203], v[28:31]
ds_read_b64_tr_b16 v[66:67], v14 offset:1024
v_mfma_f32_16x16x32_bf16 v[44:47], v[72:75], v[196:199], v[44:47]
ds_read_b64_tr_b16 v[68:69], v14 offset:4096
v_mfma_f32_16x16x32_bf16 v[44:47], v[76:79], v[204:207], v[44:47]
ds_read_b64_tr_b16 v[70:71], v14 offset:5120
s_waitcnt vmcnt(27) lgkmcnt(10)
v_mfma_f32_16x16x32_bf16 v[16:19], v[48:51], v[80:83], v[16:19]
ds_read_b64_tr_b16 v[72:73], v15 offset:0
buffer_load_dwordx4 v[192:195], v6, s[20:23], s66 offen offset:0 sc1
s_waitcnt vmcnt(27) lgkmcnt(9)
v_mfma_f32_16x16x32_bf16 v[16:19], v[52:55], v[88:91], v[16:19]
ds_read_b64_tr_b16 v[74:75], v15 offset:1024
buffer_load_dwordx4 v[200:203], v6, s[20:23], s66 offen offset:2048 sc1
s_waitcnt vmcnt(27)
v_mfma_f32_16x16x32_bf16 v[32:35], v[48:51], v[84:87], v[32:35]
ds_read_b64_tr_b16 v[76:77], v15 offset:4096
buffer_load_dwordx4 v[196:199], v6, s[20:23], s66 offen offset:256 sc1
s_waitcnt vmcnt(27)
v_mfma_f32_16x16x32_bf16 v[32:35], v[52:55], v[92:95], v[32:35]
ds_read_b64_tr_b16 v[78:79], v15 offset:5120
buffer_load_dwordx4 v[204:207], v6, s[20:23], s66 offen offset:2304 sc1
s_waitcnt lgkmcnt(10)
v_mfma_f32_16x16x32_bf16 v[20:23], v[56:59], v[80:83], v[20:23]
ds_read_b64_tr_b16 v[48:49], v12 offset:8192
s_add_u32 s66, s66, 4096
s_and_b32 s66, s66, 0xffff
s_waitcnt lgkmcnt(9)
v_mfma_f32_16x16x32_bf16 v[20:23], v[60:63], v[88:91], v[20:23]
ds_read_b64_tr_b16 v[50:51], v12 offset:9216
v_mfma_f32_16x16x32_bf16 v[36:39], v[56:59], v[84:87], v[36:39]
ds_read_b64_tr_b16 v[52:53], v12 offset:12288
v_mfma_f32_16x16x32_bf16 v[36:39], v[60:63], v[92:95], v[36:39]
ds_read_b64_tr_b16 v[54:55], v12 offset:13312
s_waitcnt lgkmcnt(10)
v_mfma_f32_16x16x32_bf16 v[24:27], v[64:67], v[80:83], v[24:27]
ds_read_b64_tr_b16 v[56:57], v13 offset:8192
s_waitcnt lgkmcnt(9)
v_mfma_f32_16x16x32_bf16 v[24:27], v[68:71], v[88:91], v[24:27]
ds_read_b64_tr_b16 v[58:59], v13 offset:9216
v_mfma_f32_16x16x32_bf16 v[40:43], v[64:67], v[84:87], v[40:43]
ds_read_b64_tr_b16 v[60:61], v13 offset:12288
v_mfma_f32_16x16x32_bf16 v[40:43], v[68:71], v[92:95], v[40:43]
ds_read_b64_tr_b16 v[62:63], v13 offset:13312
s_waitcnt lgkmcnt(10)
v_mfma_f32_16x16x32_bf16 v[28:31], v[72:75], v[80:83], v[28:31]
ds_read_b64_tr_b16 v[64:65], v14 offset:8192
s_waitcnt lgkmcnt(9)
v_mfma_f32_16x16x32_bf16 v[28:31], v[76:79], v[88:91], v[28:31]
ds_read_b64_tr_b16 v[66:67], v14 offset:9216
v_mfma_f32_16x16x32_bf16 v[44:47], v[72:75], v[84:87], v[44:47]
ds_read_b64_tr_b16 v[68:69], v14 offset:12288
v_mfma_f32_16x16x32_bf16 v[44:47], v[76:79], v[92:95], v[44:47]
ds_read_b64_tr_b16 v[70:71], v14 offset:13312
s_waitcnt vmcnt(27) lgkmcnt(10)
v_mfma_f32_16x16x32_bf16 v[16:19], v[48:51], v[96:99], v[16:19]
ds_read_b64_tr_b16 v[72:73], v15 offset:8192
s_waitcnt vmcnt(26) lgkmcnt(9)
v_mfma_f32_16x16x32_bf16 v[16:19], v[52:55], v[104:107], v[16:19]
ds_read_b64_tr_b16 v[74:75], v15 offset:9216
s_waitcnt vmcnt(25)
v_mfma_f32_16x16x32_bf16 v[32:35], v[48:51], v[100:103], v[32:35]
ds_read_b64_tr_b16 v[76:77], v15 offset:12288
s_waitcnt vmcnt(24)
v_mfma_f32_16x16x32_bf16 v[32:35], v[52:55], v[108:111], v[32:35]
ds_read_b64_tr_b16 v[78:79], v15 offset:13312
s_waitcnt lgkmcnt(10)
v_mfma_f32_16x16x32_bf16 v[20:23], v[56:59], v[96:99], v[20:23]
ds_read_b64_tr_b16 v[48:49], v12 offset:16384
s_waitcnt lgkmcnt(9)
v_mfma_f32_16x16x32_bf16 v[20:23], v[60:63], v[104:107], v[20:23]
ds_read_b64_tr_b16 v[50:51], v12 offset:17408
v_mfma_f32_16x16x32_bf16 v[36:39], v[56:59], v[100:103], v[36:39]
ds_read_b64_tr_b16 v[52:53], v12 offset:20480
v_mfma_f32_16x16x32_bf16 v[36:39], v[60:63], v[108:111], v[36:39]
ds_read_b64_tr_b16 v[54:55], v12 offset:21504
s_waitcnt lgkmcnt(10)
v_mfma_f32_16x16x32_bf16 v[24:27], v[64:67], v[96:99], v[24:27]
ds_read_b64_tr_b16 v[56:57], v13 offset:16384
s_waitcnt lgkmcnt(9)
v_mfma_f32_16x16x32_bf16 v[24:27], v[68:71], v[104:107], v[24:27]
ds_read_b64_tr_b16 v[58:59], v13 offset:17408
v_mfma_f32_16x16x32_bf16 v[40:43], v[64:67], v[100:103], v[40:43]
ds_read_b64_tr_b16 v[60:61], v13 offset:20480
v_mfma_f32_16x16x32_bf16 v[40:43], v[68:71], v[108:111], v[40:43]
ds_read_b64_tr_b16 v[62:63], v13 offset:21504
s_waitcnt lgkmcnt(10)
v_mfma_f32_16x16x32_bf16 v[28:31], v[72:75], v[96:99], v[28:31]
ds_read_b64_tr_b16 v[64:65], v14 offset:16384
s_waitcnt lgkmcnt(9)
v_mfma_f32_16x16x32_bf16 v[28:31], v[76:79], v[104:107], v[28:31]
ds_read_b64_tr_b16 v[66:67], v14 offset:17408
v_mfma_f32_16x16x32_bf16 v[44:47], v[72:75], v[100:103], v[44:47]
ds_read_b64_tr_b16 v[68:69], v14 offset:20480
v_mfma_f32_16x16x32_bf16 v[44:47], v[76:79], v[108:111], v[44:47]
ds_read_b64_tr_b16 v[70:71], v14 offset:21504
s_waitcnt vmcnt(23) lgkmcnt(10)
v_mfma_f32_16x16x32_bf16 v[16:19], v[48:51], v[112:115], v[16:19]
ds_read_b64_tr_b16 v[72:73], v15 offset:16384
s_waitcnt vmcnt(22) lgkmcnt(9)
v_mfma_f32_16x16x32_bf16 v[16:19], v[52:55], v[120:123], v[16:19]
ds_read_b64_tr_b16 v[74:75], v15 offset:17408
s_waitcnt vmcnt(21)
v_mfma_f32_16x16x32_bf16 v[32:35], v[48:51], v[116:119], v[32:35]
ds_read_b64_tr_b16 v[76:77], v15 offset:20480
s_waitcnt vmcnt(20)
v_mfma_f32_16x16x32_bf16 v[32:35], v[52:55], v[124:127], v[32:35]
ds_read_b64_tr_b16 v[78:79], v15 offset:21504
s_waitcnt lgkmcnt(10)
v_mfma_f32_16x16x32_bf16 v[20:23], v[56:59], v[112:115], v[20:23]
ds_read_b64_tr_b16 v[48:49], v12 offset:24576
s_waitcnt lgkmcnt(9)
v_mfma_f32_16x16x32_bf16 v[20:23], v[60:63], v[120:123], v[20:23]
ds_read_b64_tr_b16 v[50:51], v12 offset:25600
v_mfma_f32_16x16x32_bf16 v[36:39], v[56:59], v[116:119], v[36:39]
ds_read_b64_tr_b16 v[52:53], v12 offset:28672
v_mfma_f32_16x16x32_bf16 v[36:39], v[60:63], v[124:127], v[36:39]
ds_read_b64_tr_b16 v[54:55], v12 offset:29696
s_waitcnt lgkmcnt(10)
v_mfma_f32_16x16x32_bf16 v[24:27], v[64:67], v[112:115], v[24:27]
ds_read_b64_tr_b16 v[56:57], v13 offset:24576
s_waitcnt lgkmcnt(9)
v_mfma_f32_16x16x32_bf16 v[24:27], v[68:71], v[120:123], v[24:27]
ds_read_b64_tr_b16 v[58:59], v13 offset:25600
v_mfma_f32_16x16x32_bf16 v[40:43], v[64:67], v[116:119], v[40:43]
ds_read_b64_tr_b16 v[60:61], v13 offset:28672
v_mfma_f32_16x16x32_bf16 v[40:43], v[68:71], v[124:127], v[40:43]
ds_read_b64_tr_b16 v[62:63], v13 offset:29696
s_waitcnt lgkmcnt(10)
v_mfma_f32_16x16x32_bf16 v[28:31], v[72:75], v[112:115], v[28:31]
ds_read_b64_tr_b16 v[64:65], v14 offset:24576
s_waitcnt lgkmcnt(9)
v_mfma_f32_16x16x32_bf16 v[28:31], v[76:79], v[120:123], v[28:31]
ds_read_b64_tr_b16 v[66:67], v14 offset:25600
v_mfma_f32_16x16x32_bf16 v[44:47], v[72:75], v[116:119], v[44:47]
ds_read_b64_tr_b16 v[68:69], v14 offset:28672
v_mfma_f32_16x16x32_bf16 v[44:47], v[76:79], v[124:127], v[44:47]
ds_read_b64_tr_b16 v[70:71], v14 offset:29696
s_waitcnt vmcnt(19) lgkmcnt(10)
v_mfma_f32_16x16x32_bf16 v[16:19], v[48:51], v[128:131], v[16:19]
ds_read_b64_tr_b16 v[72:73], v15 offset:24576
s_waitcnt vmcnt(18) lgkmcnt(9)
v_mfma_f32_16x16x32_bf16 v[16:19], v[52:55], v[136:139], v[16:19]
ds_read_b64_tr_b16 v[74:75], v15 offset:25600
s_waitcnt vmcnt(17)
v_mfma_f32_16x16x32_bf16 v[32:35], v[48:51], v[132:135], v[32:35]
ds_read_b64_tr_b16 v[76:77], v15 offset:28672
s_waitcnt vmcnt(16)
v_mfma_f32_16x16x32_bf16 v[32:35], v[52:55], v[140:143], v[32:35]
ds_read_b64_tr_b16 v[78:79], v15 offset:29696
s_waitcnt lgkmcnt(10)
v_mfma_f32_16x16x32_bf16 v[20:23], v[56:59], v[128:131], v[20:23]
ds_read_b64_tr_b16 v[48:49], v12 offset:32768
s_waitcnt lgkmcnt(9)
v_mfma_f32_16x16x32_bf16 v[20:23], v[60:63], v[136:139], v[20:23]
ds_read_b64_tr_b16 v[50:51], v12 offset:33792
v_mfma_f32_16x16x32_bf16 v[36:39], v[56:59], v[132:135], v[36:39]
ds_read_b64_tr_b16 v[52:53], v12 offset:36864
v_mfma_f32_16x16x32_bf16 v[36:39], v[60:63], v[140:143], v[36:39]
ds_read_b64_tr_b16 v[54:55], v12 offset:37888
s_waitcnt lgkmcnt(10)
v_mfma_f32_16x16x32_bf16 v[24:27], v[64:67], v[128:131], v[24:27]
ds_read_b64_tr_b16 v[56:57], v13 offset:32768
s_waitcnt lgkmcnt(9)
v_mfma_f32_16x16x32_bf16 v[24:27], v[68:71], v[136:139], v[24:27]
ds_read_b64_tr_b16 v[58:59], v13 offset:33792
v_mfma_f32_16x16x32_bf16 v[40:43], v[64:67], v[132:135], v[40:43]
ds_read_b64_tr_b16 v[60:61], v13 offset:36864
v_mfma_f32_16x16x32_bf16 v[40:43], v[68:71], v[140:143], v[40:43]
ds_read_b64_tr_b16 v[62:63], v13 offset:37888
s_waitcnt lgkmcnt(10)
v_mfma_f32_16x16x32_bf16 v[28:31], v[72:75], v[128:131], v[28:31]
ds_read_b64_tr_b16 v[64:65], v14 offset:32768
s_waitcnt lgkmcnt(9)
v_mfma_f32_16x16x32_bf16 v[28:31], v[76:79], v[136:139], v[28:31]
ds_read_b64_tr_b16 v[66:67], v14 offset:33792
v_mfma_f32_16x16x32_bf16 v[44:47], v[72:75], v[132:135], v[44:47]
ds_read_b64_tr_b16 v[68:69], v14 offset:36864
v_mfma_f32_16x16x32_bf16 v[44:47], v[76:79], v[140:143], v[44:47]
ds_read_b64_tr_b16 v[70:71], v14 offset:37888
s_waitcnt vmcnt(15) lgkmcnt(10)
v_mfma_f32_16x16x32_bf16 v[16:19], v[48:51], v[144:147], v[16:19]
ds_read_b64_tr_b16 v[72:73], v15 offset:32768
s_waitcnt vmcnt(14) lgkmcnt(9)
v_mfma_f32_16x16x32_bf16 v[16:19], v[52:55], v[152:155], v[16:19]
ds_read_b64_tr_b16 v[74:75], v15 offset:33792
s_waitcnt vmcnt(13)
v_mfma_f32_16x16x32_bf16 v[32:35], v[48:51], v[148:151], v[32:35]
ds_read_b64_tr_b16 v[76:77], v15 offset:36864
s_waitcnt vmcnt(12)
v_mfma_f32_16x16x32_bf16 v[32:35], v[52:55], v[156:159], v[32:35]
ds_read_b64_tr_b16 v[78:79], v15 offset:37888
s_waitcnt lgkmcnt(10)
v_mfma_f32_16x16x32_bf16 v[20:23], v[56:59], v[144:147], v[20:23]
ds_read_b64_tr_b16 v[48:49], v12 offset:40960
s_waitcnt lgkmcnt(9)
v_mfma_f32_16x16x32_bf16 v[20:23], v[60:63], v[152:155], v[20:23]
ds_read_b64_tr_b16 v[50:51], v12 offset:41984
v_mfma_f32_16x16x32_bf16 v[36:39], v[56:59], v[148:151], v[36:39]
ds_read_b64_tr_b16 v[52:53], v12 offset:45056
v_mfma_f32_16x16x32_bf16 v[36:39], v[60:63], v[156:159], v[36:39]
ds_read_b64_tr_b16 v[54:55], v12 offset:46080
s_waitcnt lgkmcnt(10)
v_mfma_f32_16x16x32_bf16 v[24:27], v[64:67], v[144:147], v[24:27]
ds_read_b64_tr_b16 v[56:57], v13 offset:40960
s_waitcnt lgkmcnt(9)
v_mfma_f32_16x16x32_bf16 v[24:27], v[68:71], v[152:155], v[24:27]
ds_read_b64_tr_b16 v[58:59], v13 offset:41984
v_mfma_f32_16x16x32_bf16 v[40:43], v[64:67], v[148:151], v[40:43]
ds_read_b64_tr_b16 v[60:61], v13 offset:45056
v_mfma_f32_16x16x32_bf16 v[40:43], v[68:71], v[156:159], v[40:43]
ds_read_b64_tr_b16 v[62:63], v13 offset:46080
s_waitcnt lgkmcnt(10)
v_mfma_f32_16x16x32_bf16 v[28:31], v[72:75], v[144:147], v[28:31]
ds_read_b64_tr_b16 v[64:65], v14 offset:40960
s_waitcnt lgkmcnt(9)
v_mfma_f32_16x16x32_bf16 v[28:31], v[76:79], v[152:155], v[28:31]
ds_read_b64_tr_b16 v[66:67], v14 offset:41984
v_mfma_f32_16x16x32_bf16 v[44:47], v[72:75], v[148:151], v[44:47]
ds_read_b64_tr_b16 v[68:69], v14 offset:45056
v_mfma_f32_16x16x32_bf16 v[44:47], v[76:79], v[156:159], v[44:47]
ds_read_b64_tr_b16 v[70:71], v14 offset:46080
s_waitcnt vmcnt(11) lgkmcnt(10)
v_mfma_f32_16x16x32_bf16 v[16:19], v[48:51], v[160:163], v[16:19]
ds_read_b64_tr_b16 v[72:73], v15 offset:40960
s_waitcnt vmcnt(10) lgkmcnt(9)
v_mfma_f32_16x16x32_bf16 v[16:19], v[52:55], v[168:171], v[16:19]
ds_read_b64_tr_b16 v[74:75], v15 offset:41984
s_waitcnt vmcnt(9)
v_mfma_f32_16x16x32_bf16 v[32:35], v[48:51], v[164:167], v[32:35]
ds_read_b64_tr_b16 v[76:77], v15 offset:45056
s_waitcnt vmcnt(8)
v_mfma_f32_16x16x32_bf16 v[32:35], v[52:55], v[172:175], v[32:35]
ds_read_b64_tr_b16 v[78:79], v15 offset:46080
s_waitcnt lgkmcnt(10)
v_mfma_f32_16x16x32_bf16 v[20:23], v[56:59], v[160:163], v[20:23]
ds_read_b64_tr_b16 v[48:49], v12 offset:49152
s_waitcnt lgkmcnt(9)
v_mfma_f32_16x16x32_bf16 v[20:23], v[60:63], v[168:171], v[20:23]
ds_read_b64_tr_b16 v[50:51], v12 offset:50176
v_mfma_f32_16x16x32_bf16 v[36:39], v[56:59], v[164:167], v[36:39]
ds_read_b64_tr_b16 v[52:53], v12 offset:53248
v_mfma_f32_16x16x32_bf16 v[36:39], v[60:63], v[172:175], v[36:39]
ds_read_b64_tr_b16 v[54:55], v12 offset:54272
s_waitcnt lgkmcnt(10)
v_mfma_f32_16x16x32_bf16 v[24:27], v[64:67], v[160:163], v[24:27]
ds_read_b64_tr_b16 v[56:57], v13 offset:49152
s_waitcnt lgkmcnt(9)
v_mfma_f32_16x16x32_bf16 v[24:27], v[68:71], v[168:171], v[24:27]
ds_read_b64_tr_b16 v[58:59], v13 offset:50176
v_mfma_f32_16x16x32_bf16 v[40:43], v[64:67], v[164:167], v[40:43]
ds_read_b64_tr_b16 v[60:61], v13 offset:53248
v_mfma_f32_16x16x32_bf16 v[40:43], v[68:71], v[172:175], v[40:43]
ds_read_b64_tr_b16 v[62:63], v13 offset:54272
s_waitcnt lgkmcnt(10)
v_mfma_f32_16x16x32_bf16 v[28:31], v[72:75], v[160:163], v[28:31]
ds_read_b64_tr_b16 v[64:65], v14 offset:49152
s_waitcnt lgkmcnt(9)
v_mfma_f32_16x16x32_bf16 v[28:31], v[76:79], v[168:171], v[28:31]
ds_read_b64_tr_b16 v[66:67], v14 offset:50176
v_mfma_f32_16x16x32_bf16 v[44:47], v[72:75], v[164:167], v[44:47]
ds_read_b64_tr_b16 v[68:69], v14 offset:53248
v_mfma_f32_16x16x32_bf16 v[44:47], v[76:79], v[172:175], v[44:47]
ds_read_b64_tr_b16 v[70:71], v14 offset:54272
s_waitcnt vmcnt(7) lgkmcnt(10)
v_mfma_f32_16x16x32_bf16 v[16:19], v[48:51], v[176:179], v[16:19]
ds_read_b64_tr_b16 v[72:73], v15 offset:49152
s_waitcnt vmcnt(6) lgkmcnt(9)
v_mfma_f32_16x16x32_bf16 v[16:19], v[52:55], v[184:187], v[16:19]
ds_read_b64_tr_b16 v[74:75], v15 offset:50176
s_waitcnt vmcnt(5)
v_mfma_f32_16x16x32_bf16 v[32:35], v[48:51], v[180:183], v[32:35]
ds_read_b64_tr_b16 v[76:77], v15 offset:53248
s_waitcnt vmcnt(4)
v_mfma_f32_16x16x32_bf16 v[32:35], v[52:55], v[188:191], v[32:35]
ds_read_b64_tr_b16 v[78:79], v15 offset:54272
s_waitcnt lgkmcnt(10)
v_mfma_f32_16x16x32_bf16 v[20:23], v[56:59], v[176:179], v[20:23]
ds_read_b64_tr_b16 v[48:49], v12 offset:57344
s_waitcnt lgkmcnt(9)
v_mfma_f32_16x16x32_bf16 v[20:23], v[60:63], v[184:187], v[20:23]
ds_read_b64_tr_b16 v[50:51], v12 offset:58368
v_mfma_f32_16x16x32_bf16 v[36:39], v[56:59], v[180:183], v[36:39]
ds_read_b64_tr_b16 v[52:53], v12 offset:61440
v_mfma_f32_16x16x32_bf16 v[36:39], v[60:63], v[188:191], v[36:39]
ds_read_b64_tr_b16 v[54:55], v12 offset:62464
s_waitcnt lgkmcnt(10)
v_mfma_f32_16x16x32_bf16 v[24:27], v[64:67], v[176:179], v[24:27]
ds_read_b64_tr_b16 v[56:57], v13 offset:57344
s_waitcnt lgkmcnt(9)
v_mfma_f32_16x16x32_bf16 v[24:27], v[68:71], v[184:187], v[24:27]
ds_read_b64_tr_b16 v[58:59], v13 offset:58368
v_mfma_f32_16x16x32_bf16 v[40:43], v[64:67], v[180:183], v[40:43]
ds_read_b64_tr_b16 v[60:61], v13 offset:61440
v_mfma_f32_16x16x32_bf16 v[40:43], v[68:71], v[188:191], v[40:43]
ds_read_b64_tr_b16 v[62:63], v13 offset:62464
s_waitcnt lgkmcnt(10)
v_mfma_f32_16x16x32_bf16 v[28:31], v[72:75], v[176:179], v[28:31]
ds_read_b64_tr_b16 v[64:65], v14 offset:57344
s_waitcnt lgkmcnt(9)
v_mfma_f32_16x16x32_bf16 v[28:31], v[76:79], v[184:187], v[28:31]
ds_read_b64_tr_b16 v[66:67], v14 offset:58368
v_mfma_f32_16x16x32_bf16 v[44:47], v[72:75], v[180:183], v[44:47]
ds_read_b64_tr_b16 v[68:69], v14 offset:61440
v_mfma_f32_16x16x32_bf16 v[44:47], v[76:79], v[188:191], v[44:47]
ds_read_b64_tr_b16 v[70:71], v14 offset:62464
s_waitcnt vmcnt(3) lgkmcnt(10)
v_mfma_f32_16x16x32_bf16 v[16:19], v[48:51], v[192:195], v[16:19]
ds_read_b64_tr_b16 v[72:73], v15 offset:57344
s_waitcnt vmcnt(2) lgkmcnt(9)
v_mfma_f32_16x16x32_bf16 v[16:19], v[52:55], v[200:203], v[16:19]
ds_read_b64_tr_b16 v[74:75], v15 offset:58368
s_waitcnt vmcnt(1)
v_mfma_f32_16x16x32_bf16 v[32:35], v[48:51], v[196:199], v[32:35]
ds_read_b64_tr_b16 v[76:77], v15 offset:61440
s_waitcnt vmcnt(0)
v_mfma_f32_16x16x32_bf16 v[32:35], v[52:55], v[204:207], v[32:35]
ds_read_b64_tr_b16 v[78:79], v15 offset:62464
s_waitcnt lgkmcnt(10)
v_mfma_f32_16x16x32_bf16 v[20:23], v[56:59], v[192:195], v[20:23]
v_add_u32 v5, s34, 22
s_mov_b64 exec, 1
ds_write_b32 v3, v5
s_mov_b64 exec, -1
s_waitcnt lgkmcnt(9)
v_mfma_f32_16x16x32_bf16 v[20:23], v[60:63], v[200:203], v[20:23]
v_mfma_f32_16x16x32_bf16 v[36:39], v[56:59], v[196:199], v[36:39]
v_mfma_f32_16x16x32_bf16 v[36:39], v[60:63], v[204:207], v[36:39]
s_waitcnt lgkmcnt(7)
v_mfma_f32_16x16x32_bf16 v[24:27], v[64:67], v[192:195], v[24:27]
s_waitcnt lgkmcnt(5)
v_mfma_f32_16x16x32_bf16 v[24:27], v[68:71], v[200:203], v[24:27]
v_mfma_f32_16x16x32_bf16 v[40:43], v[64:67], v[196:199], v[40:43]
v_mfma_f32_16x16x32_bf16 v[40:43], v[68:71], v[204:207], v[40:43]
s_waitcnt lgkmcnt(3)
v_mfma_f32_16x16x32_bf16 v[28:31], v[72:75], v[192:195], v[28:31]
s_waitcnt lgkmcnt(1)
v_mfma_f32_16x16x32_bf16 v[28:31], v[76:79], v[200:203], v[28:31]
v_mfma_f32_16x16x32_bf16 v[44:47], v[72:75], v[196:199], v[44:47]
v_mfma_f32_16x16x32_bf16 v[44:47], v[76:79], v[204:207], v[44:47]
s_lshl2_add_u32 s73, s61, s58
s_lshl4_add_u32 s66, s61, s62
s_lshl2_add_u32 s68, s66, s58
s_lshl_b32 s68, s68, 12
s_add_u32 s68, s68, 26214400
s_lshl_b32 s66, s61, 7
s_add_u32 s66, s66, s62
s_lshl_b32 s66, s66, 7
s_add_u32 s66, s66, 274432
s_lshl_b32 s74, s73, 13
s_add_u32 s74, s74, 524288
s_lshl_b32 s67, s62, 9
s_add_u32 s67, s67, s74
v_lshlrev_b32 v6, 4, v0
s_mov_b32 s69, 0x3f803f80
v_mov_b32 v8, 0
v_mov_b32 v9, 0
v_mov_b32 v10, 0
v_mov_b32 v11, 0
v_mov_b32 v12, 0
v_mov_b32 v13, 0
v_mov_b32 v14, 0
v_dot2c_f32_bf16 v11, s69, v232
v_dot2c_f32_bf16 v11, s69, v233
v_dot2c_f32_bf16 v11, s69, v234
v_dot2c_f32_bf16 v11, s69, v235
v_dot2c_f32_bf16 v11, s69, v236
v_dot2c_f32_bf16 v11, s69, v237
v_dot2c_f32_bf16 v11, s69, v238
v_dot2c_f32_bf16 v11, s69, v239
s_cmp_eq_u32 s63, 0
v_cvt_pk_bf16_f32 v240, v16, v17
v_cvt_pk_bf16_f32 v241, v18, v19
v_cvt_pk_bf16_f32 v242, v20, v21
v_cvt_pk_bf16_f32 v243, v22, v23
v_cvt_pk_bf16_f32 v244, v24, v25
v_cvt_pk_bf16_f32 v245, v26, v27
v_cvt_pk_bf16_f32 v246, v28, v29
v_cvt_pk_bf16_f32 v247, v30, v31
v_cvt_pk_bf16_f32 v248, v32, v33
v_cvt_pk_bf16_f32 v249, v34, v35
v_cvt_pk_bf16_f32 v250, v36, v37
v_cvt_pk_bf16_f32 v251, v38, v39
v_cvt_pk_bf16_f32 v252, v40, v41
v_cvt_pk_bf16_f32 v253, v42, v43
v_cvt_pk_bf16_f32 v254, v44, v45
v_cvt_pk_bf16_f32 v255, v46, v47
s_cselect_b64 exec, -1, 0
s_cmp_eq_u32 s57, 0
s_cbranch_scc1 far_169
buffer_store_dwordx4 v[240:243], v6, s[20:23], s68 offen offset:0
buffer_store_dwordx4 v[244:247], v6, s[20:23], s68 offen offset:1024
buffer_store_dwordx4 v[248:251], v6, s[20:23], s68 offen offset:2048
buffer_store_dwordx4 v[252:255], v6, s[20:23], s68 offen offset:3072
near_170:
s_mov_b64 exec, -1
v_dot2c_f32_bf16 v8, s69, v240
v_dot2c_f32_bf16 v9, v240, v240
v_dot2c_f32_bf16 v10, v232, v240
v_dot2c_f32_bf16 v12, s69, v248
v_dot2c_f32_bf16 v13, v248, v248
v_dot2c_f32_bf16 v14, v232, v248
v_dot2c_f32_bf16 v8, s69, v241
v_dot2c_f32_bf16 v9, v241, v241
v_dot2c_f32_bf16 v10, v233, v241
v_dot2c_f32_bf16 v12, s69, v249
v_dot2c_f32_bf16 v13, v249, v249
v_dot2c_f32_bf16 v14, v233, v249
v_dot2c_f32_bf16 v8, s69, v242
v_dot2c_f32_bf16 v9, v242, v242
v_dot2c_f32_bf16 v10, v234, v242
v_dot2c_f32_bf16 v12, s69, v250
v_dot2c_f32_bf16 v13, v250, v250
v_dot2c_f32_bf16 v14, v234, v250
v_dot2c_f32_bf16 v8, s69, v243
v_dot2c_f32_bf16 v9, v243, v243
v_dot2c_f32_bf16 v10, v235, v243
v_dot2c_f32_bf16 v12, s69, v251
v_dot2c_f32_bf16 v13, v251, v251
v_dot2c_f32_bf16 v14, v235, v251
v_dot2c_f32_bf16 v8, s69, v244
v_dot2c_f32_bf16 v9, v244, v244
v_dot2c_f32_bf16 v10, v236, v244
v_dot2c_f32_bf16 v12, s69, v252
v_dot2c_f32_bf16 v13, v252, v252
v_dot2c_f32_bf16 v14, v236, v252
v_dot2c_f32_bf16 v8, s69, v245
v_dot2c_f32_bf16 v9, v245, v245
v_dot2c_f32_bf16 v10, v237, v245
v_dot2c_f32_bf16 v12, s69, v253
v_dot2c_f32_bf16 v13, v253, v253
v_dot2c_f32_bf16 v14, v237, v253
v_dot2c_f32_bf16 v8, s69, v246
v_dot2c_f32_bf16 v9, v246, v246
v_dot2c_f32_bf16 v10, v238, v246
v_dot2c_f32_bf16 v12, s69, v254
v_dot2c_f32_bf16 v13, v254, v254
v_dot2c_f32_bf16 v14, v238, v254
v_dot2c_f32_bf16 v8, s69, v247
v_dot2c_f32_bf16 v9, v247, v247
v_dot2c_f32_bf16 v10, v239, v247
v_dot2c_f32_bf16 v12, s69, v255
v_dot2c_f32_bf16 v13, v255, v255
v_dot2c_f32_bf16 v14, v239, v255
v_mov_b32 v15, v11
v_lshrrev_b32 v7, 5, v0
v_mul_u32_u24 v7, 3584, v7
v_permlane16_swap_b32 v8, v12
v_permlane16_swap_b32 v9, v13
v_permlane16_swap_b32 v10, v14
v_permlane16_swap_b32 v11, v15
v_pk_add_f32 v[8:9], v[8:9], v[12:13]
v_pk_add_f32 v[10:11], v[10:11], v[14:15]
v_mov_b32 v12, v8
v_mov_b32 v13, v9
v_mov_b32 v14, v10
v_mov_b32 v15, v11
v_permlane32_swap_b32 v12, v8
v_permlane32_swap_b32 v13, v9
v_permlane32_swap_b32 v14, v10
v_permlane32_swap_b32 v15, v11
v_pk_add_f32 v[8:9], v[8:9], v[12:13]
v_pk_add_f32 v[10:11], v[10:11], v[14:15]
v_add_u32 v7, v6, v7
v_max_u32 v8, 1, v8
v_max_u32 v9, 1, v9
v_max_u32 v10, 1, v10
v_max_u32 v11, 1, v11
s_mov_b32 exec_hi, 0
s_cmp_eq_u32 s57, 0
s_cbranch_scc1 far_171
buffer_store_dwordx4 v[8:11], v6, s[24:27], s67 offen
near_172:
s_mov_b32 exec_hi, -1
v_lshlrev_b32 v16, 16, v240
v_and_b32 v17, 0xffff0000, v240
v_lshlrev_b32 v18, 16, v241
v_and_b32 v19, 0xffff0000, v241
v_lshlrev_b32 v20, 16, v242
v_and_b32 v21, 0xffff0000, v242
v_lshlrev_b32 v22, 16, v243
v_and_b32 v23, 0xffff0000, v243
v_lshlrev_b32 v24, 16, v244
v_and_b32 v25, 0xffff0000, v244
v_lshlrev_b32 v26, 16, v245
v_and_b32 v27, 0xffff0000, v245
v_lshlrev_b32 v28, 16, v246
v_and_b32 v29, 0xffff0000, v246
v_lshlrev_b32 v30, 16, v247
v_and_b32 v31, 0xffff0000, v247
v_lshlrev_b32 v32, 16, v248
v_and_b32 v33, 0xffff0000, v248
v_lshlrev_b32 v34, 16, v249
v_and_b32 v35, 0xffff0000, v249
v_lshlrev_b32 v36, 16, v250
v_and_b32 v37, 0xffff0000, v250
v_lshlrev_b32 v38, 16, v251
v_and_b32 v39, 0xffff0000, v251
v_lshlrev_b32 v40, 16, v252
v_and_b32 v41, 0xffff0000, v252
v_lshlrev_b32 v42, 16, v253
v_and_b32 v43, 0xffff0000, v253
v_lshlrev_b32 v44, 16, v254
v_and_b32 v45, 0xffff0000, v254
v_lshlrev_b32 v46, 16, v255
v_and_b32 v47, 0xffff0000, v255
v_and_b32 v14, 15, v0
v_lshlrev_b32 v14, 11, v14
v_bfe_u32 v15, v0, 4, 1
v_lshl_add_u32 v14, v15, 5, v14
v_lshrrev_b32 v15, 5, v0
v_lshl_add_u32 v14, v15, 4, v14
s_lshl2_add_u32 s70, s61, s58
s_lshl_b32 s70, s70, 16
s_lshl_b32 s71, s62, 7
s_add_u32 s70, s70, s71
s_add_u32 s71, s70, 0x8000
s_lshl_b32 s67, s62, 6
s_sub_u32 s68, s66, 2048
s_lshl1_add_u32 s69, s67, s68
s_sub_u32 s69, s69, 10240
s_sub_u32 s72, s68, s67
s_add_u32 s72, s72, 4096
s_lshl_b32 s75, s73, 5
s_add_u32 s75, s75, 1
v_and_b32 v15, 48, v0
v_add_u32 v13, s75, v0
v_lshlrev_b32 v4, 1, v15
s_mov_b64 exec, 1
s_waitcnt vmcnt(1)
s_cmp_eq_u32 s57, 0
s_cbranch_scc1 far_173
buffer_store_dword v212, v3, s[24:27], s66 offen
near_174:
s_mov_b64 exec, -1
v_add_u32 v5, s34, 23
s_mov_b64 exec, 1
ds_write_b32 v3, v5
s_mov_b64 exec, -1
s_waitcnt vmcnt(1)
buffer_load_dwordx4 v[80:83], v7, s[24:27], s74 offen offset:0 sc1
buffer_load_dwordx4 v[84:87], v7, s[24:27], s74 offen offset:512 sc1
buffer_load_dwordx4 v[88:91], v7, s[24:27], s74 offen offset:1024 sc1
buffer_load_dwordx4 v[92:95], v7, s[24:27], s74 offen offset:1536 sc1
buffer_load_dwordx4 v[96:99], v7, s[24:27], s74 offen offset:2048 sc1
buffer_load_dwordx4 v[100:103], v7, s[24:27], s74 offen offset:2560 sc1
buffer_load_dwordx4 v[104:107], v7, s[24:27], s74 offen offset:3072 sc1
buffer_load_dwordx4 v[108:111], v7, s[24:27], s74 offen offset:3584 sc1
s_cmp_eq_u32 s63, 0
s_cbranch_scc0 mhz_175
v_lshrrev_b32 v196, 4, v0
s_cmp_eq_u32 1, 0
s_cbranch_scc0 mq_176
v_bfe_u32 v197, v0, 1, 3
v_xor_b32 v197, v197, v196
v_lshlrev_b32 v197, 4, v197
v_and_b32 v198, 15, v0
v_lshl_add_u32 v192, v198, 7, v197
v_xor_b32 v193, 64, v192
s_branch mq_177
mq_176:
v_lshlrev_b32 v192, 4, v0
v_add_u32 v193, 1024, v192
mq_177:
s_lshl_b32 s46, s65, 13
s_add_u32 s46, s46, 86016
v_add_u32 v192, s46, v192
v_add_u32 v193, s46, v193
v_bfe_u32 v197, v0, 2, 2
v_lshl_add_u32 v197, v196, 3, v197
v_bfe_u32 v198, v0, 3, 2
s_lshl_b32 s46, s64, 1
v_xor_b32 v198, s46, v198
v_lshlrev_b32 v198, 5, v198
v_lshl_add_u32 v197, v197, 7, v198
v_and_b32 v198, 3, v0
v_lshl_add_u32 v197, v198, 3, v197
v_add_u32 v194, 102400, v197
v_xor_b32 v195, 32, v194
v_mov_b32 v197, 0xf149f2ca
v_xor_b32 v216, v197, v216
v_xor_b32 v217, v197, v217
v_xor_b32 v218, v197, v218
v_xor_b32 v219, v197, v219
v_xor_b32 v220, v197, v220
v_xor_b32 v221, v197, v221
v_xor_b32 v222, v197, v222
v_xor_b32 v223, v197, v223
v_xor_b32 v224, v197, v224
v_xor_b32 v225, v197, v225
v_xor_b32 v226, v197, v226
v_xor_b32 v227, v197, v227
v_xor_b32 v228, v197, v228
v_xor_b32 v229, v197, v229
v_xor_b32 v230, v197, v230
v_xor_b32 v231, v197, v231
v_and_b32 v196, 15, v0
v_lshrrev_b32 v197, 4, v0
s_lshl_b32 s46, s65, 8
s_add_u32 s46, s46, 1280
s_mul_i32 s47, s64, 384
v_lshl_add_u32 v208, v196, 2, s46
v_lshl_add_u32 v209, v197, 4, s46
v_lshl_add_u32 v210, v196, 2, s47
v_lshl_add_u32 v211, v197, 4, s47
v_and_b32 v198, 1, v197
v_lshrrev_b32 v197, 1, v197
v_lshlrev_b32 v197, 9, v197
v_lshl_add_u32 v197, v198, 10, v197
s_lshl_b32 s46, s64, 12
s_lshl_b32 s47, s65, 13
s_add_u32 s46, s46, 131072
s_add_u32 s48, s46, 24576
s_sub_u32 s48, s48, s47
s_add_u32 s47, s46, s47
v_lshl_add_u32 v200, v196, 4, v197
v_and_b32 v198, 3, v0
v_lshl_add_u32 v197, v198, 4, v197
v_bfe_u32 v198, v0, 3, 1
v_lshl_add_u32 v197, v198, 6, v197
v_bfe_u32 v198, v0, 2, 1
v_lshl_add_u32 v198, v198, 8, v197
v_add_u32 v199, s48, v198
v_add_u32 v198, s47, v198
v_add_u32 v201, s48, v200
v_add_u32 v200, s47, v200
s_lshl_b32 s46, s59, 4
s_add_u32 s46, s46, s60
s_lshl_b32 s50, s59, 7
s_add_u32 s50, s50, s60
s_lshl_b32 s50, s50, 7
s_lshl_b32 s46, s46, 15
s_lshl_b32 s47, 1, 23
s_add_u32 s46, s46, s47
s_add_u32 s49, s46, 917504
mhz_175:
s_branch pchk_179
poll_178:
buffer_load_dwordx4 v[80:83], v7, s[24:27], s74 offen offset:0 sc1
buffer_load_dwordx4 v[84:87], v7, s[24:27], s74 offen offset:512 sc1
buffer_load_dwordx4 v[88:91], v7, s[24:27], s74 offen offset:1024 sc1
buffer_load_dwordx4 v[92:95], v7, s[24:27], s74 offen offset:1536 sc1
buffer_load_dwordx4 v[96:99], v7, s[24:27], s74 offen offset:2048 sc1
buffer_load_dwordx4 v[100:103], v7, s[24:27], s74 offen offset:2560 sc1
buffer_load_dwordx4 v[104:107], v7, s[24:27], s74 offen offset:3072 sc1
buffer_load_dwordx4 v[108:111], v7, s[24:27], s74 offen offset:3584 sc1
pchk_179:
s_waitcnt vmcnt(7)
v_min3_u32 v8, v80, v81, v82
s_waitcnt vmcnt(6)
v_min3_u32 v8, v8, v83, v84
v_min3_u32 v8, v8, v85, v86
s_waitcnt vmcnt(5)
v_min3_u32 v8, v8, v87, v88
v_min3_u32 v8, v8, v89, v90
s_waitcnt vmcnt(4)
v_min3_u32 v8, v8, v91, v92
v_min3_u32 v8, v8, v93, v94
s_waitcnt vmcnt(3)
v_min3_u32 v8, v8, v95, v96
v_min3_u32 v8, v8, v97, v98
s_waitcnt vmcnt(2)
v_min3_u32 v8, v8, v99, v100
v_min3_u32 v8, v8, v101, v102
s_waitcnt vmcnt(1)
v_min3_u32 v8, v8, v103, v104
v_min3_u32 v8, v8, v105, v106
s_waitcnt vmcnt(0)
v_min3_u32 v8, v8, v107, v108
v_min3_u32 v8, v8, v109, v110
v_min_u32 v8, v8, v111
v_cmp_eq_u32 vcc, 0, v8
s_cbranch_vccz pdone_180
s_sub_u32 s32, s32, 1
s_cmp_gt_i32 s32, 0
s_cbranch_scc1 poll_178
pdone_180:
v_pk_add_f32 v[80:81], v[80:81], v[96:97]
v_pk_add_f32 v[82:83], v[82:83], v[98:99]
v_pk_add_f32 v[84:85], v[84:85], v[100:101]
v_pk_add_f32 v[86:87], v[86:87], v[102:103]
v_pk_add_f32 v[88:89], v[88:89], v[104:105]
v_pk_add_f32 v[90:91], v[90:91], v[106:107]
v_pk_add_f32 v[92:93], v[92:93], v[108:109]
v_pk_add_f32 v[94:95], v[94:95], v[110:111]
v_pk_add_f32 v[80:81], v[80:81], v[88:89]
v_pk_add_f32 v[82:83], v[82:83], v[90:91]
v_pk_add_f32 v[84:85], v[84:85], v[92:93]
v_pk_add_f32 v[86:87], v[86:87], v[94:95]
v_pk_add_f32 v[80:81], v[80:81], v[84:85]
v_pk_add_f32 v[82:83], v[82:83], v[86:87]
v_mov_b32 v8, v80
v_mov_b32 v9, v81
v_mov_b32 v10, v82
v_mov_b32 v11, v83
v_permlane32_swap_b32 v8, v80
v_permlane32_swap_b32 v9, v81
v_permlane32_swap_b32 v10, v82
v_permlane32_swap_b32 v11, v83
v_pk_add_f32 v[8:9], v[8:9], v[80:81]
v_pk_add_f32 v[10:11], v[10:11], v[82:83]
v_mul_f32 v8, 0xba800000, v8
v_mul_f32 v9, 0x3a800000, v9
v_fma_f32 v9, -v8, v8, v9
v_max_f32 v9, 0, v9
v_add_f32 v12, 0x3727c5ac, v9
v_rsq_f32 v80, v12
v_fma_f32 v10, v8, v11, v10
v_mul_f32 v12, v80, v10
v_max_u32 v12, 1, v12
v_add_u32 v7, s34, v3
v_mov_b32 v6, v12
s_nop 1
v_max_f32_dpp v6, v6, v6 row_ror:1 row_mask:0xf bank_mask:0xf
s_nop 1
v_max_f32_dpp v6, v6, v6 row_ror:2 row_mask:0xf bank_mask:0xf
s_nop 1
v_max_f32_dpp v6, v6, v6 row_ror:4 row_mask:0xf bank_mask:0xf
s_nop 1
v_max_f32_dpp v6, v6, v6 row_ror:8 row_mask:0xf bank_mask:0xf
v_mov_b32 v11, v6
s_nop 1
v_permlane16_swap_b32 v11, v6
v_max_f32 v6, v6, v11
v_cmp_eq_f32 vcc, v6, v12
s_ff1_i32_b64 s66, vcc
s_and_b32 s66, s66, 31
s_mov_b64 exec, 1
ds_write_b32 v7, v6 offset:256
s_mov_b64 exec, -1
v_add_u32 v7, s34, v1
v_mul_f32 v81, v8, v80
v_add_f32 v10, 1.0, v80
v_mov_b32 v82, v80
v_mov_b32 v83, v81
s_and_b32 s67, s66, 15
s_lshl_b32 s67, 0x10001, s67
s_bitcmp0_b32 s66, 4
v_permlane16_swap_b32 v80, v82
v_permlane16_swap_b32 v81, v83
s_cselect_b32 s76, s67, 0
s_cselect_b32 s78, 0, s67
s_cselect_b32 s77, s67, 0
s_cselect_b32 s79, 0, s67
s_add_u32 s75, s75, s66
v_pk_fma_f32 v[48:49], v[16:17], v[80:81], v[80:81] op_sel:[0,0,1] op_sel_hi:[1,0,1]
v_pk_fma_f32 v[50:51], v[18:19], v[80:81], v[80:81] op_sel:[0,0,1] op_sel_hi:[1,0,1]
v_pk_fma_f32 v[52:53], v[20:21], v[80:81], v[80:81] op_sel:[0,0,1] op_sel_hi:[1,0,1]
v_pk_fma_f32 v[54:55], v[22:23], v[80:81], v[80:81] op_sel:[0,0,1] op_sel_hi:[1,0,1]
v_pk_fma_f32 v[56:57], v[24:25], v[80:81], v[80:81] op_sel:[0,0,1] op_sel_hi:[1,0,1]
v_pk_fma_f32 v[58:59], v[26:27], v[80:81], v[80:81] op_sel:[0,0,1] op_sel_hi:[1,0,1]
v_pk_fma_f32 v[60:61], v[28:29], v[80:81], v[80:81] op_sel:[0,0,1] op_sel_hi:[1,0,1]
v_pk_fma_f32 v[62:63], v[30:31], v[80:81], v[80:81] op_sel:[0,0,1] op_sel_hi:[1,0,1]
v_pk_fma_f32 v[64:65], v[32:33], v[82:83], v[82:83] op_sel:[0,0,1] op_sel_hi:[1,0,1]
v_pk_fma_f32 v[66:67], v[34:35], v[82:83], v[82:83] op_sel:[0,0,1] op_sel_hi:[1,0,1]
v_pk_fma_f32 v[68:69], v[36:37], v[82:83], v[82:83] op_sel:[0,0,1] op_sel_hi:[1,0,1]
v_pk_fma_f32 v[70:71], v[38:39], v[82:83], v[82:83] op_sel:[0,0,1] op_sel_hi:[1,0,1]
v_pk_fma_f32 v[72:73], v[40:41], v[82:83], v[82:83] op_sel:[0,0,1] op_sel_hi:[1,0,1]
v_pk_fma_f32 v[74:75], v[42:43], v[82:83], v[82:83] op_sel:[0,0,1] op_sel_hi:[1,0,1]
v_pk_fma_f32 v[76:77], v[44:45], v[82:83], v[82:83] op_sel:[0,0,1] op_sel_hi:[1,0,1]
v_pk_fma_f32 v[78:79], v[46:47], v[82:83], v[82:83] op_sel:[0,0,1] op_sel_hi:[1,0,1]
v_cvt_pk_bf16_f32 v84, v48, v49
v_cvt_pk_bf16_f32 v85, v50, v51
v_cvt_pk_bf16_f32 v86, v52, v53
v_cvt_pk_bf16_f32 v87, v54, v55
v_cvt_pk_bf16_f32 v88, v56, v57
v_cvt_pk_bf16_f32 v89, v58, v59
v_cvt_pk_bf16_f32 v90, v60, v61
v_cvt_pk_bf16_f32 v91, v62, v63
v_cvt_pk_bf16_f32 v92, v64, v65
v_cvt_pk_bf16_f32 v93, v66, v67
v_cvt_pk_bf16_f32 v94, v68, v69
v_cvt_pk_bf16_f32 v95, v70, v71
v_cvt_pk_bf16_f32 v96, v72, v73
v_cvt_pk_bf16_f32 v97, v74, v75
v_cvt_pk_bf16_f32 v98, v76, v77
v_cvt_pk_bf16_f32 v99, v78, v79
ds_read_b32 v11, v7 offset:256
v_max_u32 v84, 1, v84
v_max_u32 v85, 1, v85
v_max_u32 v86, 1, v86
v_max_u32 v87, 1, v87
v_max_u32 v88, 1, v88
v_max_u32 v89, 1, v89
v_max_u32 v90, 1, v90
v_max_u32 v91, 1, v91
v_max_u32 v92, 1, v92
v_max_u32 v93, 1, v93
v_max_u32 v94, 1, v94
v_max_u32 v95, 1, v95
v_max_u32 v96, 1, v96
v_max_u32 v97, 1, v97
v_max_u32 v98, 1, v98
v_max_u32 v99, 1, v99
s_branch pchk_182
poll_181:
ds_read_b32 v11, v7 offset:256
pchk_182:
s_waitcnt lgkmcnt(0)
v_cmp_eq_u32 vcc, 0, v11
s_cbranch_vccz pdone_183
s_sub_u32 s32, s32, 1
s_cmp_gt_i32 s32, 0
s_cbranch_scc1 poll_181
pdone_183:
v_cmp_eq_f32 vcc, v11, v6
s_bfm_b32 s67, s58, 0
s_and_b32 s67, s67, vcc_lo
v_cmp_gt_f32 vcc, v11, v6
s_lshl_b32 s66, 1, s66
s_or_b32 s67, s67, vcc_lo
s_cselect_b64 s[76:77], 0, s[76:77]
s_cselect_b64 s[78:79], 0, s[78:79]
s_cselect_b64 exec, 0, s[66:67]
s_bitcmp0_b32 s62, 0
s_cselect_b64 exec, exec, 0
buffer_store_dwordx2 v[12:13], off, s[24:27], s72 sc1
s_mov_b64 exec, s[76:77]
buffer_store_dwordx4 v[84:87], v4, s[24:27], s68 offen offset:0 sc1
buffer_store_dwordx4 v[88:91], v4, s[24:27], s68 offen offset:16 sc1
s_mov_b64 exec, s[78:79]
buffer_store_dwordx4 v[92:95], v4, s[24:27], s68 offen offset:0 sc1
buffer_store_dwordx4 v[96:99], v4, s[24:27], s68 offen offset:16 sc1
s_mov_b64 exec, -1
v_add_u32 v5, s34, 24
s_mov_b64 exec, 1
ds_write_b32 v3, v5
s_mov_b64 exec, -1
v_pk_add_f32 v[16:17], v[16:17], v[48:49]
v_pk_add_f32 v[18:19], v[18:19], v[50:51]
v_pk_add_f32 v[20:21], v[20:21], v[52:53]
v_pk_add_f32 v[22:23], v[22:23], v[54:55]
v_pk_add_f32 v[24:25], v[24:25], v[56:57]
v_pk_add_f32 v[26:27], v[26:27], v[58:59]
v_pk_add_f32 v[28:29], v[28:29], v[60:61]
v_pk_add_f32 v[30:31], v[30:31], v[62:63]
v_pk_add_f32 v[32:33], v[32:33], v[64:65]
v_pk_add_f32 v[34:35], v[34:35], v[66:67]
v_pk_add_f32 v[36:37], v[36:37], v[68:69]
v_pk_add_f32 v[38:39], v[38:39], v[70:71]
v_pk_add_f32 v[40:41], v[40:41], v[72:73]
v_pk_add_f32 v[42:43], v[42:43], v[74:75]
v_pk_add_f32 v[44:45], v[44:45], v[76:77]
v_pk_add_f32 v[46:47], v[46:47], v[78:79]
v_cvt_pk_bf16_f32 v240, v16, v17
v_cvt_pk_bf16_f32 v241, v18, v19
v_cvt_pk_bf16_f32 v242, v20, v21
v_cvt_pk_bf16_f32 v243, v22, v23
v_cvt_pk_bf16_f32 v244, v24, v25
v_cvt_pk_bf16_f32 v245, v26, v27
v_cvt_pk_bf16_f32 v246, v28, v29
v_cvt_pk_bf16_f32 v247, v30, v31
v_cvt_pk_bf16_f32 v248, v32, v33
v_cvt_pk_bf16_f32 v249, v34, v35
v_cvt_pk_bf16_f32 v250, v36, v37
v_cvt_pk_bf16_f32 v251, v38, v39
v_cvt_pk_bf16_f32 v252, v40, v41
v_cvt_pk_bf16_f32 v253, v42, v43
v_cvt_pk_bf16_f32 v254, v44, v45
v_cvt_pk_bf16_f32 v255, v46, v47
v_max_u32 v16, 1, v16
v_max_u32 v17, 1, v17
v_max_u32 v18, 1, v18
v_max_u32 v19, 1, v19
v_max_u32 v20, 1, v20
v_max_u32 v21, 1, v21
v_max_u32 v22, 1, v22
v_max_u32 v23, 1, v23
v_max_u32 v24, 1, v24
v_max_u32 v25, 1, v25
v_max_u32 v26, 1, v26
v_max_u32 v27, 1, v27
v_max_u32 v28, 1, v28
v_max_u32 v29, 1, v29
v_max_u32 v30, 1, v30
v_max_u32 v31, 1, v31
v_max_u32 v32, 1, v32
v_max_u32 v33, 1, v33
v_max_u32 v34, 1, v34
v_max_u32 v35, 1, v35
v_max_u32 v36, 1, v36
v_max_u32 v37, 1, v37
v_max_u32 v38, 1, v38
v_max_u32 v39, 1, v39
v_max_u32 v40, 1, v40
v_max_u32 v41, 1, v41
v_max_u32 v42, 1, v42
v_max_u32 v43, 1, v43
v_max_u32 v44, 1, v44
v_max_u32 v45, 1, v45
v_max_u32 v46, 1, v46
v_max_u32 v47, 1, v47
s_mov_b64 exec, s[76:77]
buffer_store_dwordx4 v[16:19], v15, s[24:27], s69 offen offset:0 sc1
buffer_store_dwordx4 v[20:23], v15, s[24:27], s69 offen offset:64 sc1
buffer_store_dwordx4 v[24:27], v15, s[24:27], s69 offen offset:128 sc1
buffer_store_dwordx4 v[28:31], v15, s[24:27], s69 offen offset:192 sc1
s_mov_b64 exec, s[78:79]
buffer_store_dwordx4 v[32:35], v15, s[24:27], s69 offen offset:0 sc1
buffer_store_dwordx4 v[36:39], v15, s[24:27], s69 offen offset:64 sc1
buffer_store_dwordx4 v[40:43], v15, s[24:27], s69 offen offset:128 sc1
buffer_store_dwordx4 v[44:47], v15, s[24:27], s69 offen offset:192 sc1
s_mov_b64 exec, -1
s_cmp_eq_u32 s63, 0
s_cbranch_scc0 mout_184
v_mul_f32 v11, v10, v10
v_mov_b32 v12, 0x3727c5ac
v_fma_f32 v11, v11, v9, v12
v_rsq_f32 v11, v11
v_lshrrev_b32 v12, 3, v0
v_lshlrev_b32 v12, 6, v12
v_lshl_add_u32 v12, v0, 3, v12
v_mul_f32 v10, v10, v11
v_mul_f32 v11, v8, v10
s_lshl_b32 s66, s61, 5
s_add_u32 s66, s66, s58
s_lshl_b32 s66, s66, 9
s_add_u32 s66, s66, 1675264
v_max_u32 v11, 1, v11
s_cmp_eq_u32 s62, 8
s_cselect_b32 exec_lo, -1, 0
s_mov_b32 exec_hi, 0
s_cmp_eq_u32 s57, 0
s_cbranch_scc1 far_185
buffer_store_dwordx2 v[10:11], v12, s[24:27], s66 offen
near_186:
s_mov_b64 exec, -1
s_mov_b32 s63, 1
s_mov_b32 s34, 32
s_add_u32 s24, s24, 1409024
s_addc_u32 s25, s25, 0
s_mov_b32 s26, 1409024
s_branch L_mtop
mout_184:
v_permlane16_swap_b32 v240, v242
v_permlane16_swap_b32 v241, v243
v_permlane16_swap_b32 v244, v246
v_permlane16_swap_b32 v245, v247
v_permlane16_swap_b32 v248, v250
v_permlane16_swap_b32 v249, v251
v_permlane16_swap_b32 v252, v254
v_permlane16_swap_b32 v253, v255
s_not_b64 exec, s[76:77]
buffer_store_dwordx4 v[240:243], v14, s[28:31], s70 offen offset:0
buffer_store_dwordx4 v[244:247], v14, s[28:31], s70 offen offset:64
s_not_b64 exec, s[78:79]
buffer_store_dwordx4 v[248:251], v14, s[28:31], s71 offen offset:0
buffer_store_dwordx4 v[252:255], v14, s[28:31], s71 offen offset:64
s_mov_b64 exec, -1
s_or_b32 s66, s76, s78
s_cbranch_scc0 L_end
v_mov_b32 v11, 0
s_add_u32 s35, s34, 4
lw_187:
ds_read_b32 v5, v2 offset:24
s_waitcnt lgkmcnt(0)
v_cmp_gt_i32 vcc, s35, v5
s_cbranch_vccz lwd_188
s_sleep 2
s_sub_u32 s32, s32, 1
s_cmp_gt_i32 s32, 0
s_cbranch_scc1 lw_187
lwd_188:
ds_read_b32 v11, v11 offset:32
s_waitcnt lgkmcnt(0)
v_cmp_eq_u32 vcc, s75, v11
s_cbranch_vccnz L_end
s_mov_b64 exec, s[76:77]
buffer_store_dwordx4 v[240:243], v14, s[28:31], s70 offen offset:0
buffer_store_dwordx4 v[244:247], v14, s[28:31], s70 offen offset:64
s_mov_b64 exec, s[78:79]
buffer_store_dwordx4 v[248:251], v14, s[28:31], s71 offen offset:0
buffer_store_dwordx4 v[252:255], v14, s[28:31], s71 offen offset:64
s_mov_b64 exec, -1
s_branch L_end
mspin_132:
ds_read_b32 v5, v2 offset:16
s_waitcnt lgkmcnt(0)
v_cmp_ge_u32 vcc, v4, v5
s_cbranch_vccz mback_133
s_sub_u32 s32, s32, 1
s_cmp_gt_i32 s32, 0
s_cbranch_scc1 mspin_132
s_branch mback_133
mspin_130:
msp_189:
ds_read_b32 v5, v2 offset:16
s_waitcnt lgkmcnt(0)
v_cmp_ge_u32 vcc, v4, v5
s_cbranch_vccz mback_131
s_sub_u32 s32, s32, 1
s_cmp_gt_i32 s32, 0
s_cbranch_scc1 msp_189
s_branch mback_131
lspin_134:
s_add_u32 s35, s34, 2
lw_190:
ds_read_b32 v5, v2 offset:24
s_waitcnt lgkmcnt(0)
v_cmp_gt_i32 vcc, s35, v5
s_cbranch_vccz lwd_191
s_sub_u32 s32, s32, 1
s_cmp_gt_i32 s32, 0
s_cbranch_scc1 lw_190
lwd_191:
s_branch lback_135
patch_136:
s_bfe_u32 s66, s33, 0x20005
s_lshr_b32 s67, s66, 1
s_xor_b32 s66, s66, s67
s_and_b32 s66, s66, 1
s_cmp_eq_u32 s66, s65
s_cbranch_scc0 pback_137
s_bfe_u32 s66, s33, 0x10004
s_lshl1_add_u32 s73, s67, s66
s_and_b32 s66, s33, 15
s_mov_b32 s74, 0x10001
s_mov_b32 s75, s74
s_lshl_b64 s[74:75], s[74:75], s66
s_and_b32 s66, s66, 12
s_lshl_b32 s66, s66, 2
s_bfm_b64 s[76:77], 16, s66
s_nop 7
s_mov_b64 exec, s[74:75]
s_cmp_eq_u32 s73, 0
s_cbranch_scc0 pnx_193
ds_read_b128 v[16:19], v211 offset:3456
ds_read_b128 v[20:23], v211 offset:3520
s_branch pdn_192
pnx_193:
s_cmp_eq_u32 s73, 1
s_cbranch_scc0 pnx_194
ds_read_b128 v[24:27], v211 offset:3456
ds_read_b128 v[28:31], v211 offset:3520
s_branch pdn_192
pnx_194:
s_cmp_eq_u32 s73, 2
s_cbranch_scc0 pnx_195
ds_read_b128 v[32:35], v211 offset:3456
ds_read_b128 v[36:39], v211 offset:3520
s_branch pdn_192
pnx_195:
ds_read_b128 v[40:43], v211 offset:3456
ds_read_b128 v[44:47], v211 offset:3520
pdn_192:
s_mov_b64 exec, -1
s_waitcnt lgkmcnt(0)
s_branch pback_137
patch_138:
s_nop 7
s_nop 7
s_and_b32 s66, s33, 3
s_lshl2_add_u32 s66, s73, s66
s_mov_b64 exec, s[76:77]
s_cmp_eq_u32 s66, 0
s_cbranch_scc0 pnx_198
ds_read_b32 v48, v210 offset:3584
ds_read_b32 v52, v210 offset:3648
s_branch pdn_197
pnx_198:
s_cmp_eq_u32 s66, 1
s_cbranch_scc0 pnx_199
ds_read_b32 v49, v210 offset:3584
ds_read_b32 v53, v210 offset:3648
s_branch pdn_197
pnx_199:
s_cmp_eq_u32 s66, 2
s_cbranch_scc0 pnx_200
ds_read_b32 v50, v210 offset:3584
ds_read_b32 v54, v210 offset:3648
s_branch pdn_197
pnx_200:
s_cmp_eq_u32 s66, 3
s_cbranch_scc0 pnx_201
ds_read_b32 v51, v210 offset:3584
ds_read_b32 v55, v210 offset:3648
s_branch pdn_197
pnx_201:
s_cmp_eq_u32 s66, 4
s_cbranch_scc0 pnx_202
ds_read_b32 v56, v210 offset:3584
ds_read_b32 v60, v210 offset:3648
s_branch pdn_197
pnx_202:
s_cmp_eq_u32 s66, 5
s_cbranch_scc0 pnx_203
ds_read_b32 v57, v210 offset:3584
ds_read_b32 v61, v210 offset:3648
s_branch pdn_197
pnx_203:
s_cmp_eq_u32 s66, 6
s_cbranch_scc0 pnx_204
ds_read_b32 v58, v210 offset:3584
ds_read_b32 v62, v210 offset:3648
s_branch pdn_197
pnx_204:
s_cmp_eq_u32 s66, 7
s_cbranch_scc0 pnx_205
ds_read_b32 v59, v210 offset:3584
ds_read_b32 v63, v210 offset:3648
s_branch pdn_197
pnx_205:
s_cmp_eq_u32 s66, 8
s_cbranch_scc0 pnx_206
ds_read_b32 v64, v210 offset:3584
ds_read_b32 v68, v210 offset:3648
s_branch pdn_197
pnx_206:
s_cmp_eq_u32 s66, 9
s_cbranch_scc0 pnx_207
ds_read_b32 v65, v210 offset:3584
ds_read_b32 v69, v210 offset:3648
s_branch pdn_197
pnx_207:
s_cmp_eq_u32 s66, 10
s_cbranch_scc0 pnx_208
ds_read_b32 v66, v210 offset:3584
ds_read_b32 v70, v210 offset:3648
s_branch pdn_197
pnx_208:
s_cmp_eq_u32 s66, 11
s_cbranch_scc0 pnx_209
ds_read_b32 v67, v210 offset:3584
ds_read_b32 v71, v210 offset:3648
s_branch pdn_197
pnx_209:
s_cmp_eq_u32 s66, 12
s_cbranch_scc0 pnx_210
ds_read_b32 v72, v210 offset:3584
ds_read_b32 v76, v210 offset:3648
s_branch pdn_197
pnx_210:
s_cmp_eq_u32 s66, 13
s_cbranch_scc0 pnx_211
ds_read_b32 v73, v210 offset:3584
ds_read_b32 v77, v210 offset:3648
s_branch pdn_197
pnx_211:
s_cmp_eq_u32 s66, 14
s_cbranch_scc0 pnx_212
ds_read_b32 v74, v210 offset:3584
ds_read_b32 v78, v210 offset:3648
s_branch pdn_197
pnx_212:
ds_read_b32 v75, v210 offset:3584
ds_read_b32 v79, v210 offset:3648
pdn_197:
s_mov_b64 exec, -1
s_waitcnt lgkmcnt(0)
s_branch pback_139
patch_140:
s_nop 7
s_nop 7
s_mov_b64 exec, s[74:75]
s_cmp_eq_u32 s73, 0
s_cbranch_scc0 pnx_215
ds_read_b128 v[80:83], v211 offset:3328
ds_read_b128 v[84:87], v211 offset:3392
s_branch pdn_214
pnx_215:
s_cmp_eq_u32 s73, 1
s_cbranch_scc0 pnx_216
ds_read_b128 v[88:91], v211 offset:3328
ds_read_b128 v[92:95], v211 offset:3392
s_branch pdn_214
pnx_216:
s_cmp_eq_u32 s73, 2
s_cbranch_scc0 pnx_217
ds_read_b128 v[96:99], v211 offset:3328
ds_read_b128 v[100:103], v211 offset:3392
s_branch pdn_214
pnx_217:
ds_read_b128 v[104:107], v211 offset:3328
ds_read_b128 v[108:111], v211 offset:3392
pdn_214:
s_mov_b64 exec, -1
s_waitcnt lgkmcnt(0)
s_branch pback_141
cross_151:
s_cmp_eq_u32 s67, 122880
s_cbranch_scc0 cr2_219
v_add_u32 v5, s34, 18
s_mov_b64 exec, 1
ds_write_b32 v3, v5
s_mov_b64 exec, -1
v_mov_b32 v9, 0xf149f2ca
v_xor_b32 v216, v9, v216
v_xor_b32 v217, v9, v217
v_xor_b32 v218, v9, v218
v_xor_b32 v219, v9, v219
v_xor_b32 v220, v9, v220
v_xor_b32 v221, v9, v221
v_xor_b32 v222, v9, v222
v_xor_b32 v223, v9, v223
v_xor_b32 v224, v9, v224
v_xor_b32 v225, v9, v225
v_xor_b32 v226, v9, v226
v_xor_b32 v227, v9, v227
v_xor_b32 v228, v9, v228
v_xor_b32 v229, v9, v229
v_xor_b32 v230, v9, v230
v_xor_b32 v231, v9, v231
s_mov_b32 s67, 114688
s_cmp_eq_u32 s63, 0
s_cbranch_scc0 cr3_220
v_and_b32 v9, 15, v0
v_lshlrev_b32 v9, 11, v9
v_bfe_u32 v10, v0, 4, 1
v_lshl_add_u32 v9, v10, 5, v9
v_lshrrev_b32 v10, 5, v0
v_lshl_add_u32 v9, v10, 4, v9
s_lshl2_add_u32 s70, s61, s58
s_lshl_b32 s70, s70, 16
s_lshl_b32 s71, s62, 7
s_add_u32 s70, s70, s71
s_add_u32 s71, s70, 0x8000
buffer_load_dwordx4 v[240:243], v9, s[8:11], s70 offen offset:0
buffer_load_dwordx4 v[244:247], v9, s[8:11], s70 offen offset:64
buffer_load_dwordx4 v[248:251], v9, s[8:11], s71 offen offset:0
buffer_load_dwordx4 v[252:255], v9, s[8:11], s71 offen offset:64
cr3_220:
s_cmp_eq_u32 s59, 0
s_cbranch_scc1 cback_152
v_mov_b32 v9, 0
s_add_u32 s35, s34, 18
lw_221:
ds_read_b32 v5, v9 offset:16
s_waitcnt lgkmcnt(0)
v_cmp_gt_i32 vcc, s35, v5
s_cbranch_vccz lwd_222
s_sub_u32 s32, s32, 1
s_cmp_gt_i32 s32, 0
s_cbranch_scc1 lw_221
lwd_222:
s_branch cback_152
cr2_219:
s_cmp_eq_u32 s67, 114688
s_cbranch_scc0 cr4_223
s_mov_b32 s67, 90112
s_add_u32 s35, s34, 21
lw_224:
ds_read_b32 v5, v9 offset:16
s_waitcnt lgkmcnt(0)
v_cmp_gt_i32 vcc, s35, v5
s_cbranch_vccz lwd_225
s_sub_u32 s32, s32, 1
s_cmp_gt_i32 s32, 0
s_cbranch_scc1 lw_224
lwd_225:
s_branch cback_152
cr4_223:
v_add_u32 v5, s34, 19
s_mov_b64 exec, 1
ds_write_b32 v3, v5
s_mov_b64 exec, -1
s_mov_b32 s66, 28672
s_cmp_lt_u32 s59, 2
s_cbranch_scc1 cback_152
s_add_u32 s35, s34, 21
lw_226:
ds_read_b32 v5, v2 offset:16
s_waitcnt lgkmcnt(0)
v_cmp_gt_i32 vcc, s35, v5
s_cbranch_vccz lwd_227
s_sub_u32 s32, s32, 1
s_cmp_gt_i32 s32, 0
s_cbranch_scc1 lw_226
lwd_227:
s_branch cback_152
cross_153:
s_cmp_eq_u32 s67, 122880
s_cbranch_scc0 cr2_228
s_waitcnt lgkmcnt(1)
v_add_u32 v5, s34, 18
s_mov_b64 exec, 1
ds_write_b32 v3, v5
s_mov_b64 exec, -1
v_mov_b32 v9, 0xf149f2ca
v_xor_b32 v216, v9, v216
v_xor_b32 v217, v9, v217
v_xor_b32 v218, v9, v218
v_xor_b32 v219, v9, v219
v_xor_b32 v220, v9, v220
v_xor_b32 v221, v9, v221
v_xor_b32 v222, v9, v222
v_xor_b32 v223, v9, v223
v_xor_b32 v224, v9, v224
v_xor_b32 v225, v9, v225
v_xor_b32 v226, v9, v226
v_xor_b32 v227, v9, v227
v_xor_b32 v228, v9, v228
v_xor_b32 v229, v9, v229
v_xor_b32 v230, v9, v230
v_xor_b32 v231, v9, v231
s_mov_b32 s67, 114688
s_cmp_eq_u32 s63, 0
s_cbranch_scc0 cr3_229
v_and_b32 v9, 15, v0
v_lshlrev_b32 v9, 11, v9
v_bfe_u32 v10, v0, 4, 1
v_lshl_add_u32 v9, v10, 5, v9
v_lshrrev_b32 v10, 5, v0
v_lshl_add_u32 v9, v10, 4, v9
s_lshl2_add_u32 s70, s61, s58
s_lshl_b32 s70, s70, 16
s_lshl_b32 s71, s62, 7
s_add_u32 s70, s70, s71
s_add_u32 s71, s70, 0x8000
buffer_load_dwordx4 v[240:243], v9, s[8:11], s70 offen offset:0
buffer_load_dwordx4 v[244:247], v9, s[8:11], s70 offen offset:64
buffer_load_dwordx4 v[248:251], v9, s[8:11], s71 offen offset:0
buffer_load_dwordx4 v[252:255], v9, s[8:11], s71 offen offset:64
cr3_229:
s_cmp_eq_u32 s59, 0
s_cbranch_scc1 cback_154
v_mov_b32 v9, 0
s_add_u32 s35, s34, 18
lw_230:
ds_read_b32 v5, v9 offset:16
s_waitcnt lgkmcnt(0)
v_cmp_gt_i32 vcc, s35, v5
s_cbranch_vccz lwd_231
s_sub_u32 s32, s32, 1
s_cmp_gt_i32 s32, 0
s_cbranch_scc1 lw_230
lwd_231:
s_branch cback_154
cr2_228:
s_waitcnt lgkmcnt(1)
v_cmp_gt_i32 vcc, s35, v5
s_cmp_eq_u32 s67, 114688
s_cbranch_scc0 cr4_232
s_mov_b32 s67, 90112
s_bitcmp0_b32 vcc_lo, 0
s_cbranch_scc1 cback_154
s_add_u32 s35, s34, 21
lw_233:
ds_read_b32 v5, v9 offset:16
s_waitcnt lgkmcnt(0)
v_cmp_gt_i32 vcc, s35, v5
s_cbranch_vccz lwd_234
s_sub_u32 s32, s32, 1
s_cmp_gt_i32 s32, 0
s_cbranch_scc1 lw_233
lwd_234:
s_branch cback_154
cr4_232:
v_add_u32 v5, s34, 19
s_mov_b64 exec, 1
ds_write_b32 v3, v5
s_mov_b64 exec, -1
s_mov_b32 s66, 28672
s_cmp_lt_u32 s59, 2
s_cbranch_scc1 cback_154
s_cbranch_vccz cback_154
s_add_u32 s35, s34, 21
lw_235:
ds_read_b32 v5, v2 offset:16
s_waitcnt lgkmcnt(0)
v_cmp_gt_i32 vcc, s35, v5
s_cbranch_vccz lwd_236
s_sub_u32 s32, s32, 1
s_cmp_gt_i32 s32, 0
s_cbranch_scc1 lw_235
lwd_236:
s_branch cback_154
slow_155:
s_add_u32 s70, s72, 270336
poll_237:
buffer_load_dword v10, v1, s[24:27], s70 offen sc1
pchk_238:
s_waitcnt vmcnt(0)
v_cmp_eq_u32 vcc, 0, v10
s_cbranch_vccz pdone_239
s_sub_u32 s32, s32, 1
s_cmp_gt_i32 s32, 0
s_cbranch_scc1 poll_237
pdone_239:
s_lshl_b32 s73, s60, 15
s_lshl_b32 s74, s63, 23
s_add_u32 s73, s73, s74
s_add_u32 s73, s73, 1048576
v_mov_b32 v10, 0xf149f2ca
v_mov_b32 v11, 0
v_mov_b32 v192, 0
v_mov_b32 v193, 0
v_mov_b32 v194, 0
v_mov_b32 v195, 0
v_mov_b32 v196, 0
v_mov_b32 v197, 0
v_mov_b32 v198, 0
v_mov_b32 v199, 0
v_mov_b32 v200, 0
v_mov_b32 v201, 0
v_mov_b32 v202, 0
v_mov_b32 v203, 0
v_mov_b32 v204, 0
v_mov_b32 v205, 0
v_mov_b32 v206, 0
v_mov_b32 v207, 0
v_mov_b32 v208, 0
v_mov_b32 v209, 0
v_mov_b32 v210, 0
v_mov_b32 v211, 0
s_lshl2_add_u32 s74, s59, s65
s_mov_b32 s75, 0
sl_240:
s_lshr_b32 s76, s74, 2
s_lshl_b32 s76, s76, 19
s_and_b32 s77, s74, 3
s_lshl_b32 s77, s77, 13
s_add_u32 s76, s76, s77
s_add_u32 s76, s76, s73
buffer_load_dwordx4 v[152:155], v6, s[20:23], s76 offen offset:0 sc1
buffer_load_dwordx4 v[156:159], v6, s[20:23], s76 offen offset:1024 sc1
s_cmp_eq_u32 s75, 0
s_cselect_b32 s76, 0xf149f2ca, 0
s_and_b32 s77, s75, 7
s_cselect_b32 s77, 0, -1
v_xor_b32 v112, s76, v216
v_and_b32 v112, s77, v112
v_xor_b32 v113, s76, v217
v_and_b32 v113, s77, v113
v_xor_b32 v114, s76, v218
v_and_b32 v114, s77, v114
v_xor_b32 v115, s76, v219
v_and_b32 v115, s77, v115
v_xor_b32 v116, s76, v220
v_and_b32 v116, s77, v116
v_xor_b32 v117, s76, v221
v_and_b32 v117, s77, v117
v_xor_b32 v118, s76, v222
v_and_b32 v118, s77, v118
v_xor_b32 v119, s76, v223
v_and_b32 v119, s77, v119
v_xor_b32 v120, s76, v224
v_and_b32 v120, s77, v120
v_xor_b32 v121, s76, v225
v_and_b32 v121, s77, v121
v_xor_b32 v122, s76, v226
v_and_b32 v122, s77, v122
v_xor_b32 v123, s76, v227
v_and_b32 v123, s77, v123
v_xor_b32 v124, s76, v228
v_and_b32 v124, s77, v124
v_xor_b32 v125, s76, v229
v_and_b32 v125, s77, v125
v_xor_b32 v126, s76, v230
v_and_b32 v126, s77, v126
v_xor_b32 v127, s76, v231
v_and_b32 v127, s77, v127
s_waitcnt vmcnt(1)
s_nop 0
v_mfma_f32_32x32x16_bf16 v[112:127], v[152:155], v[80:83], v[112:127]
s_waitcnt vmcnt(0)
v_mfma_f32_32x32x16_bf16 v[112:127], v[156:159], v[88:91], v[112:127]
s_nop 11
v_max3_f32 v10, v10, v112, v113
v_max3_f32 v10, v10, v114, v115
v_max3_f32 v10, v10, v116, v117
v_max3_f32 v10, v10, v118, v119
v_max3_f32 v10, v10, v120, v121
v_max3_f32 v10, v10, v122, v123
v_max3_f32 v10, v10, v124, v125
v_max3_f32 v10, v10, v126, v127
s_add_u32 s75, s75, 1
s_sub_u32 s74, s74, 1
s_cselect_b32 s75, 9, s75
s_cmp_lt_u32 s75, 9
s_cbranch_scc1 sl_240
v_mov_b32 v11, v10
s_nop 1
v_permlane32_swap_b32 v11, v10
v_max_f32 v10, v10, v11
s_lshl2_add_u32 s74, s59, s65
s_mov_b32 s75, 0
sl_241:
s_lshr_b32 s76, s74, 2
s_lshl_b32 s76, s76, 19
s_and_b32 s77, s74, 3
s_lshl_b32 s77, s77, 13
s_add_u32 s76, s76, s77
s_add_u32 s76, s76, s73
buffer_load_dwordx4 v[152:155], v6, s[20:23], s76 offen offset:0 sc1
buffer_load_dwordx4 v[156:159], v6, s[20:23], s76 offen offset:1024 sc1
buffer_load_dwordx4 v[160:163], v6, s[20:23], s76 offen offset:2048 sc1
buffer_load_dwordx4 v[164:167], v6, s[20:23], s76 offen offset:3072 sc1
s_cmp_eq_u32 s75, 0
s_cselect_b32 s76, 0xf149f2ca, 0
s_and_b32 s77, s75, 7
s_cselect_b32 s77, 0, -1
v_xor_b32 v112, s76, v216
v_and_b32 v112, s77, v112
v_sub_f32 v112, v112, v10
v_xor_b32 v113, s76, v217
v_and_b32 v113, s77, v113
v_sub_f32 v113, v113, v10
v_xor_b32 v114, s76, v218
v_and_b32 v114, s77, v114
v_sub_f32 v114, v114, v10
v_xor_b32 v115, s76, v219
v_and_b32 v115, s77, v115
v_sub_f32 v115, v115, v10
v_xor_b32 v116, s76, v220
v_and_b32 v116, s77, v116
v_sub_f32 v116, v116, v10
v_xor_b32 v117, s76, v221
v_and_b32 v117, s77, v117
v_sub_f32 v117, v117, v10
v_xor_b32 v118, s76, v222
v_and_b32 v118, s77, v118
v_sub_f32 v118, v118, v10
v_xor_b32 v119, s76, v223
v_and_b32 v119, s77, v119
v_sub_f32 v119, v119, v10
v_xor_b32 v120, s76, v224
v_and_b32 v120, s77, v120
v_sub_f32 v120, v120, v10
v_xor_b32 v121, s76, v225
v_and_b32 v121, s77, v121
v_sub_f32 v121, v121, v10
v_xor_b32 v122, s76, v226
v_and_b32 v122, s77, v122
v_sub_f32 v122, v122, v10
v_xor_b32 v123, s76, v227
v_and_b32 v123, s77, v123
v_sub_f32 v123, v123, v10
v_xor_b32 v124, s76, v228
v_and_b32 v124, s77, v124
v_sub_f32 v124, v124, v10
v_xor_b32 v125, s76, v229
v_and_b32 v125, s77, v125
v_sub_f32 v125, v125, v10
v_xor_b32 v126, s76, v230
v_and_b32 v126, s77, v126
v_sub_f32 v126, v126, v10
v_xor_b32 v127, s76, v231
v_and_b32 v127, s77, v127
v_sub_f32 v127, v127, v10
s_waitcnt vmcnt(3)
s_nop 0
v_mfma_f32_32x32x16_bf16 v[112:127], v[152:155], v[80:83], v[112:127]
s_waitcnt vmcnt(2)
v_mfma_f32_32x32x16_bf16 v[112:127], v[156:159], v[88:91], v[112:127]
s_nop 11
v_exp_f32 v112, v112
v_exp_f32 v113, v113
v_exp_f32 v114, v114
v_exp_f32 v115, v115
v_exp_f32 v116, v116
v_exp_f32 v117, v117
v_exp_f32 v118, v118
v_exp_f32 v119, v119
v_exp_f32 v120, v120
v_exp_f32 v121, v121
v_exp_f32 v122, v122
v_exp_f32 v123, v123
v_exp_f32 v124, v124
v_exp_f32 v125, v125
v_exp_f32 v126, v126
v_exp_f32 v127, v127
v_cvt_pk_bf16_f32 v144, v112, v113
v_cvt_pk_bf16_f32 v145, v114, v115
v_cvt_pk_bf16_f32 v146, v116, v117
v_cvt_pk_bf16_f32 v147, v118, v119
v_cvt_pk_bf16_f32 v148, v120, v121
v_cvt_pk_bf16_f32 v149, v122, v123
v_cvt_pk_bf16_f32 v150, v124, v125
v_cvt_pk_bf16_f32 v151, v126, v127
s_waitcnt vmcnt(1)
v_mfma_f32_32x32x16_bf16 v[192:207], v[160:163], v[144:147], v[192:207]
v_mfma_f32_16x16x32_bf16 v[208:211], v[212:215], v[144:147], v[208:211]
s_waitcnt vmcnt(0)
v_mfma_f32_32x32x16_bf16 v[192:207], v[164:167], v[148:151], v[192:207]
v_mfma_f32_16x16x32_bf16 v[208:211], v[212:215], v[148:151], v[208:211]
s_add_u32 s75, s75, 1
s_sub_u32 s74, s74, 1
s_cselect_b32 s75, 9, s75
s_cmp_lt_u32 s75, 9
s_cbranch_scc1 sl_241
v_mov_b32 v10, 0xf149f2ca
v_mov_b32 v11, 0
v_mov_b32 v16, 0
v_mov_b32 v17, 0
v_mov_b32 v18, 0
v_mov_b32 v19, 0
v_mov_b32 v20, 0
v_mov_b32 v21, 0
v_mov_b32 v22, 0
v_mov_b32 v23, 0
v_mov_b32 v24, 0
v_mov_b32 v25, 0
v_mov_b32 v26, 0
v_mov_b32 v27, 0
v_mov_b32 v28, 0
v_mov_b32 v29, 0
v_mov_b32 v30, 0
v_mov_b32 v31, 0
v_mov_b32 v32, 0
v_mov_b32 v33, 0
v_mov_b32 v34, 0
v_mov_b32 v35, 0
s_sub_u32 s74, 3, s65
s_lshl2_add_u32 s74, s59, s74
s_mov_b32 s75, 0
sl_242:
s_lshr_b32 s76, s74, 2
s_lshl_b32 s76, s76, 19
s_and_b32 s77, s74, 3
s_lshl_b32 s77, s77, 13
s_add_u32 s76, s76, s77
s_add_u32 s76, s76, s73
buffer_load_dwordx4 v[152:155], v6, s[20:23], s76 offen offset:0 sc1
buffer_load_dwordx4 v[156:159], v6, s[20:23], s76 offen offset:1024 sc1
s_cmp_eq_u32 s75, 0
s_cselect_b32 s76, 0xf149f2ca, 0
s_and_b32 s77, s75, 7
s_cselect_b32 s77, 0, -1
v_xor_b32 v112, s76, v216
v_and_b32 v112, s77, v112
v_xor_b32 v113, s76, v217
v_and_b32 v113, s77, v113
v_xor_b32 v114, s76, v218
v_and_b32 v114, s77, v114
v_xor_b32 v115, s76, v219
v_and_b32 v115, s77, v115
v_xor_b32 v116, s76, v220
v_and_b32 v116, s77, v116
v_xor_b32 v117, s76, v221
v_and_b32 v117, s77, v117
v_xor_b32 v118, s76, v222
v_and_b32 v118, s77, v118
v_xor_b32 v119, s76, v223
v_and_b32 v119, s77, v119
v_xor_b32 v120, s76, v224
v_and_b32 v120, s77, v120
v_xor_b32 v121, s76, v225
v_and_b32 v121, s77, v121
v_xor_b32 v122, s76, v226
v_and_b32 v122, s77, v122
v_xor_b32 v123, s76, v227
v_and_b32 v123, s77, v123
v_xor_b32 v124, s76, v228
v_and_b32 v124, s77, v124
v_xor_b32 v125, s76, v229
v_and_b32 v125, s77, v125
v_xor_b32 v126, s76, v230
v_and_b32 v126, s77, v126
v_xor_b32 v127, s76, v231
v_and_b32 v127, s77, v127
s_waitcnt vmcnt(1)
s_nop 0
v_mfma_f32_32x32x16_bf16 v[112:127], v[152:155], v[96:99], v[112:127]
s_waitcnt vmcnt(0)
v_mfma_f32_32x32x16_bf16 v[112:127], v[156:159], v[104:107], v[112:127]
s_nop 11
v_max3_f32 v10, v10, v112, v113
v_max3_f32 v10, v10, v114, v115
v_max3_f32 v10, v10, v116, v117
v_max3_f32 v10, v10, v118, v119
v_max3_f32 v10, v10, v120, v121
v_max3_f32 v10, v10, v122, v123
v_max3_f32 v10, v10, v124, v125
v_max3_f32 v10, v10, v126, v127
s_add_u32 s75, s75, 1
s_sub_u32 s74, s74, 1
s_cselect_b32 s75, 9, s75
s_cmp_lt_u32 s75, 9
s_cbranch_scc1 sl_242
v_mov_b32 v11, v10
s_nop 1
v_permlane32_swap_b32 v11, v10
v_max_f32 v10, v10, v11
s_sub_u32 s74, 3, s65
s_lshl2_add_u32 s74, s59, s74
s_mov_b32 s75, 0
sl_243:
s_lshr_b32 s76, s74, 2
s_lshl_b32 s76, s76, 19
s_and_b32 s77, s74, 3
s_lshl_b32 s77, s77, 13
s_add_u32 s76, s76, s77
s_add_u32 s76, s76, s73
buffer_load_dwordx4 v[152:155], v6, s[20:23], s76 offen offset:0 sc1
buffer_load_dwordx4 v[156:159], v6, s[20:23], s76 offen offset:1024 sc1
buffer_load_dwordx4 v[160:163], v6, s[20:23], s76 offen offset:2048 sc1
buffer_load_dwordx4 v[164:167], v6, s[20:23], s76 offen offset:3072 sc1
s_cmp_eq_u32 s75, 0
s_cselect_b32 s76, 0xf149f2ca, 0
s_and_b32 s77, s75, 7
s_cselect_b32 s77, 0, -1
v_xor_b32 v112, s76, v216
v_and_b32 v112, s77, v112
v_sub_f32 v112, v112, v10
v_xor_b32 v113, s76, v217
v_and_b32 v113, s77, v113
v_sub_f32 v113, v113, v10
v_xor_b32 v114, s76, v218
v_and_b32 v114, s77, v114
v_sub_f32 v114, v114, v10
v_xor_b32 v115, s76, v219
v_and_b32 v115, s77, v115
v_sub_f32 v115, v115, v10
v_xor_b32 v116, s76, v220
v_and_b32 v116, s77, v116
v_sub_f32 v116, v116, v10
v_xor_b32 v117, s76, v221
v_and_b32 v117, s77, v117
v_sub_f32 v117, v117, v10
v_xor_b32 v118, s76, v222
v_and_b32 v118, s77, v118
v_sub_f32 v118, v118, v10
v_xor_b32 v119, s76, v223
v_and_b32 v119, s77, v119
v_sub_f32 v119, v119, v10
v_xor_b32 v120, s76, v224
v_and_b32 v120, s77, v120
v_sub_f32 v120, v120, v10
v_xor_b32 v121, s76, v225
v_and_b32 v121, s77, v121
v_sub_f32 v121, v121, v10
v_xor_b32 v122, s76, v226
v_and_b32 v122, s77, v122
v_sub_f32 v122, v122, v10
v_xor_b32 v123, s76, v227
v_and_b32 v123, s77, v123
v_sub_f32 v123, v123, v10
v_xor_b32 v124, s76, v228
v_and_b32 v124, s77, v124
v_sub_f32 v124, v124, v10
v_xor_b32 v125, s76, v229
v_and_b32 v125, s77, v125
v_sub_f32 v125, v125, v10
v_xor_b32 v126, s76, v230
v_and_b32 v126, s77, v126
v_sub_f32 v126, v126, v10
v_xor_b32 v127, s76, v231
v_and_b32 v127, s77, v127
v_sub_f32 v127, v127, v10
s_waitcnt vmcnt(3)
s_nop 0
v_mfma_f32_32x32x16_bf16 v[112:127], v[152:155], v[96:99], v[112:127]
s_waitcnt vmcnt(2)
v_mfma_f32_32x32x16_bf16 v[112:127], v[156:159], v[104:107], v[112:127]
s_nop 11
v_exp_f32 v112, v112
v_exp_f32 v113, v113
v_exp_f32 v114, v114
v_exp_f32 v115, v115
v_exp_f32 v116, v116
v_exp_f32 v117, v117
v_exp_f32 v118, v118
v_exp_f32 v119, v119
v_exp_f32 v120, v120
v_exp_f32 v121, v121
v_exp_f32 v122, v122
v_exp_f32 v123, v123
v_exp_f32 v124, v124
v_exp_f32 v125, v125
v_exp_f32 v126, v126
v_exp_f32 v127, v127
v_cvt_pk_bf16_f32 v144, v112, v113
v_cvt_pk_bf16_f32 v145, v114, v115
v_cvt_pk_bf16_f32 v146, v116, v117
v_cvt_pk_bf16_f32 v147, v118, v119
v_cvt_pk_bf16_f32 v148, v120, v121
v_cvt_pk_bf16_f32 v149, v122, v123
v_cvt_pk_bf16_f32 v150, v124, v125
v_cvt_pk_bf16_f32 v151, v126, v127
s_waitcnt vmcnt(1)
v_mfma_f32_32x32x16_bf16 v[16:31], v[160:163], v[144:147], v[16:31]
v_mfma_f32_16x16x32_bf16 v[32:35], v[212:215], v[144:147], v[32:35]
s_waitcnt vmcnt(0)
v_mfma_f32_32x32x16_bf16 v[16:31], v[164:167], v[148:151], v[16:31]
v_mfma_f32_16x16x32_bf16 v[32:35], v[212:215], v[148:151], v[32:35]
s_add_u32 s75, s75, 1
s_sub_u32 s74, s74, 1
s_cselect_b32 s75, 9, s75
s_cmp_lt_u32 s75, 9
s_cbranch_scc1 sl_243
s_branch sback_156
far_157:
buffer_store_dwordx4 v[16:19], v9, s[20:23], s67 offen offset:0 sc1
buffer_store_dwordx4 v[20:23], v9, s[20:23], s67 offen offset:1024 sc1
s_branch near_158
far_159:
buffer_store_dwordx4 v[192:195], v9, s[20:23], s66 offen offset:0 sc1
buffer_store_dwordx4 v[196:199], v9, s[20:23], s66 offen offset:1024 sc1
s_branch near_160
far_163:
buffer_store_dword v212, v3, s[24:27], s70 offen sc1
s_branch near_164
mo_165:
s_lshr_b32 s67, s33, 5
s_cmp_eq_u32 s67, s66
s_cbranch_scc0 mo_166
s_and_b32 s67, s33, 31
v_sub_u32 v48, s67, v48
v_lshlrev_b32 v49, 4, v49
s_lshl_b32 s67, s62, 14
s_add_u32 s67, s67, 30686208
poll_244:
buffer_load_dwordx4 v[56:59], v49, s[20:23], s67 offen offset:0 sc1
buffer_load_dwordx4 v[60:63], v49, s[20:23], s67 offen offset:64 sc1
pchk_245:
s_waitcnt vmcnt(1)
v_min3_u32 v50, v56, v57, v58
s_waitcnt vmcnt(0)
v_min3_u32 v50, v50, v59, v60
v_min3_u32 v50, v50, v61, v62
v_min_u32 v50, v50, v63
v_cmp_eq_u32 vcc, 0, v50
s_cbranch_vccz pdone_246
s_sub_u32 s32, s32, 1
s_cmp_gt_i32 s32, 0
s_cbranch_scc1 poll_244
pdone_246:
v_cmp_eq_u32 vcc, 0, v48
s_nop 1
v_cndmask_b32 v240, v240, v56, vcc
v_cndmask_b32 v241, v241, v57, vcc
v_cndmask_b32 v242, v242, v58, vcc
v_cndmask_b32 v243, v243, v59, vcc
v_cndmask_b32 v244, v244, v60, vcc
v_cndmask_b32 v245, v245, v61, vcc
v_cndmask_b32 v246, v246, v62, vcc
v_cndmask_b32 v247, v247, v63, vcc
v_cmp_eq_u32 vcc, 16, v48
s_nop 1
v_cndmask_b32 v248, v248, v56, vcc
v_cndmask_b32 v249, v249, v57, vcc
v_cndmask_b32 v250, v250, v58, vcc
v_cndmask_b32 v251, v251, v59, vcc
v_cndmask_b32 v252, v252, v60, vcc
v_cndmask_b32 v253, v253, v61, vcc
v_cndmask_b32 v254, v254, v62, vcc
v_cndmask_b32 v255, v255, v63, vcc
s_branch mo_166
far_169:
buffer_store_dwordx4 v[240:243], v6, s[20:23], s68 offen offset:0 sc1
buffer_store_dwordx4 v[244:247], v6, s[20:23], s68 offen offset:1024 sc1
buffer_store_dwordx4 v[248:251], v6, s[20:23], s68 offen offset:2048 sc1
buffer_store_dwordx4 v[252:255], v6, s[20:23], s68 offen offset:3072 sc1
s_branch near_170
far_171:
buffer_store_dwordx4 v[8:11], v6, s[24:27], s67 offen sc1
s_branch near_172
far_173:
buffer_store_dword v212, v3, s[24:27], s66 offen sc1
s_branch near_174
far_185:
buffer_store_dwordx2 v[10:11], v12, s[24:27], s66 offen sc1
s_branch near_186
L_end:
L_fin:
s_endpgm
.section .rodata,"a"
.p2align 6
.amdhsa_kernel interleave_layers__sliding_block__moe_arch_mod__prompt_kernel
  .amdhsa_next_free_vgpr 256
  .amdhsa_next_free_sgpr 102
  .amdhsa_accum_offset 256
  .amdhsa_group_segment_fixed_size 0
  .amdhsa_kernarg_size 88
  .amdhsa_user_sgpr_count 2
  .amdhsa_user_sgpr_kernarg_segment_ptr 1
  .amdhsa_system_sgpr_workgroup_id_x 1
  .amdhsa_float_denorm_mode_32 3
.end_amdhsa_kernel
```

```asm
; @launch grid=(256,1,1) block=(512,1,1) lds=163840
.amdgcn_target "amdgcn-amd-amdhsa--gfx950"
.text
.globl interleave_layers__sliding_block__moe_arch_mod__prompt_kernel
.p2align 8
.type interleave_layers__sliding_block__moe_arch_mod__prompt_kernel,@function
interleave_layers__sliding_block__moe_arch_mod__prompt_kernel:
s_cmp_ge_u32 s2, 256
s_cbranch_scc1 L_fin
s_load_dwordx16 s[36:51], s[0:1], 0
s_load_dwordx4 s[52:55], s[0:1], 64
s_load_dwordx2 s[56:57], s[0:1], 80
v_lshrrev_b32 v1, 6, v0
v_and_b32 v0, 63, v0
s_and_b32 s64, s2, 7
v_readfirstlane_b32 s3, v1
s_lshr_b32 s65, s2, 3
s_and_b32 s66, s65, 7
s_and_b32 s67, s64, 1
s_lshl3_add_u32 s59, s67, s66
s_lshr_b32 s66, s65, 3
s_lshr_b32 s67, s64, 1
s_lshl2_add_u32 s60, s67, s66
s_and_b32 s66, s65, 1
s_lshl1_add_u32 s61, s64, s66
s_lshr_b32 s62, s65, 1
s_mov_b32 s59, s61
s_xor_b32 s60, s62, 0
s_mov_b32 s63, 0
s_mov_b32 s34, 0
s_mov_b32 s32, 200000
s_mov_b32 s33, -1
s_cmp_ge_u32 s3, 4
s_cselect_b32 s66, 3, 1
s_and_b32 s58, s3, s66
s_waitcnt lgkmcnt(0)
s_mov_b32 s8, s36
s_mov_b32 s9, s37
s_mov_b32 s10, 0x400000
s_mov_b32 s11, 0x00020000
s_mov_b32 s12, s38
s_mov_b32 s13, s39
s_mov_b32 s14, 0x600000
s_mov_b32 s15, 0x00020000
s_mov_b32 s16, s40
s_mov_b32 s17, s41
s_mov_b32 s18, 0x200000
s_mov_b32 s19, 0x00020000
s_mov_b32 s20, s56
s_mov_b32 s21, s57
s_mov_b32 s22, 0x2500000
s_mov_b32 s23, 0x00020000
s_add_u32 s24, s56, 30408704
s_addc_u32 s25, s57, 0
s_mov_b32 s26, 2818048
s_mov_b32 s27, 0x00020000
s_mov_b32 s28, s52
s_mov_b32 s29, s53
s_mov_b32 s30, 0x400000
s_mov_b32 s31, 0x00020000
s_cmp_ge_u32 s3, 4
s_cbranch_scc1 L_m
s_cmp_ge_u32 s3, 2
s_cbranch_scc1 L_f
s_setprio 1
v_and_b32 v22, 7, v0
v_lshrrev_b32 v23, 4, v0
v_lshrrev_b32 v6, 3, v0
v_xor_b32 v7, v22, v23
v_lshlrev_b32 v7, 4, v7
v_lshl_add_u32 v8, v6, 11, v7
v_xor_b32 v7, 64, v8
v_add_u32 v9, 15360, v7
v_add_u32 v10, 30720, v8
v_add_u32 v11, 46080, v7
s_lshl_b32 s70, s59, 18
s_lshl_b32 s71, s58, 16
s_add_u32 s68, s70, s71
s_sub_u32 s69, s70, s71
s_add_u32 s69, s69, 196608
s_mov_b32 s67, 128
s_lshl_b32 s75, s58, 13
s_mov_b32 s65, 86016
s_and_b32 s79, s59, 1
s_mul_i32 s70, s60, 1
s_and_b32 s71, s59, 14
s_add_u32 s70, s70, s71
s_and_b32 s70, s70, 15
s_xor_b32 s64, s70, s79
s_mul_i32 s70, s64, s67
s_add_u32 m0, s65, s75
s_add_u32 s71, s70, s68
buffer_load_dwordx4 v8, s[8:11], s71 offen offset:0 lds
buffer_load_dwordx4 v9, s[8:11], s71 offen offset:1024 lds
buffer_load_dwordx4 v10, s[8:11], s71 offen offset:2048 lds
buffer_load_dwordx4 v11, s[8:11], s71 offen offset:3072 lds
s_add_u32 m0, m0, 4096
s_add_u32 s71, s70, s69
buffer_load_dwordx4 v8, s[8:11], s71 offen offset:0 lds
buffer_load_dwordx4 v9, s[8:11], s71 offen offset:1024 lds
buffer_load_dwordx4 v10, s[8:11], s71 offen offset:2048 lds
buffer_load_dwordx4 v11, s[8:11], s71 offen offset:3072 lds
v_and_b32 v7, 2, v6
v_xor_b32 v7, v7, v22
v_mul_u32_u24 v6, 6144, v6
v_lshl_add_u32 v12, v7, 4, v6
v_xor_b32 v6, 64, v12
v_add_u32 v13, 48128, v6
v_add_u32 v14, 96256, v12
v_add_u32 v15, 144384, v6
s_mul_i32 s76, s58, 12288
s_add_u32 s76, s76, 16384
s_lshl_b32 s70, s60, 7
s_cmp_eq_u32 s58, 0
s_mov_b32 s71, 198656
s_cselect_b32 s72, 0, s71
s_mov_b32 s71, 4096
s_cselect_b32 s73, 196608, s71
s_mov_b32 s71, 200704
s_cselect_b32 s74, 2048, s71
s_add_u32 s72, s72, s70
s_add_u32 s73, s73, s70
s_add_u32 s74, s74, s70
s_mul_i32 s70, s64, 393216
s_add_u32 m0, s65, s76
s_add_u32 s71, s70, s72
buffer_load_dwordx4 v12, s[12:15], s71 offen offset:0 lds
buffer_load_dwordx4 v13, s[12:15], s71 offen offset:1024 lds
buffer_load_dwordx4 v14, s[12:15], s71 offen offset:2048 lds
buffer_load_dwordx4 v15, s[12:15], s71 offen offset:3072 lds
s_add_u32 m0, m0, 4096
s_add_u32 s71, s70, s73
buffer_load_dwordx4 v12, s[12:15], s71 offen offset:0 lds
buffer_load_dwordx4 v13, s[12:15], s71 offen offset:1024 lds
buffer_load_dwordx4 v14, s[12:15], s71 offen offset:2048 lds
buffer_load_dwordx4 v15, s[12:15], s71 offen offset:3072 lds
s_add_u32 m0, m0, 4096
s_add_u32 s71, s70, s74
buffer_load_dwordx4 v12, s[12:15], s71 offen offset:0 lds
buffer_load_dwordx4 v13, s[12:15], s71 offen offset:1024 lds
buffer_load_dwordx4 v14, s[12:15], s71 offen offset:2048 lds
buffer_load_dwordx4 v15, s[12:15], s71 offen offset:3072 lds
s_xor_b32 s64, s64, s79
s_add_u32 s64, s64, 1
s_and_b32 s64, s64, 15
s_xor_b32 s64, s64, s79
s_sub_u32 s65, s65, 40960
s_cselect_b32 s65, 86016, s65
v_and_b32 v1, 3, v0
v_lshlrev_b32 v1, 2, v1
v_and_b32 v2, 4, v1
s_lshl2_add_u32 s35, s58, 16
v_mov_b32 v3, s35
v_lshlrev_b32 v20, 4, v0
v_lshrrev_b32 v6, 2, v0
v_lshl_add_u32 v21, v6, 7, v1
v_lshrrev_b32 v6, 3, v0
v_lshlrev_b32 v23, 1, v23
v_xor_b32 v23, v23, v22
v_lshlrev_b32 v23, 4, v23
v_lshl_add_u32 v23, v6, 11, v23
s_lshl_b32 s70, s62, 7
s_lshl_b32 s71, s58, 16
s_add_u32 s70, s70, s71
v_add_u32 v16, s70, v23
v_add_u32 v17, 15360, v16
v_add_u32 v18, 30720, v16
v_add_u32 v19, 46080, v16
s_add_u32 s77, s61, s62
s_lshl_b32 s77, s77, 17
s_lshl_b32 s78, s58, 12
s_mov_b32 s66, -2
s_barrier
.p2align 4
lq_1:
s_add_u32 s35, s66, 1
lw_4:
ds_read_b32 v5, v1 offset:0
s_waitcnt lgkmcnt(0)
v_cmp_gt_i32 vcc, s35, v5
s_cbranch_vccz lwd_5
s_sub_u32 s32, s32, 1
s_cmp_gt_i32 s32, 0
s_cbranch_scc1 lw_4
lwd_5:
s_cmp_eq_u32 s66, 0
s_cbranch_scc1 lcs_2
lcb_3:
s_mul_i32 s70, s64, s67
s_add_u32 m0, s65, s75
s_add_u32 s71, s70, s68
buffer_load_dwordx4 v8, s[8:11], s71 offen offset:0 sc1 lds
buffer_load_dwordx4 v9, s[8:11], s71 offen offset:1024 sc1 lds
buffer_load_dwordx4 v10, s[8:11], s71 offen offset:2048 sc1 lds
buffer_load_dwordx4 v11, s[8:11], s71 offen offset:3072 sc1 lds
buffer_load_dword v30, off, s[12:15], 0
s_add_u32 m0, m0, 4096
s_add_u32 s71, s70, s69
buffer_load_dwordx4 v8, s[8:11], s71 offen offset:0 sc1 lds
buffer_load_dwordx4 v9, s[8:11], s71 offen offset:1024 sc1 lds
buffer_load_dwordx4 v10, s[8:11], s71 offen offset:2048 sc1 lds
buffer_load_dwordx4 v11, s[8:11], s71 offen offset:3072 sc1 lds
buffer_load_dword v30, off, s[12:15], 0
s_mul_i32 s70, s64, 393216
s_add_u32 m0, s65, s76
s_add_u32 s71, s70, s72
buffer_load_dwordx4 v12, s[12:15], s71 offen offset:0 lds
buffer_load_dwordx4 v13, s[12:15], s71 offen offset:1024 lds
buffer_load_dwordx4 v14, s[12:15], s71 offen offset:2048 lds
buffer_load_dwordx4 v15, s[12:15], s71 offen offset:3072 lds
buffer_load_dword v30, off, s[12:15], 0
v_add_u32 v5, s66, 3
s_mov_b64 exec, 1
s_waitcnt vmcnt(15)
ds_write_b32 v3, v5
s_mov_b64 exec, -1
s_mul_i32 s70, s64, 393216
s_add_u32 m0, m0, 4096
s_add_u32 s71, s70, s73
buffer_load_dwordx4 v12, s[12:15], s71 offen offset:0 lds
buffer_load_dwordx4 v13, s[12:15], s71 offen offset:1024 lds
buffer_load_dwordx4 v14, s[12:15], s71 offen offset:2048 lds
buffer_load_dwordx4 v15, s[12:15], s71 offen offset:3072 lds
buffer_load_dword v30, off, s[12:15], 0
s_mul_i32 s70, s64, 393216
s_add_u32 m0, m0, 4096
s_add_u32 s71, s70, s74
buffer_load_dwordx4 v12, s[12:15], s71 offen offset:0 lds
buffer_load_dwordx4 v13, s[12:15], s71 offen offset:1024 lds
buffer_load_dwordx4 v14, s[12:15], s71 offen offset:2048 lds
buffer_load_dwordx4 v15, s[12:15], s71 offen offset:3072 lds
buffer_load_dword v30, off, s[12:15], 0
s_xor_b32 s64, s64, s79
s_add_u32 s64, s64, 1
s_and_b32 s64, s64, 15
s_xor_b32 s64, s64, s79
s_sub_u32 s65, s65, 40960
s_cselect_b32 s65, 86016, s65
s_add_u32 s66, s66, 1
s_and_b32 s70, s66, 31
s_cmp_eq_u32 s70, 13
s_cbranch_scc0 lq_1
s_waitcnt vmcnt(0)
v_add_u32 v5, s34, 16
s_mov_b64 exec, 1
ds_write_b32 v3, v5
s_mov_b64 exec, -1
s_add_u32 s35, s34, 14
lw_6:
ds_read_b32 v5, v1 offset:0
s_waitcnt lgkmcnt(0)
v_cmp_gt_i32 vcc, s35, v5
s_cbranch_vccz lwd_7
s_sleep 1
s_sub_u32 s32, s32, 1
s_cmp_gt_i32 s32, 0
s_cbranch_scc1 lw_6
lwd_7:
s_add_u32 s70, s77, 262144
s_add_u32 m0, s78, 49152
s_and_b32 s70, s70, 0x1fffff
buffer_load_dwordx4 v16, s[16:19], s70 offen offset:0 lds
buffer_load_dwordx4 v17, s[16:19], s70 offen offset:1024 lds
buffer_load_dwordx4 v18, s[16:19], s70 offen offset:2048 lds
buffer_load_dwordx4 v19, s[16:19], s70 offen offset:3072 lds
buffer_load_dword v30, off, s[12:15], 0
s_add_u32 s70, s77, 393216
s_add_u32 m0, s78, 57344
s_and_b32 s70, s70, 0x1fffff
buffer_load_dwordx4 v16, s[16:19], s70 offen offset:0 lds
buffer_load_dwordx4 v17, s[16:19], s70 offen offset:1024 lds
buffer_load_dwordx4 v18, s[16:19], s70 offen offset:2048 lds
buffer_load_dwordx4 v19, s[16:19], s70 offen offset:3072 lds
buffer_load_dword v30, off, s[12:15], 0
s_add_u32 s70, s77, 524288
s_add_u32 m0, s78, 65536
s_and_b32 s70, s70, 0x1fffff
buffer_load_dwordx4 v16, s[16:19], s70 offen offset:0 lds
buffer_load_dwordx4 v17, s[16:19], s70 offen offset:1024 lds
buffer_load_dwordx4 v18, s[16:19], s70 offen offset:2048 lds
buffer_load_dwordx4 v19, s[16:19], s70 offen offset:3072 lds
buffer_load_dword v30, off, s[12:15], 0
s_add_u32 s70, s77, 655360
s_add_u32 m0, s78, 73728
s_and_b32 s70, s70, 0x1fffff
buffer_load_dwordx4 v16, s[16:19], s70 offen offset:0 lds
buffer_load_dwordx4 v17, s[16:19], s70 offen offset:1024 lds
buffer_load_dwordx4 v18, s[16:19], s70 offen offset:2048 lds
buffer_load_dwordx4 v19, s[16:19], s70 offen offset:3072 lds
buffer_load_dword v30, off, s[12:15], 0
s_sub_u32 s70, s59, s58
s_lshl_b32 s71, s70, 7
s_add_u32 s71, s71, s60
s_lshl4_add_u32 s70, s70, s60
s_sub_u32 s70, s70, 16
s_lshl_b32 s66, s71, 7
s_add_u32 s66, s66, 253952
s_lshl_b32 s70, s70, 15
s_lshl_b32 s71, s63, 23
s_add_u32 s70, s70, s71
s_add_u32 s64, s70, 1077248
s_mul_i32 s65, s58, -94208
s_add_u32 s35, s34, 16
lw_8:
ds_read_b32 v5, v1 offset:0
s_waitcnt lgkmcnt(0)
v_cmp_gt_i32 vcc, s35, v5
s_cbranch_vccz lwd_9
s_sleep 1
s_sub_u32 s32, s32, 1
s_cmp_gt_i32 s32, 0
s_cbranch_scc1 lw_8
lwd_9:
s_add_u32 s35, s34, 17
lw_11:
ds_read_b32 v5, v1 offset:0
s_waitcnt lgkmcnt(0)
v_cmp_gt_i32 vcc, s35, v5
s_cbranch_vccz lwd_12
s_sleep 1
s_sub_u32 s32, s32, 1
s_cmp_gt_i32 s32, 0
s_cbranch_scc1 lw_11
lwd_12:
s_cmp_gt_u32 s59, s58
s_cbranch_scc0 nokv_10
poll_13:
buffer_load_dword v6, v1, s[24:27], s66 offen sc1
pchk_14:
s_waitcnt vmcnt(0)
v_cmp_eq_u32 vcc, 0, v6
s_cbranch_vccz pdone_15
s_sub_u32 s32, s32, 1
s_cmp_gt_i32 s32, 0
s_cbranch_scc1 poll_13
pdone_15:
s_cmp_eq_u32 s58, 0
s_cbranch_scc1 kd_16
v_mov_b32 v7, 0
s_add_u32 s35, s34, 17
lw_17:
ds_read_b32 v5, v7 offset:16
s_waitcnt lgkmcnt(0)
v_cmp_gt_i32 vcc, s35, v5
s_cbranch_vccz lwd_18
s_sleep 1
s_sub_u32 s32, s32, 1
s_cmp_gt_i32 s32, 0
s_cbranch_scc1 lw_17
lwd_18:
kd_16:
s_add_u32 m0, s65, 126976
s_nop 0
buffer_load_dwordx4 v20, s[20:23], s64 offen offset:0 sc1 lds
buffer_load_dwordx4 v20, s[20:23], s64 offen offset:1024 sc1 lds
buffer_load_dwordx4 v20, s[20:23], s64 offen offset:2048 sc1 lds
buffer_load_dwordx4 v20, s[20:23], s64 offen offset:3072 sc1 lds
buffer_load_dword v30, off, s[12:15], 0
s_add_u32 m0, s65, 122880
s_sub_u32 s64, s64, 4096
buffer_load_dwordx4 v20, s[20:23], s64 offen offset:0 sc1 lds
buffer_load_dwordx4 v20, s[20:23], s64 offen offset:1024 sc1 lds
buffer_load_dwordx4 v20, s[20:23], s64 offen offset:2048 sc1 lds
buffer_load_dwordx4 v20, s[20:23], s64 offen offset:3072 sc1 lds
buffer_load_dword v30, off, s[12:15], 0
s_add_u32 m0, s65, 118784
s_sub_u32 s64, s64, 4096
buffer_load_dwordx4 v20, s[20:23], s64 offen offset:0 sc1 lds
buffer_load_dwordx4 v20, s[20:23], s64 offen offset:1024 sc1 lds
buffer_load_dwordx4 v20, s[20:23], s64 offen offset:2048 sc1 lds
buffer_load_dwordx4 v20, s[20:23], s64 offen offset:3072 sc1 lds
buffer_load_dword v30, off, s[12:15], 0
s_add_u32 m0, s65, 114688
s_sub_u32 s64, s64, 4096
buffer_load_dwordx4 v20, s[20:23], s64 offen offset:0 sc1 lds
buffer_load_dwordx4 v20, s[20:23], s64 offen offset:1024 sc1 lds
buffer_load_dwordx4 v20, s[20:23], s64 offen offset:2048 sc1 lds
buffer_load_dwordx4 v20, s[20:23], s64 offen offset:3072 sc1 lds
buffer_load_dword v30, off, s[12:15], 0
s_add_u32 m0, s65, 110592
s_sub_u32 s64, s64, 4096
buffer_load_dwordx4 v20, s[20:23], s64 offen offset:0 sc1 lds
buffer_load_dwordx4 v20, s[20:23], s64 offen offset:1024 sc1 lds
buffer_load_dwordx4 v20, s[20:23], s64 offen offset:2048 sc1 lds
buffer_load_dwordx4 v20, s[20:23], s64 offen offset:3072 sc1 lds
buffer_load_dword v30, off, s[12:15], 0
s_add_u32 m0, s65, 106496
s_sub_u32 s64, s64, 4096
buffer_load_dwordx4 v20, s[20:23], s64 offen offset:0 sc1 lds
buffer_load_dwordx4 v20, s[20:23], s64 offen offset:1024 sc1 lds
buffer_load_dwordx4 v20, s[20:23], s64 offen offset:2048 sc1 lds
buffer_load_dwordx4 v20, s[20:23], s64 offen offset:3072 sc1 lds
buffer_load_dword v30, off, s[12:15], 0
s_add_u32 m0, s65, 102400
s_sub_u32 s64, s64, 4096
buffer_load_dwordx4 v20, s[20:23], s64 offen offset:0 sc1 lds
buffer_load_dwordx4 v20, s[20:23], s64 offen offset:1024 sc1 lds
buffer_load_dwordx4 v20, s[20:23], s64 offen offset:2048 sc1 lds
buffer_load_dwordx4 v20, s[20:23], s64 offen offset:3072 sc1 lds
buffer_load_dword v30, off, s[12:15], 0
s_add_u32 m0, s65, 98304
s_sub_u32 s64, s64, 4096
buffer_load_dwordx4 v20, s[20:23], s64 offen offset:0 sc1 lds
buffer_load_dwordx4 v20, s[20:23], s64 offen offset:1024 sc1 lds
buffer_load_dwordx4 v20, s[20:23], s64 offen offset:2048 sc1 lds
buffer_load_dwordx4 v20, s[20:23], s64 offen offset:3072 sc1 lds
buffer_load_dword v30, off, s[12:15], 0
v_add_u32 v5, s34, 17
s_mov_b64 exec, 1
ds_write_b32 v3, v5
s_mov_b64 exec, -1
s_waitcnt vmcnt(30)
v_add_u32 v5, s34, 18
s_mov_b64 exec, 1
ds_write_b32 v3, v5
s_mov_b64 exec, -1
nokv_10:
s_lshl_b32 s66, s61, 14
s_add_u32 s66, s66, 268288
s_waitcnt vmcnt(0)
v_add_u32 v5, s34, 21
s_mov_b64 exec, 1
ds_write_b32 v3, v5
s_mov_b64 exec, -1
s_add_u32 s70, s77, 131072
s_add_u32 m0, s78, 40960
s_and_b32 s70, s70, 0x1fffff
buffer_load_dwordx4 v16, s[16:19], s70 offen offset:0 lds
buffer_load_dwordx4 v17, s[16:19], s70 offen offset:1024 lds
buffer_load_dwordx4 v18, s[16:19], s70 offen offset:2048 lds
buffer_load_dwordx4 v19, s[16:19], s70 offen offset:3072 lds
buffer_load_dword v30, off, s[12:15], 0
s_add_u32 s70, s77, 786432
s_add_u32 m0, s78, 81920
s_and_b32 s70, s70, 0x1fffff
buffer_load_dwordx4 v16, s[16:19], s70 offen offset:0 lds
buffer_load_dwordx4 v17, s[16:19], s70 offen offset:1024 lds
buffer_load_dwordx4 v18, s[16:19], s70 offen offset:2048 lds
buffer_load_dwordx4 v19, s[16:19], s70 offen offset:3072 lds
buffer_load_dword v30, off, s[12:15], 0
s_add_u32 s70, s77, 917504
s_add_u32 m0, s78, 90112
s_and_b32 s70, s70, 0x1fffff
buffer_load_dwordx4 v16, s[16:19], s70 offen offset:0 lds
buffer_load_dwordx4 v17, s[16:19], s70 offen offset:1024 lds
buffer_load_dwordx4 v18, s[16:19], s70 offen offset:2048 lds
buffer_load_dwordx4 v19, s[16:19], s70 offen offset:3072 lds
buffer_load_dword v30, off, s[12:15], 0
s_add_u32 s35, s34, 18
lw_20:
ds_read_b32 v5, v1 offset:0
s_waitcnt lgkmcnt(0)
v_cmp_gt_i32 vcc, s35, v5
s_cbranch_vccz lwd_21
s_sleep 1
s_sub_u32 s32, s32, 1
s_cmp_gt_i32 s32, 0
s_cbranch_scc1 lw_20
lwd_21:
s_add_u32 s70, s77, 1572864
s_add_u32 m0, s78, 131072
s_and_b32 s70, s70, 0x1fffff
buffer_load_dwordx4 v16, s[16:19], s70 offen offset:0 lds
buffer_load_dwordx4 v17, s[16:19], s70 offen offset:1024 lds
buffer_load_dwordx4 v18, s[16:19], s70 offen offset:2048 lds
buffer_load_dwordx4 v19, s[16:19], s70 offen offset:3072 lds
buffer_load_dword v30, off, s[12:15], 0
s_add_u32 s70, s77, 1703936
s_add_u32 m0, s78, 139264
s_and_b32 s70, s70, 0x1fffff
buffer_load_dwordx4 v16, s[16:19], s70 offen offset:0 lds
buffer_load_dwordx4 v17, s[16:19], s70 offen offset:1024 lds
buffer_load_dwordx4 v18, s[16:19], s70 offen offset:2048 lds
buffer_load_dwordx4 v19, s[16:19], s70 offen offset:3072 lds
buffer_load_dword v30, off, s[12:15], 0
s_add_u32 s70, s77, 1835008
s_add_u32 m0, s78, 147456
s_and_b32 s70, s70, 0x1fffff
buffer_load_dwordx4 v16, s[16:19], s70 offen offset:0 lds
buffer_load_dwordx4 v17, s[16:19], s70 offen offset:1024 lds
buffer_load_dwordx4 v18, s[16:19], s70 offen offset:2048 lds
buffer_load_dwordx4 v19, s[16:19], s70 offen offset:3072 lds
buffer_load_dword v30, off, s[12:15], 0
s_add_u32 s70, s77, 1966080
s_add_u32 m0, s78, 155648
s_and_b32 s70, s70, 0x1fffff
buffer_load_dwordx4 v16, s[16:19], s70 offen offset:0 lds
buffer_load_dwordx4 v17, s[16:19], s70 offen offset:1024 lds
buffer_load_dwordx4 v18, s[16:19], s70 offen offset:2048 lds
buffer_load_dwordx4 v19, s[16:19], s70 offen offset:3072 lds
buffer_load_dword v30, off, s[12:15], 0
s_add_u32 s35, s34, 19
lw_22:
ds_read_b32 v5, v1 offset:0
s_waitcnt lgkmcnt(0)
v_cmp_gt_i32 vcc, s35, v5
s_cbranch_vccz lwd_23
s_sleep 2
s_sub_u32 s32, s32, 1
s_cmp_gt_i32 s32, 0
s_cbranch_scc1 lw_22
lwd_23:
s_add_u32 s70, s77, 1048576
s_add_u32 m0, s78, 98304
s_and_b32 s70, s70, 0x1fffff
buffer_load_dwordx4 v16, s[16:19], s70 offen offset:0 lds
buffer_load_dwordx4 v17, s[16:19], s70 offen offset:1024 lds
buffer_load_dwordx4 v18, s[16:19], s70 offen offset:2048 lds
buffer_load_dwordx4 v19, s[16:19], s70 offen offset:3072 lds
buffer_load_dword v30, off, s[12:15], 0
s_add_u32 s70, s77, 1179648
s_add_u32 m0, s78, 106496
s_and_b32 s70, s70, 0x1fffff
buffer_load_dwordx4 v16, s[16:19], s70 offen offset:0 lds
buffer_load_dwordx4 v17, s[16:19], s70 offen offset:1024 lds
buffer_load_dwordx4 v18, s[16:19], s70 offen offset:2048 lds
buffer_load_dwordx4 v19, s[16:19], s70 offen offset:3072 lds
buffer_load_dword v30, off, s[12:15], 0
s_add_u32 s70, s77, 1310720
s_add_u32 m0, s78, 114688
s_and_b32 s70, s70, 0x1fffff
buffer_load_dwordx4 v16, s[16:19], s70 offen offset:0 lds
buffer_load_dwordx4 v17, s[16:19], s70 offen offset:1024 lds
buffer_load_dwordx4 v18, s[16:19], s70 offen offset:2048 lds
buffer_load_dwordx4 v19, s[16:19], s70 offen offset:3072 lds
buffer_load_dword v30, off, s[12:15], 0
s_add_u32 s70, s77, 1441792
s_add_u32 m0, s78, 122880
s_and_b32 s70, s70, 0x1fffff
buffer_load_dwordx4 v16, s[16:19], s70 offen offset:0 lds
buffer_load_dwordx4 v17, s[16:19], s70 offen offset:1024 lds
buffer_load_dwordx4 v18, s[16:19], s70 offen offset:2048 lds
buffer_load_dwordx4 v19, s[16:19], s70 offen offset:3072 lds
buffer_load_dword v30, off, s[12:15], 0
s_add_u32 s35, s34, 20
lw_24:
ds_read_b32 v5, v1 offset:0
s_waitcnt lgkmcnt(0)
v_cmp_gt_i32 vcc, s35, v5
s_cbranch_vccz lwd_25
s_sleep 2
s_sub_u32 s32, s32, 1
s_cmp_gt_i32 s32, 0
s_cbranch_scc1 lw_24
lwd_25:
s_add_u32 s70, s77, 0
s_add_u32 m0, s78, 32768
s_and_b32 s70, s70, 0x1fffff
buffer_load_dwordx4 v16, s[16:19], s70 offen offset:0 lds
buffer_load_dwordx4 v17, s[16:19], s70 offen offset:1024 lds
buffer_load_dwordx4 v18, s[16:19], s70 offen offset:2048 lds
buffer_load_dwordx4 v19, s[16:19], s70 offen offset:3072 lds
buffer_load_dword v30, off, s[12:15], 0
s_cmp_eq_u32 s58, 0
s_cbranch_scc0 nofo_19
s_add_u32 s35, s34, 21
lw_26:
ds_read_b32 v5, v1 offset:0
s_waitcnt lgkmcnt(0)
v_cmp_gt_i32 vcc, s35, v5
s_cbranch_vccz lwd_27
s_sleep 1
s_sub_u32 s32, s32, 1
s_cmp_gt_i32 s32, 0
s_cbranch_scc1 lw_26
lwd_27:
poll_28:
buffer_load_dword v6, v21, s[24:27], s66 offen sc1
pchk_29:
s_waitcnt vmcnt(0)
v_cmp_eq_u32 vcc, 0, v6
s_cbranch_vccz pdone_30
s_sub_u32 s32, s32, 1
s_cmp_gt_i32 s32, 0
s_cbranch_scc1 poll_28
pdone_30:
nofo_19:
s_waitcnt vmcnt(0)
v_add_u32 v5, s34, 22
s_mov_b64 exec, 1
ds_write_b32 v3, v5
s_mov_b64 exec, -1
s_cmp_eq_u32 s63, 0
s_cbranch_scc0 L_end
v_bfe_u32 v6, v0, 3, 2
v_and_b32 v7, 2, v6
v_xor_b32 v7, v7, v22
v_lshrrev_b32 v23, 5, v0
v_lshl_add_u32 v6, v23, 4, v6
v_mul_u32_u24 v6, 6144, v6
v_lshl_add_u32 v12, v7, 4, v6
v_xor_b32 v6, 64, v12
v_add_u32 v13, 23552, v6
v_add_u32 v14, 47104, v12
v_add_u32 v15, 70656, v6
v_mov_b32 v8, v20
v_mov_b32 v9, v20
v_mov_b32 v10, v20
v_mov_b32 v11, v20
s_mov_b32 s8, s56
s_mov_b32 s9, s57
s_mov_b32 s10, 0x2500000
s_mov_b32 s11, 0x00020000
s_lshl_b32 s70, s59, 18
s_add_u32 s70, s70, 26214400
s_add_u32 s68, s70, s78
s_sub_u32 s69, s70, s78
s_add_u32 s69, s69, 12288
s_mov_b32 s67, 16384
s_lshl_b32 s66, s59, 14
s_add_u32 s66, s66, 274432
s_and_b32 s79, s59, 1
s_mul_i32 s79, s79, 1
s_mul_i32 s70, s60, 1
s_and_b32 s71, s59, 14
s_add_u32 s70, s70, s71
s_and_b32 s70, s70, 15
s_xor_b32 s64, s70, s79
s_mov_b32 s65, 86016
s_add_u32 s35, s34, 22
lw_31:
ds_read_b32 v5, v1 offset:0
s_waitcnt lgkmcnt(0)
v_cmp_gt_i32 vcc, s35, v5
s_cbranch_vccz lwd_32
s_sleep 2
s_sub_u32 s32, s32, 1
s_cmp_gt_i32 s32, 0
s_cbranch_scc1 lw_31
lwd_32:
s_mul_i32 s70, s64, 393216
s_add_u32 m0, s65, s76
s_add_u32 s71, s70, s72
buffer_load_dwordx4 v12, s[12:15], s71 offen offset:0 lds
buffer_load_dwordx4 v13, s[12:15], s71 offen offset:1024 lds
buffer_load_dwordx4 v14, s[12:15], s71 offen offset:2048 lds
buffer_load_dwordx4 v15, s[12:15], s71 offen offset:3072 lds
buffer_load_dword v30, off, s[12:15], 0
s_add_u32 m0, m0, 4096
s_add_u32 s71, s70, s73
buffer_load_dwordx4 v12, s[12:15], s71 offen offset:0 lds
buffer_load_dwordx4 v13, s[12:15], s71 offen offset:1024 lds
buffer_load_dwordx4 v14, s[12:15], s71 offen offset:2048 lds
buffer_load_dwordx4 v15, s[12:15], s71 offen offset:3072 lds
buffer_load_dword v30, off, s[12:15], 0
s_add_u32 m0, m0, 4096
s_add_u32 s71, s70, s74
buffer_load_dwordx4 v12, s[12:15], s71 offen offset:0 lds
buffer_load_dwordx4 v13, s[12:15], s71 offen offset:1024 lds
buffer_load_dwordx4 v14, s[12:15], s71 offen offset:2048 lds
buffer_load_dwordx4 v15, s[12:15], s71 offen offset:3072 lds
buffer_load_dword v30, off, s[12:15], 0
s_and_b32 s79, s59, 1
s_mul_i32 s79, s79, 1
s_mul_i32 s70, s60, 1
s_and_b32 s71, s59, 14
s_add_u32 s70, s70, s71
s_and_b32 s70, s70, 15
s_xor_b32 s64, s70, s79
s_mov_b32 s65, 86016
s_add_u32 s35, s34, 23
lw_33:
ds_read_b32 v5, v1 offset:0
s_waitcnt lgkmcnt(0)
v_cmp_gt_i32 vcc, s35, v5
s_cbranch_vccz lwd_34
s_sleep 1
s_sub_u32 s32, s32, 1
s_cmp_gt_i32 s32, 0
s_cbranch_scc1 lw_33
lwd_34:
poll_35:
buffer_load_dword v6, v21, s[24:27], s66 offen sc1
pchk_36:
s_waitcnt vmcnt(0)
v_cmp_eq_u32 vcc, 0, v6
s_cbranch_vccz pdone_37
s_sub_u32 s32, s32, 1
s_cmp_gt_i32 s32, 0
s_cbranch_scc1 poll_35
pdone_37:
s_mul_i32 s70, s64, s67
s_add_u32 m0, s65, s75
s_add_u32 s71, s70, s68
buffer_load_dwordx4 v8, s[8:11], s71 offen offset:0 sc1 lds
buffer_load_dwordx4 v9, s[8:11], s71 offen offset:1024 sc1 lds
buffer_load_dwordx4 v10, s[8:11], s71 offen offset:2048 sc1 lds
buffer_load_dwordx4 v11, s[8:11], s71 offen offset:3072 sc1 lds
buffer_load_dword v30, off, s[12:15], 0
s_add_u32 m0, m0, 4096
s_add_u32 s71, s70, s69
buffer_load_dwordx4 v8, s[8:11], s71 offen offset:0 sc1 lds
buffer_load_dwordx4 v9, s[8:11], s71 offen offset:1024 sc1 lds
buffer_load_dwordx4 v10, s[8:11], s71 offen offset:2048 sc1 lds
buffer_load_dwordx4 v11, s[8:11], s71 offen offset:3072 sc1 lds
buffer_load_dword v30, off, s[12:15], 0
s_xor_b32 s64, s64, s79
s_add_u32 s64, s64, 1
s_and_b32 s64, s64, 15
s_xor_b32 s64, s64, s79
s_sub_u32 s65, s65, 40960
s_cselect_b32 s65, 86016, s65
s_mul_i32 s70, s64, s67
s_add_u32 m0, s65, s75
s_add_u32 s71, s70, s68
buffer_load_dwordx4 v8, s[8:11], s71 offen offset:0 sc1 lds
buffer_load_dwordx4 v9, s[8:11], s71 offen offset:1024 sc1 lds
buffer_load_dwordx4 v10, s[8:11], s71 offen offset:2048 sc1 lds
buffer_load_dwordx4 v11, s[8:11], s71 offen offset:3072 sc1 lds
buffer_load_dword v30, off, s[12:15], 0
s_add_u32 m0, m0, 4096
s_add_u32 s71, s70, s69
buffer_load_dwordx4 v8, s[8:11], s71 offen offset:0 sc1 lds
buffer_load_dwordx4 v9, s[8:11], s71 offen offset:1024 sc1 lds
buffer_load_dwordx4 v10, s[8:11], s71 offen offset:2048 sc1 lds
buffer_load_dwordx4 v11, s[8:11], s71 offen offset:3072 sc1 lds
buffer_load_dword v30, off, s[12:15], 0
s_mul_i32 s70, s64, 393216
s_add_u32 m0, s65, s76
s_add_u32 s71, s70, s72
buffer_load_dwordx4 v12, s[12:15], s71 offen offset:0 lds
buffer_load_dwordx4 v13, s[12:15], s71 offen offset:1024 lds
buffer_load_dwordx4 v14, s[12:15], s71 offen offset:2048 lds
buffer_load_dwordx4 v15, s[12:15], s71 offen offset:3072 lds
buffer_load_dword v30, off, s[12:15], 0
s_add_u32 m0, m0, 4096
s_add_u32 s71, s70, s73
buffer_load_dwordx4 v12, s[12:15], s71 offen offset:0 lds
buffer_load_dwordx4 v13, s[12:15], s71 offen offset:1024 lds
buffer_load_dwordx4 v14, s[12:15], s71 offen offset:2048 lds
buffer_load_dwordx4 v15, s[12:15], s71 offen offset:3072 lds
buffer_load_dword v30, off, s[12:15], 0
s_add_u32 m0, m0, 4096
s_add_u32 s71, s70, s74
buffer_load_dwordx4 v12, s[12:15], s71 offen offset:0 lds
buffer_load_dwordx4 v13, s[12:15], s71 offen offset:1024 lds
buffer_load_dwordx4 v14, s[12:15], s71 offen offset:2048 lds
buffer_load_dwordx4 v15, s[12:15], s71 offen offset:3072 lds
buffer_load_dword v30, off, s[12:15], 0
s_xor_b32 s64, s64, s79
s_add_u32 s64, s64, 1
s_and_b32 s64, s64, 15
s_xor_b32 s64, s64, s79
s_sub_u32 s65, s65, 40960
s_cselect_b32 s65, 86016, s65
s_mul_i32 s70, s64, s67
s_add_u32 m0, s65, s75
s_add_u32 s71, s70, s68
buffer_load_dwordx4 v8, s[8:11], s71 offen offset:0 sc1 lds
buffer_load_dwordx4 v9, s[8:11], s71 offen offset:1024 sc1 lds
buffer_load_dwordx4 v10, s[8:11], s71 offen offset:2048 sc1 lds
buffer_load_dwordx4 v11, s[8:11], s71 offen offset:3072 sc1 lds
buffer_load_dword v30, off, s[12:15], 0
s_add_u32 m0, m0, 4096
s_add_u32 s71, s70, s69
buffer_load_dwordx4 v8, s[8:11], s71 offen offset:0 sc1 lds
buffer_load_dwordx4 v9, s[8:11], s71 offen offset:1024 sc1 lds
buffer_load_dwordx4 v10, s[8:11], s71 offen offset:2048 sc1 lds
buffer_load_dwordx4 v11, s[8:11], s71 offen offset:3072 sc1 lds
buffer_load_dword v30, off, s[12:15], 0
s_mul_i32 s70, s64, 393216
s_add_u32 m0, s65, s76
s_add_u32 s71, s70, s72
buffer_load_dwordx4 v12, s[12:15], s71 offen offset:0 lds
buffer_load_dwordx4 v13, s[12:15], s71 offen offset:1024 lds
buffer_load_dwordx4 v14, s[12:15], s71 offen offset:2048 lds
buffer_load_dwordx4 v15, s[12:15], s71 offen offset:3072 lds
buffer_load_dword v30, off, s[12:15], 0
s_add_u32 m0, m0, 4096
s_add_u32 s71, s70, s73
buffer_load_dwordx4 v12, s[12:15], s71 offen offset:0 lds
buffer_load_dwordx4 v13, s[12:15], s71 offen offset:1024 lds
buffer_load_dwordx4 v14, s[12:15], s71 offen offset:2048 lds
buffer_load_dwordx4 v15, s[12:15], s71 offen offset:3072 lds
buffer_load_dword v30, off, s[12:15], 0
s_add_u32 m0, m0, 4096
s_add_u32 s71, s70, s74
buffer_load_dwordx4 v12, s[12:15], s71 offen offset:0 lds
buffer_load_dwordx4 v13, s[12:15], s71 offen offset:1024 lds
buffer_load_dwordx4 v14, s[12:15], s71 offen offset:2048 lds
buffer_load_dwordx4 v15, s[12:15], s71 offen offset:3072 lds
buffer_load_dword v30, off, s[12:15], 0
s_xor_b32 s64, s64, s79
s_add_u32 s64, s64, 1
s_and_b32 s64, s64, 15
s_xor_b32 s64, s64, s79
s_sub_u32 s65, s65, 40960
s_cselect_b32 s65, 86016, s65
s_waitcnt vmcnt(50)
v_add_u32 v5, s34, 33
s_mov_b64 exec, 1
ds_write_b32 v3, v5
s_mov_b64 exec, -1
s_mov_b32 s36, s64
s_mov_b32 s37, s65
s_mov_b32 s64, s59
s_mov_b32 s65, 114688
s_mul_i32 s70, s64, 393216
s_add_u32 m0, s65, s76
s_add_u32 s71, s70, s72
buffer_load_dwordx4 v12, s[12:15], s71 offen offset:0 lds
buffer_load_dwordx4 v13, s[12:15], s71 offen offset:1024 lds
buffer_load_dwordx4 v14, s[12:15], s71 offen offset:2048 lds
buffer_load_dwordx4 v15, s[12:15], s71 offen offset:3072 lds
buffer_load_dword v30, off, s[12:15], 0
s_add_u32 m0, m0, 4096
s_add_u32 s71, s70, s73
buffer_load_dwordx4 v12, s[12:15], s71 offen offset:0 lds
buffer_load_dwordx4 v13, s[12:15], s71 offen offset:1024 lds
buffer_load_dwordx4 v14, s[12:15], s71 offen offset:2048 lds
buffer_load_dwordx4 v15, s[12:15], s71 offen offset:3072 lds
buffer_load_dword v30, off, s[12:15], 0
s_add_u32 m0, m0, 4096
s_add_u32 s71, s70, s74
buffer_load_dwordx4 v12, s[12:15], s71 offen offset:0 lds
buffer_load_dwordx4 v13, s[12:15], s71 offen offset:1024 lds
buffer_load_dwordx4 v14, s[12:15], s71 offen offset:2048 lds
buffer_load_dwordx4 v15, s[12:15], s71 offen offset:3072 lds
buffer_load_dword v30, off, s[12:15], 0
s_mov_b32 s64, s36
s_mov_b32 s65, s37
s_waitcnt vmcnt(40)
v_add_u32 v5, s34, 34
s_mov_b64 exec, 1
ds_write_b32 v3, v5
s_mov_b64 exec, -1
s_mov_b32 s63, 1
s_mov_b32 s34, 32
s_add_u32 s24, s24, 1409024
s_addc_u32 s25, s25, 0
s_mov_b32 s26, 1409024
s_mov_b32 s66, 32
s_branch lq_1
lcs_2:
s_add_u32 s35, s34, 1
lw_38:
ds_read_b32 v5, v2 offset:24
s_waitcnt lgkmcnt(0)
v_cmp_gt_i32 vcc, s35, v5
s_cbranch_vccz lwd_39
s_sub_u32 s32, s32, 1
s_cmp_gt_i32 s32, 0
s_cbranch_scc1 lw_38
lwd_39:
s_branch lcb_3
L_f:
v_lshlrev_b32 v4, 4, v0
s_lshl4_add_u32 s78, s59, s60
v_mov_b32 v252, 0
v_mov_b32 v253, 0
v_mov_b32 v254, 0
v_mov_b32 v255, 0
s_lshl_b32 s35, s78, 10
s_cmp_eq_u32 s58, 0
s_cselect_b64 exec, -1, 0
buffer_store_dwordx4 v[252:255], v4, s[24:27], s35 offen offset:0 sc1
s_add_u32 s35, s35, 262144
buffer_store_dwordx4 v[252:255], v4, s[24:27], s35 offen offset:0 sc1
s_mov_b64 exec, -1
s_setprio 3
v_and_b32 v1, 3, v0
v_lshlrev_b32 v1, 2, v1
v_and_b32 v2, 4, v1
s_lshl2_add_u32 s35, s58, 24
v_mov_b32 v3, s35
s_mov_b32 s4, s54
s_mov_b32 s5, s55
s_mov_b32 s6, 0x100
s_mov_b32 s7, 0x00020000
s_add_u32 s70, s60, 4
s_lshr_b32 s70, s70, 3
s_sub_u32 s70, s60, s70
s_lshl4_add_u32 s64, s70, s59
s_and_b32 s70, s60, 7
s_cmp_eq_u32 s70, 3
s_cselect_b32 s65, 1, 0
s_mov_b32 s69, 0x3f803f80
s_barrier
s_cmp_eq_u32 s58, 0
s_cselect_b32 s16, s46, s48
s_cselect_b32 s17, s47, s49
s_mov_b32 s12, s50
s_mov_b32 s13, s51
s_mov_b32 s14, 0x0
s_mov_b32 s15, 0x00020000
s_cmp_eq_u32 s65, 0
s_cselect_b32 s18, 7340032, 0
s_mov_b32 s14, s18
s_lshr_b32 s70, s64, 3
s_and_b32 s71, s64, 7
s_lshl_b32 s66, s70, 10
s_add_u32 s66, s66, s71
s_lshl1_add_u32 s66, s66, s58
s_lshl_b32 s66, s66, 7
s_mul_i32 s71, s71, 917504
s_lshl_b32 s70, s70, 8
s_add_u32 s77, s71, s70
s_mov_b32 s48, s38
s_mov_b32 s49, s39
s_mov_b32 s50, 0x600000
s_mov_b32 s51, 0x00020000
s_mov_b32 s52, 0
s_and_b32 s54, s60, 8
s_add_u32 s54, s54, 3
s_add_u32 s53, s54, s59
s_and_b32 s55, s60, 7
s_lshl1_add_u32 s55, s55, s58
s_mul_i32 s55, s55, 24576
s_lshl_b32 s54, s54, 7
s_add_u32 s56, s54, s55
s_add_u32 s56, s56, 60
s_and_b32 s73, s2, 3
s_lshl_b32 s73, s73, 6
v_mov_b32 v14, 1
s_sub_u32 exec_lo, 1, s58
s_mov_b32 exec_hi, 0
s_waitcnt vmcnt(0)
buffer_atomic_add v14, off, s[4:7], s73 sc1
s_mov_b64 exec, -1
v_mov_b32 v8, s69
v_mov_b32 v9, s69
v_mov_b32 v10, s69
v_mov_b32 v11, s69
v_mov_b32 v12, s69
v_mov_b32 v13, s69
v_mov_b32 v14, s69
v_mov_b32 v15, s69
s_mov_b32 s70, 102400
ftop_42:
v_lshrrev_b32 v6, 4, v0
v_bfe_u32 v7, v0, 2, 2
v_lshl_add_u32 v6, v6, 3, v7
v_bfe_u32 v7, v0, 3, 2
s_lshl_b32 s71, s58, 1
v_xor_b32 v7, s71, v7
v_lshl_add_u32 v7, v7, 5, s70
v_lshl_add_u32 v6, v6, 7, v7
v_lshl_add_u32 v6, v1, 1, v6
v_xor_b32 v7, 32, v6
s_mul_i32 s71, s63, 34
s_add_u32 s35, s71, 1
lw_43:
ds_read_b32 v5, v2 offset:16
s_waitcnt lgkmcnt(0)
v_cmp_gt_i32 vcc, s35, v5
s_cbranch_vccz lwd_44
s_sleep 1
s_sub_u32 s32, s32, 1
s_cmp_gt_i32 s32, 0
s_cbranch_scc1 lw_43
lwd_44:
ds_read_b64_tr_b16 v[24:25], v6 offset:0
ds_read_b64_tr_b16 v[26:27], v6 offset:512
ds_read_b64_tr_b16 v[28:29], v6 offset:4096
ds_read_b64_tr_b16 v[30:31], v6 offset:4608
ds_read_b64_tr_b16 v[32:33], v7 offset:0
ds_read_b64_tr_b16 v[34:35], v7 offset:512
ds_read_b64_tr_b16 v[36:37], v7 offset:4096
ds_read_b64_tr_b16 v[38:39], v7 offset:4608
ds_read_b64_tr_b16 v[40:41], v6 offset:8192
ds_read_b64_tr_b16 v[42:43], v6 offset:8704
ds_read_b64_tr_b16 v[44:45], v6 offset:12288
ds_read_b64_tr_b16 v[46:47], v6 offset:12800
ds_read_b64_tr_b16 v[48:49], v7 offset:8192
ds_read_b64_tr_b16 v[50:51], v7 offset:8704
ds_read_b64_tr_b16 v[52:53], v7 offset:12288
ds_read_b64_tr_b16 v[54:55], v7 offset:12800
s_lshl_b32 s72, s60, 14
s_lshl_b32 s70, s58, 9
s_add_u32 s72, s72, s70
s_lshl_b32 s70, s59, 10
s_add_u32 s71, s72, s70
s_lshl_b32 s76, s59, 14
s_add_u32 s73, s76, 30686208
s_add_u32 s76, s76, 266240
s_waitcnt lgkmcnt(14)
v_mfma_f32_16x16x32_bf16 v[248:251], v[8:11], v[24:27], 0
s_waitcnt lgkmcnt(10)
v_mfma_f32_16x16x32_bf16 v[252:255], v[8:11], v[32:35], 0
v_mfma_f32_16x16x32_bf16 v[248:251], v[12:15], v[28:31], v[248:251]
s_waitcnt lgkmcnt(8)
v_mfma_f32_16x16x32_bf16 v[252:255], v[12:15], v[36:39], v[252:255]
ds_read_b64_tr_b16 v[24:25], v6 offset:16384
ds_read_b64_tr_b16 v[26:27], v6 offset:16896
ds_read_b64_tr_b16 v[28:29], v6 offset:20480
ds_read_b64_tr_b16 v[30:31], v6 offset:20992
ds_read_b64_tr_b16 v[32:33], v7 offset:16384
ds_read_b64_tr_b16 v[34:35], v7 offset:16896
ds_read_b64_tr_b16 v[36:37], v7 offset:20480
ds_read_b64_tr_b16 v[38:39], v7 offset:20992
v_add_u32 v5, s34, 1
s_mov_b64 exec, 1
ds_write_b32 v3, v5
s_mov_b64 exec, -1
s_waitcnt lgkmcnt(14)
v_mfma_f32_16x16x32_bf16 v[16:19], v[8:11], v[40:43], 0
s_waitcnt lgkmcnt(11)
v_mfma_f32_16x16x32_bf16 v[20:23], v[8:11], v[48:51], 0
v_mfma_f32_16x16x32_bf16 v[16:19], v[12:15], v[44:47], v[16:19]
s_waitcnt lgkmcnt(9)
v_mfma_f32_16x16x32_bf16 v[20:23], v[12:15], v[52:55], v[20:23]
v_mov_b32 v249, v252
v_mov_b32 v252, s69
v_mov_b32 v253, s69
v_mov_b32 v254, s69
v_mov_b32 v255, s69
v_mfma_f32_16x16x32_bf16 v[52:55], v[8:11], v[8:11], 0
s_nop 0
v_mfma_f32_16x16x32_bf16 v[48:51], v[8:11], v[252:255], 0
v_mfma_f32_16x16x32_bf16 v[52:55], v[12:15], v[12:15], v[52:55]
v_mfma_f32_16x16x32_bf16 v[48:51], v[12:15], v[252:255], v[48:51]
s_waitcnt lgkmcnt(7)
v_mfma_f32_16x16x32_bf16 v[40:43], v[8:11], v[24:27], 0
s_waitcnt lgkmcnt(3)
v_mfma_f32_16x16x32_bf16 v[44:47], v[8:11], v[32:35], 0
v_mfma_f32_16x16x32_bf16 v[40:43], v[12:15], v[28:31], v[40:43]
s_waitcnt lgkmcnt(1)
v_mfma_f32_16x16x32_bf16 v[44:47], v[12:15], v[36:39], v[44:47]
v_lshlrev_b32 v6, 3, v0
v_and_b32 v7, 48, v0
v_mov_b32_dpp v248, v16 quad_perm:[0,1,2,3] row_mask:0x2 bank_mask:0xf
v_mov_b32_dpp v249, v20 quad_perm:[0,1,2,3] row_mask:0x2 bank_mask:0xf
s_nop 0
v_mov_b32_dpp v248, v48 quad_perm:[0,1,2,3] row_mask:0x8 bank_mask:0xf
v_mov_b32_dpp v249, v52 quad_perm:[0,1,2,3] row_mask:0x8 bank_mask:0xf
s_nop 0
v_mov_b32_dpp v248, v40 quad_perm:[0,1,2,3] row_mask:0x4 bank_mask:0xf
v_mov_b32_dpp v249, v44 quad_perm:[0,1,2,3] row_mask:0x4 bank_mask:0xf
v_max_u32 v248, 1, v248
v_max_u32 v249, 1, v249
s_cmp_eq_u32 s63, 0
s_cbranch_scc1 fst_40
fsb_41:
buffer_store_dwordx2 v[248:249], v6, s[24:27], s71 offen sc1
s_lshl4_add_u32 s70, s58, s60
s_add_u32 s70, s70, s34
s_cmp_eq_u32 s70, 51
s_cbranch_scc1 fxt_45
fxb_46:
s_add_u32 s73, s72, 4096
s_add_u32 s74, s72, 8192
s_add_u32 s75, s72, 12288
v_lshrrev_b32 v7, 2, v0
v_lshlrev_b32 v7, 7, v7
v_lshl_add_u32 v7, v1, 2, v7
v_lshrrev_b32 v8, 5, v0
v_lshrrev_b32 v9, 4, v0
v_xor_b32 v10, v8, v9
v_and_b32 v10, 1, v10
v_lshl_add_u32 v8, v10, 1, v8
v_and_b32 v10, 15, v0
v_lshlrev_b32 v8, 7, v8
v_lshl_add_u32 v8, v10, 3, v8
v_add_u32 v8, 1280, v8
s_mul_i32 s70, s58, 384
s_lshl_b32 s71, s63, 10
s_add_u32 s70, s70, s71
s_add_u32 s70, s70, 2304
v_lshl_add_u32 v9, v9, 7, s70
v_lshl_add_u32 v9, v10, 2, v9
s_cmp_eq_u32 s63, 0
s_cbranch_scc1 fg_47
fg_48:
poll_49:
buffer_load_dwordx4 v[12:15], v7, s[24:27], s76 offen sc1
pchk_50:
s_waitcnt vmcnt(0)
v_min3_u32 v10, v12, v13, v14
v_min_u32 v10, v10, v15
v_cmp_eq_u32 vcc, 0, v10
s_cbranch_vccz pdone_51
s_sub_u32 s32, s32, 1
s_cmp_gt_i32 s32, 0
s_cbranch_scc1 poll_49
pdone_51:
s_lshr_b32 s70, s33, 7
s_sub_u32 s70, s70, s59
s_mul_i32 s70, s70, s63
s_cmp_eq_u32 s70, 0
s_cbranch_scc0 fng_52
s_lshl1_add_u32 s70, s34, -32
s_add_u32 s35, s70, 15
lw_53:
ds_read_b32 v5, v2 offset:16
s_waitcnt lgkmcnt(0)
v_cmp_gt_i32 vcc, s35, v5
s_cbranch_vccz lwd_54
s_sleep 4
s_sub_u32 s32, s32, 1
s_cmp_gt_i32 s32, 0
s_cbranch_scc1 lw_53
lwd_54:
poll_55:
buffer_load_dwordx2 v[24:25], v6, s[24:27], s72 offen offset:0 sc1
buffer_load_dwordx2 v[26:27], v6, s[24:27], s72 offen offset:1024 sc1
buffer_load_dwordx2 v[28:29], v6, s[24:27], s72 offen offset:2048 sc1
buffer_load_dwordx2 v[30:31], v6, s[24:27], s72 offen offset:3072 sc1
buffer_load_dwordx2 v[32:33], v6, s[24:27], s73 offen offset:0 sc1
buffer_load_dwordx2 v[34:35], v6, s[24:27], s73 offen offset:1024 sc1
buffer_load_dwordx2 v[36:37], v6, s[24:27], s73 offen offset:2048 sc1
buffer_load_dwordx2 v[38:39], v6, s[24:27], s73 offen offset:3072 sc1
buffer_load_dwordx2 v[40:41], v6, s[24:27], s74 offen offset:0 sc1
buffer_load_dwordx2 v[42:43], v6, s[24:27], s74 offen offset:1024 sc1
buffer_load_dwordx2 v[44:45], v6, s[24:27], s74 offen offset:2048 sc1
buffer_load_dwordx2 v[46:47], v6, s[24:27], s74 offen offset:3072 sc1
buffer_load_dwordx2 v[48:49], v6, s[24:27], s75 offen offset:0 sc1
buffer_load_dwordx2 v[50:51], v6, s[24:27], s75 offen offset:1024 sc1
buffer_load_dwordx2 v[52:53], v6, s[24:27], s75 offen offset:2048 sc1
buffer_load_dwordx2 v[54:55], v6, s[24:27], s75 offen offset:3072 sc1
pchk_56:
s_waitcnt vmcnt(14)
v_min3_u32 v10, v24, v25, v26
s_waitcnt vmcnt(13)
v_min3_u32 v10, v10, v27, v28
s_waitcnt vmcnt(12)
v_min3_u32 v10, v10, v29, v30
s_waitcnt vmcnt(11)
v_min3_u32 v10, v10, v31, v32
s_waitcnt vmcnt(10)
v_min3_u32 v10, v10, v33, v34
s_waitcnt vmcnt(9)
v_min3_u32 v10, v10, v35, v36
s_waitcnt vmcnt(8)
v_min3_u32 v10, v10, v37, v38
s_waitcnt vmcnt(7)
v_min3_u32 v10, v10, v39, v40
s_waitcnt vmcnt(6)
v_min3_u32 v10, v10, v41, v42
s_waitcnt vmcnt(5)
v_min3_u32 v10, v10, v43, v44
s_waitcnt vmcnt(4)
v_min3_u32 v10, v10, v45, v46
s_waitcnt vmcnt(3)
v_min3_u32 v10, v10, v47, v48
s_waitcnt vmcnt(2)
v_min3_u32 v10, v10, v49, v50
s_waitcnt vmcnt(1)
v_min3_u32 v10, v10, v51, v52
s_waitcnt vmcnt(0)
v_min3_u32 v10, v10, v53, v54
v_min_u32 v10, v10, v55
v_cmp_eq_u32 vcc, 0, v10
s_cbranch_vccz pdone_57
s_sub_u32 s32, s32, 1
s_cmp_gt_i32 s32, 0
s_cbranch_scc1 poll_55
pdone_57:
v_add_f32 v24, v24, v40
v_add_f32 v25, v25, v41
v_add_f32 v26, v26, v42
v_add_f32 v27, v27, v43
v_add_f32 v28, v28, v44
v_add_f32 v29, v29, v45
v_add_f32 v30, v30, v46
v_add_f32 v31, v31, v47
v_add_f32 v32, v32, v48
v_add_f32 v33, v33, v49
v_add_f32 v34, v34, v50
v_add_f32 v35, v35, v51
v_add_f32 v36, v36, v52
v_add_f32 v37, v37, v53
v_add_f32 v38, v38, v54
v_add_f32 v39, v39, v55
v_add_f32 v24, v24, v32
v_add_f32 v25, v25, v33
v_add_f32 v26, v26, v34
v_add_f32 v27, v27, v35
v_add_f32 v28, v28, v36
v_add_f32 v29, v29, v37
v_add_f32 v30, v30, v38
v_add_f32 v31, v31, v39
v_add_f32 v24, v24, v28
v_add_f32 v25, v25, v29
v_add_f32 v26, v26, v30
v_add_f32 v27, v27, v31
v_add_f32 v24, v24, v26
v_add_f32 v25, v25, v27
s_mov_b32 exec_hi, 0xffff
ds_write2_b32 v9, v24, v25 offset1:16
s_mov_b32 exec_hi, -1
v_mul_f32 v5, 0xba800000, v24
v_mul_f32 v25, 0x3a800000, v25
v_fma_f32 v25, -v5, v5, v25
v_max_f32 v25, 0, v25
v_add_f32 v25, 0x3727c5ac, v25
v_rsq_f32 v24, v25
s_nop 0
v_mul_f32 v25, v5, v24
s_lshl_b32 s70, s59, 7
s_sub_u32 s70, s33, s70
v_lshlrev_b32 v10, 1, v0
v_sub_u32 v10, s70, v10
v_readlane_b32 s70, v24, 48
v_readlane_b32 s71, v25, 48
v_cmp_eq_u32 vcc, 0, v10
s_mov_b64 exec, vcc
v_mov_b32 v12, s70
v_mov_b32 v13, s71
s_mov_b64 exec, -1
v_cmp_eq_u32 vcc, 1, v10
s_mov_b64 exec, vcc
v_mov_b32 v14, s70
v_mov_b32 v15, s71
s_mov_b64 exec, -1
fng_52:
ds_write2_b32 v8, v12, v14 offset1:1
ds_write2_b32 v8, v13, v15 offset0:128 offset1:129
s_add_u32 s71, s34, s63
v_add_u32 v5, s71, 2
s_mov_b64 exec, 1
ds_write_b32 v3, v5
s_mov_b64 exec, -1
s_setprio 0
s_cmp_eq_u32 s63, 0
s_cbranch_scc1 fnw_58
fnw_59:
s_and_b32 s70, s64, 7
s_lshl_b32 s70, s70, 7
s_add_u32 s73, s70, 276480
s_lshl1_add_u32 s72, s70, 272384
s_lshr_b32 s71, s64, 3
s_lshl_b32 s76, s71, 13
s_add_u32 s76, s76, 1048576
s_lshl2_add_u32 s74, s70, s76
s_lshl_b32 s70, s58, 8
s_add_u32 s74, s74, s70
s_add_u32 s75, s74, 4096
s_lshl4_add_u32 s76, s70, s76
v_and_b32 v251, 15, v0
v_lshlrev_b32 v6, 14, v251
v_lshrrev_b32 v252, 4, v0
v_lshl_add_u32 v7, v252, 5, v6
v_lshlrev_b32 v251, 4, v251
s_lshl_b32 s70, s58, 3
v_lshl_add_u32 v253, v252, 1, s70
v_add_u32 v253, v253, v251
v_lshlrev_b32 v254, 5, v252
v_lshl_add_u32 v254, v2, 2, v254
v_and_b32 v255, 7, v0
v_lshl_add_u32 v255, v255, 2, v252
v_lshlrev_b32 v255, 3, v255
s_add_u32 s35, s34, 22
lw_60:
ds_read_b32 v5, v1 offset:0
s_waitcnt lgkmcnt(0)
v_cmp_gt_i32 vcc, s35, v5
s_cbranch_vccz lwd_61
s_sleep 4
s_sub_u32 s32, s32, 1
s_cmp_gt_i32 s32, 0
s_cbranch_scc1 lw_60
lwd_61:
s_setprio 3
s_add_u32 s35, s34, 24
lw_62:
ds_read_b32 v5, v1 offset:0
s_waitcnt lgkmcnt(0)
v_cmp_gt_i32 vcc, s35, v5
s_cbranch_vccz lwd_63
s_sleep 2
s_sub_u32 s32, s32, 1
s_cmp_gt_i32 s32, 0
s_cbranch_scc1 lw_62
lwd_63:
s_mul_i32 s79, s63, 64
s_sub_u32 s79, 32, s79
s_add_u32 s35, s79, 3
tw_64:
ds_read_b32 v5, v2 offset:16
s_waitcnt lgkmcnt(0)
v_cmp_gt_i32 vcc, s35, v5
s_cbranch_vccz twd_65
v_readfirstlane_b32 s54, v5
s_sub_u32 s55, s35, s54
s_cmp_lt_i32 s55, 2
s_cbranch_scc1 tws_66
s_add_u32 s54, s54, 2
s_or_b32 s54, s54, 1
s_cmp_eq_u32 s54, s52
s_cbranch_scc1 tws_66
s_bitcmp1_b32 s54, 4
s_cbranch_scc1 tws_66
s_mov_b32 s52, s54
s_add_u32 s54, s54, s53
s_and_b32 s54, s54, 15
s_mul_i32 s54, s54, 393216
s_add_u32 s54, s54, s56
s_buffer_load_dwordx2 s[46:47], s[48:51], s54 offset:4096
s_buffer_load_dwordx2 s[46:47], s[48:51], s54 offset:10240
s_buffer_load_dwordx2 s[46:47], s[48:51], s54 offset:16384
s_buffer_load_dwordx2 s[46:47], s[48:51], s54 offset:22528
tws_66:
s_sleep 4
s_sub_u32 s32, s32, 1
s_cmp_gt_i32 s32, 0
s_cbranch_scc1 tw_64
twd_65:
s_cmp_eq_u32 s65, 0
s_cbranch_scc0 fnd_68
poll_69:
buffer_load_dwordx2 v[248:249], v6, s[24:27], s73 offen sc1
buffer_load_dwordx4 v[8:11], v7, s[24:27], s72 offen offset:0 sc1
buffer_load_dwordx4 v[12:15], v7, s[24:27], s72 offen offset:16 sc1
buffer_load_dwordx4 v[16:19], v7, s[24:27], s72 offen offset:128 sc1
buffer_load_dwordx4 v[20:23], v7, s[24:27], s72 offen offset:144 sc1
pchk_70:
s_waitcnt vmcnt(3)
v_min3_u32 v5, v248, v249, v8
v_min3_u32 v5, v5, v9, v10
s_waitcnt vmcnt(2)
v_min3_u32 v5, v5, v11, v12
v_min3_u32 v5, v5, v13, v14
s_waitcnt vmcnt(1)
v_min3_u32 v5, v5, v15, v16
v_min3_u32 v5, v5, v17, v18
s_waitcnt vmcnt(0)
v_min3_u32 v5, v5, v19, v20
v_min3_u32 v5, v5, v21, v22
v_min_u32 v5, v5, v23
v_cmp_eq_u32 vcc, 0, v5
s_cbranch_vccz pdone_71
s_sub_u32 s32, s32, 1
s_cmp_gt_i32 s32, 0
s_cbranch_scc1 poll_69
pdone_71:
v_mfma_f32_16x16x32_bf16 v[24:27], v[8:11], v[56:59], 0
v_mov_b32 v250, v248
v_mfma_f32_16x16x32_bf16 v[28:31], v[8:11], v[60:63], 0
s_nop 0
v_max_f32_dpp v250, v250, v250 row_ror:1 row_mask:0xf bank_mask:0xf
v_mfma_f32_16x16x32_bf16 v[32:35], v[8:11], v[64:67], 0
s_nop 0
v_max_f32_dpp v250, v250, v250 row_ror:2 row_mask:0xf bank_mask:0xf
v_mfma_f32_16x16x32_bf16 v[36:39], v[8:11], v[68:71], 0
s_nop 0
v_max_f32_dpp v250, v250, v250 row_ror:4 row_mask:0xf bank_mask:0xf
v_mfma_f32_16x16x32_bf16 v[40:43], v[8:11], v[72:75], 0
s_nop 0
v_max_f32_dpp v250, v250, v250 row_ror:8 row_mask:0xf bank_mask:0xf
v_mfma_f32_16x16x32_bf16 v[44:47], v[8:11], v[76:79], 0
v_cmp_eq_f32 vcc, v250, v248
v_mfma_f32_16x16x32_bf16 v[48:51], v[8:11], v[80:83], 0
s_ff1_i32_b64 s68, vcc
v_mfma_f32_16x16x32_bf16 v[52:55], v[8:11], v[84:87], 0
s_and_b32 s68, s68, 15
v_mfma_f32_16x16x32_bf16 v[24:27], v[12:15], v[88:91], v[24:27]
v_readlane_b32 s33, v249, s68
v_mfma_f32_16x16x32_bf16 v[28:31], v[12:15], v[92:95], v[28:31]
v_readlane_b32 s67, v248, s68
v_mfma_f32_16x16x32_bf16 v[32:35], v[12:15], v[96:99], v[32:35]
v_add_u32 v5, s34, 4
v_mfma_f32_16x16x32_bf16 v[36:39], v[12:15], v[100:103], v[36:39]
v_mov_b32 v250, s33
v_mfma_f32_16x16x32_bf16 v[40:43], v[12:15], v[104:107], v[40:43]
s_mov_b64 exec, 1
ds_write2_b32 v3, v5, v250 offset1:2
s_mov_b64 exec, -1
v_mfma_f32_16x16x32_bf16 v[44:47], v[12:15], v[108:111], v[44:47]
s_sub_u32 s33, s33, 1
v_mfma_f32_16x16x32_bf16 v[48:51], v[12:15], v[112:115], v[48:51]
s_and_b32 s33, s33, 2047
v_mfma_f32_16x16x32_bf16 v[52:55], v[12:15], v[116:119], v[52:55]
v_mfma_f32_16x16x32_bf16 v[24:27], v[16:19], v[120:123], v[24:27]
v_mfma_f32_16x16x32_bf16 v[28:31], v[16:19], v[124:127], v[28:31]
v_mfma_f32_16x16x32_bf16 v[32:35], v[16:19], v[128:131], v[32:35]
v_mfma_f32_16x16x32_bf16 v[36:39], v[16:19], v[132:135], v[36:39]
v_mfma_f32_16x16x32_bf16 v[40:43], v[16:19], v[136:139], v[40:43]
v_mfma_f32_16x16x32_bf16 v[44:47], v[16:19], v[140:143], v[44:47]
v_mfma_f32_16x16x32_bf16 v[48:51], v[16:19], v[144:147], v[48:51]
v_mfma_f32_16x16x32_bf16 v[52:55], v[16:19], v[148:151], v[52:55]
v_mfma_f32_16x16x32_bf16 v[24:27], v[20:23], v[152:155], v[24:27]
s_and_b32 s70, s68, 12
s_lshl_b32 s70, s70, 2
s_bitcmp1_b32 s68, 1
v_mfma_f32_16x16x32_bf16 v[28:31], v[20:23], v[156:159], v[28:31]
v_mfma_f32_16x16x32_bf16 v[32:35], v[20:23], v[160:163], v[32:35]
v_mfma_f32_16x16x32_bf16 v[36:39], v[20:23], v[164:167], v[36:39]
v_mfma_f32_16x16x32_bf16 v[40:43], v[20:23], v[168:171], v[40:43]
v_mfma_f32_16x16x32_bf16 v[44:47], v[20:23], v[172:175], v[44:47]
v_mfma_f32_16x16x32_bf16 v[48:51], v[20:23], v[176:179], v[48:51]
v_mfma_f32_16x16x32_bf16 v[52:55], v[20:23], v[180:183], v[52:55]
s_cbranch_scc1 fsel_74
fsel_72:
s_bitcmp1_b32 s68, 0
s_cbranch_scc1 fsel_73
v_max_u32 v8, 1, v24
v_max_u32 v9, 1, v28
v_max_u32 v10, 1, v32
v_max_u32 v11, 1, v36
v_max_u32 v12, 1, v40
v_max_u32 v13, 1, v44
v_max_u32 v14, 1, v48
v_max_u32 v15, 1, v52
s_branch fsel_76
fsel_73:
v_max_u32 v8, 1, v25
v_max_u32 v9, 1, v29
v_max_u32 v10, 1, v33
v_max_u32 v11, 1, v37
v_max_u32 v12, 1, v41
v_max_u32 v13, 1, v45
v_max_u32 v14, 1, v49
v_max_u32 v15, 1, v53
s_branch fsel_76
fsel_74:
s_bitcmp1_b32 s68, 0
s_cbranch_scc1 fsel_75
v_max_u32 v8, 1, v26
v_max_u32 v9, 1, v30
v_max_u32 v10, 1, v34
v_max_u32 v11, 1, v38
v_max_u32 v12, 1, v42
v_max_u32 v13, 1, v46
v_max_u32 v14, 1, v50
v_max_u32 v15, 1, v54
s_branch fsel_76
fsel_75:
v_max_u32 v8, 1, v27
v_max_u32 v9, 1, v31
v_max_u32 v10, 1, v35
v_max_u32 v11, 1, v39
v_max_u32 v12, 1, v43
v_max_u32 v13, 1, v47
v_max_u32 v14, 1, v51
v_max_u32 v15, 1, v55
fsel_76:
s_bfm_b64 exec, 16, s70
buffer_store_dwordx4 v[8:11], v251, s[24:27], s74 offen sc1
buffer_store_dwordx4 v[12:15], v251, s[24:27], s75 offen sc1
s_mov_b64 exec, -1
s_and_b32 s70, s64, 7
s_lshl1_add_u32 s70, s70, s58
s_mul_i32 s70, s70, 28
s_add_u32 s70, s70, s71
s_lshl_b32 s70, s70, 8
s_add_u32 s70, s70, 1277952
s_waitcnt vmcnt(0)
s_mul_i32 s79, s63, 64
s_sub_u32 s79, 32, s79
s_add_u32 s35, s79, 7
tw_77:
ds_read_b32 v5, v2 offset:16
s_waitcnt lgkmcnt(0)
v_cmp_gt_i32 vcc, s35, v5
s_cbranch_vccz twd_78
v_readfirstlane_b32 s54, v5
s_sub_u32 s55, s35, s54
s_cmp_lt_i32 s55, 2
s_cbranch_scc1 tws_79
s_add_u32 s54, s54, 2
s_or_b32 s54, s54, 1
s_cmp_eq_u32 s54, s52
s_cbranch_scc1 tws_79
s_bitcmp1_b32 s54, 4
s_cbranch_scc1 tws_79
s_mov_b32 s52, s54
s_add_u32 s54, s54, s53
s_and_b32 s54, s54, 15
s_mul_i32 s54, s54, 393216
s_add_u32 s54, s54, s56
s_buffer_load_dwordx2 s[46:47], s[48:51], s54 offset:4096
s_buffer_load_dwordx2 s[46:47], s[48:51], s54 offset:10240
s_buffer_load_dwordx2 s[46:47], s[48:51], s54 offset:16384
s_buffer_load_dwordx2 s[46:47], s[48:51], s54 offset:22528
tws_79:
s_sleep 4
s_sub_u32 s32, s32, 1
s_cmp_gt_i32 s32, 0
s_cbranch_scc1 tw_77
twd_78:
poll_80:
buffer_load_dwordx4 v[24:27], v4, s[24:27], s76 offen offset:0 sc1
buffer_load_dwordx4 v[28:31], v4, s[24:27], s76 offen offset:1024 sc1
buffer_load_dwordx4 v[32:35], v4, s[24:27], s76 offen offset:2048 sc1
buffer_load_dwordx4 v[36:39], v4, s[24:27], s76 offen offset:3072 sc1
pchk_81:
s_waitcnt vmcnt(3)
v_min3_u32 v5, v24, v25, v26
s_waitcnt vmcnt(2)
v_min3_u32 v5, v5, v27, v28
v_min3_u32 v5, v5, v29, v30
s_waitcnt vmcnt(1)
v_min3_u32 v5, v5, v31, v32
v_min3_u32 v5, v5, v33, v34
s_waitcnt vmcnt(0)
v_min3_u32 v5, v5, v35, v36
v_min3_u32 v5, v5, v37, v38
v_min_u32 v5, v5, v39
v_cmp_eq_u32 vcc, 0, v5
s_cbranch_vccz pdone_82
s_sub_u32 s32, s32, 1
s_cmp_gt_i32 s32, 0
s_cbranch_scc1 poll_80
pdone_82:
v_add_f32 v24, v24, v32
v_add_f32 v25, v25, v33
v_add_f32 v26, v26, v34
v_add_f32 v27, v27, v35
v_add_f32 v28, v28, v36
v_add_f32 v29, v29, v37
v_add_f32 v30, v30, v38
v_add_f32 v31, v31, v39
v_add_f32 v24, v24, v28
v_add_f32 v25, v25, v29
v_add_f32 v26, v26, v30
v_add_f32 v27, v27, v31
s_nop 0
v_permlane32_swap_b32 v24, v26
v_permlane32_swap_b32 v25, v27
v_add_f32 v24, v24, v26
v_add_f32 v25, v25, v27
s_nop 1
v_permlane16_swap_b32 v24, v25
v_mul_f32 v26, 0xbfb8aa3b, v24
v_exp_f32 v26, v26
v_mul_f32 v24, v24, v25
v_add_f32 v26, 1.0, v26
v_rcp_f32 v26, v26
v_add_u32 v5, s34, 5
v_mul_f32 v24, v24, v26
v_cvt_pk_bf16_f32 v24, v24, v24
ds_write_b16 v253, v24 offset:512
s_mov_b64 exec, 1
ds_write_b32 v3, v5
s_mov_b64 exec, -1
s_add_u32 s35, s34, 5
poll_83:
ds_read_b32 v5, v2 offset:24
ds_read_b128 v[8:11], v254 offset:512
ds_read_b128 v[12:15], v254 offset:640
pchk_84:
s_waitcnt lgkmcnt(2)
v_cmp_gt_i32 vcc, s35, v5
s_cbranch_vccz pdone_85
s_sleep 1
s_sub_u32 s32, s32, 1
s_cmp_gt_i32 s32, 0
s_cbranch_scc1 poll_83
pdone_85:
s_waitcnt lgkmcnt(1)
v_mfma_f32_16x16x32_bf16 v[24:27], v[8:11], v[184:187], 0
v_mfma_f32_16x16x32_bf16 v[28:31], v[8:11], v[188:191], 0
v_mfma_f32_16x16x32_bf16 v[32:35], v[8:11], v[192:195], 0
v_mfma_f32_16x16x32_bf16 v[36:39], v[8:11], v[196:199], 0
v_mfma_f32_16x16x32_bf16 v[40:43], v[8:11], v[200:203], 0
v_mfma_f32_16x16x32_bf16 v[44:47], v[8:11], v[204:207], 0
v_mfma_f32_16x16x32_bf16 v[48:51], v[8:11], v[208:211], 0
v_mfma_f32_16x16x32_bf16 v[52:55], v[8:11], v[212:215], 0
s_waitcnt lgkmcnt(0)
v_mfma_f32_16x16x32_bf16 v[24:27], v[12:15], v[216:219], v[24:27]
v_mfma_f32_16x16x32_bf16 v[28:31], v[12:15], v[220:223], v[28:31]
v_mfma_f32_16x16x32_bf16 v[32:35], v[12:15], v[224:227], v[32:35]
v_mfma_f32_16x16x32_bf16 v[36:39], v[12:15], v[228:231], v[36:39]
v_mfma_f32_16x16x32_bf16 v[40:43], v[12:15], v[232:235], v[40:43]
v_mfma_f32_16x16x32_bf16 v[44:47], v[12:15], v[236:239], v[44:47]
v_mfma_f32_16x16x32_bf16 v[48:51], v[12:15], v[240:243], v[48:51]
v_mfma_f32_16x16x32_bf16 v[52:55], v[12:15], v[244:247], v[52:55]
s_nop 0
v_add_f32_dpp v16, v25, v24 row_ror:8 row_mask:0x1 bank_mask:0xf
v_add_f32_dpp v17, v29, v28 row_ror:8 row_mask:0x1 bank_mask:0xf
s_nop 0
v_add_f32_dpp v16, v33, v32 row_ror:8 row_mask:0x2 bank_mask:0xf
v_add_f32_dpp v17, v37, v36 row_ror:8 row_mask:0x2 bank_mask:0xf
s_nop 0
v_add_f32_dpp v16, v41, v40 row_ror:8 row_mask:0x4 bank_mask:0xf
v_add_f32_dpp v17, v45, v44 row_ror:8 row_mask:0x4 bank_mask:0xf
s_nop 0
v_add_f32_dpp v16, v49, v48 row_ror:8 row_mask:0x8 bank_mask:0xf
v_add_f32_dpp v17, v53, v52 row_ror:8 row_mask:0x8 bank_mask:0xf
v_max_u32 v16, 1, v16
v_max_u32 v17, 1, v17
s_mov_b32 exec_lo, 0x00ff00ff
s_mov_b32 exec_hi, 0x00ff00ff
buffer_store_dwordx2 v[16:17], v255, s[24:27], s70 offen sc1
s_mov_b64 exec, -1
fnd_67:
s_sub_u32 s70, s60, 3
s_mul_i32 s70, s70, s63
s_or_b32 s70, s70, s58
s_cbranch_scc1 fnr_86
s_mul_i32 s72, s59, 7168
s_add_u32 s72, s72, 1277952
s_add_u32 s73, s72, 4096
s_lshl_b32 s70, s68, 6
s_add_u32 s70, s70, s59
s_lshl_b32 s70, s70, 8
s_add_u32 s76, s70, 262144
v_mov_b32 v12, s67
v_mul_f32 v12, 0xbfb8aa3b, v12
v_exp_f32 v12, v12
v_lshl_add_u32 v6, v252, 2, v251
v_add_f32 v12, 1.0, v12
v_rcp_f32 v12, v12
v_lshrrev_b32 v7, 1, v6
s_lshl4_add_u32 s70, s33, s59
s_lshl_b32 s70, s70, 7
v_and_b32 v8, 0x46, v7
v_lshl_add_u32 v8, v1, 2, v8
v_and_b32 v9, 4, v0
v_lshl_add_u32 v8, v9, 1, v8
s_waitcnt vmcnt(0)
s_cmp_gt_u32 s65, s63
s_cbranch_scc1 fpre_88
fpre_89:
s_mul_i32 s79, s63, 64
s_sub_u32 s79, 32, s79
s_add_u32 s35, s79, 11
tw_90:
ds_read_b32 v5, v2 offset:16
s_waitcnt lgkmcnt(0)
v_cmp_gt_i32 vcc, s35, v5
s_cbranch_vccz twd_91
v_readfirstlane_b32 s54, v5
s_sub_u32 s55, s35, s54
s_cmp_lt_i32 s55, 2
s_cbranch_scc1 tws_92
s_add_u32 s54, s54, 2
s_or_b32 s54, s54, 1
s_cmp_eq_u32 s54, s52
s_cbranch_scc1 tws_92
s_bitcmp1_b32 s54, 4
s_cbranch_scc1 tws_92
s_mov_b32 s52, s54
s_add_u32 s54, s54, s53
s_and_b32 s54, s54, 15
s_mul_i32 s54, s54, 393216
s_add_u32 s54, s54, s56
s_buffer_load_dwordx2 s[46:47], s[48:51], s54 offset:4096
s_buffer_load_dwordx2 s[46:47], s[48:51], s54 offset:10240
s_buffer_load_dwordx2 s[46:47], s[48:51], s54 offset:16384
s_buffer_load_dwordx2 s[46:47], s[48:51], s54 offset:22528
tws_92:
s_sleep 4
s_sub_u32 s32, s32, 1
s_cmp_gt_i32 s32, 0
s_cbranch_scc1 tw_90
twd_91:
poll_93:
buffer_load_dword v52, v6, s[24:27], s76 offen sc1
buffer_load_dwordx4 v[24:27], v4, s[24:27], s72 offen offset:0 sc1
buffer_load_dwordx4 v[28:31], v4, s[24:27], s72 offen offset:1024 sc1
buffer_load_dwordx4 v[32:35], v4, s[24:27], s72 offen offset:2048 sc1
buffer_load_dwordx4 v[36:39], v4, s[24:27], s72 offen offset:3072 sc1
buffer_load_dwordx4 v[40:43], v4, s[24:27], s73 offen offset:0 sc1
buffer_load_dwordx4 v[44:47], v4, s[24:27], s73 offen offset:1024 sc1
buffer_load_dwordx4 v[48:51], v4, s[24:27], s73 offen offset:2048 sc1
pchk_94:
s_waitcnt vmcnt(6)
v_min3_u32 v5, v24, v25, v26
s_waitcnt vmcnt(5)
v_min3_u32 v5, v5, v27, v28
v_min3_u32 v5, v5, v29, v30
s_waitcnt vmcnt(4)
v_min3_u32 v5, v5, v31, v32
v_min3_u32 v5, v5, v33, v34
s_waitcnt vmcnt(3)
v_min3_u32 v5, v5, v35, v36
v_min3_u32 v5, v5, v37, v38
s_waitcnt vmcnt(2)
v_min3_u32 v5, v5, v39, v40
v_min3_u32 v5, v5, v41, v42
s_waitcnt vmcnt(1)
v_min3_u32 v5, v5, v43, v44
v_min3_u32 v5, v5, v45, v46
s_waitcnt vmcnt(0)
v_min3_u32 v5, v5, v47, v48
v_min3_u32 v5, v5, v49, v50
v_min3_u32 v5, v5, v51, v52
v_cmp_eq_u32 vcc, 0, v5
s_cbranch_vccz pdone_95
s_sub_u32 s32, s32, 1
s_cmp_gt_i32 s32, 0
s_cbranch_scc1 poll_93
pdone_95:
v_add_f32 v24, v24, v40
v_add_f32 v25, v25, v41
v_add_f32 v26, v26, v42
v_add_f32 v27, v27, v43
v_add_f32 v28, v28, v44
v_add_f32 v29, v29, v45
v_add_f32 v30, v30, v46
v_add_f32 v31, v31, v47
v_add_f32 v32, v32, v48
v_add_f32 v33, v33, v49
v_add_f32 v34, v34, v50
v_add_f32 v35, v35, v51
v_add_f32 v24, v24, v32
v_add_f32 v25, v25, v33
v_add_f32 v26, v26, v34
v_add_f32 v27, v27, v35
v_add_f32 v28, v28, v36
v_add_f32 v29, v29, v37
v_add_f32 v30, v30, v38
v_add_f32 v31, v31, v39
v_add_f32 v24, v24, v28
v_add_f32 v25, v25, v29
v_add_f32 v26, v26, v30
v_add_f32 v27, v27, v31
s_nop 0
v_permlane32_swap_b32 v24, v26
v_permlane32_swap_b32 v25, v27
v_add_f32 v24, v24, v26
v_add_f32 v25, v25, v27
s_nop 1
v_permlane16_swap_b32 v24, v25
v_add_f32 v24, v24, v25
v_fma_f32 v24, v24, v12, v52
v_cvt_pk_bf16_f32 v24, v24, v24
s_cmp_eq_u32 s63, 0
s_cbranch_scc1 fl0_87
buffer_store_short v24, v7, s[28:31], s70 offen
s_branch L_end
fl0_87:
ds_write_b16 v8, v24 offset:384
fnr_86:
s_cmp_eq_u32 s63, 0
s_cbranch_scc0 L_end
v_add_u32 v5, s34, 6
s_mov_b64 exec, 1
ds_write_b32 v3, v5
s_mov_b64 exec, -1
s_mul_i32 s79, s63, 64
s_sub_u32 s79, 32, s79
s_add_u32 s35, s79, 11
tw_96:
ds_read_b32 v5, v2 offset:16
s_waitcnt lgkmcnt(0)
v_cmp_gt_i32 vcc, s35, v5
s_cbranch_vccz twd_97
v_readfirstlane_b32 s54, v5
s_sub_u32 s55, s35, s54
s_cmp_lt_i32 s55, 2
s_cbranch_scc1 tws_98
s_add_u32 s54, s54, 2
s_or_b32 s54, s54, 1
s_cmp_eq_u32 s54, s52
s_cbranch_scc1 tws_98
s_bitcmp1_b32 s54, 4
s_cbranch_scc1 tws_98
s_mov_b32 s52, s54
s_add_u32 s54, s54, s53
s_and_b32 s54, s54, 15
s_mul_i32 s54, s54, 393216
s_add_u32 s54, s54, s56
s_buffer_load_dwordx2 s[46:47], s[48:51], s54 offset:4096
s_buffer_load_dwordx2 s[46:47], s[48:51], s54 offset:10240
s_buffer_load_dwordx2 s[46:47], s[48:51], s54 offset:16384
s_buffer_load_dwordx2 s[46:47], s[48:51], s54 offset:22528
tws_98:
s_sleep 4
s_sub_u32 s32, s32, 1
s_cmp_gt_i32 s32, 0
s_cbranch_scc1 tw_96
twd_97:
v_and_b32 v6, 48, v0
s_add_u32 s35, s34, 6
poll_99:
ds_read_b32 v5, v2 offset:24
ds_read_b128 v[8:11], v6 offset:384
ds_read_b128 v[12:15], v6 offset:448
pchk_100:
s_waitcnt lgkmcnt(2)
v_cmp_gt_i32 vcc, s35, v5
s_cbranch_vccz pdone_101
s_sleep 1
s_sub_u32 s32, s32, 1
s_cmp_gt_i32 s32, 0
s_cbranch_scc1 poll_99
pdone_101:
s_mov_b32 s63, 1
s_mov_b32 s34, 32
s_add_u32 s24, s24, 1409024
s_addc_u32 s25, s25, 0
s_mov_b32 s26, 1409024
s_mov_b32 s70, 131072
s_mov_b32 s79, 34
s_branch ftop_42
fxt_45:
v_max_u32 v8, 1, v8
v_max_u32 v9, 1, v9
v_max_u32 v10, 1, v10
v_max_u32 v11, 1, v11
v_max_u32 v12, 1, v12
v_max_u32 v13, 1, v13
v_max_u32 v14, 1, v14
v_max_u32 v15, 1, v15
s_mov_b32 exec_lo, 0x10001
s_mov_b32 exec_hi, 0x10001
buffer_store_dwordx4 v[8:11], v7, s[20:23], s73 offen offset:0 sc1
buffer_store_dwordx4 v[12:15], v7, s[20:23], s73 offen offset:64 sc1
s_mov_b64 exec, -1
s_branch fxb_46
fst_40:
s_lshl1_add_u32 s70, s78, s58
s_lshl_b32 s70, s70, 13
v_bfe_u32 v8, v0, 2, 2
v_lshl_add_u32 v8, v8, 9, v7
v_add_u32 v8, v8, v1
v_lshlrev_b32 v8, 2, v8
buffer_load_dwordx4 v[24:27], v8, s[8:11], s70 offen offset:0
buffer_load_dwordx4 v[28:31], v8, s[8:11], s70 offen offset:256
buffer_load_dwordx4 v[32:35], v8, s[8:11], s70 offen offset:512
buffer_load_dwordx4 v[36:39], v8, s[8:11], s70 offen offset:768
buffer_load_dwordx4 v[40:43], v8, s[8:11], s70 offen offset:1024
buffer_load_dwordx4 v[44:47], v8, s[8:11], s70 offen offset:1280
buffer_load_dwordx4 v[48:51], v8, s[8:11], s70 offen offset:1536
buffer_load_dwordx4 v[52:55], v8, s[8:11], s70 offen offset:1792
v_lshlrev_b32 v9, 4, v1
s_waitcnt vmcnt(7)
v_mfma_f32_16x16x32_bf16 v[16:19], v[24:27], v[252:255], 0
v_mfma_f32_16x16x32_bf16 v[20:23], v[24:27], v[24:27], 0
s_waitcnt vmcnt(6)
v_mfma_f32_16x16x32_bf16 v[16:19], v[28:31], v[252:255], v[16:19]
v_mfma_f32_16x16x32_bf16 v[20:23], v[28:31], v[28:31], v[20:23]
s_waitcnt vmcnt(5)
v_mfma_f32_16x16x32_bf16 v[16:19], v[32:35], v[252:255], v[16:19]
v_mfma_f32_16x16x32_bf16 v[20:23], v[32:35], v[32:35], v[20:23]
s_waitcnt vmcnt(4)
v_mfma_f32_16x16x32_bf16 v[16:19], v[36:39], v[252:255], v[16:19]
v_mfma_f32_16x16x32_bf16 v[20:23], v[36:39], v[36:39], v[20:23]
s_waitcnt vmcnt(3)
v_mfma_f32_16x16x32_bf16 v[16:19], v[40:43], v[252:255], v[16:19]
v_mfma_f32_16x16x32_bf16 v[20:23], v[40:43], v[40:43], v[20:23]
s_waitcnt vmcnt(2)
v_mfma_f32_16x16x32_bf16 v[16:19], v[44:47], v[252:255], v[16:19]
v_mfma_f32_16x16x32_bf16 v[20:23], v[44:47], v[44:47], v[20:23]
s_waitcnt vmcnt(1)
v_mfma_f32_16x16x32_bf16 v[16:19], v[48:51], v[252:255], v[16:19]
v_mfma_f32_16x16x32_bf16 v[20:23], v[48:51], v[48:51], v[20:23]
s_waitcnt vmcnt(0)
v_mfma_f32_16x16x32_bf16 v[16:19], v[52:55], v[252:255], v[16:19]
v_mfma_f32_16x16x32_bf16 v[20:23], v[52:55], v[52:55], v[20:23]
s_nop 6
v_add_f32 v16, v16, v18
v_add_f32 v17, v17, v19
v_add_f32 v16, v16, v17
s_nop 0
v_mov_b32_dpp v17, v20 quad_perm:[0,0,0,0] row_mask:0xf bank_mask:0xf
s_nop 1
v_add_f32_dpp v17, v21, v17 quad_perm:[1,1,1,1] row_mask:0xf bank_mask:0xf
s_nop 1
v_add_f32_dpp v17, v22, v17 quad_perm:[2,2,2,2] row_mask:0xf bank_mask:0xf
s_nop 1
v_add_f32_dpp v17, v23, v17 quad_perm:[3,3,3,3] row_mask:0xf bank_mask:0xf
v_mul_f32 v5, 0xba800000, v16
v_mul_f32 v17, 0x3a800000, v17
v_fma_f32 v17, -v5, v5, v17
v_max_f32 v17, 0, v17
v_add_f32 v17, 0x3727c5ac, v17
v_rsq_f32 v16, v17
s_nop 0
v_mul_f32 v17, v5, v16
v_max_u32 v17, 1, v17
s_lshl_b32 s70, s60, 7
s_add_u32 s70, s70, s76
s_lshl_b32 s73, s58, 5
s_add_u32 s70, s70, s73
v_lshrrev_b32 v7, 1, v7
s_add_u32 s35, s34, 5
tw_102:
ds_read_b32 v5, v2 offset:16
s_waitcnt lgkmcnt(0)
v_cmp_gt_i32 vcc, s35, v5
s_cbranch_vccz twd_103
v_readfirstlane_b32 s54, v5
s_sub_u32 s55, s35, s54
s_cmp_lt_i32 s55, 2
s_cbranch_scc1 tws_104
s_add_u32 s54, s54, 2
s_or_b32 s54, s54, 1
s_cmp_eq_u32 s54, s52
s_cbranch_scc1 tws_104
s_bitcmp1_b32 s54, 4
s_cbranch_scc1 tws_104
s_mov_b32 s52, s54
s_add_u32 s54, s54, s53
s_and_b32 s54, s54, 15
s_mul_i32 s54, s54, 393216
s_add_u32 s54, s54, s56
s_buffer_load_dwordx2 s[46:47], s[48:51], s54 offset:4096
s_buffer_load_dwordx2 s[46:47], s[48:51], s54 offset:10240
s_buffer_load_dwordx2 s[46:47], s[48:51], s54 offset:16384
s_buffer_load_dwordx2 s[46:47], s[48:51], s54 offset:22528
tws_104:
s_sleep 4
s_sub_u32 s32, s32, 1
s_cmp_gt_i32 s32, 0
s_cbranch_scc1 tw_102
twd_103:
poll_105:
buffer_load_dword v12, v9, s[4:7], 0 offen sc1
pchk_106:
s_waitcnt vmcnt(0)
v_cmp_gt_u32 vcc, 64, v12
s_cbranch_vccz pdone_107
s_sleep 16
s_sub_u32 s32, s32, 1
s_cmp_gt_i32 s32, 0
s_cbranch_scc1 poll_105
pdone_107:
s_mov_b32 exec_lo, 0x00100001
s_mov_b32 exec_hi, 0x10000100
buffer_store_dwordx2 v[16:17], v7, s[24:27], s70 offen sc1
s_getreg_b32 s73, hwreg(HW_REG_XCC_ID)
s_mov_b64 exec, 1
v_add_u32 v12, s73, 1
buffer_store_dword v12, off, s[24:27], s70 offset:64 sc1
s_mov_b64 exec, -1
s_branch fsb_41
fg_47:
s_lshl1_add_u32 s35, s2, s58
s_lshl_b32 s35, s35, 12
s_add_u32 s44, s40, s35
s_addc_u32 s45, s41, 0
s_mov_b32 s35, 4
ft_108:
s_load_dwordx2 s[42:43], s[44:45], 60
s_load_dwordx2 s[42:43], s[44:45], 188
s_load_dwordx2 s[42:43], s[44:45], 316
s_load_dwordx2 s[42:43], s[44:45], 444
s_load_dwordx2 s[42:43], s[44:45], 572
s_load_dwordx2 s[42:43], s[44:45], 700
s_load_dwordx2 s[42:43], s[44:45], 828
s_load_dwordx2 s[42:43], s[44:45], 956
s_add_u32 s44, s44, 1024
s_addc_u32 s45, s45, 0
s_sub_u32 s35, s35, 1
s_cmp_eq_u32 s35, 0
s_cbranch_scc0 ft_108
v_lshrrev_b32 v250, 3, v0
v_mul_u32_u24 v250, 16256, v250
v_add_u32 v250, v250, v4
s_add_u32 s35, s66, 131072
buffer_load_dwordx4 v[184:187], v250, s[12:15], s35 offen nt
s_add_u32 s35, s66, 133120
buffer_load_dwordx4 v[188:191], v250, s[12:15], s35 offen nt
s_add_u32 s35, s66, 135168
buffer_load_dwordx4 v[192:195], v250, s[12:15], s35 offen nt
s_add_u32 s35, s66, 137216
buffer_load_dwordx4 v[196:199], v250, s[12:15], s35 offen nt
s_add_u32 s35, s66, 139264
buffer_load_dwordx4 v[200:203], v250, s[12:15], s35 offen nt
s_add_u32 s35, s66, 141312
buffer_load_dwordx4 v[204:207], v250, s[12:15], s35 offen nt
s_add_u32 s35, s66, 143360
buffer_load_dwordx4 v[208:211], v250, s[12:15], s35 offen nt
s_add_u32 s35, s66, 145408
buffer_load_dwordx4 v[212:215], v250, s[12:15], s35 offen nt
v_lshrrev_b32 v250, 3, v0
v_mul_u32_u24 v250, 16256, v250
v_add_u32 v250, v250, v4
s_add_u32 s35, s66, 0
buffer_load_dwordx4 v[152:155], v250, s[12:15], s35 offen nt
s_add_u32 s35, s66, 2048
buffer_load_dwordx4 v[156:159], v250, s[12:15], s35 offen nt
s_add_u32 s35, s66, 4096
buffer_load_dwordx4 v[160:163], v250, s[12:15], s35 offen nt
s_add_u32 s35, s66, 6144
buffer_load_dwordx4 v[164:167], v250, s[12:15], s35 offen nt
s_add_u32 s35, s66, 8192
buffer_load_dwordx4 v[168:171], v250, s[12:15], s35 offen nt
s_add_u32 s35, s66, 10240
buffer_load_dwordx4 v[172:175], v250, s[12:15], s35 offen nt
s_add_u32 s35, s66, 12288
buffer_load_dwordx4 v[176:179], v250, s[12:15], s35 offen nt
s_add_u32 s35, s66, 14336
buffer_load_dwordx4 v[180:183], v250, s[12:15], s35 offen nt
s_add_u32 s35, s34, 10
tw_109:
ds_read_b32 v5, v2 offset:16
s_waitcnt lgkmcnt(0)
v_cmp_gt_i32 vcc, s35, v5
s_cbranch_vccz twd_110
v_readfirstlane_b32 s54, v5
s_sub_u32 s55, s35, s54
s_cmp_lt_i32 s55, 2
s_cbranch_scc1 tws_111
s_add_u32 s54, s54, 2
s_or_b32 s54, s54, 1
s_cmp_eq_u32 s54, s52
s_cbranch_scc1 tws_111
s_bitcmp1_b32 s54, 4
s_cbranch_scc1 tws_111
s_mov_b32 s52, s54
s_add_u32 s54, s54, s53
s_and_b32 s54, s54, 15
s_mul_i32 s54, s54, 393216
s_add_u32 s54, s54, s56
s_buffer_load_dwordx2 s[46:47], s[48:51], s54 offset:4096
s_buffer_load_dwordx2 s[46:47], s[48:51], s54 offset:10240
s_buffer_load_dwordx2 s[46:47], s[48:51], s54 offset:16384
s_buffer_load_dwordx2 s[46:47], s[48:51], s54 offset:22528
tws_111:
s_sleep 4
s_sub_u32 s32, s32, 1
s_cmp_gt_i32 s32, 0
s_cbranch_scc1 tw_109
twd_110:
v_and_b32 v10, 0x7a0, v7
s_getreg_b32 s70, hwreg(HW_REG_XCC_ID)
s_add_u32 s70, s70, 1
poll_112:
buffer_load_dword v12, v10, s[24:27], s76 offen offset:64 sc1
pchk_113:
s_waitcnt vmcnt(0)
v_cmp_eq_u32 vcc, 0, v12
s_cbranch_vccz pdone_114
s_sub_u32 s32, s32, 1
s_cmp_gt_i32 s32, 0
s_cbranch_scc1 poll_112
pdone_114:
v_cmp_eq_u32 vcc, s70, v12
s_cmp_eq_u64 vcc, exec
s_cselect_b32 s70, 1, 0
v_mov_b32 v12, s70
v_mov_b32 v10, 0
s_mov_b64 exec, 1
ds_write_b32 v10, v12 offset:56
s_mov_b64 exec, -1
s_branch fg_48
fnw_58:
s_waitcnt lgkmcnt(0)
v_mov_b32 v252, 0
v_mov_b32 v253, 0
v_mov_b32 v254, 0
v_mov_b32 v255, 0
s_mul_i32 s42, s58, 1409024
s_mul_i32 s35, s78, 2048
s_add_u32 s35, s35, s42
s_add_u32 s35, s35, 524288
buffer_store_dwordx4 v[252:255], v4, s[24:27], s35 offen offset:0 sc1
buffer_store_dwordx4 v[252:255], v4, s[24:27], s35 offen offset:1024 sc1
s_mul_i32 s35, s78, 1408
s_add_u32 s35, s35, s42
s_add_u32 s35, s35, 1048576
buffer_store_dwordx4 v[252:255], v4, s[24:27], s35 offen offset:0 sc1
buffer_store_dwordx4 v[252:255], v4, s[24:27], s35 offen offset:384 sc1
s_lshl_b32 s35, s78, 10
s_add_u32 s35, s35, 1409024
s_cmp_eq_u32 s58, 1
s_cselect_b64 exec, -1, 0
buffer_store_dwordx4 v[252:255], v4, s[24:27], s35 offen offset:0 sc1
s_add_u32 s35, s35, 262144
buffer_store_dwordx4 v[252:255], v4, s[24:27], s35 offen offset:0 sc1
s_mov_b64 exec, -1
s_waitcnt vmcnt(0)
v_add_u32 v5, s34, 3
s_mov_b64 exec, 1
ds_write_b32 v3, v5
s_mov_b64 exec, -1
s_add_u32 s35, s34, 17
tw_115:
ds_read_b32 v5, v2 offset:16
s_waitcnt lgkmcnt(0)
v_cmp_gt_i32 vcc, s35, v5
s_cbranch_vccz twd_116
v_readfirstlane_b32 s54, v5
s_sub_u32 s55, s35, s54
s_cmp_lt_i32 s55, 2
s_cbranch_scc1 tws_117
s_add_u32 s54, s54, 2
s_or_b32 s54, s54, 1
s_cmp_eq_u32 s54, s52
s_cbranch_scc1 tws_117
s_bitcmp1_b32 s54, 4
s_cbranch_scc1 tws_117
s_mov_b32 s52, s54
s_add_u32 s54, s54, s53
s_and_b32 s54, s54, 15
s_mul_i32 s54, s54, 393216
s_add_u32 s54, s54, s56
s_buffer_load_dwordx2 s[46:47], s[48:51], s54 offset:4096
s_buffer_load_dwordx2 s[46:47], s[48:51], s54 offset:10240
s_buffer_load_dwordx2 s[46:47], s[48:51], s54 offset:16384
s_buffer_load_dwordx2 s[46:47], s[48:51], s54 offset:22528
tws_117:
s_sleep 4
s_sub_u32 s32, s32, 1
s_cmp_gt_i32 s32, 0
s_cbranch_scc1 tw_115
twd_116:
v_lshrrev_b32 v250, 4, v0
v_mul_u32_u24 v250, 28416, v250
v_add_u32 v250, v250, v4
s_add_u32 s35, s77, 688128
buffer_load_dwordx4 v[120:123], v250, s[16:19], s35 offen nt
s_add_u32 s35, s77, 695296
buffer_load_dwordx4 v[124:127], v250, s[16:19], s35 offen nt
s_add_u32 s35, s77, 702464
buffer_load_dwordx4 v[128:131], v250, s[16:19], s35 offen nt
s_add_u32 s35, s77, 709632
buffer_load_dwordx4 v[132:135], v250, s[16:19], s35 offen nt
s_add_u32 s35, s77, 802816
buffer_load_dwordx4 v[136:139], v250, s[16:19], s35 offen nt
s_add_u32 s35, s77, 809984
buffer_load_dwordx4 v[140:143], v250, s[16:19], s35 offen nt
s_add_u32 s35, s77, 817152
buffer_load_dwordx4 v[144:147], v250, s[16:19], s35 offen nt
s_add_u32 s35, s77, 824320
buffer_load_dwordx4 v[148:151], v250, s[16:19], s35 offen nt
v_lshrrev_b32 v250, 4, v0
v_mul_u32_u24 v250, 28416, v250
v_add_u32 v250, v250, v4
s_add_u32 s35, s77, 458752
buffer_load_dwordx4 v[88:91], v250, s[16:19], s35 offen nt
s_add_u32 s35, s77, 465920
buffer_load_dwordx4 v[92:95], v250, s[16:19], s35 offen nt
s_add_u32 s35, s77, 473088
buffer_load_dwordx4 v[96:99], v250, s[16:19], s35 offen nt
s_add_u32 s35, s77, 480256
buffer_load_dwordx4 v[100:103], v250, s[16:19], s35 offen nt
s_add_u32 s35, s77, 573440
buffer_load_dwordx4 v[104:107], v250, s[16:19], s35 offen nt
s_add_u32 s35, s77, 580608
buffer_load_dwordx4 v[108:111], v250, s[16:19], s35 offen nt
s_add_u32 s35, s77, 587776
buffer_load_dwordx4 v[112:115], v250, s[16:19], s35 offen nt
s_add_u32 s35, s77, 594944
buffer_load_dwordx4 v[116:119], v250, s[16:19], s35 offen nt
v_lshrrev_b32 v250, 4, v0
v_mul_u32_u24 v250, 28416, v250
v_add_u32 v250, v250, v4
s_add_u32 s35, s77, 229376
buffer_load_dwordx4 v[56:59], v250, s[16:19], s35 offen nt
s_add_u32 s35, s77, 236544
buffer_load_dwordx4 v[60:63], v250, s[16:19], s35 offen nt
s_add_u32 s35, s77, 243712
buffer_load_dwordx4 v[64:67], v250, s[16:19], s35 offen nt
s_add_u32 s35, s77, 250880
buffer_load_dwordx4 v[68:71], v250, s[16:19], s35 offen nt
s_add_u32 s35, s77, 344064
buffer_load_dwordx4 v[72:75], v250, s[16:19], s35 offen nt
s_add_u32 s35, s77, 351232
buffer_load_dwordx4 v[76:79], v250, s[16:19], s35 offen nt
s_add_u32 s35, s77, 358400
buffer_load_dwordx4 v[80:83], v250, s[16:19], s35 offen nt
s_add_u32 s35, s77, 365568
buffer_load_dwordx4 v[84:87], v250, s[16:19], s35 offen nt
v_lshrrev_b32 v250, 4, v0
v_mul_u32_u24 v250, 28416, v250
v_add_u32 v250, v250, v4
s_add_u32 s35, s77, 0
buffer_load_dwordx4 v[24:27], v250, s[16:19], s35 offen nt
s_add_u32 s35, s77, 7168
buffer_load_dwordx4 v[28:31], v250, s[16:19], s35 offen nt
s_add_u32 s35, s77, 14336
buffer_load_dwordx4 v[32:35], v250, s[16:19], s35 offen nt
s_add_u32 s35, s77, 21504
buffer_load_dwordx4 v[36:39], v250, s[16:19], s35 offen nt
s_add_u32 s35, s77, 114688
buffer_load_dwordx4 v[40:43], v250, s[16:19], s35 offen nt
s_add_u32 s35, s77, 121856
buffer_load_dwordx4 v[44:47], v250, s[16:19], s35 offen nt
s_add_u32 s35, s77, 129024
buffer_load_dwordx4 v[48:51], v250, s[16:19], s35 offen nt
s_add_u32 s35, s77, 136192
buffer_load_dwordx4 v[52:55], v250, s[16:19], s35 offen nt
s_waitcnt lgkmcnt(0)
s_mov_b32 s42, 0x05040100
s_mov_b32 s43, 0x07060302
s_cmp_eq_u32 s65, 0
s_cbranch_scc0 fq_118
v_perm_b32 v216, v188, v184, s42
v_perm_b32 v220, v188, v184, s43
v_perm_b32 v224, v189, v185, s42
v_perm_b32 v228, v189, v185, s43
v_perm_b32 v232, v190, v186, s42
v_perm_b32 v236, v190, v186, s43
v_perm_b32 v240, v191, v187, s42
v_perm_b32 v244, v191, v187, s43
v_perm_b32 v217, v196, v192, s42
v_perm_b32 v221, v196, v192, s43
v_perm_b32 v225, v197, v193, s42
v_perm_b32 v229, v197, v193, s43
v_perm_b32 v233, v198, v194, s42
v_perm_b32 v237, v198, v194, s43
v_perm_b32 v241, v199, v195, s42
v_perm_b32 v245, v199, v195, s43
v_perm_b32 v218, v204, v200, s42
v_perm_b32 v222, v204, v200, s43
v_perm_b32 v226, v205, v201, s42
v_perm_b32 v230, v205, v201, s43
v_perm_b32 v234, v206, v202, s42
v_perm_b32 v238, v206, v202, s43
v_perm_b32 v242, v207, v203, s42
v_perm_b32 v246, v207, v203, s43
v_perm_b32 v219, v212, v208, s42
v_perm_b32 v223, v212, v208, s43
v_perm_b32 v227, v213, v209, s42
v_perm_b32 v231, v213, v209, s43
v_perm_b32 v235, v214, v210, s42
v_perm_b32 v239, v214, v210, s43
v_perm_b32 v243, v215, v211, s42
v_perm_b32 v247, v215, v211, s43
v_perm_b32 v184, v156, v152, s42
v_perm_b32 v188, v156, v152, s43
v_perm_b32 v192, v157, v153, s42
v_perm_b32 v196, v157, v153, s43
v_perm_b32 v200, v158, v154, s42
v_perm_b32 v204, v158, v154, s43
v_perm_b32 v208, v159, v155, s42
v_perm_b32 v212, v159, v155, s43
v_perm_b32 v185, v164, v160, s42
v_perm_b32 v189, v164, v160, s43
v_perm_b32 v193, v165, v161, s42
v_perm_b32 v197, v165, v161, s43
v_perm_b32 v201, v166, v162, s42
v_perm_b32 v205, v166, v162, s43
v_perm_b32 v209, v167, v163, s42
v_perm_b32 v213, v167, v163, s43
v_perm_b32 v186, v172, v168, s42
v_perm_b32 v190, v172, v168, s43
v_perm_b32 v194, v173, v169, s42
v_perm_b32 v198, v173, v169, s43
v_perm_b32 v202, v174, v170, s42
v_perm_b32 v206, v174, v170, s43
v_perm_b32 v210, v175, v171, s42
v_perm_b32 v214, v175, v171, s43
v_perm_b32 v187, v180, v176, s42
v_perm_b32 v191, v180, v176, s43
v_perm_b32 v195, v181, v177, s42
v_perm_b32 v199, v181, v177, s43
v_perm_b32 v203, v182, v178, s42
v_perm_b32 v207, v182, v178, s43
v_perm_b32 v211, v183, v179, s42
v_perm_b32 v215, v183, v179, s43
s_waitcnt vmcnt(30)
v_perm_b32 v152, v124, v120, s42
v_perm_b32 v156, v124, v120, s43
v_perm_b32 v160, v125, v121, s42
v_perm_b32 v164, v125, v121, s43
v_perm_b32 v168, v126, v122, s42
v_perm_b32 v172, v126, v122, s43
v_perm_b32 v176, v127, v123, s42
v_perm_b32 v180, v127, v123, s43
s_waitcnt vmcnt(28)
v_perm_b32 v153, v132, v128, s42
v_perm_b32 v157, v132, v128, s43
v_perm_b32 v161, v133, v129, s42
v_perm_b32 v165, v133, v129, s43
v_perm_b32 v169, v134, v130, s42
v_perm_b32 v173, v134, v130, s43
v_perm_b32 v177, v135, v131, s42
v_perm_b32 v181, v135, v131, s43
s_waitcnt vmcnt(26)
v_perm_b32 v154, v140, v136, s42
v_perm_b32 v158, v140, v136, s43
v_perm_b32 v162, v141, v137, s42
v_perm_b32 v166, v141, v137, s43
v_perm_b32 v170, v142, v138, s42
v_perm_b32 v174, v142, v138, s43
v_perm_b32 v178, v143, v139, s42
v_perm_b32 v182, v143, v139, s43
s_waitcnt vmcnt(24)
v_perm_b32 v155, v148, v144, s42
v_perm_b32 v159, v148, v144, s43
v_perm_b32 v163, v149, v145, s42
v_perm_b32 v167, v149, v145, s43
v_perm_b32 v171, v150, v146, s42
v_perm_b32 v175, v150, v146, s43
v_perm_b32 v179, v151, v147, s42
v_perm_b32 v183, v151, v147, s43
s_waitcnt vmcnt(22)
v_perm_b32 v120, v92, v88, s42
v_perm_b32 v124, v92, v88, s43
v_perm_b32 v128, v93, v89, s42
v_perm_b32 v132, v93, v89, s43
v_perm_b32 v136, v94, v90, s42
v_perm_b32 v140, v94, v90, s43
v_perm_b32 v144, v95, v91, s42
v_perm_b32 v148, v95, v91, s43
s_waitcnt vmcnt(20)
v_perm_b32 v121, v100, v96, s42
v_perm_b32 v125, v100, v96, s43
v_perm_b32 v129, v101, v97, s42
v_perm_b32 v133, v101, v97, s43
v_perm_b32 v137, v102, v98, s42
v_perm_b32 v141, v102, v98, s43
v_perm_b32 v145, v103, v99, s42
v_perm_b32 v149, v103, v99, s43
s_waitcnt vmcnt(18)
v_perm_b32 v122, v108, v104, s42
v_perm_b32 v126, v108, v104, s43
v_perm_b32 v130, v109, v105, s42
v_perm_b32 v134, v109, v105, s43
v_perm_b32 v138, v110, v106, s42
v_perm_b32 v142, v110, v106, s43
v_perm_b32 v146, v111, v107, s42
v_perm_b32 v150, v111, v107, s43
s_waitcnt vmcnt(16)
v_perm_b32 v123, v116, v112, s42
v_perm_b32 v127, v116, v112, s43
v_perm_b32 v131, v117, v113, s42
v_perm_b32 v135, v117, v113, s43
v_perm_b32 v139, v118, v114, s42
v_perm_b32 v143, v118, v114, s43
v_perm_b32 v147, v119, v115, s42
v_perm_b32 v151, v119, v115, s43
s_waitcnt vmcnt(14)
v_perm_b32 v88, v60, v56, s42
v_perm_b32 v92, v60, v56, s43
v_perm_b32 v96, v61, v57, s42
v_perm_b32 v100, v61, v57, s43
v_perm_b32 v104, v62, v58, s42
v_perm_b32 v108, v62, v58, s43
v_perm_b32 v112, v63, v59, s42
v_perm_b32 v116, v63, v59, s43
s_waitcnt vmcnt(12)
v_perm_b32 v89, v68, v64, s42
v_perm_b32 v93, v68, v64, s43
v_perm_b32 v97, v69, v65, s42
v_perm_b32 v101, v69, v65, s43
v_perm_b32 v105, v70, v66, s42
v_perm_b32 v109, v70, v66, s43
v_perm_b32 v113, v71, v67, s42
v_perm_b32 v117, v71, v67, s43
s_waitcnt vmcnt(10)
v_perm_b32 v90, v76, v72, s42
v_perm_b32 v94, v76, v72, s43
v_perm_b32 v98, v77, v73, s42
v_perm_b32 v102, v77, v73, s43
v_perm_b32 v106, v78, v74, s42
v_perm_b32 v110, v78, v74, s43
v_perm_b32 v114, v79, v75, s42
v_perm_b32 v118, v79, v75, s43
s_waitcnt vmcnt(8)
v_perm_b32 v91, v84, v80, s42
v_perm_b32 v95, v84, v80, s43
v_perm_b32 v99, v85, v81, s42
v_perm_b32 v103, v85, v81, s43
v_perm_b32 v107, v86, v82, s42
v_perm_b32 v111, v86, v82, s43
v_perm_b32 v115, v87, v83, s42
v_perm_b32 v119, v87, v83, s43
s_waitcnt vmcnt(6)
v_perm_b32 v56, v28, v24, s42
v_perm_b32 v60, v28, v24, s43
v_perm_b32 v64, v29, v25, s42
v_perm_b32 v68, v29, v25, s43
v_perm_b32 v72, v30, v26, s42
v_perm_b32 v76, v30, v26, s43
v_perm_b32 v80, v31, v27, s42
v_perm_b32 v84, v31, v27, s43
s_waitcnt vmcnt(4)
v_perm_b32 v57, v36, v32, s42
v_perm_b32 v61, v36, v32, s43
v_perm_b32 v65, v37, v33, s42
v_perm_b32 v69, v37, v33, s43
v_perm_b32 v73, v38, v34, s42
v_perm_b32 v77, v38, v34, s43
v_perm_b32 v81, v39, v35, s42
v_perm_b32 v85, v39, v35, s43
s_waitcnt vmcnt(2)
v_perm_b32 v58, v44, v40, s42
v_perm_b32 v62, v44, v40, s43
v_perm_b32 v66, v45, v41, s42
v_perm_b32 v70, v45, v41, s43
v_perm_b32 v74, v46, v42, s42
v_perm_b32 v78, v46, v42, s43
v_perm_b32 v82, v47, v43, s42
v_perm_b32 v86, v47, v43, s43
s_waitcnt vmcnt(0)
v_perm_b32 v59, v52, v48, s42
v_perm_b32 v63, v52, v48, s43
v_perm_b32 v67, v53, v49, s42
v_perm_b32 v71, v53, v49, s43
v_perm_b32 v75, v54, v50, s42
v_perm_b32 v79, v54, v50, s43
v_perm_b32 v83, v55, v51, s42
v_perm_b32 v87, v55, v51, s43
fq_118:
s_and_b32 s54, s59, 1
s_lshl_b32 s54, s54, 1
s_sub_u32 s54, s53, s54
s_and_b32 s54, s54, 15
s_mul_i32 s54, s54, 393216
s_add_u32 s54, s54, s56
s_buffer_load_dwordx2 s[46:47], s[48:51], s54 offset:4096
s_buffer_load_dwordx2 s[46:47], s[48:51], s54 offset:10240
s_buffer_load_dwordx2 s[46:47], s[48:51], s54 offset:16384
s_buffer_load_dwordx2 s[46:47], s[48:51], s54 offset:22528
s_buffer_load_dwordx2 s[46:47], s[48:51], s54 offset:2048
s_buffer_load_dwordx2 s[46:47], s[48:51], s54 offset:8192
s_buffer_load_dwordx2 s[46:47], s[48:51], s54 offset:14336
s_buffer_load_dwordx2 s[46:47], s[48:51], s54 offset:20480
s_buffer_load_dwordx2 s[46:47], s[48:51], s54 offset:0
s_buffer_load_dwordx2 s[46:47], s[48:51], s54 offset:6144
s_buffer_load_dwordx2 s[46:47], s[48:51], s54 offset:12288
s_buffer_load_dwordx2 s[46:47], s[48:51], s54 offset:18432
s_add_u32 s54, s53, 1
s_and_b32 s54, s54, 15
s_mul_i32 s54, s54, 393216
s_add_u32 s54, s54, s56
s_buffer_load_dwordx2 s[46:47], s[48:51], s54 offset:4096
s_buffer_load_dwordx2 s[46:47], s[48:51], s54 offset:10240
s_buffer_load_dwordx2 s[46:47], s[48:51], s54 offset:16384
s_buffer_load_dwordx2 s[46:47], s[48:51], s54 offset:22528
s_buffer_load_dwordx2 s[46:47], s[48:51], s54 offset:2048
s_buffer_load_dwordx2 s[46:47], s[48:51], s54 offset:8192
s_buffer_load_dwordx2 s[46:47], s[48:51], s54 offset:14336
s_buffer_load_dwordx2 s[46:47], s[48:51], s54 offset:20480
s_buffer_load_dwordx2 s[46:47], s[48:51], s54 offset:0
s_buffer_load_dwordx2 s[46:47], s[48:51], s54 offset:6144
s_buffer_load_dwordx2 s[46:47], s[48:51], s54 offset:12288
s_buffer_load_dwordx2 s[46:47], s[48:51], s54 offset:18432
s_add_u32 s54, s53, 3
s_and_b32 s54, s54, 15
s_mul_i32 s54, s54, 393216
s_add_u32 s54, s54, s56
s_buffer_load_dwordx2 s[46:47], s[48:51], s54 offset:4096
s_buffer_load_dwordx2 s[46:47], s[48:51], s54 offset:10240
s_buffer_load_dwordx2 s[46:47], s[48:51], s54 offset:16384
s_buffer_load_dwordx2 s[46:47], s[48:51], s54 offset:22528
s_buffer_load_dwordx2 s[46:47], s[48:51], s54 offset:2048
s_buffer_load_dwordx2 s[46:47], s[48:51], s54 offset:8192
s_buffer_load_dwordx2 s[46:47], s[48:51], s54 offset:14336
s_buffer_load_dwordx2 s[46:47], s[48:51], s54 offset:20480
s_buffer_load_dwordx2 s[46:47], s[48:51], s54 offset:0
s_buffer_load_dwordx2 s[46:47], s[48:51], s54 offset:6144
s_buffer_load_dwordx2 s[46:47], s[48:51], s54 offset:12288
s_buffer_load_dwordx2 s[46:47], s[48:51], s54 offset:18432
s_add_u32 s54, s53, 5
s_and_b32 s54, s54, 15
s_mul_i32 s54, s54, 393216
s_add_u32 s54, s54, s56
s_buffer_load_dwordx2 s[46:47], s[48:51], s54 offset:4096
s_buffer_load_dwordx2 s[46:47], s[48:51], s54 offset:10240
s_buffer_load_dwordx2 s[46:47], s[48:51], s54 offset:16384
s_buffer_load_dwordx2 s[46:47], s[48:51], s54 offset:22528
s_buffer_load_dwordx2 s[46:47], s[48:51], s54 offset:2048
s_buffer_load_dwordx2 s[46:47], s[48:51], s54 offset:8192
s_buffer_load_dwordx2 s[46:47], s[48:51], s54 offset:14336
s_buffer_load_dwordx2 s[46:47], s[48:51], s54 offset:20480
s_buffer_load_dwordx2 s[46:47], s[48:51], s54 offset:0
s_buffer_load_dwordx2 s[46:47], s[48:51], s54 offset:6144
s_buffer_load_dwordx2 s[46:47], s[48:51], s54 offset:12288
s_buffer_load_dwordx2 s[46:47], s[48:51], s54 offset:18432
s_waitcnt lgkmcnt(0)
s_branch fnw_59
fnd_68:
poll_119:
buffer_load_dwordx2 v[248:249], v6, s[24:27], s73 offen sc1
pchk_120:
s_waitcnt vmcnt(0)
v_min_u32 v5, v248, v249
v_cmp_eq_u32 vcc, 0, v5
s_cbranch_vccz pdone_121
s_sleep 1
s_sub_u32 s32, s32, 1
s_cmp_gt_i32 s32, 0
s_cbranch_scc1 poll_119
pdone_121:
v_mov_b32 v250, v248
s_nop 1
v_max_f32_dpp v250, v250, v250 row_ror:1 row_mask:0xf bank_mask:0xf
s_nop 1
v_max_f32_dpp v250, v250, v250 row_ror:2 row_mask:0xf bank_mask:0xf
s_nop 1
v_max_f32_dpp v250, v250, v250 row_ror:4 row_mask:0xf bank_mask:0xf
s_nop 1
v_max_f32_dpp v250, v250, v250 row_ror:8 row_mask:0xf bank_mask:0xf
v_cmp_eq_f32 vcc, v250, v248
s_ff1_i32_b64 s68, vcc
s_and_b32 s68, s68, 15
v_readlane_b32 s33, v249, s68
v_readlane_b32 s67, v248, s68
v_add_u32 v5, s34, 4
v_mov_b32 v250, s33
s_mov_b64 exec, 1
ds_write2_b32 v3, v5, v250 offset1:2
s_mov_b64 exec, -1
s_sub_u32 s33, s33, 1
s_and_b32 s33, s33, 2047
s_branch fnd_67
fpre_88:
poll_122:
buffer_load_dwordx4 v[24:27], v4, s[24:27], s72 offen offset:0 sc1
pchk_123:
s_waitcnt vmcnt(0)
v_min3_u32 v5, v24, v25, v26
v_min_u32 v5, v5, v27
v_cmp_eq_u32 vcc, 0, v5
s_cbranch_vccz pdone_124
s_sleep 8
s_sub_u32 s32, s32, 1
s_cmp_gt_i32 s32, 0
s_cbranch_scc1 poll_122
pdone_124:
s_branch fpre_89
L_m:
s_setprio 2
v_mov_b32 v6, 0
v_mov_b32 v7, 0
v_lshlrev_b32 v8, 3, v0
ds_write_b64 v8, v[6:7]
s_waitcnt lgkmcnt(0)
s_barrier
s_lshr_b32 s64, s58, 1
s_and_b32 s65, s58, 1
v_and_b32 v1, 3, v0
v_lshlrev_b32 v1, 2, v1
v_and_b32 v2, 4, v1
s_lshl2_add_u32 s35, s58, 0
v_mov_b32 v3, s35
s_mov_b32 s4, s44
s_mov_b32 s5, s45
s_mov_b32 s6, 0x800
s_mov_b32 s7, 0x00020000
v_lshrrev_b32 v6, 4, v0
v_lshlrev_b32 v6, 3, v6
s_lshl_b32 s66, s62, 7
buffer_load_dwordx2 v[232:233], v6, s[4:7], s66 offen offset:0
buffer_load_dwordx2 v[234:235], v6, s[4:7], s66 offen offset:32
buffer_load_dwordx2 v[236:237], v6, s[4:7], s66 offen offset:64
buffer_load_dwordx2 v[238:239], v6, s[4:7], s66 offen offset:96
v_and_b32 v6, 31, v0
v_lshrrev_b32 v7, 5, v0
v_lshlrev_b32 v7, 3, v7
v_sub_u32 v6, v6, v7
v_mov_b32 v7, 0xf149f2ca
v_cmp_le_i32 vcc, 0, v6
s_nop 1
v_cndmask_b32 v216, 0, v7, vcc
v_cmp_le_i32 vcc, 1, v6
s_nop 1
v_cndmask_b32 v217, 0, v7, vcc
v_cmp_le_i32 vcc, 2, v6
s_nop 1
v_cndmask_b32 v218, 0, v7, vcc
v_cmp_le_i32 vcc, 3, v6
s_nop 1
v_cndmask_b32 v219, 0, v7, vcc
v_cmp_le_i32 vcc, 16, v6
s_nop 1
v_cndmask_b32 v220, 0, v7, vcc
v_cmp_le_i32 vcc, 17, v6
s_nop 1
v_cndmask_b32 v221, 0, v7, vcc
v_cmp_le_i32 vcc, 18, v6
s_nop 1
v_cndmask_b32 v222, 0, v7, vcc
v_cmp_le_i32 vcc, 19, v6
s_nop 1
v_cndmask_b32 v223, 0, v7, vcc
v_cmp_le_i32 vcc, 4, v6
s_nop 1
v_cndmask_b32 v224, 0, v7, vcc
v_cmp_le_i32 vcc, 5, v6
s_nop 1
v_cndmask_b32 v225, 0, v7, vcc
v_cmp_le_i32 vcc, 6, v6
s_nop 1
v_cndmask_b32 v226, 0, v7, vcc
v_cmp_le_i32 vcc, 7, v6
s_nop 1
v_cndmask_b32 v227, 0, v7, vcc
v_cmp_le_i32 vcc, 20, v6
s_nop 1
v_cndmask_b32 v228, 0, v7, vcc
v_cmp_le_i32 vcc, 21, v6
s_nop 1
v_cndmask_b32 v229, 0, v7, vcc
v_cmp_le_i32 vcc, 22, v6
s_nop 1
v_cndmask_b32 v230, 0, v7, vcc
v_cmp_le_i32 vcc, 23, v6
s_nop 1
v_cndmask_b32 v231, 0, v7, vcc
v_lshrrev_b32 v6, 2, v0
v_xor_b32 v6, v6, v0
v_and_b32 v6, 4, v6
v_mov_b32 v7, 0x3f803f80
v_cmp_eq_u32 vcc, 0, v6
s_nop 1
v_cndmask_b32 v212, 0, v7, vcc
v_cndmask_b32 v213, 0, v7, vcc
v_cndmask_b32 v214, 0, v7, vcc
v_cndmask_b32 v215, 0, v7, vcc
v_lshrrev_b32 v196, 4, v0
s_cmp_eq_u32 0, 0
s_cbranch_scc0 mq_125
v_bfe_u32 v197, v0, 1, 3
v_xor_b32 v197, v197, v196
v_lshlrev_b32 v197, 4, v197
v_and_b32 v198, 15, v0
v_lshl_add_u32 v192, v198, 7, v197
v_xor_b32 v193, 64, v192
s_branch mq_126
mq_125:
v_lshlrev_b32 v192, 4, v0
v_add_u32 v193, 1024, v192
mq_126:
s_lshl_b32 s46, s65, 13
s_add_u32 s46, s46, 86016
v_add_u32 v192, s46, v192
v_add_u32 v193, s46, v193
v_bfe_u32 v197, v0, 2, 2
v_lshl_add_u32 v197, v196, 3, v197
v_bfe_u32 v198, v0, 3, 2
s_lshl_b32 s46, s64, 1
v_xor_b32 v198, s46, v198
v_lshlrev_b32 v198, 5, v198
v_lshl_add_u32 v197, v197, 7, v198
v_and_b32 v198, 3, v0
v_lshl_add_u32 v197, v198, 3, v197
v_add_u32 v194, 102400, v197
v_xor_b32 v195, 32, v194
v_mov_b32 v197, 0xf149f2ca
v_xor_b32 v216, v197, v216
v_xor_b32 v217, v197, v217
v_xor_b32 v218, v197, v218
v_xor_b32 v219, v197, v219
v_xor_b32 v220, v197, v220
v_xor_b32 v221, v197, v221
v_xor_b32 v222, v197, v222
v_xor_b32 v223, v197, v223
v_xor_b32 v224, v197, v224
v_xor_b32 v225, v197, v225
v_xor_b32 v226, v197, v226
v_xor_b32 v227, v197, v227
v_xor_b32 v228, v197, v228
v_xor_b32 v229, v197, v229
v_xor_b32 v230, v197, v230
v_xor_b32 v231, v197, v231
v_and_b32 v196, 15, v0
v_lshrrev_b32 v197, 4, v0
s_lshl_b32 s46, s65, 8
s_add_u32 s46, s46, 1280
s_mul_i32 s47, s64, 384
v_lshl_add_u32 v208, v196, 2, s46
v_lshl_add_u32 v209, v197, 4, s46
v_lshl_add_u32 v210, v196, 2, s47
v_lshl_add_u32 v211, v197, 4, s47
v_and_b32 v198, 1, v197
v_lshrrev_b32 v197, 1, v197
v_lshlrev_b32 v197, 9, v197
v_lshl_add_u32 v197, v198, 10, v197
s_lshl_b32 s46, s64, 12
s_lshl_b32 s47, s65, 13
s_add_u32 s46, s46, 131072
s_add_u32 s48, s46, 24576
s_sub_u32 s48, s48, s47
s_add_u32 s47, s46, s47
v_lshl_add_u32 v200, v196, 4, v197
v_and_b32 v198, 3, v0
v_lshl_add_u32 v197, v198, 4, v197
v_bfe_u32 v198, v0, 3, 1
v_lshl_add_u32 v197, v198, 6, v197
v_bfe_u32 v198, v0, 2, 1
v_lshl_add_u32 v198, v198, 8, v197
v_add_u32 v199, s48, v198
v_add_u32 v198, s47, v198
v_add_u32 v201, s48, v200
v_add_u32 v200, s47, v200
s_lshl_b32 s46, s59, 4
s_add_u32 s46, s46, s60
s_lshl_b32 s50, s59, 7
s_add_u32 s50, s50, s60
s_lshl_b32 s50, s50, 7
s_lshl_b32 s46, s46, 15
s_lshl_b32 s47, 0, 23
s_add_u32 s46, s46, s47
s_add_u32 s49, s46, 917504
L_mtop:
v_mov_b32 v6, v192
v_mov_b32 v7, v193
v_mov_b32 v8, v194
v_mov_b32 v9, v195
v_mov_b32 v12, v198
v_mov_b32 v13, v199
v_mov_b32 v14, v200
v_mov_b32 v15, v201
s_mov_b32 s71, s49
s_mov_b32 s72, s50
v_add_u32 v4, s34, 1
s_mov_b32 s66, 14
s_mov_b32 s67, -40960
s_mov_b32 s68, -40960
s_mov_b32 s69, 81920
s_add_u32 s35, s34, 1
lw_127:
ds_read_b32 v5, v2 offset:16
s_waitcnt lgkmcnt(0)
v_cmp_gt_i32 vcc, s35, v5
s_cbranch_vccz lwd_128
s_sub_u32 s32, s32, 1
s_cmp_gt_i32 s32, 0
s_cbranch_scc1 lw_127
lwd_128:
ds_read_b64_tr_b16 v[144:145], v8 offset:8192
ds_read_b64_tr_b16 v[146:147], v8 offset:8704
ds_read_b64_tr_b16 v[148:149], v8 offset:12288
ds_read_b64_tr_b16 v[150:151], v8 offset:12800
ds_read_b128 v[112:115], v6 offset:0
ds_read_b128 v[116:119], v7 offset:0
ds_read_b64_tr_b16 v[152:153], v9 offset:8192
ds_read_b64_tr_b16 v[154:155], v9 offset:8704
ds_read_b64_tr_b16 v[156:157], v9 offset:12288
ds_read_b64_tr_b16 v[158:159], v9 offset:12800
ds_read_b128 v[120:123], v6 offset:2048
ds_read_b128 v[124:127], v7 offset:2048
ds_read_b128 v[128:131], v6 offset:4096
ds_read_b128 v[132:135], v7 offset:4096
ds_read_b128 v[136:139], v6 offset:6144
ds_read_b128 v[140:143], v7 offset:6144
s_waitcnt lgkmcnt(11)
v_mfma_f32_16x16x32_bf16 v[16:19], v[144:147], v[112:115], 0
ds_read_b64_tr_b16 v[160:161], v8 offset:16384
s_waitcnt lgkmcnt(11)
v_mfma_f32_16x16x32_bf16 v[16:19], v[148:151], v[116:119], v[16:19]
ds_read_b64_tr_b16 v[162:163], v8 offset:16896
s_waitcnt lgkmcnt(10)
v_mfma_f32_16x16x32_bf16 v[20:23], v[152:155], v[112:115], 0
ds_read_b64_tr_b16 v[164:165], v8 offset:20480
s_waitcnt lgkmcnt(9)
v_mfma_f32_16x16x32_bf16 v[20:23], v[156:159], v[116:119], v[20:23]
ds_read_b64_tr_b16 v[166:167], v8 offset:20992
s_waitcnt lgkmcnt(9)
v_mfma_f32_16x16x32_bf16 v[24:27], v[144:147], v[120:123], 0
ds_read_b64_tr_b16 v[168:169], v9 offset:16384
s_waitcnt lgkmcnt(9)
v_mfma_f32_16x16x32_bf16 v[24:27], v[148:151], v[124:127], v[24:27]
ds_read_b64_tr_b16 v[170:171], v9 offset:16896
v_mfma_f32_16x16x32_bf16 v[28:31], v[152:155], v[120:123], 0
ds_read_b64_tr_b16 v[172:173], v9 offset:20480
v_mfma_f32_16x16x32_bf16 v[28:31], v[156:159], v[124:127], v[28:31]
ds_read_b64_tr_b16 v[174:175], v9 offset:20992
s_waitcnt lgkmcnt(11)
v_mfma_f32_16x16x32_bf16 v[32:35], v[144:147], v[128:131], 0
ds_read_b64_tr_b16 v[176:177], v8 offset:0
s_waitcnt lgkmcnt(11)
v_mfma_f32_16x16x32_bf16 v[32:35], v[148:151], v[132:135], v[32:35]
ds_read_b64_tr_b16 v[178:179], v8 offset:512
v_mfma_f32_16x16x32_bf16 v[36:39], v[152:155], v[128:131], 0
ds_read_b64_tr_b16 v[180:181], v8 offset:4096
v_mfma_f32_16x16x32_bf16 v[36:39], v[156:159], v[132:135], v[36:39]
ds_read_b64_tr_b16 v[182:183], v8 offset:4608
s_waitcnt lgkmcnt(13)
v_mfma_f32_16x16x32_bf16 v[40:43], v[144:147], v[136:139], 0
ds_read_b64_tr_b16 v[184:185], v9 offset:0
s_waitcnt lgkmcnt(13)
v_mfma_f32_16x16x32_bf16 v[40:43], v[148:151], v[140:143], v[40:43]
ds_read_b64_tr_b16 v[186:187], v9 offset:512
v_mfma_f32_16x16x32_bf16 v[44:47], v[152:155], v[136:139], 0
ds_read_b64_tr_b16 v[188:189], v9 offset:4096
v_mfma_f32_16x16x32_bf16 v[44:47], v[156:159], v[140:143], v[44:47]
ds_read_b64_tr_b16 v[190:191], v9 offset:4608
s_waitcnt lgkmcnt(14)
v_mfma_f32_16x16x32_bf16 v[48:51], v[112:115], v[160:163], 0
s_mov_b64 exec, 1
ds_write_b32 v3, v4
s_mov_b64 exec, -1
s_waitcnt lgkmcnt(13)
v_mfma_f32_16x16x32_bf16 v[48:51], v[116:119], v[164:167], v[48:51]
v_add_u32 v8, s67, v8
v_add_u32 v9, s67, v9
s_waitcnt lgkmcnt(11)
v_mfma_f32_16x16x32_bf16 v[52:55], v[112:115], v[168:171], 0
v_add_u32 v6, s67, v6
v_add_u32 v7, s67, v7
s_waitcnt lgkmcnt(9)
v_mfma_f32_16x16x32_bf16 v[52:55], v[116:119], v[172:175], v[52:55]
s_mov_b32 s70, s67
s_mov_b32 s67, s68
s_mov_b32 s68, s69
s_mov_b32 s69, s70
v_mfma_f32_16x16x32_bf16 v[56:59], v[120:123], v[160:163], 0
ds_read_b32 v5, v2 offset:16
v_mfma_f32_16x16x32_bf16 v[56:59], v[124:127], v[164:167], v[56:59]
v_mfma_f32_16x16x32_bf16 v[60:63], v[120:123], v[168:171], 0
v_mfma_f32_16x16x32_bf16 v[60:63], v[124:127], v[172:175], v[60:63]
v_mfma_f32_16x16x32_bf16 v[64:67], v[128:131], v[160:163], 0
s_waitcnt lgkmcnt(0)
v_cmp_ge_u32 vcc, v4, v5
s_cbranch_vccnz mspin_132
mback_133:
v_add_u32 v4, 1, v4
v_mfma_f32_16x16x32_bf16 v[64:67], v[132:135], v[164:167], v[64:67]
ds_read_b64_tr_b16 v[144:145], v8 offset:8192
v_mfma_f32_16x16x32_bf16 v[68:71], v[128:131], v[168:171], 0
ds_read_b64_tr_b16 v[146:147], v8 offset:8704
v_mfma_f32_16x16x32_bf16 v[68:71], v[132:135], v[172:175], v[68:71]
ds_read_b64_tr_b16 v[148:149], v8 offset:12288
v_mfma_f32_16x16x32_bf16 v[72:75], v[136:139], v[160:163], 0
ds_read_b64_tr_b16 v[150:151], v8 offset:12800
v_mfma_f32_16x16x32_bf16 v[72:75], v[140:143], v[164:167], v[72:75]
ds_read_b64_tr_b16 v[152:153], v9 offset:8192
v_mfma_f32_16x16x32_bf16 v[76:79], v[136:139], v[168:171], 0
ds_read_b64_tr_b16 v[154:155], v9 offset:8704
v_mfma_f32_16x16x32_bf16 v[76:79], v[140:143], v[172:175], v[76:79]
ds_read_b64_tr_b16 v[156:157], v9 offset:12288
v_mfma_f32_16x16x32_bf16 v[80:83], v[176:179], v[112:115], 0
ds_read_b64_tr_b16 v[158:159], v9 offset:12800
v_mfma_f32_16x16x32_bf16 v[80:83], v[180:183], v[116:119], v[80:83]
v_mfma_f32_16x16x32_bf16 v[84:87], v[184:187], v[112:115], 0
v_mfma_f32_16x16x32_bf16 v[84:87], v[188:191], v[116:119], v[84:87]
ds_read_b128 v[112:115], v6 offset:0
ds_read_b128 v[116:119], v7 offset:0
v_mfma_f32_16x16x32_bf16 v[88:91], v[176:179], v[120:123], 0
v_mfma_f32_16x16x32_bf16 v[88:91], v[180:183], v[124:127], v[88:91]
v_mfma_f32_16x16x32_bf16 v[92:95], v[184:187], v[120:123], 0
v_mfma_f32_16x16x32_bf16 v[92:95], v[188:191], v[124:127], v[92:95]
ds_read_b128 v[120:123], v6 offset:2048
ds_read_b128 v[124:127], v7 offset:2048
v_mfma_f32_16x16x32_bf16 v[96:99], v[176:179], v[128:131], 0
v_mfma_f32_16x16x32_bf16 v[96:99], v[180:183], v[132:135], v[96:99]
v_mfma_f32_16x16x32_bf16 v[100:103], v[184:187], v[128:131], 0
v_mfma_f32_16x16x32_bf16 v[100:103], v[188:191], v[132:135], v[100:103]
ds_read_b128 v[128:131], v6 offset:4096
ds_read_b128 v[132:135], v7 offset:4096
v_mfma_f32_16x16x32_bf16 v[104:107], v[176:179], v[136:139], 0
v_mfma_f32_16x16x32_bf16 v[104:107], v[180:183], v[140:143], v[104:107]
v_mfma_f32_16x16x32_bf16 v[108:111], v[184:187], v[136:139], 0
v_mfma_f32_16x16x32_bf16 v[108:111], v[188:191], v[140:143], v[108:111]
ds_read_b128 v[136:139], v6 offset:6144
ds_read_b128 v[140:143], v7 offset:6144
.p2align 6
mqkv_129:
s_waitcnt lgkmcnt(7)
v_mfma_f32_16x16x32_bf16 v[16:19], v[144:147], v[112:115], v[16:19]
ds_read_b64_tr_b16 v[160:161], v8 offset:16384
s_waitcnt lgkmcnt(7)
v_mfma_f32_16x16x32_bf16 v[16:19], v[148:151], v[116:119], v[16:19]
ds_read_b64_tr_b16 v[162:163], v8 offset:16896
v_mfma_f32_16x16x32_bf16 v[20:23], v[152:155], v[112:115], v[20:23]
ds_read_b64_tr_b16 v[164:165], v8 offset:20480
v_mfma_f32_16x16x32_bf16 v[20:23], v[156:159], v[116:119], v[20:23]
ds_read_b64_tr_b16 v[166:167], v8 offset:20992
s_waitcnt lgkmcnt(9)
v_mfma_f32_16x16x32_bf16 v[24:27], v[144:147], v[120:123], v[24:27]
ds_read_b64_tr_b16 v[168:169], v9 offset:16384
s_waitcnt lgkmcnt(9)
v_mfma_f32_16x16x32_bf16 v[24:27], v[148:151], v[124:127], v[24:27]
ds_read_b64_tr_b16 v[170:171], v9 offset:16896
v_mfma_f32_16x16x32_bf16 v[28:31], v[152:155], v[120:123], v[28:31]
ds_read_b64_tr_b16 v[172:173], v9 offset:20480
v_mfma_f32_16x16x32_bf16 v[28:31], v[156:159], v[124:127], v[28:31]
ds_read_b64_tr_b16 v[174:175], v9 offset:20992
s_waitcnt lgkmcnt(11)
v_mfma_f32_16x16x32_bf16 v[32:35], v[144:147], v[128:131], v[32:35]
ds_read_b64_tr_b16 v[176:177], v8 offset:0
s_waitcnt lgkmcnt(11)
v_mfma_f32_16x16x32_bf16 v[32:35], v[148:151], v[132:135], v[32:35]
ds_read_b64_tr_b16 v[178:179], v8 offset:512
v_mfma_f32_16x16x32_bf16 v[36:39], v[152:155], v[128:131], v[36:39]
ds_read_b64_tr_b16 v[180:181], v8 offset:4096
v_mfma_f32_16x16x32_bf16 v[36:39], v[156:159], v[132:135], v[36:39]
ds_read_b64_tr_b16 v[182:183], v8 offset:4608
s_waitcnt lgkmcnt(13)
v_mfma_f32_16x16x32_bf16 v[40:43], v[144:147], v[136:139], v[40:43]
ds_read_b64_tr_b16 v[184:185], v9 offset:0
s_waitcnt lgkmcnt(13)
v_mfma_f32_16x16x32_bf16 v[40:43], v[148:151], v[140:143], v[40:43]
ds_read_b64_tr_b16 v[186:187], v9 offset:512
v_mfma_f32_16x16x32_bf16 v[44:47], v[152:155], v[136:139], v[44:47]
ds_read_b64_tr_b16 v[188:189], v9 offset:4096
v_mfma_f32_16x16x32_bf16 v[44:47], v[156:159], v[140:143], v[44:47]
ds_read_b64_tr_b16 v[190:191], v9 offset:4608
s_waitcnt lgkmcnt(14)
v_mfma_f32_16x16x32_bf16 v[48:51], v[112:115], v[160:163], v[48:51]
s_mov_b64 exec, 1
ds_write_b32 v3, v4
s_mov_b64 exec, -1
s_waitcnt lgkmcnt(13)
v_mfma_f32_16x16x32_bf16 v[48:51], v[116:119], v[164:167], v[48:51]
v_add_u32 v8, s67, v8
v_add_u32 v9, s67, v9
s_waitcnt lgkmcnt(11)
v_mfma_f32_16x16x32_bf16 v[52:55], v[112:115], v[168:171], v[52:55]
v_add_u32 v6, s67, v6
v_add_u32 v7, s67, v7
s_waitcnt lgkmcnt(9)
v_mfma_f32_16x16x32_bf16 v[52:55], v[116:119], v[172:175], v[52:55]
s_mov_b32 s70, s67
s_mov_b32 s67, s68
s_mov_b32 s68, s69
s_mov_b32 s69, s70
v_mfma_f32_16x16x32_bf16 v[56:59], v[120:123], v[160:163], v[56:59]
ds_read_b32 v5, v2 offset:16
v_mfma_f32_16x16x32_bf16 v[56:59], v[124:127], v[164:167], v[56:59]
v_mfma_f32_16x16x32_bf16 v[60:63], v[120:123], v[168:171], v[60:63]
v_mfma_f32_16x16x32_bf16 v[60:63], v[124:127], v[172:175], v[60:63]
v_mfma_f32_16x16x32_bf16 v[64:67], v[128:131], v[160:163], v[64:67]
s_waitcnt lgkmcnt(0)
v_cmp_ge_u32 vcc, v4, v5
s_cbranch_vccnz mspin_130
mback_131:
v_add_u32 v4, 1, v4
v_mfma_f32_16x16x32_bf16 v[64:67], v[132:135], v[164:167], v[64:67]
ds_read_b64_tr_b16 v[144:145], v8 offset:8192
v_mfma_f32_16x16x32_bf16 v[68:71], v[128:131], v[168:171], v[68:71]
ds_read_b64_tr_b16 v[146:147], v8 offset:8704
v_mfma_f32_16x16x32_bf16 v[68:71], v[132:135], v[172:175], v[68:71]
ds_read_b64_tr_b16 v[148:149], v8 offset:12288
v_mfma_f32_16x16x32_bf16 v[72:75], v[136:139], v[160:163], v[72:75]
ds_read_b64_tr_b16 v[150:151], v8 offset:12800
v_mfma_f32_16x16x32_bf16 v[72:75], v[140:143], v[164:167], v[72:75]
ds_read_b64_tr_b16 v[152:153], v9 offset:8192
v_mfma_f32_16x16x32_bf16 v[76:79], v[136:139], v[168:171], v[76:79]
ds_read_b64_tr_b16 v[154:155], v9 offset:8704
v_mfma_f32_16x16x32_bf16 v[76:79], v[140:143], v[172:175], v[76:79]
ds_read_b64_tr_b16 v[156:157], v9 offset:12288
v_mfma_f32_16x16x32_bf16 v[80:83], v[176:179], v[112:115], v[80:83]
ds_read_b64_tr_b16 v[158:159], v9 offset:12800
v_mfma_f32_16x16x32_bf16 v[80:83], v[180:183], v[116:119], v[80:83]
v_mfma_f32_16x16x32_bf16 v[84:87], v[184:187], v[112:115], v[84:87]
v_mfma_f32_16x16x32_bf16 v[84:87], v[188:191], v[116:119], v[84:87]
ds_read_b128 v[112:115], v6 offset:0
ds_read_b128 v[116:119], v7 offset:0
v_mfma_f32_16x16x32_bf16 v[88:91], v[176:179], v[120:123], v[88:91]
v_mfma_f32_16x16x32_bf16 v[88:91], v[180:183], v[124:127], v[88:91]
v_mfma_f32_16x16x32_bf16 v[92:95], v[184:187], v[120:123], v[92:95]
v_mfma_f32_16x16x32_bf16 v[92:95], v[188:191], v[124:127], v[92:95]
ds_read_b128 v[120:123], v6 offset:2048
ds_read_b128 v[124:127], v7 offset:2048
v_mfma_f32_16x16x32_bf16 v[96:99], v[176:179], v[128:131], v[96:99]
v_mfma_f32_16x16x32_bf16 v[96:99], v[180:183], v[132:135], v[96:99]
v_mfma_f32_16x16x32_bf16 v[100:103], v[184:187], v[128:131], v[100:103]
v_mfma_f32_16x16x32_bf16 v[100:103], v[188:191], v[132:135], v[100:103]
ds_read_b128 v[128:131], v6 offset:4096
ds_read_b128 v[132:135], v7 offset:4096
v_mfma_f32_16x16x32_bf16 v[104:107], v[176:179], v[136:139], v[104:107]
v_mfma_f32_16x16x32_bf16 v[104:107], v[180:183], v[140:143], v[104:107]
s_sub_u32 s66, s66, 1
s_cmp_eq_u32 s66, 0
v_mfma_f32_16x16x32_bf16 v[108:111], v[184:187], v[136:139], v[108:111]
v_mfma_f32_16x16x32_bf16 v[108:111], v[188:191], v[140:143], v[108:111]
ds_read_b128 v[136:139], v6 offset:6144
ds_read_b128 v[140:143], v7 offset:6144
s_cbranch_scc0 mqkv_129
s_waitcnt lgkmcnt(7)
v_mfma_f32_16x16x32_bf16 v[16:19], v[144:147], v[112:115], v[16:19]
ds_read_b32 v5, v2 offset:24
s_add_u32 s35, s34, 2
v_mov_b32 v6, 0
ds_read_b64_tr_b16 v[160:161], v8 offset:16384
s_waitcnt lgkmcnt(8)
v_mfma_f32_16x16x32_bf16 v[16:19], v[148:151], v[116:119], v[16:19]
ds_read_b64_tr_b16 v[162:163], v8 offset:16896
v_mfma_f32_16x16x32_bf16 v[20:23], v[152:155], v[112:115], v[20:23]
ds_read_b64_tr_b16 v[164:165], v8 offset:20480
v_mfma_f32_16x16x32_bf16 v[20:23], v[156:159], v[116:119], v[20:23]
ds_read_b64_tr_b16 v[166:167], v8 offset:20992
s_waitcnt lgkmcnt(10)
v_mfma_f32_16x16x32_bf16 v[24:27], v[144:147], v[120:123], v[24:27]
ds_read_b64_tr_b16 v[168:169], v9 offset:16384
s_waitcnt lgkmcnt(10)
v_mfma_f32_16x16x32_bf16 v[24:27], v[148:151], v[124:127], v[24:27]
ds_read_b64_tr_b16 v[170:171], v9 offset:16896
v_mfma_f32_16x16x32_bf16 v[28:31], v[152:155], v[120:123], v[28:31]
ds_read_b64_tr_b16 v[172:173], v9 offset:20480
s_waitcnt lgkmcnt(7)
v_cmp_gt_i32 vcc, s35, v5
s_cbranch_vccnz lspin_134
lback_135:
ds_read2_b32 v[6:7], v6 offset0:8 offset1:14
ds_read_b128 v[200:203], v211 offset:2432
v_mfma_f32_16x16x32_bf16 v[28:31], v[156:159], v[124:127], v[28:31]
ds_read_b64_tr_b16 v[174:175], v9 offset:20992
ds_read_b128 v[204:207], v211 offset:2496
ds_read2_b32 v[192:193], v208 offset0:0 offset1:128
v_mfma_f32_16x16x32_bf16 v[32:35], v[144:147], v[128:131], v[32:35]
ds_read2_b32 v[194:195], v208 offset0:16 offset1:144
v_mfma_f32_16x16x32_bf16 v[32:35], v[148:151], v[132:135], v[32:35]
ds_read2_b32 v[196:197], v208 offset0:32 offset1:160
ds_read2_b32 v[198:199], v208 offset0:48 offset1:176
v_mfma_f32_16x16x32_bf16 v[36:39], v[152:155], v[128:131], v[36:39]
ds_read_b64_tr_b16 v[176:177], v8 offset:0
ds_read_b64_tr_b16 v[178:179], v8 offset:512
v_mfma_f32_16x16x32_bf16 v[36:39], v[156:159], v[132:135], v[36:39]
ds_read_b64_tr_b16 v[180:181], v8 offset:4096
v_mfma_f32_16x16x32_bf16 v[40:43], v[144:147], v[136:139], v[40:43]
ds_read_b64_tr_b16 v[182:183], v8 offset:4608
ds_read_b64_tr_b16 v[184:185], v9 offset:0
v_mfma_f32_16x16x32_bf16 v[40:43], v[148:151], v[140:143], v[40:43]
ds_read_b64_tr_b16 v[186:187], v9 offset:512
ds_read_b64_tr_b16 v[188:189], v9 offset:4096
v_mfma_f32_16x16x32_bf16 v[44:47], v[152:155], v[136:139], v[44:47]
ds_read_b64_tr_b16 v[190:191], v9 offset:4608
v_mfma_f32_16x16x32_bf16 v[44:47], v[156:159], v[140:143], v[44:47]
s_mov_b64 exec, 1
ds_write_b32 v3, v4
s_mov_b64 exec, -1
s_waitcnt lgkmcnt(14)
v_readfirstlane_b32 s33, v6
v_readfirstlane_b32 s57, v7
s_sub_u32 s33, s33, 1
s_lshr_b32 s66, s33, 7
s_mov_b32 s73, -1
v_mfma_f32_16x16x32_bf16 v[48:51], v[112:115], v[160:163], v[48:51]
s_cmp_eq_u32 s66, s59
s_cbranch_scc1 patch_136
pback_137:
v_mfma_f32_16x16x32_bf16 v[48:51], v[116:119], v[164:167], v[48:51]
ds_read_b32 v10, v210 offset:2560
ds_read_b32 v11, v210 offset:2624
s_waitcnt lgkmcnt(14)
v_mul_f32 v16, v16, v192
v_mul_f32 v17, v17, v192
v_mul_f32 v18, v18, v192
v_mfma_f32_16x16x32_bf16 v[52:55], v[112:115], v[168:171], v[52:55]
v_mul_f32 v19, v19, v192
v_mul_f32 v20, v20, v192
v_mul_f32 v21, v21, v192
v_mul_f32 v22, v22, v192
v_mul_f32 v23, v23, v192
v_mfma_f32_16x16x32_bf16 v[52:55], v[116:119], v[172:175], v[52:55]
v_fmac_f32 v16, v200, v193
v_fmac_f32 v17, v201, v193
v_fmac_f32 v18, v202, v193
v_fmac_f32 v19, v203, v193
v_fmac_f32 v20, v204, v193
v_mfma_f32_16x16x32_bf16 v[56:59], v[120:123], v[160:163], v[56:59]
v_fmac_f32 v21, v205, v193
v_fmac_f32 v22, v206, v193
v_fmac_f32 v23, v207, v193
v_cvt_pk_bf16_f32 v16, v16, v17
v_cvt_pk_bf16_f32 v17, v18, v19
v_mfma_f32_16x16x32_bf16 v[56:59], v[124:127], v[164:167], v[56:59]
v_cvt_pk_bf16_f32 v18, v20, v21
v_cvt_pk_bf16_f32 v19, v22, v23
buffer_store_dwordx4 v[16:19], v12, s[20:23], s71 offen offset:0 sc1
ds_write_b128 v12, v[16:19] offset:0
ds_read_b128 v[144:147], v209 offset:0
v_mfma_f32_16x16x32_bf16 v[60:63], v[120:123], v[168:171], v[60:63]
ds_read_b128 v[20:23], v209 offset:512
s_waitcnt lgkmcnt(14)
v_mul_f32 v24, v24, v194
v_mul_f32 v25, v25, v194
v_mul_f32 v26, v26, v194
v_mul_f32 v27, v27, v194
v_mfma_f32_16x16x32_bf16 v[60:63], v[124:127], v[172:175], v[60:63]
v_mul_f32 v28, v28, v194
v_mul_f32 v29, v29, v194
v_mul_f32 v30, v30, v194
v_mul_f32 v31, v31, v194
v_fmac_f32 v24, v200, v195
v_mfma_f32_16x16x32_bf16 v[64:67], v[128:131], v[160:163], v[64:67]
v_fmac_f32 v25, v201, v195
v_fmac_f32 v26, v202, v195
v_fmac_f32 v27, v203, v195
v_fmac_f32 v28, v204, v195
v_mfma_f32_16x16x32_bf16 v[64:67], v[132:135], v[164:167], v[64:67]
v_fmac_f32 v29, v205, v195
v_fmac_f32 v30, v206, v195
v_fmac_f32 v31, v207, v195
v_cvt_pk_bf16_f32 v24, v24, v25
v_cvt_pk_bf16_f32 v25, v26, v27
v_mfma_f32_16x16x32_bf16 v[68:71], v[128:131], v[168:171], v[68:71]
v_cvt_pk_bf16_f32 v26, v28, v29
v_cvt_pk_bf16_f32 v27, v30, v31
buffer_store_dwordx4 v[24:27], v12, s[20:23], s71 offen offset:128 sc1
ds_write_b128 v12, v[24:27] offset:128
ds_read_b128 v[148:151], v209 offset:64
v_mfma_f32_16x16x32_bf16 v[68:71], v[132:135], v[172:175], v[68:71]
ds_read_b128 v[28:31], v209 offset:576
v_mul_f32 v32, v32, v196
v_mul_f32 v33, v33, v196
v_mul_f32 v34, v34, v196
v_mul_f32 v35, v35, v196
v_mfma_f32_16x16x32_bf16 v[72:75], v[136:139], v[160:163], v[72:75]
v_mul_f32 v36, v36, v196
v_mul_f32 v37, v37, v196
v_mul_f32 v38, v38, v196
v_mul_f32 v39, v39, v196
v_fmac_f32 v32, v200, v197
v_mfma_f32_16x16x32_bf16 v[72:75], v[140:143], v[164:167], v[72:75]
v_fmac_f32 v33, v201, v197
v_fmac_f32 v34, v202, v197
v_fmac_f32 v35, v203, v197
v_fmac_f32 v36, v204, v197
v_fmac_f32 v37, v205, v197
v_mfma_f32_16x16x32_bf16 v[76:79], v[136:139], v[168:171], v[76:79]
v_fmac_f32 v38, v206, v197
v_fmac_f32 v39, v207, v197
v_cvt_pk_bf16_f32 v32, v32, v33
v_cvt_pk_bf16_f32 v33, v34, v35
v_cvt_pk_bf16_f32 v34, v36, v37
v_mfma_f32_16x16x32_bf16 v[76:79], v[140:143], v[172:175], v[76:79]
v_cvt_pk_bf16_f32 v35, v38, v39
buffer_store_dwordx4 v[32:35], v13, s[20:23], s71 offen offset:0 sc1
ds_write_b128 v13, v[32:35] offset:0
ds_read_b128 v[152:155], v209 offset:128
ds_read_b128 v[36:39], v209 offset:640
v_mul_f32 v40, v40, v198
v_mul_f32 v41, v41, v198
v_mul_f32 v42, v42, v198
v_mul_f32 v43, v43, v198
v_mul_f32 v44, v44, v198
v_mul_f32 v45, v45, v198
v_mul_f32 v46, v46, v198
v_mul_f32 v47, v47, v198
v_fmac_f32 v40, v200, v199
v_fmac_f32 v41, v201, v199
v_fmac_f32 v42, v202, v199
v_fmac_f32 v43, v203, v199
v_fmac_f32 v44, v204, v199
v_fmac_f32 v45, v205, v199
v_fmac_f32 v46, v206, v199
v_fmac_f32 v47, v207, v199
v_cvt_pk_bf16_f32 v40, v40, v41
v_cvt_pk_bf16_f32 v41, v42, v43
v_cvt_pk_bf16_f32 v42, v44, v45
v_cvt_pk_bf16_f32 v43, v46, v47
buffer_store_dwordx4 v[40:43], v13, s[20:23], s71 offen offset:128 sc1
ds_write_b128 v13, v[40:43] offset:128
ds_read_b128 v[156:159], v209 offset:192
ds_read_b128 v[44:47], v209 offset:704
s_cmp_ge_i32 s73, 0
s_cbranch_scc1 patch_138
pback_139:
ds_read_b128 v[160:163], v211 offset:2304
ds_read_b128 v[164:167], v211 offset:2368
s_waitcnt lgkmcnt(12)
v_pk_mul_f32 v[48:49], v[48:49], v[144:145]
v_pk_mul_f32 v[50:51], v[50:51], v[146:147]
s_waitcnt lgkmcnt(11)
v_pk_fma_f32 v[48:49], v[20:21], v[10:11], v[48:49] op_sel:[0,0,0] op_sel_hi:[1,0,1]
v_pk_fma_f32 v[50:51], v[22:23], v[10:11], v[50:51] op_sel:[0,0,0] op_sel_hi:[1,0,1]
s_waitcnt lgkmcnt(9)
v_pk_mul_f32 v[56:57], v[56:57], v[148:149]
v_pk_mul_f32 v[58:59], v[58:59], v[150:151]
s_waitcnt lgkmcnt(8)
v_pk_fma_f32 v[56:57], v[28:29], v[10:11], v[56:57] op_sel:[0,0,0] op_sel_hi:[1,0,1]
v_pk_fma_f32 v[58:59], v[30:31], v[10:11], v[58:59] op_sel:[0,0,0] op_sel_hi:[1,0,1]
v_cvt_pk_bf16_f32 v48, v48, v49
v_cvt_pk_bf16_f32 v49, v50, v51
v_cvt_pk_bf16_f32 v50, v56, v57
v_cvt_pk_bf16_f32 v51, v58, v59
buffer_store_dwordx4 v[48:51], v14, s[20:23], s71 offen offset:2048 sc1
ds_write_b128 v14, v[48:51] offset:2048
v_pk_mul_f32 v[52:53], v[52:53], v[144:145]
v_pk_mul_f32 v[54:55], v[54:55], v[146:147]
v_pk_fma_f32 v[52:53], v[20:21], v[10:11], v[52:53] op_sel:[0,1,0] op_sel_hi:[1,1,1]
v_pk_fma_f32 v[54:55], v[22:23], v[10:11], v[54:55] op_sel:[0,1,0] op_sel_hi:[1,1,1]
v_pk_mul_f32 v[60:61], v[60:61], v[148:149]
v_pk_mul_f32 v[62:63], v[62:63], v[150:151]
v_pk_fma_f32 v[60:61], v[28:29], v[10:11], v[60:61] op_sel:[0,1,0] op_sel_hi:[1,1,1]
v_pk_fma_f32 v[62:63], v[30:31], v[10:11], v[62:63] op_sel:[0,1,0] op_sel_hi:[1,1,1]
v_cvt_pk_bf16_f32 v52, v52, v53
v_cvt_pk_bf16_f32 v53, v54, v55
v_cvt_pk_bf16_f32 v54, v60, v61
v_cvt_pk_bf16_f32 v55, v62, v63
buffer_store_dwordx4 v[52:55], v14, s[20:23], s71 offen offset:2304 sc1
ds_write_b128 v14, v[52:55] offset:2304
s_waitcnt lgkmcnt(8)
v_pk_mul_f32 v[64:65], v[64:65], v[152:153]
v_pk_mul_f32 v[66:67], v[66:67], v[154:155]
s_waitcnt lgkmcnt(7)
v_pk_fma_f32 v[64:65], v[36:37], v[10:11], v[64:65] op_sel:[0,0,0] op_sel_hi:[1,0,1]
v_pk_fma_f32 v[66:67], v[38:39], v[10:11], v[66:67] op_sel:[0,0,0] op_sel_hi:[1,0,1]
s_waitcnt lgkmcnt(5)
v_pk_mul_f32 v[72:73], v[72:73], v[156:157]
v_pk_mul_f32 v[74:75], v[74:75], v[158:159]
s_waitcnt lgkmcnt(4)
v_pk_fma_f32 v[72:73], v[44:45], v[10:11], v[72:73] op_sel:[0,0,0] op_sel_hi:[1,0,1]
v_pk_fma_f32 v[74:75], v[46:47], v[10:11], v[74:75] op_sel:[0,0,0] op_sel_hi:[1,0,1]
v_cvt_pk_bf16_f32 v64, v64, v65
v_cvt_pk_bf16_f32 v65, v66, v67
v_cvt_pk_bf16_f32 v66, v72, v73
v_cvt_pk_bf16_f32 v67, v74, v75
buffer_store_dwordx4 v[64:67], v15, s[20:23], s71 offen offset:2048 sc1
ds_write_b128 v15, v[64:67] offset:2048
v_pk_mul_f32 v[68:69], v[68:69], v[152:153]
v_pk_mul_f32 v[70:71], v[70:71], v[154:155]
v_pk_fma_f32 v[68:69], v[36:37], v[10:11], v[68:69] op_sel:[0,1,0] op_sel_hi:[1,1,1]
v_pk_fma_f32 v[70:71], v[38:39], v[10:11], v[70:71] op_sel:[0,1,0] op_sel_hi:[1,1,1]
v_pk_mul_f32 v[76:77], v[76:77], v[156:157]
v_pk_mul_f32 v[78:79], v[78:79], v[158:159]
v_pk_fma_f32 v[76:77], v[44:45], v[10:11], v[76:77] op_sel:[0,1,0] op_sel_hi:[1,1,1]
v_pk_fma_f32 v[78:79], v[46:47], v[10:11], v[78:79] op_sel:[0,1,0] op_sel_hi:[1,1,1]
v_cvt_pk_bf16_f32 v68, v68, v69
v_cvt_pk_bf16_f32 v69, v70, v71
v_cvt_pk_bf16_f32 v70, v76, v77
v_cvt_pk_bf16_f32 v71, v78, v79
buffer_store_dwordx4 v[68:71], v15, s[20:23], s71 offen offset:2304 sc1
ds_write_b128 v15, v[68:71] offset:2304
v_add_u32 v5, s34, 17
s_mov_b64 exec, 1
ds_write_b32 v3, v5
s_mov_b64 exec, -1
s_mov_b32 s66, 0x3e8293ee
v_mfma_f32_16x16x32_bf16 v[96:99], v[176:179], v[128:131], v[96:99]
v_mul_f32 v192, s66, v192
v_mfma_f32_16x16x32_bf16 v[96:99], v[180:183], v[132:135], v[96:99]
v_mfma_f32_16x16x32_bf16 v[100:103], v[184:187], v[128:131], v[100:103]
v_mul_f32 v193, s66, v193
v_mfma_f32_16x16x32_bf16 v[100:103], v[188:191], v[132:135], v[100:103]
v_mfma_f32_16x16x32_bf16 v[104:107], v[176:179], v[136:139], v[104:107]
v_mul_f32 v194, s66, v194
v_mfma_f32_16x16x32_bf16 v[104:107], v[180:183], v[140:143], v[104:107]
v_mfma_f32_16x16x32_bf16 v[108:111], v[184:187], v[136:139], v[108:111]
v_mul_f32 v195, s66, v195
v_mfma_f32_16x16x32_bf16 v[108:111], v[188:191], v[140:143], v[108:111]
v_mfma_f32_16x16x32_bf16 v[80:83], v[176:179], v[112:115], v[80:83]
v_mul_f32 v196, s66, v196
v_mfma_f32_16x16x32_bf16 v[80:83], v[180:183], v[116:119], v[80:83]
v_mfma_f32_16x16x32_bf16 v[84:87], v[184:187], v[112:115], v[84:87]
v_mul_f32 v197, s66, v197
v_mfma_f32_16x16x32_bf16 v[84:87], v[188:191], v[116:119], v[84:87]
v_mfma_f32_16x16x32_bf16 v[88:91], v[176:179], v[120:123], v[88:91]
v_mul_f32 v198, s66, v198
v_mfma_f32_16x16x32_bf16 v[88:91], v[180:183], v[124:127], v[88:91]
v_mfma_f32_16x16x32_bf16 v[92:95], v[184:187], v[120:123], v[92:95]
v_mul_f32 v199, s66, v199
v_mfma_f32_16x16x32_bf16 v[92:95], v[188:191], v[124:127], v[92:95]
s_cmp_ge_i32 s73, 0
s_cbranch_scc1 patch_140
pback_141:
v_mov_b32 v200, 0
v_mov_b32 v201, 0
v_mov_b32 v202, 0
v_mov_b32 v203, 0
v_mov_b32 v204, 0
v_mov_b32 v205, 0
v_mov_b32 v206, 0
v_mov_b32 v207, 0
v_mov_b32 v208, 0
v_mov_b32 v209, 0
v_mov_b32 v210, 0
v_mov_b32 v211, 0
v_pk_mul_f32 v[96:97], v[96:97], v[196:197] op_sel:[0,0] op_sel_hi:[1,0]
v_pk_mul_f32 v[98:99], v[98:99], v[196:197] op_sel:[0,0] op_sel_hi:[1,0]
v_pk_mul_f32 v[100:101], v[100:101], v[196:197] op_sel:[0,0] op_sel_hi:[1,0]
v_pk_mul_f32 v[102:103], v[102:103], v[196:197] op_sel:[0,0] op_sel_hi:[1,0]
s_waitcnt lgkmcnt(6)
v_pk_fma_f32 v[96:97], v[160:161], v[196:197], v[96:97] op_sel:[0,1,0] op_sel_hi:[1,1,1]
v_pk_fma_f32 v[98:99], v[162:163], v[196:197], v[98:99] op_sel:[0,1,0] op_sel_hi:[1,1,1]
s_waitcnt lgkmcnt(5)
v_pk_fma_f32 v[100:101], v[164:165], v[196:197], v[100:101] op_sel:[0,1,0] op_sel_hi:[1,1,1]
v_pk_fma_f32 v[102:103], v[166:167], v[196:197], v[102:103] op_sel:[0,1,0] op_sel_hi:[1,1,1]
v_cvt_pk_bf16_f32 v96, v96, v97
v_cvt_pk_bf16_f32 v97, v98, v99
v_cvt_pk_bf16_f32 v98, v100, v101
v_cvt_pk_bf16_f32 v99, v102, v103
v_pk_mul_f32 v[104:105], v[104:105], v[198:199] op_sel:[0,0] op_sel_hi:[1,0]
v_pk_mul_f32 v[106:107], v[106:107], v[198:199] op_sel:[0,0] op_sel_hi:[1,0]
v_pk_mul_f32 v[108:109], v[108:109], v[198:199] op_sel:[0,0] op_sel_hi:[1,0]
v_pk_mul_f32 v[110:111], v[110:111], v[198:199] op_sel:[0,0] op_sel_hi:[1,0]
v_pk_fma_f32 v[104:105], v[160:161], v[198:199], v[104:105] op_sel:[0,1,0] op_sel_hi:[1,1,1]
v_pk_fma_f32 v[106:107], v[162:163], v[198:199], v[106:107] op_sel:[0,1,0] op_sel_hi:[1,1,1]
v_pk_fma_f32 v[108:109], v[164:165], v[198:199], v[108:109] op_sel:[0,1,0] op_sel_hi:[1,1,1]
v_pk_fma_f32 v[110:111], v[166:167], v[198:199], v[110:111] op_sel:[0,1,0] op_sel_hi:[1,1,1]
v_cvt_pk_bf16_f32 v104, v104, v105
v_cvt_pk_bf16_f32 v105, v106, v107
v_cvt_pk_bf16_f32 v106, v108, v109
v_cvt_pk_bf16_f32 v107, v110, v111
v_pk_mul_f32 v[80:81], v[80:81], v[192:193] op_sel:[0,0] op_sel_hi:[1,0]
v_pk_mul_f32 v[82:83], v[82:83], v[192:193] op_sel:[0,0] op_sel_hi:[1,0]
v_pk_mul_f32 v[84:85], v[84:85], v[192:193] op_sel:[0,0] op_sel_hi:[1,0]
v_pk_mul_f32 v[86:87], v[86:87], v[192:193] op_sel:[0,0] op_sel_hi:[1,0]
v_pk_fma_f32 v[80:81], v[160:161], v[192:193], v[80:81] op_sel:[0,1,0] op_sel_hi:[1,1,1]
v_pk_fma_f32 v[82:83], v[162:163], v[192:193], v[82:83] op_sel:[0,1,0] op_sel_hi:[1,1,1]
v_pk_fma_f32 v[84:85], v[164:165], v[192:193], v[84:85] op_sel:[0,1,0] op_sel_hi:[1,1,1]
v_pk_fma_f32 v[86:87], v[166:167], v[192:193], v[86:87] op_sel:[0,1,0] op_sel_hi:[1,1,1]
v_cvt_pk_bf16_f32 v80, v80, v81
v_cvt_pk_bf16_f32 v81, v82, v83
v_cvt_pk_bf16_f32 v82, v84, v85
v_cvt_pk_bf16_f32 v83, v86, v87
v_pk_mul_f32 v[88:89], v[88:89], v[194:195] op_sel:[0,0] op_sel_hi:[1,0]
v_pk_mul_f32 v[90:91], v[90:91], v[194:195] op_sel:[0,0] op_sel_hi:[1,0]
v_pk_mul_f32 v[92:93], v[92:93], v[194:195] op_sel:[0,0] op_sel_hi:[1,0]
v_pk_mul_f32 v[94:95], v[94:95], v[194:195] op_sel:[0,0] op_sel_hi:[1,0]
v_pk_fma_f32 v[88:89], v[160:161], v[194:195], v[88:89] op_sel:[0,1,0] op_sel_hi:[1,1,1]
v_pk_fma_f32 v[90:91], v[162:163], v[194:195], v[90:91] op_sel:[0,1,0] op_sel_hi:[1,1,1]
v_pk_fma_f32 v[92:93], v[164:165], v[194:195], v[92:93] op_sel:[0,1,0] op_sel_hi:[1,1,1]
v_pk_fma_f32 v[94:95], v[166:167], v[194:195], v[94:95] op_sel:[0,1,0] op_sel_hi:[1,1,1]
v_cvt_pk_bf16_f32 v88, v88, v89
v_cvt_pk_bf16_f32 v89, v90, v91
v_cvt_pk_bf16_f32 v90, v92, v93
v_cvt_pk_bf16_f32 v91, v94, v95
v_permlane16_swap_b32 v96, v104
v_permlane16_swap_b32 v97, v105
v_permlane16_swap_b32 v98, v106
v_permlane16_swap_b32 v99, v107
v_permlane16_swap_b32 v80, v88
v_permlane16_swap_b32 v81, v89
v_permlane16_swap_b32 v82, v90
v_permlane16_swap_b32 v83, v91
v_mov_b32 v192, 0
v_mov_b32 v193, 0
v_mov_b32 v194, 0
v_mov_b32 v195, 0
v_mov_b32 v196, 0
v_mov_b32 v197, 0
v_mov_b32 v198, 0
v_mov_b32 v199, 0
s_lshl_b32 s69, s64, 12
v_lshl_add_u32 v6, v0, 4, s69
v_add_u32 v7, 131072, v6
s_lshl_b32 s69, s65, 13
s_add_u32 s66, s69, 131072
s_sub_u32 s69, 147456, s69
v_add_u32 v8, s69, v6
ds_read_b128 v[152:155], v8 offset:8192
ds_read_b128 v[156:159], v8 offset:9216
s_mov_b32 s67, 122880
s_min_u32 s69, s59, 1
s_lshl2_add_u32 s68, s69, s65
s_cmp_ge_u32 s59, 2
s_cselect_b32 s69, s65, 0
s_add_u32 s68, s68, s69
ds_read_b128 v[160:163], v8 offset:10240
ds_read_b128 v[164:167], v8 offset:11264
s_waitcnt lgkmcnt(3)
v_mfma_f32_32x32x16_bf16 v[112:127], v[152:155], v[96:99], v[216:231]
s_waitcnt lgkmcnt(2)
v_mfma_f32_32x32x16_bf16 v[112:127], v[156:159], v[104:107], v[112:127]
s_add_u32 s35, s34, 17
lw_142:
ds_read_b32 v5, v1 offset:0
s_waitcnt lgkmcnt(0)
v_cmp_gt_i32 vcc, s35, v5
s_cbranch_vccz lwd_143
s_sub_u32 s32, s32, 1
s_cmp_gt_i32 s32, 0
s_cbranch_scc1 lw_142
lwd_143:
ds_read_b128 v[152:155], v8 offset:0
ds_read_b128 v[156:159], v8 offset:1024
s_add_u32 s70, s72, 270336
s_mov_b64 exec, 1
s_waitcnt vmcnt(0)
buffer_store_dword v7, v3, s[24:27], s70 offen sc1
s_mov_b64 exec, -1
.p2align 3
v_exp_f32 v112, v112
v_exp_f32 v113, v113
v_exp_f32 v114, v114
v_exp_f32 v115, v115
v_exp_f32 v116, v116
v_exp_f32 v117, v117
s_waitcnt lgkmcnt(1)
v_mfma_f32_32x32x16_bf16 v[128:143], v[152:155], v[96:99], 0
v_exp_f32 v118, v118
v_exp_f32 v119, v119
v_cvt_pk_bf16_f32 v144, v112, v113
v_cvt_pk_bf16_f32 v145, v114, v115
s_waitcnt lgkmcnt(0)
v_mfma_f32_32x32x16_bf16 v[128:143], v[156:159], v[104:107], v[128:143]
ds_read_b128 v[152:155], v7 offset:8192
ds_read_b128 v[156:159], v7 offset:9216
v_cvt_pk_bf16_f32 v146, v116, v117
v_cvt_pk_bf16_f32 v147, v118, v119
v_exp_f32 v120, v120
v_exp_f32 v121, v121
v_mfma_f32_32x32x16_bf16 v[16:31], v[160:163], v[144:147], 0
ds_read_b128 v[160:163], v8 offset:2048
v_exp_f32 v122, v122
v_exp_f32 v123, v123
v_exp_f32 v124, v124
v_mfma_f32_16x16x32_bf16 v[32:35], v[212:215], v[144:147], 0
s_cmp_eq_u32 s65, 1
v_exp_f32 v125, v125
v_exp_f32 v126, v126
v_exp_f32 v127, v127
v_cvt_pk_bf16_f32 v148, v120, v121
v_cvt_pk_bf16_f32 v149, v122, v123
v_cvt_pk_bf16_f32 v150, v124, v125
v_cvt_pk_bf16_f32 v151, v126, v127
s_cbranch_scc1 at_144
v_exp_f32 v128, v128
v_exp_f32 v129, v129
v_mfma_f32_32x32x16_bf16 v[16:31], v[164:167], v[148:151], v[16:31]
ds_read_b128 v[164:167], v8 offset:3072
v_exp_f32 v130, v130
v_exp_f32 v131, v131
v_exp_f32 v132, v132
v_mfma_f32_16x16x32_bf16 v[32:35], v[212:215], v[148:151], v[32:35]
v_exp_f32 v133, v133
s_waitcnt lgkmcnt(3)
v_mfma_f32_32x32x16_bf16 v[112:127], v[152:155], v[96:99], 0
v_exp_f32 v134, v134
v_exp_f32 v135, v135
v_cvt_pk_bf16_f32 v144, v128, v129
v_cvt_pk_bf16_f32 v145, v130, v131
s_waitcnt lgkmcnt(2)
v_mfma_f32_32x32x16_bf16 v[112:127], v[156:159], v[104:107], v[112:127]
ds_read_b128 v[152:155], v7 offset:0
ds_read_b128 v[156:159], v7 offset:1024
v_cvt_pk_bf16_f32 v146, v132, v133
v_cvt_pk_bf16_f32 v147, v134, v135
v_exp_f32 v136, v136
v_exp_f32 v137, v137
s_waitcnt lgkmcnt(3)
v_mfma_f32_32x32x16_bf16 v[16:31], v[160:163], v[144:147], v[16:31]
ds_read_b128 v[160:163], v7 offset:10240
v_exp_f32 v138, v138
v_exp_f32 v139, v139
v_exp_f32 v140, v140
v_mfma_f32_16x16x32_bf16 v[32:35], v[212:215], v[144:147], v[32:35]
v_exp_f32 v141, v141
v_exp_f32 v142, v142
v_exp_f32 v143, v143
v_cvt_pk_bf16_f32 v148, v136, v137
v_cvt_pk_bf16_f32 v149, v138, v139
v_cvt_pk_bf16_f32 v150, v140, v141
v_cvt_pk_bf16_f32 v151, v142, v143
v_exp_f32 v112, v112
v_exp_f32 v113, v113
s_waitcnt lgkmcnt(3)
v_mfma_f32_32x32x16_bf16 v[16:31], v[164:167], v[148:151], v[16:31]
ds_read_b128 v[164:167], v7 offset:11264
v_exp_f32 v114, v114
v_exp_f32 v115, v115
v_exp_f32 v116, v116
v_mfma_f32_16x16x32_bf16 v[32:35], v[212:215], v[148:151], v[32:35]
v_exp_f32 v117, v117
s_waitcnt lgkmcnt(3)
v_mfma_f32_32x32x16_bf16 v[128:143], v[152:155], v[96:99], 0
v_exp_f32 v118, v118
v_exp_f32 v119, v119
v_cvt_pk_bf16_f32 v144, v112, v113
v_cvt_pk_bf16_f32 v145, v114, v115
s_waitcnt lgkmcnt(2)
v_mfma_f32_32x32x16_bf16 v[128:143], v[156:159], v[104:107], v[128:143]
v_cvt_pk_bf16_f32 v146, v116, v117
v_cvt_pk_bf16_f32 v147, v118, v119
v_exp_f32 v120, v120
v_exp_f32 v121, v121
s_waitcnt lgkmcnt(1)
v_mfma_f32_32x32x16_bf16 v[16:31], v[160:163], v[144:147], v[16:31]
ds_read_b128 v[160:163], v7 offset:2048
v_exp_f32 v122, v122
v_exp_f32 v123, v123
v_exp_f32 v124, v124
v_mfma_f32_16x16x32_bf16 v[32:35], v[212:215], v[144:147], v[32:35]
v_mov_b32 v8, v7
v_exp_f32 v125, v125
v_exp_f32 v126, v126
v_exp_f32 v127, v127
v_cvt_pk_bf16_f32 v148, v120, v121
v_cvt_pk_bf16_f32 v149, v122, v123
v_cvt_pk_bf16_f32 v150, v124, v125
v_cvt_pk_bf16_f32 v151, v126, v127
.p2align 3
at_144:
v_exp_f32 v128, v128
v_exp_f32 v129, v129
s_waitcnt lgkmcnt(1)
v_mfma_f32_32x32x16_bf16 v[16:31], v[164:167], v[148:151], v[16:31]
ds_read_b128 v[164:167], v8 offset:3072
v_exp_f32 v130, v130
v_exp_f32 v131, v131
v_exp_f32 v132, v132
v_mfma_f32_16x16x32_bf16 v[32:35], v[212:215], v[148:151], v[32:35]
v_exp_f32 v133, v133
v_mfma_f32_32x32x16_bf16 v[112:127], v[152:155], v[80:83], v[216:231]
v_exp_f32 v134, v134
v_exp_f32 v135, v135
v_cvt_pk_bf16_f32 v144, v128, v129
v_cvt_pk_bf16_f32 v145, v130, v131
v_mfma_f32_32x32x16_bf16 v[112:127], v[156:159], v[88:91], v[112:127]
s_sub_u32 s66, s66, 8192
s_cmp_eq_u32 s66, s67
s_cbranch_scc1 cross_151
cback_152:
v_add_u32 v8, s66, v6
ds_read_b128 v[152:155], v8 offset:0
ds_read_b128 v[156:159], v8 offset:1024
v_cvt_pk_bf16_f32 v146, v132, v133
v_cvt_pk_bf16_f32 v147, v134, v135
v_exp_f32 v136, v136
v_exp_f32 v137, v137
s_waitcnt lgkmcnt(3)
v_mfma_f32_32x32x16_bf16 v[16:31], v[160:163], v[144:147], v[16:31]
v_exp_f32 v138, v138
v_exp_f32 v139, v139
v_exp_f32 v140, v140
v_mfma_f32_16x16x32_bf16 v[32:35], v[212:215], v[144:147], v[32:35]
s_cmp_eq_u32 s68, 0
v_exp_f32 v141, v141
v_exp_f32 v142, v142
v_exp_f32 v143, v143
v_cvt_pk_bf16_f32 v148, v136, v137
v_cvt_pk_bf16_f32 v149, v138, v139
v_cvt_pk_bf16_f32 v150, v140, v141
v_cvt_pk_bf16_f32 v151, v142, v143
s_cbranch_scc1 at_148
.p2align 3
at_145:
v_exp_f32 v112, v112
v_exp_f32 v113, v113
s_waitcnt lgkmcnt(2)
v_mfma_f32_32x32x16_bf16 v[16:31], v[164:167], v[148:151], v[16:31]
v_exp_f32 v114, v114
v_exp_f32 v115, v115
v_exp_f32 v116, v116
v_mfma_f32_16x16x32_bf16 v[32:35], v[212:215], v[148:151], v[32:35]
v_exp_f32 v117, v117
s_waitcnt lgkmcnt(1)
v_mfma_f32_32x32x16_bf16 v[128:143], v[152:155], v[96:99], 0
v_exp_f32 v118, v118
v_exp_f32 v119, v119
v_cvt_pk_bf16_f32 v144, v112, v113
v_cvt_pk_bf16_f32 v145, v114, v115
s_waitcnt lgkmcnt(0)
v_mfma_f32_32x32x16_bf16 v[128:143], v[156:159], v[104:107], v[128:143]
v_cvt_pk_bf16_f32 v146, v116, v117
v_cvt_pk_bf16_f32 v147, v118, v119
v_exp_f32 v120, v120
v_exp_f32 v121, v121
v_mfma_f32_32x32x16_bf16 v[192:207], v[160:163], v[144:147], v[192:207]
ds_read_b128 v[160:163], v8 offset:2048
v_exp_f32 v122, v122
v_exp_f32 v123, v123
v_exp_f32 v124, v124
v_mfma_f32_16x16x32_bf16 v[208:211], v[212:215], v[144:147], v[208:211]
ds_read_b32 v5, v2 offset:16
s_add_u32 s35, s34, 21
v_exp_f32 v125, v125
v_exp_f32 v126, v126
v_exp_f32 v127, v127
v_cvt_pk_bf16_f32 v148, v120, v121
v_cvt_pk_bf16_f32 v149, v122, v123
v_cvt_pk_bf16_f32 v150, v124, v125
v_cvt_pk_bf16_f32 v151, v126, v127
v_exp_f32 v128, v128
v_exp_f32 v129, v129
v_mfma_f32_32x32x16_bf16 v[192:207], v[164:167], v[148:151], v[192:207]
ds_read_b128 v[164:167], v8 offset:3072
v_exp_f32 v130, v130
v_exp_f32 v131, v131
v_exp_f32 v132, v132
v_mfma_f32_16x16x32_bf16 v[208:211], v[212:215], v[148:151], v[208:211]
v_exp_f32 v133, v133
v_mfma_f32_32x32x16_bf16 v[112:127], v[152:155], v[80:83], 0
v_exp_f32 v134, v134
v_exp_f32 v135, v135
v_cvt_pk_bf16_f32 v144, v128, v129
v_cvt_pk_bf16_f32 v145, v130, v131
v_mfma_f32_32x32x16_bf16 v[112:127], v[156:159], v[88:91], v[112:127]
s_sub_u32 s66, s66, 8192
s_cmp_eq_u32 s66, s67
s_cbranch_scc1 cross_153
cback_154:
v_add_u32 v8, s66, v6
ds_read_b128 v[152:155], v8 offset:0
ds_read_b128 v[156:159], v8 offset:1024
v_cvt_pk_bf16_f32 v146, v132, v133
v_cvt_pk_bf16_f32 v147, v134, v135
v_exp_f32 v136, v136
v_exp_f32 v137, v137
s_waitcnt lgkmcnt(4)
v_mfma_f32_32x32x16_bf16 v[16:31], v[160:163], v[144:147], v[16:31]
v_exp_f32 v138, v138
v_exp_f32 v139, v139
v_exp_f32 v140, v140
v_mfma_f32_16x16x32_bf16 v[32:35], v[212:215], v[144:147], v[32:35]
s_sub_u32 s68, s68, 1
s_cmp_eq_u32 s68, 0
v_exp_f32 v141, v141
v_exp_f32 v142, v142
v_exp_f32 v143, v143
v_cvt_pk_bf16_f32 v148, v136, v137
v_cvt_pk_bf16_f32 v149, v138, v139
v_cvt_pk_bf16_f32 v150, v140, v141
v_cvt_pk_bf16_f32 v151, v142, v143
s_cbranch_scc0 at_145
s_cmp_lt_u32 s59, 2
s_cbranch_scc1 at_148
.p2align 3
v_exp_f32 v112, v112
v_exp_f32 v113, v113
s_waitcnt lgkmcnt(2)
v_mfma_f32_32x32x16_bf16 v[16:31], v[164:167], v[148:151], v[16:31]
v_exp_f32 v114, v114
v_exp_f32 v115, v115
v_exp_f32 v116, v116
v_mfma_f32_16x16x32_bf16 v[32:35], v[212:215], v[148:151], v[32:35]
v_exp_f32 v117, v117
s_waitcnt lgkmcnt(1)
v_mfma_f32_32x32x16_bf16 v[128:143], v[152:155], v[96:99], v[216:231]
v_exp_f32 v118, v118
v_exp_f32 v119, v119
v_cvt_pk_bf16_f32 v144, v112, v113
v_cvt_pk_bf16_f32 v145, v114, v115
s_waitcnt lgkmcnt(0)
v_mfma_f32_32x32x16_bf16 v[128:143], v[156:159], v[104:107], v[128:143]
v_cvt_pk_bf16_f32 v146, v116, v117
v_cvt_pk_bf16_f32 v147, v118, v119
v_exp_f32 v120, v120
v_exp_f32 v121, v121
v_mfma_f32_32x32x16_bf16 v[192:207], v[160:163], v[144:147], v[192:207]
ds_read_b128 v[160:163], v8 offset:2048
v_exp_f32 v122, v122
v_exp_f32 v123, v123
v_exp_f32 v124, v124
v_mfma_f32_16x16x32_bf16 v[208:211], v[212:215], v[144:147], v[208:211]
v_exp_f32 v125, v125
v_exp_f32 v126, v126
v_exp_f32 v127, v127
v_cvt_pk_bf16_f32 v148, v120, v121
v_cvt_pk_bf16_f32 v149, v122, v123
v_cvt_pk_bf16_f32 v150, v124, v125
v_cvt_pk_bf16_f32 v151, v126, v127
v_exp_f32 v128, v128
v_exp_f32 v129, v129
v_mfma_f32_32x32x16_bf16 v[192:207], v[164:167], v[148:151], v[192:207]
ds_read_b128 v[164:167], v8 offset:3072
v_exp_f32 v130, v130
v_exp_f32 v131, v131
v_exp_f32 v132, v132
v_mfma_f32_16x16x32_bf16 v[208:211], v[212:215], v[148:151], v[208:211]
v_exp_f32 v133, v133
v_mfma_f32_32x32x16_bf16 v[112:127], v[152:155], v[80:83], 0
v_exp_f32 v134, v134
v_exp_f32 v135, v135
v_cvt_pk_bf16_f32 v144, v128, v129
v_cvt_pk_bf16_f32 v145, v130, v131
v_mfma_f32_32x32x16_bf16 v[112:127], v[156:159], v[88:91], v[112:127]
v_subrev_u32 v8, 8192, v8
ds_read_b128 v[152:155], v8 offset:0
ds_read_b128 v[156:159], v8 offset:1024
v_cvt_pk_bf16_f32 v146, v132, v133
v_cvt_pk_bf16_f32 v147, v134, v135
v_exp_f32 v136, v136
v_exp_f32 v137, v137
s_waitcnt lgkmcnt(3)
v_mfma_f32_32x32x16_bf16 v[16:31], v[160:163], v[144:147], v[16:31]
v_exp_f32 v138, v138
v_exp_f32 v139, v139
v_exp_f32 v140, v140
v_mfma_f32_16x16x32_bf16 v[32:35], v[212:215], v[144:147], v[32:35]
s_cmp_eq_u32 s65, 1
v_exp_f32 v141, v141
v_exp_f32 v142, v142
v_exp_f32 v143, v143
v_cvt_pk_bf16_f32 v148, v136, v137
v_cvt_pk_bf16_f32 v149, v138, v139
v_cvt_pk_bf16_f32 v150, v140, v141
v_cvt_pk_bf16_f32 v151, v142, v143
s_cbranch_scc1 at_147
.p2align 3
v_exp_f32 v112, v112
v_exp_f32 v113, v113
s_waitcnt lgkmcnt(2)
v_mfma_f32_32x32x16_bf16 v[16:31], v[164:167], v[148:151], v[16:31]
v_exp_f32 v114, v114
v_exp_f32 v115, v115
v_exp_f32 v116, v116
v_mfma_f32_16x16x32_bf16 v[32:35], v[212:215], v[148:151], v[32:35]
v_exp_f32 v117, v117
s_waitcnt lgkmcnt(1)
v_mfma_f32_32x32x16_bf16 v[128:143], v[152:155], v[80:83], 0
v_exp_f32 v118, v118
v_exp_f32 v119, v119
v_cvt_pk_bf16_f32 v144, v112, v113
v_cvt_pk_bf16_f32 v145, v114, v115
s_waitcnt lgkmcnt(0)
v_mfma_f32_32x32x16_bf16 v[128:143], v[156:159], v[88:91], v[128:143]
v_subrev_u32 v8, 8192, v8
ds_read_b128 v[152:155], v8 offset:0
ds_read_b128 v[156:159], v8 offset:1024
v_cvt_pk_bf16_f32 v146, v116, v117
v_cvt_pk_bf16_f32 v147, v118, v119
v_exp_f32 v120, v120
v_exp_f32 v121, v121
v_mfma_f32_32x32x16_bf16 v[192:207], v[160:163], v[144:147], v[192:207]
ds_read_b128 v[160:163], v8 offset:10240
v_exp_f32 v122, v122
v_exp_f32 v123, v123
v_exp_f32 v124, v124
v_mfma_f32_16x16x32_bf16 v[208:211], v[212:215], v[144:147], v[208:211]
v_exp_f32 v125, v125
v_exp_f32 v126, v126
v_exp_f32 v127, v127
v_cvt_pk_bf16_f32 v148, v120, v121
v_cvt_pk_bf16_f32 v149, v122, v123
v_cvt_pk_bf16_f32 v150, v124, v125
v_cvt_pk_bf16_f32 v151, v126, v127
v_exp_f32 v128, v128
v_exp_f32 v129, v129
v_mfma_f32_32x32x16_bf16 v[192:207], v[164:167], v[148:151], v[192:207]
ds_read_b128 v[164:167], v8 offset:11264
v_exp_f32 v130, v130
v_exp_f32 v131, v131
v_exp_f32 v132, v132
v_mfma_f32_16x16x32_bf16 v[208:211], v[212:215], v[148:151], v[208:211]
v_exp_f32 v133, v133
s_waitcnt lgkmcnt(3)
v_mfma_f32_32x32x16_bf16 v[112:127], v[152:155], v[80:83], 0
v_exp_f32 v134, v134
v_exp_f32 v135, v135
v_cvt_pk_bf16_f32 v144, v128, v129
v_cvt_pk_bf16_f32 v145, v130, v131
s_waitcnt lgkmcnt(2)
v_mfma_f32_32x32x16_bf16 v[112:127], v[156:159], v[88:91], v[112:127]
v_subrev_u32 v8, 8192, v8
ds_read_b128 v[152:155], v8 offset:0
ds_read_b128 v[156:159], v8 offset:1024
v_cvt_pk_bf16_f32 v146, v132, v133
v_cvt_pk_bf16_f32 v147, v134, v135
v_exp_f32 v136, v136
v_exp_f32 v137, v137
s_waitcnt lgkmcnt(3)
v_mfma_f32_32x32x16_bf16 v[192:207], v[160:163], v[144:147], v[192:207]
ds_read_b128 v[160:163], v8 offset:10240
v_exp_f32 v138, v138
v_exp_f32 v139, v139
v_exp_f32 v140, v140
v_mfma_f32_16x16x32_bf16 v[208:211], v[212:215], v[144:147], v[208:211]
v_exp_f32 v141, v141
v_exp_f32 v142, v142
v_exp_f32 v143, v143
v_cvt_pk_bf16_f32 v148, v136, v137
v_cvt_pk_bf16_f32 v149, v138, v139
v_cvt_pk_bf16_f32 v150, v140, v141
v_cvt_pk_bf16_f32 v151, v142, v143
v_exp_f32 v112, v112
v_exp_f32 v113, v113
s_waitcnt lgkmcnt(3)
v_mfma_f32_32x32x16_bf16 v[192:207], v[164:167], v[148:151], v[192:207]
ds_read_b128 v[164:167], v8 offset:11264
v_exp_f32 v114, v114
v_exp_f32 v115, v115
v_exp_f32 v116, v116
v_mfma_f32_16x16x32_bf16 v[208:211], v[212:215], v[148:151], v[208:211]
v_exp_f32 v117, v117
s_waitcnt lgkmcnt(3)
v_mfma_f32_32x32x16_bf16 v[128:143], v[152:155], v[80:83], v[216:231]
v_exp_f32 v118, v118
v_exp_f32 v119, v119
v_cvt_pk_bf16_f32 v144, v112, v113
v_cvt_pk_bf16_f32 v145, v114, v115
s_waitcnt lgkmcnt(2)
v_mfma_f32_32x32x16_bf16 v[128:143], v[156:159], v[88:91], v[128:143]
v_cvt_pk_bf16_f32 v146, v116, v117
v_cvt_pk_bf16_f32 v147, v118, v119
v_exp_f32 v120, v120
v_exp_f32 v121, v121
s_waitcnt lgkmcnt(1)
v_mfma_f32_32x32x16_bf16 v[192:207], v[160:163], v[144:147], v[192:207]
ds_read_b128 v[160:163], v8 offset:2048
v_exp_f32 v122, v122
v_exp_f32 v123, v123
v_exp_f32 v124, v124
v_mfma_f32_16x16x32_bf16 v[208:211], v[212:215], v[144:147], v[208:211]
v_exp_f32 v125, v125
v_exp_f32 v126, v126
v_exp_f32 v127, v127
v_cvt_pk_bf16_f32 v148, v120, v121
v_cvt_pk_bf16_f32 v149, v122, v123
v_cvt_pk_bf16_f32 v150, v124, v125
v_cvt_pk_bf16_f32 v151, v126, v127
s_branch at_149
.p2align 3
at_148:
s_waitcnt lgkmcnt(3)
v_add_u32 v5, s34, 20
s_mov_b64 exec, 1
ds_write_b32 v3, v5
s_mov_b64 exec, -1
v_exp_f32 v112, v112
v_exp_f32 v113, v113
s_waitcnt lgkmcnt(3)
v_mfma_f32_32x32x16_bf16 v[16:31], v[164:167], v[148:151], v[16:31]
v_exp_f32 v114, v114
v_exp_f32 v115, v115
v_exp_f32 v116, v116
v_mfma_f32_16x16x32_bf16 v[32:35], v[212:215], v[148:151], v[32:35]
v_exp_f32 v117, v117
v_exp_f32 v118, v118
v_exp_f32 v119, v119
v_cvt_pk_bf16_f32 v144, v112, v113
v_cvt_pk_bf16_f32 v145, v114, v115
v_cvt_pk_bf16_f32 v146, v116, v117
v_cvt_pk_bf16_f32 v147, v118, v119
v_exp_f32 v120, v120
v_exp_f32 v121, v121
v_mfma_f32_32x32x16_bf16 v[192:207], v[160:163], v[144:147], v[192:207]
v_exp_f32 v122, v122
v_exp_f32 v123, v123
v_exp_f32 v124, v124
v_mfma_f32_16x16x32_bf16 v[208:211], v[212:215], v[144:147], v[208:211]
v_exp_f32 v125, v125
v_exp_f32 v126, v126
v_exp_f32 v127, v127
v_cvt_pk_bf16_f32 v148, v120, v121
v_cvt_pk_bf16_f32 v149, v122, v123
v_cvt_pk_bf16_f32 v150, v124, v125
v_cvt_pk_bf16_f32 v151, v126, v127
s_branch at_150
.p2align 3
at_147:
v_exp_f32 v112, v112
v_exp_f32 v113, v113
s_waitcnt lgkmcnt(2)
v_mfma_f32_32x32x16_bf16 v[16:31], v[164:167], v[148:151], v[16:31]
v_exp_f32 v114, v114
v_exp_f32 v115, v115
v_exp_f32 v116, v116
v_mfma_f32_16x16x32_bf16 v[32:35], v[212:215], v[148:151], v[32:35]
v_exp_f32 v117, v117
s_waitcnt lgkmcnt(1)
v_mfma_f32_32x32x16_bf16 v[128:143], v[152:155], v[80:83], v[216:231]
v_exp_f32 v118, v118
v_exp_f32 v119, v119
v_cvt_pk_bf16_f32 v144, v112, v113
v_cvt_pk_bf16_f32 v145, v114, v115
s_waitcnt lgkmcnt(0)
v_mfma_f32_32x32x16_bf16 v[128:143], v[156:159], v[88:91], v[128:143]
v_cvt_pk_bf16_f32 v146, v116, v117
v_cvt_pk_bf16_f32 v147, v118, v119
v_exp_f32 v120, v120
v_exp_f32 v121, v121
v_mfma_f32_32x32x16_bf16 v[192:207], v[160:163], v[144:147], v[192:207]
ds_read_b128 v[160:163], v8 offset:2048
v_exp_f32 v122, v122
v_exp_f32 v123, v123
v_exp_f32 v124, v124
v_mfma_f32_16x16x32_bf16 v[208:211], v[212:215], v[144:147], v[208:211]
v_exp_f32 v125, v125
v_exp_f32 v126, v126
v_exp_f32 v127, v127
v_cvt_pk_bf16_f32 v148, v120, v121
v_cvt_pk_bf16_f32 v149, v122, v123
v_cvt_pk_bf16_f32 v150, v124, v125
v_cvt_pk_bf16_f32 v151, v126, v127
.p2align 3
at_149:
v_exp_f32 v128, v128
v_exp_f32 v129, v129
s_waitcnt lgkmcnt(1)
v_mfma_f32_32x32x16_bf16 v[192:207], v[164:167], v[148:151], v[192:207]
ds_read_b128 v[164:167], v8 offset:3072
v_exp_f32 v130, v130
v_exp_f32 v131, v131
v_exp_f32 v132, v132
v_mfma_f32_16x16x32_bf16 v[208:211], v[212:215], v[148:151], v[208:211]
v_exp_f32 v133, v133
v_exp_f32 v134, v134
v_exp_f32 v135, v135
v_cvt_pk_bf16_f32 v144, v128, v129
v_cvt_pk_bf16_f32 v145, v130, v131
v_add_u32 v5, s34, 20
s_mov_b64 exec, 1
ds_write_b32 v3, v5
s_mov_b64 exec, -1
v_cvt_pk_bf16_f32 v146, v132, v133
v_cvt_pk_bf16_f32 v147, v134, v135
v_exp_f32 v136, v136
v_exp_f32 v137, v137
s_waitcnt lgkmcnt(2)
v_mfma_f32_32x32x16_bf16 v[192:207], v[160:163], v[144:147], v[192:207]
v_exp_f32 v138, v138
v_exp_f32 v139, v139
v_exp_f32 v140, v140
v_mfma_f32_16x16x32_bf16 v[208:211], v[212:215], v[144:147], v[208:211]
v_exp_f32 v141, v141
v_exp_f32 v142, v142
v_exp_f32 v143, v143
v_cvt_pk_bf16_f32 v148, v136, v137
v_cvt_pk_bf16_f32 v149, v138, v139
v_cvt_pk_bf16_f32 v150, v140, v141
v_cvt_pk_bf16_f32 v151, v142, v143
at_150:
s_lshl_b32 s66, s59, 18
s_lshl_b32 s67, s63, 22
v_mfma_f32_16x16x32_bf16 v[208:211], v[212:215], v[148:151], v[208:211]
s_add_u32 s66, s66, s67
s_lshl1_add_u32 s67, s60, s64
s_waitcnt lgkmcnt(1)
v_mfma_f32_32x32x16_bf16 v[192:207], v[164:167], v[148:151], v[192:207]
s_lshl_b32 s67, s67, 11
s_add_u32 s66, s66, s67
s_lshl_b32 s68, s65, 16
s_add_u32 s67, s66, 18022400
s_sub_u32 s67, s67, s68
s_add_u32 s66, s66, s68
s_add_u32 s66, s66, 17825792
v_lshlrev_b32 v9, 4, v0
v_subrev_u32 v10, 0x2f800000, v32
v_subrev_u32 v11, 0x2f800000, v208
v_max_u32 v10, v10, v11
v_cmp_lt_u32 vcc, 0x20000000, v10
s_cbranch_vccnz slow_155
sback_156:
s_nop 1
v_rcp_f32 v12, v32
s_nop 1
v_pk_mul_f32 v[16:17], v[16:17], v[12:13] op_sel:[0,0] op_sel_hi:[1,0]
v_pk_mul_f32 v[18:19], v[18:19], v[12:13] op_sel:[0,0] op_sel_hi:[1,0]
v_pk_mul_f32 v[20:21], v[20:21], v[12:13] op_sel:[0,0] op_sel_hi:[1,0]
v_pk_mul_f32 v[22:23], v[22:23], v[12:13] op_sel:[0,0] op_sel_hi:[1,0]
v_pk_mul_f32 v[24:25], v[24:25], v[12:13] op_sel:[0,0] op_sel_hi:[1,0]
v_pk_mul_f32 v[26:27], v[26:27], v[12:13] op_sel:[0,0] op_sel_hi:[1,0]
v_pk_mul_f32 v[28:29], v[28:29], v[12:13] op_sel:[0,0] op_sel_hi:[1,0]
v_pk_mul_f32 v[30:31], v[30:31], v[12:13] op_sel:[0,0] op_sel_hi:[1,0]
v_cvt_pk_bf16_f32 v16, v16, v17
v_cvt_pk_bf16_f32 v17, v18, v19
v_cvt_pk_bf16_f32 v18, v20, v21
v_cvt_pk_bf16_f32 v19, v22, v23
v_cvt_pk_bf16_f32 v20, v24, v25
v_cvt_pk_bf16_f32 v21, v26, v27
v_cvt_pk_bf16_f32 v22, v28, v29
v_cvt_pk_bf16_f32 v23, v30, v31
s_cmp_eq_u32 s57, 0
s_cbranch_scc1 far_157
buffer_store_dwordx4 v[16:19], v9, s[20:23], s67 offen offset:0
buffer_store_dwordx4 v[20:23], v9, s[20:23], s67 offen offset:1024
near_158:
v_rcp_f32 v12, v208
s_nop 0
v_pk_mul_f32 v[192:193], v[192:193], v[12:13] op_sel:[0,0] op_sel_hi:[1,0]
v_pk_mul_f32 v[194:195], v[194:195], v[12:13] op_sel:[0,0] op_sel_hi:[1,0]
v_pk_mul_f32 v[196:197], v[196:197], v[12:13] op_sel:[0,0] op_sel_hi:[1,0]
v_pk_mul_f32 v[198:199], v[198:199], v[12:13] op_sel:[0,0] op_sel_hi:[1,0]
v_pk_mul_f32 v[200:201], v[200:201], v[12:13] op_sel:[0,0] op_sel_hi:[1,0]
v_pk_mul_f32 v[202:203], v[202:203], v[12:13] op_sel:[0,0] op_sel_hi:[1,0]
v_pk_mul_f32 v[204:205], v[204:205], v[12:13] op_sel:[0,0] op_sel_hi:[1,0]
v_pk_mul_f32 v[206:207], v[206:207], v[12:13] op_sel:[0,0] op_sel_hi:[1,0]
v_cvt_pk_bf16_f32 v192, v192, v193
v_cvt_pk_bf16_f32 v193, v194, v195
v_cvt_pk_bf16_f32 v194, v196, v197
v_cvt_pk_bf16_f32 v195, v198, v199
v_cvt_pk_bf16_f32 v196, v200, v201
v_cvt_pk_bf16_f32 v197, v202, v203
v_cvt_pk_bf16_f32 v198, v204, v205
v_cvt_pk_bf16_f32 v199, v206, v207
s_cmp_eq_u32 s57, 0
s_cbranch_scc1 far_159
buffer_store_dwordx4 v[192:195], v9, s[20:23], s66 offen offset:0
buffer_store_dwordx4 v[196:199], v9, s[20:23], s66 offen offset:1024
near_160:
v_bfe_u32 v48, v0, 2, 3
v_lshrrev_b32 v49, 5, v0
v_lshl_add_u32 v48, v49, 4, v48
v_lshlrev_b32 v48, 7, v48
v_bfe_u32 v49, v0, 3, 2
v_lshl_add_u32 v48, v49, 5, v48
v_and_b32 v49, 3, v0
v_lshl_add_u32 v48, v49, 3, v48
v_add_u32 v8, 32768, v48
v_xor_b32 v9, 32, v8
v_xor_b32 v10, 64, v8
v_xor_b32 v11, 96, v8
v_add_u32 v12, 0x10000, v8
v_add_u32 v13, 0x10000, v9
v_add_u32 v14, 0x10000, v10
v_add_u32 v15, 0x10000, v11
v_and_b32 v48, 15, v0
v_lshrrev_b32 v49, 4, v0
s_lshl2_add_u32 s66, s61, s58
s_lshl_b32 s67, s66, 16
s_lshl_b32 s68, s63, 22
s_add_u32 s67, s67, s68
s_add_u32 s67, s67, 17825792
v_lshl_add_u32 v6, v48, 4, s67
v_lshl_add_u32 v6, v49, 9, v6
s_add_u32 s70, s72, 268288
s_add_u32 s35, s34, 3
lw_161:
ds_read_b32 v5, v2 offset:24
s_waitcnt lgkmcnt(0)
v_cmp_gt_i32 vcc, s35, v5
s_cbranch_vccz lwd_162
s_sub_u32 s32, s32, 1
s_cmp_gt_i32 s32, 0
s_cbranch_scc1 lw_161
lwd_162:
s_mov_b64 exec, 1
s_waitcnt vmcnt(0)
s_cmp_eq_u32 s57, 0
s_cbranch_scc1 far_163
buffer_store_dword v212, v3, s[24:27], s70 offen
near_164:
s_mov_b64 exec, -1
v_add_u32 v5, s34, 21
s_mov_b64 exec, 1
ds_write_b32 v3, v5
s_mov_b64 exec, -1
s_cmp_eq_u32 s63, 0
s_cbranch_scc0 mo_165
v_permlane16_swap_b32 v240, v242
v_permlane16_swap_b32 v241, v243
v_permlane16_swap_b32 v244, v246
v_permlane16_swap_b32 v245, v247
v_permlane16_swap_b32 v248, v250
v_permlane16_swap_b32 v249, v251
v_permlane16_swap_b32 v252, v254
v_permlane16_swap_b32 v253, v255
mo_166:
v_lshlrev_b32 v16, 16, v240
v_and_b32 v17, 0xffff0000, v240
v_lshlrev_b32 v18, 16, v241
v_and_b32 v19, 0xffff0000, v241
v_lshlrev_b32 v20, 16, v242
v_and_b32 v21, 0xffff0000, v242
v_lshlrev_b32 v22, 16, v243
v_and_b32 v23, 0xffff0000, v243
v_lshlrev_b32 v24, 16, v244
v_and_b32 v25, 0xffff0000, v244
v_lshlrev_b32 v26, 16, v245
v_and_b32 v27, 0xffff0000, v245
v_lshlrev_b32 v28, 16, v246
v_and_b32 v29, 0xffff0000, v246
v_lshlrev_b32 v30, 16, v247
v_and_b32 v31, 0xffff0000, v247
v_lshlrev_b32 v32, 16, v248
v_and_b32 v33, 0xffff0000, v248
v_lshlrev_b32 v34, 16, v249
v_and_b32 v35, 0xffff0000, v249
v_lshlrev_b32 v36, 16, v250
v_and_b32 v37, 0xffff0000, v250
v_lshlrev_b32 v38, 16, v251
v_and_b32 v39, 0xffff0000, v251
v_lshlrev_b32 v40, 16, v252
v_and_b32 v41, 0xffff0000, v252
v_lshlrev_b32 v42, 16, v253
v_and_b32 v43, 0xffff0000, v253
v_lshlrev_b32 v44, 16, v254
v_and_b32 v45, 0xffff0000, v254
v_lshlrev_b32 v46, 16, v255
v_and_b32 v47, 0xffff0000, v255
s_add_u32 s66, s61, s62
s_and_b32 s66, s66, 15
s_lshl_b32 s66, s66, 12
s_add_u32 s35, s34, 22
lw_167:
ds_read_b32 v5, v2 offset:16
s_waitcnt lgkmcnt(0)
v_cmp_gt_i32 vcc, s35, v5
s_cbranch_vccz lwd_168
s_sub_u32 s32, s32, 1
s_cmp_gt_i32 s32, 0
s_cbranch_scc1 lw_167
lwd_168:
buffer_load_dwordx4 v[80:83], v6, s[20:23], s66 offen offset:0 sc1
buffer_load_dwordx4 v[88:91], v6, s[20:23], s66 offen offset:2048 sc1
buffer_load_dwordx4 v[84:87], v6, s[20:23], s66 offen offset:256 sc1
buffer_load_dwordx4 v[92:95], v6, s[20:23], s66 offen offset:2304 sc1
s_add_u32 s66, s66, 4096
s_and_b32 s66, s66, 0xffff
ds_read_b64_tr_b16 v[48:49], v8 offset:0
ds_read_b64_tr_b16 v[50:51], v8 offset:1024
ds_read_b64_tr_b16 v[52:53], v8 offset:4096
ds_read_b64_tr_b16 v[54:55], v8 offset:5120
buffer_load_dwordx4 v[96:99], v6, s[20:23], s66 offen offset:0 sc1
buffer_load_dwordx4 v[104:107], v6, s[20:23], s66 offen offset:2048 sc1
buffer_load_dwordx4 v[100:103], v6, s[20:23], s66 offen offset:256 sc1
buffer_load_dwordx4 v[108:111], v6, s[20:23], s66 offen offset:2304 sc1
s_add_u32 s66, s66, 4096
s_and_b32 s66, s66, 0xffff
ds_read_b64_tr_b16 v[56:57], v9 offset:0
ds_read_b64_tr_b16 v[58:59], v9 offset:1024
ds_read_b64_tr_b16 v[60:61], v9 offset:4096
ds_read_b64_tr_b16 v[62:63], v9 offset:5120
buffer_load_dwordx4 v[112:115], v6, s[20:23], s66 offen offset:0 sc1
buffer_load_dwordx4 v[120:123], v6, s[20:23], s66 offen offset:2048 sc1
buffer_load_dwordx4 v[116:119], v6, s[20:23], s66 offen offset:256 sc1
buffer_load_dwordx4 v[124:127], v6, s[20:23], s66 offen offset:2304 sc1
s_add_u32 s66, s66, 4096
s_and_b32 s66, s66, 0xffff
ds_read_b64_tr_b16 v[64:65], v10 offset:0
ds_read_b64_tr_b16 v[66:67], v10 offset:1024
ds_read_b64_tr_b16 v[68:69], v10 offset:4096
ds_read_b64_tr_b16 v[70:71], v10 offset:5120
.p2align 3
s_waitcnt vmcnt(11) lgkmcnt(10)
v_mfma_f32_16x16x32_bf16 v[16:19], v[48:51], v[80:83], v[16:19]
ds_read_b64_tr_b16 v[72:73], v11 offset:0
buffer_load_dwordx4 v[128:131], v6, s[20:23], s66 offen offset:0 sc1
s_waitcnt vmcnt(11) lgkmcnt(9)
v_mfma_f32_16x16x32_bf16 v[16:19], v[52:55], v[88:91], v[16:19]
ds_read_b64_tr_b16 v[74:75], v11 offset:1024
s_waitcnt vmcnt(10)
v_mfma_f32_16x16x32_bf16 v[32:35], v[48:51], v[84:87], v[32:35]
ds_read_b64_tr_b16 v[76:77], v11 offset:4096
buffer_load_dwordx4 v[136:139], v6, s[20:23], s66 offen offset:2048 sc1
s_waitcnt vmcnt(10)
v_mfma_f32_16x16x32_bf16 v[32:35], v[52:55], v[92:95], v[32:35]
ds_read_b64_tr_b16 v[78:79], v11 offset:5120
s_waitcnt lgkmcnt(10)
v_mfma_f32_16x16x32_bf16 v[20:23], v[56:59], v[80:83], v[20:23]
ds_read_b64_tr_b16 v[48:49], v8 offset:8192
buffer_load_dwordx4 v[132:135], v6, s[20:23], s66 offen offset:256 sc1
s_waitcnt lgkmcnt(9)
v_mfma_f32_16x16x32_bf16 v[20:23], v[60:63], v[88:91], v[20:23]
ds_read_b64_tr_b16 v[50:51], v8 offset:9216
v_mfma_f32_16x16x32_bf16 v[36:39], v[56:59], v[84:87], v[36:39]
ds_read_b64_tr_b16 v[52:53], v8 offset:12288
buffer_load_dwordx4 v[140:143], v6, s[20:23], s66 offen offset:2304 sc1
s_add_u32 s66, s66, 4096
s_and_b32 s66, s66, 0xffff
v_mfma_f32_16x16x32_bf16 v[36:39], v[60:63], v[92:95], v[36:39]
ds_read_b64_tr_b16 v[54:55], v8 offset:13312
s_waitcnt lgkmcnt(10)
v_mfma_f32_16x16x32_bf16 v[24:27], v[64:67], v[80:83], v[24:27]
ds_read_b64_tr_b16 v[56:57], v9 offset:8192
s_waitcnt lgkmcnt(9)
v_mfma_f32_16x16x32_bf16 v[24:27], v[68:71], v[88:91], v[24:27]
ds_read_b64_tr_b16 v[58:59], v9 offset:9216
v_mfma_f32_16x16x32_bf16 v[40:43], v[64:67], v[84:87], v[40:43]
ds_read_b64_tr_b16 v[60:61], v9 offset:12288
v_mfma_f32_16x16x32_bf16 v[40:43], v[68:71], v[92:95], v[40:43]
ds_read_b64_tr_b16 v[62:63], v9 offset:13312
s_waitcnt lgkmcnt(10)
v_mfma_f32_16x16x32_bf16 v[28:31], v[72:75], v[80:83], v[28:31]
ds_read_b64_tr_b16 v[64:65], v10 offset:8192
s_waitcnt lgkmcnt(9)
v_mfma_f32_16x16x32_bf16 v[28:31], v[76:79], v[88:91], v[28:31]
ds_read_b64_tr_b16 v[66:67], v10 offset:9216
v_mfma_f32_16x16x32_bf16 v[44:47], v[72:75], v[84:87], v[44:47]
ds_read_b64_tr_b16 v[68:69], v10 offset:12288
v_mfma_f32_16x16x32_bf16 v[44:47], v[76:79], v[92:95], v[44:47]
ds_read_b64_tr_b16 v[70:71], v10 offset:13312
s_waitcnt vmcnt(11) lgkmcnt(10)
v_mfma_f32_16x16x32_bf16 v[16:19], v[48:51], v[96:99], v[16:19]
ds_read_b64_tr_b16 v[72:73], v11 offset:8192
buffer_load_dwordx4 v[144:147], v6, s[20:23], s66 offen offset:0 sc1
s_waitcnt vmcnt(11) lgkmcnt(9)
v_mfma_f32_16x16x32_bf16 v[16:19], v[52:55], v[104:107], v[16:19]
ds_read_b64_tr_b16 v[74:75], v11 offset:9216
s_waitcnt vmcnt(10)
v_mfma_f32_16x16x32_bf16 v[32:35], v[48:51], v[100:103], v[32:35]
ds_read_b64_tr_b16 v[76:77], v11 offset:12288
buffer_load_dwordx4 v[152:155], v6, s[20:23], s66 offen offset:2048 sc1
s_waitcnt vmcnt(10)
v_mfma_f32_16x16x32_bf16 v[32:35], v[52:55], v[108:111], v[32:35]
ds_read_b64_tr_b16 v[78:79], v11 offset:13312
s_waitcnt lgkmcnt(10)
v_mfma_f32_16x16x32_bf16 v[20:23], v[56:59], v[96:99], v[20:23]
ds_read_b64_tr_b16 v[48:49], v8 offset:16384
buffer_load_dwordx4 v[148:151], v6, s[20:23], s66 offen offset:256 sc1
s_waitcnt lgkmcnt(9)
v_mfma_f32_16x16x32_bf16 v[20:23], v[60:63], v[104:107], v[20:23]
ds_read_b64_tr_b16 v[50:51], v8 offset:17408
v_mfma_f32_16x16x32_bf16 v[36:39], v[56:59], v[100:103], v[36:39]
ds_read_b64_tr_b16 v[52:53], v8 offset:20480
buffer_load_dwordx4 v[156:159], v6, s[20:23], s66 offen offset:2304 sc1
s_add_u32 s66, s66, 4096
s_and_b32 s66, s66, 0xffff
v_mfma_f32_16x16x32_bf16 v[36:39], v[60:63], v[108:111], v[36:39]
ds_read_b64_tr_b16 v[54:55], v8 offset:21504
s_waitcnt lgkmcnt(10)
v_mfma_f32_16x16x32_bf16 v[24:27], v[64:67], v[96:99], v[24:27]
ds_read_b64_tr_b16 v[56:57], v9 offset:16384
s_waitcnt lgkmcnt(9)
v_mfma_f32_16x16x32_bf16 v[24:27], v[68:71], v[104:107], v[24:27]
ds_read_b64_tr_b16 v[58:59], v9 offset:17408
v_mfma_f32_16x16x32_bf16 v[40:43], v[64:67], v[100:103], v[40:43]
ds_read_b64_tr_b16 v[60:61], v9 offset:20480
v_mfma_f32_16x16x32_bf16 v[40:43], v[68:71], v[108:111], v[40:43]
ds_read_b64_tr_b16 v[62:63], v9 offset:21504
s_waitcnt lgkmcnt(10)
v_mfma_f32_16x16x32_bf16 v[28:31], v[72:75], v[96:99], v[28:31]
ds_read_b64_tr_b16 v[64:65], v10 offset:16384
s_waitcnt lgkmcnt(9)
v_mfma_f32_16x16x32_bf16 v[28:31], v[76:79], v[104:107], v[28:31]
ds_read_b64_tr_b16 v[66:67], v10 offset:17408
v_mfma_f32_16x16x32_bf16 v[44:47], v[72:75], v[100:103], v[44:47]
ds_read_b64_tr_b16 v[68:69], v10 offset:20480
v_mfma_f32_16x16x32_bf16 v[44:47], v[76:79], v[108:111], v[44:47]
ds_read_b64_tr_b16 v[70:71], v10 offset:21504
s_waitcnt vmcnt(11) lgkmcnt(10)
v_mfma_f32_16x16x32_bf16 v[16:19], v[48:51], v[112:115], v[16:19]
ds_read_b64_tr_b16 v[72:73], v11 offset:16384
buffer_load_dwordx4 v[160:163], v6, s[20:23], s66 offen offset:0 sc1
s_waitcnt vmcnt(11) lgkmcnt(9)
v_mfma_f32_16x16x32_bf16 v[16:19], v[52:55], v[120:123], v[16:19]
ds_read_b64_tr_b16 v[74:75], v11 offset:17408
s_waitcnt vmcnt(10)
v_mfma_f32_16x16x32_bf16 v[32:35], v[48:51], v[116:119], v[32:35]
ds_read_b64_tr_b16 v[76:77], v11 offset:20480
buffer_load_dwordx4 v[168:171], v6, s[20:23], s66 offen offset:2048 sc1
s_waitcnt vmcnt(10)
v_mfma_f32_16x16x32_bf16 v[32:35], v[52:55], v[124:127], v[32:35]
ds_read_b64_tr_b16 v[78:79], v11 offset:21504
s_waitcnt lgkmcnt(10)
v_mfma_f32_16x16x32_bf16 v[20:23], v[56:59], v[112:115], v[20:23]
ds_read_b64_tr_b16 v[48:49], v8 offset:24576
buffer_load_dwordx4 v[164:167], v6, s[20:23], s66 offen offset:256 sc1
s_waitcnt lgkmcnt(9)
v_mfma_f32_16x16x32_bf16 v[20:23], v[60:63], v[120:123], v[20:23]
ds_read_b64_tr_b16 v[50:51], v8 offset:25600
v_mfma_f32_16x16x32_bf16 v[36:39], v[56:59], v[116:119], v[36:39]
ds_read_b64_tr_b16 v[52:53], v8 offset:28672
buffer_load_dwordx4 v[172:175], v6, s[20:23], s66 offen offset:2304 sc1
s_add_u32 s66, s66, 4096
s_and_b32 s66, s66, 0xffff
v_mfma_f32_16x16x32_bf16 v[36:39], v[60:63], v[124:127], v[36:39]
ds_read_b64_tr_b16 v[54:55], v8 offset:29696
s_waitcnt lgkmcnt(10)
v_mfma_f32_16x16x32_bf16 v[24:27], v[64:67], v[112:115], v[24:27]
ds_read_b64_tr_b16 v[56:57], v9 offset:24576
s_waitcnt lgkmcnt(9)
v_mfma_f32_16x16x32_bf16 v[24:27], v[68:71], v[120:123], v[24:27]
ds_read_b64_tr_b16 v[58:59], v9 offset:25600
v_mfma_f32_16x16x32_bf16 v[40:43], v[64:67], v[116:119], v[40:43]
ds_read_b64_tr_b16 v[60:61], v9 offset:28672
v_mfma_f32_16x16x32_bf16 v[40:43], v[68:71], v[124:127], v[40:43]
ds_read_b64_tr_b16 v[62:63], v9 offset:29696
s_waitcnt lgkmcnt(10)
v_mfma_f32_16x16x32_bf16 v[28:31], v[72:75], v[112:115], v[28:31]
ds_read_b64_tr_b16 v[64:65], v10 offset:24576
s_waitcnt lgkmcnt(9)
v_mfma_f32_16x16x32_bf16 v[28:31], v[76:79], v[120:123], v[28:31]
ds_read_b64_tr_b16 v[66:67], v10 offset:25600
v_mfma_f32_16x16x32_bf16 v[44:47], v[72:75], v[116:119], v[44:47]
ds_read_b64_tr_b16 v[68:69], v10 offset:28672
v_mfma_f32_16x16x32_bf16 v[44:47], v[76:79], v[124:127], v[44:47]
ds_read_b64_tr_b16 v[70:71], v10 offset:29696
s_waitcnt vmcnt(11) lgkmcnt(10)
v_mfma_f32_16x16x32_bf16 v[16:19], v[48:51], v[128:131], v[16:19]
ds_read_b64_tr_b16 v[72:73], v11 offset:24576
buffer_load_dwordx4 v[176:179], v6, s[20:23], s66 offen offset:0 sc1
s_waitcnt vmcnt(11) lgkmcnt(9)
v_mfma_f32_16x16x32_bf16 v[16:19], v[52:55], v[136:139], v[16:19]
ds_read_b64_tr_b16 v[74:75], v11 offset:25600
s_waitcnt vmcnt(10)
v_mfma_f32_16x16x32_bf16 v[32:35], v[48:51], v[132:135], v[32:35]
ds_read_b64_tr_b16 v[76:77], v11 offset:28672
buffer_load_dwordx4 v[184:187], v6, s[20:23], s66 offen offset:2048 sc1
s_waitcnt vmcnt(10)
v_mfma_f32_16x16x32_bf16 v[32:35], v[52:55], v[140:143], v[32:35]
ds_read_b64_tr_b16 v[78:79], v11 offset:29696
s_waitcnt lgkmcnt(10)
v_mfma_f32_16x16x32_bf16 v[20:23], v[56:59], v[128:131], v[20:23]
ds_read_b64_tr_b16 v[48:49], v8 offset:32768
buffer_load_dwordx4 v[180:183], v6, s[20:23], s66 offen offset:256 sc1
s_waitcnt lgkmcnt(9)
v_mfma_f32_16x16x32_bf16 v[20:23], v[60:63], v[136:139], v[20:23]
ds_read_b64_tr_b16 v[50:51], v8 offset:33792
v_mfma_f32_16x16x32_bf16 v[36:39], v[56:59], v[132:135], v[36:39]
ds_read_b64_tr_b16 v[52:53], v8 offset:36864
buffer_load_dwordx4 v[188:191], v6, s[20:23], s66 offen offset:2304 sc1
s_add_u32 s66, s66, 4096
s_and_b32 s66, s66, 0xffff
v_mfma_f32_16x16x32_bf16 v[36:39], v[60:63], v[140:143], v[36:39]
ds_read_b64_tr_b16 v[54:55], v8 offset:37888
s_waitcnt lgkmcnt(10)
v_mfma_f32_16x16x32_bf16 v[24:27], v[64:67], v[128:131], v[24:27]
ds_read_b64_tr_b16 v[56:57], v9 offset:32768
s_waitcnt lgkmcnt(9)
v_mfma_f32_16x16x32_bf16 v[24:27], v[68:71], v[136:139], v[24:27]
ds_read_b64_tr_b16 v[58:59], v9 offset:33792
v_mfma_f32_16x16x32_bf16 v[40:43], v[64:67], v[132:135], v[40:43]
ds_read_b64_tr_b16 v[60:61], v9 offset:36864
v_mfma_f32_16x16x32_bf16 v[40:43], v[68:71], v[140:143], v[40:43]
ds_read_b64_tr_b16 v[62:63], v9 offset:37888
s_waitcnt lgkmcnt(10)
v_mfma_f32_16x16x32_bf16 v[28:31], v[72:75], v[128:131], v[28:31]
ds_read_b64_tr_b16 v[64:65], v10 offset:32768
s_waitcnt lgkmcnt(9)
v_mfma_f32_16x16x32_bf16 v[28:31], v[76:79], v[136:139], v[28:31]
ds_read_b64_tr_b16 v[66:67], v10 offset:33792
v_mfma_f32_16x16x32_bf16 v[44:47], v[72:75], v[132:135], v[44:47]
ds_read_b64_tr_b16 v[68:69], v10 offset:36864
v_mfma_f32_16x16x32_bf16 v[44:47], v[76:79], v[140:143], v[44:47]
ds_read_b64_tr_b16 v[70:71], v10 offset:37888
s_waitcnt vmcnt(11) lgkmcnt(10)
v_mfma_f32_16x16x32_bf16 v[16:19], v[48:51], v[144:147], v[16:19]
ds_read_b64_tr_b16 v[72:73], v11 offset:32768
buffer_load_dwordx4 v[192:195], v6, s[20:23], s66 offen offset:0 sc1
s_waitcnt vmcnt(11) lgkmcnt(9)
v_mfma_f32_16x16x32_bf16 v[16:19], v[52:55], v[152:155], v[16:19]
ds_read_b64_tr_b16 v[74:75], v11 offset:33792
s_waitcnt vmcnt(10)
v_mfma_f32_16x16x32_bf16 v[32:35], v[48:51], v[148:151], v[32:35]
ds_read_b64_tr_b16 v[76:77], v11 offset:36864
buffer_load_dwordx4 v[200:203], v6, s[20:23], s66 offen offset:2048 sc1
s_waitcnt vmcnt(10)
v_mfma_f32_16x16x32_bf16 v[32:35], v[52:55], v[156:159], v[32:35]
ds_read_b64_tr_b16 v[78:79], v11 offset:37888
s_waitcnt lgkmcnt(10)
v_mfma_f32_16x16x32_bf16 v[20:23], v[56:59], v[144:147], v[20:23]
ds_read_b64_tr_b16 v[48:49], v8 offset:40960
buffer_load_dwordx4 v[196:199], v6, s[20:23], s66 offen offset:256 sc1
s_waitcnt lgkmcnt(9)
v_mfma_f32_16x16x32_bf16 v[20:23], v[60:63], v[152:155], v[20:23]
ds_read_b64_tr_b16 v[50:51], v8 offset:41984
v_mfma_f32_16x16x32_bf16 v[36:39], v[56:59], v[148:151], v[36:39]
ds_read_b64_tr_b16 v[52:53], v8 offset:45056
buffer_load_dwordx4 v[204:207], v6, s[20:23], s66 offen offset:2304 sc1
s_add_u32 s66, s66, 4096
s_and_b32 s66, s66, 0xffff
v_mfma_f32_16x16x32_bf16 v[36:39], v[60:63], v[156:159], v[36:39]
ds_read_b64_tr_b16 v[54:55], v8 offset:46080
s_waitcnt lgkmcnt(10)
v_mfma_f32_16x16x32_bf16 v[24:27], v[64:67], v[144:147], v[24:27]
ds_read_b64_tr_b16 v[56:57], v9 offset:40960
s_waitcnt lgkmcnt(9)
v_mfma_f32_16x16x32_bf16 v[24:27], v[68:71], v[152:155], v[24:27]
ds_read_b64_tr_b16 v[58:59], v9 offset:41984
v_mfma_f32_16x16x32_bf16 v[40:43], v[64:67], v[148:151], v[40:43]
ds_read_b64_tr_b16 v[60:61], v9 offset:45056
v_mfma_f32_16x16x32_bf16 v[40:43], v[68:71], v[156:159], v[40:43]
ds_read_b64_tr_b16 v[62:63], v9 offset:46080
s_waitcnt lgkmcnt(10)
v_mfma_f32_16x16x32_bf16 v[28:31], v[72:75], v[144:147], v[28:31]
ds_read_b64_tr_b16 v[64:65], v10 offset:40960
s_waitcnt lgkmcnt(9)
v_mfma_f32_16x16x32_bf16 v[28:31], v[76:79], v[152:155], v[28:31]
ds_read_b64_tr_b16 v[66:67], v10 offset:41984
v_mfma_f32_16x16x32_bf16 v[44:47], v[72:75], v[148:151], v[44:47]
ds_read_b64_tr_b16 v[68:69], v10 offset:45056
v_mfma_f32_16x16x32_bf16 v[44:47], v[76:79], v[156:159], v[44:47]
ds_read_b64_tr_b16 v[70:71], v10 offset:46080
s_waitcnt vmcnt(11) lgkmcnt(10)
v_mfma_f32_16x16x32_bf16 v[16:19], v[48:51], v[160:163], v[16:19]
ds_read_b64_tr_b16 v[72:73], v11 offset:40960
buffer_load_dwordx4 v[80:83], v6, s[20:23], s66 offen offset:0 sc1
s_waitcnt vmcnt(11) lgkmcnt(9)
v_mfma_f32_16x16x32_bf16 v[16:19], v[52:55], v[168:171], v[16:19]
ds_read_b64_tr_b16 v[74:75], v11 offset:41984
s_waitcnt vmcnt(10)
v_mfma_f32_16x16x32_bf16 v[32:35], v[48:51], v[164:167], v[32:35]
ds_read_b64_tr_b16 v[76:77], v11 offset:45056
buffer_load_dwordx4 v[88:91], v6, s[20:23], s66 offen offset:2048 sc1
s_waitcnt vmcnt(10)
v_mfma_f32_16x16x32_bf16 v[32:35], v[52:55], v[172:175], v[32:35]
ds_read_b64_tr_b16 v[78:79], v11 offset:46080
s_waitcnt lgkmcnt(10)
v_mfma_f32_16x16x32_bf16 v[20:23], v[56:59], v[160:163], v[20:23]
ds_read_b64_tr_b16 v[48:49], v8 offset:49152
buffer_load_dwordx4 v[84:87], v6, s[20:23], s66 offen offset:256 sc1
s_waitcnt lgkmcnt(9)
v_mfma_f32_16x16x32_bf16 v[20:23], v[60:63], v[168:171], v[20:23]
ds_read_b64_tr_b16 v[50:51], v8 offset:50176
v_mfma_f32_16x16x32_bf16 v[36:39], v[56:59], v[164:167], v[36:39]
ds_read_b64_tr_b16 v[52:53], v8 offset:53248
buffer_load_dwordx4 v[92:95], v6, s[20:23], s66 offen offset:2304 sc1
s_add_u32 s66, s66, 4096
s_and_b32 s66, s66, 0xffff
v_mfma_f32_16x16x32_bf16 v[36:39], v[60:63], v[172:175], v[36:39]
ds_read_b64_tr_b16 v[54:55], v8 offset:54272
s_waitcnt lgkmcnt(10)
v_mfma_f32_16x16x32_bf16 v[24:27], v[64:67], v[160:163], v[24:27]
ds_read_b64_tr_b16 v[56:57], v9 offset:49152
s_waitcnt lgkmcnt(9)
v_mfma_f32_16x16x32_bf16 v[24:27], v[68:71], v[168:171], v[24:27]
ds_read_b64_tr_b16 v[58:59], v9 offset:50176
v_mfma_f32_16x16x32_bf16 v[40:43], v[64:67], v[164:167], v[40:43]
ds_read_b64_tr_b16 v[60:61], v9 offset:53248
v_mfma_f32_16x16x32_bf16 v[40:43], v[68:71], v[172:175], v[40:43]
ds_read_b64_tr_b16 v[62:63], v9 offset:54272
s_waitcnt lgkmcnt(10)
v_mfma_f32_16x16x32_bf16 v[28:31], v[72:75], v[160:163], v[28:31]
ds_read_b64_tr_b16 v[64:65], v10 offset:49152
s_waitcnt lgkmcnt(9)
v_mfma_f32_16x16x32_bf16 v[28:31], v[76:79], v[168:171], v[28:31]
ds_read_b64_tr_b16 v[66:67], v10 offset:50176
v_mfma_f32_16x16x32_bf16 v[44:47], v[72:75], v[164:167], v[44:47]
ds_read_b64_tr_b16 v[68:69], v10 offset:53248
v_mfma_f32_16x16x32_bf16 v[44:47], v[76:79], v[172:175], v[44:47]
ds_read_b64_tr_b16 v[70:71], v10 offset:54272
s_waitcnt vmcnt(11) lgkmcnt(10)
v_mfma_f32_16x16x32_bf16 v[16:19], v[48:51], v[176:179], v[16:19]
ds_read_b64_tr_b16 v[72:73], v11 offset:49152
buffer_load_dwordx4 v[96:99], v6, s[20:23], s66 offen offset:0 sc1
s_waitcnt vmcnt(11) lgkmcnt(9)
v_mfma_f32_16x16x32_bf16 v[16:19], v[52:55], v[184:187], v[16:19]
ds_read_b64_tr_b16 v[74:75], v11 offset:50176
s_waitcnt vmcnt(10)
v_mfma_f32_16x16x32_bf16 v[32:35], v[48:51], v[180:183], v[32:35]
ds_read_b64_tr_b16 v[76:77], v11 offset:53248
buffer_load_dwordx4 v[104:107], v6, s[20:23], s66 offen offset:2048 sc1
s_waitcnt vmcnt(10)
v_mfma_f32_16x16x32_bf16 v[32:35], v[52:55], v[188:191], v[32:35]
ds_read_b64_tr_b16 v[78:79], v11 offset:54272
s_waitcnt lgkmcnt(10)
v_mfma_f32_16x16x32_bf16 v[20:23], v[56:59], v[176:179], v[20:23]
ds_read_b64_tr_b16 v[48:49], v8 offset:57344
buffer_load_dwordx4 v[100:103], v6, s[20:23], s66 offen offset:256 sc1
s_waitcnt lgkmcnt(9)
v_mfma_f32_16x16x32_bf16 v[20:23], v[60:63], v[184:187], v[20:23]
ds_read_b64_tr_b16 v[50:51], v8 offset:58368
v_mfma_f32_16x16x32_bf16 v[36:39], v[56:59], v[180:183], v[36:39]
ds_read_b64_tr_b16 v[52:53], v8 offset:61440
buffer_load_dwordx4 v[108:111], v6, s[20:23], s66 offen offset:2304 sc1
s_add_u32 s66, s66, 4096
s_and_b32 s66, s66, 0xffff
v_mfma_f32_16x16x32_bf16 v[36:39], v[60:63], v[188:191], v[36:39]
ds_read_b64_tr_b16 v[54:55], v8 offset:62464
s_waitcnt lgkmcnt(10)
v_mfma_f32_16x16x32_bf16 v[24:27], v[64:67], v[176:179], v[24:27]
ds_read_b64_tr_b16 v[56:57], v9 offset:57344
s_waitcnt lgkmcnt(9)
v_mfma_f32_16x16x32_bf16 v[24:27], v[68:71], v[184:187], v[24:27]
ds_read_b64_tr_b16 v[58:59], v9 offset:58368
v_mfma_f32_16x16x32_bf16 v[40:43], v[64:67], v[180:183], v[40:43]
ds_read_b64_tr_b16 v[60:61], v9 offset:61440
v_mfma_f32_16x16x32_bf16 v[40:43], v[68:71], v[188:191], v[40:43]
ds_read_b64_tr_b16 v[62:63], v9 offset:62464
s_waitcnt lgkmcnt(10)
v_mfma_f32_16x16x32_bf16 v[28:31], v[72:75], v[176:179], v[28:31]
ds_read_b64_tr_b16 v[64:65], v10 offset:57344
s_waitcnt lgkmcnt(9)
v_mfma_f32_16x16x32_bf16 v[28:31], v[76:79], v[184:187], v[28:31]
ds_read_b64_tr_b16 v[66:67], v10 offset:58368
v_mfma_f32_16x16x32_bf16 v[44:47], v[72:75], v[180:183], v[44:47]
ds_read_b64_tr_b16 v[68:69], v10 offset:61440
v_mfma_f32_16x16x32_bf16 v[44:47], v[76:79], v[188:191], v[44:47]
ds_read_b64_tr_b16 v[70:71], v10 offset:62464
s_waitcnt vmcnt(11) lgkmcnt(10)
v_mfma_f32_16x16x32_bf16 v[16:19], v[48:51], v[192:195], v[16:19]
ds_read_b64_tr_b16 v[72:73], v11 offset:57344
buffer_load_dwordx4 v[112:115], v6, s[20:23], s66 offen offset:0 sc1
s_waitcnt vmcnt(11) lgkmcnt(9)
v_mfma_f32_16x16x32_bf16 v[16:19], v[52:55], v[200:203], v[16:19]
ds_read_b64_tr_b16 v[74:75], v11 offset:58368
s_waitcnt vmcnt(10)
v_mfma_f32_16x16x32_bf16 v[32:35], v[48:51], v[196:199], v[32:35]
ds_read_b64_tr_b16 v[76:77], v11 offset:61440
buffer_load_dwordx4 v[120:123], v6, s[20:23], s66 offen offset:2048 sc1
s_waitcnt vmcnt(10)
v_mfma_f32_16x16x32_bf16 v[32:35], v[52:55], v[204:207], v[32:35]
ds_read_b64_tr_b16 v[78:79], v11 offset:62464
s_waitcnt lgkmcnt(10)
v_mfma_f32_16x16x32_bf16 v[20:23], v[56:59], v[192:195], v[20:23]
ds_read_b64_tr_b16 v[48:49], v12 offset:0
buffer_load_dwordx4 v[116:119], v6, s[20:23], s66 offen offset:256 sc1
s_waitcnt lgkmcnt(9)
v_mfma_f32_16x16x32_bf16 v[20:23], v[60:63], v[200:203], v[20:23]
ds_read_b64_tr_b16 v[50:51], v12 offset:1024
v_mfma_f32_16x16x32_bf16 v[36:39], v[56:59], v[196:199], v[36:39]
ds_read_b64_tr_b16 v[52:53], v12 offset:4096
buffer_load_dwordx4 v[124:127], v6, s[20:23], s66 offen offset:2304 sc1
s_add_u32 s66, s66, 4096
s_and_b32 s66, s66, 0xffff
v_mfma_f32_16x16x32_bf16 v[36:39], v[60:63], v[204:207], v[36:39]
ds_read_b64_tr_b16 v[54:55], v12 offset:5120
s_waitcnt lgkmcnt(10)
v_mfma_f32_16x16x32_bf16 v[24:27], v[64:67], v[192:195], v[24:27]
ds_read_b64_tr_b16 v[56:57], v13 offset:0
s_waitcnt lgkmcnt(9)
v_mfma_f32_16x16x32_bf16 v[24:27], v[68:71], v[200:203], v[24:27]
ds_read_b64_tr_b16 v[58:59], v13 offset:1024
v_mfma_f32_16x16x32_bf16 v[40:43], v[64:67], v[196:199], v[40:43]
ds_read_b64_tr_b16 v[60:61], v13 offset:4096
v_mfma_f32_16x16x32_bf16 v[40:43], v[68:71], v[204:207], v[40:43]
ds_read_b64_tr_b16 v[62:63], v13 offset:5120
s_waitcnt lgkmcnt(10)
v_mfma_f32_16x16x32_bf16 v[28:31], v[72:75], v[192:195], v[28:31]
ds_read_b64_tr_b16 v[64:65], v14 offset:0
s_waitcnt lgkmcnt(9)
v_mfma_f32_16x16x32_bf16 v[28:31], v[76:79], v[200:203], v[28:31]
ds_read_b64_tr_b16 v[66:67], v14 offset:1024
v_mfma_f32_16x16x32_bf16 v[44:47], v[72:75], v[196:199], v[44:47]
ds_read_b64_tr_b16 v[68:69], v14 offset:4096
v_mfma_f32_16x16x32_bf16 v[44:47], v[76:79], v[204:207], v[44:47]
ds_read_b64_tr_b16 v[70:71], v14 offset:5120
s_waitcnt vmcnt(11) lgkmcnt(10)
v_mfma_f32_16x16x32_bf16 v[16:19], v[48:51], v[80:83], v[16:19]
ds_read_b64_tr_b16 v[72:73], v15 offset:0
buffer_load_dwordx4 v[128:131], v6, s[20:23], s66 offen offset:0 sc1
s_waitcnt vmcnt(11) lgkmcnt(9)
v_mfma_f32_16x16x32_bf16 v[16:19], v[52:55], v[88:91], v[16:19]
ds_read_b64_tr_b16 v[74:75], v15 offset:1024
s_waitcnt vmcnt(10)
v_mfma_f32_16x16x32_bf16 v[32:35], v[48:51], v[84:87], v[32:35]
ds_read_b64_tr_b16 v[76:77], v15 offset:4096
buffer_load_dwordx4 v[136:139], v6, s[20:23], s66 offen offset:2048 sc1
s_waitcnt vmcnt(10)
v_mfma_f32_16x16x32_bf16 v[32:35], v[52:55], v[92:95], v[32:35]
ds_read_b64_tr_b16 v[78:79], v15 offset:5120
s_waitcnt lgkmcnt(10)
v_mfma_f32_16x16x32_bf16 v[20:23], v[56:59], v[80:83], v[20:23]
ds_read_b64_tr_b16 v[48:49], v12 offset:8192
buffer_load_dwordx4 v[132:135], v6, s[20:23], s66 offen offset:256 sc1
s_waitcnt lgkmcnt(9)
v_mfma_f32_16x16x32_bf16 v[20:23], v[60:63], v[88:91], v[20:23]
ds_read_b64_tr_b16 v[50:51], v12 offset:9216
v_mfma_f32_16x16x32_bf16 v[36:39], v[56:59], v[84:87], v[36:39]
ds_read_b64_tr_b16 v[52:53], v12 offset:12288
buffer_load_dwordx4 v[140:143], v6, s[20:23], s66 offen offset:2304 sc1
s_add_u32 s66, s66, 4096
s_and_b32 s66, s66, 0xffff
v_mfma_f32_16x16x32_bf16 v[36:39], v[60:63], v[92:95], v[36:39]
ds_read_b64_tr_b16 v[54:55], v12 offset:13312
s_waitcnt lgkmcnt(10)
v_mfma_f32_16x16x32_bf16 v[24:27], v[64:67], v[80:83], v[24:27]
ds_read_b64_tr_b16 v[56:57], v13 offset:8192
s_waitcnt lgkmcnt(9)
v_mfma_f32_16x16x32_bf16 v[24:27], v[68:71], v[88:91], v[24:27]
ds_read_b64_tr_b16 v[58:59], v13 offset:9216
v_mfma_f32_16x16x32_bf16 v[40:43], v[64:67], v[84:87], v[40:43]
ds_read_b64_tr_b16 v[60:61], v13 offset:12288
v_mfma_f32_16x16x32_bf16 v[40:43], v[68:71], v[92:95], v[40:43]
ds_read_b64_tr_b16 v[62:63], v13 offset:13312
s_waitcnt lgkmcnt(10)
v_mfma_f32_16x16x32_bf16 v[28:31], v[72:75], v[80:83], v[28:31]
ds_read_b64_tr_b16 v[64:65], v14 offset:8192
s_waitcnt lgkmcnt(9)
v_mfma_f32_16x16x32_bf16 v[28:31], v[76:79], v[88:91], v[28:31]
ds_read_b64_tr_b16 v[66:67], v14 offset:9216
v_mfma_f32_16x16x32_bf16 v[44:47], v[72:75], v[84:87], v[44:47]
ds_read_b64_tr_b16 v[68:69], v14 offset:12288
v_mfma_f32_16x16x32_bf16 v[44:47], v[76:79], v[92:95], v[44:47]
ds_read_b64_tr_b16 v[70:71], v14 offset:13312
s_waitcnt vmcnt(11) lgkmcnt(10)
v_mfma_f32_16x16x32_bf16 v[16:19], v[48:51], v[96:99], v[16:19]
ds_read_b64_tr_b16 v[72:73], v15 offset:8192
buffer_load_dwordx4 v[144:147], v6, s[20:23], s66 offen offset:0 sc1
s_waitcnt vmcnt(11) lgkmcnt(9)
v_mfma_f32_16x16x32_bf16 v[16:19], v[52:55], v[104:107], v[16:19]
ds_read_b64_tr_b16 v[74:75], v15 offset:9216
s_waitcnt vmcnt(10)
v_mfma_f32_16x16x32_bf16 v[32:35], v[48:51], v[100:103], v[32:35]
ds_read_b64_tr_b16 v[76:77], v15 offset:12288
buffer_load_dwordx4 v[152:155], v6, s[20:23], s66 offen offset:2048 sc1
s_waitcnt vmcnt(10)
v_mfma_f32_16x16x32_bf16 v[32:35], v[52:55], v[108:111], v[32:35]
ds_read_b64_tr_b16 v[78:79], v15 offset:13312
s_waitcnt lgkmcnt(10)
v_mfma_f32_16x16x32_bf16 v[20:23], v[56:59], v[96:99], v[20:23]
ds_read_b64_tr_b16 v[48:49], v12 offset:16384
buffer_load_dwordx4 v[148:151], v6, s[20:23], s66 offen offset:256 sc1
s_waitcnt lgkmcnt(9)
v_mfma_f32_16x16x32_bf16 v[20:23], v[60:63], v[104:107], v[20:23]
ds_read_b64_tr_b16 v[50:51], v12 offset:17408
v_mfma_f32_16x16x32_bf16 v[36:39], v[56:59], v[100:103], v[36:39]
ds_read_b64_tr_b16 v[52:53], v12 offset:20480
buffer_load_dwordx4 v[156:159], v6, s[20:23], s66 offen offset:2304 sc1
s_add_u32 s66, s66, 4096
s_and_b32 s66, s66, 0xffff
v_mfma_f32_16x16x32_bf16 v[36:39], v[60:63], v[108:111], v[36:39]
ds_read_b64_tr_b16 v[54:55], v12 offset:21504
s_waitcnt lgkmcnt(10)
v_mfma_f32_16x16x32_bf16 v[24:27], v[64:67], v[96:99], v[24:27]
ds_read_b64_tr_b16 v[56:57], v13 offset:16384
s_waitcnt lgkmcnt(9)
v_mfma_f32_16x16x32_bf16 v[24:27], v[68:71], v[104:107], v[24:27]
ds_read_b64_tr_b16 v[58:59], v13 offset:17408
v_mfma_f32_16x16x32_bf16 v[40:43], v[64:67], v[100:103], v[40:43]
ds_read_b64_tr_b16 v[60:61], v13 offset:20480
v_mfma_f32_16x16x32_bf16 v[40:43], v[68:71], v[108:111], v[40:43]
ds_read_b64_tr_b16 v[62:63], v13 offset:21504
s_waitcnt lgkmcnt(10)
v_mfma_f32_16x16x32_bf16 v[28:31], v[72:75], v[96:99], v[28:31]
ds_read_b64_tr_b16 v[64:65], v14 offset:16384
s_waitcnt lgkmcnt(9)
v_mfma_f32_16x16x32_bf16 v[28:31], v[76:79], v[104:107], v[28:31]
ds_read_b64_tr_b16 v[66:67], v14 offset:17408
v_mfma_f32_16x16x32_bf16 v[44:47], v[72:75], v[100:103], v[44:47]
ds_read_b64_tr_b16 v[68:69], v14 offset:20480
v_mfma_f32_16x16x32_bf16 v[44:47], v[76:79], v[108:111], v[44:47]
ds_read_b64_tr_b16 v[70:71], v14 offset:21504
s_waitcnt vmcnt(11) lgkmcnt(10)
v_mfma_f32_16x16x32_bf16 v[16:19], v[48:51], v[112:115], v[16:19]
ds_read_b64_tr_b16 v[72:73], v15 offset:16384
buffer_load_dwordx4 v[160:163], v6, s[20:23], s66 offen offset:0 sc1
s_waitcnt vmcnt(11) lgkmcnt(9)
v_mfma_f32_16x16x32_bf16 v[16:19], v[52:55], v[120:123], v[16:19]
ds_read_b64_tr_b16 v[74:75], v15 offset:17408
s_waitcnt vmcnt(10)
v_mfma_f32_16x16x32_bf16 v[32:35], v[48:51], v[116:119], v[32:35]
ds_read_b64_tr_b16 v[76:77], v15 offset:20480
buffer_load_dwordx4 v[168:171], v6, s[20:23], s66 offen offset:2048 sc1
s_waitcnt vmcnt(10)
v_mfma_f32_16x16x32_bf16 v[32:35], v[52:55], v[124:127], v[32:35]
ds_read_b64_tr_b16 v[78:79], v15 offset:21504
s_waitcnt lgkmcnt(10)
v_mfma_f32_16x16x32_bf16 v[20:23], v[56:59], v[112:115], v[20:23]
ds_read_b64_tr_b16 v[48:49], v12 offset:24576
buffer_load_dwordx4 v[164:167], v6, s[20:23], s66 offen offset:256 sc1
s_waitcnt lgkmcnt(9)
v_mfma_f32_16x16x32_bf16 v[20:23], v[60:63], v[120:123], v[20:23]
ds_read_b64_tr_b16 v[50:51], v12 offset:25600
v_mfma_f32_16x16x32_bf16 v[36:39], v[56:59], v[116:119], v[36:39]
ds_read_b64_tr_b16 v[52:53], v12 offset:28672
buffer_load_dwordx4 v[172:175], v6, s[20:23], s66 offen offset:2304 sc1
s_add_u32 s66, s66, 4096
s_and_b32 s66, s66, 0xffff
v_mfma_f32_16x16x32_bf16 v[36:39], v[60:63], v[124:127], v[36:39]
ds_read_b64_tr_b16 v[54:55], v12 offset:29696
s_waitcnt lgkmcnt(10)
v_mfma_f32_16x16x32_bf16 v[24:27], v[64:67], v[112:115], v[24:27]
ds_read_b64_tr_b16 v[56:57], v13 offset:24576
s_waitcnt lgkmcnt(9)
v_mfma_f32_16x16x32_bf16 v[24:27], v[68:71], v[120:123], v[24:27]
ds_read_b64_tr_b16 v[58:59], v13 offset:25600
v_mfma_f32_16x16x32_bf16 v[40:43], v[64:67], v[116:119], v[40:43]
ds_read_b64_tr_b16 v[60:61], v13 offset:28672
v_mfma_f32_16x16x32_bf16 v[40:43], v[68:71], v[124:127], v[40:43]
ds_read_b64_tr_b16 v[62:63], v13 offset:29696
s_waitcnt lgkmcnt(10)
v_mfma_f32_16x16x32_bf16 v[28:31], v[72:75], v[112:115], v[28:31]
ds_read_b64_tr_b16 v[64:65], v14 offset:24576
s_waitcnt lgkmcnt(9)
v_mfma_f32_16x16x32_bf16 v[28:31], v[76:79], v[120:123], v[28:31]
ds_read_b64_tr_b16 v[66:67], v14 offset:25600
v_mfma_f32_16x16x32_bf16 v[44:47], v[72:75], v[116:119], v[44:47]
ds_read_b64_tr_b16 v[68:69], v14 offset:28672
v_mfma_f32_16x16x32_bf16 v[44:47], v[76:79], v[124:127], v[44:47]
ds_read_b64_tr_b16 v[70:71], v14 offset:29696
s_waitcnt vmcnt(11) lgkmcnt(10)
v_mfma_f32_16x16x32_bf16 v[16:19], v[48:51], v[128:131], v[16:19]
ds_read_b64_tr_b16 v[72:73], v15 offset:24576
buffer_load_dwordx4 v[176:179], v6, s[20:23], s66 offen offset:0 sc1
s_waitcnt vmcnt(11) lgkmcnt(9)
v_mfma_f32_16x16x32_bf16 v[16:19], v[52:55], v[136:139], v[16:19]
ds_read_b64_tr_b16 v[74:75], v15 offset:25600
s_waitcnt vmcnt(10)
v_mfma_f32_16x16x32_bf16 v[32:35], v[48:51], v[132:135], v[32:35]
ds_read_b64_tr_b16 v[76:77], v15 offset:28672
buffer_load_dwordx4 v[184:187], v6, s[20:23], s66 offen offset:2048 sc1
s_waitcnt vmcnt(10)
v_mfma_f32_16x16x32_bf16 v[32:35], v[52:55], v[140:143], v[32:35]
ds_read_b64_tr_b16 v[78:79], v15 offset:29696
s_waitcnt lgkmcnt(10)
v_mfma_f32_16x16x32_bf16 v[20:23], v[56:59], v[128:131], v[20:23]
ds_read_b64_tr_b16 v[48:49], v12 offset:32768
buffer_load_dwordx4 v[180:183], v6, s[20:23], s66 offen offset:256 sc1
s_waitcnt lgkmcnt(9)
v_mfma_f32_16x16x32_bf16 v[20:23], v[60:63], v[136:139], v[20:23]
ds_read_b64_tr_b16 v[50:51], v12 offset:33792
v_mfma_f32_16x16x32_bf16 v[36:39], v[56:59], v[132:135], v[36:39]
ds_read_b64_tr_b16 v[52:53], v12 offset:36864
buffer_load_dwordx4 v[188:191], v6, s[20:23], s66 offen offset:2304 sc1
s_add_u32 s66, s66, 4096
s_and_b32 s66, s66, 0xffff
v_mfma_f32_16x16x32_bf16 v[36:39], v[60:63], v[140:143], v[36:39]
ds_read_b64_tr_b16 v[54:55], v12 offset:37888
s_waitcnt lgkmcnt(10)
v_mfma_f32_16x16x32_bf16 v[24:27], v[64:67], v[128:131], v[24:27]
ds_read_b64_tr_b16 v[56:57], v13 offset:32768
s_waitcnt lgkmcnt(9)
v_mfma_f32_16x16x32_bf16 v[24:27], v[68:71], v[136:139], v[24:27]
ds_read_b64_tr_b16 v[58:59], v13 offset:33792
v_mfma_f32_16x16x32_bf16 v[40:43], v[64:67], v[132:135], v[40:43]
ds_read_b64_tr_b16 v[60:61], v13 offset:36864
v_mfma_f32_16x16x32_bf16 v[40:43], v[68:71], v[140:143], v[40:43]
ds_read_b64_tr_b16 v[62:63], v13 offset:37888
s_waitcnt lgkmcnt(10)
v_mfma_f32_16x16x32_bf16 v[28:31], v[72:75], v[128:131], v[28:31]
ds_read_b64_tr_b16 v[64:65], v14 offset:32768
s_waitcnt lgkmcnt(9)
v_mfma_f32_16x16x32_bf16 v[28:31], v[76:79], v[136:139], v[28:31]
ds_read_b64_tr_b16 v[66:67], v14 offset:33792
v_mfma_f32_16x16x32_bf16 v[44:47], v[72:75], v[132:135], v[44:47]
ds_read_b64_tr_b16 v[68:69], v14 offset:36864
v_mfma_f32_16x16x32_bf16 v[44:47], v[76:79], v[140:143], v[44:47]
ds_read_b64_tr_b16 v[70:71], v14 offset:37888
s_waitcnt vmcnt(11) lgkmcnt(10)
v_mfma_f32_16x16x32_bf16 v[16:19], v[48:51], v[144:147], v[16:19]
ds_read_b64_tr_b16 v[72:73], v15 offset:32768
buffer_load_dwordx4 v[192:195], v6, s[20:23], s66 offen offset:0 sc1
s_waitcnt vmcnt(11) lgkmcnt(9)
v_mfma_f32_16x16x32_bf16 v[16:19], v[52:55], v[152:155], v[16:19]
ds_read_b64_tr_b16 v[74:75], v15 offset:33792
s_waitcnt vmcnt(10)
v_mfma_f32_16x16x32_bf16 v[32:35], v[48:51], v[148:151], v[32:35]
ds_read_b64_tr_b16 v[76:77], v15 offset:36864
buffer_load_dwordx4 v[200:203], v6, s[20:23], s66 offen offset:2048 sc1
s_waitcnt vmcnt(10)
v_mfma_f32_16x16x32_bf16 v[32:35], v[52:55], v[156:159], v[32:35]
ds_read_b64_tr_b16 v[78:79], v15 offset:37888
s_waitcnt lgkmcnt(10)
v_mfma_f32_16x16x32_bf16 v[20:23], v[56:59], v[144:147], v[20:23]
ds_read_b64_tr_b16 v[48:49], v12 offset:40960
buffer_load_dwordx4 v[196:199], v6, s[20:23], s66 offen offset:256 sc1
s_waitcnt lgkmcnt(9)
v_mfma_f32_16x16x32_bf16 v[20:23], v[60:63], v[152:155], v[20:23]
ds_read_b64_tr_b16 v[50:51], v12 offset:41984
v_mfma_f32_16x16x32_bf16 v[36:39], v[56:59], v[148:151], v[36:39]
ds_read_b64_tr_b16 v[52:53], v12 offset:45056
buffer_load_dwordx4 v[204:207], v6, s[20:23], s66 offen offset:2304 sc1
s_add_u32 s66, s66, 4096
s_and_b32 s66, s66, 0xffff
v_mfma_f32_16x16x32_bf16 v[36:39], v[60:63], v[156:159], v[36:39]
ds_read_b64_tr_b16 v[54:55], v12 offset:46080
s_waitcnt lgkmcnt(10)
v_mfma_f32_16x16x32_bf16 v[24:27], v[64:67], v[144:147], v[24:27]
ds_read_b64_tr_b16 v[56:57], v13 offset:40960
s_waitcnt lgkmcnt(9)
v_mfma_f32_16x16x32_bf16 v[24:27], v[68:71], v[152:155], v[24:27]
ds_read_b64_tr_b16 v[58:59], v13 offset:41984
v_mfma_f32_16x16x32_bf16 v[40:43], v[64:67], v[148:151], v[40:43]
ds_read_b64_tr_b16 v[60:61], v13 offset:45056
v_mfma_f32_16x16x32_bf16 v[40:43], v[68:71], v[156:159], v[40:43]
ds_read_b64_tr_b16 v[62:63], v13 offset:46080
s_waitcnt lgkmcnt(10)
v_mfma_f32_16x16x32_bf16 v[28:31], v[72:75], v[144:147], v[28:31]
ds_read_b64_tr_b16 v[64:65], v14 offset:40960
s_waitcnt lgkmcnt(9)
v_mfma_f32_16x16x32_bf16 v[28:31], v[76:79], v[152:155], v[28:31]
ds_read_b64_tr_b16 v[66:67], v14 offset:41984
v_mfma_f32_16x16x32_bf16 v[44:47], v[72:75], v[148:151], v[44:47]
ds_read_b64_tr_b16 v[68:69], v14 offset:45056
v_mfma_f32_16x16x32_bf16 v[44:47], v[76:79], v[156:159], v[44:47]
ds_read_b64_tr_b16 v[70:71], v14 offset:46080
s_waitcnt vmcnt(11) lgkmcnt(10)
v_mfma_f32_16x16x32_bf16 v[16:19], v[48:51], v[160:163], v[16:19]
ds_read_b64_tr_b16 v[72:73], v15 offset:40960
s_waitcnt vmcnt(10) lgkmcnt(9)
v_mfma_f32_16x16x32_bf16 v[16:19], v[52:55], v[168:171], v[16:19]
ds_read_b64_tr_b16 v[74:75], v15 offset:41984
s_waitcnt vmcnt(9)
v_mfma_f32_16x16x32_bf16 v[32:35], v[48:51], v[164:167], v[32:35]
ds_read_b64_tr_b16 v[76:77], v15 offset:45056
s_waitcnt vmcnt(8)
v_mfma_f32_16x16x32_bf16 v[32:35], v[52:55], v[172:175], v[32:35]
ds_read_b64_tr_b16 v[78:79], v15 offset:46080
s_waitcnt lgkmcnt(10)
v_mfma_f32_16x16x32_bf16 v[20:23], v[56:59], v[160:163], v[20:23]
ds_read_b64_tr_b16 v[48:49], v12 offset:49152
s_waitcnt lgkmcnt(9)
v_mfma_f32_16x16x32_bf16 v[20:23], v[60:63], v[168:171], v[20:23]
ds_read_b64_tr_b16 v[50:51], v12 offset:50176
v_mfma_f32_16x16x32_bf16 v[36:39], v[56:59], v[164:167], v[36:39]
ds_read_b64_tr_b16 v[52:53], v12 offset:53248
v_mfma_f32_16x16x32_bf16 v[36:39], v[60:63], v[172:175], v[36:39]
ds_read_b64_tr_b16 v[54:55], v12 offset:54272
s_waitcnt lgkmcnt(10)
v_mfma_f32_16x16x32_bf16 v[24:27], v[64:67], v[160:163], v[24:27]
ds_read_b64_tr_b16 v[56:57], v13 offset:49152
s_waitcnt lgkmcnt(9)
v_mfma_f32_16x16x32_bf16 v[24:27], v[68:71], v[168:171], v[24:27]
ds_read_b64_tr_b16 v[58:59], v13 offset:50176
v_mfma_f32_16x16x32_bf16 v[40:43], v[64:67], v[164:167], v[40:43]
ds_read_b64_tr_b16 v[60:61], v13 offset:53248
v_mfma_f32_16x16x32_bf16 v[40:43], v[68:71], v[172:175], v[40:43]
ds_read_b64_tr_b16 v[62:63], v13 offset:54272
s_waitcnt lgkmcnt(10)
v_mfma_f32_16x16x32_bf16 v[28:31], v[72:75], v[160:163], v[28:31]
ds_read_b64_tr_b16 v[64:65], v14 offset:49152
s_waitcnt lgkmcnt(9)
v_mfma_f32_16x16x32_bf16 v[28:31], v[76:79], v[168:171], v[28:31]
ds_read_b64_tr_b16 v[66:67], v14 offset:50176
v_mfma_f32_16x16x32_bf16 v[44:47], v[72:75], v[164:167], v[44:47]
ds_read_b64_tr_b16 v[68:69], v14 offset:53248
v_mfma_f32_16x16x32_bf16 v[44:47], v[76:79], v[172:175], v[44:47]
ds_read_b64_tr_b16 v[70:71], v14 offset:54272
s_waitcnt vmcnt(7) lgkmcnt(10)
v_mfma_f32_16x16x32_bf16 v[16:19], v[48:51], v[176:179], v[16:19]
ds_read_b64_tr_b16 v[72:73], v15 offset:49152
s_waitcnt vmcnt(6) lgkmcnt(9)
v_mfma_f32_16x16x32_bf16 v[16:19], v[52:55], v[184:187], v[16:19]
ds_read_b64_tr_b16 v[74:75], v15 offset:50176
s_waitcnt vmcnt(5)
v_mfma_f32_16x16x32_bf16 v[32:35], v[48:51], v[180:183], v[32:35]
ds_read_b64_tr_b16 v[76:77], v15 offset:53248
s_waitcnt vmcnt(4)
v_mfma_f32_16x16x32_bf16 v[32:35], v[52:55], v[188:191], v[32:35]
ds_read_b64_tr_b16 v[78:79], v15 offset:54272
s_waitcnt lgkmcnt(10)
v_mfma_f32_16x16x32_bf16 v[20:23], v[56:59], v[176:179], v[20:23]
ds_read_b64_tr_b16 v[48:49], v12 offset:57344
s_waitcnt lgkmcnt(9)
v_mfma_f32_16x16x32_bf16 v[20:23], v[60:63], v[184:187], v[20:23]
ds_read_b64_tr_b16 v[50:51], v12 offset:58368
v_mfma_f32_16x16x32_bf16 v[36:39], v[56:59], v[180:183], v[36:39]
ds_read_b64_tr_b16 v[52:53], v12 offset:61440
v_mfma_f32_16x16x32_bf16 v[36:39], v[60:63], v[188:191], v[36:39]
ds_read_b64_tr_b16 v[54:55], v12 offset:62464
s_waitcnt lgkmcnt(10)
v_mfma_f32_16x16x32_bf16 v[24:27], v[64:67], v[176:179], v[24:27]
ds_read_b64_tr_b16 v[56:57], v13 offset:57344
s_waitcnt lgkmcnt(9)
v_mfma_f32_16x16x32_bf16 v[24:27], v[68:71], v[184:187], v[24:27]
ds_read_b64_tr_b16 v[58:59], v13 offset:58368
v_mfma_f32_16x16x32_bf16 v[40:43], v[64:67], v[180:183], v[40:43]
ds_read_b64_tr_b16 v[60:61], v13 offset:61440
v_mfma_f32_16x16x32_bf16 v[40:43], v[68:71], v[188:191], v[40:43]
ds_read_b64_tr_b16 v[62:63], v13 offset:62464
s_waitcnt lgkmcnt(10)
v_mfma_f32_16x16x32_bf16 v[28:31], v[72:75], v[176:179], v[28:31]
ds_read_b64_tr_b16 v[64:65], v14 offset:57344
s_waitcnt lgkmcnt(9)
v_mfma_f32_16x16x32_bf16 v[28:31], v[76:79], v[184:187], v[28:31]
ds_read_b64_tr_b16 v[66:67], v14 offset:58368
v_mfma_f32_16x16x32_bf16 v[44:47], v[72:75], v[180:183], v[44:47]
ds_read_b64_tr_b16 v[68:69], v14 offset:61440
v_mfma_f32_16x16x32_bf16 v[44:47], v[76:79], v[188:191], v[44:47]
ds_read_b64_tr_b16 v[70:71], v14 offset:62464
s_waitcnt vmcnt(3) lgkmcnt(10)
v_mfma_f32_16x16x32_bf16 v[16:19], v[48:51], v[192:195], v[16:19]
ds_read_b64_tr_b16 v[72:73], v15 offset:57344
s_waitcnt vmcnt(2) lgkmcnt(9)
v_mfma_f32_16x16x32_bf16 v[16:19], v[52:55], v[200:203], v[16:19]
ds_read_b64_tr_b16 v[74:75], v15 offset:58368
s_waitcnt vmcnt(1)
v_mfma_f32_16x16x32_bf16 v[32:35], v[48:51], v[196:199], v[32:35]
ds_read_b64_tr_b16 v[76:77], v15 offset:61440
s_waitcnt vmcnt(0)
v_mfma_f32_16x16x32_bf16 v[32:35], v[52:55], v[204:207], v[32:35]
ds_read_b64_tr_b16 v[78:79], v15 offset:62464
s_waitcnt lgkmcnt(10)
v_mfma_f32_16x16x32_bf16 v[20:23], v[56:59], v[192:195], v[20:23]
v_add_u32 v5, s34, 22
s_mov_b64 exec, 1
ds_write_b32 v3, v5
s_mov_b64 exec, -1
s_waitcnt lgkmcnt(9)
v_mfma_f32_16x16x32_bf16 v[20:23], v[60:63], v[200:203], v[20:23]
v_mfma_f32_16x16x32_bf16 v[36:39], v[56:59], v[196:199], v[36:39]
v_mfma_f32_16x16x32_bf16 v[36:39], v[60:63], v[204:207], v[36:39]
s_waitcnt lgkmcnt(7)
v_mfma_f32_16x16x32_bf16 v[24:27], v[64:67], v[192:195], v[24:27]
s_waitcnt lgkmcnt(5)
v_mfma_f32_16x16x32_bf16 v[24:27], v[68:71], v[200:203], v[24:27]
v_mfma_f32_16x16x32_bf16 v[40:43], v[64:67], v[196:199], v[40:43]
v_mfma_f32_16x16x32_bf16 v[40:43], v[68:71], v[204:207], v[40:43]
s_waitcnt lgkmcnt(3)
v_mfma_f32_16x16x32_bf16 v[28:31], v[72:75], v[192:195], v[28:31]
s_waitcnt lgkmcnt(1)
v_mfma_f32_16x16x32_bf16 v[28:31], v[76:79], v[200:203], v[28:31]
v_mfma_f32_16x16x32_bf16 v[44:47], v[72:75], v[196:199], v[44:47]
v_mfma_f32_16x16x32_bf16 v[44:47], v[76:79], v[204:207], v[44:47]
s_lshl2_add_u32 s73, s61, s58
s_lshl4_add_u32 s66, s61, s62
s_lshl2_add_u32 s68, s66, s58
s_lshl_b32 s68, s68, 12
s_add_u32 s68, s68, 26214400
s_lshl_b32 s66, s61, 7
s_add_u32 s66, s66, s62
s_lshl_b32 s66, s66, 7
s_add_u32 s66, s66, 274432
s_lshl_b32 s74, s73, 13
s_add_u32 s74, s74, 524288
s_lshl_b32 s67, s62, 9
s_add_u32 s67, s67, s74
v_lshlrev_b32 v6, 4, v0
s_mov_b32 s69, 0x3f803f80
v_mov_b32 v8, 0
v_mov_b32 v9, 0
v_mov_b32 v10, 0
v_mov_b32 v11, 0
v_mov_b32 v12, 0
v_mov_b32 v13, 0
v_mov_b32 v14, 0
v_dot2c_f32_bf16 v11, s69, v232
v_dot2c_f32_bf16 v11, s69, v233
v_dot2c_f32_bf16 v11, s69, v234
v_dot2c_f32_bf16 v11, s69, v235
v_dot2c_f32_bf16 v11, s69, v236
v_dot2c_f32_bf16 v11, s69, v237
v_dot2c_f32_bf16 v11, s69, v238
v_dot2c_f32_bf16 v11, s69, v239
s_cmp_eq_u32 s63, 0
v_cvt_pk_bf16_f32 v240, v16, v17
v_cvt_pk_bf16_f32 v241, v18, v19
v_cvt_pk_bf16_f32 v242, v20, v21
v_cvt_pk_bf16_f32 v243, v22, v23
v_cvt_pk_bf16_f32 v244, v24, v25
v_cvt_pk_bf16_f32 v245, v26, v27
v_cvt_pk_bf16_f32 v246, v28, v29
v_cvt_pk_bf16_f32 v247, v30, v31
v_cvt_pk_bf16_f32 v248, v32, v33
v_cvt_pk_bf16_f32 v249, v34, v35
v_cvt_pk_bf16_f32 v250, v36, v37
v_cvt_pk_bf16_f32 v251, v38, v39
v_cvt_pk_bf16_f32 v252, v40, v41
v_cvt_pk_bf16_f32 v253, v42, v43
v_cvt_pk_bf16_f32 v254, v44, v45
v_cvt_pk_bf16_f32 v255, v46, v47
s_cselect_b64 exec, -1, 0
s_cmp_eq_u32 s57, 0
s_cbranch_scc1 far_169
buffer_store_dwordx4 v[240:243], v6, s[20:23], s68 offen offset:0
buffer_store_dwordx4 v[244:247], v6, s[20:23], s68 offen offset:1024
buffer_store_dwordx4 v[248:251], v6, s[20:23], s68 offen offset:2048
buffer_store_dwordx4 v[252:255], v6, s[20:23], s68 offen offset:3072
near_170:
s_mov_b64 exec, -1
v_dot2c_f32_bf16 v8, s69, v240
v_dot2c_f32_bf16 v9, v240, v240
v_dot2c_f32_bf16 v10, v232, v240
v_dot2c_f32_bf16 v12, s69, v248
v_dot2c_f32_bf16 v13, v248, v248
v_dot2c_f32_bf16 v14, v232, v248
v_dot2c_f32_bf16 v8, s69, v241
v_dot2c_f32_bf16 v9, v241, v241
v_dot2c_f32_bf16 v10, v233, v241
v_dot2c_f32_bf16 v12, s69, v249
v_dot2c_f32_bf16 v13, v249, v249
v_dot2c_f32_bf16 v14, v233, v249
v_dot2c_f32_bf16 v8, s69, v242
v_dot2c_f32_bf16 v9, v242, v242
v_dot2c_f32_bf16 v10, v234, v242
v_dot2c_f32_bf16 v12, s69, v250
v_dot2c_f32_bf16 v13, v250, v250
v_dot2c_f32_bf16 v14, v234, v250
v_dot2c_f32_bf16 v8, s69, v243
v_dot2c_f32_bf16 v9, v243, v243
v_dot2c_f32_bf16 v10, v235, v243
v_dot2c_f32_bf16 v12, s69, v251
v_dot2c_f32_bf16 v13, v251, v251
v_dot2c_f32_bf16 v14, v235, v251
v_dot2c_f32_bf16 v8, s69, v244
v_dot2c_f32_bf16 v9, v244, v244
v_dot2c_f32_bf16 v10, v236, v244
v_dot2c_f32_bf16 v12, s69, v252
v_dot2c_f32_bf16 v13, v252, v252
v_dot2c_f32_bf16 v14, v236, v252
v_dot2c_f32_bf16 v8, s69, v245
v_dot2c_f32_bf16 v9, v245, v245
v_dot2c_f32_bf16 v10, v237, v245
v_dot2c_f32_bf16 v12, s69, v253
v_dot2c_f32_bf16 v13, v253, v253
v_dot2c_f32_bf16 v14, v237, v253
v_dot2c_f32_bf16 v8, s69, v246
v_dot2c_f32_bf16 v9, v246, v246
v_dot2c_f32_bf16 v10, v238, v246
v_dot2c_f32_bf16 v12, s69, v254
v_dot2c_f32_bf16 v13, v254, v254
v_dot2c_f32_bf16 v14, v238, v254
v_dot2c_f32_bf16 v8, s69, v247
v_dot2c_f32_bf16 v9, v247, v247
v_dot2c_f32_bf16 v10, v239, v247
v_dot2c_f32_bf16 v12, s69, v255
v_dot2c_f32_bf16 v13, v255, v255
v_dot2c_f32_bf16 v14, v239, v255
v_mov_b32 v15, v11
v_lshrrev_b32 v7, 5, v0
v_mul_u32_u24 v7, 3584, v7
v_permlane16_swap_b32 v8, v12
v_permlane16_swap_b32 v9, v13
v_permlane16_swap_b32 v10, v14
v_permlane16_swap_b32 v11, v15
v_pk_add_f32 v[8:9], v[8:9], v[12:13]
v_pk_add_f32 v[10:11], v[10:11], v[14:15]
v_mov_b32 v12, v8
v_mov_b32 v13, v9
v_mov_b32 v14, v10
v_mov_b32 v15, v11
v_permlane32_swap_b32 v12, v8
v_permlane32_swap_b32 v13, v9
v_permlane32_swap_b32 v14, v10
v_permlane32_swap_b32 v15, v11
v_pk_add_f32 v[8:9], v[8:9], v[12:13]
v_pk_add_f32 v[10:11], v[10:11], v[14:15]
v_add_u32 v7, v6, v7
v_max_u32 v8, 1, v8
v_max_u32 v9, 1, v9
v_max_u32 v10, 1, v10
v_max_u32 v11, 1, v11
s_mov_b32 exec_hi, 0
s_cmp_eq_u32 s57, 0
s_cbranch_scc1 far_171
buffer_store_dwordx4 v[8:11], v6, s[24:27], s67 offen
near_172:
s_mov_b32 exec_hi, -1
v_lshlrev_b32 v16, 16, v240
v_and_b32 v17, 0xffff0000, v240
v_lshlrev_b32 v18, 16, v241
v_and_b32 v19, 0xffff0000, v241
v_lshlrev_b32 v20, 16, v242
v_and_b32 v21, 0xffff0000, v242
v_lshlrev_b32 v22, 16, v243
v_and_b32 v23, 0xffff0000, v243
v_lshlrev_b32 v24, 16, v244
v_and_b32 v25, 0xffff0000, v244
v_lshlrev_b32 v26, 16, v245
v_and_b32 v27, 0xffff0000, v245
v_lshlrev_b32 v28, 16, v246
v_and_b32 v29, 0xffff0000, v246
v_lshlrev_b32 v30, 16, v247
v_and_b32 v31, 0xffff0000, v247
v_lshlrev_b32 v32, 16, v248
v_and_b32 v33, 0xffff0000, v248
v_lshlrev_b32 v34, 16, v249
v_and_b32 v35, 0xffff0000, v249
v_lshlrev_b32 v36, 16, v250
v_and_b32 v37, 0xffff0000, v250
v_lshlrev_b32 v38, 16, v251
v_and_b32 v39, 0xffff0000, v251
v_lshlrev_b32 v40, 16, v252
v_and_b32 v41, 0xffff0000, v252
v_lshlrev_b32 v42, 16, v253
v_and_b32 v43, 0xffff0000, v253
v_lshlrev_b32 v44, 16, v254
v_and_b32 v45, 0xffff0000, v254
v_lshlrev_b32 v46, 16, v255
v_and_b32 v47, 0xffff0000, v255
v_and_b32 v14, 15, v0
v_lshlrev_b32 v14, 11, v14
v_bfe_u32 v15, v0, 4, 1
v_lshl_add_u32 v14, v15, 5, v14
v_lshrrev_b32 v15, 5, v0
v_lshl_add_u32 v14, v15, 4, v14
s_lshl2_add_u32 s70, s61, s58
s_lshl_b32 s70, s70, 16
s_lshl_b32 s71, s62, 7
s_add_u32 s70, s70, s71
s_add_u32 s71, s70, 0x8000
s_lshl_b32 s67, s62, 6
s_sub_u32 s68, s66, 2048
s_lshl1_add_u32 s69, s67, s68
s_sub_u32 s69, s69, 10240
s_sub_u32 s72, s68, s67
s_add_u32 s72, s72, 4096
s_lshl_b32 s75, s73, 5
s_add_u32 s75, s75, 1
v_and_b32 v15, 48, v0
v_add_u32 v13, s75, v0
v_lshlrev_b32 v4, 1, v15
s_mov_b64 exec, 1
s_waitcnt vmcnt(1)
s_cmp_eq_u32 s57, 0
s_cbranch_scc1 far_173
buffer_store_dword v212, v3, s[24:27], s66 offen
near_174:
s_mov_b64 exec, -1
v_add_u32 v5, s34, 23
s_mov_b64 exec, 1
ds_write_b32 v3, v5
s_mov_b64 exec, -1
s_waitcnt vmcnt(1)
buffer_load_dwordx4 v[80:83], v7, s[24:27], s74 offen offset:0 sc1
buffer_load_dwordx4 v[84:87], v7, s[24:27], s74 offen offset:512 sc1
buffer_load_dwordx4 v[88:91], v7, s[24:27], s74 offen offset:1024 sc1
buffer_load_dwordx4 v[92:95], v7, s[24:27], s74 offen offset:1536 sc1
buffer_load_dwordx4 v[96:99], v7, s[24:27], s74 offen offset:2048 sc1
buffer_load_dwordx4 v[100:103], v7, s[24:27], s74 offen offset:2560 sc1
buffer_load_dwordx4 v[104:107], v7, s[24:27], s74 offen offset:3072 sc1
buffer_load_dwordx4 v[108:111], v7, s[24:27], s74 offen offset:3584 sc1
s_cmp_eq_u32 s63, 0
s_cbranch_scc0 mhz_175
v_lshrrev_b32 v196, 4, v0
s_cmp_eq_u32 1, 0
s_cbranch_scc0 mq_176
v_bfe_u32 v197, v0, 1, 3
v_xor_b32 v197, v197, v196
v_lshlrev_b32 v197, 4, v197
v_and_b32 v198, 15, v0
v_lshl_add_u32 v192, v198, 7, v197
v_xor_b32 v193, 64, v192
s_branch mq_177
mq_176:
v_lshlrev_b32 v192, 4, v0
v_add_u32 v193, 1024, v192
mq_177:
s_lshl_b32 s46, s65, 13
s_add_u32 s46, s46, 86016
v_add_u32 v192, s46, v192
v_add_u32 v193, s46, v193
v_bfe_u32 v197, v0, 2, 2
v_lshl_add_u32 v197, v196, 3, v197
v_bfe_u32 v198, v0, 3, 2
s_lshl_b32 s46, s64, 1
v_xor_b32 v198, s46, v198
v_lshlrev_b32 v198, 5, v198
v_lshl_add_u32 v197, v197, 7, v198
v_and_b32 v198, 3, v0
v_lshl_add_u32 v197, v198, 3, v197
v_add_u32 v194, 102400, v197
v_xor_b32 v195, 32, v194
v_mov_b32 v197, 0xf149f2ca
v_xor_b32 v216, v197, v216
v_xor_b32 v217, v197, v217
v_xor_b32 v218, v197, v218
v_xor_b32 v219, v197, v219
v_xor_b32 v220, v197, v220
v_xor_b32 v221, v197, v221
v_xor_b32 v222, v197, v222
v_xor_b32 v223, v197, v223
v_xor_b32 v224, v197, v224
v_xor_b32 v225, v197, v225
v_xor_b32 v226, v197, v226
v_xor_b32 v227, v197, v227
v_xor_b32 v228, v197, v228
v_xor_b32 v229, v197, v229
v_xor_b32 v230, v197, v230
v_xor_b32 v231, v197, v231
v_and_b32 v196, 15, v0
v_lshrrev_b32 v197, 4, v0
s_lshl_b32 s46, s65, 8
s_add_u32 s46, s46, 1280
s_mul_i32 s47, s64, 384
v_lshl_add_u32 v208, v196, 2, s46
v_lshl_add_u32 v209, v197, 4, s46
v_lshl_add_u32 v210, v196, 2, s47
v_lshl_add_u32 v211, v197, 4, s47
v_and_b32 v198, 1, v197
v_lshrrev_b32 v197, 1, v197
v_lshlrev_b32 v197, 9, v197
v_lshl_add_u32 v197, v198, 10, v197
s_lshl_b32 s46, s64, 12
s_lshl_b32 s47, s65, 13
s_add_u32 s46, s46, 131072
s_add_u32 s48, s46, 24576
s_sub_u32 s48, s48, s47
s_add_u32 s47, s46, s47
v_lshl_add_u32 v200, v196, 4, v197
v_and_b32 v198, 3, v0
v_lshl_add_u32 v197, v198, 4, v197
v_bfe_u32 v198, v0, 3, 1
v_lshl_add_u32 v197, v198, 6, v197
v_bfe_u32 v198, v0, 2, 1
v_lshl_add_u32 v198, v198, 8, v197
v_add_u32 v199, s48, v198
v_add_u32 v198, s47, v198
v_add_u32 v201, s48, v200
v_add_u32 v200, s47, v200
s_lshl_b32 s46, s59, 4
s_add_u32 s46, s46, s60
s_lshl_b32 s50, s59, 7
s_add_u32 s50, s50, s60
s_lshl_b32 s50, s50, 7
s_lshl_b32 s46, s46, 15
s_lshl_b32 s47, 1, 23
s_add_u32 s46, s46, s47
s_add_u32 s49, s46, 917504
mhz_175:
s_branch pchk_179
poll_178:
buffer_load_dwordx4 v[80:83], v7, s[24:27], s74 offen offset:0 sc1
buffer_load_dwordx4 v[84:87], v7, s[24:27], s74 offen offset:512 sc1
buffer_load_dwordx4 v[88:91], v7, s[24:27], s74 offen offset:1024 sc1
buffer_load_dwordx4 v[92:95], v7, s[24:27], s74 offen offset:1536 sc1
buffer_load_dwordx4 v[96:99], v7, s[24:27], s74 offen offset:2048 sc1
buffer_load_dwordx4 v[100:103], v7, s[24:27], s74 offen offset:2560 sc1
buffer_load_dwordx4 v[104:107], v7, s[24:27], s74 offen offset:3072 sc1
buffer_load_dwordx4 v[108:111], v7, s[24:27], s74 offen offset:3584 sc1
pchk_179:
s_waitcnt vmcnt(7)
v_min3_u32 v8, v80, v81, v82
s_waitcnt vmcnt(6)
v_min3_u32 v8, v8, v83, v84
v_min3_u32 v8, v8, v85, v86
s_waitcnt vmcnt(5)
v_min3_u32 v8, v8, v87, v88
v_min3_u32 v8, v8, v89, v90
s_waitcnt vmcnt(4)
v_min3_u32 v8, v8, v91, v92
v_min3_u32 v8, v8, v93, v94
s_waitcnt vmcnt(3)
v_min3_u32 v8, v8, v95, v96
v_min3_u32 v8, v8, v97, v98
s_waitcnt vmcnt(2)
v_min3_u32 v8, v8, v99, v100
v_min3_u32 v8, v8, v101, v102
s_waitcnt vmcnt(1)
v_min3_u32 v8, v8, v103, v104
v_min3_u32 v8, v8, v105, v106
s_waitcnt vmcnt(0)
v_min3_u32 v8, v8, v107, v108
v_min3_u32 v8, v8, v109, v110
v_min_u32 v8, v8, v111
v_cmp_eq_u32 vcc, 0, v8
s_cbranch_vccz pdone_180
s_sub_u32 s32, s32, 1
s_cmp_gt_i32 s32, 0
s_cbranch_scc1 poll_178
pdone_180:
v_pk_add_f32 v[80:81], v[80:81], v[96:97]
v_pk_add_f32 v[82:83], v[82:83], v[98:99]
v_pk_add_f32 v[84:85], v[84:85], v[100:101]
v_pk_add_f32 v[86:87], v[86:87], v[102:103]
v_pk_add_f32 v[88:89], v[88:89], v[104:105]
v_pk_add_f32 v[90:91], v[90:91], v[106:107]
v_pk_add_f32 v[92:93], v[92:93], v[108:109]
v_pk_add_f32 v[94:95], v[94:95], v[110:111]
v_pk_add_f32 v[80:81], v[80:81], v[88:89]
v_pk_add_f32 v[82:83], v[82:83], v[90:91]
v_pk_add_f32 v[84:85], v[84:85], v[92:93]
v_pk_add_f32 v[86:87], v[86:87], v[94:95]
v_pk_add_f32 v[80:81], v[80:81], v[84:85]
v_pk_add_f32 v[82:83], v[82:83], v[86:87]
v_mov_b32 v8, v80
v_mov_b32 v9, v81
v_mov_b32 v10, v82
v_mov_b32 v11, v83
v_permlane32_swap_b32 v8, v80
v_permlane32_swap_b32 v9, v81
v_permlane32_swap_b32 v10, v82
v_permlane32_swap_b32 v11, v83
v_pk_add_f32 v[8:9], v[8:9], v[80:81]
v_pk_add_f32 v[10:11], v[10:11], v[82:83]
v_mul_f32 v8, 0xba800000, v8
v_mul_f32 v9, 0x3a800000, v9
v_fma_f32 v9, -v8, v8, v9
v_max_f32 v9, 0, v9
v_add_f32 v12, 0x3727c5ac, v9
v_rsq_f32 v80, v12
v_fma_f32 v10, v8, v11, v10
v_mul_f32 v12, v80, v10
v_max_u32 v12, 1, v12
v_add_u32 v7, s34, v3
v_mov_b32 v6, v12
s_nop 1
v_max_f32_dpp v6, v6, v6 row_ror:1 row_mask:0xf bank_mask:0xf
s_nop 1
v_max_f32_dpp v6, v6, v6 row_ror:2 row_mask:0xf bank_mask:0xf
s_nop 1
v_max_f32_dpp v6, v6, v6 row_ror:4 row_mask:0xf bank_mask:0xf
s_nop 1
v_max_f32_dpp v6, v6, v6 row_ror:8 row_mask:0xf bank_mask:0xf
v_mov_b32 v11, v6
s_nop 1
v_permlane16_swap_b32 v11, v6
v_max_f32 v6, v6, v11
v_cmp_eq_f32 vcc, v6, v12
s_ff1_i32_b64 s66, vcc
s_and_b32 s66, s66, 31
s_mov_b64 exec, 1
ds_write_b32 v7, v6 offset:256
s_mov_b64 exec, -1
v_add_u32 v7, s34, v1
v_mul_f32 v81, v8, v80
v_add_f32 v10, 1.0, v80
v_mov_b32 v82, v80
v_mov_b32 v83, v81
s_and_b32 s67, s66, 15
s_lshl_b32 s67, 0x10001, s67
s_bitcmp0_b32 s66, 4
v_permlane16_swap_b32 v80, v82
v_permlane16_swap_b32 v81, v83
s_cselect_b32 s76, s67, 0
s_cselect_b32 s78, 0, s67
s_cselect_b32 s77, s67, 0
s_cselect_b32 s79, 0, s67
s_add_u32 s75, s75, s66
v_pk_fma_f32 v[48:49], v[16:17], v[80:81], v[80:81] op_sel:[0,0,1] op_sel_hi:[1,0,1]
v_pk_fma_f32 v[50:51], v[18:19], v[80:81], v[80:81] op_sel:[0,0,1] op_sel_hi:[1,0,1]
v_pk_fma_f32 v[52:53], v[20:21], v[80:81], v[80:81] op_sel:[0,0,1] op_sel_hi:[1,0,1]
v_pk_fma_f32 v[54:55], v[22:23], v[80:81], v[80:81] op_sel:[0,0,1] op_sel_hi:[1,0,1]
v_pk_fma_f32 v[56:57], v[24:25], v[80:81], v[80:81] op_sel:[0,0,1] op_sel_hi:[1,0,1]
v_pk_fma_f32 v[58:59], v[26:27], v[80:81], v[80:81] op_sel:[0,0,1] op_sel_hi:[1,0,1]
v_pk_fma_f32 v[60:61], v[28:29], v[80:81], v[80:81] op_sel:[0,0,1] op_sel_hi:[1,0,1]
v_pk_fma_f32 v[62:63], v[30:31], v[80:81], v[80:81] op_sel:[0,0,1] op_sel_hi:[1,0,1]
v_pk_fma_f32 v[64:65], v[32:33], v[82:83], v[82:83] op_sel:[0,0,1] op_sel_hi:[1,0,1]
v_pk_fma_f32 v[66:67], v[34:35], v[82:83], v[82:83] op_sel:[0,0,1] op_sel_hi:[1,0,1]
v_pk_fma_f32 v[68:69], v[36:37], v[82:83], v[82:83] op_sel:[0,0,1] op_sel_hi:[1,0,1]
v_pk_fma_f32 v[70:71], v[38:39], v[82:83], v[82:83] op_sel:[0,0,1] op_sel_hi:[1,0,1]
v_pk_fma_f32 v[72:73], v[40:41], v[82:83], v[82:83] op_sel:[0,0,1] op_sel_hi:[1,0,1]
v_pk_fma_f32 v[74:75], v[42:43], v[82:83], v[82:83] op_sel:[0,0,1] op_sel_hi:[1,0,1]
v_pk_fma_f32 v[76:77], v[44:45], v[82:83], v[82:83] op_sel:[0,0,1] op_sel_hi:[1,0,1]
v_pk_fma_f32 v[78:79], v[46:47], v[82:83], v[82:83] op_sel:[0,0,1] op_sel_hi:[1,0,1]
v_cvt_pk_bf16_f32 v84, v48, v49
v_cvt_pk_bf16_f32 v85, v50, v51
v_cvt_pk_bf16_f32 v86, v52, v53
v_cvt_pk_bf16_f32 v87, v54, v55
v_cvt_pk_bf16_f32 v88, v56, v57
v_cvt_pk_bf16_f32 v89, v58, v59
v_cvt_pk_bf16_f32 v90, v60, v61
v_cvt_pk_bf16_f32 v91, v62, v63
v_cvt_pk_bf16_f32 v92, v64, v65
v_cvt_pk_bf16_f32 v93, v66, v67
v_cvt_pk_bf16_f32 v94, v68, v69
v_cvt_pk_bf16_f32 v95, v70, v71
v_cvt_pk_bf16_f32 v96, v72, v73
v_cvt_pk_bf16_f32 v97, v74, v75
v_cvt_pk_bf16_f32 v98, v76, v77
v_cvt_pk_bf16_f32 v99, v78, v79
ds_read_b32 v11, v7 offset:256
v_max_u32 v84, 1, v84
v_max_u32 v85, 1, v85
v_max_u32 v86, 1, v86
v_max_u32 v87, 1, v87
v_max_u32 v88, 1, v88
v_max_u32 v89, 1, v89
v_max_u32 v90, 1, v90
v_max_u32 v91, 1, v91
v_max_u32 v92, 1, v92
v_max_u32 v93, 1, v93
v_max_u32 v94, 1, v94
v_max_u32 v95, 1, v95
v_max_u32 v96, 1, v96
v_max_u32 v97, 1, v97
v_max_u32 v98, 1, v98
v_max_u32 v99, 1, v99
s_branch pchk_182
poll_181:
ds_read_b32 v11, v7 offset:256
pchk_182:
s_waitcnt lgkmcnt(0)
v_cmp_eq_u32 vcc, 0, v11
s_cbranch_vccz pdone_183
s_sub_u32 s32, s32, 1
s_cmp_gt_i32 s32, 0
s_cbranch_scc1 poll_181
pdone_183:
v_cmp_eq_f32 vcc, v11, v6
s_bfm_b32 s67, s58, 0
s_and_b32 s67, s67, vcc_lo
v_cmp_gt_f32 vcc, v11, v6
s_lshl_b32 s66, 1, s66
s_or_b32 s67, s67, vcc_lo
s_cselect_b64 s[76:77], 0, s[76:77]
s_cselect_b64 s[78:79], 0, s[78:79]
s_cselect_b64 exec, 0, s[66:67]
s_bitcmp0_b32 s62, 0
s_cselect_b64 exec, exec, 0
buffer_store_dwordx2 v[12:13], off, s[24:27], s72 sc1
s_mov_b64 exec, s[76:77]
buffer_store_dwordx4 v[84:87], v4, s[24:27], s68 offen offset:0 sc1
buffer_store_dwordx4 v[88:91], v4, s[24:27], s68 offen offset:16 sc1
s_mov_b64 exec, s[78:79]
buffer_store_dwordx4 v[92:95], v4, s[24:27], s68 offen offset:0 sc1
buffer_store_dwordx4 v[96:99], v4, s[24:27], s68 offen offset:16 sc1
s_mov_b64 exec, -1
v_add_u32 v5, s34, 24
s_mov_b64 exec, 1
ds_write_b32 v3, v5
s_mov_b64 exec, -1
v_pk_add_f32 v[16:17], v[16:17], v[48:49]
v_pk_add_f32 v[18:19], v[18:19], v[50:51]
v_pk_add_f32 v[20:21], v[20:21], v[52:53]
v_pk_add_f32 v[22:23], v[22:23], v[54:55]
v_pk_add_f32 v[24:25], v[24:25], v[56:57]
v_pk_add_f32 v[26:27], v[26:27], v[58:59]
v_pk_add_f32 v[28:29], v[28:29], v[60:61]
v_pk_add_f32 v[30:31], v[30:31], v[62:63]
v_pk_add_f32 v[32:33], v[32:33], v[64:65]
v_pk_add_f32 v[34:35], v[34:35], v[66:67]
v_pk_add_f32 v[36:37], v[36:37], v[68:69]
v_pk_add_f32 v[38:39], v[38:39], v[70:71]
v_pk_add_f32 v[40:41], v[40:41], v[72:73]
v_pk_add_f32 v[42:43], v[42:43], v[74:75]
v_pk_add_f32 v[44:45], v[44:45], v[76:77]
v_pk_add_f32 v[46:47], v[46:47], v[78:79]
v_cvt_pk_bf16_f32 v240, v16, v17
v_cvt_pk_bf16_f32 v241, v18, v19
v_cvt_pk_bf16_f32 v242, v20, v21
v_cvt_pk_bf16_f32 v243, v22, v23
v_cvt_pk_bf16_f32 v244, v24, v25
v_cvt_pk_bf16_f32 v245, v26, v27
v_cvt_pk_bf16_f32 v246, v28, v29
v_cvt_pk_bf16_f32 v247, v30, v31
v_cvt_pk_bf16_f32 v248, v32, v33
v_cvt_pk_bf16_f32 v249, v34, v35
v_cvt_pk_bf16_f32 v250, v36, v37
v_cvt_pk_bf16_f32 v251, v38, v39
v_cvt_pk_bf16_f32 v252, v40, v41
v_cvt_pk_bf16_f32 v253, v42, v43
v_cvt_pk_bf16_f32 v254, v44, v45
v_cvt_pk_bf16_f32 v255, v46, v47
v_max_u32 v16, 1, v16
v_max_u32 v17, 1, v17
v_max_u32 v18, 1, v18
v_max_u32 v19, 1, v19
v_max_u32 v20, 1, v20
v_max_u32 v21, 1, v21
v_max_u32 v22, 1, v22
v_max_u32 v23, 1, v23
v_max_u32 v24, 1, v24
v_max_u32 v25, 1, v25
v_max_u32 v26, 1, v26
v_max_u32 v27, 1, v27
v_max_u32 v28, 1, v28
v_max_u32 v29, 1, v29
v_max_u32 v30, 1, v30
v_max_u32 v31, 1, v31
v_max_u32 v32, 1, v32
v_max_u32 v33, 1, v33
v_max_u32 v34, 1, v34
v_max_u32 v35, 1, v35
v_max_u32 v36, 1, v36
v_max_u32 v37, 1, v37
v_max_u32 v38, 1, v38
v_max_u32 v39, 1, v39
v_max_u32 v40, 1, v40
v_max_u32 v41, 1, v41
v_max_u32 v42, 1, v42
v_max_u32 v43, 1, v43
v_max_u32 v44, 1, v44
v_max_u32 v45, 1, v45
v_max_u32 v46, 1, v46
v_max_u32 v47, 1, v47
s_mov_b64 exec, s[76:77]
buffer_store_dwordx4 v[16:19], v15, s[24:27], s69 offen offset:0 sc1
buffer_store_dwordx4 v[20:23], v15, s[24:27], s69 offen offset:64 sc1
buffer_store_dwordx4 v[24:27], v15, s[24:27], s69 offen offset:128 sc1
buffer_store_dwordx4 v[28:31], v15, s[24:27], s69 offen offset:192 sc1
s_mov_b64 exec, s[78:79]
buffer_store_dwordx4 v[32:35], v15, s[24:27], s69 offen offset:0 sc1
buffer_store_dwordx4 v[36:39], v15, s[24:27], s69 offen offset:64 sc1
buffer_store_dwordx4 v[40:43], v15, s[24:27], s69 offen offset:128 sc1
buffer_store_dwordx4 v[44:47], v15, s[24:27], s69 offen offset:192 sc1
s_mov_b64 exec, -1
s_cmp_eq_u32 s63, 0
s_cbranch_scc0 mout_184
v_mul_f32 v11, v10, v10
v_mov_b32 v12, 0x3727c5ac
v_fma_f32 v11, v11, v9, v12
v_rsq_f32 v11, v11
v_lshrrev_b32 v12, 3, v0
v_lshlrev_b32 v12, 6, v12
v_lshl_add_u32 v12, v0, 3, v12
v_mul_f32 v10, v10, v11
v_mul_f32 v11, v8, v10
s_lshl_b32 s66, s61, 5
s_add_u32 s66, s66, s58
s_lshl_b32 s66, s66, 9
s_add_u32 s66, s66, 1675264
v_max_u32 v11, 1, v11
s_cmp_eq_u32 s62, 8
s_cselect_b32 exec_lo, -1, 0
s_mov_b32 exec_hi, 0
s_cmp_eq_u32 s57, 0
s_cbranch_scc1 far_185
buffer_store_dwordx2 v[10:11], v12, s[24:27], s66 offen
near_186:
s_mov_b64 exec, -1
s_mov_b32 s63, 1
s_mov_b32 s34, 32
s_add_u32 s24, s24, 1409024
s_addc_u32 s25, s25, 0
s_mov_b32 s26, 1409024
s_branch L_mtop
mout_184:
v_permlane16_swap_b32 v240, v242
v_permlane16_swap_b32 v241, v243
v_permlane16_swap_b32 v244, v246
v_permlane16_swap_b32 v245, v247
v_permlane16_swap_b32 v248, v250
v_permlane16_swap_b32 v249, v251
v_permlane16_swap_b32 v252, v254
v_permlane16_swap_b32 v253, v255
s_not_b64 exec, s[76:77]
buffer_store_dwordx4 v[240:243], v14, s[28:31], s70 offen offset:0
buffer_store_dwordx4 v[244:247], v14, s[28:31], s70 offen offset:64
s_not_b64 exec, s[78:79]
buffer_store_dwordx4 v[248:251], v14, s[28:31], s71 offen offset:0
buffer_store_dwordx4 v[252:255], v14, s[28:31], s71 offen offset:64
s_mov_b64 exec, -1
s_or_b32 s66, s76, s78
s_cbranch_scc0 L_end
v_mov_b32 v11, 0
s_add_u32 s35, s34, 4
lw_187:
ds_read_b32 v5, v2 offset:24
s_waitcnt lgkmcnt(0)
v_cmp_gt_i32 vcc, s35, v5
s_cbranch_vccz lwd_188
s_sleep 2
s_sub_u32 s32, s32, 1
s_cmp_gt_i32 s32, 0
s_cbranch_scc1 lw_187
lwd_188:
ds_read_b32 v11, v11 offset:32
s_waitcnt lgkmcnt(0)
v_cmp_eq_u32 vcc, s75, v11
s_cbranch_vccnz L_end
s_mov_b64 exec, s[76:77]
buffer_store_dwordx4 v[240:243], v14, s[28:31], s70 offen offset:0
buffer_store_dwordx4 v[244:247], v14, s[28:31], s70 offen offset:64
s_mov_b64 exec, s[78:79]
buffer_store_dwordx4 v[248:251], v14, s[28:31], s71 offen offset:0
buffer_store_dwordx4 v[252:255], v14, s[28:31], s71 offen offset:64
s_mov_b64 exec, -1
s_branch L_end
mspin_132:
ds_read_b32 v5, v2 offset:16
s_waitcnt lgkmcnt(0)
v_cmp_ge_u32 vcc, v4, v5
s_cbranch_vccz mback_133
s_sub_u32 s32, s32, 1
s_cmp_gt_i32 s32, 0
s_cbranch_scc1 mspin_132
s_branch mback_133
mspin_130:
msp_189:
ds_read_b32 v5, v2 offset:16
s_waitcnt lgkmcnt(0)
v_cmp_ge_u32 vcc, v4, v5
s_cbranch_vccz mback_131
s_sub_u32 s32, s32, 1
s_cmp_gt_i32 s32, 0
s_cbranch_scc1 msp_189
s_branch mback_131
lspin_134:
s_add_u32 s35, s34, 2
lw_190:
ds_read_b32 v5, v2 offset:24
s_waitcnt lgkmcnt(0)
v_cmp_gt_i32 vcc, s35, v5
s_cbranch_vccz lwd_191
s_sub_u32 s32, s32, 1
s_cmp_gt_i32 s32, 0
s_cbranch_scc1 lw_190
lwd_191:
s_branch lback_135
patch_136:
s_bfe_u32 s66, s33, 0x20005
s_lshr_b32 s67, s66, 1
s_xor_b32 s66, s66, s67
s_and_b32 s66, s66, 1
s_cmp_eq_u32 s66, s65
s_cbranch_scc0 pback_137
s_bfe_u32 s66, s33, 0x10004
s_lshl1_add_u32 s73, s67, s66
s_and_b32 s66, s33, 15
s_mov_b32 s74, 0x10001
s_mov_b32 s75, s74
s_lshl_b64 s[74:75], s[74:75], s66
s_and_b32 s66, s66, 12
s_lshl_b32 s66, s66, 2
s_bfm_b64 s[76:77], 16, s66
s_nop 7
s_mov_b64 exec, s[74:75]
s_cmp_eq_u32 s73, 0
s_cbranch_scc0 pnx_193
ds_read_b128 v[16:19], v211 offset:3456
ds_read_b128 v[20:23], v211 offset:3520
s_branch pdn_192
pnx_193:
s_cmp_eq_u32 s73, 1
s_cbranch_scc0 pnx_194
ds_read_b128 v[24:27], v211 offset:3456
ds_read_b128 v[28:31], v211 offset:3520
s_branch pdn_192
pnx_194:
s_cmp_eq_u32 s73, 2
s_cbranch_scc0 pnx_195
ds_read_b128 v[32:35], v211 offset:3456
ds_read_b128 v[36:39], v211 offset:3520
s_branch pdn_192
pnx_195:
ds_read_b128 v[40:43], v211 offset:3456
ds_read_b128 v[44:47], v211 offset:3520
pdn_192:
s_mov_b64 exec, -1
s_waitcnt lgkmcnt(0)
s_branch pback_137
patch_138:
s_nop 7
s_nop 7
s_and_b32 s66, s33, 3
s_lshl2_add_u32 s66, s73, s66
s_mov_b64 exec, s[76:77]
s_cmp_eq_u32 s66, 0
s_cbranch_scc0 pnx_198
ds_read_b32 v48, v210 offset:3584
ds_read_b32 v52, v210 offset:3648
s_branch pdn_197
pnx_198:
s_cmp_eq_u32 s66, 1
s_cbranch_scc0 pnx_199
ds_read_b32 v49, v210 offset:3584
ds_read_b32 v53, v210 offset:3648
s_branch pdn_197
pnx_199:
s_cmp_eq_u32 s66, 2
s_cbranch_scc0 pnx_200
ds_read_b32 v50, v210 offset:3584
ds_read_b32 v54, v210 offset:3648
s_branch pdn_197
pnx_200:
s_cmp_eq_u32 s66, 3
s_cbranch_scc0 pnx_201
ds_read_b32 v51, v210 offset:3584
ds_read_b32 v55, v210 offset:3648
s_branch pdn_197
pnx_201:
s_cmp_eq_u32 s66, 4
s_cbranch_scc0 pnx_202
ds_read_b32 v56, v210 offset:3584
ds_read_b32 v60, v210 offset:3648
s_branch pdn_197
pnx_202:
s_cmp_eq_u32 s66, 5
s_cbranch_scc0 pnx_203
ds_read_b32 v57, v210 offset:3584
ds_read_b32 v61, v210 offset:3648
s_branch pdn_197
pnx_203:
s_cmp_eq_u32 s66, 6
s_cbranch_scc0 pnx_204
ds_read_b32 v58, v210 offset:3584
ds_read_b32 v62, v210 offset:3648
s_branch pdn_197
pnx_204:
s_cmp_eq_u32 s66, 7
s_cbranch_scc0 pnx_205
ds_read_b32 v59, v210 offset:3584
ds_read_b32 v63, v210 offset:3648
s_branch pdn_197
pnx_205:
s_cmp_eq_u32 s66, 8
s_cbranch_scc0 pnx_206
ds_read_b32 v64, v210 offset:3584
ds_read_b32 v68, v210 offset:3648
s_branch pdn_197
pnx_206:
s_cmp_eq_u32 s66, 9
s_cbranch_scc0 pnx_207
ds_read_b32 v65, v210 offset:3584
ds_read_b32 v69, v210 offset:3648
s_branch pdn_197
pnx_207:
s_cmp_eq_u32 s66, 10
s_cbranch_scc0 pnx_208
ds_read_b32 v66, v210 offset:3584
ds_read_b32 v70, v210 offset:3648
s_branch pdn_197
pnx_208:
s_cmp_eq_u32 s66, 11
s_cbranch_scc0 pnx_209
ds_read_b32 v67, v210 offset:3584
ds_read_b32 v71, v210 offset:3648
s_branch pdn_197
pnx_209:
s_cmp_eq_u32 s66, 12
s_cbranch_scc0 pnx_210
ds_read_b32 v72, v210 offset:3584
ds_read_b32 v76, v210 offset:3648
s_branch pdn_197
pnx_210:
s_cmp_eq_u32 s66, 13
s_cbranch_scc0 pnx_211
ds_read_b32 v73, v210 offset:3584
ds_read_b32 v77, v210 offset:3648
s_branch pdn_197
pnx_211:
s_cmp_eq_u32 s66, 14
s_cbranch_scc0 pnx_212
ds_read_b32 v74, v210 offset:3584
ds_read_b32 v78, v210 offset:3648
s_branch pdn_197
pnx_212:
ds_read_b32 v75, v210 offset:3584
ds_read_b32 v79, v210 offset:3648
pdn_197:
s_mov_b64 exec, -1
s_waitcnt lgkmcnt(0)
s_branch pback_139
patch_140:
s_nop 7
s_nop 7
s_mov_b64 exec, s[74:75]
s_cmp_eq_u32 s73, 0
s_cbranch_scc0 pnx_215
ds_read_b128 v[80:83], v211 offset:3328
ds_read_b128 v[84:87], v211 offset:3392
s_branch pdn_214
pnx_215:
s_cmp_eq_u32 s73, 1
s_cbranch_scc0 pnx_216
ds_read_b128 v[88:91], v211 offset:3328
ds_read_b128 v[92:95], v211 offset:3392
s_branch pdn_214
pnx_216:
s_cmp_eq_u32 s73, 2
s_cbranch_scc0 pnx_217
ds_read_b128 v[96:99], v211 offset:3328
ds_read_b128 v[100:103], v211 offset:3392
s_branch pdn_214
pnx_217:
ds_read_b128 v[104:107], v211 offset:3328
ds_read_b128 v[108:111], v211 offset:3392
pdn_214:
s_mov_b64 exec, -1
s_waitcnt lgkmcnt(0)
s_branch pback_141
cross_151:
s_cmp_eq_u32 s67, 122880
s_cbranch_scc0 cr2_219
v_add_u32 v5, s34, 18
s_mov_b64 exec, 1
ds_write_b32 v3, v5
s_mov_b64 exec, -1
v_mov_b32 v9, 0xf149f2ca
v_xor_b32 v216, v9, v216
v_xor_b32 v217, v9, v217
v_xor_b32 v218, v9, v218
v_xor_b32 v219, v9, v219
v_xor_b32 v220, v9, v220
v_xor_b32 v221, v9, v221
v_xor_b32 v222, v9, v222
v_xor_b32 v223, v9, v223
v_xor_b32 v224, v9, v224
v_xor_b32 v225, v9, v225
v_xor_b32 v226, v9, v226
v_xor_b32 v227, v9, v227
v_xor_b32 v228, v9, v228
v_xor_b32 v229, v9, v229
v_xor_b32 v230, v9, v230
v_xor_b32 v231, v9, v231
s_mov_b32 s67, 114688
s_cmp_eq_u32 s63, 0
s_cbranch_scc0 cr3_220
v_and_b32 v9, 15, v0
v_lshlrev_b32 v9, 11, v9
v_bfe_u32 v10, v0, 4, 1
v_lshl_add_u32 v9, v10, 5, v9
v_lshrrev_b32 v10, 5, v0
v_lshl_add_u32 v9, v10, 4, v9
s_lshl2_add_u32 s70, s61, s58
s_lshl_b32 s70, s70, 16
s_lshl_b32 s71, s62, 7
s_add_u32 s70, s70, s71
s_add_u32 s71, s70, 0x8000
buffer_load_dwordx4 v[240:243], v9, s[8:11], s70 offen offset:0
buffer_load_dwordx4 v[244:247], v9, s[8:11], s70 offen offset:64
buffer_load_dwordx4 v[248:251], v9, s[8:11], s71 offen offset:0
buffer_load_dwordx4 v[252:255], v9, s[8:11], s71 offen offset:64
cr3_220:
s_cmp_eq_u32 s59, 0
s_cbranch_scc1 cback_152
v_mov_b32 v9, 0
s_add_u32 s35, s34, 18
lw_221:
ds_read_b32 v5, v9 offset:16
s_waitcnt lgkmcnt(0)
v_cmp_gt_i32 vcc, s35, v5
s_cbranch_vccz lwd_222
s_sub_u32 s32, s32, 1
s_cmp_gt_i32 s32, 0
s_cbranch_scc1 lw_221
lwd_222:
s_branch cback_152
cr2_219:
s_cmp_eq_u32 s67, 114688
s_cbranch_scc0 cr4_223
s_mov_b32 s67, 90112
s_add_u32 s35, s34, 21
lw_224:
ds_read_b32 v5, v9 offset:16
s_waitcnt lgkmcnt(0)
v_cmp_gt_i32 vcc, s35, v5
s_cbranch_vccz lwd_225
s_sub_u32 s32, s32, 1
s_cmp_gt_i32 s32, 0
s_cbranch_scc1 lw_224
lwd_225:
s_branch cback_152
cr4_223:
v_add_u32 v5, s34, 19
s_mov_b64 exec, 1
ds_write_b32 v3, v5
s_mov_b64 exec, -1
s_mov_b32 s66, 28672
s_cmp_lt_u32 s59, 2
s_cbranch_scc1 cback_152
s_add_u32 s35, s34, 21
lw_226:
ds_read_b32 v5, v2 offset:16
s_waitcnt lgkmcnt(0)
v_cmp_gt_i32 vcc, s35, v5
s_cbranch_vccz lwd_227
s_sub_u32 s32, s32, 1
s_cmp_gt_i32 s32, 0
s_cbranch_scc1 lw_226
lwd_227:
s_branch cback_152
cross_153:
s_cmp_eq_u32 s67, 122880
s_cbranch_scc0 cr2_228
s_waitcnt lgkmcnt(1)
v_add_u32 v5, s34, 18
s_mov_b64 exec, 1
ds_write_b32 v3, v5
s_mov_b64 exec, -1
v_mov_b32 v9, 0xf149f2ca
v_xor_b32 v216, v9, v216
v_xor_b32 v217, v9, v217
v_xor_b32 v218, v9, v218
v_xor_b32 v219, v9, v219
v_xor_b32 v220, v9, v220
v_xor_b32 v221, v9, v221
v_xor_b32 v222, v9, v222
v_xor_b32 v223, v9, v223
v_xor_b32 v224, v9, v224
v_xor_b32 v225, v9, v225
v_xor_b32 v226, v9, v226
v_xor_b32 v227, v9, v227
v_xor_b32 v228, v9, v228
v_xor_b32 v229, v9, v229
v_xor_b32 v230, v9, v230
v_xor_b32 v231, v9, v231
s_mov_b32 s67, 114688
s_cmp_eq_u32 s63, 0
s_cbranch_scc0 cr3_229
v_and_b32 v9, 15, v0
v_lshlrev_b32 v9, 11, v9
v_bfe_u32 v10, v0, 4, 1
v_lshl_add_u32 v9, v10, 5, v9
v_lshrrev_b32 v10, 5, v0
v_lshl_add_u32 v9, v10, 4, v9
s_lshl2_add_u32 s70, s61, s58
s_lshl_b32 s70, s70, 16
s_lshl_b32 s71, s62, 7
s_add_u32 s70, s70, s71
s_add_u32 s71, s70, 0x8000
buffer_load_dwordx4 v[240:243], v9, s[8:11], s70 offen offset:0
buffer_load_dwordx4 v[244:247], v9, s[8:11], s70 offen offset:64
buffer_load_dwordx4 v[248:251], v9, s[8:11], s71 offen offset:0
buffer_load_dwordx4 v[252:255], v9, s[8:11], s71 offen offset:64
cr3_229:
s_cmp_eq_u32 s59, 0
s_cbranch_scc1 cback_154
v_mov_b32 v9, 0
s_add_u32 s35, s34, 18
lw_230:
ds_read_b32 v5, v9 offset:16
s_waitcnt lgkmcnt(0)
v_cmp_gt_i32 vcc, s35, v5
s_cbranch_vccz lwd_231
s_sub_u32 s32, s32, 1
s_cmp_gt_i32 s32, 0
s_cbranch_scc1 lw_230
lwd_231:
s_branch cback_154
cr2_228:
s_waitcnt lgkmcnt(1)
v_cmp_gt_i32 vcc, s35, v5
s_cmp_eq_u32 s67, 114688
s_cbranch_scc0 cr4_232
s_mov_b32 s67, 90112
s_bitcmp0_b32 vcc_lo, 0
s_cbranch_scc1 cback_154
s_add_u32 s35, s34, 21
lw_233:
ds_read_b32 v5, v9 offset:16
s_waitcnt lgkmcnt(0)
v_cmp_gt_i32 vcc, s35, v5
s_cbranch_vccz lwd_234
s_sub_u32 s32, s32, 1
s_cmp_gt_i32 s32, 0
s_cbranch_scc1 lw_233
lwd_234:
s_branch cback_154
cr4_232:
v_add_u32 v5, s34, 19
s_mov_b64 exec, 1
ds_write_b32 v3, v5
s_mov_b64 exec, -1
s_mov_b32 s66, 28672
s_cmp_lt_u32 s59, 2
s_cbranch_scc1 cback_154
s_cbranch_vccz cback_154
s_add_u32 s35, s34, 21
lw_235:
ds_read_b32 v5, v2 offset:16
s_waitcnt lgkmcnt(0)
v_cmp_gt_i32 vcc, s35, v5
s_cbranch_vccz lwd_236
s_sub_u32 s32, s32, 1
s_cmp_gt_i32 s32, 0
s_cbranch_scc1 lw_235
lwd_236:
s_branch cback_154
slow_155:
s_add_u32 s70, s72, 270336
poll_237:
buffer_load_dword v10, v1, s[24:27], s70 offen sc1
pchk_238:
s_waitcnt vmcnt(0)
v_cmp_eq_u32 vcc, 0, v10
s_cbranch_vccz pdone_239
s_sub_u32 s32, s32, 1
s_cmp_gt_i32 s32, 0
s_cbranch_scc1 poll_237
pdone_239:
s_lshl_b32 s73, s60, 15
s_lshl_b32 s74, s63, 23
s_add_u32 s73, s73, s74
s_add_u32 s73, s73, 1048576
v_mov_b32 v10, 0xf149f2ca
v_mov_b32 v11, 0
v_mov_b32 v192, 0
v_mov_b32 v193, 0
v_mov_b32 v194, 0
v_mov_b32 v195, 0
v_mov_b32 v196, 0
v_mov_b32 v197, 0
v_mov_b32 v198, 0
v_mov_b32 v199, 0
v_mov_b32 v200, 0
v_mov_b32 v201, 0
v_mov_b32 v202, 0
v_mov_b32 v203, 0
v_mov_b32 v204, 0
v_mov_b32 v205, 0
v_mov_b32 v206, 0
v_mov_b32 v207, 0
v_mov_b32 v208, 0
v_mov_b32 v209, 0
v_mov_b32 v210, 0
v_mov_b32 v211, 0
s_lshl2_add_u32 s74, s59, s65
s_mov_b32 s75, 0
sl_240:
s_lshr_b32 s76, s74, 2
s_lshl_b32 s76, s76, 19
s_and_b32 s77, s74, 3
s_lshl_b32 s77, s77, 13
s_add_u32 s76, s76, s77
s_add_u32 s76, s76, s73
buffer_load_dwordx4 v[152:155], v6, s[20:23], s76 offen offset:0 sc1
buffer_load_dwordx4 v[156:159], v6, s[20:23], s76 offen offset:1024 sc1
s_cmp_eq_u32 s75, 0
s_cselect_b32 s76, 0xf149f2ca, 0
s_and_b32 s77, s75, 7
s_cselect_b32 s77, 0, -1
v_xor_b32 v112, s76, v216
v_and_b32 v112, s77, v112
v_xor_b32 v113, s76, v217
v_and_b32 v113, s77, v113
v_xor_b32 v114, s76, v218
v_and_b32 v114, s77, v114
v_xor_b32 v115, s76, v219
v_and_b32 v115, s77, v115
v_xor_b32 v116, s76, v220
v_and_b32 v116, s77, v116
v_xor_b32 v117, s76, v221
v_and_b32 v117, s77, v117
v_xor_b32 v118, s76, v222
v_and_b32 v118, s77, v118
v_xor_b32 v119, s76, v223
v_and_b32 v119, s77, v119
v_xor_b32 v120, s76, v224
v_and_b32 v120, s77, v120
v_xor_b32 v121, s76, v225
v_and_b32 v121, s77, v121
v_xor_b32 v122, s76, v226
v_and_b32 v122, s77, v122
v_xor_b32 v123, s76, v227
v_and_b32 v123, s77, v123
v_xor_b32 v124, s76, v228
v_and_b32 v124, s77, v124
v_xor_b32 v125, s76, v229
v_and_b32 v125, s77, v125
v_xor_b32 v126, s76, v230
v_and_b32 v126, s77, v126
v_xor_b32 v127, s76, v231
v_and_b32 v127, s77, v127
s_waitcnt vmcnt(1)
s_nop 0
v_mfma_f32_32x32x16_bf16 v[112:127], v[152:155], v[80:83], v[112:127]
s_waitcnt vmcnt(0)
v_mfma_f32_32x32x16_bf16 v[112:127], v[156:159], v[88:91], v[112:127]
s_nop 11
v_max3_f32 v10, v10, v112, v113
v_max3_f32 v10, v10, v114, v115
v_max3_f32 v10, v10, v116, v117
v_max3_f32 v10, v10, v118, v119
v_max3_f32 v10, v10, v120, v121
v_max3_f32 v10, v10, v122, v123
v_max3_f32 v10, v10, v124, v125
v_max3_f32 v10, v10, v126, v127
s_add_u32 s75, s75, 1
s_sub_u32 s74, s74, 1
s_cselect_b32 s75, 9, s75
s_cmp_lt_u32 s75, 9
s_cbranch_scc1 sl_240
v_mov_b32 v11, v10
s_nop 1
v_permlane32_swap_b32 v11, v10
v_max_f32 v10, v10, v11
s_lshl2_add_u32 s74, s59, s65
s_mov_b32 s75, 0
sl_241:
s_lshr_b32 s76, s74, 2
s_lshl_b32 s76, s76, 19
s_and_b32 s77, s74, 3
s_lshl_b32 s77, s77, 13
s_add_u32 s76, s76, s77
s_add_u32 s76, s76, s73
buffer_load_dwordx4 v[152:155], v6, s[20:23], s76 offen offset:0 sc1
buffer_load_dwordx4 v[156:159], v6, s[20:23], s76 offen offset:1024 sc1
buffer_load_dwordx4 v[160:163], v6, s[20:23], s76 offen offset:2048 sc1
buffer_load_dwordx4 v[164:167], v6, s[20:23], s76 offen offset:3072 sc1
s_cmp_eq_u32 s75, 0
s_cselect_b32 s76, 0xf149f2ca, 0
s_and_b32 s77, s75, 7
s_cselect_b32 s77, 0, -1
v_xor_b32 v112, s76, v216
v_and_b32 v112, s77, v112
v_sub_f32 v112, v112, v10
v_xor_b32 v113, s76, v217
v_and_b32 v113, s77, v113
v_sub_f32 v113, v113, v10
v_xor_b32 v114, s76, v218
v_and_b32 v114, s77, v114
v_sub_f32 v114, v114, v10
v_xor_b32 v115, s76, v219
v_and_b32 v115, s77, v115
v_sub_f32 v115, v115, v10
v_xor_b32 v116, s76, v220
v_and_b32 v116, s77, v116
v_sub_f32 v116, v116, v10
v_xor_b32 v117, s76, v221
v_and_b32 v117, s77, v117
v_sub_f32 v117, v117, v10
v_xor_b32 v118, s76, v222
v_and_b32 v118, s77, v118
v_sub_f32 v118, v118, v10
v_xor_b32 v119, s76, v223
v_and_b32 v119, s77, v119
v_sub_f32 v119, v119, v10
v_xor_b32 v120, s76, v224
v_and_b32 v120, s77, v120
v_sub_f32 v120, v120, v10
v_xor_b32 v121, s76, v225
v_and_b32 v121, s77, v121
v_sub_f32 v121, v121, v10
v_xor_b32 v122, s76, v226
v_and_b32 v122, s77, v122
v_sub_f32 v122, v122, v10
v_xor_b32 v123, s76, v227
v_and_b32 v123, s77, v123
v_sub_f32 v123, v123, v10
v_xor_b32 v124, s76, v228
v_and_b32 v124, s77, v124
v_sub_f32 v124, v124, v10
v_xor_b32 v125, s76, v229
v_and_b32 v125, s77, v125
v_sub_f32 v125, v125, v10
v_xor_b32 v126, s76, v230
v_and_b32 v126, s77, v126
v_sub_f32 v126, v126, v10
v_xor_b32 v127, s76, v231
v_and_b32 v127, s77, v127
v_sub_f32 v127, v127, v10
s_waitcnt vmcnt(3)
s_nop 0
v_mfma_f32_32x32x16_bf16 v[112:127], v[152:155], v[80:83], v[112:127]
s_waitcnt vmcnt(2)
v_mfma_f32_32x32x16_bf16 v[112:127], v[156:159], v[88:91], v[112:127]
s_nop 11
v_exp_f32 v112, v112
v_exp_f32 v113, v113
v_exp_f32 v114, v114
v_exp_f32 v115, v115
v_exp_f32 v116, v116
v_exp_f32 v117, v117
v_exp_f32 v118, v118
v_exp_f32 v119, v119
v_exp_f32 v120, v120
v_exp_f32 v121, v121
v_exp_f32 v122, v122
v_exp_f32 v123, v123
v_exp_f32 v124, v124
v_exp_f32 v125, v125
v_exp_f32 v126, v126
v_exp_f32 v127, v127
v_cvt_pk_bf16_f32 v144, v112, v113
v_cvt_pk_bf16_f32 v145, v114, v115
v_cvt_pk_bf16_f32 v146, v116, v117
v_cvt_pk_bf16_f32 v147, v118, v119
v_cvt_pk_bf16_f32 v148, v120, v121
v_cvt_pk_bf16_f32 v149, v122, v123
v_cvt_pk_bf16_f32 v150, v124, v125
v_cvt_pk_bf16_f32 v151, v126, v127
s_waitcnt vmcnt(1)
v_mfma_f32_32x32x16_bf16 v[192:207], v[160:163], v[144:147], v[192:207]
v_mfma_f32_16x16x32_bf16 v[208:211], v[212:215], v[144:147], v[208:211]
s_waitcnt vmcnt(0)
v_mfma_f32_32x32x16_bf16 v[192:207], v[164:167], v[148:151], v[192:207]
v_mfma_f32_16x16x32_bf16 v[208:211], v[212:215], v[148:151], v[208:211]
s_add_u32 s75, s75, 1
s_sub_u32 s74, s74, 1
s_cselect_b32 s75, 9, s75
s_cmp_lt_u32 s75, 9
s_cbranch_scc1 sl_241
v_mov_b32 v10, 0xf149f2ca
v_mov_b32 v11, 0
v_mov_b32 v16, 0
v_mov_b32 v17, 0
v_mov_b32 v18, 0
v_mov_b32 v19, 0
v_mov_b32 v20, 0
v_mov_b32 v21, 0
v_mov_b32 v22, 0
v_mov_b32 v23, 0
v_mov_b32 v24, 0
v_mov_b32 v25, 0
v_mov_b32 v26, 0
v_mov_b32 v27, 0
v_mov_b32 v28, 0
v_mov_b32 v29, 0
v_mov_b32 v30, 0
v_mov_b32 v31, 0
v_mov_b32 v32, 0
v_mov_b32 v33, 0
v_mov_b32 v34, 0
v_mov_b32 v35, 0
s_sub_u32 s74, 3, s65
s_lshl2_add_u32 s74, s59, s74
s_mov_b32 s75, 0
sl_242:
s_lshr_b32 s76, s74, 2
s_lshl_b32 s76, s76, 19
s_and_b32 s77, s74, 3
s_lshl_b32 s77, s77, 13
s_add_u32 s76, s76, s77
s_add_u32 s76, s76, s73
buffer_load_dwordx4 v[152:155], v6, s[20:23], s76 offen offset:0 sc1
buffer_load_dwordx4 v[156:159], v6, s[20:23], s76 offen offset:1024 sc1
s_cmp_eq_u32 s75, 0
s_cselect_b32 s76, 0xf149f2ca, 0
s_and_b32 s77, s75, 7
s_cselect_b32 s77, 0, -1
v_xor_b32 v112, s76, v216
v_and_b32 v112, s77, v112
v_xor_b32 v113, s76, v217
v_and_b32 v113, s77, v113
v_xor_b32 v114, s76, v218
v_and_b32 v114, s77, v114
v_xor_b32 v115, s76, v219
v_and_b32 v115, s77, v115
v_xor_b32 v116, s76, v220
v_and_b32 v116, s77, v116
v_xor_b32 v117, s76, v221
v_and_b32 v117, s77, v117
v_xor_b32 v118, s76, v222
v_and_b32 v118, s77, v118
v_xor_b32 v119, s76, v223
v_and_b32 v119, s77, v119
v_xor_b32 v120, s76, v224
v_and_b32 v120, s77, v120
v_xor_b32 v121, s76, v225
v_and_b32 v121, s77, v121
v_xor_b32 v122, s76, v226
v_and_b32 v122, s77, v122
v_xor_b32 v123, s76, v227
v_and_b32 v123, s77, v123
v_xor_b32 v124, s76, v228
v_and_b32 v124, s77, v124
v_xor_b32 v125, s76, v229
v_and_b32 v125, s77, v125
v_xor_b32 v126, s76, v230
v_and_b32 v126, s77, v126
v_xor_b32 v127, s76, v231
v_and_b32 v127, s77, v127
s_waitcnt vmcnt(1)
s_nop 0
v_mfma_f32_32x32x16_bf16 v[112:127], v[152:155], v[96:99], v[112:127]
s_waitcnt vmcnt(0)
v_mfma_f32_32x32x16_bf16 v[112:127], v[156:159], v[104:107], v[112:127]
s_nop 11
v_max3_f32 v10, v10, v112, v113
v_max3_f32 v10, v10, v114, v115
v_max3_f32 v10, v10, v116, v117
v_max3_f32 v10, v10, v118, v119
v_max3_f32 v10, v10, v120, v121
v_max3_f32 v10, v10, v122, v123
v_max3_f32 v10, v10, v124, v125
v_max3_f32 v10, v10, v126, v127
s_add_u32 s75, s75, 1
s_sub_u32 s74, s74, 1
s_cselect_b32 s75, 9, s75
s_cmp_lt_u32 s75, 9
s_cbranch_scc1 sl_242
v_mov_b32 v11, v10
s_nop 1
v_permlane32_swap_b32 v11, v10
v_max_f32 v10, v10, v11
s_sub_u32 s74, 3, s65
s_lshl2_add_u32 s74, s59, s74
s_mov_b32 s75, 0
sl_243:
s_lshr_b32 s76, s74, 2
s_lshl_b32 s76, s76, 19
s_and_b32 s77, s74, 3
s_lshl_b32 s77, s77, 13
s_add_u32 s76, s76, s77
s_add_u32 s76, s76, s73
buffer_load_dwordx4 v[152:155], v6, s[20:23], s76 offen offset:0 sc1
buffer_load_dwordx4 v[156:159], v6, s[20:23], s76 offen offset:1024 sc1
buffer_load_dwordx4 v[160:163], v6, s[20:23], s76 offen offset:2048 sc1
buffer_load_dwordx4 v[164:167], v6, s[20:23], s76 offen offset:3072 sc1
s_cmp_eq_u32 s75, 0
s_cselect_b32 s76, 0xf149f2ca, 0
s_and_b32 s77, s75, 7
s_cselect_b32 s77, 0, -1
v_xor_b32 v112, s76, v216
v_and_b32 v112, s77, v112
v_sub_f32 v112, v112, v10
v_xor_b32 v113, s76, v217
v_and_b32 v113, s77, v113
v_sub_f32 v113, v113, v10
v_xor_b32 v114, s76, v218
v_and_b32 v114, s77, v114
v_sub_f32 v114, v114, v10
v_xor_b32 v115, s76, v219
v_and_b32 v115, s77, v115
v_sub_f32 v115, v115, v10
v_xor_b32 v116, s76, v220
v_and_b32 v116, s77, v116
v_sub_f32 v116, v116, v10
v_xor_b32 v117, s76, v221
v_and_b32 v117, s77, v117
v_sub_f32 v117, v117, v10
v_xor_b32 v118, s76, v222
v_and_b32 v118, s77, v118
v_sub_f32 v118, v118, v10
v_xor_b32 v119, s76, v223
v_and_b32 v119, s77, v119
v_sub_f32 v119, v119, v10
v_xor_b32 v120, s76, v224
v_and_b32 v120, s77, v120
v_sub_f32 v120, v120, v10
v_xor_b32 v121, s76, v225
v_and_b32 v121, s77, v121
v_sub_f32 v121, v121, v10
v_xor_b32 v122, s76, v226
v_and_b32 v122, s77, v122
v_sub_f32 v122, v122, v10
v_xor_b32 v123, s76, v227
v_and_b32 v123, s77, v123
v_sub_f32 v123, v123, v10
v_xor_b32 v124, s76, v228
v_and_b32 v124, s77, v124
v_sub_f32 v124, v124, v10
v_xor_b32 v125, s76, v229
v_and_b32 v125, s77, v125
v_sub_f32 v125, v125, v10
v_xor_b32 v126, s76, v230
v_and_b32 v126, s77, v126
v_sub_f32 v126, v126, v10
v_xor_b32 v127, s76, v231
v_and_b32 v127, s77, v127
v_sub_f32 v127, v127, v10
s_waitcnt vmcnt(3)
s_nop 0
v_mfma_f32_32x32x16_bf16 v[112:127], v[152:155], v[96:99], v[112:127]
s_waitcnt vmcnt(2)
v_mfma_f32_32x32x16_bf16 v[112:127], v[156:159], v[104:107], v[112:127]
s_nop 11
v_exp_f32 v112, v112
v_exp_f32 v113, v113
v_exp_f32 v114, v114
v_exp_f32 v115, v115
v_exp_f32 v116, v116
v_exp_f32 v117, v117
v_exp_f32 v118, v118
v_exp_f32 v119, v119
v_exp_f32 v120, v120
v_exp_f32 v121, v121
v_exp_f32 v122, v122
v_exp_f32 v123, v123
v_exp_f32 v124, v124
v_exp_f32 v125, v125
v_exp_f32 v126, v126
v_exp_f32 v127, v127
v_cvt_pk_bf16_f32 v144, v112, v113
v_cvt_pk_bf16_f32 v145, v114, v115
v_cvt_pk_bf16_f32 v146, v116, v117
v_cvt_pk_bf16_f32 v147, v118, v119
v_cvt_pk_bf16_f32 v148, v120, v121
v_cvt_pk_bf16_f32 v149, v122, v123
v_cvt_pk_bf16_f32 v150, v124, v125
v_cvt_pk_bf16_f32 v151, v126, v127
s_waitcnt vmcnt(1)
v_mfma_f32_32x32x16_bf16 v[16:31], v[160:163], v[144:147], v[16:31]
v_mfma_f32_16x16x32_bf16 v[32:35], v[212:215], v[144:147], v[32:35]
s_waitcnt vmcnt(0)
v_mfma_f32_32x32x16_bf16 v[16:31], v[164:167], v[148:151], v[16:31]
v_mfma_f32_16x16x32_bf16 v[32:35], v[212:215], v[148:151], v[32:35]
s_add_u32 s75, s75, 1
s_sub_u32 s74, s74, 1
s_cselect_b32 s75, 9, s75
s_cmp_lt_u32 s75, 9
s_cbranch_scc1 sl_243
s_branch sback_156
far_157:
buffer_store_dwordx4 v[16:19], v9, s[20:23], s67 offen offset:0 sc1
buffer_store_dwordx4 v[20:23], v9, s[20:23], s67 offen offset:1024 sc1
s_branch near_158
far_159:
buffer_store_dwordx4 v[192:195], v9, s[20:23], s66 offen offset:0 sc1
buffer_store_dwordx4 v[196:199], v9, s[20:23], s66 offen offset:1024 sc1
s_branch near_160
far_163:
buffer_store_dword v212, v3, s[24:27], s70 offen sc1
s_branch near_164
mo_165:
s_lshr_b32 s67, s33, 5
s_cmp_eq_u32 s67, s66
s_cbranch_scc0 mo_166
s_and_b32 s67, s33, 31
v_sub_u32 v48, s67, v48
v_lshlrev_b32 v49, 4, v49
s_lshl_b32 s67, s62, 14
s_add_u32 s67, s67, 30686208
poll_244:
buffer_load_dwordx4 v[56:59], v49, s[20:23], s67 offen offset:0 sc1
buffer_load_dwordx4 v[60:63], v49, s[20:23], s67 offen offset:64 sc1
pchk_245:
s_waitcnt vmcnt(1)
v_min3_u32 v50, v56, v57, v58
s_waitcnt vmcnt(0)
v_min3_u32 v50, v50, v59, v60
v_min3_u32 v50, v50, v61, v62
v_min_u32 v50, v50, v63
v_cmp_eq_u32 vcc, 0, v50
s_cbranch_vccz pdone_246
s_sub_u32 s32, s32, 1
s_cmp_gt_i32 s32, 0
s_cbranch_scc1 poll_244
pdone_246:
v_cmp_eq_u32 vcc, 0, v48
s_nop 1
v_cndmask_b32 v240, v240, v56, vcc
v_cndmask_b32 v241, v241, v57, vcc
v_cndmask_b32 v242, v242, v58, vcc
v_cndmask_b32 v243, v243, v59, vcc
v_cndmask_b32 v244, v244, v60, vcc
v_cndmask_b32 v245, v245, v61, vcc
v_cndmask_b32 v246, v246, v62, vcc
v_cndmask_b32 v247, v247, v63, vcc
v_cmp_eq_u32 vcc, 16, v48
s_nop 1
v_cndmask_b32 v248, v248, v56, vcc
v_cndmask_b32 v249, v249, v57, vcc
v_cndmask_b32 v250, v250, v58, vcc
v_cndmask_b32 v251, v251, v59, vcc
v_cndmask_b32 v252, v252, v60, vcc
v_cndmask_b32 v253, v253, v61, vcc
v_cndmask_b32 v254, v254, v62, vcc
v_cndmask_b32 v255, v255, v63, vcc
s_branch mo_166
far_169:
buffer_store_dwordx4 v[240:243], v6, s[20:23], s68 offen offset:0 sc1
buffer_store_dwordx4 v[244:247], v6, s[20:23], s68 offen offset:1024 sc1
buffer_store_dwordx4 v[248:251], v6, s[20:23], s68 offen offset:2048 sc1
buffer_store_dwordx4 v[252:255], v6, s[20:23], s68 offen offset:3072 sc1
s_branch near_170
far_171:
buffer_store_dwordx4 v[8:11], v6, s[24:27], s67 offen sc1
s_branch near_172
far_173:
buffer_store_dword v212, v3, s[24:27], s66 offen sc1
s_branch near_174
far_185:
buffer_store_dwordx2 v[10:11], v12, s[24:27], s66 offen sc1
s_branch near_186
L_end:
L_fin:
s_endpgm
.section .rodata,"a"
.p2align 6
.amdhsa_kernel interleave_layers__sliding_block__moe_arch_mod__prompt_kernel
  .amdhsa_next_free_vgpr 256
  .amdhsa_next_free_sgpr 102
  .amdhsa_accum_offset 256
  .amdhsa_group_segment_fixed_size 0
  .amdhsa_kernarg_size 88
  .amdhsa_user_sgpr_count 2
  .amdhsa_user_sgpr_kernarg_segment_ptr 1
  .amdhsa_system_sgpr_workgroup_id_x 1
  .amdhsa_float_denorm_mode_32 3
.end_amdhsa_kernel
```

```asm
; @launch grid=(256,1,1) block=(512,1,1) lds=163840
.amdgcn_target "amdgcn-amd-amdhsa--gfx950"
.text
.globl interleave_layers__sliding_block__moe_arch_mod__prompt_kernel
.p2align 8
.type interleave_layers__sliding_block__moe_arch_mod__prompt_kernel,@function
interleave_layers__sliding_block__moe_arch_mod__prompt_kernel:
s_cmp_ge_u32 s2, 256
s_cbranch_scc1 L_fin
s_load_dwordx16 s[36:51], s[0:1], 0
s_load_dwordx4 s[52:55], s[0:1], 64
s_load_dwordx2 s[56:57], s[0:1], 80
v_lshrrev_b32 v1, 6, v0
v_and_b32 v0, 63, v0
s_and_b32 s64, s2, 7
v_readfirstlane_b32 s3, v1
s_lshr_b32 s65, s2, 3
s_and_b32 s66, s65, 7
s_and_b32 s67, s64, 1
s_lshl3_add_u32 s59, s67, s66
s_lshr_b32 s66, s65, 3
s_lshr_b32 s67, s64, 1
s_lshl2_add_u32 s60, s67, s66
s_and_b32 s66, s65, 1
s_lshl1_add_u32 s61, s64, s66
s_lshr_b32 s62, s65, 1
s_mov_b32 s59, s61
s_xor_b32 s60, s62, 0
s_mov_b32 s63, 0
s_mov_b32 s34, 0
s_mov_b32 s32, 200000
s_mov_b32 s33, -1
s_cmp_ge_u32 s3, 4
s_cselect_b32 s66, 3, 1
s_and_b32 s58, s3, s66
s_waitcnt lgkmcnt(0)
s_mov_b32 s8, s36
s_mov_b32 s9, s37
s_mov_b32 s10, 0x400000
s_mov_b32 s11, 0x00020000
s_mov_b32 s12, s38
s_mov_b32 s13, s39
s_mov_b32 s14, 0x600000
s_mov_b32 s15, 0x00020000
s_mov_b32 s16, s40
s_mov_b32 s17, s41
s_mov_b32 s18, 0x200000
s_mov_b32 s19, 0x00020000
s_mov_b32 s20, s56
s_mov_b32 s21, s57
s_mov_b32 s22, 0x2500000
s_mov_b32 s23, 0x00020000
s_add_u32 s24, s56, 30408704
s_addc_u32 s25, s57, 0
s_mov_b32 s26, 2818048
s_mov_b32 s27, 0x00020000
s_mov_b32 s28, s52
s_mov_b32 s29, s53
s_mov_b32 s30, 0x400000
s_mov_b32 s31, 0x00020000
s_cmp_ge_u32 s3, 4
s_cbranch_scc1 L_m
s_cmp_ge_u32 s3, 2
s_cbranch_scc1 L_f
s_setprio 1
v_and_b32 v22, 7, v0
v_lshrrev_b32 v23, 4, v0
v_lshrrev_b32 v6, 3, v0
v_xor_b32 v7, v22, v23
v_lshlrev_b32 v7, 4, v7
v_lshl_add_u32 v8, v6, 11, v7
v_xor_b32 v7, 64, v8
v_add_u32 v9, 15360, v7
v_add_u32 v10, 30720, v8
v_add_u32 v11, 46080, v7
s_lshl_b32 s70, s59, 18
s_lshl_b32 s71, s58, 16
s_add_u32 s68, s70, s71
s_sub_u32 s69, s70, s71
s_add_u32 s69, s69, 196608
s_mov_b32 s67, 128
s_lshl_b32 s75, s58, 13
s_mov_b32 s65, 86016
s_and_b32 s79, s59, 1
s_mul_i32 s70, s60, 1
s_and_b32 s71, s59, 14
s_add_u32 s70, s70, s71
s_and_b32 s70, s70, 15
s_xor_b32 s64, s70, s79
s_mul_i32 s70, s64, s67
s_add_u32 m0, s65, s75
s_add_u32 s71, s70, s68
buffer_load_dwordx4 v8, s[8:11], s71 offen offset:0 lds
buffer_load_dwordx4 v9, s[8:11], s71 offen offset:1024 lds
buffer_load_dwordx4 v10, s[8:11], s71 offen offset:2048 lds
buffer_load_dwordx4 v11, s[8:11], s71 offen offset:3072 lds
s_add_u32 m0, m0, 4096
s_add_u32 s71, s70, s69
buffer_load_dwordx4 v8, s[8:11], s71 offen offset:0 lds
buffer_load_dwordx4 v9, s[8:11], s71 offen offset:1024 lds
buffer_load_dwordx4 v10, s[8:11], s71 offen offset:2048 lds
buffer_load_dwordx4 v11, s[8:11], s71 offen offset:3072 lds
v_and_b32 v7, 2, v6
v_xor_b32 v7, v7, v22
v_mul_u32_u24 v6, 6144, v6
v_lshl_add_u32 v12, v7, 4, v6
v_xor_b32 v6, 64, v12
v_add_u32 v13, 48128, v6
v_add_u32 v14, 96256, v12
v_add_u32 v15, 144384, v6
s_mul_i32 s76, s58, 12288
s_add_u32 s76, s76, 16384
s_lshl_b32 s70, s60, 7
s_cmp_eq_u32 s58, 0
s_mov_b32 s71, 198656
s_cselect_b32 s72, 0, s71
s_mov_b32 s71, 4096
s_cselect_b32 s73, 196608, s71
s_mov_b32 s71, 200704
s_cselect_b32 s74, 2048, s71
s_add_u32 s72, s72, s70
s_add_u32 s73, s73, s70
s_add_u32 s74, s74, s70
s_mul_i32 s70, s64, 393216
s_add_u32 m0, s65, s76
s_add_u32 s71, s70, s72
buffer_load_dwordx4 v12, s[12:15], s71 offen offset:0 lds
buffer_load_dwordx4 v13, s[12:15], s71 offen offset:1024 lds
buffer_load_dwordx4 v14, s[12:15], s71 offen offset:2048 lds
buffer_load_dwordx4 v15, s[12:15], s71 offen offset:3072 lds
s_add_u32 m0, m0, 4096
s_add_u32 s71, s70, s73
buffer_load_dwordx4 v12, s[12:15], s71 offen offset:0 lds
buffer_load_dwordx4 v13, s[12:15], s71 offen offset:1024 lds
buffer_load_dwordx4 v14, s[12:15], s71 offen offset:2048 lds
buffer_load_dwordx4 v15, s[12:15], s71 offen offset:3072 lds
s_add_u32 m0, m0, 4096
s_add_u32 s71, s70, s74
buffer_load_dwordx4 v12, s[12:15], s71 offen offset:0 lds
buffer_load_dwordx4 v13, s[12:15], s71 offen offset:1024 lds
buffer_load_dwordx4 v14, s[12:15], s71 offen offset:2048 lds
buffer_load_dwordx4 v15, s[12:15], s71 offen offset:3072 lds
s_xor_b32 s64, s64, s79
s_add_u32 s64, s64, 1
s_and_b32 s64, s64, 15
s_xor_b32 s64, s64, s79
s_sub_u32 s65, s65, 40960
s_cselect_b32 s65, 86016, s65
v_and_b32 v1, 3, v0
v_lshlrev_b32 v1, 2, v1
v_and_b32 v2, 4, v1
s_lshl2_add_u32 s35, s58, 16
v_mov_b32 v3, s35
v_lshlrev_b32 v20, 4, v0
v_lshrrev_b32 v6, 2, v0
v_lshl_add_u32 v21, v6, 7, v1
v_lshrrev_b32 v6, 3, v0
v_lshlrev_b32 v23, 1, v23
v_xor_b32 v23, v23, v22
v_lshlrev_b32 v23, 4, v23
v_lshl_add_u32 v23, v6, 11, v23
s_lshl_b32 s70, s62, 7
s_lshl_b32 s71, s58, 16
s_add_u32 s70, s70, s71
v_add_u32 v16, s70, v23
v_add_u32 v17, 15360, v16
v_add_u32 v18, 30720, v16
v_add_u32 v19, 46080, v16
s_add_u32 s77, s61, s62
s_lshl_b32 s77, s77, 17
s_lshl_b32 s78, s58, 12
s_mov_b32 s66, -2
s_barrier
.p2align 4
lq_1:
s_add_u32 s35, s66, 1
lw_4:
ds_read_b32 v5, v1 offset:0
s_waitcnt lgkmcnt(0)
v_cmp_gt_i32 vcc, s35, v5
s_cbranch_vccz lwd_5
s_sub_u32 s32, s32, 1
s_cmp_gt_i32 s32, 0
s_cbranch_scc1 lw_4
lwd_5:
s_cmp_eq_u32 s66, 0
s_cbranch_scc1 lcs_2
lcb_3:
s_mul_i32 s70, s64, s67
s_add_u32 m0, s65, s75
s_add_u32 s71, s70, s68
buffer_load_dwordx4 v8, s[8:11], s71 offen offset:0 sc1 lds
buffer_load_dwordx4 v9, s[8:11], s71 offen offset:1024 sc1 lds
buffer_load_dwordx4 v10, s[8:11], s71 offen offset:2048 sc1 lds
buffer_load_dwordx4 v11, s[8:11], s71 offen offset:3072 sc1 lds
buffer_load_dword v30, off, s[12:15], 0
s_add_u32 m0, m0, 4096
s_add_u32 s71, s70, s69
buffer_load_dwordx4 v8, s[8:11], s71 offen offset:0 sc1 lds
buffer_load_dwordx4 v9, s[8:11], s71 offen offset:1024 sc1 lds
buffer_load_dwordx4 v10, s[8:11], s71 offen offset:2048 sc1 lds
buffer_load_dwordx4 v11, s[8:11], s71 offen offset:3072 sc1 lds
buffer_load_dword v30, off, s[12:15], 0
s_mul_i32 s70, s64, 393216
s_add_u32 m0, s65, s76
s_add_u32 s71, s70, s72
buffer_load_dwordx4 v12, s[12:15], s71 offen offset:0 lds
buffer_load_dwordx4 v13, s[12:15], s71 offen offset:1024 lds
buffer_load_dwordx4 v14, s[12:15], s71 offen offset:2048 lds
buffer_load_dwordx4 v15, s[12:15], s71 offen offset:3072 lds
buffer_load_dword v30, off, s[12:15], 0
v_add_u32 v5, s66, 3
s_mov_b64 exec, 1
s_waitcnt vmcnt(15)
ds_write_b32 v3, v5
s_mov_b64 exec, -1
s_mul_i32 s70, s64, 393216
s_add_u32 m0, m0, 4096
s_add_u32 s71, s70, s73
buffer_load_dwordx4 v12, s[12:15], s71 offen offset:0 lds
buffer_load_dwordx4 v13, s[12:15], s71 offen offset:1024 lds
buffer_load_dwordx4 v14, s[12:15], s71 offen offset:2048 lds
buffer_load_dwordx4 v15, s[12:15], s71 offen offset:3072 lds
buffer_load_dword v30, off, s[12:15], 0
s_mul_i32 s70, s64, 393216
s_add_u32 m0, m0, 4096
s_add_u32 s71, s70, s74
buffer_load_dwordx4 v12, s[12:15], s71 offen offset:0 lds
buffer_load_dwordx4 v13, s[12:15], s71 offen offset:1024 lds
buffer_load_dwordx4 v14, s[12:15], s71 offen offset:2048 lds
buffer_load_dwordx4 v15, s[12:15], s71 offen offset:3072 lds
buffer_load_dword v30, off, s[12:15], 0
s_xor_b32 s64, s64, s79
s_add_u32 s64, s64, 1
s_and_b32 s64, s64, 15
s_xor_b32 s64, s64, s79
s_sub_u32 s65, s65, 40960
s_cselect_b32 s65, 86016, s65
s_add_u32 s66, s66, 1
s_and_b32 s70, s66, 31
s_cmp_eq_u32 s70, 13
s_cbranch_scc0 lq_1
s_waitcnt vmcnt(0)
v_add_u32 v5, s34, 16
s_mov_b64 exec, 1
ds_write_b32 v3, v5
s_mov_b64 exec, -1
s_add_u32 s35, s34, 14
lw_6:
ds_read_b32 v5, v1 offset:0
s_waitcnt lgkmcnt(0)
v_cmp_gt_i32 vcc, s35, v5
s_cbranch_vccz lwd_7
s_sleep 1
s_sub_u32 s32, s32, 1
s_cmp_gt_i32 s32, 0
s_cbranch_scc1 lw_6
lwd_7:
s_add_u32 s70, s77, 262144
s_add_u32 m0, s78, 49152
s_and_b32 s70, s70, 0x1fffff
buffer_load_dwordx4 v16, s[16:19], s70 offen offset:0 lds
buffer_load_dwordx4 v17, s[16:19], s70 offen offset:1024 lds
buffer_load_dwordx4 v18, s[16:19], s70 offen offset:2048 lds
buffer_load_dwordx4 v19, s[16:19], s70 offen offset:3072 lds
buffer_load_dword v30, off, s[12:15], 0
s_add_u32 s70, s77, 393216
s_add_u32 m0, s78, 57344
s_and_b32 s70, s70, 0x1fffff
buffer_load_dwordx4 v16, s[16:19], s70 offen offset:0 lds
buffer_load_dwordx4 v17, s[16:19], s70 offen offset:1024 lds
buffer_load_dwordx4 v18, s[16:19], s70 offen offset:2048 lds
buffer_load_dwordx4 v19, s[16:19], s70 offen offset:3072 lds
buffer_load_dword v30, off, s[12:15], 0
s_add_u32 s70, s77, 524288
s_add_u32 m0, s78, 65536
s_and_b32 s70, s70, 0x1fffff
buffer_load_dwordx4 v16, s[16:19], s70 offen offset:0 lds
buffer_load_dwordx4 v17, s[16:19], s70 offen offset:1024 lds
buffer_load_dwordx4 v18, s[16:19], s70 offen offset:2048 lds
buffer_load_dwordx4 v19, s[16:19], s70 offen offset:3072 lds
buffer_load_dword v30, off, s[12:15], 0
s_add_u32 s70, s77, 655360
s_add_u32 m0, s78, 73728
s_and_b32 s70, s70, 0x1fffff
buffer_load_dwordx4 v16, s[16:19], s70 offen offset:0 lds
buffer_load_dwordx4 v17, s[16:19], s70 offen offset:1024 lds
buffer_load_dwordx4 v18, s[16:19], s70 offen offset:2048 lds
buffer_load_dwordx4 v19, s[16:19], s70 offen offset:3072 lds
buffer_load_dword v30, off, s[12:15], 0
s_sub_u32 s70, s59, s58
s_lshl_b32 s71, s70, 7
s_add_u32 s71, s71, s60
s_lshl4_add_u32 s70, s70, s60
s_sub_u32 s70, s70, 16
s_lshl_b32 s66, s71, 7
s_add_u32 s66, s66, 253952
s_lshl_b32 s70, s70, 15
s_lshl_b32 s71, s63, 23
s_add_u32 s70, s70, s71
s_add_u32 s64, s70, 1077248
s_mul_i32 s65, s58, -94208
s_add_u32 s35, s34, 16
lw_8:
ds_read_b32 v5, v1 offset:0
s_waitcnt lgkmcnt(0)
v_cmp_gt_i32 vcc, s35, v5
s_cbranch_vccz lwd_9
s_sleep 1
s_sub_u32 s32, s32, 1
s_cmp_gt_i32 s32, 0
s_cbranch_scc1 lw_8
lwd_9:
s_add_u32 s35, s34, 17
lw_11:
ds_read_b32 v5, v1 offset:0
s_waitcnt lgkmcnt(0)
v_cmp_gt_i32 vcc, s35, v5
s_cbranch_vccz lwd_12
s_sleep 1
s_sub_u32 s32, s32, 1
s_cmp_gt_i32 s32, 0
s_cbranch_scc1 lw_11
lwd_12:
s_cmp_gt_u32 s59, s58
s_cbranch_scc0 nokv_10
poll_13:
buffer_load_dword v6, v1, s[24:27], s66 offen sc1
pchk_14:
s_waitcnt vmcnt(0)
v_cmp_eq_u32 vcc, 0, v6
s_cbranch_vccz pdone_15
s_sub_u32 s32, s32, 1
s_cmp_gt_i32 s32, 0
s_cbranch_scc1 poll_13
pdone_15:
s_cmp_eq_u32 s58, 0
s_cbranch_scc1 kd_16
v_mov_b32 v7, 0
s_add_u32 s35, s34, 17
lw_17:
ds_read_b32 v5, v7 offset:16
s_waitcnt lgkmcnt(0)
v_cmp_gt_i32 vcc, s35, v5
s_cbranch_vccz lwd_18
s_sleep 1
s_sub_u32 s32, s32, 1
s_cmp_gt_i32 s32, 0
s_cbranch_scc1 lw_17
lwd_18:
kd_16:
s_add_u32 m0, s65, 126976
s_nop 0
buffer_load_dwordx4 v20, s[20:23], s64 offen offset:0 sc1 lds
buffer_load_dwordx4 v20, s[20:23], s64 offen offset:1024 sc1 lds
buffer_load_dwordx4 v20, s[20:23], s64 offen offset:2048 sc1 lds
buffer_load_dwordx4 v20, s[20:23], s64 offen offset:3072 sc1 lds
buffer_load_dword v30, off, s[12:15], 0
s_add_u32 m0, s65, 122880
s_sub_u32 s64, s64, 4096
buffer_load_dwordx4 v20, s[20:23], s64 offen offset:0 sc1 lds
buffer_load_dwordx4 v20, s[20:23], s64 offen offset:1024 sc1 lds
buffer_load_dwordx4 v20, s[20:23], s64 offen offset:2048 sc1 lds
buffer_load_dwordx4 v20, s[20:23], s64 offen offset:3072 sc1 lds
buffer_load_dword v30, off, s[12:15], 0
s_add_u32 m0, s65, 118784
s_sub_u32 s64, s64, 4096
buffer_load_dwordx4 v20, s[20:23], s64 offen offset:0 sc1 lds
buffer_load_dwordx4 v20, s[20:23], s64 offen offset:1024 sc1 lds
buffer_load_dwordx4 v20, s[20:23], s64 offen offset:2048 sc1 lds
buffer_load_dwordx4 v20, s[20:23], s64 offen offset:3072 sc1 lds
buffer_load_dword v30, off, s[12:15], 0
s_add_u32 m0, s65, 114688
s_sub_u32 s64, s64, 4096
buffer_load_dwordx4 v20, s[20:23], s64 offen offset:0 sc1 lds
buffer_load_dwordx4 v20, s[20:23], s64 offen offset:1024 sc1 lds
buffer_load_dwordx4 v20, s[20:23], s64 offen offset:2048 sc1 lds
buffer_load_dwordx4 v20, s[20:23], s64 offen offset:3072 sc1 lds
buffer_load_dword v30, off, s[12:15], 0
s_add_u32 m0, s65, 110592
s_sub_u32 s64, s64, 4096
buffer_load_dwordx4 v20, s[20:23], s64 offen offset:0 sc1 lds
buffer_load_dwordx4 v20, s[20:23], s64 offen offset:1024 sc1 lds
buffer_load_dwordx4 v20, s[20:23], s64 offen offset:2048 sc1 lds
buffer_load_dwordx4 v20, s[20:23], s64 offen offset:3072 sc1 lds
buffer_load_dword v30, off, s[12:15], 0
s_add_u32 m0, s65, 106496
s_sub_u32 s64, s64, 4096
buffer_load_dwordx4 v20, s[20:23], s64 offen offset:0 sc1 lds
buffer_load_dwordx4 v20, s[20:23], s64 offen offset:1024 sc1 lds
buffer_load_dwordx4 v20, s[20:23], s64 offen offset:2048 sc1 lds
buffer_load_dwordx4 v20, s[20:23], s64 offen offset:3072 sc1 lds
buffer_load_dword v30, off, s[12:15], 0
s_add_u32 m0, s65, 102400
s_sub_u32 s64, s64, 4096
buffer_load_dwordx4 v20, s[20:23], s64 offen offset:0 sc1 lds
buffer_load_dwordx4 v20, s[20:23], s64 offen offset:1024 sc1 lds
buffer_load_dwordx4 v20, s[20:23], s64 offen offset:2048 sc1 lds
buffer_load_dwordx4 v20, s[20:23], s64 offen offset:3072 sc1 lds
buffer_load_dword v30, off, s[12:15], 0
s_add_u32 m0, s65, 98304
s_sub_u32 s64, s64, 4096
buffer_load_dwordx4 v20, s[20:23], s64 offen offset:0 sc1 lds
buffer_load_dwordx4 v20, s[20:23], s64 offen offset:1024 sc1 lds
buffer_load_dwordx4 v20, s[20:23], s64 offen offset:2048 sc1 lds
buffer_load_dwordx4 v20, s[20:23], s64 offen offset:3072 sc1 lds
buffer_load_dword v30, off, s[12:15], 0
v_add_u32 v5, s34, 17
s_mov_b64 exec, 1
ds_write_b32 v3, v5
s_mov_b64 exec, -1
s_waitcnt vmcnt(30)
v_add_u32 v5, s34, 18
s_mov_b64 exec, 1
ds_write_b32 v3, v5
s_mov_b64 exec, -1
nokv_10:
s_lshl_b32 s66, s61, 14
s_add_u32 s66, s66, 268288
s_waitcnt vmcnt(0)
v_add_u32 v5, s34, 21
s_mov_b64 exec, 1
ds_write_b32 v3, v5
s_mov_b64 exec, -1
s_add_u32 s70, s77, 131072
s_add_u32 m0, s78, 40960
s_and_b32 s70, s70, 0x1fffff
buffer_load_dwordx4 v16, s[16:19], s70 offen offset:0 lds
buffer_load_dwordx4 v17, s[16:19], s70 offen offset:1024 lds
buffer_load_dwordx4 v18, s[16:19], s70 offen offset:2048 lds
buffer_load_dwordx4 v19, s[16:19], s70 offen offset:3072 lds
buffer_load_dword v30, off, s[12:15], 0
s_add_u32 s70, s77, 786432
s_add_u32 m0, s78, 81920
s_and_b32 s70, s70, 0x1fffff
buffer_load_dwordx4 v16, s[16:19], s70 offen offset:0 lds
buffer_load_dwordx4 v17, s[16:19], s70 offen offset:1024 lds
buffer_load_dwordx4 v18, s[16:19], s70 offen offset:2048 lds
buffer_load_dwordx4 v19, s[16:19], s70 offen offset:3072 lds
buffer_load_dword v30, off, s[12:15], 0
s_add_u32 s70, s77, 917504
s_add_u32 m0, s78, 90112
s_and_b32 s70, s70, 0x1fffff
buffer_load_dwordx4 v16, s[16:19], s70 offen offset:0 lds
buffer_load_dwordx4 v17, s[16:19], s70 offen offset:1024 lds
buffer_load_dwordx4 v18, s[16:19], s70 offen offset:2048 lds
buffer_load_dwordx4 v19, s[16:19], s70 offen offset:3072 lds
buffer_load_dword v30, off, s[12:15], 0
s_add_u32 s35, s34, 18
lw_20:
ds_read_b32 v5, v1 offset:0
s_waitcnt lgkmcnt(0)
v_cmp_gt_i32 vcc, s35, v5
s_cbranch_vccz lwd_21
s_sleep 1
s_sub_u32 s32, s32, 1
s_cmp_gt_i32 s32, 0
s_cbranch_scc1 lw_20
lwd_21:
s_add_u32 s70, s77, 1572864
s_add_u32 m0, s78, 131072
s_and_b32 s70, s70, 0x1fffff
buffer_load_dwordx4 v16, s[16:19], s70 offen offset:0 lds
buffer_load_dwordx4 v17, s[16:19], s70 offen offset:1024 lds
buffer_load_dwordx4 v18, s[16:19], s70 offen offset:2048 lds
buffer_load_dwordx4 v19, s[16:19], s70 offen offset:3072 lds
buffer_load_dword v30, off, s[12:15], 0
s_add_u32 s70, s77, 1703936
s_add_u32 m0, s78, 139264
s_and_b32 s70, s70, 0x1fffff
buffer_load_dwordx4 v16, s[16:19], s70 offen offset:0 lds
buffer_load_dwordx4 v17, s[16:19], s70 offen offset:1024 lds
buffer_load_dwordx4 v18, s[16:19], s70 offen offset:2048 lds
buffer_load_dwordx4 v19, s[16:19], s70 offen offset:3072 lds
buffer_load_dword v30, off, s[12:15], 0
s_add_u32 s70, s77, 1835008
s_add_u32 m0, s78, 147456
s_and_b32 s70, s70, 0x1fffff
buffer_load_dwordx4 v16, s[16:19], s70 offen offset:0 lds
buffer_load_dwordx4 v17, s[16:19], s70 offen offset:1024 lds
buffer_load_dwordx4 v18, s[16:19], s70 offen offset:2048 lds
buffer_load_dwordx4 v19, s[16:19], s70 offen offset:3072 lds
buffer_load_dword v30, off, s[12:15], 0
s_add_u32 s70, s77, 1966080
s_add_u32 m0, s78, 155648
s_and_b32 s70, s70, 0x1fffff
buffer_load_dwordx4 v16, s[16:19], s70 offen offset:0 lds
buffer_load_dwordx4 v17, s[16:19], s70 offen offset:1024 lds
buffer_load_dwordx4 v18, s[16:19], s70 offen offset:2048 lds
buffer_load_dwordx4 v19, s[16:19], s70 offen offset:3072 lds
buffer_load_dword v30, off, s[12:15], 0
s_add_u32 s35, s34, 19
lw_22:
ds_read_b32 v5, v1 offset:0
s_waitcnt lgkmcnt(0)
v_cmp_gt_i32 vcc, s35, v5
s_cbranch_vccz lwd_23
s_sleep 2
s_sub_u32 s32, s32, 1
s_cmp_gt_i32 s32, 0
s_cbranch_scc1 lw_22
lwd_23:
s_add_u32 s70, s77, 1048576
s_add_u32 m0, s78, 98304
s_and_b32 s70, s70, 0x1fffff
buffer_load_dwordx4 v16, s[16:19], s70 offen offset:0 lds
buffer_load_dwordx4 v17, s[16:19], s70 offen offset:1024 lds
buffer_load_dwordx4 v18, s[16:19], s70 offen offset:2048 lds
buffer_load_dwordx4 v19, s[16:19], s70 offen offset:3072 lds
buffer_load_dword v30, off, s[12:15], 0
s_add_u32 s70, s77, 1179648
s_add_u32 m0, s78, 106496
s_and_b32 s70, s70, 0x1fffff
buffer_load_dwordx4 v16, s[16:19], s70 offen offset:0 lds
buffer_load_dwordx4 v17, s[16:19], s70 offen offset:1024 lds
buffer_load_dwordx4 v18, s[16:19], s70 offen offset:2048 lds
buffer_load_dwordx4 v19, s[16:19], s70 offen offset:3072 lds
buffer_load_dword v30, off, s[12:15], 0
s_add_u32 s70, s77, 1310720
s_add_u32 m0, s78, 114688
s_and_b32 s70, s70, 0x1fffff
buffer_load_dwordx4 v16, s[16:19], s70 offen offset:0 lds
buffer_load_dwordx4 v17, s[16:19], s70 offen offset:1024 lds
buffer_load_dwordx4 v18, s[16:19], s70 offen offset:2048 lds
buffer_load_dwordx4 v19, s[16:19], s70 offen offset:3072 lds
buffer_load_dword v30, off, s[12:15], 0
s_add_u32 s70, s77, 1441792
s_add_u32 m0, s78, 122880
s_and_b32 s70, s70, 0x1fffff
buffer_load_dwordx4 v16, s[16:19], s70 offen offset:0 lds
buffer_load_dwordx4 v17, s[16:19], s70 offen offset:1024 lds
buffer_load_dwordx4 v18, s[16:19], s70 offen offset:2048 lds
buffer_load_dwordx4 v19, s[16:19], s70 offen offset:3072 lds
buffer_load_dword v30, off, s[12:15], 0
s_add_u32 s35, s34, 20
lw_24:
ds_read_b32 v5, v1 offset:0
s_waitcnt lgkmcnt(0)
v_cmp_gt_i32 vcc, s35, v5
s_cbranch_vccz lwd_25
s_sleep 2
s_sub_u32 s32, s32, 1
s_cmp_gt_i32 s32, 0
s_cbranch_scc1 lw_24
lwd_25:
s_add_u32 s70, s77, 0
s_add_u32 m0, s78, 32768
s_and_b32 s70, s70, 0x1fffff
buffer_load_dwordx4 v16, s[16:19], s70 offen offset:0 lds
buffer_load_dwordx4 v17, s[16:19], s70 offen offset:1024 lds
buffer_load_dwordx4 v18, s[16:19], s70 offen offset:2048 lds
buffer_load_dwordx4 v19, s[16:19], s70 offen offset:3072 lds
buffer_load_dword v30, off, s[12:15], 0
s_cmp_eq_u32 s58, 0
s_cbranch_scc0 nofo_19
s_add_u32 s35, s34, 21
lw_26:
ds_read_b32 v5, v1 offset:0
s_waitcnt lgkmcnt(0)
v_cmp_gt_i32 vcc, s35, v5
s_cbranch_vccz lwd_27
s_sleep 1
s_sub_u32 s32, s32, 1
s_cmp_gt_i32 s32, 0
s_cbranch_scc1 lw_26
lwd_27:
poll_28:
buffer_load_dword v6, v21, s[24:27], s66 offen sc1
pchk_29:
s_waitcnt vmcnt(0)
v_cmp_eq_u32 vcc, 0, v6
s_cbranch_vccz pdone_30
s_sub_u32 s32, s32, 1
s_cmp_gt_i32 s32, 0
s_cbranch_scc1 poll_28
pdone_30:
nofo_19:
s_waitcnt vmcnt(0)
v_add_u32 v5, s34, 22
s_mov_b64 exec, 1
ds_write_b32 v3, v5
s_mov_b64 exec, -1
s_cmp_eq_u32 s63, 0
s_cbranch_scc0 L_end
v_bfe_u32 v6, v0, 3, 2
v_and_b32 v7, 2, v6
v_xor_b32 v7, v7, v22
v_lshrrev_b32 v23, 5, v0
v_lshl_add_u32 v6, v23, 4, v6
v_mul_u32_u24 v6, 6144, v6
v_lshl_add_u32 v12, v7, 4, v6
v_xor_b32 v6, 64, v12
v_add_u32 v13, 23552, v6
v_add_u32 v14, 47104, v12
v_add_u32 v15, 70656, v6
v_mov_b32 v8, v20
v_mov_b32 v9, v20
v_mov_b32 v10, v20
v_mov_b32 v11, v20
s_mov_b32 s8, s56
s_mov_b32 s9, s57
s_mov_b32 s10, 0x2500000
s_mov_b32 s11, 0x00020000
s_lshl_b32 s70, s59, 18
s_add_u32 s70, s70, 26214400
s_add_u32 s68, s70, s78
s_sub_u32 s69, s70, s78
s_add_u32 s69, s69, 12288
s_mov_b32 s67, 16384
s_lshl_b32 s66, s59, 14
s_add_u32 s66, s66, 274432
s_and_b32 s79, s59, 1
s_mul_i32 s79, s79, 1
s_mul_i32 s70, s60, 1
s_and_b32 s71, s59, 14
s_add_u32 s70, s70, s71
s_and_b32 s70, s70, 15
s_xor_b32 s64, s70, s79
s_mov_b32 s65, 86016
s_add_u32 s35, s34, 22
lw_31:
ds_read_b32 v5, v1 offset:0
s_waitcnt lgkmcnt(0)
v_cmp_gt_i32 vcc, s35, v5
s_cbranch_vccz lwd_32
s_sleep 2
s_sub_u32 s32, s32, 1
s_cmp_gt_i32 s32, 0
s_cbranch_scc1 lw_31
lwd_32:
s_mul_i32 s70, s64, 393216
s_add_u32 m0, s65, s76
s_add_u32 s71, s70, s72
buffer_load_dwordx4 v12, s[12:15], s71 offen offset:0 lds
buffer_load_dwordx4 v13, s[12:15], s71 offen offset:1024 lds
buffer_load_dwordx4 v14, s[12:15], s71 offen offset:2048 lds
buffer_load_dwordx4 v15, s[12:15], s71 offen offset:3072 lds
buffer_load_dword v30, off, s[12:15], 0
s_add_u32 m0, m0, 4096
s_add_u32 s71, s70, s73
buffer_load_dwordx4 v12, s[12:15], s71 offen offset:0 lds
buffer_load_dwordx4 v13, s[12:15], s71 offen offset:1024 lds
buffer_load_dwordx4 v14, s[12:15], s71 offen offset:2048 lds
buffer_load_dwordx4 v15, s[12:15], s71 offen offset:3072 lds
buffer_load_dword v30, off, s[12:15], 0
s_add_u32 m0, m0, 4096
s_add_u32 s71, s70, s74
buffer_load_dwordx4 v12, s[12:15], s71 offen offset:0 lds
buffer_load_dwordx4 v13, s[12:15], s71 offen offset:1024 lds
buffer_load_dwordx4 v14, s[12:15], s71 offen offset:2048 lds
buffer_load_dwordx4 v15, s[12:15], s71 offen offset:3072 lds
buffer_load_dword v30, off, s[12:15], 0
s_and_b32 s79, s59, 1
s_mul_i32 s79, s79, 1
s_mul_i32 s70, s60, 1
s_and_b32 s71, s59, 14
s_add_u32 s70, s70, s71
s_and_b32 s70, s70, 15
s_xor_b32 s64, s70, s79
s_mov_b32 s65, 86016
s_add_u32 s35, s34, 23
lw_33:
ds_read_b32 v5, v1 offset:0
s_waitcnt lgkmcnt(0)
v_cmp_gt_i32 vcc, s35, v5
s_cbranch_vccz lwd_34
s_sleep 1
s_sub_u32 s32, s32, 1
s_cmp_gt_i32 s32, 0
s_cbranch_scc1 lw_33
lwd_34:
poll_35:
buffer_load_dword v6, v21, s[24:27], s66 offen sc1
pchk_36:
s_waitcnt vmcnt(0)
v_cmp_eq_u32 vcc, 0, v6
s_cbranch_vccz pdone_37
s_sub_u32 s32, s32, 1
s_cmp_gt_i32 s32, 0
s_cbranch_scc1 poll_35
pdone_37:
s_mul_i32 s70, s64, s67
s_add_u32 m0, s65, s75
s_add_u32 s71, s70, s68
buffer_load_dwordx4 v8, s[8:11], s71 offen offset:0 sc1 lds
buffer_load_dwordx4 v9, s[8:11], s71 offen offset:1024 sc1 lds
buffer_load_dwordx4 v10, s[8:11], s71 offen offset:2048 sc1 lds
buffer_load_dwordx4 v11, s[8:11], s71 offen offset:3072 sc1 lds
buffer_load_dword v30, off, s[12:15], 0
s_add_u32 m0, m0, 4096
s_add_u32 s71, s70, s69
buffer_load_dwordx4 v8, s[8:11], s71 offen offset:0 sc1 lds
buffer_load_dwordx4 v9, s[8:11], s71 offen offset:1024 sc1 lds
buffer_load_dwordx4 v10, s[8:11], s71 offen offset:2048 sc1 lds
buffer_load_dwordx4 v11, s[8:11], s71 offen offset:3072 sc1 lds
buffer_load_dword v30, off, s[12:15], 0
s_xor_b32 s64, s64, s79
s_add_u32 s64, s64, 1
s_and_b32 s64, s64, 15
s_xor_b32 s64, s64, s79
s_sub_u32 s65, s65, 40960
s_cselect_b32 s65, 86016, s65
s_mul_i32 s70, s64, s67
s_add_u32 m0, s65, s75
s_add_u32 s71, s70, s68
buffer_load_dwordx4 v8, s[8:11], s71 offen offset:0 sc1 lds
buffer_load_dwordx4 v9, s[8:11], s71 offen offset:1024 sc1 lds
buffer_load_dwordx4 v10, s[8:11], s71 offen offset:2048 sc1 lds
buffer_load_dwordx4 v11, s[8:11], s71 offen offset:3072 sc1 lds
buffer_load_dword v30, off, s[12:15], 0
s_add_u32 m0, m0, 4096
s_add_u32 s71, s70, s69
buffer_load_dwordx4 v8, s[8:11], s71 offen offset:0 sc1 lds
buffer_load_dwordx4 v9, s[8:11], s71 offen offset:1024 sc1 lds
buffer_load_dwordx4 v10, s[8:11], s71 offen offset:2048 sc1 lds
buffer_load_dwordx4 v11, s[8:11], s71 offen offset:3072 sc1 lds
buffer_load_dword v30, off, s[12:15], 0
s_mul_i32 s70, s64, 393216
s_add_u32 m0, s65, s76
s_add_u32 s71, s70, s72
buffer_load_dwordx4 v12, s[12:15], s71 offen offset:0 lds
buffer_load_dwordx4 v13, s[12:15], s71 offen offset:1024 lds
buffer_load_dwordx4 v14, s[12:15], s71 offen offset:2048 lds
buffer_load_dwordx4 v15, s[12:15], s71 offen offset:3072 lds
buffer_load_dword v30, off, s[12:15], 0
s_add_u32 m0, m0, 4096
s_add_u32 s71, s70, s73
buffer_load_dwordx4 v12, s[12:15], s71 offen offset:0 lds
buffer_load_dwordx4 v13, s[12:15], s71 offen offset:1024 lds
buffer_load_dwordx4 v14, s[12:15], s71 offen offset:2048 lds
buffer_load_dwordx4 v15, s[12:15], s71 offen offset:3072 lds
buffer_load_dword v30, off, s[12:15], 0
s_add_u32 m0, m0, 4096
s_add_u32 s71, s70, s74
buffer_load_dwordx4 v12, s[12:15], s71 offen offset:0 lds
buffer_load_dwordx4 v13, s[12:15], s71 offen offset:1024 lds
buffer_load_dwordx4 v14, s[12:15], s71 offen offset:2048 lds
buffer_load_dwordx4 v15, s[12:15], s71 offen offset:3072 lds
buffer_load_dword v30, off, s[12:15], 0
s_xor_b32 s64, s64, s79
s_add_u32 s64, s64, 1
s_and_b32 s64, s64, 15
s_xor_b32 s64, s64, s79
s_sub_u32 s65, s65, 40960
s_cselect_b32 s65, 86016, s65
s_mul_i32 s70, s64, s67
s_add_u32 m0, s65, s75
s_add_u32 s71, s70, s68
buffer_load_dwordx4 v8, s[8:11], s71 offen offset:0 sc1 lds
buffer_load_dwordx4 v9, s[8:11], s71 offen offset:1024 sc1 lds
buffer_load_dwordx4 v10, s[8:11], s71 offen offset:2048 sc1 lds
buffer_load_dwordx4 v11, s[8:11], s71 offen offset:3072 sc1 lds
buffer_load_dword v30, off, s[12:15], 0
s_add_u32 m0, m0, 4096
s_add_u32 s71, s70, s69
buffer_load_dwordx4 v8, s[8:11], s71 offen offset:0 sc1 lds
buffer_load_dwordx4 v9, s[8:11], s71 offen offset:1024 sc1 lds
buffer_load_dwordx4 v10, s[8:11], s71 offen offset:2048 sc1 lds
buffer_load_dwordx4 v11, s[8:11], s71 offen offset:3072 sc1 lds
buffer_load_dword v30, off, s[12:15], 0
s_mul_i32 s70, s64, 393216
s_add_u32 m0, s65, s76
s_add_u32 s71, s70, s72
buffer_load_dwordx4 v12, s[12:15], s71 offen offset:0 lds
buffer_load_dwordx4 v13, s[12:15], s71 offen offset:1024 lds
buffer_load_dwordx4 v14, s[12:15], s71 offen offset:2048 lds
buffer_load_dwordx4 v15, s[12:15], s71 offen offset:3072 lds
buffer_load_dword v30, off, s[12:15], 0
s_add_u32 m0, m0, 4096
s_add_u32 s71, s70, s73
buffer_load_dwordx4 v12, s[12:15], s71 offen offset:0 lds
buffer_load_dwordx4 v13, s[12:15], s71 offen offset:1024 lds
buffer_load_dwordx4 v14, s[12:15], s71 offen offset:2048 lds
buffer_load_dwordx4 v15, s[12:15], s71 offen offset:3072 lds
buffer_load_dword v30, off, s[12:15], 0
s_add_u32 m0, m0, 4096
s_add_u32 s71, s70, s74
buffer_load_dwordx4 v12, s[12:15], s71 offen offset:0 lds
buffer_load_dwordx4 v13, s[12:15], s71 offen offset:1024 lds
buffer_load_dwordx4 v14, s[12:15], s71 offen offset:2048 lds
buffer_load_dwordx4 v15, s[12:15], s71 offen offset:3072 lds
buffer_load_dword v30, off, s[12:15], 0
s_xor_b32 s64, s64, s79
s_add_u32 s64, s64, 1
s_and_b32 s64, s64, 15
s_xor_b32 s64, s64, s79
s_sub_u32 s65, s65, 40960
s_cselect_b32 s65, 86016, s65
s_waitcnt vmcnt(50)
v_add_u32 v5, s34, 33
s_mov_b64 exec, 1
ds_write_b32 v3, v5
s_mov_b64 exec, -1
s_mov_b32 s36, s64
s_mov_b32 s37, s65
s_mov_b32 s64, s59
s_mov_b32 s65, 114688
s_mul_i32 s70, s64, 393216
s_add_u32 m0, s65, s76
s_add_u32 s71, s70, s72
buffer_load_dwordx4 v12, s[12:15], s71 offen offset:0 lds
buffer_load_dwordx4 v13, s[12:15], s71 offen offset:1024 lds
buffer_load_dwordx4 v14, s[12:15], s71 offen offset:2048 lds
buffer_load_dwordx4 v15, s[12:15], s71 offen offset:3072 lds
buffer_load_dword v30, off, s[12:15], 0
s_add_u32 m0, m0, 4096
s_add_u32 s71, s70, s73
buffer_load_dwordx4 v12, s[12:15], s71 offen offset:0 lds
buffer_load_dwordx4 v13, s[12:15], s71 offen offset:1024 lds
buffer_load_dwordx4 v14, s[12:15], s71 offen offset:2048 lds
buffer_load_dwordx4 v15, s[12:15], s71 offen offset:3072 lds
buffer_load_dword v30, off, s[12:15], 0
s_add_u32 m0, m0, 4096
s_add_u32 s71, s70, s74
buffer_load_dwordx4 v12, s[12:15], s71 offen offset:0 lds
buffer_load_dwordx4 v13, s[12:15], s71 offen offset:1024 lds
buffer_load_dwordx4 v14, s[12:15], s71 offen offset:2048 lds
buffer_load_dwordx4 v15, s[12:15], s71 offen offset:3072 lds
buffer_load_dword v30, off, s[12:15], 0
s_mov_b32 s64, s36
s_mov_b32 s65, s37
s_waitcnt vmcnt(40)
v_add_u32 v5, s34, 34
s_mov_b64 exec, 1
ds_write_b32 v3, v5
s_mov_b64 exec, -1
s_mov_b32 s63, 1
s_mov_b32 s34, 32
s_add_u32 s24, s24, 1409024
s_addc_u32 s25, s25, 0
s_mov_b32 s26, 1409024
s_mov_b32 s66, 32
s_branch lq_1
lcs_2:
s_add_u32 s35, s34, 1
lw_38:
ds_read_b32 v5, v2 offset:24
s_waitcnt lgkmcnt(0)
v_cmp_gt_i32 vcc, s35, v5
s_cbranch_vccz lwd_39
s_sub_u32 s32, s32, 1
s_cmp_gt_i32 s32, 0
s_cbranch_scc1 lw_38
lwd_39:
s_branch lcb_3
L_f:
v_lshlrev_b32 v4, 4, v0
s_lshl4_add_u32 s78, s59, s60
v_mov_b32 v252, 0
v_mov_b32 v253, 0
v_mov_b32 v254, 0
v_mov_b32 v255, 0
s_lshl_b32 s35, s78, 10
s_cmp_eq_u32 s58, 0
s_cselect_b64 exec, -1, 0
buffer_store_dwordx4 v[252:255], v4, s[24:27], s35 offen offset:0 sc1
s_add_u32 s35, s35, 262144
buffer_store_dwordx4 v[252:255], v4, s[24:27], s35 offen offset:0 sc1
s_mov_b64 exec, -1
s_setprio 3
v_and_b32 v1, 3, v0
v_lshlrev_b32 v1, 2, v1
v_and_b32 v2, 4, v1
s_lshl2_add_u32 s35, s58, 24
v_mov_b32 v3, s35
s_mov_b32 s4, s54
s_mov_b32 s5, s55
s_mov_b32 s6, 0x100
s_mov_b32 s7, 0x00020000
s_add_u32 s70, s60, 4
s_lshr_b32 s70, s70, 3
s_sub_u32 s70, s60, s70
s_lshl4_add_u32 s64, s70, s59
s_and_b32 s70, s60, 7
s_cmp_eq_u32 s70, 3
s_cselect_b32 s65, 1, 0
s_mov_b32 s69, 0x3f803f80
s_barrier
s_cmp_eq_u32 s58, 0
s_cselect_b32 s16, s46, s48
s_cselect_b32 s17, s47, s49
s_mov_b32 s12, s50
s_mov_b32 s13, s51
s_mov_b32 s14, 0x0
s_mov_b32 s15, 0x00020000
s_cmp_eq_u32 s65, 0
s_cselect_b32 s18, 7340032, 0
s_mov_b32 s14, s18
s_lshr_b32 s70, s64, 3
s_and_b32 s71, s64, 7
s_lshl_b32 s66, s70, 10
s_add_u32 s66, s66, s71
s_lshl1_add_u32 s66, s66, s58
s_lshl_b32 s66, s66, 7
s_mul_i32 s71, s71, 917504
s_lshl_b32 s70, s70, 8
s_add_u32 s77, s71, s70
s_mov_b32 s48, s38
s_mov_b32 s49, s39
s_mov_b32 s50, 0x600000
s_mov_b32 s51, 0x00020000
s_mov_b32 s52, 0
s_and_b32 s54, s60, 8
s_add_u32 s54, s54, 3
s_add_u32 s53, s54, s59
s_and_b32 s55, s60, 7
s_lshl1_add_u32 s55, s55, s58
s_mul_i32 s55, s55, 24576
s_lshl_b32 s54, s54, 7
s_add_u32 s56, s54, s55
s_add_u32 s56, s56, 60
s_and_b32 s73, s2, 3
s_lshl_b32 s73, s73, 6
v_mov_b32 v14, 1
s_sub_u32 exec_lo, 1, s58
s_mov_b32 exec_hi, 0
s_waitcnt vmcnt(0)
buffer_atomic_add v14, off, s[4:7], s73 sc1
s_mov_b64 exec, -1
v_mov_b32 v8, s69
v_mov_b32 v9, s69
v_mov_b32 v10, s69
v_mov_b32 v11, s69
v_mov_b32 v12, s69
v_mov_b32 v13, s69
v_mov_b32 v14, s69
v_mov_b32 v15, s69
s_mov_b32 s70, 102400
ftop_42:
v_lshrrev_b32 v6, 4, v0
v_bfe_u32 v7, v0, 2, 2
v_lshl_add_u32 v6, v6, 3, v7
v_bfe_u32 v7, v0, 3, 2
s_lshl_b32 s71, s58, 1
v_xor_b32 v7, s71, v7
v_lshl_add_u32 v7, v7, 5, s70
v_lshl_add_u32 v6, v6, 7, v7
v_lshl_add_u32 v6, v1, 1, v6
v_xor_b32 v7, 32, v6
s_mul_i32 s71, s63, 34
s_add_u32 s35, s71, 1
lw_43:
ds_read_b32 v5, v2 offset:16
s_waitcnt lgkmcnt(0)
v_cmp_gt_i32 vcc, s35, v5
s_cbranch_vccz lwd_44
s_sleep 1
s_sub_u32 s32, s32, 1
s_cmp_gt_i32 s32, 0
s_cbranch_scc1 lw_43
lwd_44:
ds_read_b64_tr_b16 v[24:25], v6 offset:0
ds_read_b64_tr_b16 v[26:27], v6 offset:512
ds_read_b64_tr_b16 v[28:29], v6 offset:4096
ds_read_b64_tr_b16 v[30:31], v6 offset:4608
ds_read_b64_tr_b16 v[32:33], v7 offset:0
ds_read_b64_tr_b16 v[34:35], v7 offset:512
ds_read_b64_tr_b16 v[36:37], v7 offset:4096
ds_read_b64_tr_b16 v[38:39], v7 offset:4608
ds_read_b64_tr_b16 v[40:41], v6 offset:8192
ds_read_b64_tr_b16 v[42:43], v6 offset:8704
ds_read_b64_tr_b16 v[44:45], v6 offset:12288
ds_read_b64_tr_b16 v[46:47], v6 offset:12800
ds_read_b64_tr_b16 v[48:49], v7 offset:8192
ds_read_b64_tr_b16 v[50:51], v7 offset:8704
ds_read_b64_tr_b16 v[52:53], v7 offset:12288
ds_read_b64_tr_b16 v[54:55], v7 offset:12800
s_lshl_b32 s72, s60, 14
s_lshl_b32 s70, s58, 9
s_add_u32 s72, s72, s70
s_lshl_b32 s70, s59, 10
s_add_u32 s71, s72, s70
s_lshl_b32 s76, s59, 14
s_add_u32 s73, s76, 30686208
s_add_u32 s76, s76, 266240
s_waitcnt lgkmcnt(14)
v_mfma_f32_16x16x32_bf16 v[248:251], v[8:11], v[24:27], 0
s_waitcnt lgkmcnt(10)
v_mfma_f32_16x16x32_bf16 v[252:255], v[8:11], v[32:35], 0
v_mfma_f32_16x16x32_bf16 v[248:251], v[12:15], v[28:31], v[248:251]
s_waitcnt lgkmcnt(8)
v_mfma_f32_16x16x32_bf16 v[252:255], v[12:15], v[36:39], v[252:255]
ds_read_b64_tr_b16 v[24:25], v6 offset:16384
ds_read_b64_tr_b16 v[26:27], v6 offset:16896
ds_read_b64_tr_b16 v[28:29], v6 offset:20480
ds_read_b64_tr_b16 v[30:31], v6 offset:20992
ds_read_b64_tr_b16 v[32:33], v7 offset:16384
ds_read_b64_tr_b16 v[34:35], v7 offset:16896
ds_read_b64_tr_b16 v[36:37], v7 offset:20480
ds_read_b64_tr_b16 v[38:39], v7 offset:20992
v_add_u32 v5, s34, 1
s_mov_b64 exec, 1
ds_write_b32 v3, v5
s_mov_b64 exec, -1
s_waitcnt lgkmcnt(14)
v_mfma_f32_16x16x32_bf16 v[16:19], v[8:11], v[40:43], 0
s_waitcnt lgkmcnt(11)
v_mfma_f32_16x16x32_bf16 v[20:23], v[8:11], v[48:51], 0
v_mfma_f32_16x16x32_bf16 v[16:19], v[12:15], v[44:47], v[16:19]
s_waitcnt lgkmcnt(9)
v_mfma_f32_16x16x32_bf16 v[20:23], v[12:15], v[52:55], v[20:23]
v_mov_b32 v249, v252
v_mov_b32 v252, s69
v_mov_b32 v253, s69
v_mov_b32 v254, s69
v_mov_b32 v255, s69
v_mfma_f32_16x16x32_bf16 v[52:55], v[8:11], v[8:11], 0
s_nop 0
v_mfma_f32_16x16x32_bf16 v[48:51], v[8:11], v[252:255], 0
v_mfma_f32_16x16x32_bf16 v[52:55], v[12:15], v[12:15], v[52:55]
v_mfma_f32_16x16x32_bf16 v[48:51], v[12:15], v[252:255], v[48:51]
s_waitcnt lgkmcnt(7)
v_mfma_f32_16x16x32_bf16 v[40:43], v[8:11], v[24:27], 0
s_waitcnt lgkmcnt(3)
v_mfma_f32_16x16x32_bf16 v[44:47], v[8:11], v[32:35], 0
v_mfma_f32_16x16x32_bf16 v[40:43], v[12:15], v[28:31], v[40:43]
s_waitcnt lgkmcnt(1)
v_mfma_f32_16x16x32_bf16 v[44:47], v[12:15], v[36:39], v[44:47]
v_lshlrev_b32 v6, 3, v0
v_and_b32 v7, 48, v0
v_mov_b32_dpp v248, v16 quad_perm:[0,1,2,3] row_mask:0x2 bank_mask:0xf
v_mov_b32_dpp v249, v20 quad_perm:[0,1,2,3] row_mask:0x2 bank_mask:0xf
s_nop 0
v_mov_b32_dpp v248, v48 quad_perm:[0,1,2,3] row_mask:0x8 bank_mask:0xf
v_mov_b32_dpp v249, v52 quad_perm:[0,1,2,3] row_mask:0x8 bank_mask:0xf
s_nop 0
v_mov_b32_dpp v248, v40 quad_perm:[0,1,2,3] row_mask:0x4 bank_mask:0xf
v_mov_b32_dpp v249, v44 quad_perm:[0,1,2,3] row_mask:0x4 bank_mask:0xf
v_max_u32 v248, 1, v248
v_max_u32 v249, 1, v249
s_cmp_eq_u32 s63, 0
s_cbranch_scc1 fst_40
fsb_41:
buffer_store_dwordx2 v[248:249], v6, s[24:27], s71 offen sc1
s_lshl4_add_u32 s70, s58, s60
s_add_u32 s70, s70, s34
s_cmp_eq_u32 s70, 51
s_cbranch_scc1 fxt_45
fxb_46:
s_add_u32 s73, s72, 4096
s_add_u32 s74, s72, 8192
s_add_u32 s75, s72, 12288
v_lshrrev_b32 v7, 2, v0
v_lshlrev_b32 v7, 7, v7
v_lshl_add_u32 v7, v1, 2, v7
v_lshrrev_b32 v8, 5, v0
v_lshrrev_b32 v9, 4, v0
v_xor_b32 v10, v8, v9
v_and_b32 v10, 1, v10
v_lshl_add_u32 v8, v10, 1, v8
v_and_b32 v10, 15, v0
v_lshlrev_b32 v8, 7, v8
v_lshl_add_u32 v8, v10, 3, v8
v_add_u32 v8, 1280, v8
s_mul_i32 s70, s58, 384
s_lshl_b32 s71, s63, 10
s_add_u32 s70, s70, s71
s_add_u32 s70, s70, 2304
v_lshl_add_u32 v9, v9, 7, s70
v_lshl_add_u32 v9, v10, 2, v9
s_cmp_eq_u32 s63, 0
s_cbranch_scc1 fg_47
fg_48:
poll_49:
buffer_load_dwordx4 v[12:15], v7, s[24:27], s76 offen sc1
pchk_50:
s_waitcnt vmcnt(0)
v_min3_u32 v10, v12, v13, v14
v_min_u32 v10, v10, v15
v_cmp_eq_u32 vcc, 0, v10
s_cbranch_vccz pdone_51
s_sub_u32 s32, s32, 1
s_cmp_gt_i32 s32, 0
s_cbranch_scc1 poll_49
pdone_51:
s_lshr_b32 s70, s33, 7
s_sub_u32 s70, s70, s59
s_mul_i32 s70, s70, s63
s_cmp_eq_u32 s70, 0
s_cbranch_scc0 fng_52
s_lshl1_add_u32 s70, s34, -32
s_add_u32 s35, s70, 15
lw_53:
ds_read_b32 v5, v2 offset:16
s_waitcnt lgkmcnt(0)
v_cmp_gt_i32 vcc, s35, v5
s_cbranch_vccz lwd_54
s_sleep 4
s_sub_u32 s32, s32, 1
s_cmp_gt_i32 s32, 0
s_cbranch_scc1 lw_53
lwd_54:
poll_55:
buffer_load_dwordx2 v[24:25], v6, s[24:27], s72 offen offset:0 sc1
buffer_load_dwordx2 v[26:27], v6, s[24:27], s72 offen offset:1024 sc1
buffer_load_dwordx2 v[28:29], v6, s[24:27], s72 offen offset:2048 sc1
buffer_load_dwordx2 v[30:31], v6, s[24:27], s72 offen offset:3072 sc1
buffer_load_dwordx2 v[32:33], v6, s[24:27], s73 offen offset:0 sc1
buffer_load_dwordx2 v[34:35], v6, s[24:27], s73 offen offset:1024 sc1
buffer_load_dwordx2 v[36:37], v6, s[24:27], s73 offen offset:2048 sc1
buffer_load_dwordx2 v[38:39], v6, s[24:27], s73 offen offset:3072 sc1
buffer_load_dwordx2 v[40:41], v6, s[24:27], s74 offen offset:0 sc1
buffer_load_dwordx2 v[42:43], v6, s[24:27], s74 offen offset:1024 sc1
buffer_load_dwordx2 v[44:45], v6, s[24:27], s74 offen offset:2048 sc1
buffer_load_dwordx2 v[46:47], v6, s[24:27], s74 offen offset:3072 sc1
buffer_load_dwordx2 v[48:49], v6, s[24:27], s75 offen offset:0 sc1
buffer_load_dwordx2 v[50:51], v6, s[24:27], s75 offen offset:1024 sc1
buffer_load_dwordx2 v[52:53], v6, s[24:27], s75 offen offset:2048 sc1
buffer_load_dwordx2 v[54:55], v6, s[24:27], s75 offen offset:3072 sc1
pchk_56:
s_waitcnt vmcnt(14)
v_min3_u32 v10, v24, v25, v26
s_waitcnt vmcnt(13)
v_min3_u32 v10, v10, v27, v28
s_waitcnt vmcnt(12)
v_min3_u32 v10, v10, v29, v30
s_waitcnt vmcnt(11)
v_min3_u32 v10, v10, v31, v32
s_waitcnt vmcnt(10)
v_min3_u32 v10, v10, v33, v34
s_waitcnt vmcnt(9)
v_min3_u32 v10, v10, v35, v36
s_waitcnt vmcnt(8)
v_min3_u32 v10, v10, v37, v38
s_waitcnt vmcnt(7)
v_min3_u32 v10, v10, v39, v40
s_waitcnt vmcnt(6)
v_min3_u32 v10, v10, v41, v42
s_waitcnt vmcnt(5)
v_min3_u32 v10, v10, v43, v44
s_waitcnt vmcnt(4)
v_min3_u32 v10, v10, v45, v46
s_waitcnt vmcnt(3)
v_min3_u32 v10, v10, v47, v48
s_waitcnt vmcnt(2)
v_min3_u32 v10, v10, v49, v50
s_waitcnt vmcnt(1)
v_min3_u32 v10, v10, v51, v52
s_waitcnt vmcnt(0)
v_min3_u32 v10, v10, v53, v54
v_min_u32 v10, v10, v55
v_cmp_eq_u32 vcc, 0, v10
s_cbranch_vccz pdone_57
s_sub_u32 s32, s32, 1
s_cmp_gt_i32 s32, 0
s_cbranch_scc1 poll_55
pdone_57:
v_add_f32 v24, v24, v40
v_add_f32 v25, v25, v41
v_add_f32 v26, v26, v42
v_add_f32 v27, v27, v43
v_add_f32 v28, v28, v44
v_add_f32 v29, v29, v45
v_add_f32 v30, v30, v46
v_add_f32 v31, v31, v47
v_add_f32 v32, v32, v48
v_add_f32 v33, v33, v49
v_add_f32 v34, v34, v50
v_add_f32 v35, v35, v51
v_add_f32 v36, v36, v52
v_add_f32 v37, v37, v53
v_add_f32 v38, v38, v54
v_add_f32 v39, v39, v55
v_add_f32 v24, v24, v32
v_add_f32 v25, v25, v33
v_add_f32 v26, v26, v34
v_add_f32 v27, v27, v35
v_add_f32 v28, v28, v36
v_add_f32 v29, v29, v37
v_add_f32 v30, v30, v38
v_add_f32 v31, v31, v39
v_add_f32 v24, v24, v28
v_add_f32 v25, v25, v29
v_add_f32 v26, v26, v30
v_add_f32 v27, v27, v31
v_add_f32 v24, v24, v26
v_add_f32 v25, v25, v27
s_mov_b32 exec_hi, 0xffff
ds_write2_b32 v9, v24, v25 offset1:16
s_mov_b32 exec_hi, -1
v_mul_f32 v5, 0xba800000, v24
v_mul_f32 v25, 0x3a800000, v25
v_fma_f32 v25, -v5, v5, v25
v_max_f32 v25, 0, v25
v_add_f32 v25, 0x3727c5ac, v25
v_rsq_f32 v24, v25
s_nop 0
v_mul_f32 v25, v5, v24
s_lshl_b32 s70, s59, 7
s_sub_u32 s70, s33, s70
v_lshlrev_b32 v10, 1, v0
v_sub_u32 v10, s70, v10
v_readlane_b32 s70, v24, 48
v_readlane_b32 s71, v25, 48
v_cmp_eq_u32 vcc, 0, v10
s_mov_b64 exec, vcc
v_mov_b32 v12, s70
v_mov_b32 v13, s71
s_mov_b64 exec, -1
v_cmp_eq_u32 vcc, 1, v10
s_mov_b64 exec, vcc
v_mov_b32 v14, s70
v_mov_b32 v15, s71
s_mov_b64 exec, -1
fng_52:
ds_write2_b32 v8, v12, v14 offset1:1
ds_write2_b32 v8, v13, v15 offset0:128 offset1:129
s_add_u32 s71, s34, s63
v_add_u32 v5, s71, 2
s_mov_b64 exec, 1
ds_write_b32 v3, v5
s_mov_b64 exec, -1
s_setprio 0
s_cmp_eq_u32 s63, 0
s_cbranch_scc1 fnw_58
fnw_59:
s_and_b32 s70, s64, 7
s_lshl_b32 s70, s70, 7
s_add_u32 s73, s70, 276480
s_lshl1_add_u32 s72, s70, 272384
s_lshr_b32 s71, s64, 3
s_lshl_b32 s76, s71, 13
s_add_u32 s76, s76, 1048576
s_lshl2_add_u32 s74, s70, s76
s_lshl_b32 s70, s58, 8
s_add_u32 s74, s74, s70
s_add_u32 s75, s74, 4096
s_lshl4_add_u32 s76, s70, s76
v_and_b32 v251, 15, v0
v_lshlrev_b32 v6, 14, v251
v_lshrrev_b32 v252, 4, v0
v_lshl_add_u32 v7, v252, 5, v6
v_lshlrev_b32 v251, 4, v251
s_lshl_b32 s70, s58, 3
v_lshl_add_u32 v253, v252, 1, s70
v_add_u32 v253, v253, v251
v_lshlrev_b32 v254, 5, v252
v_lshl_add_u32 v254, v2, 2, v254
v_and_b32 v255, 7, v0
v_lshl_add_u32 v255, v255, 2, v252
v_lshlrev_b32 v255, 3, v255
s_add_u32 s35, s34, 22
lw_60:
ds_read_b32 v5, v1 offset:0
s_waitcnt lgkmcnt(0)
v_cmp_gt_i32 vcc, s35, v5
s_cbranch_vccz lwd_61
s_sleep 4
s_sub_u32 s32, s32, 1
s_cmp_gt_i32 s32, 0
s_cbranch_scc1 lw_60
lwd_61:
s_setprio 3
s_add_u32 s35, s34, 24
lw_62:
ds_read_b32 v5, v1 offset:0
s_waitcnt lgkmcnt(0)
v_cmp_gt_i32 vcc, s35, v5
s_cbranch_vccz lwd_63
s_sleep 2
s_sub_u32 s32, s32, 1
s_cmp_gt_i32 s32, 0
s_cbranch_scc1 lw_62
lwd_63:
s_mul_i32 s79, s63, 64
s_sub_u32 s79, 32, s79
s_add_u32 s35, s79, 3
tw_64:
ds_read_b32 v5, v2 offset:16
s_waitcnt lgkmcnt(0)
v_cmp_gt_i32 vcc, s35, v5
s_cbranch_vccz twd_65
v_readfirstlane_b32 s54, v5
s_sub_u32 s55, s35, s54
s_cmp_lt_i32 s55, 2
s_cbranch_scc1 tws_66
s_add_u32 s54, s54, 2
s_or_b32 s54, s54, 1
s_cmp_eq_u32 s54, s52
s_cbranch_scc1 tws_66
s_bitcmp1_b32 s54, 4
s_cbranch_scc1 tws_66
s_mov_b32 s52, s54
s_add_u32 s54, s54, s53
s_and_b32 s54, s54, 15
s_mul_i32 s54, s54, 393216
s_add_u32 s54, s54, s56
s_buffer_load_dwordx2 s[46:47], s[48:51], s54 offset:4096
s_buffer_load_dwordx2 s[46:47], s[48:51], s54 offset:10240
s_buffer_load_dwordx2 s[46:47], s[48:51], s54 offset:16384
s_buffer_load_dwordx2 s[46:47], s[48:51], s54 offset:22528
tws_66:
s_sleep 4
s_sub_u32 s32, s32, 1
s_cmp_gt_i32 s32, 0
s_cbranch_scc1 tw_64
twd_65:
s_cmp_eq_u32 s65, 0
s_cbranch_scc0 fnd_68
poll_69:
buffer_load_dwordx2 v[248:249], v6, s[24:27], s73 offen sc1
buffer_load_dwordx4 v[8:11], v7, s[24:27], s72 offen offset:0 sc1
buffer_load_dwordx4 v[12:15], v7, s[24:27], s72 offen offset:16 sc1
buffer_load_dwordx4 v[16:19], v7, s[24:27], s72 offen offset:128 sc1
buffer_load_dwordx4 v[20:23], v7, s[24:27], s72 offen offset:144 sc1
pchk_70:
s_waitcnt vmcnt(3)
v_min3_u32 v5, v248, v249, v8
v_min3_u32 v5, v5, v9, v10
s_waitcnt vmcnt(2)
v_min3_u32 v5, v5, v11, v12
v_min3_u32 v5, v5, v13, v14
s_waitcnt vmcnt(1)
v_min3_u32 v5, v5, v15, v16
v_min3_u32 v5, v5, v17, v18
s_waitcnt vmcnt(0)
v_min3_u32 v5, v5, v19, v20
v_min3_u32 v5, v5, v21, v22
v_min_u32 v5, v5, v23
v_cmp_eq_u32 vcc, 0, v5
s_cbranch_vccz pdone_71
s_sub_u32 s32, s32, 1
s_cmp_gt_i32 s32, 0
s_cbranch_scc1 poll_69
pdone_71:
v_mfma_f32_16x16x32_bf16 v[24:27], v[8:11], v[56:59], 0
v_mov_b32 v250, v248
v_mfma_f32_16x16x32_bf16 v[28:31], v[8:11], v[60:63], 0
s_nop 0
v_max_f32_dpp v250, v250, v250 row_ror:1 row_mask:0xf bank_mask:0xf
v_mfma_f32_16x16x32_bf16 v[32:35], v[8:11], v[64:67], 0
s_nop 0
v_max_f32_dpp v250, v250, v250 row_ror:2 row_mask:0xf bank_mask:0xf
v_mfma_f32_16x16x32_bf16 v[36:39], v[8:11], v[68:71], 0
s_nop 0
v_max_f32_dpp v250, v250, v250 row_ror:4 row_mask:0xf bank_mask:0xf
v_mfma_f32_16x16x32_bf16 v[40:43], v[8:11], v[72:75], 0
s_nop 0
v_max_f32_dpp v250, v250, v250 row_ror:8 row_mask:0xf bank_mask:0xf
v_mfma_f32_16x16x32_bf16 v[44:47], v[8:11], v[76:79], 0
v_cmp_eq_f32 vcc, v250, v248
v_mfma_f32_16x16x32_bf16 v[48:51], v[8:11], v[80:83], 0
s_ff1_i32_b64 s68, vcc
v_mfma_f32_16x16x32_bf16 v[52:55], v[8:11], v[84:87], 0
s_and_b32 s68, s68, 15
v_mfma_f32_16x16x32_bf16 v[24:27], v[12:15], v[88:91], v[24:27]
v_readlane_b32 s33, v249, s68
v_mfma_f32_16x16x32_bf16 v[28:31], v[12:15], v[92:95], v[28:31]
v_readlane_b32 s67, v248, s68
v_mfma_f32_16x16x32_bf16 v[32:35], v[12:15], v[96:99], v[32:35]
v_add_u32 v5, s34, 4
v_mfma_f32_16x16x32_bf16 v[36:39], v[12:15], v[100:103], v[36:39]
v_mov_b32 v250, s33
v_mfma_f32_16x16x32_bf16 v[40:43], v[12:15], v[104:107], v[40:43]
s_mov_b64 exec, 1
ds_write2_b32 v3, v5, v250 offset1:2
s_mov_b64 exec, -1
v_mfma_f32_16x16x32_bf16 v[44:47], v[12:15], v[108:111], v[44:47]
s_sub_u32 s33, s33, 1
v_mfma_f32_16x16x32_bf16 v[48:51], v[12:15], v[112:115], v[48:51]
s_and_b32 s33, s33, 2047
v_mfma_f32_16x16x32_bf16 v[52:55], v[12:15], v[116:119], v[52:55]
v_mfma_f32_16x16x32_bf16 v[24:27], v[16:19], v[120:123], v[24:27]
v_mfma_f32_16x16x32_bf16 v[28:31], v[16:19], v[124:127], v[28:31]
v_mfma_f32_16x16x32_bf16 v[32:35], v[16:19], v[128:131], v[32:35]
v_mfma_f32_16x16x32_bf16 v[36:39], v[16:19], v[132:135], v[36:39]
v_mfma_f32_16x16x32_bf16 v[40:43], v[16:19], v[136:139], v[40:43]
v_mfma_f32_16x16x32_bf16 v[44:47], v[16:19], v[140:143], v[44:47]
v_mfma_f32_16x16x32_bf16 v[48:51], v[16:19], v[144:147], v[48:51]
v_mfma_f32_16x16x32_bf16 v[52:55], v[16:19], v[148:151], v[52:55]
v_mfma_f32_16x16x32_bf16 v[24:27], v[20:23], v[152:155], v[24:27]
s_and_b32 s70, s68, 12
s_lshl_b32 s70, s70, 2
s_bitcmp1_b32 s68, 1
v_mfma_f32_16x16x32_bf16 v[28:31], v[20:23], v[156:159], v[28:31]
v_mfma_f32_16x16x32_bf16 v[32:35], v[20:23], v[160:163], v[32:35]
v_mfma_f32_16x16x32_bf16 v[36:39], v[20:23], v[164:167], v[36:39]
v_mfma_f32_16x16x32_bf16 v[40:43], v[20:23], v[168:171], v[40:43]
v_mfma_f32_16x16x32_bf16 v[44:47], v[20:23], v[172:175], v[44:47]
v_mfma_f32_16x16x32_bf16 v[48:51], v[20:23], v[176:179], v[48:51]
v_mfma_f32_16x16x32_bf16 v[52:55], v[20:23], v[180:183], v[52:55]
s_cbranch_scc1 fsel_74
fsel_72:
s_bitcmp1_b32 s68, 0
s_cbranch_scc1 fsel_73
v_max_u32 v8, 1, v24
v_max_u32 v9, 1, v28
v_max_u32 v10, 1, v32
v_max_u32 v11, 1, v36
v_max_u32 v12, 1, v40
v_max_u32 v13, 1, v44
v_max_u32 v14, 1, v48
v_max_u32 v15, 1, v52
s_branch fsel_76
fsel_73:
v_max_u32 v8, 1, v25
v_max_u32 v9, 1, v29
v_max_u32 v10, 1, v33
v_max_u32 v11, 1, v37
v_max_u32 v12, 1, v41
v_max_u32 v13, 1, v45
v_max_u32 v14, 1, v49
v_max_u32 v15, 1, v53
s_branch fsel_76
fsel_74:
s_bitcmp1_b32 s68, 0
s_cbranch_scc1 fsel_75
v_max_u32 v8, 1, v26
v_max_u32 v9, 1, v30
v_max_u32 v10, 1, v34
v_max_u32 v11, 1, v38
v_max_u32 v12, 1, v42
v_max_u32 v13, 1, v46
v_max_u32 v14, 1, v50
v_max_u32 v15, 1, v54
s_branch fsel_76
fsel_75:
v_max_u32 v8, 1, v27
v_max_u32 v9, 1, v31
v_max_u32 v10, 1, v35
v_max_u32 v11, 1, v39
v_max_u32 v12, 1, v43
v_max_u32 v13, 1, v47
v_max_u32 v14, 1, v51
v_max_u32 v15, 1, v55
fsel_76:
s_bfm_b64 exec, 16, s70
buffer_store_dwordx4 v[8:11], v251, s[24:27], s74 offen sc1
buffer_store_dwordx4 v[12:15], v251, s[24:27], s75 offen sc1
s_mov_b64 exec, -1
s_and_b32 s70, s64, 7
s_lshl1_add_u32 s70, s70, s58
s_mul_i32 s70, s70, 28
s_add_u32 s70, s70, s71
s_lshl_b32 s70, s70, 8
s_add_u32 s70, s70, 1277952
s_waitcnt vmcnt(0)
s_mul_i32 s79, s63, 64
s_sub_u32 s79, 32, s79
s_add_u32 s35, s79, 7
tw_77:
ds_read_b32 v5, v2 offset:16
s_waitcnt lgkmcnt(0)
v_cmp_gt_i32 vcc, s35, v5
s_cbranch_vccz twd_78
v_readfirstlane_b32 s54, v5
s_sub_u32 s55, s35, s54
s_cmp_lt_i32 s55, 2
s_cbranch_scc1 tws_79
s_add_u32 s54, s54, 2
s_or_b32 s54, s54, 1
s_cmp_eq_u32 s54, s52
s_cbranch_scc1 tws_79
s_bitcmp1_b32 s54, 4
s_cbranch_scc1 tws_79
s_mov_b32 s52, s54
s_add_u32 s54, s54, s53
s_and_b32 s54, s54, 15
s_mul_i32 s54, s54, 393216
s_add_u32 s54, s54, s56
s_buffer_load_dwordx2 s[46:47], s[48:51], s54 offset:4096
s_buffer_load_dwordx2 s[46:47], s[48:51], s54 offset:10240
s_buffer_load_dwordx2 s[46:47], s[48:51], s54 offset:16384
s_buffer_load_dwordx2 s[46:47], s[48:51], s54 offset:22528
tws_79:
s_sleep 4
s_sub_u32 s32, s32, 1
s_cmp_gt_i32 s32, 0
s_cbranch_scc1 tw_77
twd_78:
poll_80:
buffer_load_dwordx4 v[24:27], v4, s[24:27], s76 offen offset:0 sc1
buffer_load_dwordx4 v[28:31], v4, s[24:27], s76 offen offset:1024 sc1
buffer_load_dwordx4 v[32:35], v4, s[24:27], s76 offen offset:2048 sc1
buffer_load_dwordx4 v[36:39], v4, s[24:27], s76 offen offset:3072 sc1
pchk_81:
s_waitcnt vmcnt(3)
v_min3_u32 v5, v24, v25, v26
s_waitcnt vmcnt(2)
v_min3_u32 v5, v5, v27, v28
v_min3_u32 v5, v5, v29, v30
s_waitcnt vmcnt(1)
v_min3_u32 v5, v5, v31, v32
v_min3_u32 v5, v5, v33, v34
s_waitcnt vmcnt(0)
v_min3_u32 v5, v5, v35, v36
v_min3_u32 v5, v5, v37, v38
v_min_u32 v5, v5, v39
v_cmp_eq_u32 vcc, 0, v5
s_cbranch_vccz pdone_82
s_sub_u32 s32, s32, 1
s_cmp_gt_i32 s32, 0
s_cbranch_scc1 poll_80
pdone_82:
v_add_f32 v24, v24, v32
v_add_f32 v25, v25, v33
v_add_f32 v26, v26, v34
v_add_f32 v27, v27, v35
v_add_f32 v28, v28, v36
v_add_f32 v29, v29, v37
v_add_f32 v30, v30, v38
v_add_f32 v31, v31, v39
v_add_f32 v24, v24, v28
v_add_f32 v25, v25, v29
v_add_f32 v26, v26, v30
v_add_f32 v27, v27, v31
s_nop 0
v_permlane32_swap_b32 v24, v26
v_permlane32_swap_b32 v25, v27
v_add_f32 v24, v24, v26
v_add_f32 v25, v25, v27
s_nop 1
v_permlane16_swap_b32 v24, v25
v_mul_f32 v26, 0xbfb8aa3b, v24
v_exp_f32 v26, v26
v_mul_f32 v24, v24, v25
v_add_f32 v26, 1.0, v26
v_rcp_f32 v26, v26
v_add_u32 v5, s34, 5
v_mul_f32 v24, v24, v26
v_cvt_pk_bf16_f32 v24, v24, v24
ds_write_b16 v253, v24 offset:512
s_mov_b64 exec, 1
ds_write_b32 v3, v5
s_mov_b64 exec, -1
s_add_u32 s35, s34, 5
poll_83:
ds_read_b32 v5, v2 offset:24
ds_read_b128 v[8:11], v254 offset:512
ds_read_b128 v[12:15], v254 offset:640
pchk_84:
s_waitcnt lgkmcnt(2)
v_cmp_gt_i32 vcc, s35, v5
s_cbranch_vccz pdone_85
s_sleep 1
s_sub_u32 s32, s32, 1
s_cmp_gt_i32 s32, 0
s_cbranch_scc1 poll_83
pdone_85:
s_waitcnt lgkmcnt(1)
v_mfma_f32_16x16x32_bf16 v[24:27], v[8:11], v[184:187], 0
v_mfma_f32_16x16x32_bf16 v[28:31], v[8:11], v[188:191], 0
v_mfma_f32_16x16x32_bf16 v[32:35], v[8:11], v[192:195], 0
v_mfma_f32_16x16x32_bf16 v[36:39], v[8:11], v[196:199], 0
v_mfma_f32_16x16x32_bf16 v[40:43], v[8:11], v[200:203], 0
v_mfma_f32_16x16x32_bf16 v[44:47], v[8:11], v[204:207], 0
v_mfma_f32_16x16x32_bf16 v[48:51], v[8:11], v[208:211], 0
v_mfma_f32_16x16x32_bf16 v[52:55], v[8:11], v[212:215], 0
s_waitcnt lgkmcnt(0)
v_mfma_f32_16x16x32_bf16 v[24:27], v[12:15], v[216:219], v[24:27]
v_mfma_f32_16x16x32_bf16 v[28:31], v[12:15], v[220:223], v[28:31]
v_mfma_f32_16x16x32_bf16 v[32:35], v[12:15], v[224:227], v[32:35]
v_mfma_f32_16x16x32_bf16 v[36:39], v[12:15], v[228:231], v[36:39]
v_mfma_f32_16x16x32_bf16 v[40:43], v[12:15], v[232:235], v[40:43]
v_mfma_f32_16x16x32_bf16 v[44:47], v[12:15], v[236:239], v[44:47]
v_mfma_f32_16x16x32_bf16 v[48:51], v[12:15], v[240:243], v[48:51]
v_mfma_f32_16x16x32_bf16 v[52:55], v[12:15], v[244:247], v[52:55]
s_nop 0
v_add_f32_dpp v16, v25, v24 row_ror:8 row_mask:0x1 bank_mask:0xf
v_add_f32_dpp v17, v29, v28 row_ror:8 row_mask:0x1 bank_mask:0xf
s_nop 0
v_add_f32_dpp v16, v33, v32 row_ror:8 row_mask:0x2 bank_mask:0xf
v_add_f32_dpp v17, v37, v36 row_ror:8 row_mask:0x2 bank_mask:0xf
s_nop 0
v_add_f32_dpp v16, v41, v40 row_ror:8 row_mask:0x4 bank_mask:0xf
v_add_f32_dpp v17, v45, v44 row_ror:8 row_mask:0x4 bank_mask:0xf
s_nop 0
v_add_f32_dpp v16, v49, v48 row_ror:8 row_mask:0x8 bank_mask:0xf
v_add_f32_dpp v17, v53, v52 row_ror:8 row_mask:0x8 bank_mask:0xf
v_max_u32 v16, 1, v16
v_max_u32 v17, 1, v17
s_mov_b32 exec_lo, 0x00ff00ff
s_mov_b32 exec_hi, 0x00ff00ff
buffer_store_dwordx2 v[16:17], v255, s[24:27], s70 offen sc1
s_mov_b64 exec, -1
fnd_67:
s_sub_u32 s70, s60, 3
s_mul_i32 s70, s70, s63
s_or_b32 s70, s70, s58
s_cbranch_scc1 fnr_86
s_mul_i32 s72, s59, 7168
s_add_u32 s72, s72, 1277952
s_add_u32 s73, s72, 4096
s_lshl_b32 s70, s68, 6
s_add_u32 s70, s70, s59
s_lshl_b32 s70, s70, 8
s_add_u32 s76, s70, 262144
v_mov_b32 v12, s67
v_mul_f32 v12, 0xbfb8aa3b, v12
v_exp_f32 v12, v12
v_lshl_add_u32 v6, v252, 2, v251
v_add_f32 v12, 1.0, v12
v_rcp_f32 v12, v12
v_lshrrev_b32 v7, 1, v6
s_lshl4_add_u32 s70, s33, s59
s_lshl_b32 s70, s70, 7
v_and_b32 v8, 0x46, v7
v_lshl_add_u32 v8, v1, 2, v8
v_and_b32 v9, 4, v0
v_lshl_add_u32 v8, v9, 1, v8
s_waitcnt vmcnt(0)
s_cmp_gt_u32 s65, s63
s_cbranch_scc1 fpre_88
fpre_89:
s_mul_i32 s79, s63, 64
s_sub_u32 s79, 32, s79
s_add_u32 s35, s79, 11
tw_90:
ds_read_b32 v5, v2 offset:16
s_waitcnt lgkmcnt(0)
v_cmp_gt_i32 vcc, s35, v5
s_cbranch_vccz twd_91
v_readfirstlane_b32 s54, v5
s_sub_u32 s55, s35, s54
s_cmp_lt_i32 s55, 2
s_cbranch_scc1 tws_92
s_add_u32 s54, s54, 2
s_or_b32 s54, s54, 1
s_cmp_eq_u32 s54, s52
s_cbranch_scc1 tws_92
s_bitcmp1_b32 s54, 4
s_cbranch_scc1 tws_92
s_mov_b32 s52, s54
s_add_u32 s54, s54, s53
s_and_b32 s54, s54, 15
s_mul_i32 s54, s54, 393216
s_add_u32 s54, s54, s56
s_buffer_load_dwordx2 s[46:47], s[48:51], s54 offset:4096
s_buffer_load_dwordx2 s[46:47], s[48:51], s54 offset:10240
s_buffer_load_dwordx2 s[46:47], s[48:51], s54 offset:16384
s_buffer_load_dwordx2 s[46:47], s[48:51], s54 offset:22528
tws_92:
s_sleep 4
s_sub_u32 s32, s32, 1
s_cmp_gt_i32 s32, 0
s_cbranch_scc1 tw_90
twd_91:
poll_93:
buffer_load_dword v52, v6, s[24:27], s76 offen sc1
buffer_load_dwordx4 v[24:27], v4, s[24:27], s72 offen offset:0 sc1
buffer_load_dwordx4 v[28:31], v4, s[24:27], s72 offen offset:1024 sc1
buffer_load_dwordx4 v[32:35], v4, s[24:27], s72 offen offset:2048 sc1
buffer_load_dwordx4 v[36:39], v4, s[24:27], s72 offen offset:3072 sc1
buffer_load_dwordx4 v[40:43], v4, s[24:27], s73 offen offset:0 sc1
buffer_load_dwordx4 v[44:47], v4, s[24:27], s73 offen offset:1024 sc1
buffer_load_dwordx4 v[48:51], v4, s[24:27], s73 offen offset:2048 sc1
pchk_94:
s_waitcnt vmcnt(6)
v_min3_u32 v5, v24, v25, v26
s_waitcnt vmcnt(5)
v_min3_u32 v5, v5, v27, v28
v_min3_u32 v5, v5, v29, v30
s_waitcnt vmcnt(4)
v_min3_u32 v5, v5, v31, v32
v_min3_u32 v5, v5, v33, v34
s_waitcnt vmcnt(3)
v_min3_u32 v5, v5, v35, v36
v_min3_u32 v5, v5, v37, v38
s_waitcnt vmcnt(2)
v_min3_u32 v5, v5, v39, v40
v_min3_u32 v5, v5, v41, v42
s_waitcnt vmcnt(1)
v_min3_u32 v5, v5, v43, v44
v_min3_u32 v5, v5, v45, v46
s_waitcnt vmcnt(0)
v_min3_u32 v5, v5, v47, v48
v_min3_u32 v5, v5, v49, v50
v_min3_u32 v5, v5, v51, v52
v_cmp_eq_u32 vcc, 0, v5
s_cbranch_vccz pdone_95
s_sub_u32 s32, s32, 1
s_cmp_gt_i32 s32, 0
s_cbranch_scc1 poll_93
pdone_95:
v_add_f32 v24, v24, v40
v_add_f32 v25, v25, v41
v_add_f32 v26, v26, v42
v_add_f32 v27, v27, v43
v_add_f32 v28, v28, v44
v_add_f32 v29, v29, v45
v_add_f32 v30, v30, v46
v_add_f32 v31, v31, v47
v_add_f32 v32, v32, v48
v_add_f32 v33, v33, v49
v_add_f32 v34, v34, v50
v_add_f32 v35, v35, v51
v_add_f32 v24, v24, v32
v_add_f32 v25, v25, v33
v_add_f32 v26, v26, v34
v_add_f32 v27, v27, v35
v_add_f32 v28, v28, v36
v_add_f32 v29, v29, v37
v_add_f32 v30, v30, v38
v_add_f32 v31, v31, v39
v_add_f32 v24, v24, v28
v_add_f32 v25, v25, v29
v_add_f32 v26, v26, v30
v_add_f32 v27, v27, v31
s_nop 0
v_permlane32_swap_b32 v24, v26
v_permlane32_swap_b32 v25, v27
v_add_f32 v24, v24, v26
v_add_f32 v25, v25, v27
s_nop 1
v_permlane16_swap_b32 v24, v25
v_add_f32 v24, v24, v25
v_fma_f32 v24, v24, v12, v52
v_cvt_pk_bf16_f32 v24, v24, v24
s_cmp_eq_u32 s63, 0
s_cbranch_scc1 fl0_87
buffer_store_short v24, v7, s[28:31], s70 offen
s_branch L_end
fl0_87:
ds_write_b16 v8, v24 offset:384
fnr_86:
s_cmp_eq_u32 s63, 0
s_cbranch_scc0 L_end
v_add_u32 v5, s34, 6
s_mov_b64 exec, 1
ds_write_b32 v3, v5
s_mov_b64 exec, -1
s_mul_i32 s79, s63, 64
s_sub_u32 s79, 32, s79
s_add_u32 s35, s79, 11
tw_96:
ds_read_b32 v5, v2 offset:16
s_waitcnt lgkmcnt(0)
v_cmp_gt_i32 vcc, s35, v5
s_cbranch_vccz twd_97
v_readfirstlane_b32 s54, v5
s_sub_u32 s55, s35, s54
s_cmp_lt_i32 s55, 2
s_cbranch_scc1 tws_98
s_add_u32 s54, s54, 2
s_or_b32 s54, s54, 1
s_cmp_eq_u32 s54, s52
s_cbranch_scc1 tws_98
s_bitcmp1_b32 s54, 4
s_cbranch_scc1 tws_98
s_mov_b32 s52, s54
s_add_u32 s54, s54, s53
s_and_b32 s54, s54, 15
s_mul_i32 s54, s54, 393216
s_add_u32 s54, s54, s56
s_buffer_load_dwordx2 s[46:47], s[48:51], s54 offset:4096
s_buffer_load_dwordx2 s[46:47], s[48:51], s54 offset:10240
s_buffer_load_dwordx2 s[46:47], s[48:51], s54 offset:16384
s_buffer_load_dwordx2 s[46:47], s[48:51], s54 offset:22528
tws_98:
s_sleep 4
s_sub_u32 s32, s32, 1
s_cmp_gt_i32 s32, 0
s_cbranch_scc1 tw_96
twd_97:
v_and_b32 v6, 48, v0
s_add_u32 s35, s34, 6
poll_99:
ds_read_b32 v5, v2 offset:24
ds_read_b128 v[8:11], v6 offset:384
ds_read_b128 v[12:15], v6 offset:448
pchk_100:
s_waitcnt lgkmcnt(2)
v_cmp_gt_i32 vcc, s35, v5
s_cbranch_vccz pdone_101
s_sleep 1
s_sub_u32 s32, s32, 1
s_cmp_gt_i32 s32, 0
s_cbranch_scc1 poll_99
pdone_101:
s_mov_b32 s63, 1
s_mov_b32 s34, 32
s_add_u32 s24, s24, 1409024
s_addc_u32 s25, s25, 0
s_mov_b32 s26, 1409024
s_mov_b32 s70, 131072
s_mov_b32 s79, 34
s_branch ftop_42
fxt_45:
v_max_u32 v8, 1, v8
v_max_u32 v9, 1, v9
v_max_u32 v10, 1, v10
v_max_u32 v11, 1, v11
v_max_u32 v12, 1, v12
v_max_u32 v13, 1, v13
v_max_u32 v14, 1, v14
v_max_u32 v15, 1, v15
s_mov_b32 exec_lo, 0x10001
s_mov_b32 exec_hi, 0x10001
buffer_store_dwordx4 v[8:11], v7, s[20:23], s73 offen offset:0 sc1
buffer_store_dwordx4 v[12:15], v7, s[20:23], s73 offen offset:64 sc1
s_mov_b64 exec, -1
s_branch fxb_46
fst_40:
s_lshl1_add_u32 s70, s78, s58
s_lshl_b32 s70, s70, 13
v_bfe_u32 v8, v0, 2, 2
v_lshl_add_u32 v8, v8, 9, v7
v_add_u32 v8, v8, v1
v_lshlrev_b32 v8, 2, v8
buffer_load_dwordx4 v[24:27], v8, s[8:11], s70 offen offset:0
buffer_load_dwordx4 v[28:31], v8, s[8:11], s70 offen offset:256
buffer_load_dwordx4 v[32:35], v8, s[8:11], s70 offen offset:512
buffer_load_dwordx4 v[36:39], v8, s[8:11], s70 offen offset:768
buffer_load_dwordx4 v[40:43], v8, s[8:11], s70 offen offset:1024
buffer_load_dwordx4 v[44:47], v8, s[8:11], s70 offen offset:1280
buffer_load_dwordx4 v[48:51], v8, s[8:11], s70 offen offset:1536
buffer_load_dwordx4 v[52:55], v8, s[8:11], s70 offen offset:1792
v_lshlrev_b32 v9, 4, v1
s_waitcnt vmcnt(7)
v_mfma_f32_16x16x32_bf16 v[16:19], v[24:27], v[252:255], 0
v_mfma_f32_16x16x32_bf16 v[20:23], v[24:27], v[24:27], 0
s_waitcnt vmcnt(6)
v_mfma_f32_16x16x32_bf16 v[16:19], v[28:31], v[252:255], v[16:19]
v_mfma_f32_16x16x32_bf16 v[20:23], v[28:31], v[28:31], v[20:23]
s_waitcnt vmcnt(5)
v_mfma_f32_16x16x32_bf16 v[16:19], v[32:35], v[252:255], v[16:19]
v_mfma_f32_16x16x32_bf16 v[20:23], v[32:35], v[32:35], v[20:23]
s_waitcnt vmcnt(4)
v_mfma_f32_16x16x32_bf16 v[16:19], v[36:39], v[252:255], v[16:19]
v_mfma_f32_16x16x32_bf16 v[20:23], v[36:39], v[36:39], v[20:23]
s_waitcnt vmcnt(3)
v_mfma_f32_16x16x32_bf16 v[16:19], v[40:43], v[252:255], v[16:19]
v_mfma_f32_16x16x32_bf16 v[20:23], v[40:43], v[40:43], v[20:23]
s_waitcnt vmcnt(2)
v_mfma_f32_16x16x32_bf16 v[16:19], v[44:47], v[252:255], v[16:19]
v_mfma_f32_16x16x32_bf16 v[20:23], v[44:47], v[44:47], v[20:23]
s_waitcnt vmcnt(1)
v_mfma_f32_16x16x32_bf16 v[16:19], v[48:51], v[252:255], v[16:19]
v_mfma_f32_16x16x32_bf16 v[20:23], v[48:51], v[48:51], v[20:23]
s_waitcnt vmcnt(0)
v_mfma_f32_16x16x32_bf16 v[16:19], v[52:55], v[252:255], v[16:19]
v_mfma_f32_16x16x32_bf16 v[20:23], v[52:55], v[52:55], v[20:23]
s_nop 6
v_add_f32 v16, v16, v18
v_add_f32 v17, v17, v19
v_add_f32 v16, v16, v17
s_nop 0
v_mov_b32_dpp v17, v20 quad_perm:[0,0,0,0] row_mask:0xf bank_mask:0xf
s_nop 1
v_add_f32_dpp v17, v21, v17 quad_perm:[1,1,1,1] row_mask:0xf bank_mask:0xf
s_nop 1
v_add_f32_dpp v17, v22, v17 quad_perm:[2,2,2,2] row_mask:0xf bank_mask:0xf
s_nop 1
v_add_f32_dpp v17, v23, v17 quad_perm:[3,3,3,3] row_mask:0xf bank_mask:0xf
v_mul_f32 v5, 0xba800000, v16
v_mul_f32 v17, 0x3a800000, v17
v_fma_f32 v17, -v5, v5, v17
v_max_f32 v17, 0, v17
v_add_f32 v17, 0x3727c5ac, v17
v_rsq_f32 v16, v17
s_nop 0
v_mul_f32 v17, v5, v16
v_max_u32 v17, 1, v17
s_lshl_b32 s70, s60, 7
s_add_u32 s70, s70, s76
s_lshl_b32 s73, s58, 5
s_add_u32 s70, s70, s73
v_lshrrev_b32 v7, 1, v7
s_add_u32 s35, s34, 5
tw_102:
ds_read_b32 v5, v2 offset:16
s_waitcnt lgkmcnt(0)
v_cmp_gt_i32 vcc, s35, v5
s_cbranch_vccz twd_103
v_readfirstlane_b32 s54, v5
s_sub_u32 s55, s35, s54
s_cmp_lt_i32 s55, 2
s_cbranch_scc1 tws_104
s_add_u32 s54, s54, 2
s_or_b32 s54, s54, 1
s_cmp_eq_u32 s54, s52
s_cbranch_scc1 tws_104
s_bitcmp1_b32 s54, 4
s_cbranch_scc1 tws_104
s_mov_b32 s52, s54
s_add_u32 s54, s54, s53
s_and_b32 s54, s54, 15
s_mul_i32 s54, s54, 393216
s_add_u32 s54, s54, s56
s_buffer_load_dwordx2 s[46:47], s[48:51], s54 offset:4096
s_buffer_load_dwordx2 s[46:47], s[48:51], s54 offset:10240
s_buffer_load_dwordx2 s[46:47], s[48:51], s54 offset:16384
s_buffer_load_dwordx2 s[46:47], s[48:51], s54 offset:22528
tws_104:
s_sleep 4
s_sub_u32 s32, s32, 1
s_cmp_gt_i32 s32, 0
s_cbranch_scc1 tw_102
twd_103:
poll_105:
buffer_load_dword v12, v9, s[4:7], 0 offen sc1
pchk_106:
s_waitcnt vmcnt(0)
v_cmp_gt_u32 vcc, 64, v12
s_cbranch_vccz pdone_107
s_sleep 16
s_sub_u32 s32, s32, 1
s_cmp_gt_i32 s32, 0
s_cbranch_scc1 poll_105
pdone_107:
s_mov_b32 exec_lo, 0x00100001
s_mov_b32 exec_hi, 0x10000100
buffer_store_dwordx2 v[16:17], v7, s[24:27], s70 offen sc1
s_getreg_b32 s73, hwreg(HW_REG_XCC_ID)
s_mov_b64 exec, 1
v_add_u32 v12, s73, 1
buffer_store_dword v12, off, s[24:27], s70 offset:64 sc1
s_mov_b64 exec, -1
s_branch fsb_41
fg_47:
s_lshl1_add_u32 s35, s2, s58
s_lshl_b32 s35, s35, 12
s_add_u32 s44, s40, s35
s_addc_u32 s45, s41, 0
s_mov_b32 s35, 4
ft_108:
s_load_dwordx2 s[42:43], s[44:45], 60
s_load_dwordx2 s[42:43], s[44:45], 188
s_load_dwordx2 s[42:43], s[44:45], 316
s_load_dwordx2 s[42:43], s[44:45], 444
s_load_dwordx2 s[42:43], s[44:45], 572
s_load_dwordx2 s[42:43], s[44:45], 700
s_load_dwordx2 s[42:43], s[44:45], 828
s_load_dwordx2 s[42:43], s[44:45], 956
s_add_u32 s44, s44, 1024
s_addc_u32 s45, s45, 0
s_sub_u32 s35, s35, 1
s_cmp_eq_u32 s35, 0
s_cbranch_scc0 ft_108
v_lshrrev_b32 v250, 3, v0
v_mul_u32_u24 v250, 16256, v250
v_add_u32 v250, v250, v4
s_add_u32 s35, s66, 131072
buffer_load_dwordx4 v[184:187], v250, s[12:15], s35 offen nt
s_add_u32 s35, s66, 133120
buffer_load_dwordx4 v[188:191], v250, s[12:15], s35 offen nt
s_add_u32 s35, s66, 135168
buffer_load_dwordx4 v[192:195], v250, s[12:15], s35 offen nt
s_add_u32 s35, s66, 137216
buffer_load_dwordx4 v[196:199], v250, s[12:15], s35 offen nt
s_add_u32 s35, s66, 139264
buffer_load_dwordx4 v[200:203], v250, s[12:15], s35 offen nt
s_add_u32 s35, s66, 141312
buffer_load_dwordx4 v[204:207], v250, s[12:15], s35 offen nt
s_add_u32 s35, s66, 143360
buffer_load_dwordx4 v[208:211], v250, s[12:15], s35 offen nt
s_add_u32 s35, s66, 145408
buffer_load_dwordx4 v[212:215], v250, s[12:15], s35 offen nt
v_lshrrev_b32 v250, 3, v0
v_mul_u32_u24 v250, 16256, v250
v_add_u32 v250, v250, v4
s_add_u32 s35, s66, 0
buffer_load_dwordx4 v[152:155], v250, s[12:15], s35 offen nt
s_add_u32 s35, s66, 2048
buffer_load_dwordx4 v[156:159], v250, s[12:15], s35 offen nt
s_add_u32 s35, s66, 4096
buffer_load_dwordx4 v[160:163], v250, s[12:15], s35 offen nt
s_add_u32 s35, s66, 6144
buffer_load_dwordx4 v[164:167], v250, s[12:15], s35 offen nt
s_add_u32 s35, s66, 8192
buffer_load_dwordx4 v[168:171], v250, s[12:15], s35 offen nt
s_add_u32 s35, s66, 10240
buffer_load_dwordx4 v[172:175], v250, s[12:15], s35 offen nt
s_add_u32 s35, s66, 12288
buffer_load_dwordx4 v[176:179], v250, s[12:15], s35 offen nt
s_add_u32 s35, s66, 14336
buffer_load_dwordx4 v[180:183], v250, s[12:15], s35 offen nt
s_add_u32 s35, s34, 10
tw_109:
ds_read_b32 v5, v2 offset:16
s_waitcnt lgkmcnt(0)
v_cmp_gt_i32 vcc, s35, v5
s_cbranch_vccz twd_110
v_readfirstlane_b32 s54, v5
s_sub_u32 s55, s35, s54
s_cmp_lt_i32 s55, 2
s_cbranch_scc1 tws_111
s_add_u32 s54, s54, 2
s_or_b32 s54, s54, 1
s_cmp_eq_u32 s54, s52
s_cbranch_scc1 tws_111
s_bitcmp1_b32 s54, 4
s_cbranch_scc1 tws_111
s_mov_b32 s52, s54
s_add_u32 s54, s54, s53
s_and_b32 s54, s54, 15
s_mul_i32 s54, s54, 393216
s_add_u32 s54, s54, s56
s_buffer_load_dwordx2 s[46:47], s[48:51], s54 offset:4096
s_buffer_load_dwordx2 s[46:47], s[48:51], s54 offset:10240
s_buffer_load_dwordx2 s[46:47], s[48:51], s54 offset:16384
s_buffer_load_dwordx2 s[46:47], s[48:51], s54 offset:22528
tws_111:
s_sleep 4
s_sub_u32 s32, s32, 1
s_cmp_gt_i32 s32, 0
s_cbranch_scc1 tw_109
twd_110:
v_and_b32 v10, 0x7a0, v7
s_getreg_b32 s70, hwreg(HW_REG_XCC_ID)
s_add_u32 s70, s70, 1
poll_112:
buffer_load_dword v12, v10, s[24:27], s76 offen offset:64 sc1
pchk_113:
s_waitcnt vmcnt(0)
v_cmp_eq_u32 vcc, 0, v12
s_cbranch_vccz pdone_114
s_sub_u32 s32, s32, 1
s_cmp_gt_i32 s32, 0
s_cbranch_scc1 poll_112
pdone_114:
v_cmp_eq_u32 vcc, s70, v12
s_cmp_eq_u64 vcc, exec
s_cselect_b32 s70, 1, 0
v_mov_b32 v12, s70
v_mov_b32 v10, 0
s_mov_b64 exec, 1
ds_write_b32 v10, v12 offset:56
s_mov_b64 exec, -1
s_branch fg_48
fnw_58:
s_waitcnt lgkmcnt(0)
v_mov_b32 v252, 0
v_mov_b32 v253, 0
v_mov_b32 v254, 0
v_mov_b32 v255, 0
s_mul_i32 s42, s58, 1409024
s_mul_i32 s35, s78, 2048
s_add_u32 s35, s35, s42
s_add_u32 s35, s35, 524288
buffer_store_dwordx4 v[252:255], v4, s[24:27], s35 offen offset:0 sc1
buffer_store_dwordx4 v[252:255], v4, s[24:27], s35 offen offset:1024 sc1
s_mul_i32 s35, s78, 1408
s_add_u32 s35, s35, s42
s_add_u32 s35, s35, 1048576
buffer_store_dwordx4 v[252:255], v4, s[24:27], s35 offen offset:0 sc1
buffer_store_dwordx4 v[252:255], v4, s[24:27], s35 offen offset:384 sc1
s_lshl_b32 s35, s78, 10
s_add_u32 s35, s35, 1409024
s_cmp_eq_u32 s58, 1
s_cselect_b64 exec, -1, 0
buffer_store_dwordx4 v[252:255], v4, s[24:27], s35 offen offset:0 sc1
s_add_u32 s35, s35, 262144
buffer_store_dwordx4 v[252:255], v4, s[24:27], s35 offen offset:0 sc1
s_mov_b64 exec, -1
s_waitcnt vmcnt(0)
v_add_u32 v5, s34, 3
s_mov_b64 exec, 1
ds_write_b32 v3, v5
s_mov_b64 exec, -1
s_add_u32 s35, s34, 17
tw_115:
ds_read_b32 v5, v2 offset:16
s_waitcnt lgkmcnt(0)
v_cmp_gt_i32 vcc, s35, v5
s_cbranch_vccz twd_116
v_readfirstlane_b32 s54, v5
s_sub_u32 s55, s35, s54
s_cmp_lt_i32 s55, 2
s_cbranch_scc1 tws_117
s_add_u32 s54, s54, 2
s_or_b32 s54, s54, 1
s_cmp_eq_u32 s54, s52
s_cbranch_scc1 tws_117
s_bitcmp1_b32 s54, 4
s_cbranch_scc1 tws_117
s_mov_b32 s52, s54
s_add_u32 s54, s54, s53
s_and_b32 s54, s54, 15
s_mul_i32 s54, s54, 393216
s_add_u32 s54, s54, s56
s_buffer_load_dwordx2 s[46:47], s[48:51], s54 offset:4096
s_buffer_load_dwordx2 s[46:47], s[48:51], s54 offset:10240
s_buffer_load_dwordx2 s[46:47], s[48:51], s54 offset:16384
s_buffer_load_dwordx2 s[46:47], s[48:51], s54 offset:22528
tws_117:
s_sleep 4
s_sub_u32 s32, s32, 1
s_cmp_gt_i32 s32, 0
s_cbranch_scc1 tw_115
twd_116:
v_lshrrev_b32 v250, 4, v0
v_mul_u32_u24 v250, 28416, v250
v_add_u32 v250, v250, v4
s_add_u32 s35, s77, 688128
buffer_load_dwordx4 v[120:123], v250, s[16:19], s35 offen nt
s_add_u32 s35, s77, 695296
buffer_load_dwordx4 v[124:127], v250, s[16:19], s35 offen nt
s_add_u32 s35, s77, 702464
buffer_load_dwordx4 v[128:131], v250, s[16:19], s35 offen nt
s_add_u32 s35, s77, 709632
buffer_load_dwordx4 v[132:135], v250, s[16:19], s35 offen nt
s_add_u32 s35, s77, 802816
buffer_load_dwordx4 v[136:139], v250, s[16:19], s35 offen nt
s_add_u32 s35, s77, 809984
buffer_load_dwordx4 v[140:143], v250, s[16:19], s35 offen nt
s_add_u32 s35, s77, 817152
buffer_load_dwordx4 v[144:147], v250, s[16:19], s35 offen nt
s_add_u32 s35, s77, 824320
buffer_load_dwordx4 v[148:151], v250, s[16:19], s35 offen nt
v_lshrrev_b32 v250, 4, v0
v_mul_u32_u24 v250, 28416, v250
v_add_u32 v250, v250, v4
s_add_u32 s35, s77, 458752
buffer_load_dwordx4 v[88:91], v250, s[16:19], s35 offen nt
s_add_u32 s35, s77, 465920
buffer_load_dwordx4 v[92:95], v250, s[16:19], s35 offen nt
s_add_u32 s35, s77, 473088
buffer_load_dwordx4 v[96:99], v250, s[16:19], s35 offen nt
s_add_u32 s35, s77, 480256
buffer_load_dwordx4 v[100:103], v250, s[16:19], s35 offen nt
s_add_u32 s35, s77, 573440
buffer_load_dwordx4 v[104:107], v250, s[16:19], s35 offen nt
s_add_u32 s35, s77, 580608
buffer_load_dwordx4 v[108:111], v250, s[16:19], s35 offen nt
s_add_u32 s35, s77, 587776
buffer_load_dwordx4 v[112:115], v250, s[16:19], s35 offen nt
s_add_u32 s35, s77, 594944
buffer_load_dwordx4 v[116:119], v250, s[16:19], s35 offen nt
v_lshrrev_b32 v250, 4, v0
v_mul_u32_u24 v250, 28416, v250
v_add_u32 v250, v250, v4
s_add_u32 s35, s77, 229376
buffer_load_dwordx4 v[56:59], v250, s[16:19], s35 offen nt
s_add_u32 s35, s77, 236544
buffer_load_dwordx4 v[60:63], v250, s[16:19], s35 offen nt
s_add_u32 s35, s77, 243712
buffer_load_dwordx4 v[64:67], v250, s[16:19], s35 offen nt
s_add_u32 s35, s77, 250880
buffer_load_dwordx4 v[68:71], v250, s[16:19], s35 offen nt
s_add_u32 s35, s77, 344064
buffer_load_dwordx4 v[72:75], v250, s[16:19], s35 offen nt
s_add_u32 s35, s77, 351232
buffer_load_dwordx4 v[76:79], v250, s[16:19], s35 offen nt
s_add_u32 s35, s77, 358400
buffer_load_dwordx4 v[80:83], v250, s[16:19], s35 offen nt
s_add_u32 s35, s77, 365568
buffer_load_dwordx4 v[84:87], v250, s[16:19], s35 offen nt
v_lshrrev_b32 v250, 4, v0
v_mul_u32_u24 v250, 28416, v250
v_add_u32 v250, v250, v4
s_add_u32 s35, s77, 0
buffer_load_dwordx4 v[24:27], v250, s[16:19], s35 offen nt
s_add_u32 s35, s77, 7168
buffer_load_dwordx4 v[28:31], v250, s[16:19], s35 offen nt
s_add_u32 s35, s77, 14336
buffer_load_dwordx4 v[32:35], v250, s[16:19], s35 offen nt
s_add_u32 s35, s77, 21504
buffer_load_dwordx4 v[36:39], v250, s[16:19], s35 offen nt
s_add_u32 s35, s77, 114688
buffer_load_dwordx4 v[40:43], v250, s[16:19], s35 offen nt
s_add_u32 s35, s77, 121856
buffer_load_dwordx4 v[44:47], v250, s[16:19], s35 offen nt
s_add_u32 s35, s77, 129024
buffer_load_dwordx4 v[48:51], v250, s[16:19], s35 offen nt
s_add_u32 s35, s77, 136192
buffer_load_dwordx4 v[52:55], v250, s[16:19], s35 offen nt
s_waitcnt lgkmcnt(0)
s_mov_b32 s42, 0x05040100
s_mov_b32 s43, 0x07060302
s_cmp_eq_u32 s65, 0
s_cbranch_scc0 fq_118
v_perm_b32 v216, v188, v184, s42
v_perm_b32 v220, v188, v184, s43
v_perm_b32 v224, v189, v185, s42
v_perm_b32 v228, v189, v185, s43
v_perm_b32 v232, v190, v186, s42
v_perm_b32 v236, v190, v186, s43
v_perm_b32 v240, v191, v187, s42
v_perm_b32 v244, v191, v187, s43
v_perm_b32 v217, v196, v192, s42
v_perm_b32 v221, v196, v192, s43
v_perm_b32 v225, v197, v193, s42
v_perm_b32 v229, v197, v193, s43
v_perm_b32 v233, v198, v194, s42
v_perm_b32 v237, v198, v194, s43
v_perm_b32 v241, v199, v195, s42
v_perm_b32 v245, v199, v195, s43
v_perm_b32 v218, v204, v200, s42
v_perm_b32 v222, v204, v200, s43
v_perm_b32 v226, v205, v201, s42
v_perm_b32 v230, v205, v201, s43
v_perm_b32 v234, v206, v202, s42
v_perm_b32 v238, v206, v202, s43
v_perm_b32 v242, v207, v203, s42
v_perm_b32 v246, v207, v203, s43
v_perm_b32 v219, v212, v208, s42
v_perm_b32 v223, v212, v208, s43
v_perm_b32 v227, v213, v209, s42
v_perm_b32 v231, v213, v209, s43
v_perm_b32 v235, v214, v210, s42
v_perm_b32 v239, v214, v210, s43
v_perm_b32 v243, v215, v211, s42
v_perm_b32 v247, v215, v211, s43
v_perm_b32 v184, v156, v152, s42
v_perm_b32 v188, v156, v152, s43
v_perm_b32 v192, v157, v153, s42
v_perm_b32 v196, v157, v153, s43
v_perm_b32 v200, v158, v154, s42
v_perm_b32 v204, v158, v154, s43
v_perm_b32 v208, v159, v155, s42
v_perm_b32 v212, v159, v155, s43
v_perm_b32 v185, v164, v160, s42
v_perm_b32 v189, v164, v160, s43
v_perm_b32 v193, v165, v161, s42
v_perm_b32 v197, v165, v161, s43
v_perm_b32 v201, v166, v162, s42
v_perm_b32 v205, v166, v162, s43
v_perm_b32 v209, v167, v163, s42
v_perm_b32 v213, v167, v163, s43
v_perm_b32 v186, v172, v168, s42
v_perm_b32 v190, v172, v168, s43
v_perm_b32 v194, v173, v169, s42
v_perm_b32 v198, v173, v169, s43
v_perm_b32 v202, v174, v170, s42
v_perm_b32 v206, v174, v170, s43
v_perm_b32 v210, v175, v171, s42
v_perm_b32 v214, v175, v171, s43
v_perm_b32 v187, v180, v176, s42
v_perm_b32 v191, v180, v176, s43
v_perm_b32 v195, v181, v177, s42
v_perm_b32 v199, v181, v177, s43
v_perm_b32 v203, v182, v178, s42
v_perm_b32 v207, v182, v178, s43
v_perm_b32 v211, v183, v179, s42
v_perm_b32 v215, v183, v179, s43
s_waitcnt vmcnt(30)
v_perm_b32 v152, v124, v120, s42
v_perm_b32 v156, v124, v120, s43
v_perm_b32 v160, v125, v121, s42
v_perm_b32 v164, v125, v121, s43
v_perm_b32 v168, v126, v122, s42
v_perm_b32 v172, v126, v122, s43
v_perm_b32 v176, v127, v123, s42
v_perm_b32 v180, v127, v123, s43
s_waitcnt vmcnt(28)
v_perm_b32 v153, v132, v128, s42
v_perm_b32 v157, v132, v128, s43
v_perm_b32 v161, v133, v129, s42
v_perm_b32 v165, v133, v129, s43
v_perm_b32 v169, v134, v130, s42
v_perm_b32 v173, v134, v130, s43
v_perm_b32 v177, v135, v131, s42
v_perm_b32 v181, v135, v131, s43
s_waitcnt vmcnt(26)
v_perm_b32 v154, v140, v136, s42
v_perm_b32 v158, v140, v136, s43
v_perm_b32 v162, v141, v137, s42
v_perm_b32 v166, v141, v137, s43
v_perm_b32 v170, v142, v138, s42
v_perm_b32 v174, v142, v138, s43
v_perm_b32 v178, v143, v139, s42
v_perm_b32 v182, v143, v139, s43
s_waitcnt vmcnt(24)
v_perm_b32 v155, v148, v144, s42
v_perm_b32 v159, v148, v144, s43
v_perm_b32 v163, v149, v145, s42
v_perm_b32 v167, v149, v145, s43
v_perm_b32 v171, v150, v146, s42
v_perm_b32 v175, v150, v146, s43
v_perm_b32 v179, v151, v147, s42
v_perm_b32 v183, v151, v147, s43
s_waitcnt vmcnt(22)
v_perm_b32 v120, v92, v88, s42
v_perm_b32 v124, v92, v88, s43
v_perm_b32 v128, v93, v89, s42
v_perm_b32 v132, v93, v89, s43
v_perm_b32 v136, v94, v90, s42
v_perm_b32 v140, v94, v90, s43
v_perm_b32 v144, v95, v91, s42
v_perm_b32 v148, v95, v91, s43
s_waitcnt vmcnt(20)
v_perm_b32 v121, v100, v96, s42
v_perm_b32 v125, v100, v96, s43
v_perm_b32 v129, v101, v97, s42
v_perm_b32 v133, v101, v97, s43
v_perm_b32 v137, v102, v98, s42
v_perm_b32 v141, v102, v98, s43
v_perm_b32 v145, v103, v99, s42
v_perm_b32 v149, v103, v99, s43
s_waitcnt vmcnt(18)
v_perm_b32 v122, v108, v104, s42
v_perm_b32 v126, v108, v104, s43
v_perm_b32 v130, v109, v105, s42
v_perm_b32 v134, v109, v105, s43
v_perm_b32 v138, v110, v106, s42
v_perm_b32 v142, v110, v106, s43
v_perm_b32 v146, v111, v107, s42
v_perm_b32 v150, v111, v107, s43
s_waitcnt vmcnt(16)
v_perm_b32 v123, v116, v112, s42
v_perm_b32 v127, v116, v112, s43
v_perm_b32 v131, v117, v113, s42
v_perm_b32 v135, v117, v113, s43
v_perm_b32 v139, v118, v114, s42
v_perm_b32 v143, v118, v114, s43
v_perm_b32 v147, v119, v115, s42
v_perm_b32 v151, v119, v115, s43
s_waitcnt vmcnt(14)
v_perm_b32 v88, v60, v56, s42
v_perm_b32 v92, v60, v56, s43
v_perm_b32 v96, v61, v57, s42
v_perm_b32 v100, v61, v57, s43
v_perm_b32 v104, v62, v58, s42
v_perm_b32 v108, v62, v58, s43
v_perm_b32 v112, v63, v59, s42
v_perm_b32 v116, v63, v59, s43
s_waitcnt vmcnt(12)
v_perm_b32 v89, v68, v64, s42
v_perm_b32 v93, v68, v64, s43
v_perm_b32 v97, v69, v65, s42
v_perm_b32 v101, v69, v65, s43
v_perm_b32 v105, v70, v66, s42
v_perm_b32 v109, v70, v66, s43
v_perm_b32 v113, v71, v67, s42
v_perm_b32 v117, v71, v67, s43
s_waitcnt vmcnt(10)
v_perm_b32 v90, v76, v72, s42
v_perm_b32 v94, v76, v72, s43
v_perm_b32 v98, v77, v73, s42
v_perm_b32 v102, v77, v73, s43
v_perm_b32 v106, v78, v74, s42
v_perm_b32 v110, v78, v74, s43
v_perm_b32 v114, v79, v75, s42
v_perm_b32 v118, v79, v75, s43
s_waitcnt vmcnt(8)
v_perm_b32 v91, v84, v80, s42
v_perm_b32 v95, v84, v80, s43
v_perm_b32 v99, v85, v81, s42
v_perm_b32 v103, v85, v81, s43
v_perm_b32 v107, v86, v82, s42
v_perm_b32 v111, v86, v82, s43
v_perm_b32 v115, v87, v83, s42
v_perm_b32 v119, v87, v83, s43
s_waitcnt vmcnt(6)
v_perm_b32 v56, v28, v24, s42
v_perm_b32 v60, v28, v24, s43
v_perm_b32 v64, v29, v25, s42
v_perm_b32 v68, v29, v25, s43
v_perm_b32 v72, v30, v26, s42
v_perm_b32 v76, v30, v26, s43
v_perm_b32 v80, v31, v27, s42
v_perm_b32 v84, v31, v27, s43
s_waitcnt vmcnt(4)
v_perm_b32 v57, v36, v32, s42
v_perm_b32 v61, v36, v32, s43
v_perm_b32 v65, v37, v33, s42
v_perm_b32 v69, v37, v33, s43
v_perm_b32 v73, v38, v34, s42
v_perm_b32 v77, v38, v34, s43
v_perm_b32 v81, v39, v35, s42
v_perm_b32 v85, v39, v35, s43
s_waitcnt vmcnt(2)
v_perm_b32 v58, v44, v40, s42
v_perm_b32 v62, v44, v40, s43
v_perm_b32 v66, v45, v41, s42
v_perm_b32 v70, v45, v41, s43
v_perm_b32 v74, v46, v42, s42
v_perm_b32 v78, v46, v42, s43
v_perm_b32 v82, v47, v43, s42
v_perm_b32 v86, v47, v43, s43
s_waitcnt vmcnt(0)
v_perm_b32 v59, v52, v48, s42
v_perm_b32 v63, v52, v48, s43
v_perm_b32 v67, v53, v49, s42
v_perm_b32 v71, v53, v49, s43
v_perm_b32 v75, v54, v50, s42
v_perm_b32 v79, v54, v50, s43
v_perm_b32 v83, v55, v51, s42
v_perm_b32 v87, v55, v51, s43
fq_118:
s_and_b32 s54, s59, 1
s_lshl_b32 s54, s54, 1
s_sub_u32 s54, s53, s54
s_and_b32 s54, s54, 15
s_mul_i32 s54, s54, 393216
s_add_u32 s54, s54, s56
s_buffer_load_dwordx2 s[46:47], s[48:51], s54 offset:4096
s_buffer_load_dwordx2 s[46:47], s[48:51], s54 offset:10240
s_buffer_load_dwordx2 s[46:47], s[48:51], s54 offset:16384
s_buffer_load_dwordx2 s[46:47], s[48:51], s54 offset:22528
s_buffer_load_dwordx2 s[46:47], s[48:51], s54 offset:2048
s_buffer_load_dwordx2 s[46:47], s[48:51], s54 offset:8192
s_buffer_load_dwordx2 s[46:47], s[48:51], s54 offset:14336
s_buffer_load_dwordx2 s[46:47], s[48:51], s54 offset:20480
s_buffer_load_dwordx2 s[46:47], s[48:51], s54 offset:0
s_buffer_load_dwordx2 s[46:47], s[48:51], s54 offset:6144
s_buffer_load_dwordx2 s[46:47], s[48:51], s54 offset:12288
s_buffer_load_dwordx2 s[46:47], s[48:51], s54 offset:18432
s_add_u32 s54, s53, 1
s_and_b32 s54, s54, 15
s_mul_i32 s54, s54, 393216
s_add_u32 s54, s54, s56
s_buffer_load_dwordx2 s[46:47], s[48:51], s54 offset:4096
s_buffer_load_dwordx2 s[46:47], s[48:51], s54 offset:10240
s_buffer_load_dwordx2 s[46:47], s[48:51], s54 offset:16384
s_buffer_load_dwordx2 s[46:47], s[48:51], s54 offset:22528
s_buffer_load_dwordx2 s[46:47], s[48:51], s54 offset:2048
s_buffer_load_dwordx2 s[46:47], s[48:51], s54 offset:8192
s_buffer_load_dwordx2 s[46:47], s[48:51], s54 offset:14336
s_buffer_load_dwordx2 s[46:47], s[48:51], s54 offset:20480
s_buffer_load_dwordx2 s[46:47], s[48:51], s54 offset:0
s_buffer_load_dwordx2 s[46:47], s[48:51], s54 offset:6144
s_buffer_load_dwordx2 s[46:47], s[48:51], s54 offset:12288
s_buffer_load_dwordx2 s[46:47], s[48:51], s54 offset:18432
s_add_u32 s54, s53, 3
s_and_b32 s54, s54, 15
s_mul_i32 s54, s54, 393216
s_add_u32 s54, s54, s56
s_buffer_load_dwordx2 s[46:47], s[48:51], s54 offset:4096
s_buffer_load_dwordx2 s[46:47], s[48:51], s54 offset:10240
s_buffer_load_dwordx2 s[46:47], s[48:51], s54 offset:16384
s_buffer_load_dwordx2 s[46:47], s[48:51], s54 offset:22528
s_buffer_load_dwordx2 s[46:47], s[48:51], s54 offset:2048
s_buffer_load_dwordx2 s[46:47], s[48:51], s54 offset:8192
s_buffer_load_dwordx2 s[46:47], s[48:51], s54 offset:14336
s_buffer_load_dwordx2 s[46:47], s[48:51], s54 offset:20480
s_buffer_load_dwordx2 s[46:47], s[48:51], s54 offset:0
s_buffer_load_dwordx2 s[46:47], s[48:51], s54 offset:6144
s_buffer_load_dwordx2 s[46:47], s[48:51], s54 offset:12288
s_buffer_load_dwordx2 s[46:47], s[48:51], s54 offset:18432
s_add_u32 s54, s53, 5
s_and_b32 s54, s54, 15
s_mul_i32 s54, s54, 393216
s_add_u32 s54, s54, s56
s_buffer_load_dwordx2 s[46:47], s[48:51], s54 offset:4096
s_buffer_load_dwordx2 s[46:47], s[48:51], s54 offset:10240
s_buffer_load_dwordx2 s[46:47], s[48:51], s54 offset:16384
s_buffer_load_dwordx2 s[46:47], s[48:51], s54 offset:22528
s_buffer_load_dwordx2 s[46:47], s[48:51], s54 offset:2048
s_buffer_load_dwordx2 s[46:47], s[48:51], s54 offset:8192
s_buffer_load_dwordx2 s[46:47], s[48:51], s54 offset:14336
s_buffer_load_dwordx2 s[46:47], s[48:51], s54 offset:20480
s_buffer_load_dwordx2 s[46:47], s[48:51], s54 offset:0
s_buffer_load_dwordx2 s[46:47], s[48:51], s54 offset:6144
s_buffer_load_dwordx2 s[46:47], s[48:51], s54 offset:12288
s_buffer_load_dwordx2 s[46:47], s[48:51], s54 offset:18432
s_waitcnt lgkmcnt(0)
s_branch fnw_59
fnd_68:
poll_119:
buffer_load_dwordx2 v[248:249], v6, s[24:27], s73 offen sc1
pchk_120:
s_waitcnt vmcnt(0)
v_min_u32 v5, v248, v249
v_cmp_eq_u32 vcc, 0, v5
s_cbranch_vccz pdone_121
s_sleep 1
s_sub_u32 s32, s32, 1
s_cmp_gt_i32 s32, 0
s_cbranch_scc1 poll_119
pdone_121:
v_mov_b32 v250, v248
s_nop 1
v_max_f32_dpp v250, v250, v250 row_ror:1 row_mask:0xf bank_mask:0xf
s_nop 1
v_max_f32_dpp v250, v250, v250 row_ror:2 row_mask:0xf bank_mask:0xf
s_nop 1
v_max_f32_dpp v250, v250, v250 row_ror:4 row_mask:0xf bank_mask:0xf
s_nop 1
v_max_f32_dpp v250, v250, v250 row_ror:8 row_mask:0xf bank_mask:0xf
v_cmp_eq_f32 vcc, v250, v248
s_ff1_i32_b64 s68, vcc
s_and_b32 s68, s68, 15
v_readlane_b32 s33, v249, s68
v_readlane_b32 s67, v248, s68
v_add_u32 v5, s34, 4
v_mov_b32 v250, s33
s_mov_b64 exec, 1
ds_write2_b32 v3, v5, v250 offset1:2
s_mov_b64 exec, -1
s_sub_u32 s33, s33, 1
s_and_b32 s33, s33, 2047
s_branch fnd_67
fpre_88:
poll_122:
buffer_load_dwordx4 v[24:27], v4, s[24:27], s72 offen offset:0 sc1
pchk_123:
s_waitcnt vmcnt(0)
v_min3_u32 v5, v24, v25, v26
v_min_u32 v5, v5, v27
v_cmp_eq_u32 vcc, 0, v5
s_cbranch_vccz pdone_124
s_sleep 8
s_sub_u32 s32, s32, 1
s_cmp_gt_i32 s32, 0
s_cbranch_scc1 poll_122
pdone_124:
s_branch fpre_89
L_m:
s_setprio 2
v_mov_b32 v6, 0
v_mov_b32 v7, 0
v_lshlrev_b32 v8, 3, v0
ds_write_b64 v8, v[6:7]
s_waitcnt lgkmcnt(0)
s_barrier
s_lshr_b32 s64, s58, 1
s_and_b32 s65, s58, 1
v_and_b32 v1, 3, v0
v_lshlrev_b32 v1, 2, v1
v_and_b32 v2, 4, v1
s_lshl2_add_u32 s35, s58, 0
v_mov_b32 v3, s35
s_mov_b32 s4, s44
s_mov_b32 s5, s45
s_mov_b32 s6, 0x800
s_mov_b32 s7, 0x00020000
v_lshrrev_b32 v6, 4, v0
v_lshlrev_b32 v6, 3, v6
s_lshl_b32 s66, s62, 7
buffer_load_dwordx2 v[232:233], v6, s[4:7], s66 offen offset:0
buffer_load_dwordx2 v[234:235], v6, s[4:7], s66 offen offset:32
buffer_load_dwordx2 v[236:237], v6, s[4:7], s66 offen offset:64
buffer_load_dwordx2 v[238:239], v6, s[4:7], s66 offen offset:96
v_and_b32 v6, 31, v0
v_lshrrev_b32 v7, 5, v0
v_lshlrev_b32 v7, 3, v7
v_sub_u32 v6, v6, v7
v_mov_b32 v7, 0xf149f2ca
v_cmp_le_i32 vcc, 0, v6
s_nop 1
v_cndmask_b32 v216, 0, v7, vcc
v_cmp_le_i32 vcc, 1, v6
s_nop 1
v_cndmask_b32 v217, 0, v7, vcc
v_cmp_le_i32 vcc, 2, v6
s_nop 1
v_cndmask_b32 v218, 0, v7, vcc
v_cmp_le_i32 vcc, 3, v6
s_nop 1
v_cndmask_b32 v219, 0, v7, vcc
v_cmp_le_i32 vcc, 16, v6
s_nop 1
v_cndmask_b32 v220, 0, v7, vcc
v_cmp_le_i32 vcc, 17, v6
s_nop 1
v_cndmask_b32 v221, 0, v7, vcc
v_cmp_le_i32 vcc, 18, v6
s_nop 1
v_cndmask_b32 v222, 0, v7, vcc
v_cmp_le_i32 vcc, 19, v6
s_nop 1
v_cndmask_b32 v223, 0, v7, vcc
v_cmp_le_i32 vcc, 4, v6
s_nop 1
v_cndmask_b32 v224, 0, v7, vcc
v_cmp_le_i32 vcc, 5, v6
s_nop 1
v_cndmask_b32 v225, 0, v7, vcc
v_cmp_le_i32 vcc, 6, v6
s_nop 1
v_cndmask_b32 v226, 0, v7, vcc
v_cmp_le_i32 vcc, 7, v6
s_nop 1
v_cndmask_b32 v227, 0, v7, vcc
v_cmp_le_i32 vcc, 20, v6
s_nop 1
v_cndmask_b32 v228, 0, v7, vcc
v_cmp_le_i32 vcc, 21, v6
s_nop 1
v_cndmask_b32 v229, 0, v7, vcc
v_cmp_le_i32 vcc, 22, v6
s_nop 1
v_cndmask_b32 v230, 0, v7, vcc
v_cmp_le_i32 vcc, 23, v6
s_nop 1
v_cndmask_b32 v231, 0, v7, vcc
v_lshrrev_b32 v6, 2, v0
v_xor_b32 v6, v6, v0
v_and_b32 v6, 4, v6
v_mov_b32 v7, 0x3f803f80
v_cmp_eq_u32 vcc, 0, v6
s_nop 1
v_cndmask_b32 v212, 0, v7, vcc
v_cndmask_b32 v213, 0, v7, vcc
v_cndmask_b32 v214, 0, v7, vcc
v_cndmask_b32 v215, 0, v7, vcc
v_lshrrev_b32 v196, 4, v0
s_cmp_eq_u32 0, 0
s_cbranch_scc0 mq_125
v_bfe_u32 v197, v0, 1, 3
v_xor_b32 v197, v197, v196
v_lshlrev_b32 v197, 4, v197
v_and_b32 v198, 15, v0
v_lshl_add_u32 v192, v198, 7, v197
v_xor_b32 v193, 64, v192
s_branch mq_126
mq_125:
v_lshlrev_b32 v192, 4, v0
v_add_u32 v193, 1024, v192
mq_126:
s_lshl_b32 s46, s65, 13
s_add_u32 s46, s46, 86016
v_add_u32 v192, s46, v192
v_add_u32 v193, s46, v193
v_bfe_u32 v197, v0, 2, 2
v_lshl_add_u32 v197, v196, 3, v197
v_bfe_u32 v198, v0, 3, 2
s_lshl_b32 s46, s64, 1
v_xor_b32 v198, s46, v198
v_lshlrev_b32 v198, 5, v198
v_lshl_add_u32 v197, v197, 7, v198
v_and_b32 v198, 3, v0
v_lshl_add_u32 v197, v198, 3, v197
v_add_u32 v194, 102400, v197
v_xor_b32 v195, 32, v194
v_mov_b32 v197, 0xf149f2ca
v_xor_b32 v216, v197, v216
v_xor_b32 v217, v197, v217
v_xor_b32 v218, v197, v218
v_xor_b32 v219, v197, v219
v_xor_b32 v220, v197, v220
v_xor_b32 v221, v197, v221
v_xor_b32 v222, v197, v222
v_xor_b32 v223, v197, v223
v_xor_b32 v224, v197, v224
v_xor_b32 v225, v197, v225
v_xor_b32 v226, v197, v226
v_xor_b32 v227, v197, v227
v_xor_b32 v228, v197, v228
v_xor_b32 v229, v197, v229
v_xor_b32 v230, v197, v230
v_xor_b32 v231, v197, v231
v_and_b32 v196, 15, v0
v_lshrrev_b32 v197, 4, v0
s_lshl_b32 s46, s65, 8
s_add_u32 s46, s46, 1280
s_mul_i32 s47, s64, 384
v_lshl_add_u32 v208, v196, 2, s46
v_lshl_add_u32 v209, v197, 4, s46
v_lshl_add_u32 v210, v196, 2, s47
v_lshl_add_u32 v211, v197, 4, s47
v_and_b32 v198, 1, v197
v_lshrrev_b32 v197, 1, v197
v_lshlrev_b32 v197, 9, v197
v_lshl_add_u32 v197, v198, 10, v197
s_lshl_b32 s46, s64, 12
s_lshl_b32 s47, s65, 13
s_add_u32 s46, s46, 131072
s_add_u32 s48, s46, 24576
s_sub_u32 s48, s48, s47
s_add_u32 s47, s46, s47
v_lshl_add_u32 v200, v196, 4, v197
v_and_b32 v198, 3, v0
v_lshl_add_u32 v197, v198, 4, v197
v_bfe_u32 v198, v0, 3, 1
v_lshl_add_u32 v197, v198, 6, v197
v_bfe_u32 v198, v0, 2, 1
v_lshl_add_u32 v198, v198, 8, v197
v_add_u32 v199, s48, v198
v_add_u32 v198, s47, v198
v_add_u32 v201, s48, v200
v_add_u32 v200, s47, v200
s_lshl_b32 s46, s59, 4
s_add_u32 s46, s46, s60
s_lshl_b32 s50, s59, 7
s_add_u32 s50, s50, s60
s_lshl_b32 s50, s50, 7
s_lshl_b32 s46, s46, 15
s_lshl_b32 s47, 0, 23
s_add_u32 s46, s46, s47
s_add_u32 s49, s46, 917504
L_mtop:
v_mov_b32 v6, v192
v_mov_b32 v7, v193
v_mov_b32 v8, v194
v_mov_b32 v9, v195
v_mov_b32 v12, v198
v_mov_b32 v13, v199
v_mov_b32 v14, v200
v_mov_b32 v15, v201
s_mov_b32 s71, s49
s_mov_b32 s72, s50
v_add_u32 v4, s34, 1
s_mov_b32 s66, 14
s_mov_b32 s67, -40960
s_mov_b32 s68, -40960
s_mov_b32 s69, 81920
s_add_u32 s35, s34, 1
lw_127:
ds_read_b32 v5, v2 offset:16
s_waitcnt lgkmcnt(0)
v_cmp_gt_i32 vcc, s35, v5
s_cbranch_vccz lwd_128
s_sub_u32 s32, s32, 1
s_cmp_gt_i32 s32, 0
s_cbranch_scc1 lw_127
lwd_128:
ds_read_b64_tr_b16 v[144:145], v8 offset:8192
ds_read_b64_tr_b16 v[146:147], v8 offset:8704
ds_read_b64_tr_b16 v[148:149], v8 offset:12288
ds_read_b64_tr_b16 v[150:151], v8 offset:12800
ds_read_b128 v[112:115], v6 offset:0
ds_read_b128 v[116:119], v7 offset:0
ds_read_b64_tr_b16 v[152:153], v9 offset:8192
ds_read_b64_tr_b16 v[154:155], v9 offset:8704
ds_read_b64_tr_b16 v[156:157], v9 offset:12288
ds_read_b64_tr_b16 v[158:159], v9 offset:12800
ds_read_b128 v[120:123], v6 offset:2048
ds_read_b128 v[124:127], v7 offset:2048
ds_read_b128 v[128:131], v6 offset:4096
ds_read_b128 v[132:135], v7 offset:4096
ds_read_b128 v[136:139], v6 offset:6144
ds_read_b128 v[140:143], v7 offset:6144
s_waitcnt lgkmcnt(11)
v_mfma_f32_16x16x32_bf16 v[16:19], v[144:147], v[112:115], 0
ds_read_b64_tr_b16 v[160:161], v8 offset:16384
s_waitcnt lgkmcnt(11)
v_mfma_f32_16x16x32_bf16 v[16:19], v[148:151], v[116:119], v[16:19]
ds_read_b64_tr_b16 v[162:163], v8 offset:16896
s_waitcnt lgkmcnt(10)
v_mfma_f32_16x16x32_bf16 v[20:23], v[152:155], v[112:115], 0
ds_read_b64_tr_b16 v[164:165], v8 offset:20480
s_waitcnt lgkmcnt(9)
v_mfma_f32_16x16x32_bf16 v[20:23], v[156:159], v[116:119], v[20:23]
ds_read_b64_tr_b16 v[166:167], v8 offset:20992
s_waitcnt lgkmcnt(9)
v_mfma_f32_16x16x32_bf16 v[24:27], v[144:147], v[120:123], 0
ds_read_b64_tr_b16 v[168:169], v9 offset:16384
s_waitcnt lgkmcnt(9)
v_mfma_f32_16x16x32_bf16 v[24:27], v[148:151], v[124:127], v[24:27]
ds_read_b64_tr_b16 v[170:171], v9 offset:16896
v_mfma_f32_16x16x32_bf16 v[28:31], v[152:155], v[120:123], 0
ds_read_b64_tr_b16 v[172:173], v9 offset:20480
v_mfma_f32_16x16x32_bf16 v[28:31], v[156:159], v[124:127], v[28:31]
ds_read_b64_tr_b16 v[174:175], v9 offset:20992
s_waitcnt lgkmcnt(11)
v_mfma_f32_16x16x32_bf16 v[32:35], v[144:147], v[128:131], 0
ds_read_b64_tr_b16 v[176:177], v8 offset:0
s_waitcnt lgkmcnt(11)
v_mfma_f32_16x16x32_bf16 v[32:35], v[148:151], v[132:135], v[32:35]
ds_read_b64_tr_b16 v[178:179], v8 offset:512
v_mfma_f32_16x16x32_bf16 v[36:39], v[152:155], v[128:131], 0
ds_read_b64_tr_b16 v[180:181], v8 offset:4096
v_mfma_f32_16x16x32_bf16 v[36:39], v[156:159], v[132:135], v[36:39]
ds_read_b64_tr_b16 v[182:183], v8 offset:4608
s_waitcnt lgkmcnt(13)
v_mfma_f32_16x16x32_bf16 v[40:43], v[144:147], v[136:139], 0
ds_read_b64_tr_b16 v[184:185], v9 offset:0
s_waitcnt lgkmcnt(13)
v_mfma_f32_16x16x32_bf16 v[40:43], v[148:151], v[140:143], v[40:43]
ds_read_b64_tr_b16 v[186:187], v9 offset:512
v_mfma_f32_16x16x32_bf16 v[44:47], v[152:155], v[136:139], 0
ds_read_b64_tr_b16 v[188:189], v9 offset:4096
v_mfma_f32_16x16x32_bf16 v[44:47], v[156:159], v[140:143], v[44:47]
ds_read_b64_tr_b16 v[190:191], v9 offset:4608
s_waitcnt lgkmcnt(14)
v_mfma_f32_16x16x32_bf16 v[48:51], v[112:115], v[160:163], 0
s_mov_b64 exec, 1
ds_write_b32 v3, v4
s_mov_b64 exec, -1
s_waitcnt lgkmcnt(13)
v_mfma_f32_16x16x32_bf16 v[48:51], v[116:119], v[164:167], v[48:51]
v_add_u32 v8, s67, v8
v_add_u32 v9, s67, v9
s_waitcnt lgkmcnt(11)
v_mfma_f32_16x16x32_bf16 v[52:55], v[112:115], v[168:171], 0
v_add_u32 v6, s67, v6
v_add_u32 v7, s67, v7
s_waitcnt lgkmcnt(9)
v_mfma_f32_16x16x32_bf16 v[52:55], v[116:119], v[172:175], v[52:55]
s_mov_b32 s70, s67
s_mov_b32 s67, s68
s_mov_b32 s68, s69
s_mov_b32 s69, s70
v_mfma_f32_16x16x32_bf16 v[56:59], v[120:123], v[160:163], 0
ds_read_b32 v5, v2 offset:16
v_mfma_f32_16x16x32_bf16 v[56:59], v[124:127], v[164:167], v[56:59]
v_mfma_f32_16x16x32_bf16 v[60:63], v[120:123], v[168:171], 0
v_mfma_f32_16x16x32_bf16 v[60:63], v[124:127], v[172:175], v[60:63]
v_mfma_f32_16x16x32_bf16 v[64:67], v[128:131], v[160:163], 0
s_waitcnt lgkmcnt(0)
v_cmp_ge_u32 vcc, v4, v5
s_cbranch_vccnz mspin_132
mback_133:
v_add_u32 v4, 1, v4
v_mfma_f32_16x16x32_bf16 v[64:67], v[132:135], v[164:167], v[64:67]
ds_read_b64_tr_b16 v[144:145], v8 offset:8192
v_mfma_f32_16x16x32_bf16 v[68:71], v[128:131], v[168:171], 0
ds_read_b64_tr_b16 v[146:147], v8 offset:8704
v_mfma_f32_16x16x32_bf16 v[68:71], v[132:135], v[172:175], v[68:71]
ds_read_b64_tr_b16 v[148:149], v8 offset:12288
v_mfma_f32_16x16x32_bf16 v[72:75], v[136:139], v[160:163], 0
ds_read_b64_tr_b16 v[150:151], v8 offset:12800
v_mfma_f32_16x16x32_bf16 v[72:75], v[140:143], v[164:167], v[72:75]
ds_read_b64_tr_b16 v[152:153], v9 offset:8192
v_mfma_f32_16x16x32_bf16 v[76:79], v[136:139], v[168:171], 0
ds_read_b64_tr_b16 v[154:155], v9 offset:8704
v_mfma_f32_16x16x32_bf16 v[76:79], v[140:143], v[172:175], v[76:79]
ds_read_b64_tr_b16 v[156:157], v9 offset:12288
v_mfma_f32_16x16x32_bf16 v[80:83], v[176:179], v[112:115], 0
ds_read_b64_tr_b16 v[158:159], v9 offset:12800
v_mfma_f32_16x16x32_bf16 v[80:83], v[180:183], v[116:119], v[80:83]
v_mfma_f32_16x16x32_bf16 v[84:87], v[184:187], v[112:115], 0
v_mfma_f32_16x16x32_bf16 v[84:87], v[188:191], v[116:119], v[84:87]
ds_read_b128 v[112:115], v6 offset:0
ds_read_b128 v[116:119], v7 offset:0
v_mfma_f32_16x16x32_bf16 v[88:91], v[176:179], v[120:123], 0
v_mfma_f32_16x16x32_bf16 v[88:91], v[180:183], v[124:127], v[88:91]
v_mfma_f32_16x16x32_bf16 v[92:95], v[184:187], v[120:123], 0
v_mfma_f32_16x16x32_bf16 v[92:95], v[188:191], v[124:127], v[92:95]
ds_read_b128 v[120:123], v6 offset:2048
ds_read_b128 v[124:127], v7 offset:2048
v_mfma_f32_16x16x32_bf16 v[96:99], v[176:179], v[128:131], 0
v_mfma_f32_16x16x32_bf16 v[96:99], v[180:183], v[132:135], v[96:99]
v_mfma_f32_16x16x32_bf16 v[100:103], v[184:187], v[128:131], 0
v_mfma_f32_16x16x32_bf16 v[100:103], v[188:191], v[132:135], v[100:103]
ds_read_b128 v[128:131], v6 offset:4096
ds_read_b128 v[132:135], v7 offset:4096
v_mfma_f32_16x16x32_bf16 v[104:107], v[176:179], v[136:139], 0
v_mfma_f32_16x16x32_bf16 v[104:107], v[180:183], v[140:143], v[104:107]
v_mfma_f32_16x16x32_bf16 v[108:111], v[184:187], v[136:139], 0
v_mfma_f32_16x16x32_bf16 v[108:111], v[188:191], v[140:143], v[108:111]
ds_read_b128 v[136:139], v6 offset:6144
ds_read_b128 v[140:143], v7 offset:6144
.p2align 6
mqkv_129:
s_waitcnt lgkmcnt(7)
v_mfma_f32_16x16x32_bf16 v[16:19], v[144:147], v[112:115], v[16:19]
ds_read_b64_tr_b16 v[160:161], v8 offset:16384
s_waitcnt lgkmcnt(7)
v_mfma_f32_16x16x32_bf16 v[16:19], v[148:151], v[116:119], v[16:19]
ds_read_b64_tr_b16 v[162:163], v8 offset:16896
v_mfma_f32_16x16x32_bf16 v[20:23], v[152:155], v[112:115], v[20:23]
ds_read_b64_tr_b16 v[164:165], v8 offset:20480
v_mfma_f32_16x16x32_bf16 v[20:23], v[156:159], v[116:119], v[20:23]
ds_read_b64_tr_b16 v[166:167], v8 offset:20992
s_waitcnt lgkmcnt(9)
v_mfma_f32_16x16x32_bf16 v[24:27], v[144:147], v[120:123], v[24:27]
ds_read_b64_tr_b16 v[168:169], v9 offset:16384
s_waitcnt lgkmcnt(9)
v_mfma_f32_16x16x32_bf16 v[24:27], v[148:151], v[124:127], v[24:27]
ds_read_b64_tr_b16 v[170:171], v9 offset:16896
v_mfma_f32_16x16x32_bf16 v[28:31], v[152:155], v[120:123], v[28:31]
ds_read_b64_tr_b16 v[172:173], v9 offset:20480
v_mfma_f32_16x16x32_bf16 v[28:31], v[156:159], v[124:127], v[28:31]
ds_read_b64_tr_b16 v[174:175], v9 offset:20992
s_waitcnt lgkmcnt(11)
v_mfma_f32_16x16x32_bf16 v[32:35], v[144:147], v[128:131], v[32:35]
ds_read_b64_tr_b16 v[176:177], v8 offset:0
s_waitcnt lgkmcnt(11)
v_mfma_f32_16x16x32_bf16 v[32:35], v[148:151], v[132:135], v[32:35]
ds_read_b64_tr_b16 v[178:179], v8 offset:512
v_mfma_f32_16x16x32_bf16 v[36:39], v[152:155], v[128:131], v[36:39]
ds_read_b64_tr_b16 v[180:181], v8 offset:4096
v_mfma_f32_16x16x32_bf16 v[36:39], v[156:159], v[132:135], v[36:39]
ds_read_b64_tr_b16 v[182:183], v8 offset:4608
s_waitcnt lgkmcnt(13)
v_mfma_f32_16x16x32_bf16 v[40:43], v[144:147], v[136:139], v[40:43]
ds_read_b64_tr_b16 v[184:185], v9 offset:0
s_waitcnt lgkmcnt(13)
v_mfma_f32_16x16x32_bf16 v[40:43], v[148:151], v[140:143], v[40:43]
ds_read_b64_tr_b16 v[186:187], v9 offset:512
v_mfma_f32_16x16x32_bf16 v[44:47], v[152:155], v[136:139], v[44:47]
ds_read_b64_tr_b16 v[188:189], v9 offset:4096
v_mfma_f32_16x16x32_bf16 v[44:47], v[156:159], v[140:143], v[44:47]
ds_read_b64_tr_b16 v[190:191], v9 offset:4608
s_waitcnt lgkmcnt(14)
v_mfma_f32_16x16x32_bf16 v[48:51], v[112:115], v[160:163], v[48:51]
s_mov_b64 exec, 1
ds_write_b32 v3, v4
s_mov_b64 exec, -1
s_waitcnt lgkmcnt(13)
v_mfma_f32_16x16x32_bf16 v[48:51], v[116:119], v[164:167], v[48:51]
v_add_u32 v8, s67, v8
v_add_u32 v9, s67, v9
s_waitcnt lgkmcnt(11)
v_mfma_f32_16x16x32_bf16 v[52:55], v[112:115], v[168:171], v[52:55]
v_add_u32 v6, s67, v6
v_add_u32 v7, s67, v7
s_waitcnt lgkmcnt(9)
v_mfma_f32_16x16x32_bf16 v[52:55], v[116:119], v[172:175], v[52:55]
s_mov_b32 s70, s67
s_mov_b32 s67, s68
s_mov_b32 s68, s69
s_mov_b32 s69, s70
v_mfma_f32_16x16x32_bf16 v[56:59], v[120:123], v[160:163], v[56:59]
ds_read_b32 v5, v2 offset:16
v_mfma_f32_16x16x32_bf16 v[56:59], v[124:127], v[164:167], v[56:59]
v_mfma_f32_16x16x32_bf16 v[60:63], v[120:123], v[168:171], v[60:63]
v_mfma_f32_16x16x32_bf16 v[60:63], v[124:127], v[172:175], v[60:63]
v_mfma_f32_16x16x32_bf16 v[64:67], v[128:131], v[160:163], v[64:67]
s_waitcnt lgkmcnt(0)
v_cmp_ge_u32 vcc, v4, v5
s_cbranch_vccnz mspin_130
mback_131:
v_add_u32 v4, 1, v4
v_mfma_f32_16x16x32_bf16 v[64:67], v[132:135], v[164:167], v[64:67]
ds_read_b64_tr_b16 v[144:145], v8 offset:8192
v_mfma_f32_16x16x32_bf16 v[68:71], v[128:131], v[168:171], v[68:71]
ds_read_b64_tr_b16 v[146:147], v8 offset:8704
v_mfma_f32_16x16x32_bf16 v[68:71], v[132:135], v[172:175], v[68:71]
ds_read_b64_tr_b16 v[148:149], v8 offset:12288
v_mfma_f32_16x16x32_bf16 v[72:75], v[136:139], v[160:163], v[72:75]
ds_read_b64_tr_b16 v[150:151], v8 offset:12800
v_mfma_f32_16x16x32_bf16 v[72:75], v[140:143], v[164:167], v[72:75]
ds_read_b64_tr_b16 v[152:153], v9 offset:8192
v_mfma_f32_16x16x32_bf16 v[76:79], v[136:139], v[168:171], v[76:79]
ds_read_b64_tr_b16 v[154:155], v9 offset:8704
v_mfma_f32_16x16x32_bf16 v[76:79], v[140:143], v[172:175], v[76:79]
ds_read_b64_tr_b16 v[156:157], v9 offset:12288
v_mfma_f32_16x16x32_bf16 v[80:83], v[176:179], v[112:115], v[80:83]
ds_read_b64_tr_b16 v[158:159], v9 offset:12800
v_mfma_f32_16x16x32_bf16 v[80:83], v[180:183], v[116:119], v[80:83]
v_mfma_f32_16x16x32_bf16 v[84:87], v[184:187], v[112:115], v[84:87]
v_mfma_f32_16x16x32_bf16 v[84:87], v[188:191], v[116:119], v[84:87]
ds_read_b128 v[112:115], v6 offset:0
ds_read_b128 v[116:119], v7 offset:0
v_mfma_f32_16x16x32_bf16 v[88:91], v[176:179], v[120:123], v[88:91]
v_mfma_f32_16x16x32_bf16 v[88:91], v[180:183], v[124:127], v[88:91]
v_mfma_f32_16x16x32_bf16 v[92:95], v[184:187], v[120:123], v[92:95]
v_mfma_f32_16x16x32_bf16 v[92:95], v[188:191], v[124:127], v[92:95]
ds_read_b128 v[120:123], v6 offset:2048
ds_read_b128 v[124:127], v7 offset:2048
v_mfma_f32_16x16x32_bf16 v[96:99], v[176:179], v[128:131], v[96:99]
v_mfma_f32_16x16x32_bf16 v[96:99], v[180:183], v[132:135], v[96:99]
v_mfma_f32_16x16x32_bf16 v[100:103], v[184:187], v[128:131], v[100:103]
v_mfma_f32_16x16x32_bf16 v[100:103], v[188:191], v[132:135], v[100:103]
ds_read_b128 v[128:131], v6 offset:4096
ds_read_b128 v[132:135], v7 offset:4096
v_mfma_f32_16x16x32_bf16 v[104:107], v[176:179], v[136:139], v[104:107]
v_mfma_f32_16x16x32_bf16 v[104:107], v[180:183], v[140:143], v[104:107]
s_sub_u32 s66, s66, 1
s_cmp_eq_u32 s66, 0
v_mfma_f32_16x16x32_bf16 v[108:111], v[184:187], v[136:139], v[108:111]
v_mfma_f32_16x16x32_bf16 v[108:111], v[188:191], v[140:143], v[108:111]
ds_read_b128 v[136:139], v6 offset:6144
ds_read_b128 v[140:143], v7 offset:6144
s_cbranch_scc0 mqkv_129
s_waitcnt lgkmcnt(7)
v_mfma_f32_16x16x32_bf16 v[16:19], v[144:147], v[112:115], v[16:19]
ds_read_b32 v5, v2 offset:24
s_add_u32 s35, s34, 2
v_mov_b32 v6, 0
ds_read_b64_tr_b16 v[160:161], v8 offset:16384
s_waitcnt lgkmcnt(8)
v_mfma_f32_16x16x32_bf16 v[16:19], v[148:151], v[116:119], v[16:19]
ds_read_b64_tr_b16 v[162:163], v8 offset:16896
v_mfma_f32_16x16x32_bf16 v[20:23], v[152:155], v[112:115], v[20:23]
ds_read_b64_tr_b16 v[164:165], v8 offset:20480
v_mfma_f32_16x16x32_bf16 v[20:23], v[156:159], v[116:119], v[20:23]
ds_read_b64_tr_b16 v[166:167], v8 offset:20992
s_waitcnt lgkmcnt(10)
v_mfma_f32_16x16x32_bf16 v[24:27], v[144:147], v[120:123], v[24:27]
ds_read_b64_tr_b16 v[168:169], v9 offset:16384
s_waitcnt lgkmcnt(10)
v_mfma_f32_16x16x32_bf16 v[24:27], v[148:151], v[124:127], v[24:27]
ds_read_b64_tr_b16 v[170:171], v9 offset:16896
v_mfma_f32_16x16x32_bf16 v[28:31], v[152:155], v[120:123], v[28:31]
ds_read_b64_tr_b16 v[172:173], v9 offset:20480
s_waitcnt lgkmcnt(7)
v_cmp_gt_i32 vcc, s35, v5
s_cbranch_vccnz lspin_134
lback_135:
ds_read2_b32 v[6:7], v6 offset0:8 offset1:14
ds_read_b128 v[200:203], v211 offset:2432
v_mfma_f32_16x16x32_bf16 v[28:31], v[156:159], v[124:127], v[28:31]
ds_read_b64_tr_b16 v[174:175], v9 offset:20992
ds_read_b128 v[204:207], v211 offset:2496
ds_read2_b32 v[192:193], v208 offset0:0 offset1:128
v_mfma_f32_16x16x32_bf16 v[32:35], v[144:147], v[128:131], v[32:35]
ds_read2_b32 v[194:195], v208 offset0:16 offset1:144
v_mfma_f32_16x16x32_bf16 v[32:35], v[148:151], v[132:135], v[32:35]
ds_read2_b32 v[196:197], v208 offset0:32 offset1:160
ds_read2_b32 v[198:199], v208 offset0:48 offset1:176
v_mfma_f32_16x16x32_bf16 v[36:39], v[152:155], v[128:131], v[36:39]
ds_read_b64_tr_b16 v[176:177], v8 offset:0
ds_read_b64_tr_b16 v[178:179], v8 offset:512
v_mfma_f32_16x16x32_bf16 v[36:39], v[156:159], v[132:135], v[36:39]
ds_read_b64_tr_b16 v[180:181], v8 offset:4096
v_mfma_f32_16x16x32_bf16 v[40:43], v[144:147], v[136:139], v[40:43]
ds_read_b64_tr_b16 v[182:183], v8 offset:4608
ds_read_b64_tr_b16 v[184:185], v9 offset:0
v_mfma_f32_16x16x32_bf16 v[40:43], v[148:151], v[140:143], v[40:43]
ds_read_b64_tr_b16 v[186:187], v9 offset:512
ds_read_b64_tr_b16 v[188:189], v9 offset:4096
v_mfma_f32_16x16x32_bf16 v[44:47], v[152:155], v[136:139], v[44:47]
ds_read_b64_tr_b16 v[190:191], v9 offset:4608
v_mfma_f32_16x16x32_bf16 v[44:47], v[156:159], v[140:143], v[44:47]
s_mov_b64 exec, 1
ds_write_b32 v3, v4
s_mov_b64 exec, -1
s_waitcnt lgkmcnt(14)
v_readfirstlane_b32 s33, v6
v_readfirstlane_b32 s57, v7
s_sub_u32 s33, s33, 1
s_lshr_b32 s66, s33, 7
s_mov_b32 s73, -1
v_mfma_f32_16x16x32_bf16 v[48:51], v[112:115], v[160:163], v[48:51]
s_cmp_eq_u32 s66, s59
s_cbranch_scc1 patch_136
pback_137:
v_mfma_f32_16x16x32_bf16 v[48:51], v[116:119], v[164:167], v[48:51]
ds_read_b32 v10, v210 offset:2560
ds_read_b32 v11, v210 offset:2624
s_waitcnt lgkmcnt(14)
v_mul_f32 v16, v16, v192
v_mul_f32 v17, v17, v192
v_mul_f32 v18, v18, v192
v_mfma_f32_16x16x32_bf16 v[52:55], v[112:115], v[168:171], v[52:55]
v_mul_f32 v19, v19, v192
v_mul_f32 v20, v20, v192
v_mul_f32 v21, v21, v192
v_mul_f32 v22, v22, v192
v_mul_f32 v23, v23, v192
v_mfma_f32_16x16x32_bf16 v[52:55], v[116:119], v[172:175], v[52:55]
v_fmac_f32 v16, v200, v193
v_fmac_f32 v17, v201, v193
v_fmac_f32 v18, v202, v193
v_fmac_f32 v19, v203, v193
v_fmac_f32 v20, v204, v193
v_mfma_f32_16x16x32_bf16 v[56:59], v[120:123], v[160:163], v[56:59]
v_fmac_f32 v21, v205, v193
v_fmac_f32 v22, v206, v193
v_fmac_f32 v23, v207, v193
v_cvt_pk_bf16_f32 v16, v16, v17
v_cvt_pk_bf16_f32 v17, v18, v19
v_mfma_f32_16x16x32_bf16 v[56:59], v[124:127], v[164:167], v[56:59]
v_cvt_pk_bf16_f32 v18, v20, v21
v_cvt_pk_bf16_f32 v19, v22, v23
buffer_store_dwordx4 v[16:19], v12, s[20:23], s71 offen offset:0 sc1
ds_write_b128 v12, v[16:19] offset:0
ds_read_b128 v[144:147], v209 offset:0
v_mfma_f32_16x16x32_bf16 v[60:63], v[120:123], v[168:171], v[60:63]
ds_read_b128 v[20:23], v209 offset:512
s_waitcnt lgkmcnt(14)
v_mul_f32 v24, v24, v194
v_mul_f32 v25, v25, v194
v_mul_f32 v26, v26, v194
v_mul_f32 v27, v27, v194
v_mfma_f32_16x16x32_bf16 v[60:63], v[124:127], v[172:175], v[60:63]
v_mul_f32 v28, v28, v194
v_mul_f32 v29, v29, v194
v_mul_f32 v30, v30, v194
v_mul_f32 v31, v31, v194
v_fmac_f32 v24, v200, v195
v_mfma_f32_16x16x32_bf16 v[64:67], v[128:131], v[160:163], v[64:67]
v_fmac_f32 v25, v201, v195
v_fmac_f32 v26, v202, v195
v_fmac_f32 v27, v203, v195
v_fmac_f32 v28, v204, v195
v_mfma_f32_16x16x32_bf16 v[64:67], v[132:135], v[164:167], v[64:67]
v_fmac_f32 v29, v205, v195
v_fmac_f32 v30, v206, v195
v_fmac_f32 v31, v207, v195
v_cvt_pk_bf16_f32 v24, v24, v25
v_cvt_pk_bf16_f32 v25, v26, v27
v_mfma_f32_16x16x32_bf16 v[68:71], v[128:131], v[168:171], v[68:71]
v_cvt_pk_bf16_f32 v26, v28, v29
v_cvt_pk_bf16_f32 v27, v30, v31
buffer_store_dwordx4 v[24:27], v12, s[20:23], s71 offen offset:128 sc1
ds_write_b128 v12, v[24:27] offset:128
ds_read_b128 v[148:151], v209 offset:64
v_mfma_f32_16x16x32_bf16 v[68:71], v[132:135], v[172:175], v[68:71]
ds_read_b128 v[28:31], v209 offset:576
v_mul_f32 v32, v32, v196
v_mul_f32 v33, v33, v196
v_mul_f32 v34, v34, v196
v_mul_f32 v35, v35, v196
v_mfma_f32_16x16x32_bf16 v[72:75], v[136:139], v[160:163], v[72:75]
v_mul_f32 v36, v36, v196
v_mul_f32 v37, v37, v196
v_mul_f32 v38, v38, v196
v_mul_f32 v39, v39, v196
v_fmac_f32 v32, v200, v197
v_mfma_f32_16x16x32_bf16 v[72:75], v[140:143], v[164:167], v[72:75]
v_fmac_f32 v33, v201, v197
v_fmac_f32 v34, v202, v197
v_fmac_f32 v35, v203, v197
v_fmac_f32 v36, v204, v197
v_fmac_f32 v37, v205, v197
v_mfma_f32_16x16x32_bf16 v[76:79], v[136:139], v[168:171], v[76:79]
v_fmac_f32 v38, v206, v197
v_fmac_f32 v39, v207, v197
v_cvt_pk_bf16_f32 v32, v32, v33
v_cvt_pk_bf16_f32 v33, v34, v35
v_cvt_pk_bf16_f32 v34, v36, v37
v_mfma_f32_16x16x32_bf16 v[76:79], v[140:143], v[172:175], v[76:79]
v_cvt_pk_bf16_f32 v35, v38, v39
buffer_store_dwordx4 v[32:35], v13, s[20:23], s71 offen offset:0 sc1
ds_write_b128 v13, v[32:35] offset:0
ds_read_b128 v[152:155], v209 offset:128
ds_read_b128 v[36:39], v209 offset:640
v_mul_f32 v40, v40, v198
v_mul_f32 v41, v41, v198
v_mul_f32 v42, v42, v198
v_mul_f32 v43, v43, v198
v_mul_f32 v44, v44, v198
v_mul_f32 v45, v45, v198
v_mul_f32 v46, v46, v198
v_mul_f32 v47, v47, v198
v_fmac_f32 v40, v200, v199
v_fmac_f32 v41, v201, v199
v_fmac_f32 v42, v202, v199
v_fmac_f32 v43, v203, v199
v_fmac_f32 v44, v204, v199
v_fmac_f32 v45, v205, v199
v_fmac_f32 v46, v206, v199
v_fmac_f32 v47, v207, v199
v_cvt_pk_bf16_f32 v40, v40, v41
v_cvt_pk_bf16_f32 v41, v42, v43
v_cvt_pk_bf16_f32 v42, v44, v45
v_cvt_pk_bf16_f32 v43, v46, v47
buffer_store_dwordx4 v[40:43], v13, s[20:23], s71 offen offset:128 sc1
ds_write_b128 v13, v[40:43] offset:128
ds_read_b128 v[156:159], v209 offset:192
ds_read_b128 v[44:47], v209 offset:704
s_cmp_ge_i32 s73, 0
s_cbranch_scc1 patch_138
pback_139:
ds_read_b128 v[160:163], v211 offset:2304
ds_read_b128 v[164:167], v211 offset:2368
s_waitcnt lgkmcnt(12)
v_pk_mul_f32 v[48:49], v[48:49], v[144:145]
v_pk_mul_f32 v[50:51], v[50:51], v[146:147]
s_waitcnt lgkmcnt(11)
v_pk_fma_f32 v[48:49], v[20:21], v[10:11], v[48:49] op_sel:[0,0,0] op_sel_hi:[1,0,1]
v_pk_fma_f32 v[50:51], v[22:23], v[10:11], v[50:51] op_sel:[0,0,0] op_sel_hi:[1,0,1]
s_waitcnt lgkmcnt(9)
v_pk_mul_f32 v[56:57], v[56:57], v[148:149]
v_pk_mul_f32 v[58:59], v[58:59], v[150:151]
s_waitcnt lgkmcnt(8)
v_pk_fma_f32 v[56:57], v[28:29], v[10:11], v[56:57] op_sel:[0,0,0] op_sel_hi:[1,0,1]
v_pk_fma_f32 v[58:59], v[30:31], v[10:11], v[58:59] op_sel:[0,0,0] op_sel_hi:[1,0,1]
v_cvt_pk_bf16_f32 v48, v48, v49
v_cvt_pk_bf16_f32 v49, v50, v51
v_cvt_pk_bf16_f32 v50, v56, v57
v_cvt_pk_bf16_f32 v51, v58, v59
buffer_store_dwordx4 v[48:51], v14, s[20:23], s71 offen offset:2048 sc1
ds_write_b128 v14, v[48:51] offset:2048
v_pk_mul_f32 v[52:53], v[52:53], v[144:145]
v_pk_mul_f32 v[54:55], v[54:55], v[146:147]
v_pk_fma_f32 v[52:53], v[20:21], v[10:11], v[52:53] op_sel:[0,1,0] op_sel_hi:[1,1,1]
v_pk_fma_f32 v[54:55], v[22:23], v[10:11], v[54:55] op_sel:[0,1,0] op_sel_hi:[1,1,1]
v_pk_mul_f32 v[60:61], v[60:61], v[148:149]
v_pk_mul_f32 v[62:63], v[62:63], v[150:151]
v_pk_fma_f32 v[60:61], v[28:29], v[10:11], v[60:61] op_sel:[0,1,0] op_sel_hi:[1,1,1]
v_pk_fma_f32 v[62:63], v[30:31], v[10:11], v[62:63] op_sel:[0,1,0] op_sel_hi:[1,1,1]
v_cvt_pk_bf16_f32 v52, v52, v53
v_cvt_pk_bf16_f32 v53, v54, v55
v_cvt_pk_bf16_f32 v54, v60, v61
v_cvt_pk_bf16_f32 v55, v62, v63
buffer_store_dwordx4 v[52:55], v14, s[20:23], s71 offen offset:2304 sc1
ds_write_b128 v14, v[52:55] offset:2304
s_waitcnt lgkmcnt(8)
v_pk_mul_f32 v[64:65], v[64:65], v[152:153]
v_pk_mul_f32 v[66:67], v[66:67], v[154:155]
s_waitcnt lgkmcnt(7)
v_pk_fma_f32 v[64:65], v[36:37], v[10:11], v[64:65] op_sel:[0,0,0] op_sel_hi:[1,0,1]
v_pk_fma_f32 v[66:67], v[38:39], v[10:11], v[66:67] op_sel:[0,0,0] op_sel_hi:[1,0,1]
s_waitcnt lgkmcnt(5)
v_pk_mul_f32 v[72:73], v[72:73], v[156:157]
v_pk_mul_f32 v[74:75], v[74:75], v[158:159]
s_waitcnt lgkmcnt(4)
v_pk_fma_f32 v[72:73], v[44:45], v[10:11], v[72:73] op_sel:[0,0,0] op_sel_hi:[1,0,1]
v_pk_fma_f32 v[74:75], v[46:47], v[10:11], v[74:75] op_sel:[0,0,0] op_sel_hi:[1,0,1]
v_cvt_pk_bf16_f32 v64, v64, v65
v_cvt_pk_bf16_f32 v65, v66, v67
v_cvt_pk_bf16_f32 v66, v72, v73
v_cvt_pk_bf16_f32 v67, v74, v75
buffer_store_dwordx4 v[64:67], v15, s[20:23], s71 offen offset:2048 sc1
ds_write_b128 v15, v[64:67] offset:2048
v_pk_mul_f32 v[68:69], v[68:69], v[152:153]
v_pk_mul_f32 v[70:71], v[70:71], v[154:155]
v_pk_fma_f32 v[68:69], v[36:37], v[10:11], v[68:69] op_sel:[0,1,0] op_sel_hi:[1,1,1]
v_pk_fma_f32 v[70:71], v[38:39], v[10:11], v[70:71] op_sel:[0,1,0] op_sel_hi:[1,1,1]
v_pk_mul_f32 v[76:77], v[76:77], v[156:157]
v_pk_mul_f32 v[78:79], v[78:79], v[158:159]
v_pk_fma_f32 v[76:77], v[44:45], v[10:11], v[76:77] op_sel:[0,1,0] op_sel_hi:[1,1,1]
v_pk_fma_f32 v[78:79], v[46:47], v[10:11], v[78:79] op_sel:[0,1,0] op_sel_hi:[1,1,1]
v_cvt_pk_bf16_f32 v68, v68, v69
v_cvt_pk_bf16_f32 v69, v70, v71
v_cvt_pk_bf16_f32 v70, v76, v77
v_cvt_pk_bf16_f32 v71, v78, v79
buffer_store_dwordx4 v[68:71], v15, s[20:23], s71 offen offset:2304 sc1
ds_write_b128 v15, v[68:71] offset:2304
v_add_u32 v5, s34, 17
s_mov_b64 exec, 1
ds_write_b32 v3, v5
s_mov_b64 exec, -1
s_mov_b32 s66, 0x3e8293ee
v_mfma_f32_16x16x32_bf16 v[96:99], v[176:179], v[128:131], v[96:99]
v_mul_f32 v192, s66, v192
v_mfma_f32_16x16x32_bf16 v[96:99], v[180:183], v[132:135], v[96:99]
v_mfma_f32_16x16x32_bf16 v[100:103], v[184:187], v[128:131], v[100:103]
v_mul_f32 v193, s66, v193
v_mfma_f32_16x16x32_bf16 v[100:103], v[188:191], v[132:135], v[100:103]
v_mfma_f32_16x16x32_bf16 v[104:107], v[176:179], v[136:139], v[104:107]
v_mul_f32 v194, s66, v194
v_mfma_f32_16x16x32_bf16 v[104:107], v[180:183], v[140:143], v[104:107]
v_mfma_f32_16x16x32_bf16 v[108:111], v[184:187], v[136:139], v[108:111]
v_mul_f32 v195, s66, v195
v_mfma_f32_16x16x32_bf16 v[108:111], v[188:191], v[140:143], v[108:111]
v_mfma_f32_16x16x32_bf16 v[80:83], v[176:179], v[112:115], v[80:83]
v_mul_f32 v196, s66, v196
v_mfma_f32_16x16x32_bf16 v[80:83], v[180:183], v[116:119], v[80:83]
v_mfma_f32_16x16x32_bf16 v[84:87], v[184:187], v[112:115], v[84:87]
v_mul_f32 v197, s66, v197
v_mfma_f32_16x16x32_bf16 v[84:87], v[188:191], v[116:119], v[84:87]
v_mfma_f32_16x16x32_bf16 v[88:91], v[176:179], v[120:123], v[88:91]
v_mul_f32 v198, s66, v198
v_mfma_f32_16x16x32_bf16 v[88:91], v[180:183], v[124:127], v[88:91]
v_mfma_f32_16x16x32_bf16 v[92:95], v[184:187], v[120:123], v[92:95]
v_mul_f32 v199, s66, v199
v_mfma_f32_16x16x32_bf16 v[92:95], v[188:191], v[124:127], v[92:95]
s_cmp_ge_i32 s73, 0
s_cbranch_scc1 patch_140
pback_141:
v_mov_b32 v200, 0
v_mov_b32 v201, 0
v_mov_b32 v202, 0
v_mov_b32 v203, 0
v_mov_b32 v204, 0
v_mov_b32 v205, 0
v_mov_b32 v206, 0
v_mov_b32 v207, 0
v_mov_b32 v208, 0
v_mov_b32 v209, 0
v_mov_b32 v210, 0
v_mov_b32 v211, 0
v_pk_mul_f32 v[96:97], v[96:97], v[196:197] op_sel:[0,0] op_sel_hi:[1,0]
v_pk_mul_f32 v[98:99], v[98:99], v[196:197] op_sel:[0,0] op_sel_hi:[1,0]
v_pk_mul_f32 v[100:101], v[100:101], v[196:197] op_sel:[0,0] op_sel_hi:[1,0]
v_pk_mul_f32 v[102:103], v[102:103], v[196:197] op_sel:[0,0] op_sel_hi:[1,0]
s_waitcnt lgkmcnt(6)
v_pk_fma_f32 v[96:97], v[160:161], v[196:197], v[96:97] op_sel:[0,1,0] op_sel_hi:[1,1,1]
v_pk_fma_f32 v[98:99], v[162:163], v[196:197], v[98:99] op_sel:[0,1,0] op_sel_hi:[1,1,1]
s_waitcnt lgkmcnt(5)
v_pk_fma_f32 v[100:101], v[164:165], v[196:197], v[100:101] op_sel:[0,1,0] op_sel_hi:[1,1,1]
v_pk_fma_f32 v[102:103], v[166:167], v[196:197], v[102:103] op_sel:[0,1,0] op_sel_hi:[1,1,1]
v_cvt_pk_bf16_f32 v96, v96, v97
v_cvt_pk_bf16_f32 v97, v98, v99
v_cvt_pk_bf16_f32 v98, v100, v101
v_cvt_pk_bf16_f32 v99, v102, v103
v_pk_mul_f32 v[104:105], v[104:105], v[198:199] op_sel:[0,0] op_sel_hi:[1,0]
v_pk_mul_f32 v[106:107], v[106:107], v[198:199] op_sel:[0,0] op_sel_hi:[1,0]
v_pk_mul_f32 v[108:109], v[108:109], v[198:199] op_sel:[0,0] op_sel_hi:[1,0]
v_pk_mul_f32 v[110:111], v[110:111], v[198:199] op_sel:[0,0] op_sel_hi:[1,0]
v_pk_fma_f32 v[104:105], v[160:161], v[198:199], v[104:105] op_sel:[0,1,0] op_sel_hi:[1,1,1]
v_pk_fma_f32 v[106:107], v[162:163], v[198:199], v[106:107] op_sel:[0,1,0] op_sel_hi:[1,1,1]
v_pk_fma_f32 v[108:109], v[164:165], v[198:199], v[108:109] op_sel:[0,1,0] op_sel_hi:[1,1,1]
v_pk_fma_f32 v[110:111], v[166:167], v[198:199], v[110:111] op_sel:[0,1,0] op_sel_hi:[1,1,1]
v_cvt_pk_bf16_f32 v104, v104, v105
v_cvt_pk_bf16_f32 v105, v106, v107
v_cvt_pk_bf16_f32 v106, v108, v109
v_cvt_pk_bf16_f32 v107, v110, v111
v_pk_mul_f32 v[80:81], v[80:81], v[192:193] op_sel:[0,0] op_sel_hi:[1,0]
v_pk_mul_f32 v[82:83], v[82:83], v[192:193] op_sel:[0,0] op_sel_hi:[1,0]
v_pk_mul_f32 v[84:85], v[84:85], v[192:193] op_sel:[0,0] op_sel_hi:[1,0]
v_pk_mul_f32 v[86:87], v[86:87], v[192:193] op_sel:[0,0] op_sel_hi:[1,0]
v_pk_fma_f32 v[80:81], v[160:161], v[192:193], v[80:81] op_sel:[0,1,0] op_sel_hi:[1,1,1]
v_pk_fma_f32 v[82:83], v[162:163], v[192:193], v[82:83] op_sel:[0,1,0] op_sel_hi:[1,1,1]
v_pk_fma_f32 v[84:85], v[164:165], v[192:193], v[84:85] op_sel:[0,1,0] op_sel_hi:[1,1,1]
v_pk_fma_f32 v[86:87], v[166:167], v[192:193], v[86:87] op_sel:[0,1,0] op_sel_hi:[1,1,1]
v_cvt_pk_bf16_f32 v80, v80, v81
v_cvt_pk_bf16_f32 v81, v82, v83
v_cvt_pk_bf16_f32 v82, v84, v85
v_cvt_pk_bf16_f32 v83, v86, v87
v_pk_mul_f32 v[88:89], v[88:89], v[194:195] op_sel:[0,0] op_sel_hi:[1,0]
v_pk_mul_f32 v[90:91], v[90:91], v[194:195] op_sel:[0,0] op_sel_hi:[1,0]
v_pk_mul_f32 v[92:93], v[92:93], v[194:195] op_sel:[0,0] op_sel_hi:[1,0]
v_pk_mul_f32 v[94:95], v[94:95], v[194:195] op_sel:[0,0] op_sel_hi:[1,0]
v_pk_fma_f32 v[88:89], v[160:161], v[194:195], v[88:89] op_sel:[0,1,0] op_sel_hi:[1,1,1]
v_pk_fma_f32 v[90:91], v[162:163], v[194:195], v[90:91] op_sel:[0,1,0] op_sel_hi:[1,1,1]
v_pk_fma_f32 v[92:93], v[164:165], v[194:195], v[92:93] op_sel:[0,1,0] op_sel_hi:[1,1,1]
v_pk_fma_f32 v[94:95], v[166:167], v[194:195], v[94:95] op_sel:[0,1,0] op_sel_hi:[1,1,1]
v_cvt_pk_bf16_f32 v88, v88, v89
v_cvt_pk_bf16_f32 v89, v90, v91
v_cvt_pk_bf16_f32 v90, v92, v93
v_cvt_pk_bf16_f32 v91, v94, v95
v_permlane16_swap_b32 v96, v104
v_permlane16_swap_b32 v97, v105
v_permlane16_swap_b32 v98, v106
v_permlane16_swap_b32 v99, v107
v_permlane16_swap_b32 v80, v88
v_permlane16_swap_b32 v81, v89
v_permlane16_swap_b32 v82, v90
v_permlane16_swap_b32 v83, v91
v_mov_b32 v192, 0
v_mov_b32 v193, 0
v_mov_b32 v194, 0
v_mov_b32 v195, 0
v_mov_b32 v196, 0
v_mov_b32 v197, 0
v_mov_b32 v198, 0
v_mov_b32 v199, 0
s_lshl_b32 s69, s64, 12
v_lshl_add_u32 v6, v0, 4, s69
v_add_u32 v7, 131072, v6
s_lshl_b32 s69, s65, 13
s_add_u32 s66, s69, 131072
s_sub_u32 s69, 147456, s69
v_add_u32 v8, s69, v6
ds_read_b128 v[152:155], v8 offset:8192
ds_read_b128 v[156:159], v8 offset:9216
s_mov_b32 s67, 122880
s_min_u32 s69, s59, 1
s_lshl2_add_u32 s68, s69, s65
s_cmp_ge_u32 s59, 2
s_cselect_b32 s69, s65, 0
s_add_u32 s68, s68, s69
ds_read_b128 v[160:163], v8 offset:10240
ds_read_b128 v[164:167], v8 offset:11264
s_waitcnt lgkmcnt(3)
v_mfma_f32_32x32x16_bf16 v[112:127], v[152:155], v[96:99], v[216:231]
s_waitcnt lgkmcnt(2)
v_mfma_f32_32x32x16_bf16 v[112:127], v[156:159], v[104:107], v[112:127]
s_add_u32 s35, s34, 17
lw_142:
ds_read_b32 v5, v1 offset:0
s_waitcnt lgkmcnt(0)
v_cmp_gt_i32 vcc, s35, v5
s_cbranch_vccz lwd_143
s_sub_u32 s32, s32, 1
s_cmp_gt_i32 s32, 0
s_cbranch_scc1 lw_142
lwd_143:
ds_read_b128 v[152:155], v8 offset:0
ds_read_b128 v[156:159], v8 offset:1024
s_add_u32 s70, s72, 270336
s_mov_b64 exec, 1
s_waitcnt vmcnt(0)
buffer_store_dword v7, v3, s[24:27], s70 offen sc1
s_mov_b64 exec, -1
.p2align 3
v_exp_f32 v112, v112
v_exp_f32 v113, v113
v_exp_f32 v114, v114
v_exp_f32 v115, v115
v_exp_f32 v116, v116
v_exp_f32 v117, v117
s_waitcnt lgkmcnt(1)
v_mfma_f32_32x32x16_bf16 v[128:143], v[152:155], v[96:99], 0
v_exp_f32 v118, v118
v_exp_f32 v119, v119
v_cvt_pk_bf16_f32 v144, v112, v113
v_cvt_pk_bf16_f32 v145, v114, v115
s_waitcnt lgkmcnt(0)
v_mfma_f32_32x32x16_bf16 v[128:143], v[156:159], v[104:107], v[128:143]
ds_read_b128 v[152:155], v7 offset:8192
ds_read_b128 v[156:159], v7 offset:9216
v_cvt_pk_bf16_f32 v146, v116, v117
v_cvt_pk_bf16_f32 v147, v118, v119
v_exp_f32 v120, v120
v_exp_f32 v121, v121
v_mfma_f32_32x32x16_bf16 v[16:31], v[160:163], v[144:147], 0
ds_read_b128 v[160:163], v8 offset:2048
v_exp_f32 v122, v122
v_exp_f32 v123, v123
v_exp_f32 v124, v124
v_mfma_f32_16x16x32_bf16 v[32:35], v[212:215], v[144:147], 0
s_cmp_eq_u32 s65, 1
v_exp_f32 v125, v125
v_exp_f32 v126, v126
v_exp_f32 v127, v127
v_cvt_pk_bf16_f32 v148, v120, v121
v_cvt_pk_bf16_f32 v149, v122, v123
v_cvt_pk_bf16_f32 v150, v124, v125
v_cvt_pk_bf16_f32 v151, v126, v127
s_cbranch_scc1 at_144
v_exp_f32 v128, v128
v_exp_f32 v129, v129
v_mfma_f32_32x32x16_bf16 v[16:31], v[164:167], v[148:151], v[16:31]
ds_read_b128 v[164:167], v8 offset:3072
v_exp_f32 v130, v130
v_exp_f32 v131, v131
v_exp_f32 v132, v132
v_mfma_f32_16x16x32_bf16 v[32:35], v[212:215], v[148:151], v[32:35]
v_exp_f32 v133, v133
s_waitcnt lgkmcnt(3)
v_mfma_f32_32x32x16_bf16 v[112:127], v[152:155], v[96:99], 0
v_exp_f32 v134, v134
v_exp_f32 v135, v135
v_cvt_pk_bf16_f32 v144, v128, v129
v_cvt_pk_bf16_f32 v145, v130, v131
s_waitcnt lgkmcnt(2)
v_mfma_f32_32x32x16_bf16 v[112:127], v[156:159], v[104:107], v[112:127]
ds_read_b128 v[152:155], v7 offset:0
ds_read_b128 v[156:159], v7 offset:1024
v_cvt_pk_bf16_f32 v146, v132, v133
v_cvt_pk_bf16_f32 v147, v134, v135
v_exp_f32 v136, v136
v_exp_f32 v137, v137
s_waitcnt lgkmcnt(3)
v_mfma_f32_32x32x16_bf16 v[16:31], v[160:163], v[144:147], v[16:31]
ds_read_b128 v[160:163], v7 offset:10240
v_exp_f32 v138, v138
v_exp_f32 v139, v139
v_exp_f32 v140, v140
v_mfma_f32_16x16x32_bf16 v[32:35], v[212:215], v[144:147], v[32:35]
v_exp_f32 v141, v141
v_exp_f32 v142, v142
v_exp_f32 v143, v143
v_cvt_pk_bf16_f32 v148, v136, v137
v_cvt_pk_bf16_f32 v149, v138, v139
v_cvt_pk_bf16_f32 v150, v140, v141
v_cvt_pk_bf16_f32 v151, v142, v143
v_exp_f32 v112, v112
v_exp_f32 v113, v113
s_waitcnt lgkmcnt(3)
v_mfma_f32_32x32x16_bf16 v[16:31], v[164:167], v[148:151], v[16:31]
ds_read_b128 v[164:167], v7 offset:11264
v_exp_f32 v114, v114
v_exp_f32 v115, v115
v_exp_f32 v116, v116
v_mfma_f32_16x16x32_bf16 v[32:35], v[212:215], v[148:151], v[32:35]
v_exp_f32 v117, v117
s_waitcnt lgkmcnt(3)
v_mfma_f32_32x32x16_bf16 v[128:143], v[152:155], v[96:99], 0
v_exp_f32 v118, v118
v_exp_f32 v119, v119
v_cvt_pk_bf16_f32 v144, v112, v113
v_cvt_pk_bf16_f32 v145, v114, v115
s_waitcnt lgkmcnt(2)
v_mfma_f32_32x32x16_bf16 v[128:143], v[156:159], v[104:107], v[128:143]
v_cvt_pk_bf16_f32 v146, v116, v117
v_cvt_pk_bf16_f32 v147, v118, v119
v_exp_f32 v120, v120
v_exp_f32 v121, v121
s_waitcnt lgkmcnt(1)
v_mfma_f32_32x32x16_bf16 v[16:31], v[160:163], v[144:147], v[16:31]
ds_read_b128 v[160:163], v7 offset:2048
v_exp_f32 v122, v122
v_exp_f32 v123, v123
v_exp_f32 v124, v124
v_mfma_f32_16x16x32_bf16 v[32:35], v[212:215], v[144:147], v[32:35]
v_mov_b32 v8, v7
v_exp_f32 v125, v125
v_exp_f32 v126, v126
v_exp_f32 v127, v127
v_cvt_pk_bf16_f32 v148, v120, v121
v_cvt_pk_bf16_f32 v149, v122, v123
v_cvt_pk_bf16_f32 v150, v124, v125
v_cvt_pk_bf16_f32 v151, v126, v127
.p2align 3
at_144:
v_exp_f32 v128, v128
v_exp_f32 v129, v129
s_waitcnt lgkmcnt(1)
v_mfma_f32_32x32x16_bf16 v[16:31], v[164:167], v[148:151], v[16:31]
ds_read_b128 v[164:167], v8 offset:3072
v_exp_f32 v130, v130
v_exp_f32 v131, v131
v_exp_f32 v132, v132
v_mfma_f32_16x16x32_bf16 v[32:35], v[212:215], v[148:151], v[32:35]
v_exp_f32 v133, v133
v_mfma_f32_32x32x16_bf16 v[112:127], v[152:155], v[80:83], v[216:231]
v_exp_f32 v134, v134
v_exp_f32 v135, v135
v_cvt_pk_bf16_f32 v144, v128, v129
v_cvt_pk_bf16_f32 v145, v130, v131
v_mfma_f32_32x32x16_bf16 v[112:127], v[156:159], v[88:91], v[112:127]
s_sub_u32 s66, s66, 8192
s_cmp_eq_u32 s66, s67
s_cbranch_scc1 cross_151
cback_152:
v_add_u32 v8, s66, v6
ds_read_b128 v[152:155], v8 offset:0
ds_read_b128 v[156:159], v8 offset:1024
v_cvt_pk_bf16_f32 v146, v132, v133
v_cvt_pk_bf16_f32 v147, v134, v135
v_exp_f32 v136, v136
v_exp_f32 v137, v137
s_waitcnt lgkmcnt(3)
v_mfma_f32_32x32x16_bf16 v[16:31], v[160:163], v[144:147], v[16:31]
v_exp_f32 v138, v138
v_exp_f32 v139, v139
v_exp_f32 v140, v140
v_mfma_f32_16x16x32_bf16 v[32:35], v[212:215], v[144:147], v[32:35]
s_cmp_eq_u32 s68, 0
v_exp_f32 v141, v141
v_exp_f32 v142, v142
v_exp_f32 v143, v143
v_cvt_pk_bf16_f32 v148, v136, v137
v_cvt_pk_bf16_f32 v149, v138, v139
v_cvt_pk_bf16_f32 v150, v140, v141
v_cvt_pk_bf16_f32 v151, v142, v143
s_cbranch_scc1 at_148
.p2align 3
at_145:
v_exp_f32 v112, v112
v_exp_f32 v113, v113
s_waitcnt lgkmcnt(2)
v_mfma_f32_32x32x16_bf16 v[16:31], v[164:167], v[148:151], v[16:31]
v_exp_f32 v114, v114
v_exp_f32 v115, v115
v_exp_f32 v116, v116
v_mfma_f32_16x16x32_bf16 v[32:35], v[212:215], v[148:151], v[32:35]
v_exp_f32 v117, v117
s_waitcnt lgkmcnt(1)
v_mfma_f32_32x32x16_bf16 v[128:143], v[152:155], v[96:99], 0
v_exp_f32 v118, v118
v_exp_f32 v119, v119
v_cvt_pk_bf16_f32 v144, v112, v113
v_cvt_pk_bf16_f32 v145, v114, v115
s_waitcnt lgkmcnt(0)
v_mfma_f32_32x32x16_bf16 v[128:143], v[156:159], v[104:107], v[128:143]
v_cvt_pk_bf16_f32 v146, v116, v117
v_cvt_pk_bf16_f32 v147, v118, v119
v_exp_f32 v120, v120
v_exp_f32 v121, v121
v_mfma_f32_32x32x16_bf16 v[192:207], v[160:163], v[144:147], v[192:207]
ds_read_b128 v[160:163], v8 offset:2048
v_exp_f32 v122, v122
v_exp_f32 v123, v123
v_exp_f32 v124, v124
v_mfma_f32_16x16x32_bf16 v[208:211], v[212:215], v[144:147], v[208:211]
ds_read_b32 v5, v2 offset:16
s_add_u32 s35, s34, 21
v_exp_f32 v125, v125
v_exp_f32 v126, v126
v_exp_f32 v127, v127
v_cvt_pk_bf16_f32 v148, v120, v121
v_cvt_pk_bf16_f32 v149, v122, v123
v_cvt_pk_bf16_f32 v150, v124, v125
v_cvt_pk_bf16_f32 v151, v126, v127
v_exp_f32 v128, v128
v_exp_f32 v129, v129
v_mfma_f32_32x32x16_bf16 v[192:207], v[164:167], v[148:151], v[192:207]
ds_read_b128 v[164:167], v8 offset:3072
v_exp_f32 v130, v130
v_exp_f32 v131, v131
v_exp_f32 v132, v132
v_mfma_f32_16x16x32_bf16 v[208:211], v[212:215], v[148:151], v[208:211]
v_exp_f32 v133, v133
v_mfma_f32_32x32x16_bf16 v[112:127], v[152:155], v[80:83], 0
v_exp_f32 v134, v134
v_exp_f32 v135, v135
v_cvt_pk_bf16_f32 v144, v128, v129
v_cvt_pk_bf16_f32 v145, v130, v131
v_mfma_f32_32x32x16_bf16 v[112:127], v[156:159], v[88:91], v[112:127]
s_sub_u32 s66, s66, 8192
s_cmp_eq_u32 s66, s67
s_cbranch_scc1 cross_153
cback_154:
v_add_u32 v8, s66, v6
ds_read_b128 v[152:155], v8 offset:0
ds_read_b128 v[156:159], v8 offset:1024
v_cvt_pk_bf16_f32 v146, v132, v133
v_cvt_pk_bf16_f32 v147, v134, v135
v_exp_f32 v136, v136
v_exp_f32 v137, v137
s_waitcnt lgkmcnt(4)
v_mfma_f32_32x32x16_bf16 v[16:31], v[160:163], v[144:147], v[16:31]
v_exp_f32 v138, v138
v_exp_f32 v139, v139
v_exp_f32 v140, v140
v_mfma_f32_16x16x32_bf16 v[32:35], v[212:215], v[144:147], v[32:35]
s_sub_u32 s68, s68, 1
s_cmp_eq_u32 s68, 0
v_exp_f32 v141, v141
v_exp_f32 v142, v142
v_exp_f32 v143, v143
v_cvt_pk_bf16_f32 v148, v136, v137
v_cvt_pk_bf16_f32 v149, v138, v139
v_cvt_pk_bf16_f32 v150, v140, v141
v_cvt_pk_bf16_f32 v151, v142, v143
s_cbranch_scc0 at_145
s_cmp_lt_u32 s59, 2
s_cbranch_scc1 at_148
.p2align 3
v_exp_f32 v112, v112
v_exp_f32 v113, v113
s_waitcnt lgkmcnt(2)
v_mfma_f32_32x32x16_bf16 v[16:31], v[164:167], v[148:151], v[16:31]
v_exp_f32 v114, v114
v_exp_f32 v115, v115
v_exp_f32 v116, v116
v_mfma_f32_16x16x32_bf16 v[32:35], v[212:215], v[148:151], v[32:35]
v_exp_f32 v117, v117
s_waitcnt lgkmcnt(1)
v_mfma_f32_32x32x16_bf16 v[128:143], v[152:155], v[96:99], v[216:231]
v_exp_f32 v118, v118
v_exp_f32 v119, v119
v_cvt_pk_bf16_f32 v144, v112, v113
v_cvt_pk_bf16_f32 v145, v114, v115
s_waitcnt lgkmcnt(0)
v_mfma_f32_32x32x16_bf16 v[128:143], v[156:159], v[104:107], v[128:143]
v_cvt_pk_bf16_f32 v146, v116, v117
v_cvt_pk_bf16_f32 v147, v118, v119
v_exp_f32 v120, v120
v_exp_f32 v121, v121
v_mfma_f32_32x32x16_bf16 v[192:207], v[160:163], v[144:147], v[192:207]
ds_read_b128 v[160:163], v8 offset:2048
v_exp_f32 v122, v122
v_exp_f32 v123, v123
v_exp_f32 v124, v124
v_mfma_f32_16x16x32_bf16 v[208:211], v[212:215], v[144:147], v[208:211]
v_exp_f32 v125, v125
v_exp_f32 v126, v126
v_exp_f32 v127, v127
v_cvt_pk_bf16_f32 v148, v120, v121
v_cvt_pk_bf16_f32 v149, v122, v123
v_cvt_pk_bf16_f32 v150, v124, v125
v_cvt_pk_bf16_f32 v151, v126, v127
v_exp_f32 v128, v128
v_exp_f32 v129, v129
v_mfma_f32_32x32x16_bf16 v[192:207], v[164:167], v[148:151], v[192:207]
ds_read_b128 v[164:167], v8 offset:3072
v_exp_f32 v130, v130
v_exp_f32 v131, v131
v_exp_f32 v132, v132
v_mfma_f32_16x16x32_bf16 v[208:211], v[212:215], v[148:151], v[208:211]
v_exp_f32 v133, v133
v_mfma_f32_32x32x16_bf16 v[112:127], v[152:155], v[80:83], 0
v_exp_f32 v134, v134
v_exp_f32 v135, v135
v_cvt_pk_bf16_f32 v144, v128, v129
v_cvt_pk_bf16_f32 v145, v130, v131
v_mfma_f32_32x32x16_bf16 v[112:127], v[156:159], v[88:91], v[112:127]
v_subrev_u32 v8, 8192, v8
ds_read_b128 v[152:155], v8 offset:0
ds_read_b128 v[156:159], v8 offset:1024
v_cvt_pk_bf16_f32 v146, v132, v133
v_cvt_pk_bf16_f32 v147, v134, v135
v_exp_f32 v136, v136
v_exp_f32 v137, v137
s_waitcnt lgkmcnt(3)
v_mfma_f32_32x32x16_bf16 v[16:31], v[160:163], v[144:147], v[16:31]
v_exp_f32 v138, v138
v_exp_f32 v139, v139
v_exp_f32 v140, v140
v_mfma_f32_16x16x32_bf16 v[32:35], v[212:215], v[144:147], v[32:35]
s_cmp_eq_u32 s65, 1
v_exp_f32 v141, v141
v_exp_f32 v142, v142
v_exp_f32 v143, v143
v_cvt_pk_bf16_f32 v148, v136, v137
v_cvt_pk_bf16_f32 v149, v138, v139
v_cvt_pk_bf16_f32 v150, v140, v141
v_cvt_pk_bf16_f32 v151, v142, v143
s_cbranch_scc1 at_147
.p2align 3
v_exp_f32 v112, v112
v_exp_f32 v113, v113
s_waitcnt lgkmcnt(2)
v_mfma_f32_32x32x16_bf16 v[16:31], v[164:167], v[148:151], v[16:31]
v_exp_f32 v114, v114
v_exp_f32 v115, v115
v_exp_f32 v116, v116
v_mfma_f32_16x16x32_bf16 v[32:35], v[212:215], v[148:151], v[32:35]
v_exp_f32 v117, v117
s_waitcnt lgkmcnt(1)
v_mfma_f32_32x32x16_bf16 v[128:143], v[152:155], v[80:83], 0
v_exp_f32 v118, v118
v_exp_f32 v119, v119
v_cvt_pk_bf16_f32 v144, v112, v113
v_cvt_pk_bf16_f32 v145, v114, v115
s_waitcnt lgkmcnt(0)
v_mfma_f32_32x32x16_bf16 v[128:143], v[156:159], v[88:91], v[128:143]
v_subrev_u32 v8, 8192, v8
ds_read_b128 v[152:155], v8 offset:0
ds_read_b128 v[156:159], v8 offset:1024
v_cvt_pk_bf16_f32 v146, v116, v117
v_cvt_pk_bf16_f32 v147, v118, v119
v_exp_f32 v120, v120
v_exp_f32 v121, v121
v_mfma_f32_32x32x16_bf16 v[192:207], v[160:163], v[144:147], v[192:207]
ds_read_b128 v[160:163], v8 offset:10240
v_exp_f32 v122, v122
v_exp_f32 v123, v123
v_exp_f32 v124, v124
v_mfma_f32_16x16x32_bf16 v[208:211], v[212:215], v[144:147], v[208:211]
v_exp_f32 v125, v125
v_exp_f32 v126, v126
v_exp_f32 v127, v127
v_cvt_pk_bf16_f32 v148, v120, v121
v_cvt_pk_bf16_f32 v149, v122, v123
v_cvt_pk_bf16_f32 v150, v124, v125
v_cvt_pk_bf16_f32 v151, v126, v127
v_exp_f32 v128, v128
v_exp_f32 v129, v129
v_mfma_f32_32x32x16_bf16 v[192:207], v[164:167], v[148:151], v[192:207]
ds_read_b128 v[164:167], v8 offset:11264
v_exp_f32 v130, v130
v_exp_f32 v131, v131
v_exp_f32 v132, v132
v_mfma_f32_16x16x32_bf16 v[208:211], v[212:215], v[148:151], v[208:211]
v_exp_f32 v133, v133
s_waitcnt lgkmcnt(3)
v_mfma_f32_32x32x16_bf16 v[112:127], v[152:155], v[80:83], 0
v_exp_f32 v134, v134
v_exp_f32 v135, v135
v_cvt_pk_bf16_f32 v144, v128, v129
v_cvt_pk_bf16_f32 v145, v130, v131
s_waitcnt lgkmcnt(2)
v_mfma_f32_32x32x16_bf16 v[112:127], v[156:159], v[88:91], v[112:127]
v_subrev_u32 v8, 8192, v8
ds_read_b128 v[152:155], v8 offset:0
ds_read_b128 v[156:159], v8 offset:1024
v_cvt_pk_bf16_f32 v146, v132, v133
v_cvt_pk_bf16_f32 v147, v134, v135
v_exp_f32 v136, v136
v_exp_f32 v137, v137
s_waitcnt lgkmcnt(3)
v_mfma_f32_32x32x16_bf16 v[192:207], v[160:163], v[144:147], v[192:207]
ds_read_b128 v[160:163], v8 offset:10240
v_exp_f32 v138, v138
v_exp_f32 v139, v139
v_exp_f32 v140, v140
v_mfma_f32_16x16x32_bf16 v[208:211], v[212:215], v[144:147], v[208:211]
v_exp_f32 v141, v141
v_exp_f32 v142, v142
v_exp_f32 v143, v143
v_cvt_pk_bf16_f32 v148, v136, v137
v_cvt_pk_bf16_f32 v149, v138, v139
v_cvt_pk_bf16_f32 v150, v140, v141
v_cvt_pk_bf16_f32 v151, v142, v143
v_exp_f32 v112, v112
v_exp_f32 v113, v113
s_waitcnt lgkmcnt(3)
v_mfma_f32_32x32x16_bf16 v[192:207], v[164:167], v[148:151], v[192:207]
ds_read_b128 v[164:167], v8 offset:11264
v_exp_f32 v114, v114
v_exp_f32 v115, v115
v_exp_f32 v116, v116
v_mfma_f32_16x16x32_bf16 v[208:211], v[212:215], v[148:151], v[208:211]
v_exp_f32 v117, v117
s_waitcnt lgkmcnt(3)
v_mfma_f32_32x32x16_bf16 v[128:143], v[152:155], v[80:83], v[216:231]
v_exp_f32 v118, v118
v_exp_f32 v119, v119
v_cvt_pk_bf16_f32 v144, v112, v113
v_cvt_pk_bf16_f32 v145, v114, v115
s_waitcnt lgkmcnt(2)
v_mfma_f32_32x32x16_bf16 v[128:143], v[156:159], v[88:91], v[128:143]
v_cvt_pk_bf16_f32 v146, v116, v117
v_cvt_pk_bf16_f32 v147, v118, v119
v_exp_f32 v120, v120
v_exp_f32 v121, v121
s_waitcnt lgkmcnt(1)
v_mfma_f32_32x32x16_bf16 v[192:207], v[160:163], v[144:147], v[192:207]
ds_read_b128 v[160:163], v8 offset:2048
v_exp_f32 v122, v122
v_exp_f32 v123, v123
v_exp_f32 v124, v124
v_mfma_f32_16x16x32_bf16 v[208:211], v[212:215], v[144:147], v[208:211]
v_exp_f32 v125, v125
v_exp_f32 v126, v126
v_exp_f32 v127, v127
v_cvt_pk_bf16_f32 v148, v120, v121
v_cvt_pk_bf16_f32 v149, v122, v123
v_cvt_pk_bf16_f32 v150, v124, v125
v_cvt_pk_bf16_f32 v151, v126, v127
s_branch at_149
.p2align 3
at_148:
s_waitcnt lgkmcnt(3)
v_add_u32 v5, s34, 20
s_mov_b64 exec, 1
ds_write_b32 v3, v5
s_mov_b64 exec, -1
v_exp_f32 v112, v112
v_exp_f32 v113, v113
s_waitcnt lgkmcnt(3)
v_mfma_f32_32x32x16_bf16 v[16:31], v[164:167], v[148:151], v[16:31]
v_exp_f32 v114, v114
v_exp_f32 v115, v115
v_exp_f32 v116, v116
v_mfma_f32_16x16x32_bf16 v[32:35], v[212:215], v[148:151], v[32:35]
v_exp_f32 v117, v117
v_exp_f32 v118, v118
v_exp_f32 v119, v119
v_cvt_pk_bf16_f32 v144, v112, v113
v_cvt_pk_bf16_f32 v145, v114, v115
v_cvt_pk_bf16_f32 v146, v116, v117
v_cvt_pk_bf16_f32 v147, v118, v119
v_exp_f32 v120, v120
v_exp_f32 v121, v121
v_mfma_f32_32x32x16_bf16 v[192:207], v[160:163], v[144:147], v[192:207]
v_exp_f32 v122, v122
v_exp_f32 v123, v123
v_exp_f32 v124, v124
v_mfma_f32_16x16x32_bf16 v[208:211], v[212:215], v[144:147], v[208:211]
v_exp_f32 v125, v125
v_exp_f32 v126, v126
v_exp_f32 v127, v127
v_cvt_pk_bf16_f32 v148, v120, v121
v_cvt_pk_bf16_f32 v149, v122, v123
v_cvt_pk_bf16_f32 v150, v124, v125
v_cvt_pk_bf16_f32 v151, v126, v127
s_branch at_150
.p2align 3
at_147:
v_exp_f32 v112, v112
v_exp_f32 v113, v113
s_waitcnt lgkmcnt(2)
v_mfma_f32_32x32x16_bf16 v[16:31], v[164:167], v[148:151], v[16:31]
v_exp_f32 v114, v114
v_exp_f32 v115, v115
v_exp_f32 v116, v116
v_mfma_f32_16x16x32_bf16 v[32:35], v[212:215], v[148:151], v[32:35]
v_exp_f32 v117, v117
s_waitcnt lgkmcnt(1)
v_mfma_f32_32x32x16_bf16 v[128:143], v[152:155], v[80:83], v[216:231]
v_exp_f32 v118, v118
v_exp_f32 v119, v119
v_cvt_pk_bf16_f32 v144, v112, v113
v_cvt_pk_bf16_f32 v145, v114, v115
s_waitcnt lgkmcnt(0)
v_mfma_f32_32x32x16_bf16 v[128:143], v[156:159], v[88:91], v[128:143]
v_cvt_pk_bf16_f32 v146, v116, v117
v_cvt_pk_bf16_f32 v147, v118, v119
v_exp_f32 v120, v120
v_exp_f32 v121, v121
v_mfma_f32_32x32x16_bf16 v[192:207], v[160:163], v[144:147], v[192:207]
ds_read_b128 v[160:163], v8 offset:2048
v_exp_f32 v122, v122
v_exp_f32 v123, v123
v_exp_f32 v124, v124
v_mfma_f32_16x16x32_bf16 v[208:211], v[212:215], v[144:147], v[208:211]
v_exp_f32 v125, v125
v_exp_f32 v126, v126
v_exp_f32 v127, v127
v_cvt_pk_bf16_f32 v148, v120, v121
v_cvt_pk_bf16_f32 v149, v122, v123
v_cvt_pk_bf16_f32 v150, v124, v125
v_cvt_pk_bf16_f32 v151, v126, v127
.p2align 3
at_149:
v_exp_f32 v128, v128
v_exp_f32 v129, v129
s_waitcnt lgkmcnt(1)
v_mfma_f32_32x32x16_bf16 v[192:207], v[164:167], v[148:151], v[192:207]
ds_read_b128 v[164:167], v8 offset:3072
v_exp_f32 v130, v130
v_exp_f32 v131, v131
v_exp_f32 v132, v132
v_mfma_f32_16x16x32_bf16 v[208:211], v[212:215], v[148:151], v[208:211]
v_exp_f32 v133, v133
v_exp_f32 v134, v134
v_exp_f32 v135, v135
v_cvt_pk_bf16_f32 v144, v128, v129
v_cvt_pk_bf16_f32 v145, v130, v131
v_add_u32 v5, s34, 20
s_mov_b64 exec, 1
ds_write_b32 v3, v5
s_mov_b64 exec, -1
v_cvt_pk_bf16_f32 v146, v132, v133
v_cvt_pk_bf16_f32 v147, v134, v135
v_exp_f32 v136, v136
v_exp_f32 v137, v137
s_waitcnt lgkmcnt(2)
v_mfma_f32_32x32x16_bf16 v[192:207], v[160:163], v[144:147], v[192:207]
v_exp_f32 v138, v138
v_exp_f32 v139, v139
v_exp_f32 v140, v140
v_mfma_f32_16x16x32_bf16 v[208:211], v[212:215], v[144:147], v[208:211]
v_exp_f32 v141, v141
v_exp_f32 v142, v142
v_exp_f32 v143, v143
v_cvt_pk_bf16_f32 v148, v136, v137
v_cvt_pk_bf16_f32 v149, v138, v139
v_cvt_pk_bf16_f32 v150, v140, v141
v_cvt_pk_bf16_f32 v151, v142, v143
at_150:
s_lshl_b32 s66, s59, 18
s_lshl_b32 s67, s63, 22
v_mfma_f32_16x16x32_bf16 v[208:211], v[212:215], v[148:151], v[208:211]
s_add_u32 s66, s66, s67
s_lshl1_add_u32 s67, s60, s64
s_waitcnt lgkmcnt(1)
v_mfma_f32_32x32x16_bf16 v[192:207], v[164:167], v[148:151], v[192:207]
s_lshl_b32 s67, s67, 11
s_add_u32 s66, s66, s67
s_lshl_b32 s68, s65, 16
s_add_u32 s67, s66, 18022400
s_sub_u32 s67, s67, s68
s_add_u32 s66, s66, s68
s_add_u32 s66, s66, 17825792
v_lshlrev_b32 v9, 4, v0
v_subrev_u32 v10, 0x2f800000, v32
v_subrev_u32 v11, 0x2f800000, v208
v_max_u32 v10, v10, v11
v_cmp_lt_u32 vcc, 0x20000000, v10
s_cbranch_vccnz slow_155
sback_156:
s_nop 1
v_rcp_f32 v12, v32
s_nop 1
v_pk_mul_f32 v[16:17], v[16:17], v[12:13] op_sel:[0,0] op_sel_hi:[1,0]
v_pk_mul_f32 v[18:19], v[18:19], v[12:13] op_sel:[0,0] op_sel_hi:[1,0]
v_pk_mul_f32 v[20:21], v[20:21], v[12:13] op_sel:[0,0] op_sel_hi:[1,0]
v_pk_mul_f32 v[22:23], v[22:23], v[12:13] op_sel:[0,0] op_sel_hi:[1,0]
v_pk_mul_f32 v[24:25], v[24:25], v[12:13] op_sel:[0,0] op_sel_hi:[1,0]
v_pk_mul_f32 v[26:27], v[26:27], v[12:13] op_sel:[0,0] op_sel_hi:[1,0]
v_pk_mul_f32 v[28:29], v[28:29], v[12:13] op_sel:[0,0] op_sel_hi:[1,0]
v_pk_mul_f32 v[30:31], v[30:31], v[12:13] op_sel:[0,0] op_sel_hi:[1,0]
v_cvt_pk_bf16_f32 v16, v16, v17
v_cvt_pk_bf16_f32 v17, v18, v19
v_cvt_pk_bf16_f32 v18, v20, v21
v_cvt_pk_bf16_f32 v19, v22, v23
v_cvt_pk_bf16_f32 v20, v24, v25
v_cvt_pk_bf16_f32 v21, v26, v27
v_cvt_pk_bf16_f32 v22, v28, v29
v_cvt_pk_bf16_f32 v23, v30, v31
s_cmp_eq_u32 s57, 0
s_cbranch_scc1 far_157
buffer_store_dwordx4 v[16:19], v9, s[20:23], s67 offen offset:0
buffer_store_dwordx4 v[20:23], v9, s[20:23], s67 offen offset:1024
near_158:
v_rcp_f32 v12, v208
s_nop 0
v_pk_mul_f32 v[192:193], v[192:193], v[12:13] op_sel:[0,0] op_sel_hi:[1,0]
v_pk_mul_f32 v[194:195], v[194:195], v[12:13] op_sel:[0,0] op_sel_hi:[1,0]
v_pk_mul_f32 v[196:197], v[196:197], v[12:13] op_sel:[0,0] op_sel_hi:[1,0]
v_pk_mul_f32 v[198:199], v[198:199], v[12:13] op_sel:[0,0] op_sel_hi:[1,0]
v_pk_mul_f32 v[200:201], v[200:201], v[12:13] op_sel:[0,0] op_sel_hi:[1,0]
v_pk_mul_f32 v[202:203], v[202:203], v[12:13] op_sel:[0,0] op_sel_hi:[1,0]
v_pk_mul_f32 v[204:205], v[204:205], v[12:13] op_sel:[0,0] op_sel_hi:[1,0]
v_pk_mul_f32 v[206:207], v[206:207], v[12:13] op_sel:[0,0] op_sel_hi:[1,0]
v_cvt_pk_bf16_f32 v192, v192, v193
v_cvt_pk_bf16_f32 v193, v194, v195
v_cvt_pk_bf16_f32 v194, v196, v197
v_cvt_pk_bf16_f32 v195, v198, v199
v_cvt_pk_bf16_f32 v196, v200, v201
v_cvt_pk_bf16_f32 v197, v202, v203
v_cvt_pk_bf16_f32 v198, v204, v205
v_cvt_pk_bf16_f32 v199, v206, v207
s_cmp_eq_u32 s57, 0
s_cbranch_scc1 far_159
buffer_store_dwordx4 v[192:195], v9, s[20:23], s66 offen offset:0
buffer_store_dwordx4 v[196:199], v9, s[20:23], s66 offen offset:1024
near_160:
v_bfe_u32 v48, v0, 2, 3
v_lshrrev_b32 v49, 5, v0
v_lshl_add_u32 v48, v49, 4, v48
v_lshlrev_b32 v48, 7, v48
v_bfe_u32 v49, v0, 3, 2
v_lshl_add_u32 v48, v49, 5, v48
v_and_b32 v49, 3, v0
v_lshl_add_u32 v48, v49, 3, v48
v_add_u32 v8, 32768, v48
v_xor_b32 v9, 32, v8
v_xor_b32 v10, 64, v8
v_xor_b32 v11, 96, v8
v_add_u32 v12, 0x10000, v8
v_add_u32 v13, 0x10000, v9
v_add_u32 v14, 0x10000, v10
v_add_u32 v15, 0x10000, v11
v_and_b32 v48, 15, v0
v_lshrrev_b32 v49, 4, v0
s_lshl2_add_u32 s66, s61, s58
s_lshl_b32 s67, s66, 16
s_lshl_b32 s68, s63, 22
s_add_u32 s67, s67, s68
s_add_u32 s67, s67, 17825792
v_lshl_add_u32 v6, v48, 4, s67
v_lshl_add_u32 v6, v49, 9, v6
s_add_u32 s70, s72, 268288
s_add_u32 s35, s34, 3
lw_161:
ds_read_b32 v5, v2 offset:24
s_waitcnt lgkmcnt(0)
v_cmp_gt_i32 vcc, s35, v5
s_cbranch_vccz lwd_162
s_sub_u32 s32, s32, 1
s_cmp_gt_i32 s32, 0
s_cbranch_scc1 lw_161
lwd_162:
s_mov_b64 exec, 1
s_waitcnt vmcnt(0)
s_cmp_eq_u32 s57, 0
s_cbranch_scc1 far_163
buffer_store_dword v212, v3, s[24:27], s70 offen
near_164:
s_mov_b64 exec, -1
v_add_u32 v5, s34, 21
s_mov_b64 exec, 1
ds_write_b32 v3, v5
s_mov_b64 exec, -1
s_cmp_eq_u32 s63, 0
s_cbranch_scc0 mo_165
v_permlane16_swap_b32 v240, v242
v_permlane16_swap_b32 v241, v243
v_permlane16_swap_b32 v244, v246
v_permlane16_swap_b32 v245, v247
v_permlane16_swap_b32 v248, v250
v_permlane16_swap_b32 v249, v251
v_permlane16_swap_b32 v252, v254
v_permlane16_swap_b32 v253, v255
mo_166:
v_lshlrev_b32 v16, 16, v240
v_and_b32 v17, 0xffff0000, v240
v_lshlrev_b32 v18, 16, v241
v_and_b32 v19, 0xffff0000, v241
v_lshlrev_b32 v20, 16, v242
v_and_b32 v21, 0xffff0000, v242
v_lshlrev_b32 v22, 16, v243
v_and_b32 v23, 0xffff0000, v243
v_lshlrev_b32 v24, 16, v244
v_and_b32 v25, 0xffff0000, v244
v_lshlrev_b32 v26, 16, v245
v_and_b32 v27, 0xffff0000, v245
v_lshlrev_b32 v28, 16, v246
v_and_b32 v29, 0xffff0000, v246
v_lshlrev_b32 v30, 16, v247
v_and_b32 v31, 0xffff0000, v247
v_lshlrev_b32 v32, 16, v248
v_and_b32 v33, 0xffff0000, v248
v_lshlrev_b32 v34, 16, v249
v_and_b32 v35, 0xffff0000, v249
v_lshlrev_b32 v36, 16, v250
v_and_b32 v37, 0xffff0000, v250
v_lshlrev_b32 v38, 16, v251
v_and_b32 v39, 0xffff0000, v251
v_lshlrev_b32 v40, 16, v252
v_and_b32 v41, 0xffff0000, v252
v_lshlrev_b32 v42, 16, v253
v_and_b32 v43, 0xffff0000, v253
v_lshlrev_b32 v44, 16, v254
v_and_b32 v45, 0xffff0000, v254
v_lshlrev_b32 v46, 16, v255
v_and_b32 v47, 0xffff0000, v255
s_add_u32 s66, s61, s62
s_and_b32 s66, s66, 15
s_lshl_b32 s66, s66, 12
s_mov_b32 s69, 0x3f803f80
v_mov_b32 v208, 0
v_dot2c_f32_bf16 v208, s69, v232
v_dot2c_f32_bf16 v208, s69, v233
v_dot2c_f32_bf16 v208, s69, v234
v_dot2c_f32_bf16 v208, s69, v235
v_dot2c_f32_bf16 v208, s69, v236
v_dot2c_f32_bf16 v208, s69, v237
v_dot2c_f32_bf16 v208, s69, v238
v_dot2c_f32_bf16 v208, s69, v239
s_add_u32 s35, s34, 22
lw_167:
ds_read_b32 v5, v2 offset:16
s_waitcnt lgkmcnt(0)
v_cmp_gt_i32 vcc, s35, v5
s_cbranch_vccz lwd_168
s_sub_u32 s32, s32, 1
s_cmp_gt_i32 s32, 0
s_cbranch_scc1 lw_167
lwd_168:
buffer_load_dwordx4 v[80:83], v6, s[20:23], s66 offen offset:0 sc1
buffer_load_dwordx4 v[88:91], v6, s[20:23], s66 offen offset:2048 sc1
buffer_load_dwordx4 v[84:87], v6, s[20:23], s66 offen offset:256 sc1
buffer_load_dwordx4 v[92:95], v6, s[20:23], s66 offen offset:2304 sc1
s_add_u32 s66, s66, 4096
s_and_b32 s66, s66, 0xffff
ds_read_b64_tr_b16 v[48:49], v8 offset:0
ds_read_b64_tr_b16 v[50:51], v8 offset:1024
ds_read_b64_tr_b16 v[52:53], v8 offset:4096
ds_read_b64_tr_b16 v[54:55], v8 offset:5120
buffer_load_dwordx4 v[96:99], v6, s[20:23], s66 offen offset:0 sc1
buffer_load_dwordx4 v[104:107], v6, s[20:23], s66 offen offset:2048 sc1
buffer_load_dwordx4 v[100:103], v6, s[20:23], s66 offen offset:256 sc1
buffer_load_dwordx4 v[108:111], v6, s[20:23], s66 offen offset:2304 sc1
s_add_u32 s66, s66, 4096
s_and_b32 s66, s66, 0xffff
ds_read_b64_tr_b16 v[56:57], v9 offset:0
ds_read_b64_tr_b16 v[58:59], v9 offset:1024
ds_read_b64_tr_b16 v[60:61], v9 offset:4096
ds_read_b64_tr_b16 v[62:63], v9 offset:5120
buffer_load_dwordx4 v[112:115], v6, s[20:23], s66 offen offset:0 sc1
buffer_load_dwordx4 v[120:123], v6, s[20:23], s66 offen offset:2048 sc1
buffer_load_dwordx4 v[116:119], v6, s[20:23], s66 offen offset:256 sc1
buffer_load_dwordx4 v[124:127], v6, s[20:23], s66 offen offset:2304 sc1
s_add_u32 s66, s66, 4096
s_and_b32 s66, s66, 0xffff
ds_read_b64_tr_b16 v[64:65], v10 offset:0
ds_read_b64_tr_b16 v[66:67], v10 offset:1024
ds_read_b64_tr_b16 v[68:69], v10 offset:4096
ds_read_b64_tr_b16 v[70:71], v10 offset:5120
.p2align 3
s_waitcnt vmcnt(11) lgkmcnt(10)
v_mfma_f32_16x16x32_bf16 v[16:19], v[48:51], v[80:83], v[16:19]
ds_read_b64_tr_b16 v[72:73], v11 offset:0
buffer_load_dwordx4 v[128:131], v6, s[20:23], s66 offen offset:0 sc1
s_waitcnt vmcnt(11) lgkmcnt(9)
v_mfma_f32_16x16x32_bf16 v[16:19], v[52:55], v[88:91], v[16:19]
ds_read_b64_tr_b16 v[74:75], v11 offset:1024
s_waitcnt vmcnt(10)
v_mfma_f32_16x16x32_bf16 v[32:35], v[48:51], v[84:87], v[32:35]
ds_read_b64_tr_b16 v[76:77], v11 offset:4096
buffer_load_dwordx4 v[136:139], v6, s[20:23], s66 offen offset:2048 sc1
s_waitcnt vmcnt(10)
v_mfma_f32_16x16x32_bf16 v[32:35], v[52:55], v[92:95], v[32:35]
ds_read_b64_tr_b16 v[78:79], v11 offset:5120
s_waitcnt lgkmcnt(10)
v_mfma_f32_16x16x32_bf16 v[20:23], v[56:59], v[80:83], v[20:23]
ds_read_b64_tr_b16 v[48:49], v8 offset:8192
buffer_load_dwordx4 v[132:135], v6, s[20:23], s66 offen offset:256 sc1
s_waitcnt lgkmcnt(9)
v_mfma_f32_16x16x32_bf16 v[20:23], v[60:63], v[88:91], v[20:23]
ds_read_b64_tr_b16 v[50:51], v8 offset:9216
v_mfma_f32_16x16x32_bf16 v[36:39], v[56:59], v[84:87], v[36:39]
ds_read_b64_tr_b16 v[52:53], v8 offset:12288
buffer_load_dwordx4 v[140:143], v6, s[20:23], s66 offen offset:2304 sc1
s_add_u32 s66, s66, 4096
s_and_b32 s66, s66, 0xffff
v_mfma_f32_16x16x32_bf16 v[36:39], v[60:63], v[92:95], v[36:39]
ds_read_b64_tr_b16 v[54:55], v8 offset:13312
s_waitcnt lgkmcnt(10)
v_mfma_f32_16x16x32_bf16 v[24:27], v[64:67], v[80:83], v[24:27]
ds_read_b64_tr_b16 v[56:57], v9 offset:8192
s_waitcnt lgkmcnt(9)
v_mfma_f32_16x16x32_bf16 v[24:27], v[68:71], v[88:91], v[24:27]
ds_read_b64_tr_b16 v[58:59], v9 offset:9216
v_mfma_f32_16x16x32_bf16 v[40:43], v[64:67], v[84:87], v[40:43]
ds_read_b64_tr_b16 v[60:61], v9 offset:12288
v_mfma_f32_16x16x32_bf16 v[40:43], v[68:71], v[92:95], v[40:43]
ds_read_b64_tr_b16 v[62:63], v9 offset:13312
s_waitcnt lgkmcnt(10)
v_mfma_f32_16x16x32_bf16 v[28:31], v[72:75], v[80:83], v[28:31]
ds_read_b64_tr_b16 v[64:65], v10 offset:8192
s_waitcnt lgkmcnt(9)
v_mfma_f32_16x16x32_bf16 v[28:31], v[76:79], v[88:91], v[28:31]
ds_read_b64_tr_b16 v[66:67], v10 offset:9216
v_mfma_f32_16x16x32_bf16 v[44:47], v[72:75], v[84:87], v[44:47]
ds_read_b64_tr_b16 v[68:69], v10 offset:12288
v_mfma_f32_16x16x32_bf16 v[44:47], v[76:79], v[92:95], v[44:47]
ds_read_b64_tr_b16 v[70:71], v10 offset:13312
s_waitcnt vmcnt(11) lgkmcnt(10)
v_mfma_f32_16x16x32_bf16 v[16:19], v[48:51], v[96:99], v[16:19]
ds_read_b64_tr_b16 v[72:73], v11 offset:8192
buffer_load_dwordx4 v[144:147], v6, s[20:23], s66 offen offset:0 sc1
s_waitcnt vmcnt(11) lgkmcnt(9)
v_mfma_f32_16x16x32_bf16 v[16:19], v[52:55], v[104:107], v[16:19]
ds_read_b64_tr_b16 v[74:75], v11 offset:9216
s_waitcnt vmcnt(10)
v_mfma_f32_16x16x32_bf16 v[32:35], v[48:51], v[100:103], v[32:35]
ds_read_b64_tr_b16 v[76:77], v11 offset:12288
buffer_load_dwordx4 v[152:155], v6, s[20:23], s66 offen offset:2048 sc1
s_waitcnt vmcnt(10)
v_mfma_f32_16x16x32_bf16 v[32:35], v[52:55], v[108:111], v[32:35]
ds_read_b64_tr_b16 v[78:79], v11 offset:13312
s_waitcnt lgkmcnt(10)
v_mfma_f32_16x16x32_bf16 v[20:23], v[56:59], v[96:99], v[20:23]
ds_read_b64_tr_b16 v[48:49], v8 offset:16384
buffer_load_dwordx4 v[148:151], v6, s[20:23], s66 offen offset:256 sc1
s_waitcnt lgkmcnt(9)
v_mfma_f32_16x16x32_bf16 v[20:23], v[60:63], v[104:107], v[20:23]
ds_read_b64_tr_b16 v[50:51], v8 offset:17408
v_mfma_f32_16x16x32_bf16 v[36:39], v[56:59], v[100:103], v[36:39]
ds_read_b64_tr_b16 v[52:53], v8 offset:20480
buffer_load_dwordx4 v[156:159], v6, s[20:23], s66 offen offset:2304 sc1
s_add_u32 s66, s66, 4096
s_and_b32 s66, s66, 0xffff
v_mfma_f32_16x16x32_bf16 v[36:39], v[60:63], v[108:111], v[36:39]
ds_read_b64_tr_b16 v[54:55], v8 offset:21504
s_waitcnt lgkmcnt(10)
v_mfma_f32_16x16x32_bf16 v[24:27], v[64:67], v[96:99], v[24:27]
ds_read_b64_tr_b16 v[56:57], v9 offset:16384
s_waitcnt lgkmcnt(9)
v_mfma_f32_16x16x32_bf16 v[24:27], v[68:71], v[104:107], v[24:27]
ds_read_b64_tr_b16 v[58:59], v9 offset:17408
v_mfma_f32_16x16x32_bf16 v[40:43], v[64:67], v[100:103], v[40:43]
ds_read_b64_tr_b16 v[60:61], v9 offset:20480
v_mfma_f32_16x16x32_bf16 v[40:43], v[68:71], v[108:111], v[40:43]
ds_read_b64_tr_b16 v[62:63], v9 offset:21504
s_waitcnt lgkmcnt(10)
v_mfma_f32_16x16x32_bf16 v[28:31], v[72:75], v[96:99], v[28:31]
ds_read_b64_tr_b16 v[64:65], v10 offset:16384
s_waitcnt lgkmcnt(9)
v_mfma_f32_16x16x32_bf16 v[28:31], v[76:79], v[104:107], v[28:31]
ds_read_b64_tr_b16 v[66:67], v10 offset:17408
v_mfma_f32_16x16x32_bf16 v[44:47], v[72:75], v[100:103], v[44:47]
ds_read_b64_tr_b16 v[68:69], v10 offset:20480
v_mfma_f32_16x16x32_bf16 v[44:47], v[76:79], v[108:111], v[44:47]
ds_read_b64_tr_b16 v[70:71], v10 offset:21504
s_waitcnt vmcnt(11) lgkmcnt(10)
v_mfma_f32_16x16x32_bf16 v[16:19], v[48:51], v[112:115], v[16:19]
ds_read_b64_tr_b16 v[72:73], v11 offset:16384
buffer_load_dwordx4 v[160:163], v6, s[20:23], s66 offen offset:0 sc1
s_waitcnt vmcnt(11) lgkmcnt(9)
v_mfma_f32_16x16x32_bf16 v[16:19], v[52:55], v[120:123], v[16:19]
ds_read_b64_tr_b16 v[74:75], v11 offset:17408
s_waitcnt vmcnt(10)
v_mfma_f32_16x16x32_bf16 v[32:35], v[48:51], v[116:119], v[32:35]
ds_read_b64_tr_b16 v[76:77], v11 offset:20480
buffer_load_dwordx4 v[168:171], v6, s[20:23], s66 offen offset:2048 sc1
s_waitcnt vmcnt(10)
v_mfma_f32_16x16x32_bf16 v[32:35], v[52:55], v[124:127], v[32:35]
ds_read_b64_tr_b16 v[78:79], v11 offset:21504
s_waitcnt lgkmcnt(10)
v_mfma_f32_16x16x32_bf16 v[20:23], v[56:59], v[112:115], v[20:23]
ds_read_b64_tr_b16 v[48:49], v8 offset:24576
buffer_load_dwordx4 v[164:167], v6, s[20:23], s66 offen offset:256 sc1
s_waitcnt lgkmcnt(9)
v_mfma_f32_16x16x32_bf16 v[20:23], v[60:63], v[120:123], v[20:23]
ds_read_b64_tr_b16 v[50:51], v8 offset:25600
v_mfma_f32_16x16x32_bf16 v[36:39], v[56:59], v[116:119], v[36:39]
ds_read_b64_tr_b16 v[52:53], v8 offset:28672
buffer_load_dwordx4 v[172:175], v6, s[20:23], s66 offen offset:2304 sc1
s_add_u32 s66, s66, 4096
s_and_b32 s66, s66, 0xffff
v_mfma_f32_16x16x32_bf16 v[36:39], v[60:63], v[124:127], v[36:39]
ds_read_b64_tr_b16 v[54:55], v8 offset:29696
s_waitcnt lgkmcnt(10)
v_mfma_f32_16x16x32_bf16 v[24:27], v[64:67], v[112:115], v[24:27]
ds_read_b64_tr_b16 v[56:57], v9 offset:24576
s_waitcnt lgkmcnt(9)
v_mfma_f32_16x16x32_bf16 v[24:27], v[68:71], v[120:123], v[24:27]
ds_read_b64_tr_b16 v[58:59], v9 offset:25600
v_mfma_f32_16x16x32_bf16 v[40:43], v[64:67], v[116:119], v[40:43]
ds_read_b64_tr_b16 v[60:61], v9 offset:28672
v_mfma_f32_16x16x32_bf16 v[40:43], v[68:71], v[124:127], v[40:43]
ds_read_b64_tr_b16 v[62:63], v9 offset:29696
s_waitcnt lgkmcnt(10)
v_mfma_f32_16x16x32_bf16 v[28:31], v[72:75], v[112:115], v[28:31]
ds_read_b64_tr_b16 v[64:65], v10 offset:24576
s_waitcnt lgkmcnt(9)
v_mfma_f32_16x16x32_bf16 v[28:31], v[76:79], v[120:123], v[28:31]
ds_read_b64_tr_b16 v[66:67], v10 offset:25600
v_mfma_f32_16x16x32_bf16 v[44:47], v[72:75], v[116:119], v[44:47]
ds_read_b64_tr_b16 v[68:69], v10 offset:28672
v_mfma_f32_16x16x32_bf16 v[44:47], v[76:79], v[124:127], v[44:47]
ds_read_b64_tr_b16 v[70:71], v10 offset:29696
s_waitcnt vmcnt(11) lgkmcnt(10)
v_mfma_f32_16x16x32_bf16 v[16:19], v[48:51], v[128:131], v[16:19]
ds_read_b64_tr_b16 v[72:73], v11 offset:24576
buffer_load_dwordx4 v[176:179], v6, s[20:23], s66 offen offset:0 sc1
s_waitcnt vmcnt(11) lgkmcnt(9)
v_mfma_f32_16x16x32_bf16 v[16:19], v[52:55], v[136:139], v[16:19]
ds_read_b64_tr_b16 v[74:75], v11 offset:25600
s_waitcnt vmcnt(10)
v_mfma_f32_16x16x32_bf16 v[32:35], v[48:51], v[132:135], v[32:35]
ds_read_b64_tr_b16 v[76:77], v11 offset:28672
buffer_load_dwordx4 v[184:187], v6, s[20:23], s66 offen offset:2048 sc1
s_waitcnt vmcnt(10)
v_mfma_f32_16x16x32_bf16 v[32:35], v[52:55], v[140:143], v[32:35]
ds_read_b64_tr_b16 v[78:79], v11 offset:29696
s_waitcnt lgkmcnt(10)
v_mfma_f32_16x16x32_bf16 v[20:23], v[56:59], v[128:131], v[20:23]
ds_read_b64_tr_b16 v[48:49], v8 offset:32768
buffer_load_dwordx4 v[180:183], v6, s[20:23], s66 offen offset:256 sc1
s_waitcnt lgkmcnt(9)
v_mfma_f32_16x16x32_bf16 v[20:23], v[60:63], v[136:139], v[20:23]
ds_read_b64_tr_b16 v[50:51], v8 offset:33792
v_mfma_f32_16x16x32_bf16 v[36:39], v[56:59], v[132:135], v[36:39]
ds_read_b64_tr_b16 v[52:53], v8 offset:36864
buffer_load_dwordx4 v[188:191], v6, s[20:23], s66 offen offset:2304 sc1
s_add_u32 s66, s66, 4096
s_and_b32 s66, s66, 0xffff
v_mfma_f32_16x16x32_bf16 v[36:39], v[60:63], v[140:143], v[36:39]
ds_read_b64_tr_b16 v[54:55], v8 offset:37888
s_waitcnt lgkmcnt(10)
v_mfma_f32_16x16x32_bf16 v[24:27], v[64:67], v[128:131], v[24:27]
ds_read_b64_tr_b16 v[56:57], v9 offset:32768
s_waitcnt lgkmcnt(9)
v_mfma_f32_16x16x32_bf16 v[24:27], v[68:71], v[136:139], v[24:27]
ds_read_b64_tr_b16 v[58:59], v9 offset:33792
v_mfma_f32_16x16x32_bf16 v[40:43], v[64:67], v[132:135], v[40:43]
ds_read_b64_tr_b16 v[60:61], v9 offset:36864
v_mfma_f32_16x16x32_bf16 v[40:43], v[68:71], v[140:143], v[40:43]
ds_read_b64_tr_b16 v[62:63], v9 offset:37888
s_waitcnt lgkmcnt(10)
v_mfma_f32_16x16x32_bf16 v[28:31], v[72:75], v[128:131], v[28:31]
ds_read_b64_tr_b16 v[64:65], v10 offset:32768
s_waitcnt lgkmcnt(9)
v_mfma_f32_16x16x32_bf16 v[28:31], v[76:79], v[136:139], v[28:31]
ds_read_b64_tr_b16 v[66:67], v10 offset:33792
v_mfma_f32_16x16x32_bf16 v[44:47], v[72:75], v[132:135], v[44:47]
ds_read_b64_tr_b16 v[68:69], v10 offset:36864
v_mfma_f32_16x16x32_bf16 v[44:47], v[76:79], v[140:143], v[44:47]
ds_read_b64_tr_b16 v[70:71], v10 offset:37888
s_waitcnt vmcnt(11) lgkmcnt(10)
v_mfma_f32_16x16x32_bf16 v[16:19], v[48:51], v[144:147], v[16:19]
ds_read_b64_tr_b16 v[72:73], v11 offset:32768
buffer_load_dwordx4 v[192:195], v6, s[20:23], s66 offen offset:0 sc1
s_waitcnt vmcnt(11) lgkmcnt(9)
v_mfma_f32_16x16x32_bf16 v[16:19], v[52:55], v[152:155], v[16:19]
ds_read_b64_tr_b16 v[74:75], v11 offset:33792
s_waitcnt vmcnt(10)
v_mfma_f32_16x16x32_bf16 v[32:35], v[48:51], v[148:151], v[32:35]
ds_read_b64_tr_b16 v[76:77], v11 offset:36864
buffer_load_dwordx4 v[200:203], v6, s[20:23], s66 offen offset:2048 sc1
s_waitcnt vmcnt(10)
v_mfma_f32_16x16x32_bf16 v[32:35], v[52:55], v[156:159], v[32:35]
ds_read_b64_tr_b16 v[78:79], v11 offset:37888
s_waitcnt lgkmcnt(10)
v_mfma_f32_16x16x32_bf16 v[20:23], v[56:59], v[144:147], v[20:23]
ds_read_b64_tr_b16 v[48:49], v8 offset:40960
buffer_load_dwordx4 v[196:199], v6, s[20:23], s66 offen offset:256 sc1
s_waitcnt lgkmcnt(9)
v_mfma_f32_16x16x32_bf16 v[20:23], v[60:63], v[152:155], v[20:23]
ds_read_b64_tr_b16 v[50:51], v8 offset:41984
v_mfma_f32_16x16x32_bf16 v[36:39], v[56:59], v[148:151], v[36:39]
ds_read_b64_tr_b16 v[52:53], v8 offset:45056
buffer_load_dwordx4 v[204:207], v6, s[20:23], s66 offen offset:2304 sc1
s_add_u32 s66, s66, 4096
s_and_b32 s66, s66, 0xffff
v_mfma_f32_16x16x32_bf16 v[36:39], v[60:63], v[156:159], v[36:39]
ds_read_b64_tr_b16 v[54:55], v8 offset:46080
s_waitcnt lgkmcnt(10)
v_mfma_f32_16x16x32_bf16 v[24:27], v[64:67], v[144:147], v[24:27]
ds_read_b64_tr_b16 v[56:57], v9 offset:40960
s_waitcnt lgkmcnt(9)
v_mfma_f32_16x16x32_bf16 v[24:27], v[68:71], v[152:155], v[24:27]
ds_read_b64_tr_b16 v[58:59], v9 offset:41984
v_mfma_f32_16x16x32_bf16 v[40:43], v[64:67], v[148:151], v[40:43]
ds_read_b64_tr_b16 v[60:61], v9 offset:45056
v_mfma_f32_16x16x32_bf16 v[40:43], v[68:71], v[156:159], v[40:43]
ds_read_b64_tr_b16 v[62:63], v9 offset:46080
s_waitcnt lgkmcnt(10)
v_mfma_f32_16x16x32_bf16 v[28:31], v[72:75], v[144:147], v[28:31]
ds_read_b64_tr_b16 v[64:65], v10 offset:40960
s_waitcnt lgkmcnt(9)
v_mfma_f32_16x16x32_bf16 v[28:31], v[76:79], v[152:155], v[28:31]
ds_read_b64_tr_b16 v[66:67], v10 offset:41984
v_mfma_f32_16x16x32_bf16 v[44:47], v[72:75], v[148:151], v[44:47]
ds_read_b64_tr_b16 v[68:69], v10 offset:45056
v_mfma_f32_16x16x32_bf16 v[44:47], v[76:79], v[156:159], v[44:47]
ds_read_b64_tr_b16 v[70:71], v10 offset:46080
s_waitcnt vmcnt(11) lgkmcnt(10)
v_mfma_f32_16x16x32_bf16 v[16:19], v[48:51], v[160:163], v[16:19]
ds_read_b64_tr_b16 v[72:73], v11 offset:40960
buffer_load_dwordx4 v[80:83], v6, s[20:23], s66 offen offset:0 sc1
s_waitcnt vmcnt(11) lgkmcnt(9)
v_mfma_f32_16x16x32_bf16 v[16:19], v[52:55], v[168:171], v[16:19]
ds_read_b64_tr_b16 v[74:75], v11 offset:41984
s_waitcnt vmcnt(10)
v_mfma_f32_16x16x32_bf16 v[32:35], v[48:51], v[164:167], v[32:35]
ds_read_b64_tr_b16 v[76:77], v11 offset:45056
buffer_load_dwordx4 v[88:91], v6, s[20:23], s66 offen offset:2048 sc1
s_waitcnt vmcnt(10)
v_mfma_f32_16x16x32_bf16 v[32:35], v[52:55], v[172:175], v[32:35]
ds_read_b64_tr_b16 v[78:79], v11 offset:46080
s_waitcnt lgkmcnt(10)
v_mfma_f32_16x16x32_bf16 v[20:23], v[56:59], v[160:163], v[20:23]
ds_read_b64_tr_b16 v[48:49], v8 offset:49152
buffer_load_dwordx4 v[84:87], v6, s[20:23], s66 offen offset:256 sc1
s_waitcnt lgkmcnt(9)
v_mfma_f32_16x16x32_bf16 v[20:23], v[60:63], v[168:171], v[20:23]
ds_read_b64_tr_b16 v[50:51], v8 offset:50176
v_mfma_f32_16x16x32_bf16 v[36:39], v[56:59], v[164:167], v[36:39]
ds_read_b64_tr_b16 v[52:53], v8 offset:53248
buffer_load_dwordx4 v[92:95], v6, s[20:23], s66 offen offset:2304 sc1
s_add_u32 s66, s66, 4096
s_and_b32 s66, s66, 0xffff
v_mfma_f32_16x16x32_bf16 v[36:39], v[60:63], v[172:175], v[36:39]
ds_read_b64_tr_b16 v[54:55], v8 offset:54272
s_waitcnt lgkmcnt(10)
v_mfma_f32_16x16x32_bf16 v[24:27], v[64:67], v[160:163], v[24:27]
ds_read_b64_tr_b16 v[56:57], v9 offset:49152
s_waitcnt lgkmcnt(9)
v_mfma_f32_16x16x32_bf16 v[24:27], v[68:71], v[168:171], v[24:27]
ds_read_b64_tr_b16 v[58:59], v9 offset:50176
v_mfma_f32_16x16x32_bf16 v[40:43], v[64:67], v[164:167], v[40:43]
ds_read_b64_tr_b16 v[60:61], v9 offset:53248
v_mfma_f32_16x16x32_bf16 v[40:43], v[68:71], v[172:175], v[40:43]
ds_read_b64_tr_b16 v[62:63], v9 offset:54272
s_waitcnt lgkmcnt(10)
v_mfma_f32_16x16x32_bf16 v[28:31], v[72:75], v[160:163], v[28:31]
ds_read_b64_tr_b16 v[64:65], v10 offset:49152
s_waitcnt lgkmcnt(9)
v_mfma_f32_16x16x32_bf16 v[28:31], v[76:79], v[168:171], v[28:31]
ds_read_b64_tr_b16 v[66:67], v10 offset:50176
v_mfma_f32_16x16x32_bf16 v[44:47], v[72:75], v[164:167], v[44:47]
ds_read_b64_tr_b16 v[68:69], v10 offset:53248
v_mfma_f32_16x16x32_bf16 v[44:47], v[76:79], v[172:175], v[44:47]
ds_read_b64_tr_b16 v[70:71], v10 offset:54272
s_waitcnt vmcnt(11) lgkmcnt(10)
v_mfma_f32_16x16x32_bf16 v[16:19], v[48:51], v[176:179], v[16:19]
ds_read_b64_tr_b16 v[72:73], v11 offset:49152
buffer_load_dwordx4 v[96:99], v6, s[20:23], s66 offen offset:0 sc1
s_waitcnt vmcnt(11) lgkmcnt(9)
v_mfma_f32_16x16x32_bf16 v[16:19], v[52:55], v[184:187], v[16:19]
ds_read_b64_tr_b16 v[74:75], v11 offset:50176
s_waitcnt vmcnt(10)
v_mfma_f32_16x16x32_bf16 v[32:35], v[48:51], v[180:183], v[32:35]
ds_read_b64_tr_b16 v[76:77], v11 offset:53248
buffer_load_dwordx4 v[104:107], v6, s[20:23], s66 offen offset:2048 sc1
s_waitcnt vmcnt(10)
v_mfma_f32_16x16x32_bf16 v[32:35], v[52:55], v[188:191], v[32:35]
ds_read_b64_tr_b16 v[78:79], v11 offset:54272
s_waitcnt lgkmcnt(10)
v_mfma_f32_16x16x32_bf16 v[20:23], v[56:59], v[176:179], v[20:23]
ds_read_b64_tr_b16 v[48:49], v8 offset:57344
buffer_load_dwordx4 v[100:103], v6, s[20:23], s66 offen offset:256 sc1
s_waitcnt lgkmcnt(9)
v_mfma_f32_16x16x32_bf16 v[20:23], v[60:63], v[184:187], v[20:23]
ds_read_b64_tr_b16 v[50:51], v8 offset:58368
v_mfma_f32_16x16x32_bf16 v[36:39], v[56:59], v[180:183], v[36:39]
ds_read_b64_tr_b16 v[52:53], v8 offset:61440
buffer_load_dwordx4 v[108:111], v6, s[20:23], s66 offen offset:2304 sc1
s_add_u32 s66, s66, 4096
s_and_b32 s66, s66, 0xffff
v_mfma_f32_16x16x32_bf16 v[36:39], v[60:63], v[188:191], v[36:39]
ds_read_b64_tr_b16 v[54:55], v8 offset:62464
s_waitcnt lgkmcnt(10)
v_mfma_f32_16x16x32_bf16 v[24:27], v[64:67], v[176:179], v[24:27]
ds_read_b64_tr_b16 v[56:57], v9 offset:57344
s_waitcnt lgkmcnt(9)
v_mfma_f32_16x16x32_bf16 v[24:27], v[68:71], v[184:187], v[24:27]
ds_read_b64_tr_b16 v[58:59], v9 offset:58368
v_mfma_f32_16x16x32_bf16 v[40:43], v[64:67], v[180:183], v[40:43]
ds_read_b64_tr_b16 v[60:61], v9 offset:61440
v_mfma_f32_16x16x32_bf16 v[40:43], v[68:71], v[188:191], v[40:43]
ds_read_b64_tr_b16 v[62:63], v9 offset:62464
s_waitcnt lgkmcnt(10)
v_mfma_f32_16x16x32_bf16 v[28:31], v[72:75], v[176:179], v[28:31]
ds_read_b64_tr_b16 v[64:65], v10 offset:57344
s_waitcnt lgkmcnt(9)
v_mfma_f32_16x16x32_bf16 v[28:31], v[76:79], v[184:187], v[28:31]
ds_read_b64_tr_b16 v[66:67], v10 offset:58368
v_mfma_f32_16x16x32_bf16 v[44:47], v[72:75], v[180:183], v[44:47]
ds_read_b64_tr_b16 v[68:69], v10 offset:61440
v_mfma_f32_16x16x32_bf16 v[44:47], v[76:79], v[188:191], v[44:47]
ds_read_b64_tr_b16 v[70:71], v10 offset:62464
s_waitcnt vmcnt(11) lgkmcnt(10)
v_mfma_f32_16x16x32_bf16 v[16:19], v[48:51], v[192:195], v[16:19]
ds_read_b64_tr_b16 v[72:73], v11 offset:57344
buffer_load_dwordx4 v[112:115], v6, s[20:23], s66 offen offset:0 sc1
s_waitcnt vmcnt(11) lgkmcnt(9)
v_mfma_f32_16x16x32_bf16 v[16:19], v[52:55], v[200:203], v[16:19]
ds_read_b64_tr_b16 v[74:75], v11 offset:58368
s_waitcnt vmcnt(10)
v_mfma_f32_16x16x32_bf16 v[32:35], v[48:51], v[196:199], v[32:35]
ds_read_b64_tr_b16 v[76:77], v11 offset:61440
buffer_load_dwordx4 v[120:123], v6, s[20:23], s66 offen offset:2048 sc1
s_waitcnt vmcnt(10)
v_mfma_f32_16x16x32_bf16 v[32:35], v[52:55], v[204:207], v[32:35]
ds_read_b64_tr_b16 v[78:79], v11 offset:62464
s_waitcnt lgkmcnt(10)
v_mfma_f32_16x16x32_bf16 v[20:23], v[56:59], v[192:195], v[20:23]
ds_read_b64_tr_b16 v[48:49], v12 offset:0
buffer_load_dwordx4 v[116:119], v6, s[20:23], s66 offen offset:256 sc1
s_waitcnt lgkmcnt(9)
v_mfma_f32_16x16x32_bf16 v[20:23], v[60:63], v[200:203], v[20:23]
ds_read_b64_tr_b16 v[50:51], v12 offset:1024
v_mfma_f32_16x16x32_bf16 v[36:39], v[56:59], v[196:199], v[36:39]
ds_read_b64_tr_b16 v[52:53], v12 offset:4096
buffer_load_dwordx4 v[124:127], v6, s[20:23], s66 offen offset:2304 sc1
s_add_u32 s66, s66, 4096
s_and_b32 s66, s66, 0xffff
v_mfma_f32_16x16x32_bf16 v[36:39], v[60:63], v[204:207], v[36:39]
ds_read_b64_tr_b16 v[54:55], v12 offset:5120
s_waitcnt lgkmcnt(10)
v_mfma_f32_16x16x32_bf16 v[24:27], v[64:67], v[192:195], v[24:27]
ds_read_b64_tr_b16 v[56:57], v13 offset:0
s_waitcnt lgkmcnt(9)
v_mfma_f32_16x16x32_bf16 v[24:27], v[68:71], v[200:203], v[24:27]
ds_read_b64_tr_b16 v[58:59], v13 offset:1024
v_mfma_f32_16x16x32_bf16 v[40:43], v[64:67], v[196:199], v[40:43]
ds_read_b64_tr_b16 v[60:61], v13 offset:4096
v_mfma_f32_16x16x32_bf16 v[40:43], v[68:71], v[204:207], v[40:43]
ds_read_b64_tr_b16 v[62:63], v13 offset:5120
s_waitcnt lgkmcnt(10)
v_mfma_f32_16x16x32_bf16 v[28:31], v[72:75], v[192:195], v[28:31]
ds_read_b64_tr_b16 v[64:65], v14 offset:0
s_waitcnt lgkmcnt(9)
v_mfma_f32_16x16x32_bf16 v[28:31], v[76:79], v[200:203], v[28:31]
ds_read_b64_tr_b16 v[66:67], v14 offset:1024
v_mfma_f32_16x16x32_bf16 v[44:47], v[72:75], v[196:199], v[44:47]
ds_read_b64_tr_b16 v[68:69], v14 offset:4096
v_mfma_f32_16x16x32_bf16 v[44:47], v[76:79], v[204:207], v[44:47]
ds_read_b64_tr_b16 v[70:71], v14 offset:5120
s_waitcnt vmcnt(11) lgkmcnt(10)
v_mfma_f32_16x16x32_bf16 v[16:19], v[48:51], v[80:83], v[16:19]
ds_read_b64_tr_b16 v[72:73], v15 offset:0
buffer_load_dwordx4 v[128:131], v6, s[20:23], s66 offen offset:0 sc1
s_waitcnt vmcnt(11) lgkmcnt(9)
v_mfma_f32_16x16x32_bf16 v[16:19], v[52:55], v[88:91], v[16:19]
ds_read_b64_tr_b16 v[74:75], v15 offset:1024
s_waitcnt vmcnt(10)
v_mfma_f32_16x16x32_bf16 v[32:35], v[48:51], v[84:87], v[32:35]
ds_read_b64_tr_b16 v[76:77], v15 offset:4096
buffer_load_dwordx4 v[136:139], v6, s[20:23], s66 offen offset:2048 sc1
s_waitcnt vmcnt(10)
v_mfma_f32_16x16x32_bf16 v[32:35], v[52:55], v[92:95], v[32:35]
ds_read_b64_tr_b16 v[78:79], v15 offset:5120
s_waitcnt lgkmcnt(10)
v_mfma_f32_16x16x32_bf16 v[20:23], v[56:59], v[80:83], v[20:23]
ds_read_b64_tr_b16 v[48:49], v12 offset:8192
buffer_load_dwordx4 v[132:135], v6, s[20:23], s66 offen offset:256 sc1
s_waitcnt lgkmcnt(9)
v_mfma_f32_16x16x32_bf16 v[20:23], v[60:63], v[88:91], v[20:23]
ds_read_b64_tr_b16 v[50:51], v12 offset:9216
v_mfma_f32_16x16x32_bf16 v[36:39], v[56:59], v[84:87], v[36:39]
ds_read_b64_tr_b16 v[52:53], v12 offset:12288
buffer_load_dwordx4 v[140:143], v6, s[20:23], s66 offen offset:2304 sc1
s_add_u32 s66, s66, 4096
s_and_b32 s66, s66, 0xffff
v_mfma_f32_16x16x32_bf16 v[36:39], v[60:63], v[92:95], v[36:39]
ds_read_b64_tr_b16 v[54:55], v12 offset:13312
s_waitcnt lgkmcnt(10)
v_mfma_f32_16x16x32_bf16 v[24:27], v[64:67], v[80:83], v[24:27]
ds_read_b64_tr_b16 v[56:57], v13 offset:8192
s_waitcnt lgkmcnt(9)
v_mfma_f32_16x16x32_bf16 v[24:27], v[68:71], v[88:91], v[24:27]
ds_read_b64_tr_b16 v[58:59], v13 offset:9216
v_mfma_f32_16x16x32_bf16 v[40:43], v[64:67], v[84:87], v[40:43]
ds_read_b64_tr_b16 v[60:61], v13 offset:12288
v_mfma_f32_16x16x32_bf16 v[40:43], v[68:71], v[92:95], v[40:43]
ds_read_b64_tr_b16 v[62:63], v13 offset:13312
s_waitcnt lgkmcnt(10)
v_mfma_f32_16x16x32_bf16 v[28:31], v[72:75], v[80:83], v[28:31]
ds_read_b64_tr_b16 v[64:65], v14 offset:8192
s_waitcnt lgkmcnt(9)
v_mfma_f32_16x16x32_bf16 v[28:31], v[76:79], v[88:91], v[28:31]
ds_read_b64_tr_b16 v[66:67], v14 offset:9216
v_mfma_f32_16x16x32_bf16 v[44:47], v[72:75], v[84:87], v[44:47]
ds_read_b64_tr_b16 v[68:69], v14 offset:12288
v_mfma_f32_16x16x32_bf16 v[44:47], v[76:79], v[92:95], v[44:47]
ds_read_b64_tr_b16 v[70:71], v14 offset:13312
s_waitcnt vmcnt(11) lgkmcnt(10)
v_mfma_f32_16x16x32_bf16 v[16:19], v[48:51], v[96:99], v[16:19]
ds_read_b64_tr_b16 v[72:73], v15 offset:8192
buffer_load_dwordx4 v[144:147], v6, s[20:23], s66 offen offset:0 sc1
s_waitcnt vmcnt(11) lgkmcnt(9)
v_mfma_f32_16x16x32_bf16 v[16:19], v[52:55], v[104:107], v[16:19]
ds_read_b64_tr_b16 v[74:75], v15 offset:9216
s_waitcnt vmcnt(10)
v_mfma_f32_16x16x32_bf16 v[32:35], v[48:51], v[100:103], v[32:35]
ds_read_b64_tr_b16 v[76:77], v15 offset:12288
buffer_load_dwordx4 v[152:155], v6, s[20:23], s66 offen offset:2048 sc1
s_waitcnt vmcnt(10)
v_mfma_f32_16x16x32_bf16 v[32:35], v[52:55], v[108:111], v[32:35]
ds_read_b64_tr_b16 v[78:79], v15 offset:13312
s_waitcnt lgkmcnt(10)
v_mfma_f32_16x16x32_bf16 v[20:23], v[56:59], v[96:99], v[20:23]
ds_read_b64_tr_b16 v[48:49], v12 offset:16384
buffer_load_dwordx4 v[148:151], v6, s[20:23], s66 offen offset:256 sc1
s_waitcnt lgkmcnt(9)
v_mfma_f32_16x16x32_bf16 v[20:23], v[60:63], v[104:107], v[20:23]
ds_read_b64_tr_b16 v[50:51], v12 offset:17408
v_mfma_f32_16x16x32_bf16 v[36:39], v[56:59], v[100:103], v[36:39]
ds_read_b64_tr_b16 v[52:53], v12 offset:20480
buffer_load_dwordx4 v[156:159], v6, s[20:23], s66 offen offset:2304 sc1
s_add_u32 s66, s66, 4096
s_and_b32 s66, s66, 0xffff
v_mfma_f32_16x16x32_bf16 v[36:39], v[60:63], v[108:111], v[36:39]
ds_read_b64_tr_b16 v[54:55], v12 offset:21504
s_waitcnt lgkmcnt(10)
v_mfma_f32_16x16x32_bf16 v[24:27], v[64:67], v[96:99], v[24:27]
ds_read_b64_tr_b16 v[56:57], v13 offset:16384
s_waitcnt lgkmcnt(9)
v_mfma_f32_16x16x32_bf16 v[24:27], v[68:71], v[104:107], v[24:27]
ds_read_b64_tr_b16 v[58:59], v13 offset:17408
v_mfma_f32_16x16x32_bf16 v[40:43], v[64:67], v[100:103], v[40:43]
ds_read_b64_tr_b16 v[60:61], v13 offset:20480
v_mfma_f32_16x16x32_bf16 v[40:43], v[68:71], v[108:111], v[40:43]
ds_read_b64_tr_b16 v[62:63], v13 offset:21504
s_waitcnt lgkmcnt(10)
v_mfma_f32_16x16x32_bf16 v[28:31], v[72:75], v[96:99], v[28:31]
ds_read_b64_tr_b16 v[64:65], v14 offset:16384
s_waitcnt lgkmcnt(9)
v_mfma_f32_16x16x32_bf16 v[28:31], v[76:79], v[104:107], v[28:31]
ds_read_b64_tr_b16 v[66:67], v14 offset:17408
v_mfma_f32_16x16x32_bf16 v[44:47], v[72:75], v[100:103], v[44:47]
ds_read_b64_tr_b16 v[68:69], v14 offset:20480
v_mfma_f32_16x16x32_bf16 v[44:47], v[76:79], v[108:111], v[44:47]
ds_read_b64_tr_b16 v[70:71], v14 offset:21504
s_waitcnt vmcnt(11) lgkmcnt(10)
v_mfma_f32_16x16x32_bf16 v[16:19], v[48:51], v[112:115], v[16:19]
ds_read_b64_tr_b16 v[72:73], v15 offset:16384
buffer_load_dwordx4 v[160:163], v6, s[20:23], s66 offen offset:0 sc1
s_waitcnt vmcnt(11) lgkmcnt(9)
v_mfma_f32_16x16x32_bf16 v[16:19], v[52:55], v[120:123], v[16:19]
ds_read_b64_tr_b16 v[74:75], v15 offset:17408
s_waitcnt vmcnt(10)
v_mfma_f32_16x16x32_bf16 v[32:35], v[48:51], v[116:119], v[32:35]
ds_read_b64_tr_b16 v[76:77], v15 offset:20480
buffer_load_dwordx4 v[168:171], v6, s[20:23], s66 offen offset:2048 sc1
s_waitcnt vmcnt(10)
v_mfma_f32_16x16x32_bf16 v[32:35], v[52:55], v[124:127], v[32:35]
ds_read_b64_tr_b16 v[78:79], v15 offset:21504
s_waitcnt lgkmcnt(10)
v_mfma_f32_16x16x32_bf16 v[20:23], v[56:59], v[112:115], v[20:23]
ds_read_b64_tr_b16 v[48:49], v12 offset:24576
buffer_load_dwordx4 v[164:167], v6, s[20:23], s66 offen offset:256 sc1
s_waitcnt lgkmcnt(9)
v_mfma_f32_16x16x32_bf16 v[20:23], v[60:63], v[120:123], v[20:23]
ds_read_b64_tr_b16 v[50:51], v12 offset:25600
v_mfma_f32_16x16x32_bf16 v[36:39], v[56:59], v[116:119], v[36:39]
ds_read_b64_tr_b16 v[52:53], v12 offset:28672
buffer_load_dwordx4 v[172:175], v6, s[20:23], s66 offen offset:2304 sc1
s_add_u32 s66, s66, 4096
s_and_b32 s66, s66, 0xffff
v_mfma_f32_16x16x32_bf16 v[36:39], v[60:63], v[124:127], v[36:39]
ds_read_b64_tr_b16 v[54:55], v12 offset:29696
s_waitcnt lgkmcnt(10)
v_mfma_f32_16x16x32_bf16 v[24:27], v[64:67], v[112:115], v[24:27]
ds_read_b64_tr_b16 v[56:57], v13 offset:24576
s_waitcnt lgkmcnt(9)
v_mfma_f32_16x16x32_bf16 v[24:27], v[68:71], v[120:123], v[24:27]
ds_read_b64_tr_b16 v[58:59], v13 offset:25600
v_mfma_f32_16x16x32_bf16 v[40:43], v[64:67], v[116:119], v[40:43]
ds_read_b64_tr_b16 v[60:61], v13 offset:28672
v_mfma_f32_16x16x32_bf16 v[40:43], v[68:71], v[124:127], v[40:43]
ds_read_b64_tr_b16 v[62:63], v13 offset:29696
s_waitcnt lgkmcnt(10)
v_mfma_f32_16x16x32_bf16 v[28:31], v[72:75], v[112:115], v[28:31]
ds_read_b64_tr_b16 v[64:65], v14 offset:24576
s_waitcnt lgkmcnt(9)
v_mfma_f32_16x16x32_bf16 v[28:31], v[76:79], v[120:123], v[28:31]
ds_read_b64_tr_b16 v[66:67], v14 offset:25600
v_mfma_f32_16x16x32_bf16 v[44:47], v[72:75], v[116:119], v[44:47]
ds_read_b64_tr_b16 v[68:69], v14 offset:28672
v_mfma_f32_16x16x32_bf16 v[44:47], v[76:79], v[124:127], v[44:47]
ds_read_b64_tr_b16 v[70:71], v14 offset:29696
s_waitcnt vmcnt(11) lgkmcnt(10)
v_mfma_f32_16x16x32_bf16 v[16:19], v[48:51], v[128:131], v[16:19]
ds_read_b64_tr_b16 v[72:73], v15 offset:24576
buffer_load_dwordx4 v[176:179], v6, s[20:23], s66 offen offset:0 sc1
s_waitcnt vmcnt(11) lgkmcnt(9)
v_mfma_f32_16x16x32_bf16 v[16:19], v[52:55], v[136:139], v[16:19]
ds_read_b64_tr_b16 v[74:75], v15 offset:25600
s_waitcnt vmcnt(10)
v_mfma_f32_16x16x32_bf16 v[32:35], v[48:51], v[132:135], v[32:35]
ds_read_b64_tr_b16 v[76:77], v15 offset:28672
buffer_load_dwordx4 v[184:187], v6, s[20:23], s66 offen offset:2048 sc1
s_waitcnt vmcnt(10)
v_mfma_f32_16x16x32_bf16 v[32:35], v[52:55], v[140:143], v[32:35]
ds_read_b64_tr_b16 v[78:79], v15 offset:29696
s_waitcnt lgkmcnt(10)
v_mfma_f32_16x16x32_bf16 v[20:23], v[56:59], v[128:131], v[20:23]
ds_read_b64_tr_b16 v[48:49], v12 offset:32768
buffer_load_dwordx4 v[180:183], v6, s[20:23], s66 offen offset:256 sc1
s_waitcnt lgkmcnt(9)
v_mfma_f32_16x16x32_bf16 v[20:23], v[60:63], v[136:139], v[20:23]
ds_read_b64_tr_b16 v[50:51], v12 offset:33792
v_mfma_f32_16x16x32_bf16 v[36:39], v[56:59], v[132:135], v[36:39]
ds_read_b64_tr_b16 v[52:53], v12 offset:36864
buffer_load_dwordx4 v[188:191], v6, s[20:23], s66 offen offset:2304 sc1
s_add_u32 s66, s66, 4096
s_and_b32 s66, s66, 0xffff
v_mfma_f32_16x16x32_bf16 v[36:39], v[60:63], v[140:143], v[36:39]
ds_read_b64_tr_b16 v[54:55], v12 offset:37888
s_waitcnt lgkmcnt(10)
v_mfma_f32_16x16x32_bf16 v[24:27], v[64:67], v[128:131], v[24:27]
ds_read_b64_tr_b16 v[56:57], v13 offset:32768
s_waitcnt lgkmcnt(9)
v_mfma_f32_16x16x32_bf16 v[24:27], v[68:71], v[136:139], v[24:27]
ds_read_b64_tr_b16 v[58:59], v13 offset:33792
v_mfma_f32_16x16x32_bf16 v[40:43], v[64:67], v[132:135], v[40:43]
ds_read_b64_tr_b16 v[60:61], v13 offset:36864
v_mfma_f32_16x16x32_bf16 v[40:43], v[68:71], v[140:143], v[40:43]
ds_read_b64_tr_b16 v[62:63], v13 offset:37888
s_waitcnt lgkmcnt(10)
v_mfma_f32_16x16x32_bf16 v[28:31], v[72:75], v[128:131], v[28:31]
ds_read_b64_tr_b16 v[64:65], v14 offset:32768
s_waitcnt lgkmcnt(9)
v_mfma_f32_16x16x32_bf16 v[28:31], v[76:79], v[136:139], v[28:31]
ds_read_b64_tr_b16 v[66:67], v14 offset:33792
v_mfma_f32_16x16x32_bf16 v[44:47], v[72:75], v[132:135], v[44:47]
ds_read_b64_tr_b16 v[68:69], v14 offset:36864
v_mfma_f32_16x16x32_bf16 v[44:47], v[76:79], v[140:143], v[44:47]
ds_read_b64_tr_b16 v[70:71], v14 offset:37888
s_waitcnt vmcnt(11) lgkmcnt(10)
v_mfma_f32_16x16x32_bf16 v[16:19], v[48:51], v[144:147], v[16:19]
ds_read_b64_tr_b16 v[72:73], v15 offset:32768
buffer_load_dwordx4 v[192:195], v6, s[20:23], s66 offen offset:0 sc1
s_waitcnt vmcnt(11) lgkmcnt(9)
v_mfma_f32_16x16x32_bf16 v[16:19], v[52:55], v[152:155], v[16:19]
ds_read_b64_tr_b16 v[74:75], v15 offset:33792
s_waitcnt vmcnt(10)
v_mfma_f32_16x16x32_bf16 v[32:35], v[48:51], v[148:151], v[32:35]
ds_read_b64_tr_b16 v[76:77], v15 offset:36864
buffer_load_dwordx4 v[200:203], v6, s[20:23], s66 offen offset:2048 sc1
s_waitcnt vmcnt(10)
v_mfma_f32_16x16x32_bf16 v[32:35], v[52:55], v[156:159], v[32:35]
ds_read_b64_tr_b16 v[78:79], v15 offset:37888
s_waitcnt lgkmcnt(10)
v_mfma_f32_16x16x32_bf16 v[20:23], v[56:59], v[144:147], v[20:23]
ds_read_b64_tr_b16 v[48:49], v12 offset:40960
buffer_load_dwordx4 v[196:199], v6, s[20:23], s66 offen offset:256 sc1
s_waitcnt lgkmcnt(9)
v_mfma_f32_16x16x32_bf16 v[20:23], v[60:63], v[152:155], v[20:23]
ds_read_b64_tr_b16 v[50:51], v12 offset:41984
v_mfma_f32_16x16x32_bf16 v[36:39], v[56:59], v[148:151], v[36:39]
ds_read_b64_tr_b16 v[52:53], v12 offset:45056
buffer_load_dwordx4 v[204:207], v6, s[20:23], s66 offen offset:2304 sc1
s_add_u32 s66, s66, 4096
s_and_b32 s66, s66, 0xffff
v_mfma_f32_16x16x32_bf16 v[36:39], v[60:63], v[156:159], v[36:39]
ds_read_b64_tr_b16 v[54:55], v12 offset:46080
s_waitcnt lgkmcnt(10)
v_mfma_f32_16x16x32_bf16 v[24:27], v[64:67], v[144:147], v[24:27]
ds_read_b64_tr_b16 v[56:57], v13 offset:40960
s_waitcnt lgkmcnt(9)
v_mfma_f32_16x16x32_bf16 v[24:27], v[68:71], v[152:155], v[24:27]
ds_read_b64_tr_b16 v[58:59], v13 offset:41984
v_mfma_f32_16x16x32_bf16 v[40:43], v[64:67], v[148:151], v[40:43]
ds_read_b64_tr_b16 v[60:61], v13 offset:45056
v_mfma_f32_16x16x32_bf16 v[40:43], v[68:71], v[156:159], v[40:43]
ds_read_b64_tr_b16 v[62:63], v13 offset:46080
s_waitcnt lgkmcnt(10)
v_mfma_f32_16x16x32_bf16 v[28:31], v[72:75], v[144:147], v[28:31]
ds_read_b64_tr_b16 v[64:65], v14 offset:40960
s_waitcnt lgkmcnt(9)
v_mfma_f32_16x16x32_bf16 v[28:31], v[76:79], v[152:155], v[28:31]
ds_read_b64_tr_b16 v[66:67], v14 offset:41984
v_mfma_f32_16x16x32_bf16 v[44:47], v[72:75], v[148:151], v[44:47]
ds_read_b64_tr_b16 v[68:69], v14 offset:45056
v_mfma_f32_16x16x32_bf16 v[44:47], v[76:79], v[156:159], v[44:47]
ds_read_b64_tr_b16 v[70:71], v14 offset:46080
s_waitcnt vmcnt(11) lgkmcnt(10)
v_mfma_f32_16x16x32_bf16 v[16:19], v[48:51], v[160:163], v[16:19]
ds_read_b64_tr_b16 v[72:73], v15 offset:40960
s_waitcnt vmcnt(10) lgkmcnt(9)
v_mfma_f32_16x16x32_bf16 v[16:19], v[52:55], v[168:171], v[16:19]
ds_read_b64_tr_b16 v[74:75], v15 offset:41984
s_waitcnt vmcnt(9)
v_mfma_f32_16x16x32_bf16 v[32:35], v[48:51], v[164:167], v[32:35]
ds_read_b64_tr_b16 v[76:77], v15 offset:45056
s_waitcnt vmcnt(8)
v_mfma_f32_16x16x32_bf16 v[32:35], v[52:55], v[172:175], v[32:35]
ds_read_b64_tr_b16 v[78:79], v15 offset:46080
s_waitcnt lgkmcnt(10)
v_mfma_f32_16x16x32_bf16 v[20:23], v[56:59], v[160:163], v[20:23]
ds_read_b64_tr_b16 v[48:49], v12 offset:49152
s_waitcnt lgkmcnt(9)
v_mfma_f32_16x16x32_bf16 v[20:23], v[60:63], v[168:171], v[20:23]
ds_read_b64_tr_b16 v[50:51], v12 offset:50176
v_mfma_f32_16x16x32_bf16 v[36:39], v[56:59], v[164:167], v[36:39]
ds_read_b64_tr_b16 v[52:53], v12 offset:53248
v_mfma_f32_16x16x32_bf16 v[36:39], v[60:63], v[172:175], v[36:39]
ds_read_b64_tr_b16 v[54:55], v12 offset:54272
s_waitcnt lgkmcnt(10)
v_mfma_f32_16x16x32_bf16 v[24:27], v[64:67], v[160:163], v[24:27]
ds_read_b64_tr_b16 v[56:57], v13 offset:49152
s_waitcnt lgkmcnt(9)
v_mfma_f32_16x16x32_bf16 v[24:27], v[68:71], v[168:171], v[24:27]
ds_read_b64_tr_b16 v[58:59], v13 offset:50176
v_mfma_f32_16x16x32_bf16 v[40:43], v[64:67], v[164:167], v[40:43]
ds_read_b64_tr_b16 v[60:61], v13 offset:53248
v_mfma_f32_16x16x32_bf16 v[40:43], v[68:71], v[172:175], v[40:43]
ds_read_b64_tr_b16 v[62:63], v13 offset:54272
s_waitcnt lgkmcnt(10)
v_mfma_f32_16x16x32_bf16 v[28:31], v[72:75], v[160:163], v[28:31]
ds_read_b64_tr_b16 v[64:65], v14 offset:49152
s_waitcnt lgkmcnt(9)
v_mfma_f32_16x16x32_bf16 v[28:31], v[76:79], v[168:171], v[28:31]
ds_read_b64_tr_b16 v[66:67], v14 offset:50176
v_mfma_f32_16x16x32_bf16 v[44:47], v[72:75], v[164:167], v[44:47]
ds_read_b64_tr_b16 v[68:69], v14 offset:53248
v_mfma_f32_16x16x32_bf16 v[44:47], v[76:79], v[172:175], v[44:47]
ds_read_b64_tr_b16 v[70:71], v14 offset:54272
s_waitcnt vmcnt(7) lgkmcnt(10)
v_mfma_f32_16x16x32_bf16 v[16:19], v[48:51], v[176:179], v[16:19]
ds_read_b64_tr_b16 v[72:73], v15 offset:49152
s_waitcnt vmcnt(6) lgkmcnt(9)
v_mfma_f32_16x16x32_bf16 v[16:19], v[52:55], v[184:187], v[16:19]
ds_read_b64_tr_b16 v[74:75], v15 offset:50176
s_waitcnt vmcnt(5)
v_mfma_f32_16x16x32_bf16 v[32:35], v[48:51], v[180:183], v[32:35]
ds_read_b64_tr_b16 v[76:77], v15 offset:53248
s_waitcnt vmcnt(4)
v_mfma_f32_16x16x32_bf16 v[32:35], v[52:55], v[188:191], v[32:35]
ds_read_b64_tr_b16 v[78:79], v15 offset:54272
s_waitcnt lgkmcnt(10)
v_mfma_f32_16x16x32_bf16 v[20:23], v[56:59], v[176:179], v[20:23]
ds_read_b64_tr_b16 v[48:49], v12 offset:57344
s_waitcnt lgkmcnt(9)
v_mfma_f32_16x16x32_bf16 v[20:23], v[60:63], v[184:187], v[20:23]
ds_read_b64_tr_b16 v[50:51], v12 offset:58368
v_mfma_f32_16x16x32_bf16 v[36:39], v[56:59], v[180:183], v[36:39]
ds_read_b64_tr_b16 v[52:53], v12 offset:61440
v_mfma_f32_16x16x32_bf16 v[36:39], v[60:63], v[188:191], v[36:39]
ds_read_b64_tr_b16 v[54:55], v12 offset:62464
s_waitcnt lgkmcnt(10)
v_mfma_f32_16x16x32_bf16 v[24:27], v[64:67], v[176:179], v[24:27]
ds_read_b64_tr_b16 v[56:57], v13 offset:57344
s_waitcnt lgkmcnt(9)
v_mfma_f32_16x16x32_bf16 v[24:27], v[68:71], v[184:187], v[24:27]
ds_read_b64_tr_b16 v[58:59], v13 offset:58368
v_mfma_f32_16x16x32_bf16 v[40:43], v[64:67], v[180:183], v[40:43]
ds_read_b64_tr_b16 v[60:61], v13 offset:61440
v_mfma_f32_16x16x32_bf16 v[40:43], v[68:71], v[188:191], v[40:43]
ds_read_b64_tr_b16 v[62:63], v13 offset:62464
s_waitcnt lgkmcnt(10)
v_mfma_f32_16x16x32_bf16 v[28:31], v[72:75], v[176:179], v[28:31]
ds_read_b64_tr_b16 v[64:65], v14 offset:57344
s_waitcnt lgkmcnt(9)
v_mfma_f32_16x16x32_bf16 v[28:31], v[76:79], v[184:187], v[28:31]
ds_read_b64_tr_b16 v[66:67], v14 offset:58368
v_mfma_f32_16x16x32_bf16 v[44:47], v[72:75], v[180:183], v[44:47]
ds_read_b64_tr_b16 v[68:69], v14 offset:61440
v_mfma_f32_16x16x32_bf16 v[44:47], v[76:79], v[188:191], v[44:47]
ds_read_b64_tr_b16 v[70:71], v14 offset:62464
s_waitcnt vmcnt(3) lgkmcnt(10)
v_mfma_f32_16x16x32_bf16 v[16:19], v[48:51], v[192:195], v[16:19]
ds_read_b64_tr_b16 v[72:73], v15 offset:57344
s_waitcnt vmcnt(2) lgkmcnt(9)
v_mfma_f32_16x16x32_bf16 v[16:19], v[52:55], v[200:203], v[16:19]
ds_read_b64_tr_b16 v[74:75], v15 offset:58368
s_waitcnt vmcnt(1)
v_mfma_f32_16x16x32_bf16 v[32:35], v[48:51], v[196:199], v[32:35]
ds_read_b64_tr_b16 v[76:77], v15 offset:61440
s_waitcnt vmcnt(0)
v_mfma_f32_16x16x32_bf16 v[32:35], v[52:55], v[204:207], v[32:35]
ds_read_b64_tr_b16 v[78:79], v15 offset:62464
s_waitcnt lgkmcnt(10)
v_mfma_f32_16x16x32_bf16 v[20:23], v[56:59], v[192:195], v[20:23]
v_add_u32 v5, s34, 22
s_mov_b64 exec, 1
ds_write_b32 v3, v5
s_mov_b64 exec, -1
s_waitcnt lgkmcnt(9)
v_mfma_f32_16x16x32_bf16 v[20:23], v[60:63], v[200:203], v[20:23]
s_lshl2_add_u32 s73, s61, s58
s_lshl4_add_u32 s66, s61, s62
s_lshl2_add_u32 s68, s66, s58
v_mfma_f32_16x16x32_bf16 v[36:39], v[56:59], v[196:199], v[36:39]
s_lshl_b32 s68, s68, 12
s_add_u32 s68, s68, 26214400
s_lshl_b32 s66, s61, 7
v_mfma_f32_16x16x32_bf16 v[36:39], v[60:63], v[204:207], v[36:39]
s_add_u32 s66, s66, s62
s_lshl_b32 s66, s66, 7
s_add_u32 s66, s66, 274432
s_waitcnt lgkmcnt(7)
v_mfma_f32_16x16x32_bf16 v[24:27], v[64:67], v[192:195], v[24:27]
s_lshl_b32 s74, s73, 13
s_add_u32 s74, s74, 524288
s_lshl_b32 s67, s62, 9
s_waitcnt lgkmcnt(5)
v_mfma_f32_16x16x32_bf16 v[24:27], v[68:71], v[200:203], v[24:27]
s_add_u32 s67, s67, s74
v_lshlrev_b32 v6, 4, v0
s_mov_b32 s69, 0x3f803f80
v_mfma_f32_16x16x32_bf16 v[40:43], v[64:67], v[196:199], v[40:43]
v_mov_b32 v8, 0
v_mov_b32 v9, 0
v_mov_b32 v10, 0
v_mfma_f32_16x16x32_bf16 v[40:43], v[68:71], v[204:207], v[40:43]
v_mov_b32 v12, 0
v_mov_b32 v13, 0
v_mov_b32 v14, 0
s_waitcnt lgkmcnt(3)
v_mfma_f32_16x16x32_bf16 v[28:31], v[72:75], v[192:195], v[28:31]
v_mov_b32 v11, v208
v_cvt_pk_bf16_f32 v240, v16, v17
v_cvt_pk_bf16_f32 v241, v18, v19
s_waitcnt lgkmcnt(1)
v_mfma_f32_16x16x32_bf16 v[28:31], v[76:79], v[200:203], v[28:31]
v_cvt_pk_bf16_f32 v248, v32, v33
v_cvt_pk_bf16_f32 v249, v34, v35
v_cvt_pk_bf16_f32 v242, v20, v21
v_mfma_f32_16x16x32_bf16 v[44:47], v[72:75], v[196:199], v[44:47]
v_cvt_pk_bf16_f32 v243, v22, v23
v_cvt_pk_bf16_f32 v250, v36, v37
v_cvt_pk_bf16_f32 v251, v38, v39
v_mfma_f32_16x16x32_bf16 v[44:47], v[76:79], v[204:207], v[44:47]
s_cmp_eq_u32 s63, 0
v_cvt_pk_bf16_f32 v244, v24, v25
v_cvt_pk_bf16_f32 v245, v26, v27
v_cvt_pk_bf16_f32 v252, v40, v41
v_cvt_pk_bf16_f32 v253, v42, v43
v_cvt_pk_bf16_f32 v246, v28, v29
v_cvt_pk_bf16_f32 v247, v30, v31
s_nop 0
v_cvt_pk_bf16_f32 v254, v44, v45
v_cvt_pk_bf16_f32 v255, v46, v47
s_cselect_b64 exec, -1, 0
s_cmp_eq_u32 s57, 0
s_cbranch_scc1 far_169
buffer_store_dwordx4 v[240:243], v6, s[20:23], s68 offen offset:0
buffer_store_dwordx4 v[244:247], v6, s[20:23], s68 offen offset:1024
buffer_store_dwordx4 v[248:251], v6, s[20:23], s68 offen offset:2048
buffer_store_dwordx4 v[252:255], v6, s[20:23], s68 offen offset:3072
near_170:
s_mov_b64 exec, -1
v_dot2c_f32_bf16 v8, s69, v240
v_dot2c_f32_bf16 v9, v240, v240
v_dot2c_f32_bf16 v10, v232, v240
v_dot2c_f32_bf16 v12, s69, v248
v_dot2c_f32_bf16 v13, v248, v248
v_dot2c_f32_bf16 v14, v232, v248
v_dot2c_f32_bf16 v8, s69, v241
v_dot2c_f32_bf16 v9, v241, v241
v_dot2c_f32_bf16 v10, v233, v241
v_dot2c_f32_bf16 v12, s69, v249
v_dot2c_f32_bf16 v13, v249, v249
v_dot2c_f32_bf16 v14, v233, v249
v_dot2c_f32_bf16 v8, s69, v242
v_dot2c_f32_bf16 v9, v242, v242
v_dot2c_f32_bf16 v10, v234, v242
v_dot2c_f32_bf16 v12, s69, v250
v_dot2c_f32_bf16 v13, v250, v250
v_dot2c_f32_bf16 v14, v234, v250
v_dot2c_f32_bf16 v8, s69, v243
v_dot2c_f32_bf16 v9, v243, v243
v_dot2c_f32_bf16 v10, v235, v243
v_dot2c_f32_bf16 v12, s69, v251
v_dot2c_f32_bf16 v13, v251, v251
v_dot2c_f32_bf16 v14, v235, v251
v_dot2c_f32_bf16 v8, s69, v244
v_dot2c_f32_bf16 v9, v244, v244
v_dot2c_f32_bf16 v10, v236, v244
v_dot2c_f32_bf16 v12, s69, v252
v_dot2c_f32_bf16 v13, v252, v252
v_dot2c_f32_bf16 v14, v236, v252
v_dot2c_f32_bf16 v8, s69, v245
v_dot2c_f32_bf16 v9, v245, v245
v_dot2c_f32_bf16 v10, v237, v245
v_dot2c_f32_bf16 v12, s69, v253
v_dot2c_f32_bf16 v13, v253, v253
v_dot2c_f32_bf16 v14, v237, v253
v_dot2c_f32_bf16 v8, s69, v246
v_dot2c_f32_bf16 v9, v246, v246
v_dot2c_f32_bf16 v10, v238, v246
v_dot2c_f32_bf16 v12, s69, v254
v_dot2c_f32_bf16 v13, v254, v254
v_dot2c_f32_bf16 v14, v238, v254
v_dot2c_f32_bf16 v8, s69, v247
v_dot2c_f32_bf16 v9, v247, v247
v_dot2c_f32_bf16 v10, v239, v247
v_dot2c_f32_bf16 v12, s69, v255
v_dot2c_f32_bf16 v13, v255, v255
v_dot2c_f32_bf16 v14, v239, v255
v_mov_b32 v15, v11
v_lshrrev_b32 v7, 5, v0
v_mul_u32_u24 v7, 3584, v7
v_permlane16_swap_b32 v8, v12
v_permlane16_swap_b32 v9, v13
v_permlane16_swap_b32 v10, v14
v_permlane16_swap_b32 v11, v15
v_pk_add_f32 v[8:9], v[8:9], v[12:13]
v_pk_add_f32 v[10:11], v[10:11], v[14:15]
v_mov_b32 v12, v8
v_mov_b32 v13, v9
v_mov_b32 v14, v10
v_mov_b32 v15, v11
v_permlane32_swap_b32 v12, v8
v_permlane32_swap_b32 v13, v9
v_permlane32_swap_b32 v14, v10
v_permlane32_swap_b32 v15, v11
v_pk_add_f32 v[8:9], v[8:9], v[12:13]
v_pk_add_f32 v[10:11], v[10:11], v[14:15]
v_add_u32 v7, v6, v7
v_max_u32 v8, 1, v8
v_max_u32 v9, 1, v9
v_max_u32 v10, 1, v10
v_max_u32 v11, 1, v11
s_mov_b32 exec_hi, 0
s_cmp_eq_u32 s57, 0
s_cbranch_scc1 far_171
buffer_store_dwordx4 v[8:11], v6, s[24:27], s67 offen
near_172:
s_mov_b32 exec_hi, -1
v_lshlrev_b32 v16, 16, v240
v_and_b32 v17, 0xffff0000, v240
v_lshlrev_b32 v18, 16, v241
v_and_b32 v19, 0xffff0000, v241
v_lshlrev_b32 v20, 16, v242
v_and_b32 v21, 0xffff0000, v242
v_lshlrev_b32 v22, 16, v243
v_and_b32 v23, 0xffff0000, v243
v_lshlrev_b32 v24, 16, v244
v_and_b32 v25, 0xffff0000, v244
v_lshlrev_b32 v26, 16, v245
v_and_b32 v27, 0xffff0000, v245
v_lshlrev_b32 v28, 16, v246
v_and_b32 v29, 0xffff0000, v246
v_lshlrev_b32 v30, 16, v247
v_and_b32 v31, 0xffff0000, v247
v_lshlrev_b32 v32, 16, v248
v_and_b32 v33, 0xffff0000, v248
v_lshlrev_b32 v34, 16, v249
v_and_b32 v35, 0xffff0000, v249
v_lshlrev_b32 v36, 16, v250
v_and_b32 v37, 0xffff0000, v250
v_lshlrev_b32 v38, 16, v251
v_and_b32 v39, 0xffff0000, v251
v_lshlrev_b32 v40, 16, v252
v_and_b32 v41, 0xffff0000, v252
v_lshlrev_b32 v42, 16, v253
v_and_b32 v43, 0xffff0000, v253
v_lshlrev_b32 v44, 16, v254
v_and_b32 v45, 0xffff0000, v254
v_lshlrev_b32 v46, 16, v255
v_and_b32 v47, 0xffff0000, v255
v_and_b32 v14, 15, v0
v_lshlrev_b32 v14, 11, v14
v_bfe_u32 v15, v0, 4, 1
v_lshl_add_u32 v14, v15, 5, v14
v_lshrrev_b32 v15, 5, v0
v_lshl_add_u32 v14, v15, 4, v14
s_lshl2_add_u32 s70, s61, s58
s_lshl_b32 s70, s70, 16
s_lshl_b32 s71, s62, 7
s_add_u32 s70, s70, s71
s_add_u32 s71, s70, 0x8000
s_lshl_b32 s67, s62, 6
s_sub_u32 s68, s66, 2048
s_lshl1_add_u32 s69, s67, s68
s_sub_u32 s69, s69, 10240
s_sub_u32 s72, s68, s67
s_add_u32 s72, s72, 4096
s_lshl_b32 s75, s73, 5
s_add_u32 s75, s75, 1
v_and_b32 v15, 48, v0
v_add_u32 v13, s75, v0
v_lshlrev_b32 v4, 1, v15
s_mov_b64 exec, 1
s_waitcnt vmcnt(1)
s_cmp_eq_u32 s57, 0
s_cbranch_scc1 far_173
buffer_store_dword v212, v3, s[24:27], s66 offen
near_174:
s_mov_b64 exec, -1
v_add_u32 v5, s34, 23
s_mov_b64 exec, 1
ds_write_b32 v3, v5
s_mov_b64 exec, -1
s_waitcnt vmcnt(1)
buffer_load_dwordx4 v[80:83], v7, s[24:27], s74 offen offset:0 sc1
buffer_load_dwordx4 v[84:87], v7, s[24:27], s74 offen offset:512 sc1
buffer_load_dwordx4 v[88:91], v7, s[24:27], s74 offen offset:1024 sc1
buffer_load_dwordx4 v[92:95], v7, s[24:27], s74 offen offset:1536 sc1
buffer_load_dwordx4 v[96:99], v7, s[24:27], s74 offen offset:2048 sc1
buffer_load_dwordx4 v[100:103], v7, s[24:27], s74 offen offset:2560 sc1
buffer_load_dwordx4 v[104:107], v7, s[24:27], s74 offen offset:3072 sc1
buffer_load_dwordx4 v[108:111], v7, s[24:27], s74 offen offset:3584 sc1
s_cmp_eq_u32 s63, 0
s_cbranch_scc0 mhz_175
v_lshrrev_b32 v196, 4, v0
s_cmp_eq_u32 1, 0
s_cbranch_scc0 mq_176
v_bfe_u32 v197, v0, 1, 3
v_xor_b32 v197, v197, v196
v_lshlrev_b32 v197, 4, v197
v_and_b32 v198, 15, v0
v_lshl_add_u32 v192, v198, 7, v197
v_xor_b32 v193, 64, v192
s_branch mq_177
mq_176:
v_lshlrev_b32 v192, 4, v0
v_add_u32 v193, 1024, v192
mq_177:
s_lshl_b32 s46, s65, 13
s_add_u32 s46, s46, 86016
v_add_u32 v192, s46, v192
v_add_u32 v193, s46, v193
v_bfe_u32 v197, v0, 2, 2
v_lshl_add_u32 v197, v196, 3, v197
v_bfe_u32 v198, v0, 3, 2
s_lshl_b32 s46, s64, 1
v_xor_b32 v198, s46, v198
v_lshlrev_b32 v198, 5, v198
v_lshl_add_u32 v197, v197, 7, v198
v_and_b32 v198, 3, v0
v_lshl_add_u32 v197, v198, 3, v197
v_add_u32 v194, 102400, v197
v_xor_b32 v195, 32, v194
v_mov_b32 v197, 0xf149f2ca
v_xor_b32 v216, v197, v216
v_xor_b32 v217, v197, v217
v_xor_b32 v218, v197, v218
v_xor_b32 v219, v197, v219
v_xor_b32 v220, v197, v220
v_xor_b32 v221, v197, v221
v_xor_b32 v222, v197, v222
v_xor_b32 v223, v197, v223
v_xor_b32 v224, v197, v224
v_xor_b32 v225, v197, v225
v_xor_b32 v226, v197, v226
v_xor_b32 v227, v197, v227
v_xor_b32 v228, v197, v228
v_xor_b32 v229, v197, v229
v_xor_b32 v230, v197, v230
v_xor_b32 v231, v197, v231
v_and_b32 v196, 15, v0
v_lshrrev_b32 v197, 4, v0
s_lshl_b32 s46, s65, 8
s_add_u32 s46, s46, 1280
s_mul_i32 s47, s64, 384
v_lshl_add_u32 v208, v196, 2, s46
v_lshl_add_u32 v209, v197, 4, s46
v_lshl_add_u32 v210, v196, 2, s47
v_lshl_add_u32 v211, v197, 4, s47
v_and_b32 v198, 1, v197
v_lshrrev_b32 v197, 1, v197
v_lshlrev_b32 v197, 9, v197
v_lshl_add_u32 v197, v198, 10, v197
s_lshl_b32 s46, s64, 12
s_lshl_b32 s47, s65, 13
s_add_u32 s46, s46, 131072
s_add_u32 s48, s46, 24576
s_sub_u32 s48, s48, s47
s_add_u32 s47, s46, s47
v_lshl_add_u32 v200, v196, 4, v197
v_and_b32 v198, 3, v0
v_lshl_add_u32 v197, v198, 4, v197
v_bfe_u32 v198, v0, 3, 1
v_lshl_add_u32 v197, v198, 6, v197
v_bfe_u32 v198, v0, 2, 1
v_lshl_add_u32 v198, v198, 8, v197
v_add_u32 v199, s48, v198
v_add_u32 v198, s47, v198
v_add_u32 v201, s48, v200
v_add_u32 v200, s47, v200
s_lshl_b32 s46, s59, 4
s_add_u32 s46, s46, s60
s_lshl_b32 s50, s59, 7
s_add_u32 s50, s50, s60
s_lshl_b32 s50, s50, 7
s_lshl_b32 s46, s46, 15
s_lshl_b32 s47, 1, 23
s_add_u32 s46, s46, s47
s_add_u32 s49, s46, 917504
mhz_175:
s_branch pchk_179
poll_178:
buffer_load_dwordx4 v[80:83], v7, s[24:27], s74 offen offset:0 sc1
buffer_load_dwordx4 v[84:87], v7, s[24:27], s74 offen offset:512 sc1
buffer_load_dwordx4 v[88:91], v7, s[24:27], s74 offen offset:1024 sc1
buffer_load_dwordx4 v[92:95], v7, s[24:27], s74 offen offset:1536 sc1
buffer_load_dwordx4 v[96:99], v7, s[24:27], s74 offen offset:2048 sc1
buffer_load_dwordx4 v[100:103], v7, s[24:27], s74 offen offset:2560 sc1
buffer_load_dwordx4 v[104:107], v7, s[24:27], s74 offen offset:3072 sc1
buffer_load_dwordx4 v[108:111], v7, s[24:27], s74 offen offset:3584 sc1
pchk_179:
s_waitcnt vmcnt(7)
v_min3_u32 v8, v80, v81, v82
s_waitcnt vmcnt(6)
v_min3_u32 v8, v8, v83, v84
v_min3_u32 v8, v8, v85, v86
s_waitcnt vmcnt(5)
v_min3_u32 v8, v8, v87, v88
v_min3_u32 v8, v8, v89, v90
s_waitcnt vmcnt(4)
v_min3_u32 v8, v8, v91, v92
v_min3_u32 v8, v8, v93, v94
s_waitcnt vmcnt(3)
v_min3_u32 v8, v8, v95, v96
v_min3_u32 v8, v8, v97, v98
s_waitcnt vmcnt(2)
v_min3_u32 v8, v8, v99, v100
v_min3_u32 v8, v8, v101, v102
s_waitcnt vmcnt(1)
v_min3_u32 v8, v8, v103, v104
v_min3_u32 v8, v8, v105, v106
s_waitcnt vmcnt(0)
v_min3_u32 v8, v8, v107, v108
v_min3_u32 v8, v8, v109, v110
v_min_u32 v8, v8, v111
v_cmp_eq_u32 vcc, 0, v8
s_cbranch_vccz pdone_180
s_sub_u32 s32, s32, 1
s_cmp_gt_i32 s32, 0
s_cbranch_scc1 poll_178
pdone_180:
v_pk_add_f32 v[80:81], v[80:81], v[96:97]
v_pk_add_f32 v[82:83], v[82:83], v[98:99]
v_pk_add_f32 v[84:85], v[84:85], v[100:101]
v_pk_add_f32 v[86:87], v[86:87], v[102:103]
v_pk_add_f32 v[88:89], v[88:89], v[104:105]
v_pk_add_f32 v[90:91], v[90:91], v[106:107]
v_pk_add_f32 v[92:93], v[92:93], v[108:109]
v_pk_add_f32 v[94:95], v[94:95], v[110:111]
v_pk_add_f32 v[80:81], v[80:81], v[88:89]
v_pk_add_f32 v[82:83], v[82:83], v[90:91]
v_pk_add_f32 v[84:85], v[84:85], v[92:93]
v_pk_add_f32 v[86:87], v[86:87], v[94:95]
v_pk_add_f32 v[80:81], v[80:81], v[84:85]
v_pk_add_f32 v[82:83], v[82:83], v[86:87]
v_mov_b32 v8, v80
v_mov_b32 v9, v81
v_mov_b32 v10, v82
v_mov_b32 v11, v83
v_permlane32_swap_b32 v8, v80
v_permlane32_swap_b32 v9, v81
v_permlane32_swap_b32 v10, v82
v_permlane32_swap_b32 v11, v83
v_pk_add_f32 v[8:9], v[8:9], v[80:81]
v_pk_add_f32 v[10:11], v[10:11], v[82:83]
v_mul_f32 v8, 0xba800000, v8
v_mul_f32 v9, 0x3a800000, v9
v_fma_f32 v9, -v8, v8, v9
v_max_f32 v9, 0, v9
v_add_f32 v12, 0x3727c5ac, v9
v_rsq_f32 v80, v12
v_fma_f32 v10, v8, v11, v10
v_mul_f32 v12, v80, v10
v_max_u32 v12, 1, v12
v_add_u32 v7, s34, v3
v_mov_b32 v6, v12
s_nop 1
v_max_f32_dpp v6, v6, v6 row_ror:1 row_mask:0xf bank_mask:0xf
s_nop 1
v_max_f32_dpp v6, v6, v6 row_ror:2 row_mask:0xf bank_mask:0xf
s_nop 1
v_max_f32_dpp v6, v6, v6 row_ror:4 row_mask:0xf bank_mask:0xf
s_nop 1
v_max_f32_dpp v6, v6, v6 row_ror:8 row_mask:0xf bank_mask:0xf
v_mov_b32 v11, v6
s_nop 1
v_permlane16_swap_b32 v11, v6
v_max_f32 v6, v6, v11
v_cmp_eq_f32 vcc, v6, v12
s_ff1_i32_b64 s66, vcc
s_and_b32 s66, s66, 31
s_mov_b64 exec, 1
ds_write_b32 v7, v6 offset:256
s_mov_b64 exec, -1
v_add_u32 v7, s34, v1
v_mul_f32 v81, v8, v80
v_add_f32 v10, 1.0, v80
v_mov_b32 v82, v80
v_mov_b32 v83, v81
s_and_b32 s67, s66, 15
s_lshl_b32 s67, 0x10001, s67
s_bitcmp0_b32 s66, 4
v_permlane16_swap_b32 v80, v82
v_permlane16_swap_b32 v81, v83
s_cselect_b32 s76, s67, 0
s_cselect_b32 s78, 0, s67
s_cselect_b32 s77, s67, 0
s_cselect_b32 s79, 0, s67
s_add_u32 s75, s75, s66
v_pk_fma_f32 v[48:49], v[16:17], v[80:81], v[80:81] op_sel:[0,0,1] op_sel_hi:[1,0,1]
v_pk_fma_f32 v[50:51], v[18:19], v[80:81], v[80:81] op_sel:[0,0,1] op_sel_hi:[1,0,1]
v_pk_fma_f32 v[52:53], v[20:21], v[80:81], v[80:81] op_sel:[0,0,1] op_sel_hi:[1,0,1]
v_pk_fma_f32 v[54:55], v[22:23], v[80:81], v[80:81] op_sel:[0,0,1] op_sel_hi:[1,0,1]
v_pk_fma_f32 v[56:57], v[24:25], v[80:81], v[80:81] op_sel:[0,0,1] op_sel_hi:[1,0,1]
v_pk_fma_f32 v[58:59], v[26:27], v[80:81], v[80:81] op_sel:[0,0,1] op_sel_hi:[1,0,1]
v_pk_fma_f32 v[60:61], v[28:29], v[80:81], v[80:81] op_sel:[0,0,1] op_sel_hi:[1,0,1]
v_pk_fma_f32 v[62:63], v[30:31], v[80:81], v[80:81] op_sel:[0,0,1] op_sel_hi:[1,0,1]
v_pk_fma_f32 v[64:65], v[32:33], v[82:83], v[82:83] op_sel:[0,0,1] op_sel_hi:[1,0,1]
v_pk_fma_f32 v[66:67], v[34:35], v[82:83], v[82:83] op_sel:[0,0,1] op_sel_hi:[1,0,1]
v_pk_fma_f32 v[68:69], v[36:37], v[82:83], v[82:83] op_sel:[0,0,1] op_sel_hi:[1,0,1]
v_pk_fma_f32 v[70:71], v[38:39], v[82:83], v[82:83] op_sel:[0,0,1] op_sel_hi:[1,0,1]
v_pk_fma_f32 v[72:73], v[40:41], v[82:83], v[82:83] op_sel:[0,0,1] op_sel_hi:[1,0,1]
v_pk_fma_f32 v[74:75], v[42:43], v[82:83], v[82:83] op_sel:[0,0,1] op_sel_hi:[1,0,1]
v_pk_fma_f32 v[76:77], v[44:45], v[82:83], v[82:83] op_sel:[0,0,1] op_sel_hi:[1,0,1]
v_pk_fma_f32 v[78:79], v[46:47], v[82:83], v[82:83] op_sel:[0,0,1] op_sel_hi:[1,0,1]
v_cvt_pk_bf16_f32 v84, v48, v49
v_cvt_pk_bf16_f32 v85, v50, v51
v_cvt_pk_bf16_f32 v86, v52, v53
v_cvt_pk_bf16_f32 v87, v54, v55
v_cvt_pk_bf16_f32 v88, v56, v57
v_cvt_pk_bf16_f32 v89, v58, v59
v_cvt_pk_bf16_f32 v90, v60, v61
v_cvt_pk_bf16_f32 v91, v62, v63
v_cvt_pk_bf16_f32 v92, v64, v65
v_cvt_pk_bf16_f32 v93, v66, v67
v_cvt_pk_bf16_f32 v94, v68, v69
v_cvt_pk_bf16_f32 v95, v70, v71
v_cvt_pk_bf16_f32 v96, v72, v73
v_cvt_pk_bf16_f32 v97, v74, v75
v_cvt_pk_bf16_f32 v98, v76, v77
v_cvt_pk_bf16_f32 v99, v78, v79
ds_read_b32 v11, v7 offset:256
v_max_u32 v84, 1, v84
v_max_u32 v85, 1, v85
v_max_u32 v86, 1, v86
v_max_u32 v87, 1, v87
v_max_u32 v88, 1, v88
v_max_u32 v89, 1, v89
v_max_u32 v90, 1, v90
v_max_u32 v91, 1, v91
v_max_u32 v92, 1, v92
v_max_u32 v93, 1, v93
v_max_u32 v94, 1, v94
v_max_u32 v95, 1, v95
v_max_u32 v96, 1, v96
v_max_u32 v97, 1, v97
v_max_u32 v98, 1, v98
v_max_u32 v99, 1, v99
s_branch pchk_182
poll_181:
ds_read_b32 v11, v7 offset:256
pchk_182:
s_waitcnt lgkmcnt(0)
v_cmp_eq_u32 vcc, 0, v11
s_cbranch_vccz pdone_183
s_sub_u32 s32, s32, 1
s_cmp_gt_i32 s32, 0
s_cbranch_scc1 poll_181
pdone_183:
v_cmp_eq_f32 vcc, v11, v6
s_bfm_b32 s67, s58, 0
s_and_b32 s67, s67, vcc_lo
v_cmp_gt_f32 vcc, v11, v6
s_lshl_b32 s66, 1, s66
s_or_b32 s67, s67, vcc_lo
s_cselect_b64 s[76:77], 0, s[76:77]
s_cselect_b64 s[78:79], 0, s[78:79]
s_cselect_b64 exec, 0, s[66:67]
s_bitcmp0_b32 s62, 0
s_cselect_b64 exec, exec, 0
buffer_store_dwordx2 v[12:13], off, s[24:27], s72 sc1
s_mov_b64 exec, s[76:77]
buffer_store_dwordx4 v[84:87], v4, s[24:27], s68 offen offset:0 sc1
buffer_store_dwordx4 v[88:91], v4, s[24:27], s68 offen offset:16 sc1
s_mov_b64 exec, s[78:79]
buffer_store_dwordx4 v[92:95], v4, s[24:27], s68 offen offset:0 sc1
buffer_store_dwordx4 v[96:99], v4, s[24:27], s68 offen offset:16 sc1
s_mov_b64 exec, -1
v_add_u32 v5, s34, 24
s_mov_b64 exec, 1
ds_write_b32 v3, v5
s_mov_b64 exec, -1
v_pk_add_f32 v[16:17], v[16:17], v[48:49]
v_pk_add_f32 v[18:19], v[18:19], v[50:51]
v_pk_add_f32 v[20:21], v[20:21], v[52:53]
v_pk_add_f32 v[22:23], v[22:23], v[54:55]
v_pk_add_f32 v[24:25], v[24:25], v[56:57]
v_pk_add_f32 v[26:27], v[26:27], v[58:59]
v_pk_add_f32 v[28:29], v[28:29], v[60:61]
v_pk_add_f32 v[30:31], v[30:31], v[62:63]
v_pk_add_f32 v[32:33], v[32:33], v[64:65]
v_pk_add_f32 v[34:35], v[34:35], v[66:67]
v_pk_add_f32 v[36:37], v[36:37], v[68:69]
v_pk_add_f32 v[38:39], v[38:39], v[70:71]
v_pk_add_f32 v[40:41], v[40:41], v[72:73]
v_pk_add_f32 v[42:43], v[42:43], v[74:75]
v_pk_add_f32 v[44:45], v[44:45], v[76:77]
v_pk_add_f32 v[46:47], v[46:47], v[78:79]
v_cvt_pk_bf16_f32 v240, v16, v17
v_cvt_pk_bf16_f32 v241, v18, v19
v_cvt_pk_bf16_f32 v242, v20, v21
v_cvt_pk_bf16_f32 v243, v22, v23
v_cvt_pk_bf16_f32 v244, v24, v25
v_cvt_pk_bf16_f32 v245, v26, v27
v_cvt_pk_bf16_f32 v246, v28, v29
v_cvt_pk_bf16_f32 v247, v30, v31
v_cvt_pk_bf16_f32 v248, v32, v33
v_cvt_pk_bf16_f32 v249, v34, v35
v_cvt_pk_bf16_f32 v250, v36, v37
v_cvt_pk_bf16_f32 v251, v38, v39
v_cvt_pk_bf16_f32 v252, v40, v41
v_cvt_pk_bf16_f32 v253, v42, v43
v_cvt_pk_bf16_f32 v254, v44, v45
v_cvt_pk_bf16_f32 v255, v46, v47
v_max_u32 v16, 1, v16
v_max_u32 v17, 1, v17
v_max_u32 v18, 1, v18
v_max_u32 v19, 1, v19
v_max_u32 v20, 1, v20
v_max_u32 v21, 1, v21
v_max_u32 v22, 1, v22
v_max_u32 v23, 1, v23
v_max_u32 v24, 1, v24
v_max_u32 v25, 1, v25
v_max_u32 v26, 1, v26
v_max_u32 v27, 1, v27
v_max_u32 v28, 1, v28
v_max_u32 v29, 1, v29
v_max_u32 v30, 1, v30
v_max_u32 v31, 1, v31
v_max_u32 v32, 1, v32
v_max_u32 v33, 1, v33
v_max_u32 v34, 1, v34
v_max_u32 v35, 1, v35
v_max_u32 v36, 1, v36
v_max_u32 v37, 1, v37
v_max_u32 v38, 1, v38
v_max_u32 v39, 1, v39
v_max_u32 v40, 1, v40
v_max_u32 v41, 1, v41
v_max_u32 v42, 1, v42
v_max_u32 v43, 1, v43
v_max_u32 v44, 1, v44
v_max_u32 v45, 1, v45
v_max_u32 v46, 1, v46
v_max_u32 v47, 1, v47
s_mov_b64 exec, s[76:77]
buffer_store_dwordx4 v[16:19], v15, s[24:27], s69 offen offset:0 sc1
buffer_store_dwordx4 v[20:23], v15, s[24:27], s69 offen offset:64 sc1
buffer_store_dwordx4 v[24:27], v15, s[24:27], s69 offen offset:128 sc1
buffer_store_dwordx4 v[28:31], v15, s[24:27], s69 offen offset:192 sc1
s_mov_b64 exec, s[78:79]
buffer_store_dwordx4 v[32:35], v15, s[24:27], s69 offen offset:0 sc1
buffer_store_dwordx4 v[36:39], v15, s[24:27], s69 offen offset:64 sc1
buffer_store_dwordx4 v[40:43], v15, s[24:27], s69 offen offset:128 sc1
buffer_store_dwordx4 v[44:47], v15, s[24:27], s69 offen offset:192 sc1
s_mov_b64 exec, -1
s_cmp_eq_u32 s63, 0
s_cbranch_scc0 mout_184
v_mul_f32 v11, v10, v10
v_mov_b32 v12, 0x3727c5ac
v_fma_f32 v11, v11, v9, v12
v_rsq_f32 v11, v11
v_lshrrev_b32 v12, 3, v0
v_lshlrev_b32 v12, 6, v12
v_lshl_add_u32 v12, v0, 3, v12
v_mul_f32 v10, v10, v11
v_mul_f32 v11, v8, v10
s_lshl_b32 s66, s61, 5
s_add_u32 s66, s66, s58
s_lshl_b32 s66, s66, 9
s_add_u32 s66, s66, 1675264
v_max_u32 v11, 1, v11
s_cmp_eq_u32 s62, 8
s_cselect_b32 exec_lo, -1, 0
s_mov_b32 exec_hi, 0
s_cmp_eq_u32 s57, 0
s_cbranch_scc1 far_185
buffer_store_dwordx2 v[10:11], v12, s[24:27], s66 offen
near_186:
s_mov_b64 exec, -1
s_mov_b32 s63, 1
s_mov_b32 s34, 32
s_add_u32 s24, s24, 1409024
s_addc_u32 s25, s25, 0
s_mov_b32 s26, 1409024
s_branch L_mtop
mout_184:
v_permlane16_swap_b32 v240, v242
v_permlane16_swap_b32 v241, v243
v_permlane16_swap_b32 v244, v246
v_permlane16_swap_b32 v245, v247
v_permlane16_swap_b32 v248, v250
v_permlane16_swap_b32 v249, v251
v_permlane16_swap_b32 v252, v254
v_permlane16_swap_b32 v253, v255
s_not_b64 exec, s[76:77]
buffer_store_dwordx4 v[240:243], v14, s[28:31], s70 offen offset:0
buffer_store_dwordx4 v[244:247], v14, s[28:31], s70 offen offset:64
s_not_b64 exec, s[78:79]
buffer_store_dwordx4 v[248:251], v14, s[28:31], s71 offen offset:0
buffer_store_dwordx4 v[252:255], v14, s[28:31], s71 offen offset:64
s_mov_b64 exec, -1
s_or_b32 s66, s76, s78
s_cbranch_scc0 L_end
v_mov_b32 v11, 0
s_add_u32 s35, s34, 4
lw_187:
ds_read_b32 v5, v2 offset:24
s_waitcnt lgkmcnt(0)
v_cmp_gt_i32 vcc, s35, v5
s_cbranch_vccz lwd_188
s_sleep 2
s_sub_u32 s32, s32, 1
s_cmp_gt_i32 s32, 0
s_cbranch_scc1 lw_187
lwd_188:
ds_read_b32 v11, v11 offset:32
s_waitcnt lgkmcnt(0)
v_cmp_eq_u32 vcc, s75, v11
s_cbranch_vccnz L_end
s_mov_b64 exec, s[76:77]
buffer_store_dwordx4 v[240:243], v14, s[28:31], s70 offen offset:0
buffer_store_dwordx4 v[244:247], v14, s[28:31], s70 offen offset:64
s_mov_b64 exec, s[78:79]
buffer_store_dwordx4 v[248:251], v14, s[28:31], s71 offen offset:0
buffer_store_dwordx4 v[252:255], v14, s[28:31], s71 offen offset:64
s_mov_b64 exec, -1
s_branch L_end
mspin_132:
ds_read_b32 v5, v2 offset:16
s_waitcnt lgkmcnt(0)
v_cmp_ge_u32 vcc, v4, v5
s_cbranch_vccz mback_133
s_sub_u32 s32, s32, 1
s_cmp_gt_i32 s32, 0
s_cbranch_scc1 mspin_132
s_branch mback_133
mspin_130:
msp_189:
ds_read_b32 v5, v2 offset:16
s_waitcnt lgkmcnt(0)
v_cmp_ge_u32 vcc, v4, v5
s_cbranch_vccz mback_131
s_sub_u32 s32, s32, 1
s_cmp_gt_i32 s32, 0
s_cbranch_scc1 msp_189
s_branch mback_131
lspin_134:
s_add_u32 s35, s34, 2
lw_190:
ds_read_b32 v5, v2 offset:24
s_waitcnt lgkmcnt(0)
v_cmp_gt_i32 vcc, s35, v5
s_cbranch_vccz lwd_191
s_sub_u32 s32, s32, 1
s_cmp_gt_i32 s32, 0
s_cbranch_scc1 lw_190
lwd_191:
s_branch lback_135
patch_136:
s_bfe_u32 s66, s33, 0x20005
s_lshr_b32 s67, s66, 1
s_xor_b32 s66, s66, s67
s_and_b32 s66, s66, 1
s_cmp_eq_u32 s66, s65
s_cbranch_scc0 pback_137
s_bfe_u32 s66, s33, 0x10004
s_lshl1_add_u32 s73, s67, s66
s_and_b32 s66, s33, 15
s_mov_b32 s74, 0x10001
s_mov_b32 s75, s74
s_lshl_b64 s[74:75], s[74:75], s66
s_and_b32 s66, s66, 12
s_lshl_b32 s66, s66, 2
s_bfm_b64 s[76:77], 16, s66
s_nop 7
s_mov_b64 exec, s[74:75]
s_cmp_eq_u32 s73, 0
s_cbranch_scc0 pnx_193
ds_read_b128 v[16:19], v211 offset:3456
ds_read_b128 v[20:23], v211 offset:3520
s_branch pdn_192
pnx_193:
s_cmp_eq_u32 s73, 1
s_cbranch_scc0 pnx_194
ds_read_b128 v[24:27], v211 offset:3456
ds_read_b128 v[28:31], v211 offset:3520
s_branch pdn_192
pnx_194:
s_cmp_eq_u32 s73, 2
s_cbranch_scc0 pnx_195
ds_read_b128 v[32:35], v211 offset:3456
ds_read_b128 v[36:39], v211 offset:3520
s_branch pdn_192
pnx_195:
ds_read_b128 v[40:43], v211 offset:3456
ds_read_b128 v[44:47], v211 offset:3520
pdn_192:
s_mov_b64 exec, -1
s_waitcnt lgkmcnt(0)
s_branch pback_137
patch_138:
s_nop 7
s_nop 7
s_and_b32 s66, s33, 3
s_lshl2_add_u32 s66, s73, s66
s_mov_b64 exec, s[76:77]
s_cmp_eq_u32 s66, 0
s_cbranch_scc0 pnx_198
ds_read_b32 v48, v210 offset:3584
ds_read_b32 v52, v210 offset:3648
s_branch pdn_197
pnx_198:
s_cmp_eq_u32 s66, 1
s_cbranch_scc0 pnx_199
ds_read_b32 v49, v210 offset:3584
ds_read_b32 v53, v210 offset:3648
s_branch pdn_197
pnx_199:
s_cmp_eq_u32 s66, 2
s_cbranch_scc0 pnx_200
ds_read_b32 v50, v210 offset:3584
ds_read_b32 v54, v210 offset:3648
s_branch pdn_197
pnx_200:
s_cmp_eq_u32 s66, 3
s_cbranch_scc0 pnx_201
ds_read_b32 v51, v210 offset:3584
ds_read_b32 v55, v210 offset:3648
s_branch pdn_197
pnx_201:
s_cmp_eq_u32 s66, 4
s_cbranch_scc0 pnx_202
ds_read_b32 v56, v210 offset:3584
ds_read_b32 v60, v210 offset:3648
s_branch pdn_197
pnx_202:
s_cmp_eq_u32 s66, 5
s_cbranch_scc0 pnx_203
ds_read_b32 v57, v210 offset:3584
ds_read_b32 v61, v210 offset:3648
s_branch pdn_197
pnx_203:
s_cmp_eq_u32 s66, 6
s_cbranch_scc0 pnx_204
ds_read_b32 v58, v210 offset:3584
ds_read_b32 v62, v210 offset:3648
s_branch pdn_197
pnx_204:
s_cmp_eq_u32 s66, 7
s_cbranch_scc0 pnx_205
ds_read_b32 v59, v210 offset:3584
ds_read_b32 v63, v210 offset:3648
s_branch pdn_197
pnx_205:
s_cmp_eq_u32 s66, 8
s_cbranch_scc0 pnx_206
ds_read_b32 v64, v210 offset:3584
ds_read_b32 v68, v210 offset:3648
s_branch pdn_197
pnx_206:
s_cmp_eq_u32 s66, 9
s_cbranch_scc0 pnx_207
ds_read_b32 v65, v210 offset:3584
ds_read_b32 v69, v210 offset:3648
s_branch pdn_197
pnx_207:
s_cmp_eq_u32 s66, 10
s_cbranch_scc0 pnx_208
ds_read_b32 v66, v210 offset:3584
ds_read_b32 v70, v210 offset:3648
s_branch pdn_197
pnx_208:
s_cmp_eq_u32 s66, 11
s_cbranch_scc0 pnx_209
ds_read_b32 v67, v210 offset:3584
ds_read_b32 v71, v210 offset:3648
s_branch pdn_197
pnx_209:
s_cmp_eq_u32 s66, 12
s_cbranch_scc0 pnx_210
ds_read_b32 v72, v210 offset:3584
ds_read_b32 v76, v210 offset:3648
s_branch pdn_197
pnx_210:
s_cmp_eq_u32 s66, 13
s_cbranch_scc0 pnx_211
ds_read_b32 v73, v210 offset:3584
ds_read_b32 v77, v210 offset:3648
s_branch pdn_197
pnx_211:
s_cmp_eq_u32 s66, 14
s_cbranch_scc0 pnx_212
ds_read_b32 v74, v210 offset:3584
ds_read_b32 v78, v210 offset:3648
s_branch pdn_197
pnx_212:
ds_read_b32 v75, v210 offset:3584
ds_read_b32 v79, v210 offset:3648
pdn_197:
s_mov_b64 exec, -1
s_waitcnt lgkmcnt(0)
s_branch pback_139
patch_140:
s_nop 7
s_nop 7
s_mov_b64 exec, s[74:75]
s_cmp_eq_u32 s73, 0
s_cbranch_scc0 pnx_215
ds_read_b128 v[80:83], v211 offset:3328
ds_read_b128 v[84:87], v211 offset:3392
s_branch pdn_214
pnx_215:
s_cmp_eq_u32 s73, 1
s_cbranch_scc0 pnx_216
ds_read_b128 v[88:91], v211 offset:3328
ds_read_b128 v[92:95], v211 offset:3392
s_branch pdn_214
pnx_216:
s_cmp_eq_u32 s73, 2
s_cbranch_scc0 pnx_217
ds_read_b128 v[96:99], v211 offset:3328
ds_read_b128 v[100:103], v211 offset:3392
s_branch pdn_214
pnx_217:
ds_read_b128 v[104:107], v211 offset:3328
ds_read_b128 v[108:111], v211 offset:3392
pdn_214:
s_mov_b64 exec, -1
s_waitcnt lgkmcnt(0)
s_branch pback_141
cross_151:
s_cmp_eq_u32 s67, 122880
s_cbranch_scc0 cr2_219
v_add_u32 v5, s34, 18
s_mov_b64 exec, 1
ds_write_b32 v3, v5
s_mov_b64 exec, -1
v_mov_b32 v9, 0xf149f2ca
v_xor_b32 v216, v9, v216
v_xor_b32 v217, v9, v217
v_xor_b32 v218, v9, v218
v_xor_b32 v219, v9, v219
v_xor_b32 v220, v9, v220
v_xor_b32 v221, v9, v221
v_xor_b32 v222, v9, v222
v_xor_b32 v223, v9, v223
v_xor_b32 v224, v9, v224
v_xor_b32 v225, v9, v225
v_xor_b32 v226, v9, v226
v_xor_b32 v227, v9, v227
v_xor_b32 v228, v9, v228
v_xor_b32 v229, v9, v229
v_xor_b32 v230, v9, v230
v_xor_b32 v231, v9, v231
s_mov_b32 s67, 114688
s_cmp_eq_u32 s63, 0
s_cbranch_scc0 cr3_220
v_and_b32 v9, 15, v0
v_lshlrev_b32 v9, 11, v9
v_bfe_u32 v10, v0, 4, 1
v_lshl_add_u32 v9, v10, 5, v9
v_lshrrev_b32 v10, 5, v0
v_lshl_add_u32 v9, v10, 4, v9
s_lshl2_add_u32 s70, s61, s58
s_lshl_b32 s70, s70, 16
s_lshl_b32 s71, s62, 7
s_add_u32 s70, s70, s71
s_add_u32 s71, s70, 0x8000
buffer_load_dwordx4 v[240:243], v9, s[8:11], s70 offen offset:0
buffer_load_dwordx4 v[244:247], v9, s[8:11], s70 offen offset:64
buffer_load_dwordx4 v[248:251], v9, s[8:11], s71 offen offset:0
buffer_load_dwordx4 v[252:255], v9, s[8:11], s71 offen offset:64
cr3_220:
s_cmp_eq_u32 s59, 0
s_cbranch_scc1 cback_152
v_mov_b32 v9, 0
s_add_u32 s35, s34, 18
lw_221:
ds_read_b32 v5, v9 offset:16
s_waitcnt lgkmcnt(0)
v_cmp_gt_i32 vcc, s35, v5
s_cbranch_vccz lwd_222
s_sub_u32 s32, s32, 1
s_cmp_gt_i32 s32, 0
s_cbranch_scc1 lw_221
lwd_222:
s_branch cback_152
cr2_219:
s_cmp_eq_u32 s67, 114688
s_cbranch_scc0 cr4_223
s_mov_b32 s67, 90112
s_add_u32 s35, s34, 21
lw_224:
ds_read_b32 v5, v9 offset:16
s_waitcnt lgkmcnt(0)
v_cmp_gt_i32 vcc, s35, v5
s_cbranch_vccz lwd_225
s_sub_u32 s32, s32, 1
s_cmp_gt_i32 s32, 0
s_cbranch_scc1 lw_224
lwd_225:
s_branch cback_152
cr4_223:
v_add_u32 v5, s34, 19
s_mov_b64 exec, 1
ds_write_b32 v3, v5
s_mov_b64 exec, -1
s_mov_b32 s66, 28672
s_cmp_lt_u32 s59, 2
s_cbranch_scc1 cback_152
s_add_u32 s35, s34, 21
lw_226:
ds_read_b32 v5, v2 offset:16
s_waitcnt lgkmcnt(0)
v_cmp_gt_i32 vcc, s35, v5
s_cbranch_vccz lwd_227
s_sub_u32 s32, s32, 1
s_cmp_gt_i32 s32, 0
s_cbranch_scc1 lw_226
lwd_227:
s_branch cback_152
cross_153:
s_cmp_eq_u32 s67, 122880
s_cbranch_scc0 cr2_228
s_waitcnt lgkmcnt(1)
v_add_u32 v5, s34, 18
s_mov_b64 exec, 1
ds_write_b32 v3, v5
s_mov_b64 exec, -1
v_mov_b32 v9, 0xf149f2ca
v_xor_b32 v216, v9, v216
v_xor_b32 v217, v9, v217
v_xor_b32 v218, v9, v218
v_xor_b32 v219, v9, v219
v_xor_b32 v220, v9, v220
v_xor_b32 v221, v9, v221
v_xor_b32 v222, v9, v222
v_xor_b32 v223, v9, v223
v_xor_b32 v224, v9, v224
v_xor_b32 v225, v9, v225
v_xor_b32 v226, v9, v226
v_xor_b32 v227, v9, v227
v_xor_b32 v228, v9, v228
v_xor_b32 v229, v9, v229
v_xor_b32 v230, v9, v230
v_xor_b32 v231, v9, v231
s_mov_b32 s67, 114688
s_cmp_eq_u32 s63, 0
s_cbranch_scc0 cr3_229
v_and_b32 v9, 15, v0
v_lshlrev_b32 v9, 11, v9
v_bfe_u32 v10, v0, 4, 1
v_lshl_add_u32 v9, v10, 5, v9
v_lshrrev_b32 v10, 5, v0
v_lshl_add_u32 v9, v10, 4, v9
s_lshl2_add_u32 s70, s61, s58
s_lshl_b32 s70, s70, 16
s_lshl_b32 s71, s62, 7
s_add_u32 s70, s70, s71
s_add_u32 s71, s70, 0x8000
buffer_load_dwordx4 v[240:243], v9, s[8:11], s70 offen offset:0
buffer_load_dwordx4 v[244:247], v9, s[8:11], s70 offen offset:64
buffer_load_dwordx4 v[248:251], v9, s[8:11], s71 offen offset:0
buffer_load_dwordx4 v[252:255], v9, s[8:11], s71 offen offset:64
cr3_229:
s_cmp_eq_u32 s59, 0
s_cbranch_scc1 cback_154
v_mov_b32 v9, 0
s_add_u32 s35, s34, 18
lw_230:
ds_read_b32 v5, v9 offset:16
s_waitcnt lgkmcnt(0)
v_cmp_gt_i32 vcc, s35, v5
s_cbranch_vccz lwd_231
s_sub_u32 s32, s32, 1
s_cmp_gt_i32 s32, 0
s_cbranch_scc1 lw_230
lwd_231:
s_branch cback_154
cr2_228:
s_waitcnt lgkmcnt(1)
v_cmp_gt_i32 vcc, s35, v5
s_cmp_eq_u32 s67, 114688
s_cbranch_scc0 cr4_232
s_mov_b32 s67, 90112
s_bitcmp0_b32 vcc_lo, 0
s_cbranch_scc1 cback_154
s_add_u32 s35, s34, 21
lw_233:
ds_read_b32 v5, v9 offset:16
s_waitcnt lgkmcnt(0)
v_cmp_gt_i32 vcc, s35, v5
s_cbranch_vccz lwd_234
s_sub_u32 s32, s32, 1
s_cmp_gt_i32 s32, 0
s_cbranch_scc1 lw_233
lwd_234:
s_branch cback_154
cr4_232:
v_add_u32 v5, s34, 19
s_mov_b64 exec, 1
ds_write_b32 v3, v5
s_mov_b64 exec, -1
s_mov_b32 s66, 28672
s_cmp_lt_u32 s59, 2
s_cbranch_scc1 cback_154
s_cbranch_vccz cback_154
s_add_u32 s35, s34, 21
lw_235:
ds_read_b32 v5, v2 offset:16
s_waitcnt lgkmcnt(0)
v_cmp_gt_i32 vcc, s35, v5
s_cbranch_vccz lwd_236
s_sub_u32 s32, s32, 1
s_cmp_gt_i32 s32, 0
s_cbranch_scc1 lw_235
lwd_236:
s_branch cback_154
slow_155:
s_add_u32 s70, s72, 270336
poll_237:
buffer_load_dword v10, v1, s[24:27], s70 offen sc1
pchk_238:
s_waitcnt vmcnt(0)
v_cmp_eq_u32 vcc, 0, v10
s_cbranch_vccz pdone_239
s_sub_u32 s32, s32, 1
s_cmp_gt_i32 s32, 0
s_cbranch_scc1 poll_237
pdone_239:
s_lshl_b32 s73, s60, 15
s_lshl_b32 s74, s63, 23
s_add_u32 s73, s73, s74
s_add_u32 s73, s73, 1048576
v_mov_b32 v10, 0xf149f2ca
v_mov_b32 v11, 0
v_mov_b32 v192, 0
v_mov_b32 v193, 0
v_mov_b32 v194, 0
v_mov_b32 v195, 0
v_mov_b32 v196, 0
v_mov_b32 v197, 0
v_mov_b32 v198, 0
v_mov_b32 v199, 0
v_mov_b32 v200, 0
v_mov_b32 v201, 0
v_mov_b32 v202, 0
v_mov_b32 v203, 0
v_mov_b32 v204, 0
v_mov_b32 v205, 0
v_mov_b32 v206, 0
v_mov_b32 v207, 0
v_mov_b32 v208, 0
v_mov_b32 v209, 0
v_mov_b32 v210, 0
v_mov_b32 v211, 0
s_lshl2_add_u32 s74, s59, s65
s_mov_b32 s75, 0
sl_240:
s_lshr_b32 s76, s74, 2
s_lshl_b32 s76, s76, 19
s_and_b32 s77, s74, 3
s_lshl_b32 s77, s77, 13
s_add_u32 s76, s76, s77
s_add_u32 s76, s76, s73
buffer_load_dwordx4 v[152:155], v6, s[20:23], s76 offen offset:0 sc1
buffer_load_dwordx4 v[156:159], v6, s[20:23], s76 offen offset:1024 sc1
s_cmp_eq_u32 s75, 0
s_cselect_b32 s76, 0xf149f2ca, 0
s_and_b32 s77, s75, 7
s_cselect_b32 s77, 0, -1
v_xor_b32 v112, s76, v216
v_and_b32 v112, s77, v112
v_xor_b32 v113, s76, v217
v_and_b32 v113, s77, v113
v_xor_b32 v114, s76, v218
v_and_b32 v114, s77, v114
v_xor_b32 v115, s76, v219
v_and_b32 v115, s77, v115
v_xor_b32 v116, s76, v220
v_and_b32 v116, s77, v116
v_xor_b32 v117, s76, v221
v_and_b32 v117, s77, v117
v_xor_b32 v118, s76, v222
v_and_b32 v118, s77, v118
v_xor_b32 v119, s76, v223
v_and_b32 v119, s77, v119
v_xor_b32 v120, s76, v224
v_and_b32 v120, s77, v120
v_xor_b32 v121, s76, v225
v_and_b32 v121, s77, v121
v_xor_b32 v122, s76, v226
v_and_b32 v122, s77, v122
v_xor_b32 v123, s76, v227
v_and_b32 v123, s77, v123
v_xor_b32 v124, s76, v228
v_and_b32 v124, s77, v124
v_xor_b32 v125, s76, v229
v_and_b32 v125, s77, v125
v_xor_b32 v126, s76, v230
v_and_b32 v126, s77, v126
v_xor_b32 v127, s76, v231
v_and_b32 v127, s77, v127
s_waitcnt vmcnt(1)
s_nop 0
v_mfma_f32_32x32x16_bf16 v[112:127], v[152:155], v[80:83], v[112:127]
s_waitcnt vmcnt(0)
v_mfma_f32_32x32x16_bf16 v[112:127], v[156:159], v[88:91], v[112:127]
s_nop 11
v_max3_f32 v10, v10, v112, v113
v_max3_f32 v10, v10, v114, v115
v_max3_f32 v10, v10, v116, v117
v_max3_f32 v10, v10, v118, v119
v_max3_f32 v10, v10, v120, v121
v_max3_f32 v10, v10, v122, v123
v_max3_f32 v10, v10, v124, v125
v_max3_f32 v10, v10, v126, v127
s_add_u32 s75, s75, 1
s_sub_u32 s74, s74, 1
s_cselect_b32 s75, 9, s75
s_cmp_lt_u32 s75, 9
s_cbranch_scc1 sl_240
v_mov_b32 v11, v10
s_nop 1
v_permlane32_swap_b32 v11, v10
v_max_f32 v10, v10, v11
s_lshl2_add_u32 s74, s59, s65
s_mov_b32 s75, 0
sl_241:
s_lshr_b32 s76, s74, 2
s_lshl_b32 s76, s76, 19
s_and_b32 s77, s74, 3
s_lshl_b32 s77, s77, 13
s_add_u32 s76, s76, s77
s_add_u32 s76, s76, s73
buffer_load_dwordx4 v[152:155], v6, s[20:23], s76 offen offset:0 sc1
buffer_load_dwordx4 v[156:159], v6, s[20:23], s76 offen offset:1024 sc1
buffer_load_dwordx4 v[160:163], v6, s[20:23], s76 offen offset:2048 sc1
buffer_load_dwordx4 v[164:167], v6, s[20:23], s76 offen offset:3072 sc1
s_cmp_eq_u32 s75, 0
s_cselect_b32 s76, 0xf149f2ca, 0
s_and_b32 s77, s75, 7
s_cselect_b32 s77, 0, -1
v_xor_b32 v112, s76, v216
v_and_b32 v112, s77, v112
v_sub_f32 v112, v112, v10
v_xor_b32 v113, s76, v217
v_and_b32 v113, s77, v113
v_sub_f32 v113, v113, v10
v_xor_b32 v114, s76, v218
v_and_b32 v114, s77, v114
v_sub_f32 v114, v114, v10
v_xor_b32 v115, s76, v219
v_and_b32 v115, s77, v115
v_sub_f32 v115, v115, v10
v_xor_b32 v116, s76, v220
v_and_b32 v116, s77, v116
v_sub_f32 v116, v116, v10
v_xor_b32 v117, s76, v221
v_and_b32 v117, s77, v117
v_sub_f32 v117, v117, v10
v_xor_b32 v118, s76, v222
v_and_b32 v118, s77, v118
v_sub_f32 v118, v118, v10
v_xor_b32 v119, s76, v223
v_and_b32 v119, s77, v119
v_sub_f32 v119, v119, v10
v_xor_b32 v120, s76, v224
v_and_b32 v120, s77, v120
v_sub_f32 v120, v120, v10
v_xor_b32 v121, s76, v225
v_and_b32 v121, s77, v121
v_sub_f32 v121, v121, v10
v_xor_b32 v122, s76, v226
v_and_b32 v122, s77, v122
v_sub_f32 v122, v122, v10
v_xor_b32 v123, s76, v227
v_and_b32 v123, s77, v123
v_sub_f32 v123, v123, v10
v_xor_b32 v124, s76, v228
v_and_b32 v124, s77, v124
v_sub_f32 v124, v124, v10
v_xor_b32 v125, s76, v229
v_and_b32 v125, s77, v125
v_sub_f32 v125, v125, v10
v_xor_b32 v126, s76, v230
v_and_b32 v126, s77, v126
v_sub_f32 v126, v126, v10
v_xor_b32 v127, s76, v231
v_and_b32 v127, s77, v127
v_sub_f32 v127, v127, v10
s_waitcnt vmcnt(3)
s_nop 0
v_mfma_f32_32x32x16_bf16 v[112:127], v[152:155], v[80:83], v[112:127]
s_waitcnt vmcnt(2)
v_mfma_f32_32x32x16_bf16 v[112:127], v[156:159], v[88:91], v[112:127]
s_nop 11
v_exp_f32 v112, v112
v_exp_f32 v113, v113
v_exp_f32 v114, v114
v_exp_f32 v115, v115
v_exp_f32 v116, v116
v_exp_f32 v117, v117
v_exp_f32 v118, v118
v_exp_f32 v119, v119
v_exp_f32 v120, v120
v_exp_f32 v121, v121
v_exp_f32 v122, v122
v_exp_f32 v123, v123
v_exp_f32 v124, v124
v_exp_f32 v125, v125
v_exp_f32 v126, v126
v_exp_f32 v127, v127
v_cvt_pk_bf16_f32 v144, v112, v113
v_cvt_pk_bf16_f32 v145, v114, v115
v_cvt_pk_bf16_f32 v146, v116, v117
v_cvt_pk_bf16_f32 v147, v118, v119
v_cvt_pk_bf16_f32 v148, v120, v121
v_cvt_pk_bf16_f32 v149, v122, v123
v_cvt_pk_bf16_f32 v150, v124, v125
v_cvt_pk_bf16_f32 v151, v126, v127
s_waitcnt vmcnt(1)
v_mfma_f32_32x32x16_bf16 v[192:207], v[160:163], v[144:147], v[192:207]
v_mfma_f32_16x16x32_bf16 v[208:211], v[212:215], v[144:147], v[208:211]
s_waitcnt vmcnt(0)
v_mfma_f32_32x32x16_bf16 v[192:207], v[164:167], v[148:151], v[192:207]
v_mfma_f32_16x16x32_bf16 v[208:211], v[212:215], v[148:151], v[208:211]
s_add_u32 s75, s75, 1
s_sub_u32 s74, s74, 1
s_cselect_b32 s75, 9, s75
s_cmp_lt_u32 s75, 9
s_cbranch_scc1 sl_241
v_mov_b32 v10, 0xf149f2ca
v_mov_b32 v11, 0
v_mov_b32 v16, 0
v_mov_b32 v17, 0
v_mov_b32 v18, 0
v_mov_b32 v19, 0
v_mov_b32 v20, 0
v_mov_b32 v21, 0
v_mov_b32 v22, 0
v_mov_b32 v23, 0
v_mov_b32 v24, 0
v_mov_b32 v25, 0
v_mov_b32 v26, 0
v_mov_b32 v27, 0
v_mov_b32 v28, 0
v_mov_b32 v29, 0
v_mov_b32 v30, 0
v_mov_b32 v31, 0
v_mov_b32 v32, 0
v_mov_b32 v33, 0
v_mov_b32 v34, 0
v_mov_b32 v35, 0
s_sub_u32 s74, 3, s65
s_lshl2_add_u32 s74, s59, s74
s_mov_b32 s75, 0
sl_242:
s_lshr_b32 s76, s74, 2
s_lshl_b32 s76, s76, 19
s_and_b32 s77, s74, 3
s_lshl_b32 s77, s77, 13
s_add_u32 s76, s76, s77
s_add_u32 s76, s76, s73
buffer_load_dwordx4 v[152:155], v6, s[20:23], s76 offen offset:0 sc1
buffer_load_dwordx4 v[156:159], v6, s[20:23], s76 offen offset:1024 sc1
s_cmp_eq_u32 s75, 0
s_cselect_b32 s76, 0xf149f2ca, 0
s_and_b32 s77, s75, 7
s_cselect_b32 s77, 0, -1
v_xor_b32 v112, s76, v216
v_and_b32 v112, s77, v112
v_xor_b32 v113, s76, v217
v_and_b32 v113, s77, v113
v_xor_b32 v114, s76, v218
v_and_b32 v114, s77, v114
v_xor_b32 v115, s76, v219
v_and_b32 v115, s77, v115
v_xor_b32 v116, s76, v220
v_and_b32 v116, s77, v116
v_xor_b32 v117, s76, v221
v_and_b32 v117, s77, v117
v_xor_b32 v118, s76, v222
v_and_b32 v118, s77, v118
v_xor_b32 v119, s76, v223
v_and_b32 v119, s77, v119
v_xor_b32 v120, s76, v224
v_and_b32 v120, s77, v120
v_xor_b32 v121, s76, v225
v_and_b32 v121, s77, v121
v_xor_b32 v122, s76, v226
v_and_b32 v122, s77, v122
v_xor_b32 v123, s76, v227
v_and_b32 v123, s77, v123
v_xor_b32 v124, s76, v228
v_and_b32 v124, s77, v124
v_xor_b32 v125, s76, v229
v_and_b32 v125, s77, v125
v_xor_b32 v126, s76, v230
v_and_b32 v126, s77, v126
v_xor_b32 v127, s76, v231
v_and_b32 v127, s77, v127
s_waitcnt vmcnt(1)
s_nop 0
v_mfma_f32_32x32x16_bf16 v[112:127], v[152:155], v[96:99], v[112:127]
s_waitcnt vmcnt(0)
v_mfma_f32_32x32x16_bf16 v[112:127], v[156:159], v[104:107], v[112:127]
s_nop 11
v_max3_f32 v10, v10, v112, v113
v_max3_f32 v10, v10, v114, v115
v_max3_f32 v10, v10, v116, v117
v_max3_f32 v10, v10, v118, v119
v_max3_f32 v10, v10, v120, v121
v_max3_f32 v10, v10, v122, v123
v_max3_f32 v10, v10, v124, v125
v_max3_f32 v10, v10, v126, v127
s_add_u32 s75, s75, 1
s_sub_u32 s74, s74, 1
s_cselect_b32 s75, 9, s75
s_cmp_lt_u32 s75, 9
s_cbranch_scc1 sl_242
v_mov_b32 v11, v10
s_nop 1
v_permlane32_swap_b32 v11, v10
v_max_f32 v10, v10, v11
s_sub_u32 s74, 3, s65
s_lshl2_add_u32 s74, s59, s74
s_mov_b32 s75, 0
sl_243:
s_lshr_b32 s76, s74, 2
s_lshl_b32 s76, s76, 19
s_and_b32 s77, s74, 3
s_lshl_b32 s77, s77, 13
s_add_u32 s76, s76, s77
s_add_u32 s76, s76, s73
buffer_load_dwordx4 v[152:155], v6, s[20:23], s76 offen offset:0 sc1
buffer_load_dwordx4 v[156:159], v6, s[20:23], s76 offen offset:1024 sc1
buffer_load_dwordx4 v[160:163], v6, s[20:23], s76 offen offset:2048 sc1
buffer_load_dwordx4 v[164:167], v6, s[20:23], s76 offen offset:3072 sc1
s_cmp_eq_u32 s75, 0
s_cselect_b32 s76, 0xf149f2ca, 0
s_and_b32 s77, s75, 7
s_cselect_b32 s77, 0, -1
v_xor_b32 v112, s76, v216
v_and_b32 v112, s77, v112
v_sub_f32 v112, v112, v10
v_xor_b32 v113, s76, v217
v_and_b32 v113, s77, v113
v_sub_f32 v113, v113, v10
v_xor_b32 v114, s76, v218
v_and_b32 v114, s77, v114
v_sub_f32 v114, v114, v10
v_xor_b32 v115, s76, v219
v_and_b32 v115, s77, v115
v_sub_f32 v115, v115, v10
v_xor_b32 v116, s76, v220
v_and_b32 v116, s77, v116
v_sub_f32 v116, v116, v10
v_xor_b32 v117, s76, v221
v_and_b32 v117, s77, v117
v_sub_f32 v117, v117, v10
v_xor_b32 v118, s76, v222
v_and_b32 v118, s77, v118
v_sub_f32 v118, v118, v10
v_xor_b32 v119, s76, v223
v_and_b32 v119, s77, v119
v_sub_f32 v119, v119, v10
v_xor_b32 v120, s76, v224
v_and_b32 v120, s77, v120
v_sub_f32 v120, v120, v10
v_xor_b32 v121, s76, v225
v_and_b32 v121, s77, v121
v_sub_f32 v121, v121, v10
v_xor_b32 v122, s76, v226
v_and_b32 v122, s77, v122
v_sub_f32 v122, v122, v10
v_xor_b32 v123, s76, v227
v_and_b32 v123, s77, v123
v_sub_f32 v123, v123, v10
v_xor_b32 v124, s76, v228
v_and_b32 v124, s77, v124
v_sub_f32 v124, v124, v10
v_xor_b32 v125, s76, v229
v_and_b32 v125, s77, v125
v_sub_f32 v125, v125, v10
v_xor_b32 v126, s76, v230
v_and_b32 v126, s77, v126
v_sub_f32 v126, v126, v10
v_xor_b32 v127, s76, v231
v_and_b32 v127, s77, v127
v_sub_f32 v127, v127, v10
s_waitcnt vmcnt(3)
s_nop 0
v_mfma_f32_32x32x16_bf16 v[112:127], v[152:155], v[96:99], v[112:127]
s_waitcnt vmcnt(2)
v_mfma_f32_32x32x16_bf16 v[112:127], v[156:159], v[104:107], v[112:127]
s_nop 11
v_exp_f32 v112, v112
v_exp_f32 v113, v113
v_exp_f32 v114, v114
v_exp_f32 v115, v115
v_exp_f32 v116, v116
v_exp_f32 v117, v117
v_exp_f32 v118, v118
v_exp_f32 v119, v119
v_exp_f32 v120, v120
v_exp_f32 v121, v121
v_exp_f32 v122, v122
v_exp_f32 v123, v123
v_exp_f32 v124, v124
v_exp_f32 v125, v125
v_exp_f32 v126, v126
v_exp_f32 v127, v127
v_cvt_pk_bf16_f32 v144, v112, v113
v_cvt_pk_bf16_f32 v145, v114, v115
v_cvt_pk_bf16_f32 v146, v116, v117
v_cvt_pk_bf16_f32 v147, v118, v119
v_cvt_pk_bf16_f32 v148, v120, v121
v_cvt_pk_bf16_f32 v149, v122, v123
v_cvt_pk_bf16_f32 v150, v124, v125
v_cvt_pk_bf16_f32 v151, v126, v127
s_waitcnt vmcnt(1)
v_mfma_f32_32x32x16_bf16 v[16:31], v[160:163], v[144:147], v[16:31]
v_mfma_f32_16x16x32_bf16 v[32:35], v[212:215], v[144:147], v[32:35]
s_waitcnt vmcnt(0)
v_mfma_f32_32x32x16_bf16 v[16:31], v[164:167], v[148:151], v[16:31]
v_mfma_f32_16x16x32_bf16 v[32:35], v[212:215], v[148:151], v[32:35]
s_add_u32 s75, s75, 1
s_sub_u32 s74, s74, 1
s_cselect_b32 s75, 9, s75
s_cmp_lt_u32 s75, 9
s_cbranch_scc1 sl_243
s_branch sback_156
far_157:
buffer_store_dwordx4 v[16:19], v9, s[20:23], s67 offen offset:0 sc1
buffer_store_dwordx4 v[20:23], v9, s[20:23], s67 offen offset:1024 sc1
s_branch near_158
far_159:
buffer_store_dwordx4 v[192:195], v9, s[20:23], s66 offen offset:0 sc1
buffer_store_dwordx4 v[196:199], v9, s[20:23], s66 offen offset:1024 sc1
s_branch near_160
far_163:
buffer_store_dword v212, v3, s[24:27], s70 offen sc1
s_branch near_164
mo_165:
s_lshr_b32 s67, s33, 5
s_cmp_eq_u32 s67, s66
s_cbranch_scc0 mo_166
s_and_b32 s67, s33, 31
v_sub_u32 v48, s67, v48
v_lshlrev_b32 v49, 4, v49
s_lshl_b32 s67, s62, 14
s_add_u32 s67, s67, 30686208
poll_244:
buffer_load_dwordx4 v[56:59], v49, s[20:23], s67 offen offset:0 sc1
buffer_load_dwordx4 v[60:63], v49, s[20:23], s67 offen offset:64 sc1
pchk_245:
s_waitcnt vmcnt(1)
v_min3_u32 v50, v56, v57, v58
s_waitcnt vmcnt(0)
v_min3_u32 v50, v50, v59, v60
v_min3_u32 v50, v50, v61, v62
v_min_u32 v50, v50, v63
v_cmp_eq_u32 vcc, 0, v50
s_cbranch_vccz pdone_246
s_sub_u32 s32, s32, 1
s_cmp_gt_i32 s32, 0
s_cbranch_scc1 poll_244
pdone_246:
v_cmp_eq_u32 vcc, 0, v48
s_nop 1
v_cndmask_b32 v240, v240, v56, vcc
v_cndmask_b32 v241, v241, v57, vcc
v_cndmask_b32 v242, v242, v58, vcc
v_cndmask_b32 v243, v243, v59, vcc
v_cndmask_b32 v244, v244, v60, vcc
v_cndmask_b32 v245, v245, v61, vcc
v_cndmask_b32 v246, v246, v62, vcc
v_cndmask_b32 v247, v247, v63, vcc
v_cmp_eq_u32 vcc, 16, v48
s_nop 1
v_cndmask_b32 v248, v248, v56, vcc
v_cndmask_b32 v249, v249, v57, vcc
v_cndmask_b32 v250, v250, v58, vcc
v_cndmask_b32 v251, v251, v59, vcc
v_cndmask_b32 v252, v252, v60, vcc
v_cndmask_b32 v253, v253, v61, vcc
v_cndmask_b32 v254, v254, v62, vcc
v_cndmask_b32 v255, v255, v63, vcc
s_branch mo_166
far_169:
buffer_store_dwordx4 v[240:243], v6, s[20:23], s68 offen offset:0 sc1
buffer_store_dwordx4 v[244:247], v6, s[20:23], s68 offen offset:1024 sc1
buffer_store_dwordx4 v[248:251], v6, s[20:23], s68 offen offset:2048 sc1
buffer_store_dwordx4 v[252:255], v6, s[20:23], s68 offen offset:3072 sc1
s_branch near_170
far_171:
buffer_store_dwordx4 v[8:11], v6, s[24:27], s67 offen sc1
s_branch near_172
far_173:
buffer_store_dword v212, v3, s[24:27], s66 offen sc1
s_branch near_174
far_185:
buffer_store_dwordx2 v[10:11], v12, s[24:27], s66 offen sc1
s_branch near_186
L_end:
L_fin:
s_endpgm
.section .rodata,"a"
.p2align 6
.amdhsa_kernel interleave_layers__sliding_block__moe_arch_mod__prompt_kernel
  .amdhsa_next_free_vgpr 256
  .amdhsa_next_free_sgpr 102
  .amdhsa_accum_offset 256
  .amdhsa_group_segment_fixed_size 0
  .amdhsa_kernarg_size 88
  .amdhsa_user_sgpr_count 2
  .amdhsa_user_sgpr_kernarg_segment_ptr 1
  .amdhsa_system_sgpr_workgroup_id_x 1
  .amdhsa_float_denorm_mode_32 3
.end_amdhsa_kernel
```

```asm
; @launch grid=(256,1,1) block=(512,1,1) lds=163840
.amdgcn_target "amdgcn-amd-amdhsa--gfx950"
.text
.globl interleave_layers__sliding_block__moe_arch_mod__prompt_kernel
.p2align 8
.type interleave_layers__sliding_block__moe_arch_mod__prompt_kernel,@function
interleave_layers__sliding_block__moe_arch_mod__prompt_kernel:
s_cmp_ge_u32 s2, 256
s_cbranch_scc1 L_fin
s_load_dwordx16 s[36:51], s[0:1], 0
s_load_dwordx4 s[52:55], s[0:1], 64
s_load_dwordx2 s[56:57], s[0:1], 80
v_lshrrev_b32 v1, 6, v0
v_and_b32 v0, 63, v0
s_and_b32 s64, s2, 7
v_readfirstlane_b32 s3, v1
s_lshr_b32 s65, s2, 3
s_and_b32 s66, s65, 7
s_and_b32 s67, s64, 1
s_lshl3_add_u32 s59, s67, s66
s_lshr_b32 s66, s65, 3
s_lshr_b32 s67, s64, 1
s_lshl2_add_u32 s60, s67, s66
s_and_b32 s66, s65, 1
s_lshl1_add_u32 s61, s64, s66
s_lshr_b32 s62, s65, 1
s_mov_b32 s59, s61
s_xor_b32 s60, s62, 0
s_mov_b32 s63, 0
s_mov_b32 s34, 0
s_mov_b32 s32, 200000
s_mov_b32 s33, -1
s_cmp_ge_u32 s3, 4
s_cselect_b32 s66, 3, 1
s_and_b32 s58, s3, s66
s_waitcnt lgkmcnt(0)
s_mov_b32 s8, s36
s_mov_b32 s9, s37
s_mov_b32 s10, 0x400000
s_mov_b32 s11, 0x00020000
s_mov_b32 s12, s38
s_mov_b32 s13, s39
s_mov_b32 s14, 0x600000
s_mov_b32 s15, 0x00020000
s_mov_b32 s16, s40
s_mov_b32 s17, s41
s_mov_b32 s18, 0x200000
s_mov_b32 s19, 0x00020000
s_mov_b32 s20, s56
s_mov_b32 s21, s57
s_mov_b32 s22, 0x2500000
s_mov_b32 s23, 0x00020000
s_add_u32 s24, s56, 30408704
s_addc_u32 s25, s57, 0
s_mov_b32 s26, 2818048
s_mov_b32 s27, 0x00020000
s_mov_b32 s28, s52
s_mov_b32 s29, s53
s_mov_b32 s30, 0x400000
s_mov_b32 s31, 0x00020000
s_cmp_ge_u32 s3, 4
s_cbranch_scc1 L_m
s_cmp_ge_u32 s3, 2
s_cbranch_scc1 L_f
s_setprio 1
v_and_b32 v22, 7, v0
v_lshrrev_b32 v23, 4, v0
v_lshrrev_b32 v6, 3, v0
v_xor_b32 v7, v22, v23
v_lshlrev_b32 v7, 4, v7
v_lshl_add_u32 v8, v6, 11, v7
v_xor_b32 v7, 64, v8
v_add_u32 v9, 15360, v7
v_add_u32 v10, 30720, v8
v_add_u32 v11, 46080, v7
s_lshl_b32 s70, s59, 18
s_lshl_b32 s71, s58, 16
s_add_u32 s68, s70, s71
s_sub_u32 s69, s70, s71
s_add_u32 s69, s69, 196608
s_mov_b32 s67, 128
s_lshl_b32 s75, s58, 13
s_mov_b32 s65, 86016
s_and_b32 s79, s59, 1
s_mul_i32 s70, s60, 1
s_and_b32 s71, s59, 14
s_add_u32 s70, s70, s71
s_and_b32 s70, s70, 15
s_xor_b32 s64, s70, s79
s_mul_i32 s70, s64, s67
s_add_u32 m0, s65, s75
s_add_u32 s71, s70, s68
buffer_load_dwordx4 v8, s[8:11], s71 offen offset:0 lds
buffer_load_dwordx4 v9, s[8:11], s71 offen offset:1024 lds
buffer_load_dwordx4 v10, s[8:11], s71 offen offset:2048 lds
buffer_load_dwordx4 v11, s[8:11], s71 offen offset:3072 lds
s_add_u32 m0, m0, 4096
s_add_u32 s71, s70, s69
buffer_load_dwordx4 v8, s[8:11], s71 offen offset:0 lds
buffer_load_dwordx4 v9, s[8:11], s71 offen offset:1024 lds
buffer_load_dwordx4 v10, s[8:11], s71 offen offset:2048 lds
buffer_load_dwordx4 v11, s[8:11], s71 offen offset:3072 lds
v_and_b32 v7, 2, v6
v_xor_b32 v7, v7, v22
v_mul_u32_u24 v6, 6144, v6
v_lshl_add_u32 v12, v7, 4, v6
v_xor_b32 v6, 64, v12
v_add_u32 v13, 48128, v6
v_add_u32 v14, 96256, v12
v_add_u32 v15, 144384, v6
s_mul_i32 s76, s58, 12288
s_add_u32 s76, s76, 16384
s_lshl_b32 s70, s60, 7
s_cmp_eq_u32 s58, 0
s_mov_b32 s71, 198656
s_cselect_b32 s72, 0, s71
s_mov_b32 s71, 4096
s_cselect_b32 s73, 196608, s71
s_mov_b32 s71, 200704
s_cselect_b32 s74, 2048, s71
s_add_u32 s72, s72, s70
s_add_u32 s73, s73, s70
s_add_u32 s74, s74, s70
s_mul_i32 s70, s64, 393216
s_add_u32 m0, s65, s76
s_add_u32 s71, s70, s72
buffer_load_dwordx4 v12, s[12:15], s71 offen offset:0 lds
buffer_load_dwordx4 v13, s[12:15], s71 offen offset:1024 lds
buffer_load_dwordx4 v14, s[12:15], s71 offen offset:2048 lds
buffer_load_dwordx4 v15, s[12:15], s71 offen offset:3072 lds
s_add_u32 m0, m0, 4096
s_add_u32 s71, s70, s73
buffer_load_dwordx4 v12, s[12:15], s71 offen offset:0 lds
buffer_load_dwordx4 v13, s[12:15], s71 offen offset:1024 lds
buffer_load_dwordx4 v14, s[12:15], s71 offen offset:2048 lds
buffer_load_dwordx4 v15, s[12:15], s71 offen offset:3072 lds
s_add_u32 m0, m0, 4096
s_add_u32 s71, s70, s74
buffer_load_dwordx4 v12, s[12:15], s71 offen offset:0 lds
buffer_load_dwordx4 v13, s[12:15], s71 offen offset:1024 lds
buffer_load_dwordx4 v14, s[12:15], s71 offen offset:2048 lds
buffer_load_dwordx4 v15, s[12:15], s71 offen offset:3072 lds
s_xor_b32 s64, s64, s79
s_add_u32 s64, s64, 1
s_and_b32 s64, s64, 15
s_xor_b32 s64, s64, s79
s_sub_u32 s65, s65, 40960
s_cselect_b32 s65, 86016, s65
v_and_b32 v1, 3, v0
v_lshlrev_b32 v1, 2, v1
v_and_b32 v2, 4, v1
s_lshl2_add_u32 s35, s58, 16
v_mov_b32 v3, s35
v_lshlrev_b32 v20, 4, v0
v_lshrrev_b32 v6, 2, v0
v_lshl_add_u32 v21, v6, 7, v1
v_lshrrev_b32 v6, 3, v0
v_lshlrev_b32 v23, 1, v23
v_xor_b32 v23, v23, v22
v_lshlrev_b32 v23, 4, v23
v_lshl_add_u32 v23, v6, 11, v23
s_lshl_b32 s70, s62, 7
s_lshl_b32 s71, s58, 16
s_add_u32 s70, s70, s71
v_add_u32 v16, s70, v23
v_add_u32 v17, 15360, v16
v_add_u32 v18, 30720, v16
v_add_u32 v19, 46080, v16
s_add_u32 s77, s61, s62
s_lshl_b32 s77, s77, 17
s_lshl_b32 s78, s58, 12
s_mov_b32 s66, -2
s_barrier
.p2align 4
lq_1:
s_add_u32 s35, s66, 1
lw_4:
ds_read_b32 v5, v1 offset:0
s_waitcnt lgkmcnt(0)
v_cmp_gt_i32 vcc, s35, v5
s_cbranch_vccz lwd_5
s_sub_u32 s32, s32, 1
s_cmp_gt_i32 s32, 0
s_cbranch_scc1 lw_4
lwd_5:
s_cmp_eq_u32 s66, 0
s_cbranch_scc1 lcs_2
lcb_3:
s_mul_i32 s70, s64, s67
s_add_u32 m0, s65, s75
s_add_u32 s71, s70, s68
buffer_load_dwordx4 v8, s[8:11], s71 offen offset:0 sc1 lds
buffer_load_dwordx4 v9, s[8:11], s71 offen offset:1024 sc1 lds
buffer_load_dwordx4 v10, s[8:11], s71 offen offset:2048 sc1 lds
buffer_load_dwordx4 v11, s[8:11], s71 offen offset:3072 sc1 lds
buffer_load_dword v30, off, s[12:15], 0
s_add_u32 m0, m0, 4096
s_add_u32 s71, s70, s69
buffer_load_dwordx4 v8, s[8:11], s71 offen offset:0 sc1 lds
buffer_load_dwordx4 v9, s[8:11], s71 offen offset:1024 sc1 lds
buffer_load_dwordx4 v10, s[8:11], s71 offen offset:2048 sc1 lds
buffer_load_dwordx4 v11, s[8:11], s71 offen offset:3072 sc1 lds
buffer_load_dword v30, off, s[12:15], 0
s_mul_i32 s70, s64, 393216
s_add_u32 m0, s65, s76
s_add_u32 s71, s70, s72
buffer_load_dwordx4 v12, s[12:15], s71 offen offset:0 lds
buffer_load_dwordx4 v13, s[12:15], s71 offen offset:1024 lds
buffer_load_dwordx4 v14, s[12:15], s71 offen offset:2048 lds
buffer_load_dwordx4 v15, s[12:15], s71 offen offset:3072 lds
buffer_load_dword v30, off, s[12:15], 0
v_add_u32 v5, s66, 3
s_mov_b64 exec, 1
s_waitcnt vmcnt(15)
ds_write_b32 v3, v5
s_mov_b64 exec, -1
s_mul_i32 s70, s64, 393216
s_add_u32 m0, m0, 4096
s_add_u32 s71, s70, s73
buffer_load_dwordx4 v12, s[12:15], s71 offen offset:0 lds
buffer_load_dwordx4 v13, s[12:15], s71 offen offset:1024 lds
buffer_load_dwordx4 v14, s[12:15], s71 offen offset:2048 lds
buffer_load_dwordx4 v15, s[12:15], s71 offen offset:3072 lds
buffer_load_dword v30, off, s[12:15], 0
s_mul_i32 s70, s64, 393216
s_add_u32 m0, m0, 4096
s_add_u32 s71, s70, s74
buffer_load_dwordx4 v12, s[12:15], s71 offen offset:0 lds
buffer_load_dwordx4 v13, s[12:15], s71 offen offset:1024 lds
buffer_load_dwordx4 v14, s[12:15], s71 offen offset:2048 lds
buffer_load_dwordx4 v15, s[12:15], s71 offen offset:3072 lds
buffer_load_dword v30, off, s[12:15], 0
s_xor_b32 s64, s64, s79
s_add_u32 s64, s64, 1
s_and_b32 s64, s64, 15
s_xor_b32 s64, s64, s79
s_sub_u32 s65, s65, 40960
s_cselect_b32 s65, 86016, s65
s_add_u32 s66, s66, 1
s_and_b32 s70, s66, 31
s_cmp_eq_u32 s70, 13
s_cbranch_scc0 lq_1
s_waitcnt vmcnt(0)
v_add_u32 v5, s34, 16
s_mov_b64 exec, 1
ds_write_b32 v3, v5
s_mov_b64 exec, -1
s_add_u32 s35, s34, 14
lw_6:
ds_read_b32 v5, v1 offset:0
s_waitcnt lgkmcnt(0)
v_cmp_gt_i32 vcc, s35, v5
s_cbranch_vccz lwd_7
s_sleep 1
s_sub_u32 s32, s32, 1
s_cmp_gt_i32 s32, 0
s_cbranch_scc1 lw_6
lwd_7:
s_add_u32 s70, s77, 262144
s_add_u32 m0, s78, 49152
s_and_b32 s70, s70, 0x1fffff
buffer_load_dwordx4 v16, s[16:19], s70 offen offset:0 lds
buffer_load_dwordx4 v17, s[16:19], s70 offen offset:1024 lds
buffer_load_dwordx4 v18, s[16:19], s70 offen offset:2048 lds
buffer_load_dwordx4 v19, s[16:19], s70 offen offset:3072 lds
buffer_load_dword v30, off, s[12:15], 0
s_add_u32 s70, s77, 393216
s_add_u32 m0, s78, 57344
s_and_b32 s70, s70, 0x1fffff
buffer_load_dwordx4 v16, s[16:19], s70 offen offset:0 lds
buffer_load_dwordx4 v17, s[16:19], s70 offen offset:1024 lds
buffer_load_dwordx4 v18, s[16:19], s70 offen offset:2048 lds
buffer_load_dwordx4 v19, s[16:19], s70 offen offset:3072 lds
buffer_load_dword v30, off, s[12:15], 0
s_add_u32 s70, s77, 524288
s_add_u32 m0, s78, 65536
s_and_b32 s70, s70, 0x1fffff
buffer_load_dwordx4 v16, s[16:19], s70 offen offset:0 lds
buffer_load_dwordx4 v17, s[16:19], s70 offen offset:1024 lds
buffer_load_dwordx4 v18, s[16:19], s70 offen offset:2048 lds
buffer_load_dwordx4 v19, s[16:19], s70 offen offset:3072 lds
buffer_load_dword v30, off, s[12:15], 0
s_add_u32 s70, s77, 655360
s_add_u32 m0, s78, 73728
s_and_b32 s70, s70, 0x1fffff
buffer_load_dwordx4 v16, s[16:19], s70 offen offset:0 lds
buffer_load_dwordx4 v17, s[16:19], s70 offen offset:1024 lds
buffer_load_dwordx4 v18, s[16:19], s70 offen offset:2048 lds
buffer_load_dwordx4 v19, s[16:19], s70 offen offset:3072 lds
buffer_load_dword v30, off, s[12:15], 0
s_sub_u32 s70, s59, s58
s_lshl_b32 s71, s70, 7
s_add_u32 s71, s71, s60
s_lshl4_add_u32 s70, s70, s60
s_sub_u32 s70, s70, 16
s_lshl_b32 s66, s71, 7
s_add_u32 s66, s66, 253952
s_lshl_b32 s70, s70, 15
s_lshl_b32 s71, s63, 23
s_add_u32 s70, s70, s71
s_add_u32 s64, s70, 1077248
s_mul_i32 s65, s58, -94208
s_add_u32 s35, s34, 16
lw_8:
ds_read_b32 v5, v1 offset:0
s_waitcnt lgkmcnt(0)
v_cmp_gt_i32 vcc, s35, v5
s_cbranch_vccz lwd_9
s_sleep 1
s_sub_u32 s32, s32, 1
s_cmp_gt_i32 s32, 0
s_cbranch_scc1 lw_8
lwd_9:
s_add_u32 s35, s34, 17
lw_11:
ds_read_b32 v5, v1 offset:0
s_waitcnt lgkmcnt(0)
v_cmp_gt_i32 vcc, s35, v5
s_cbranch_vccz lwd_12
s_sleep 1
s_sub_u32 s32, s32, 1
s_cmp_gt_i32 s32, 0
s_cbranch_scc1 lw_11
lwd_12:
s_cmp_gt_u32 s59, s58
s_cbranch_scc0 nokv_10
poll_13:
buffer_load_dword v6, v1, s[24:27], s66 offen sc1
pchk_14:
s_waitcnt vmcnt(0)
v_cmp_eq_u32 vcc, 0, v6
s_cbranch_vccz pdone_15
s_sub_u32 s32, s32, 1
s_cmp_gt_i32 s32, 0
s_cbranch_scc1 poll_13
pdone_15:
s_cmp_eq_u32 s58, 0
s_cbranch_scc1 kd_16
v_mov_b32 v7, 0
s_add_u32 s35, s34, 17
lw_17:
ds_read_b32 v5, v7 offset:16
s_waitcnt lgkmcnt(0)
v_cmp_gt_i32 vcc, s35, v5
s_cbranch_vccz lwd_18
s_sleep 1
s_sub_u32 s32, s32, 1
s_cmp_gt_i32 s32, 0
s_cbranch_scc1 lw_17
lwd_18:
kd_16:
s_add_u32 m0, s65, 126976
s_nop 0
buffer_load_dwordx4 v20, s[20:23], s64 offen offset:0 sc1 lds
buffer_load_dwordx4 v20, s[20:23], s64 offen offset:1024 sc1 lds
buffer_load_dwordx4 v20, s[20:23], s64 offen offset:2048 sc1 lds
buffer_load_dwordx4 v20, s[20:23], s64 offen offset:3072 sc1 lds
buffer_load_dword v30, off, s[12:15], 0
s_add_u32 m0, s65, 122880
s_sub_u32 s64, s64, 4096
buffer_load_dwordx4 v20, s[20:23], s64 offen offset:0 sc1 lds
buffer_load_dwordx4 v20, s[20:23], s64 offen offset:1024 sc1 lds
buffer_load_dwordx4 v20, s[20:23], s64 offen offset:2048 sc1 lds
buffer_load_dwordx4 v20, s[20:23], s64 offen offset:3072 sc1 lds
buffer_load_dword v30, off, s[12:15], 0
s_add_u32 m0, s65, 118784
s_sub_u32 s64, s64, 4096
buffer_load_dwordx4 v20, s[20:23], s64 offen offset:0 sc1 lds
buffer_load_dwordx4 v20, s[20:23], s64 offen offset:1024 sc1 lds
buffer_load_dwordx4 v20, s[20:23], s64 offen offset:2048 sc1 lds
buffer_load_dwordx4 v20, s[20:23], s64 offen offset:3072 sc1 lds
buffer_load_dword v30, off, s[12:15], 0
s_add_u32 m0, s65, 114688
s_sub_u32 s64, s64, 4096
buffer_load_dwordx4 v20, s[20:23], s64 offen offset:0 sc1 lds
buffer_load_dwordx4 v20, s[20:23], s64 offen offset:1024 sc1 lds
buffer_load_dwordx4 v20, s[20:23], s64 offen offset:2048 sc1 lds
buffer_load_dwordx4 v20, s[20:23], s64 offen offset:3072 sc1 lds
buffer_load_dword v30, off, s[12:15], 0
s_add_u32 m0, s65, 110592
s_sub_u32 s64, s64, 4096
buffer_load_dwordx4 v20, s[20:23], s64 offen offset:0 sc1 lds
buffer_load_dwordx4 v20, s[20:23], s64 offen offset:1024 sc1 lds
buffer_load_dwordx4 v20, s[20:23], s64 offen offset:2048 sc1 lds
buffer_load_dwordx4 v20, s[20:23], s64 offen offset:3072 sc1 lds
buffer_load_dword v30, off, s[12:15], 0
s_add_u32 m0, s65, 106496
s_sub_u32 s64, s64, 4096
buffer_load_dwordx4 v20, s[20:23], s64 offen offset:0 sc1 lds
buffer_load_dwordx4 v20, s[20:23], s64 offen offset:1024 sc1 lds
buffer_load_dwordx4 v20, s[20:23], s64 offen offset:2048 sc1 lds
buffer_load_dwordx4 v20, s[20:23], s64 offen offset:3072 sc1 lds
buffer_load_dword v30, off, s[12:15], 0
s_add_u32 m0, s65, 102400
s_sub_u32 s64, s64, 4096
buffer_load_dwordx4 v20, s[20:23], s64 offen offset:0 sc1 lds
buffer_load_dwordx4 v20, s[20:23], s64 offen offset:1024 sc1 lds
buffer_load_dwordx4 v20, s[20:23], s64 offen offset:2048 sc1 lds
buffer_load_dwordx4 v20, s[20:23], s64 offen offset:3072 sc1 lds
buffer_load_dword v30, off, s[12:15], 0
s_add_u32 m0, s65, 98304
s_sub_u32 s64, s64, 4096
buffer_load_dwordx4 v20, s[20:23], s64 offen offset:0 sc1 lds
buffer_load_dwordx4 v20, s[20:23], s64 offen offset:1024 sc1 lds
buffer_load_dwordx4 v20, s[20:23], s64 offen offset:2048 sc1 lds
buffer_load_dwordx4 v20, s[20:23], s64 offen offset:3072 sc1 lds
buffer_load_dword v30, off, s[12:15], 0
v_add_u32 v5, s34, 17
s_mov_b64 exec, 1
ds_write_b32 v3, v5
s_mov_b64 exec, -1
s_waitcnt vmcnt(30)
v_add_u32 v5, s34, 18
s_mov_b64 exec, 1
ds_write_b32 v3, v5
s_mov_b64 exec, -1
nokv_10:
s_lshl_b32 s66, s61, 14
s_add_u32 s66, s66, 268288
s_waitcnt vmcnt(0)
v_add_u32 v5, s34, 21
s_mov_b64 exec, 1
ds_write_b32 v3, v5
s_mov_b64 exec, -1
s_add_u32 s70, s77, 131072
s_add_u32 m0, s78, 40960
s_and_b32 s70, s70, 0x1fffff
buffer_load_dwordx4 v16, s[16:19], s70 offen offset:0 lds
buffer_load_dwordx4 v17, s[16:19], s70 offen offset:1024 lds
buffer_load_dwordx4 v18, s[16:19], s70 offen offset:2048 lds
buffer_load_dwordx4 v19, s[16:19], s70 offen offset:3072 lds
buffer_load_dword v30, off, s[12:15], 0
s_add_u32 s70, s77, 786432
s_add_u32 m0, s78, 81920
s_and_b32 s70, s70, 0x1fffff
buffer_load_dwordx4 v16, s[16:19], s70 offen offset:0 lds
buffer_load_dwordx4 v17, s[16:19], s70 offen offset:1024 lds
buffer_load_dwordx4 v18, s[16:19], s70 offen offset:2048 lds
buffer_load_dwordx4 v19, s[16:19], s70 offen offset:3072 lds
buffer_load_dword v30, off, s[12:15], 0
s_add_u32 s70, s77, 917504
s_add_u32 m0, s78, 90112
s_and_b32 s70, s70, 0x1fffff
buffer_load_dwordx4 v16, s[16:19], s70 offen offset:0 lds
buffer_load_dwordx4 v17, s[16:19], s70 offen offset:1024 lds
buffer_load_dwordx4 v18, s[16:19], s70 offen offset:2048 lds
buffer_load_dwordx4 v19, s[16:19], s70 offen offset:3072 lds
buffer_load_dword v30, off, s[12:15], 0
s_add_u32 s35, s34, 18
lw_20:
ds_read_b32 v5, v1 offset:0
s_waitcnt lgkmcnt(0)
v_cmp_gt_i32 vcc, s35, v5
s_cbranch_vccz lwd_21
s_sleep 1
s_sub_u32 s32, s32, 1
s_cmp_gt_i32 s32, 0
s_cbranch_scc1 lw_20
lwd_21:
s_add_u32 s70, s77, 1572864
s_add_u32 m0, s78, 131072
s_and_b32 s70, s70, 0x1fffff
buffer_load_dwordx4 v16, s[16:19], s70 offen offset:0 lds
buffer_load_dwordx4 v17, s[16:19], s70 offen offset:1024 lds
buffer_load_dwordx4 v18, s[16:19], s70 offen offset:2048 lds
buffer_load_dwordx4 v19, s[16:19], s70 offen offset:3072 lds
buffer_load_dword v30, off, s[12:15], 0
s_add_u32 s70, s77, 1703936
s_add_u32 m0, s78, 139264
s_and_b32 s70, s70, 0x1fffff
buffer_load_dwordx4 v16, s[16:19], s70 offen offset:0 lds
buffer_load_dwordx4 v17, s[16:19], s70 offen offset:1024 lds
buffer_load_dwordx4 v18, s[16:19], s70 offen offset:2048 lds
buffer_load_dwordx4 v19, s[16:19], s70 offen offset:3072 lds
buffer_load_dword v30, off, s[12:15], 0
s_add_u32 s70, s77, 1835008
s_add_u32 m0, s78, 147456
s_and_b32 s70, s70, 0x1fffff
buffer_load_dwordx4 v16, s[16:19], s70 offen offset:0 lds
buffer_load_dwordx4 v17, s[16:19], s70 offen offset:1024 lds
buffer_load_dwordx4 v18, s[16:19], s70 offen offset:2048 lds
buffer_load_dwordx4 v19, s[16:19], s70 offen offset:3072 lds
buffer_load_dword v30, off, s[12:15], 0
s_add_u32 s70, s77, 1966080
s_add_u32 m0, s78, 155648
s_and_b32 s70, s70, 0x1fffff
buffer_load_dwordx4 v16, s[16:19], s70 offen offset:0 lds
buffer_load_dwordx4 v17, s[16:19], s70 offen offset:1024 lds
buffer_load_dwordx4 v18, s[16:19], s70 offen offset:2048 lds
buffer_load_dwordx4 v19, s[16:19], s70 offen offset:3072 lds
buffer_load_dword v30, off, s[12:15], 0
s_add_u32 s35, s34, 19
lw_22:
ds_read_b32 v5, v1 offset:0
s_waitcnt lgkmcnt(0)
v_cmp_gt_i32 vcc, s35, v5
s_cbranch_vccz lwd_23
s_sleep 2
s_sub_u32 s32, s32, 1
s_cmp_gt_i32 s32, 0
s_cbranch_scc1 lw_22
lwd_23:
s_add_u32 s70, s77, 1048576
s_add_u32 m0, s78, 98304
s_and_b32 s70, s70, 0x1fffff
buffer_load_dwordx4 v16, s[16:19], s70 offen offset:0 lds
buffer_load_dwordx4 v17, s[16:19], s70 offen offset:1024 lds
buffer_load_dwordx4 v18, s[16:19], s70 offen offset:2048 lds
buffer_load_dwordx4 v19, s[16:19], s70 offen offset:3072 lds
buffer_load_dword v30, off, s[12:15], 0
s_add_u32 s70, s77, 1179648
s_add_u32 m0, s78, 106496
s_and_b32 s70, s70, 0x1fffff
buffer_load_dwordx4 v16, s[16:19], s70 offen offset:0 lds
buffer_load_dwordx4 v17, s[16:19], s70 offen offset:1024 lds
buffer_load_dwordx4 v18, s[16:19], s70 offen offset:2048 lds
buffer_load_dwordx4 v19, s[16:19], s70 offen offset:3072 lds
buffer_load_dword v30, off, s[12:15], 0
s_add_u32 s70, s77, 1310720
s_add_u32 m0, s78, 114688
s_and_b32 s70, s70, 0x1fffff
buffer_load_dwordx4 v16, s[16:19], s70 offen offset:0 lds
buffer_load_dwordx4 v17, s[16:19], s70 offen offset:1024 lds
buffer_load_dwordx4 v18, s[16:19], s70 offen offset:2048 lds
buffer_load_dwordx4 v19, s[16:19], s70 offen offset:3072 lds
buffer_load_dword v30, off, s[12:15], 0
s_add_u32 s70, s77, 1441792
s_add_u32 m0, s78, 122880
s_and_b32 s70, s70, 0x1fffff
buffer_load_dwordx4 v16, s[16:19], s70 offen offset:0 lds
buffer_load_dwordx4 v17, s[16:19], s70 offen offset:1024 lds
buffer_load_dwordx4 v18, s[16:19], s70 offen offset:2048 lds
buffer_load_dwordx4 v19, s[16:19], s70 offen offset:3072 lds
buffer_load_dword v30, off, s[12:15], 0
s_add_u32 s35, s34, 20
lw_24:
ds_read_b32 v5, v1 offset:0
s_waitcnt lgkmcnt(0)
v_cmp_gt_i32 vcc, s35, v5
s_cbranch_vccz lwd_25
s_sleep 2
s_sub_u32 s32, s32, 1
s_cmp_gt_i32 s32, 0
s_cbranch_scc1 lw_24
lwd_25:
s_add_u32 s70, s77, 0
s_add_u32 m0, s78, 32768
s_and_b32 s70, s70, 0x1fffff
buffer_load_dwordx4 v16, s[16:19], s70 offen offset:0 lds
buffer_load_dwordx4 v17, s[16:19], s70 offen offset:1024 lds
buffer_load_dwordx4 v18, s[16:19], s70 offen offset:2048 lds
buffer_load_dwordx4 v19, s[16:19], s70 offen offset:3072 lds
buffer_load_dword v30, off, s[12:15], 0
s_cmp_eq_u32 s58, 0
s_cbranch_scc0 nofo_19
s_add_u32 s35, s34, 21
lw_26:
ds_read_b32 v5, v1 offset:0
s_waitcnt lgkmcnt(0)
v_cmp_gt_i32 vcc, s35, v5
s_cbranch_vccz lwd_27
s_sleep 1
s_sub_u32 s32, s32, 1
s_cmp_gt_i32 s32, 0
s_cbranch_scc1 lw_26
lwd_27:
poll_28:
buffer_load_dword v6, v21, s[24:27], s66 offen sc1
pchk_29:
s_waitcnt vmcnt(0)
v_cmp_eq_u32 vcc, 0, v6
s_mov_b64 exec, vcc
s_cbranch_vccz pdone_30
s_sleep 1
s_sub_u32 s32, s32, 1
s_cmp_gt_i32 s32, 0
s_cbranch_scc1 poll_28
pdone_30:
s_mov_b64 exec, -1
nofo_19:
s_waitcnt vmcnt(0)
v_add_u32 v5, s34, 22
s_mov_b64 exec, 1
ds_write_b32 v3, v5
s_mov_b64 exec, -1
s_cmp_eq_u32 s63, 0
s_cbranch_scc0 L_end
v_bfe_u32 v6, v0, 3, 2
v_and_b32 v7, 2, v6
v_xor_b32 v7, v7, v22
v_lshrrev_b32 v23, 5, v0
v_lshl_add_u32 v6, v23, 4, v6
v_mul_u32_u24 v6, 6144, v6
v_lshl_add_u32 v12, v7, 4, v6
v_xor_b32 v6, 64, v12
v_add_u32 v13, 23552, v6
v_add_u32 v14, 47104, v12
v_add_u32 v15, 70656, v6
v_mov_b32 v8, v20
v_mov_b32 v9, v20
v_mov_b32 v10, v20
v_mov_b32 v11, v20
s_mov_b32 s8, s56
s_mov_b32 s9, s57
s_mov_b32 s10, 0x2500000
s_mov_b32 s11, 0x00020000
s_lshl_b32 s70, s59, 18
s_add_u32 s70, s70, 26214400
s_add_u32 s68, s70, s78
s_sub_u32 s69, s70, s78
s_add_u32 s69, s69, 12288
s_mov_b32 s67, 16384
s_lshl_b32 s66, s59, 14
s_add_u32 s66, s66, 274432
s_and_b32 s79, s59, 1
s_mul_i32 s79, s79, 1
s_mul_i32 s70, s60, 1
s_and_b32 s71, s59, 14
s_add_u32 s70, s70, s71
s_and_b32 s70, s70, 15
s_xor_b32 s64, s70, s79
s_mov_b32 s65, 86016
s_add_u32 s35, s34, 22
lw_31:
ds_read_b32 v5, v1 offset:0
s_waitcnt lgkmcnt(0)
v_cmp_gt_i32 vcc, s35, v5
s_cbranch_vccz lwd_32
s_sleep 2
s_sub_u32 s32, s32, 1
s_cmp_gt_i32 s32, 0
s_cbranch_scc1 lw_31
lwd_32:
s_mul_i32 s70, s64, 393216
s_add_u32 m0, s65, s76
s_add_u32 s71, s70, s72
buffer_load_dwordx4 v12, s[12:15], s71 offen offset:0 lds
buffer_load_dwordx4 v13, s[12:15], s71 offen offset:1024 lds
buffer_load_dwordx4 v14, s[12:15], s71 offen offset:2048 lds
buffer_load_dwordx4 v15, s[12:15], s71 offen offset:3072 lds
buffer_load_dword v30, off, s[12:15], 0
s_add_u32 m0, m0, 4096
s_add_u32 s71, s70, s73
buffer_load_dwordx4 v12, s[12:15], s71 offen offset:0 lds
buffer_load_dwordx4 v13, s[12:15], s71 offen offset:1024 lds
buffer_load_dwordx4 v14, s[12:15], s71 offen offset:2048 lds
buffer_load_dwordx4 v15, s[12:15], s71 offen offset:3072 lds
buffer_load_dword v30, off, s[12:15], 0
s_add_u32 m0, m0, 4096
s_add_u32 s71, s70, s74
buffer_load_dwordx4 v12, s[12:15], s71 offen offset:0 lds
buffer_load_dwordx4 v13, s[12:15], s71 offen offset:1024 lds
buffer_load_dwordx4 v14, s[12:15], s71 offen offset:2048 lds
buffer_load_dwordx4 v15, s[12:15], s71 offen offset:3072 lds
buffer_load_dword v30, off, s[12:15], 0
s_and_b32 s79, s59, 1
s_mul_i32 s79, s79, 1
s_mul_i32 s70, s60, 1
s_and_b32 s71, s59, 14
s_add_u32 s70, s70, s71
s_and_b32 s70, s70, 15
s_xor_b32 s64, s70, s79
s_mov_b32 s65, 86016
s_add_u32 s35, s34, 23
lw_33:
ds_read_b32 v5, v1 offset:0
s_waitcnt lgkmcnt(0)
v_cmp_gt_i32 vcc, s35, v5
s_cbranch_vccz lwd_34
s_sleep 1
s_sub_u32 s32, s32, 1
s_cmp_gt_i32 s32, 0
s_cbranch_scc1 lw_33
lwd_34:
poll_35:
buffer_load_dword v6, v21, s[24:27], s66 offen sc1
pchk_36:
s_waitcnt vmcnt(0)
v_cmp_eq_u32 vcc, 0, v6
s_mov_b64 exec, vcc
s_cbranch_vccz pdone_37
s_sleep 1
s_sub_u32 s32, s32, 1
s_cmp_gt_i32 s32, 0
s_cbranch_scc1 poll_35
pdone_37:
s_mov_b64 exec, -1
s_mul_i32 s70, s64, s67
s_add_u32 m0, s65, s75
s_add_u32 s71, s70, s68
buffer_load_dwordx4 v8, s[8:11], s71 offen offset:0 sc1 lds
buffer_load_dwordx4 v9, s[8:11], s71 offen offset:1024 sc1 lds
buffer_load_dwordx4 v10, s[8:11], s71 offen offset:2048 sc1 lds
buffer_load_dwordx4 v11, s[8:11], s71 offen offset:3072 sc1 lds
buffer_load_dword v30, off, s[12:15], 0
s_add_u32 m0, m0, 4096
s_add_u32 s71, s70, s69
buffer_load_dwordx4 v8, s[8:11], s71 offen offset:0 sc1 lds
buffer_load_dwordx4 v9, s[8:11], s71 offen offset:1024 sc1 lds
buffer_load_dwordx4 v10, s[8:11], s71 offen offset:2048 sc1 lds
buffer_load_dwordx4 v11, s[8:11], s71 offen offset:3072 sc1 lds
buffer_load_dword v30, off, s[12:15], 0
s_xor_b32 s64, s64, s79
s_add_u32 s64, s64, 1
s_and_b32 s64, s64, 15
s_xor_b32 s64, s64, s79
s_sub_u32 s65, s65, 40960
s_cselect_b32 s65, 86016, s65
s_mul_i32 s70, s64, s67
s_add_u32 m0, s65, s75
s_add_u32 s71, s70, s68
buffer_load_dwordx4 v8, s[8:11], s71 offen offset:0 sc1 lds
buffer_load_dwordx4 v9, s[8:11], s71 offen offset:1024 sc1 lds
buffer_load_dwordx4 v10, s[8:11], s71 offen offset:2048 sc1 lds
buffer_load_dwordx4 v11, s[8:11], s71 offen offset:3072 sc1 lds
buffer_load_dword v30, off, s[12:15], 0
s_add_u32 m0, m0, 4096
s_add_u32 s71, s70, s69
buffer_load_dwordx4 v8, s[8:11], s71 offen offset:0 sc1 lds
buffer_load_dwordx4 v9, s[8:11], s71 offen offset:1024 sc1 lds
buffer_load_dwordx4 v10, s[8:11], s71 offen offset:2048 sc1 lds
buffer_load_dwordx4 v11, s[8:11], s71 offen offset:3072 sc1 lds
buffer_load_dword v30, off, s[12:15], 0
s_mul_i32 s70, s64, 393216
s_add_u32 m0, s65, s76
s_add_u32 s71, s70, s72
buffer_load_dwordx4 v12, s[12:15], s71 offen offset:0 lds
buffer_load_dwordx4 v13, s[12:15], s71 offen offset:1024 lds
buffer_load_dwordx4 v14, s[12:15], s71 offen offset:2048 lds
buffer_load_dwordx4 v15, s[12:15], s71 offen offset:3072 lds
buffer_load_dword v30, off, s[12:15], 0
s_add_u32 m0, m0, 4096
s_add_u32 s71, s70, s73
buffer_load_dwordx4 v12, s[12:15], s71 offen offset:0 lds
buffer_load_dwordx4 v13, s[12:15], s71 offen offset:1024 lds
buffer_load_dwordx4 v14, s[12:15], s71 offen offset:2048 lds
buffer_load_dwordx4 v15, s[12:15], s71 offen offset:3072 lds
buffer_load_dword v30, off, s[12:15], 0
s_add_u32 m0, m0, 4096
s_add_u32 s71, s70, s74
buffer_load_dwordx4 v12, s[12:15], s71 offen offset:0 lds
buffer_load_dwordx4 v13, s[12:15], s71 offen offset:1024 lds
buffer_load_dwordx4 v14, s[12:15], s71 offen offset:2048 lds
buffer_load_dwordx4 v15, s[12:15], s71 offen offset:3072 lds
buffer_load_dword v30, off, s[12:15], 0
s_xor_b32 s64, s64, s79
s_add_u32 s64, s64, 1
s_and_b32 s64, s64, 15
s_xor_b32 s64, s64, s79
s_sub_u32 s65, s65, 40960
s_cselect_b32 s65, 86016, s65
s_mul_i32 s70, s64, s67
s_add_u32 m0, s65, s75
s_add_u32 s71, s70, s68
buffer_load_dwordx4 v8, s[8:11], s71 offen offset:0 sc1 lds
buffer_load_dwordx4 v9, s[8:11], s71 offen offset:1024 sc1 lds
buffer_load_dwordx4 v10, s[8:11], s71 offen offset:2048 sc1 lds
buffer_load_dwordx4 v11, s[8:11], s71 offen offset:3072 sc1 lds
buffer_load_dword v30, off, s[12:15], 0
s_add_u32 m0, m0, 4096
s_add_u32 s71, s70, s69
buffer_load_dwordx4 v8, s[8:11], s71 offen offset:0 sc1 lds
buffer_load_dwordx4 v9, s[8:11], s71 offen offset:1024 sc1 lds
buffer_load_dwordx4 v10, s[8:11], s71 offen offset:2048 sc1 lds
buffer_load_dwordx4 v11, s[8:11], s71 offen offset:3072 sc1 lds
buffer_load_dword v30, off, s[12:15], 0
s_mul_i32 s70, s64, 393216
s_add_u32 m0, s65, s76
s_add_u32 s71, s70, s72
buffer_load_dwordx4 v12, s[12:15], s71 offen offset:0 lds
buffer_load_dwordx4 v13, s[12:15], s71 offen offset:1024 lds
buffer_load_dwordx4 v14, s[12:15], s71 offen offset:2048 lds
buffer_load_dwordx4 v15, s[12:15], s71 offen offset:3072 lds
buffer_load_dword v30, off, s[12:15], 0
s_add_u32 m0, m0, 4096
s_add_u32 s71, s70, s73
buffer_load_dwordx4 v12, s[12:15], s71 offen offset:0 lds
buffer_load_dwordx4 v13, s[12:15], s71 offen offset:1024 lds
buffer_load_dwordx4 v14, s[12:15], s71 offen offset:2048 lds
buffer_load_dwordx4 v15, s[12:15], s71 offen offset:3072 lds
buffer_load_dword v30, off, s[12:15], 0
s_add_u32 m0, m0, 4096
s_add_u32 s71, s70, s74
buffer_load_dwordx4 v12, s[12:15], s71 offen offset:0 lds
buffer_load_dwordx4 v13, s[12:15], s71 offen offset:1024 lds
buffer_load_dwordx4 v14, s[12:15], s71 offen offset:2048 lds
buffer_load_dwordx4 v15, s[12:15], s71 offen offset:3072 lds
buffer_load_dword v30, off, s[12:15], 0
s_xor_b32 s64, s64, s79
s_add_u32 s64, s64, 1
s_and_b32 s64, s64, 15
s_xor_b32 s64, s64, s79
s_sub_u32 s65, s65, 40960
s_cselect_b32 s65, 86016, s65
s_waitcnt vmcnt(50)
v_add_u32 v5, s34, 33
s_mov_b64 exec, 1
ds_write_b32 v3, v5
s_mov_b64 exec, -1
s_mov_b32 s36, s64
s_mov_b32 s37, s65
s_mov_b32 s64, s59
s_mov_b32 s65, 114688
s_mul_i32 s70, s64, 393216
s_add_u32 m0, s65, s76
s_add_u32 s71, s70, s72
buffer_load_dwordx4 v12, s[12:15], s71 offen offset:0 lds
buffer_load_dwordx4 v13, s[12:15], s71 offen offset:1024 lds
buffer_load_dwordx4 v14, s[12:15], s71 offen offset:2048 lds
buffer_load_dwordx4 v15, s[12:15], s71 offen offset:3072 lds
buffer_load_dword v30, off, s[12:15], 0
s_add_u32 m0, m0, 4096
s_add_u32 s71, s70, s73
buffer_load_dwordx4 v12, s[12:15], s71 offen offset:0 lds
buffer_load_dwordx4 v13, s[12:15], s71 offen offset:1024 lds
buffer_load_dwordx4 v14, s[12:15], s71 offen offset:2048 lds
buffer_load_dwordx4 v15, s[12:15], s71 offen offset:3072 lds
buffer_load_dword v30, off, s[12:15], 0
s_add_u32 m0, m0, 4096
s_add_u32 s71, s70, s74
buffer_load_dwordx4 v12, s[12:15], s71 offen offset:0 lds
buffer_load_dwordx4 v13, s[12:15], s71 offen offset:1024 lds
buffer_load_dwordx4 v14, s[12:15], s71 offen offset:2048 lds
buffer_load_dwordx4 v15, s[12:15], s71 offen offset:3072 lds
buffer_load_dword v30, off, s[12:15], 0
s_mov_b32 s64, s36
s_mov_b32 s65, s37
s_waitcnt vmcnt(40)
v_add_u32 v5, s34, 34
s_mov_b64 exec, 1
ds_write_b32 v3, v5
s_mov_b64 exec, -1
s_mov_b32 s63, 1
s_mov_b32 s34, 32
s_add_u32 s24, s24, 1409024
s_addc_u32 s25, s25, 0
s_mov_b32 s26, 1409024
s_mov_b32 s66, 32
s_branch lq_1
lcs_2:
s_add_u32 s35, s34, 1
lw_38:
ds_read_b32 v5, v2 offset:24
s_waitcnt lgkmcnt(0)
v_cmp_gt_i32 vcc, s35, v5
s_cbranch_vccz lwd_39
s_sub_u32 s32, s32, 1
s_cmp_gt_i32 s32, 0
s_cbranch_scc1 lw_38
lwd_39:
s_branch lcb_3
L_f:
v_lshlrev_b32 v4, 4, v0
s_lshl4_add_u32 s78, s59, s60
v_mov_b32 v252, 0
v_mov_b32 v253, 0
v_mov_b32 v254, 0
v_mov_b32 v255, 0
s_lshl_b32 s35, s78, 10
s_cmp_eq_u32 s58, 0
s_cselect_b64 exec, -1, 0
buffer_store_dwordx4 v[252:255], v4, s[24:27], s35 offen offset:0 sc1
s_add_u32 s35, s35, 262144
buffer_store_dwordx4 v[252:255], v4, s[24:27], s35 offen offset:0 sc1
s_mov_b64 exec, -1
s_setprio 3
v_and_b32 v1, 3, v0
v_lshlrev_b32 v1, 2, v1
v_and_b32 v2, 4, v1
s_lshl2_add_u32 s35, s58, 24
v_mov_b32 v3, s35
s_mov_b32 s4, s54
s_mov_b32 s5, s55
s_mov_b32 s6, 0x100
s_mov_b32 s7, 0x00020000
s_add_u32 s70, s60, 4
s_lshr_b32 s70, s70, 3
s_sub_u32 s70, s60, s70
s_lshl4_add_u32 s64, s70, s59
s_and_b32 s70, s60, 7
s_cmp_eq_u32 s70, 3
s_cselect_b32 s65, 1, 0
s_mov_b32 s69, 0x3f803f80
s_barrier
s_cmp_eq_u32 s58, 0
s_cselect_b32 s16, s46, s48
s_cselect_b32 s17, s47, s49
s_mov_b32 s12, s50
s_mov_b32 s13, s51
s_mov_b32 s14, 0x0
s_mov_b32 s15, 0x00020000
s_cmp_eq_u32 s65, 0
s_cselect_b32 s18, 7340032, 0
s_mov_b32 s14, s18
s_lshr_b32 s70, s64, 3
s_and_b32 s71, s64, 7
s_lshl_b32 s66, s70, 10
s_add_u32 s66, s66, s71
s_lshl1_add_u32 s66, s66, s58
s_lshl_b32 s66, s66, 7
s_mul_i32 s71, s71, 917504
s_lshl_b32 s70, s70, 8
s_add_u32 s77, s71, s70
s_mov_b32 s48, s38
s_mov_b32 s49, s39
s_mov_b32 s50, 0x600000
s_mov_b32 s51, 0x00020000
s_mov_b32 s52, 0
s_and_b32 s54, s60, 8
s_add_u32 s54, s54, 3
s_add_u32 s53, s54, s59
s_and_b32 s55, s60, 7
s_lshl1_add_u32 s55, s55, s58
s_mul_i32 s55, s55, 24576
s_lshl_b32 s54, s54, 7
s_add_u32 s56, s54, s55
s_add_u32 s56, s56, 60
s_and_b32 s73, s2, 3
s_lshl_b32 s73, s73, 6
v_mov_b32 v14, 1
s_sub_u32 exec_lo, 1, s58
s_mov_b32 exec_hi, 0
s_waitcnt vmcnt(0)
buffer_atomic_add v14, off, s[4:7], s73 sc1
s_mov_b64 exec, -1
v_mov_b32 v8, s69
v_mov_b32 v9, s69
v_mov_b32 v10, s69
v_mov_b32 v11, s69
v_mov_b32 v12, s69
v_mov_b32 v13, s69
v_mov_b32 v14, s69
v_mov_b32 v15, s69
s_mov_b32 s70, 102400
ftop_42:
v_lshrrev_b32 v6, 4, v0
v_bfe_u32 v7, v0, 2, 2
v_lshl_add_u32 v6, v6, 3, v7
v_bfe_u32 v7, v0, 3, 2
s_lshl_b32 s71, s58, 1
v_xor_b32 v7, s71, v7
v_lshl_add_u32 v7, v7, 5, s70
v_lshl_add_u32 v6, v6, 7, v7
v_lshl_add_u32 v6, v1, 1, v6
v_xor_b32 v7, 32, v6
s_mul_i32 s71, s63, 34
s_add_u32 s35, s71, 1
lw_43:
ds_read_b32 v5, v2 offset:16
s_waitcnt lgkmcnt(0)
v_cmp_gt_i32 vcc, s35, v5
s_cbranch_vccz lwd_44
s_sleep 1
s_sub_u32 s32, s32, 1
s_cmp_gt_i32 s32, 0
s_cbranch_scc1 lw_43
lwd_44:
ds_read_b64_tr_b16 v[24:25], v6 offset:0
ds_read_b64_tr_b16 v[26:27], v6 offset:512
ds_read_b64_tr_b16 v[28:29], v6 offset:4096
ds_read_b64_tr_b16 v[30:31], v6 offset:4608
ds_read_b64_tr_b16 v[32:33], v7 offset:0
ds_read_b64_tr_b16 v[34:35], v7 offset:512
ds_read_b64_tr_b16 v[36:37], v7 offset:4096
ds_read_b64_tr_b16 v[38:39], v7 offset:4608
ds_read_b64_tr_b16 v[40:41], v6 offset:8192
ds_read_b64_tr_b16 v[42:43], v6 offset:8704
ds_read_b64_tr_b16 v[44:45], v6 offset:12288
ds_read_b64_tr_b16 v[46:47], v6 offset:12800
ds_read_b64_tr_b16 v[48:49], v7 offset:8192
ds_read_b64_tr_b16 v[50:51], v7 offset:8704
ds_read_b64_tr_b16 v[52:53], v7 offset:12288
ds_read_b64_tr_b16 v[54:55], v7 offset:12800
s_lshl_b32 s72, s60, 14
s_lshl_b32 s70, s58, 9
s_add_u32 s72, s72, s70
s_lshl_b32 s70, s59, 10
s_add_u32 s71, s72, s70
s_lshl_b32 s76, s59, 14
s_add_u32 s73, s76, 30686208
s_add_u32 s76, s76, 266240
s_waitcnt lgkmcnt(14)
v_mfma_f32_16x16x32_bf16 v[248:251], v[8:11], v[24:27], 0
s_waitcnt lgkmcnt(10)
v_mfma_f32_16x16x32_bf16 v[252:255], v[8:11], v[32:35], 0
v_mfma_f32_16x16x32_bf16 v[248:251], v[12:15], v[28:31], v[248:251]
s_waitcnt lgkmcnt(8)
v_mfma_f32_16x16x32_bf16 v[252:255], v[12:15], v[36:39], v[252:255]
ds_read_b64_tr_b16 v[24:25], v6 offset:16384
ds_read_b64_tr_b16 v[26:27], v6 offset:16896
ds_read_b64_tr_b16 v[28:29], v6 offset:20480
ds_read_b64_tr_b16 v[30:31], v6 offset:20992
ds_read_b64_tr_b16 v[32:33], v7 offset:16384
ds_read_b64_tr_b16 v[34:35], v7 offset:16896
ds_read_b64_tr_b16 v[36:37], v7 offset:20480
ds_read_b64_tr_b16 v[38:39], v7 offset:20992
v_add_u32 v5, s34, 1
s_mov_b64 exec, 1
ds_write_b32 v3, v5
s_mov_b64 exec, -1
s_waitcnt lgkmcnt(14)
v_mfma_f32_16x16x32_bf16 v[16:19], v[8:11], v[40:43], 0
s_waitcnt lgkmcnt(11)
v_mfma_f32_16x16x32_bf16 v[20:23], v[8:11], v[48:51], 0
v_mfma_f32_16x16x32_bf16 v[16:19], v[12:15], v[44:47], v[16:19]
s_waitcnt lgkmcnt(9)
v_mfma_f32_16x16x32_bf16 v[20:23], v[12:15], v[52:55], v[20:23]
v_mov_b32 v249, v252
v_mov_b32 v252, s69
v_mov_b32 v253, s69
v_mov_b32 v254, s69
v_mov_b32 v255, s69
v_mfma_f32_16x16x32_bf16 v[52:55], v[8:11], v[8:11], 0
s_nop 0
v_mfma_f32_16x16x32_bf16 v[48:51], v[8:11], v[252:255], 0
v_mfma_f32_16x16x32_bf16 v[52:55], v[12:15], v[12:15], v[52:55]
v_mfma_f32_16x16x32_bf16 v[48:51], v[12:15], v[252:255], v[48:51]
s_waitcnt lgkmcnt(7)
v_mfma_f32_16x16x32_bf16 v[40:43], v[8:11], v[24:27], 0
s_waitcnt lgkmcnt(3)
v_mfma_f32_16x16x32_bf16 v[44:47], v[8:11], v[32:35], 0
v_mfma_f32_16x16x32_bf16 v[40:43], v[12:15], v[28:31], v[40:43]
s_waitcnt lgkmcnt(1)
v_mfma_f32_16x16x32_bf16 v[44:47], v[12:15], v[36:39], v[44:47]
v_lshlrev_b32 v6, 3, v0
v_and_b32 v7, 48, v0
v_mov_b32_dpp v248, v16 quad_perm:[0,1,2,3] row_mask:0x2 bank_mask:0xf
v_mov_b32_dpp v249, v20 quad_perm:[0,1,2,3] row_mask:0x2 bank_mask:0xf
s_nop 0
v_mov_b32_dpp v248, v48 quad_perm:[0,1,2,3] row_mask:0x8 bank_mask:0xf
v_mov_b32_dpp v249, v52 quad_perm:[0,1,2,3] row_mask:0x8 bank_mask:0xf
s_nop 0
v_mov_b32_dpp v248, v40 quad_perm:[0,1,2,3] row_mask:0x4 bank_mask:0xf
v_mov_b32_dpp v249, v44 quad_perm:[0,1,2,3] row_mask:0x4 bank_mask:0xf
v_max_u32 v248, 1, v248
v_max_u32 v249, 1, v249
s_cmp_eq_u32 s63, 0
s_cbranch_scc1 fst_40
fsb_41:
buffer_store_dwordx2 v[248:249], v6, s[24:27], s71 offen sc1
s_lshl4_add_u32 s70, s58, s60
s_add_u32 s70, s70, s34
s_cmp_eq_u32 s70, 51
s_cbranch_scc1 fxt_45
fxb_46:
s_add_u32 s73, s72, 4096
s_add_u32 s74, s72, 8192
s_add_u32 s75, s72, 12288
v_lshrrev_b32 v7, 2, v0
v_lshlrev_b32 v7, 7, v7
v_lshl_add_u32 v7, v1, 2, v7
v_lshrrev_b32 v8, 5, v0
v_lshrrev_b32 v9, 4, v0
v_xor_b32 v10, v8, v9
v_and_b32 v10, 1, v10
v_lshl_add_u32 v8, v10, 1, v8
v_and_b32 v10, 15, v0
v_lshlrev_b32 v8, 7, v8
v_lshl_add_u32 v8, v10, 3, v8
v_add_u32 v8, 1280, v8
s_mul_i32 s70, s58, 384
s_lshl_b32 s71, s63, 10
s_add_u32 s70, s70, s71
s_add_u32 s70, s70, 2304
v_lshl_add_u32 v9, v9, 7, s70
v_lshl_add_u32 v9, v10, 2, v9
s_cmp_eq_u32 s63, 0
s_cbranch_scc1 fg_47
fg_48:
poll_49:
buffer_load_dwordx4 v[12:15], v7, s[24:27], s76 offen sc1
pchk_50:
s_waitcnt vmcnt(0)
v_min3_u32 v10, v12, v13, v14
v_min_u32 v10, v10, v15
v_cmp_eq_u32 vcc, 0, v10
s_cbranch_vccz pdone_51
s_sub_u32 s32, s32, 1
s_cmp_gt_i32 s32, 0
s_cbranch_scc1 poll_49
pdone_51:
s_lshr_b32 s70, s33, 7
s_sub_u32 s70, s70, s59
s_mul_i32 s70, s70, s63
s_cmp_eq_u32 s70, 0
s_cbranch_scc0 fng_52
s_lshl1_add_u32 s70, s34, -32
s_add_u32 s35, s70, 15
lw_53:
ds_read_b32 v5, v2 offset:16
s_waitcnt lgkmcnt(0)
v_cmp_gt_i32 vcc, s35, v5
s_cbranch_vccz lwd_54
s_sleep 4
s_sub_u32 s32, s32, 1
s_cmp_gt_i32 s32, 0
s_cbranch_scc1 lw_53
lwd_54:
poll_55:
buffer_load_dwordx2 v[24:25], v6, s[24:27], s72 offen offset:0 sc1
buffer_load_dwordx2 v[26:27], v6, s[24:27], s72 offen offset:1024 sc1
buffer_load_dwordx2 v[28:29], v6, s[24:27], s72 offen offset:2048 sc1
buffer_load_dwordx2 v[30:31], v6, s[24:27], s72 offen offset:3072 sc1
buffer_load_dwordx2 v[32:33], v6, s[24:27], s73 offen offset:0 sc1
buffer_load_dwordx2 v[34:35], v6, s[24:27], s73 offen offset:1024 sc1
buffer_load_dwordx2 v[36:37], v6, s[24:27], s73 offen offset:2048 sc1
buffer_load_dwordx2 v[38:39], v6, s[24:27], s73 offen offset:3072 sc1
buffer_load_dwordx2 v[40:41], v6, s[24:27], s74 offen offset:0 sc1
buffer_load_dwordx2 v[42:43], v6, s[24:27], s74 offen offset:1024 sc1
buffer_load_dwordx2 v[44:45], v6, s[24:27], s74 offen offset:2048 sc1
buffer_load_dwordx2 v[46:47], v6, s[24:27], s74 offen offset:3072 sc1
buffer_load_dwordx2 v[48:49], v6, s[24:27], s75 offen offset:0 sc1
buffer_load_dwordx2 v[50:51], v6, s[24:27], s75 offen offset:1024 sc1
buffer_load_dwordx2 v[52:53], v6, s[24:27], s75 offen offset:2048 sc1
buffer_load_dwordx2 v[54:55], v6, s[24:27], s75 offen offset:3072 sc1
pchk_56:
s_waitcnt vmcnt(14)
v_min3_u32 v10, v24, v25, v26
s_waitcnt vmcnt(13)
v_min3_u32 v10, v10, v27, v28
s_waitcnt vmcnt(12)
v_min3_u32 v10, v10, v29, v30
s_waitcnt vmcnt(11)
v_min3_u32 v10, v10, v31, v32
s_waitcnt vmcnt(10)
v_min3_u32 v10, v10, v33, v34
s_waitcnt vmcnt(9)
v_min3_u32 v10, v10, v35, v36
s_waitcnt vmcnt(8)
v_min3_u32 v10, v10, v37, v38
s_waitcnt vmcnt(7)
v_min3_u32 v10, v10, v39, v40
s_waitcnt vmcnt(6)
v_min3_u32 v10, v10, v41, v42
s_waitcnt vmcnt(5)
v_min3_u32 v10, v10, v43, v44
s_waitcnt vmcnt(4)
v_min3_u32 v10, v10, v45, v46
s_waitcnt vmcnt(3)
v_min3_u32 v10, v10, v47, v48
s_waitcnt vmcnt(2)
v_min3_u32 v10, v10, v49, v50
s_waitcnt vmcnt(1)
v_min3_u32 v10, v10, v51, v52
s_waitcnt vmcnt(0)
v_min3_u32 v10, v10, v53, v54
v_min_u32 v10, v10, v55
v_cmp_eq_u32 vcc, 0, v10
s_cbranch_vccz pdone_57
s_sub_u32 s32, s32, 1
s_cmp_gt_i32 s32, 0
s_cbranch_scc1 poll_55
pdone_57:
v_add_f32 v24, v24, v40
v_add_f32 v25, v25, v41
v_add_f32 v26, v26, v42
v_add_f32 v27, v27, v43
v_add_f32 v28, v28, v44
v_add_f32 v29, v29, v45
v_add_f32 v30, v30, v46
v_add_f32 v31, v31, v47
v_add_f32 v32, v32, v48
v_add_f32 v33, v33, v49
v_add_f32 v34, v34, v50
v_add_f32 v35, v35, v51
v_add_f32 v36, v36, v52
v_add_f32 v37, v37, v53
v_add_f32 v38, v38, v54
v_add_f32 v39, v39, v55
v_add_f32 v24, v24, v32
v_add_f32 v25, v25, v33
v_add_f32 v26, v26, v34
v_add_f32 v27, v27, v35
v_add_f32 v28, v28, v36
v_add_f32 v29, v29, v37
v_add_f32 v30, v30, v38
v_add_f32 v31, v31, v39
v_add_f32 v24, v24, v28
v_add_f32 v25, v25, v29
v_add_f32 v26, v26, v30
v_add_f32 v27, v27, v31
v_add_f32 v24, v24, v26
v_add_f32 v25, v25, v27
s_mov_b32 exec_hi, 0xffff
ds_write2_b32 v9, v24, v25 offset1:16
s_mov_b32 exec_hi, -1
v_mul_f32 v5, 0xba800000, v24
v_mul_f32 v25, 0x3a800000, v25
v_fma_f32 v25, -v5, v5, v25
v_max_f32 v25, 0, v25
v_add_f32 v25, 0x3727c5ac, v25
v_rsq_f32 v24, v25
s_nop 0
v_mul_f32 v25, v5, v24
s_lshl_b32 s70, s59, 7
s_sub_u32 s70, s33, s70
v_lshlrev_b32 v10, 1, v0
v_sub_u32 v10, s70, v10
v_readlane_b32 s70, v24, 48
v_readlane_b32 s71, v25, 48
v_cmp_eq_u32 vcc, 0, v10
s_mov_b64 exec, vcc
v_mov_b32 v12, s70
v_mov_b32 v13, s71
s_mov_b64 exec, -1
v_cmp_eq_u32 vcc, 1, v10
s_mov_b64 exec, vcc
v_mov_b32 v14, s70
v_mov_b32 v15, s71
s_mov_b64 exec, -1
fng_52:
ds_write2_b32 v8, v12, v14 offset1:1
ds_write2_b32 v8, v13, v15 offset0:128 offset1:129
s_add_u32 s71, s34, s63
v_add_u32 v5, s71, 2
s_mov_b64 exec, 1
ds_write_b32 v3, v5
s_mov_b64 exec, -1
s_setprio 0
s_cmp_eq_u32 s63, 0
s_cbranch_scc1 fnw_58
fnw_59:
s_and_b32 s70, s64, 7
s_lshl_b32 s70, s70, 7
s_add_u32 s73, s70, 276480
s_lshl1_add_u32 s72, s70, 272384
s_lshr_b32 s71, s64, 3
s_lshl_b32 s76, s71, 13
s_add_u32 s76, s76, 1048576
s_lshl2_add_u32 s74, s70, s76
s_lshl_b32 s70, s58, 8
s_add_u32 s74, s74, s70
s_add_u32 s75, s74, 4096
s_lshl4_add_u32 s76, s70, s76
v_and_b32 v251, 15, v0
v_lshlrev_b32 v6, 14, v251
v_lshrrev_b32 v252, 4, v0
v_lshl_add_u32 v7, v252, 5, v6
v_lshlrev_b32 v251, 4, v251
s_lshl_b32 s70, s58, 3
v_lshl_add_u32 v253, v252, 1, s70
v_add_u32 v253, v253, v251
v_lshlrev_b32 v254, 5, v252
v_lshl_add_u32 v254, v2, 2, v254
v_and_b32 v255, 7, v0
v_lshl_add_u32 v255, v255, 2, v252
v_lshlrev_b32 v255, 3, v255
s_add_u32 s35, s34, 22
lw_60:
ds_read_b32 v5, v1 offset:0
s_waitcnt lgkmcnt(0)
v_cmp_gt_i32 vcc, s35, v5
s_cbranch_vccz lwd_61
s_sleep 4
s_sub_u32 s32, s32, 1
s_cmp_gt_i32 s32, 0
s_cbranch_scc1 lw_60
lwd_61:
s_setprio 3
s_add_u32 s35, s34, 24
lw_62:
ds_read_b32 v5, v1 offset:0
s_waitcnt lgkmcnt(0)
v_cmp_gt_i32 vcc, s35, v5
s_cbranch_vccz lwd_63
s_sleep 2
s_sub_u32 s32, s32, 1
s_cmp_gt_i32 s32, 0
s_cbranch_scc1 lw_62
lwd_63:
s_mul_i32 s79, s63, 64
s_sub_u32 s79, 32, s79
s_add_u32 s35, s79, 3
tw_64:
ds_read_b32 v5, v2 offset:16
s_waitcnt lgkmcnt(0)
v_cmp_gt_i32 vcc, s35, v5
s_cbranch_vccz twd_65
v_readfirstlane_b32 s54, v5
s_sub_u32 s55, s35, s54
s_cmp_lt_i32 s55, 2
s_cbranch_scc1 tws_66
s_add_u32 s54, s54, 2
s_or_b32 s54, s54, 1
s_cmp_eq_u32 s54, s52
s_cbranch_scc1 tws_66
s_bitcmp1_b32 s54, 4
s_cbranch_scc1 tws_66
s_mov_b32 s52, s54
s_add_u32 s54, s54, s53
s_and_b32 s54, s54, 15
s_mul_i32 s54, s54, 393216
s_add_u32 s54, s54, s56
s_buffer_load_dwordx2 s[46:47], s[48:51], s54 offset:4096
s_buffer_load_dwordx2 s[46:47], s[48:51], s54 offset:10240
s_buffer_load_dwordx2 s[46:47], s[48:51], s54 offset:16384
s_buffer_load_dwordx2 s[46:47], s[48:51], s54 offset:22528
tws_66:
s_sleep 4
s_sub_u32 s32, s32, 1
s_cmp_gt_i32 s32, 0
s_cbranch_scc1 tw_64
twd_65:
s_cmp_eq_u32 s65, 0
s_cbranch_scc0 fnd_68
poll_69:
buffer_load_dwordx2 v[248:249], v6, s[24:27], s73 offen sc1
buffer_load_dwordx4 v[8:11], v7, s[24:27], s72 offen offset:0 sc1
buffer_load_dwordx4 v[12:15], v7, s[24:27], s72 offen offset:16 sc1
buffer_load_dwordx4 v[16:19], v7, s[24:27], s72 offen offset:128 sc1
buffer_load_dwordx4 v[20:23], v7, s[24:27], s72 offen offset:144 sc1
pchk_70:
s_waitcnt vmcnt(3)
v_min3_u32 v5, v248, v249, v8
v_min3_u32 v5, v5, v9, v10
s_waitcnt vmcnt(2)
v_min3_u32 v5, v5, v11, v12
v_min3_u32 v5, v5, v13, v14
s_waitcnt vmcnt(1)
v_min3_u32 v5, v5, v15, v16
v_min3_u32 v5, v5, v17, v18
s_waitcnt vmcnt(0)
v_min3_u32 v5, v5, v19, v20
v_min3_u32 v5, v5, v21, v22
v_min_u32 v5, v5, v23
v_cmp_eq_u32 vcc, 0, v5
s_mov_b64 exec, vcc
s_cbranch_vccz pdone_71
s_sleep 3
s_sub_u32 s32, s32, 1
s_cmp_gt_i32 s32, 0
s_cbranch_scc1 poll_69
pdone_71:
s_mov_b64 exec, -1
v_mfma_f32_16x16x32_bf16 v[24:27], v[8:11], v[56:59], 0
v_mov_b32 v250, v248
v_mfma_f32_16x16x32_bf16 v[28:31], v[8:11], v[60:63], 0
s_nop 0
v_max_f32_dpp v250, v250, v250 row_ror:1 row_mask:0xf bank_mask:0xf
v_mfma_f32_16x16x32_bf16 v[32:35], v[8:11], v[64:67], 0
s_nop 0
v_max_f32_dpp v250, v250, v250 row_ror:2 row_mask:0xf bank_mask:0xf
v_mfma_f32_16x16x32_bf16 v[36:39], v[8:11], v[68:71], 0
s_nop 0
v_max_f32_dpp v250, v250, v250 row_ror:4 row_mask:0xf bank_mask:0xf
v_mfma_f32_16x16x32_bf16 v[40:43], v[8:11], v[72:75], 0
s_nop 0
v_max_f32_dpp v250, v250, v250 row_ror:8 row_mask:0xf bank_mask:0xf
v_mfma_f32_16x16x32_bf16 v[44:47], v[8:11], v[76:79], 0
v_cmp_eq_f32 vcc, v250, v248
v_mfma_f32_16x16x32_bf16 v[48:51], v[8:11], v[80:83], 0
s_ff1_i32_b64 s68, vcc
v_mfma_f32_16x16x32_bf16 v[52:55], v[8:11], v[84:87], 0
s_and_b32 s68, s68, 15
v_mfma_f32_16x16x32_bf16 v[24:27], v[12:15], v[88:91], v[24:27]
v_readlane_b32 s33, v249, s68
v_mfma_f32_16x16x32_bf16 v[28:31], v[12:15], v[92:95], v[28:31]
v_readlane_b32 s67, v248, s68
v_mfma_f32_16x16x32_bf16 v[32:35], v[12:15], v[96:99], v[32:35]
v_add_u32 v5, s34, 4
v_mfma_f32_16x16x32_bf16 v[36:39], v[12:15], v[100:103], v[36:39]
v_mov_b32 v250, s33
v_mfma_f32_16x16x32_bf16 v[40:43], v[12:15], v[104:107], v[40:43]
s_mov_b64 exec, 1
ds_write2_b32 v3, v5, v250 offset1:2
s_mov_b64 exec, -1
v_mfma_f32_16x16x32_bf16 v[44:47], v[12:15], v[108:111], v[44:47]
s_sub_u32 s33, s33, 1
v_mfma_f32_16x16x32_bf16 v[48:51], v[12:15], v[112:115], v[48:51]
s_and_b32 s33, s33, 2047
v_mfma_f32_16x16x32_bf16 v[52:55], v[12:15], v[116:119], v[52:55]
v_mfma_f32_16x16x32_bf16 v[24:27], v[16:19], v[120:123], v[24:27]
v_mfma_f32_16x16x32_bf16 v[28:31], v[16:19], v[124:127], v[28:31]
v_mfma_f32_16x16x32_bf16 v[32:35], v[16:19], v[128:131], v[32:35]
v_mfma_f32_16x16x32_bf16 v[36:39], v[16:19], v[132:135], v[36:39]
v_mfma_f32_16x16x32_bf16 v[40:43], v[16:19], v[136:139], v[40:43]
v_mfma_f32_16x16x32_bf16 v[44:47], v[16:19], v[140:143], v[44:47]
v_mfma_f32_16x16x32_bf16 v[48:51], v[16:19], v[144:147], v[48:51]
v_mfma_f32_16x16x32_bf16 v[52:55], v[16:19], v[148:151], v[52:55]
v_mfma_f32_16x16x32_bf16 v[24:27], v[20:23], v[152:155], v[24:27]
s_and_b32 s70, s68, 12
s_lshl_b32 s70, s70, 2
s_bitcmp1_b32 s68, 1
v_mfma_f32_16x16x32_bf16 v[28:31], v[20:23], v[156:159], v[28:31]
v_mfma_f32_16x16x32_bf16 v[32:35], v[20:23], v[160:163], v[32:35]
v_mfma_f32_16x16x32_bf16 v[36:39], v[20:23], v[164:167], v[36:39]
v_mfma_f32_16x16x32_bf16 v[40:43], v[20:23], v[168:171], v[40:43]
v_mfma_f32_16x16x32_bf16 v[44:47], v[20:23], v[172:175], v[44:47]
v_mfma_f32_16x16x32_bf16 v[48:51], v[20:23], v[176:179], v[48:51]
v_mfma_f32_16x16x32_bf16 v[52:55], v[20:23], v[180:183], v[52:55]
s_cbranch_scc1 fsel_74
fsel_72:
s_bitcmp1_b32 s68, 0
s_cbranch_scc1 fsel_73
v_max_u32 v8, 1, v24
v_max_u32 v9, 1, v28
v_max_u32 v10, 1, v32
v_max_u32 v11, 1, v36
v_max_u32 v12, 1, v40
v_max_u32 v13, 1, v44
v_max_u32 v14, 1, v48
v_max_u32 v15, 1, v52
s_branch fsel_76
fsel_73:
v_max_u32 v8, 1, v25
v_max_u32 v9, 1, v29
v_max_u32 v10, 1, v33
v_max_u32 v11, 1, v37
v_max_u32 v12, 1, v41
v_max_u32 v13, 1, v45
v_max_u32 v14, 1, v49
v_max_u32 v15, 1, v53
s_branch fsel_76
fsel_74:
s_bitcmp1_b32 s68, 0
s_cbranch_scc1 fsel_75
v_max_u32 v8, 1, v26
v_max_u32 v9, 1, v30
v_max_u32 v10, 1, v34
v_max_u32 v11, 1, v38
v_max_u32 v12, 1, v42
v_max_u32 v13, 1, v46
v_max_u32 v14, 1, v50
v_max_u32 v15, 1, v54
s_branch fsel_76
fsel_75:
v_max_u32 v8, 1, v27
v_max_u32 v9, 1, v31
v_max_u32 v10, 1, v35
v_max_u32 v11, 1, v39
v_max_u32 v12, 1, v43
v_max_u32 v13, 1, v47
v_max_u32 v14, 1, v51
v_max_u32 v15, 1, v55
fsel_76:
s_bfm_b64 exec, 16, s70
buffer_store_dwordx4 v[8:11], v251, s[24:27], s74 offen sc1
buffer_store_dwordx4 v[12:15], v251, s[24:27], s75 offen sc1
s_mov_b64 exec, -1
s_and_b32 s70, s64, 7
s_lshl1_add_u32 s70, s70, s58
s_mul_i32 s70, s70, 28
s_add_u32 s70, s70, s71
s_lshl_b32 s70, s70, 8
s_add_u32 s70, s70, 1277952
s_waitcnt vmcnt(0)
s_mul_i32 s79, s63, 64
s_sub_u32 s79, 32, s79
s_add_u32 s35, s79, 7
tw_78:
ds_read_b32 v5, v2 offset:16
s_waitcnt lgkmcnt(0)
v_cmp_gt_i32 vcc, s35, v5
s_cbranch_vccz twd_79
v_readfirstlane_b32 s54, v5
s_sub_u32 s55, s35, s54
s_cmp_lt_i32 s55, 2
s_cbranch_scc1 tws_80
s_add_u32 s54, s54, 2
s_or_b32 s54, s54, 1
s_cmp_eq_u32 s54, s52
s_cbranch_scc1 tws_80
s_bitcmp1_b32 s54, 4
s_cbranch_scc1 tws_80
s_mov_b32 s52, s54
s_add_u32 s54, s54, s53
s_and_b32 s54, s54, 15
s_mul_i32 s54, s54, 393216
s_add_u32 s54, s54, s56
s_buffer_load_dwordx2 s[46:47], s[48:51], s54 offset:4096
s_buffer_load_dwordx2 s[46:47], s[48:51], s54 offset:10240
s_buffer_load_dwordx2 s[46:47], s[48:51], s54 offset:16384
s_buffer_load_dwordx2 s[46:47], s[48:51], s54 offset:22528
tws_80:
s_sleep 4
s_sub_u32 s32, s32, 1
s_cmp_gt_i32 s32, 0
s_cbranch_scc1 tw_78
twd_79:
poll_81:
buffer_load_dwordx4 v[24:27], v4, s[24:27], s76 offen offset:0 sc1
buffer_load_dwordx4 v[28:31], v4, s[24:27], s76 offen offset:1024 sc1
buffer_load_dwordx4 v[32:35], v4, s[24:27], s76 offen offset:2048 sc1
buffer_load_dwordx4 v[36:39], v4, s[24:27], s76 offen offset:3072 sc1
pchk_82:
s_waitcnt vmcnt(3)
v_min3_u32 v5, v24, v25, v26
s_waitcnt vmcnt(2)
v_min3_u32 v5, v5, v27, v28
v_min3_u32 v5, v5, v29, v30
s_waitcnt vmcnt(1)
v_min3_u32 v5, v5, v31, v32
v_min3_u32 v5, v5, v33, v34
s_waitcnt vmcnt(0)
v_min3_u32 v5, v5, v35, v36
v_min3_u32 v5, v5, v37, v38
v_min_u32 v5, v5, v39
v_cmp_eq_u32 vcc, 0, v5
s_cbranch_vccz pdone_83
s_sub_u32 s32, s32, 1
s_cmp_gt_i32 s32, 0
s_cbranch_scc1 poll_81
pdone_83:
v_add_f32 v24, v24, v32
v_add_f32 v25, v25, v33
v_add_f32 v26, v26, v34
v_add_f32 v27, v27, v35
v_add_f32 v28, v28, v36
v_add_f32 v29, v29, v37
v_add_f32 v30, v30, v38
v_add_f32 v31, v31, v39
fj_77:
v_add_f32 v24, v24, v28
v_add_f32 v25, v25, v29
v_add_f32 v26, v26, v30
v_add_f32 v27, v27, v31
s_nop 0
v_permlane32_swap_b32 v24, v26
v_permlane32_swap_b32 v25, v27
v_add_f32 v24, v24, v26
v_add_f32 v25, v25, v27
s_nop 1
v_permlane16_swap_b32 v24, v25
v_mul_f32 v26, 0xbfb8aa3b, v24
v_exp_f32 v26, v26
v_mul_f32 v24, v24, v25
v_add_f32 v26, 1.0, v26
v_rcp_f32 v26, v26
v_add_u32 v5, s34, 5
v_mul_f32 v24, v24, v26
v_cvt_pk_bf16_f32 v24, v24, v24
ds_write_b16 v253, v24 offset:512
s_mov_b64 exec, 1
ds_write_b32 v3, v5
s_mov_b64 exec, -1
s_add_u32 s35, s34, 5
poll_84:
ds_read_b32 v5, v2 offset:24
ds_read_b128 v[8:11], v254 offset:512
ds_read_b128 v[12:15], v254 offset:640
pchk_85:
s_waitcnt lgkmcnt(2)
v_cmp_gt_i32 vcc, s35, v5
s_cbranch_vccz pdone_86
s_sleep 1
s_sub_u32 s32, s32, 1
s_cmp_gt_i32 s32, 0
s_cbranch_scc1 poll_84
pdone_86:
s_waitcnt lgkmcnt(1)
v_mfma_f32_16x16x32_bf16 v[24:27], v[8:11], v[184:187], 0
v_mfma_f32_16x16x32_bf16 v[28:31], v[8:11], v[188:191], 0
v_mfma_f32_16x16x32_bf16 v[32:35], v[8:11], v[192:195], 0
v_mfma_f32_16x16x32_bf16 v[36:39], v[8:11], v[196:199], 0
v_mfma_f32_16x16x32_bf16 v[40:43], v[8:11], v[200:203], 0
v_mfma_f32_16x16x32_bf16 v[44:47], v[8:11], v[204:207], 0
v_mfma_f32_16x16x32_bf16 v[48:51], v[8:11], v[208:211], 0
v_mfma_f32_16x16x32_bf16 v[52:55], v[8:11], v[212:215], 0
s_waitcnt lgkmcnt(0)
v_mfma_f32_16x16x32_bf16 v[24:27], v[12:15], v[216:219], v[24:27]
v_mfma_f32_16x16x32_bf16 v[28:31], v[12:15], v[220:223], v[28:31]
v_mfma_f32_16x16x32_bf16 v[32:35], v[12:15], v[224:227], v[32:35]
v_mfma_f32_16x16x32_bf16 v[36:39], v[12:15], v[228:231], v[36:39]
v_mfma_f32_16x16x32_bf16 v[40:43], v[12:15], v[232:235], v[40:43]
v_mfma_f32_16x16x32_bf16 v[44:47], v[12:15], v[236:239], v[44:47]
v_mfma_f32_16x16x32_bf16 v[48:51], v[12:15], v[240:243], v[48:51]
v_mfma_f32_16x16x32_bf16 v[52:55], v[12:15], v[244:247], v[52:55]
s_nop 0
v_add_f32_dpp v16, v25, v24 row_ror:8 row_mask:0x1 bank_mask:0xf
v_add_f32_dpp v17, v29, v28 row_ror:8 row_mask:0x1 bank_mask:0xf
s_nop 0
v_add_f32_dpp v16, v33, v32 row_ror:8 row_mask:0x2 bank_mask:0xf
v_add_f32_dpp v17, v37, v36 row_ror:8 row_mask:0x2 bank_mask:0xf
s_nop 0
v_add_f32_dpp v16, v41, v40 row_ror:8 row_mask:0x4 bank_mask:0xf
v_add_f32_dpp v17, v45, v44 row_ror:8 row_mask:0x4 bank_mask:0xf
s_nop 0
v_add_f32_dpp v16, v49, v48 row_ror:8 row_mask:0x8 bank_mask:0xf
v_add_f32_dpp v17, v53, v52 row_ror:8 row_mask:0x8 bank_mask:0xf
v_max_u32 v16, 1, v16
v_max_u32 v17, 1, v17
s_mov_b32 exec_lo, 0x00ff00ff
s_mov_b32 exec_hi, 0x00ff00ff
buffer_store_dwordx2 v[16:17], v255, s[24:27], s70 offen sc1
s_mov_b64 exec, -1
fnd_67:
s_sub_u32 s70, s60, 3
s_mul_i32 s70, s70, s63
s_or_b32 s70, s70, s58
s_cbranch_scc1 fnr_87
s_mul_i32 s72, s59, 7168
s_add_u32 s72, s72, 1277952
s_add_u32 s73, s72, 4096
s_lshl_b32 s70, s68, 6
s_add_u32 s70, s70, s59
s_lshl_b32 s70, s70, 8
s_add_u32 s76, s70, 262144
v_mov_b32 v12, s67
v_mul_f32 v12, 0xbfb8aa3b, v12
v_exp_f32 v12, v12
v_lshl_add_u32 v6, v252, 2, v251
v_add_f32 v12, 1.0, v12
v_rcp_f32 v12, v12
v_lshrrev_b32 v7, 1, v6
s_lshl4_add_u32 s70, s33, s59
s_lshl_b32 s70, s70, 7
v_and_b32 v8, 0x46, v7
v_lshl_add_u32 v8, v1, 2, v8
v_and_b32 v9, 4, v0
v_lshl_add_u32 v8, v9, 1, v8
s_waitcnt vmcnt(0)
s_cmp_gt_u32 s65, s63
s_cbranch_scc1 fpre_90
fpre_91:
s_mul_i32 s79, s63, 64
s_sub_u32 s79, 32, s79
s_add_u32 s35, s79, 11
tw_92:
ds_read_b32 v5, v2 offset:16
s_waitcnt lgkmcnt(0)
v_cmp_gt_i32 vcc, s35, v5
s_cbranch_vccz twd_93
v_readfirstlane_b32 s54, v5
s_sub_u32 s55, s35, s54
s_cmp_lt_i32 s55, 2
s_cbranch_scc1 tws_94
s_add_u32 s54, s54, 2
s_or_b32 s54, s54, 1
s_cmp_eq_u32 s54, s52
s_cbranch_scc1 tws_94
s_bitcmp1_b32 s54, 4
s_cbranch_scc1 tws_94
s_mov_b32 s52, s54
s_add_u32 s54, s54, s53
s_and_b32 s54, s54, 15
s_mul_i32 s54, s54, 393216
s_add_u32 s54, s54, s56
s_buffer_load_dwordx2 s[46:47], s[48:51], s54 offset:4096
s_buffer_load_dwordx2 s[46:47], s[48:51], s54 offset:10240
s_buffer_load_dwordx2 s[46:47], s[48:51], s54 offset:16384
s_buffer_load_dwordx2 s[46:47], s[48:51], s54 offset:22528
tws_94:
s_sleep 4
s_sub_u32 s32, s32, 1
s_cmp_gt_i32 s32, 0
s_cbranch_scc1 tw_92
twd_93:
poll_95:
buffer_load_dword v52, v6, s[24:27], s76 offen sc1
buffer_load_dwordx4 v[24:27], v4, s[24:27], s72 offen offset:0 sc1
buffer_load_dwordx4 v[28:31], v4, s[24:27], s72 offen offset:1024 sc1
buffer_load_dwordx4 v[32:35], v4, s[24:27], s72 offen offset:2048 sc1
buffer_load_dwordx4 v[36:39], v4, s[24:27], s72 offen offset:3072 sc1
buffer_load_dwordx4 v[40:43], v4, s[24:27], s73 offen offset:0 sc1
buffer_load_dwordx4 v[44:47], v4, s[24:27], s73 offen offset:1024 sc1
buffer_load_dwordx4 v[48:51], v4, s[24:27], s73 offen offset:2048 sc1
pchk_96:
s_waitcnt vmcnt(6)
v_min3_u32 v5, v24, v25, v26
s_waitcnt vmcnt(5)
v_min3_u32 v5, v5, v27, v28
v_min3_u32 v5, v5, v29, v30
s_waitcnt vmcnt(4)
v_min3_u32 v5, v5, v31, v32
v_min3_u32 v5, v5, v33, v34
s_waitcnt vmcnt(3)
v_min3_u32 v5, v5, v35, v36
v_min3_u32 v5, v5, v37, v38
s_waitcnt vmcnt(2)
v_min3_u32 v5, v5, v39, v40
v_min3_u32 v5, v5, v41, v42
s_waitcnt vmcnt(1)
v_min3_u32 v5, v5, v43, v44
v_min3_u32 v5, v5, v45, v46
s_waitcnt vmcnt(0)
v_min3_u32 v5, v5, v47, v48
v_min3_u32 v5, v5, v49, v50
v_min3_u32 v5, v5, v51, v52
v_cmp_eq_u32 vcc, 0, v5
s_cbranch_vccz pdone_97
s_sub_u32 s32, s32, 1
s_cmp_gt_i32 s32, 0
s_cbranch_scc1 poll_95
pdone_97:
v_add_f32 v24, v24, v40
v_add_f32 v25, v25, v41
v_add_f32 v26, v26, v42
v_add_f32 v27, v27, v43
v_add_f32 v28, v28, v44
v_add_f32 v29, v29, v45
v_add_f32 v30, v30, v46
v_add_f32 v31, v31, v47
v_add_f32 v32, v32, v48
v_add_f32 v33, v33, v49
v_add_f32 v34, v34, v50
v_add_f32 v35, v35, v51
fj_89:
v_add_f32 v24, v24, v32
v_add_f32 v25, v25, v33
v_add_f32 v26, v26, v34
v_add_f32 v27, v27, v35
v_add_f32 v28, v28, v36
v_add_f32 v29, v29, v37
v_add_f32 v30, v30, v38
v_add_f32 v31, v31, v39
v_add_f32 v24, v24, v28
v_add_f32 v25, v25, v29
v_add_f32 v26, v26, v30
v_add_f32 v27, v27, v31
s_nop 0
v_permlane32_swap_b32 v24, v26
v_permlane32_swap_b32 v25, v27
v_add_f32 v24, v24, v26
v_add_f32 v25, v25, v27
s_nop 1
v_permlane16_swap_b32 v24, v25
v_add_f32 v24, v24, v25
v_fma_f32 v24, v24, v12, v52
v_cvt_pk_bf16_f32 v24, v24, v24
s_cmp_eq_u32 s63, 0
s_cbranch_scc1 fl0_88
buffer_store_short v24, v7, s[28:31], s70 offen
s_branch L_end
fl0_88:
ds_write_b16 v8, v24 offset:384
fnr_87:
s_cmp_eq_u32 s63, 0
s_cbranch_scc0 L_end
v_add_u32 v5, s34, 6
s_mov_b64 exec, 1
ds_write_b32 v3, v5
s_mov_b64 exec, -1
s_mul_i32 s79, s63, 64
s_sub_u32 s79, 32, s79
s_add_u32 s35, s79, 11
tw_98:
ds_read_b32 v5, v2 offset:16
s_waitcnt lgkmcnt(0)
v_cmp_gt_i32 vcc, s35, v5
s_cbranch_vccz twd_99
v_readfirstlane_b32 s54, v5
s_sub_u32 s55, s35, s54
s_cmp_lt_i32 s55, 2
s_cbranch_scc1 tws_100
s_add_u32 s54, s54, 2
s_or_b32 s54, s54, 1
s_cmp_eq_u32 s54, s52
s_cbranch_scc1 tws_100
s_bitcmp1_b32 s54, 4
s_cbranch_scc1 tws_100
s_mov_b32 s52, s54
s_add_u32 s54, s54, s53
s_and_b32 s54, s54, 15
s_mul_i32 s54, s54, 393216
s_add_u32 s54, s54, s56
s_buffer_load_dwordx2 s[46:47], s[48:51], s54 offset:4096
s_buffer_load_dwordx2 s[46:47], s[48:51], s54 offset:10240
s_buffer_load_dwordx2 s[46:47], s[48:51], s54 offset:16384
s_buffer_load_dwordx2 s[46:47], s[48:51], s54 offset:22528
tws_100:
s_sleep 4
s_sub_u32 s32, s32, 1
s_cmp_gt_i32 s32, 0
s_cbranch_scc1 tw_98
twd_99:
v_and_b32 v6, 48, v0
s_add_u32 s35, s34, 6
poll_101:
ds_read_b32 v5, v2 offset:24
ds_read_b128 v[8:11], v6 offset:384
ds_read_b128 v[12:15], v6 offset:448
pchk_102:
s_waitcnt lgkmcnt(2)
v_cmp_gt_i32 vcc, s35, v5
s_cbranch_vccz pdone_103
s_sleep 1
s_sub_u32 s32, s32, 1
s_cmp_gt_i32 s32, 0
s_cbranch_scc1 poll_101
pdone_103:
s_mov_b32 s63, 1
s_mov_b32 s34, 32
s_add_u32 s24, s24, 1409024
s_addc_u32 s25, s25, 0
s_mov_b32 s26, 1409024
s_mov_b32 s70, 131072
s_mov_b32 s79, 34
s_branch ftop_42
fxt_45:
v_max_u32 v8, 1, v8
v_max_u32 v9, 1, v9
v_max_u32 v10, 1, v10
v_max_u32 v11, 1, v11
v_max_u32 v12, 1, v12
v_max_u32 v13, 1, v13
v_max_u32 v14, 1, v14
v_max_u32 v15, 1, v15
s_mov_b32 exec_lo, 0x10001
s_mov_b32 exec_hi, 0x10001
buffer_store_dwordx4 v[8:11], v7, s[20:23], s73 offen offset:0 sc1
buffer_store_dwordx4 v[12:15], v7, s[20:23], s73 offen offset:64 sc1
s_mov_b64 exec, -1
s_branch fxb_46
fst_40:
s_lshl1_add_u32 s70, s78, s58
s_lshl_b32 s70, s70, 13
v_bfe_u32 v8, v0, 2, 2
v_lshl_add_u32 v8, v8, 9, v7
v_add_u32 v8, v8, v1
v_lshlrev_b32 v8, 2, v8
buffer_load_dwordx4 v[24:27], v8, s[8:11], s70 offen offset:0
buffer_load_dwordx4 v[28:31], v8, s[8:11], s70 offen offset:256
buffer_load_dwordx4 v[32:35], v8, s[8:11], s70 offen offset:512
buffer_load_dwordx4 v[36:39], v8, s[8:11], s70 offen offset:768
buffer_load_dwordx4 v[40:43], v8, s[8:11], s70 offen offset:1024
buffer_load_dwordx4 v[44:47], v8, s[8:11], s70 offen offset:1280
buffer_load_dwordx4 v[48:51], v8, s[8:11], s70 offen offset:1536
buffer_load_dwordx4 v[52:55], v8, s[8:11], s70 offen offset:1792
v_lshlrev_b32 v9, 4, v1
s_waitcnt vmcnt(7)
v_mfma_f32_16x16x32_bf16 v[16:19], v[24:27], v[252:255], 0
v_mfma_f32_16x16x32_bf16 v[20:23], v[24:27], v[24:27], 0
s_waitcnt vmcnt(6)
v_mfma_f32_16x16x32_bf16 v[16:19], v[28:31], v[252:255], v[16:19]
v_mfma_f32_16x16x32_bf16 v[20:23], v[28:31], v[28:31], v[20:23]
s_waitcnt vmcnt(5)
v_mfma_f32_16x16x32_bf16 v[16:19], v[32:35], v[252:255], v[16:19]
v_mfma_f32_16x16x32_bf16 v[20:23], v[32:35], v[32:35], v[20:23]
s_waitcnt vmcnt(4)
v_mfma_f32_16x16x32_bf16 v[16:19], v[36:39], v[252:255], v[16:19]
v_mfma_f32_16x16x32_bf16 v[20:23], v[36:39], v[36:39], v[20:23]
s_waitcnt vmcnt(3)
v_mfma_f32_16x16x32_bf16 v[16:19], v[40:43], v[252:255], v[16:19]
v_mfma_f32_16x16x32_bf16 v[20:23], v[40:43], v[40:43], v[20:23]
s_waitcnt vmcnt(2)
v_mfma_f32_16x16x32_bf16 v[16:19], v[44:47], v[252:255], v[16:19]
v_mfma_f32_16x16x32_bf16 v[20:23], v[44:47], v[44:47], v[20:23]
s_waitcnt vmcnt(1)
v_mfma_f32_16x16x32_bf16 v[16:19], v[48:51], v[252:255], v[16:19]
v_mfma_f32_16x16x32_bf16 v[20:23], v[48:51], v[48:51], v[20:23]
s_waitcnt vmcnt(0)
v_mfma_f32_16x16x32_bf16 v[16:19], v[52:55], v[252:255], v[16:19]
v_mfma_f32_16x16x32_bf16 v[20:23], v[52:55], v[52:55], v[20:23]
s_nop 6
v_add_f32 v16, v16, v18
v_add_f32 v17, v17, v19
v_add_f32 v16, v16, v17
s_nop 0
v_mov_b32_dpp v17, v20 quad_perm:[0,0,0,0] row_mask:0xf bank_mask:0xf
s_nop 1
v_add_f32_dpp v17, v21, v17 quad_perm:[1,1,1,1] row_mask:0xf bank_mask:0xf
s_nop 1
v_add_f32_dpp v17, v22, v17 quad_perm:[2,2,2,2] row_mask:0xf bank_mask:0xf
s_nop 1
v_add_f32_dpp v17, v23, v17 quad_perm:[3,3,3,3] row_mask:0xf bank_mask:0xf
v_mul_f32 v5, 0xba800000, v16
v_mul_f32 v17, 0x3a800000, v17
v_fma_f32 v17, -v5, v5, v17
v_max_f32 v17, 0, v17
v_add_f32 v17, 0x3727c5ac, v17
v_rsq_f32 v16, v17
s_nop 0
v_mul_f32 v17, v5, v16
v_max_u32 v17, 1, v17
s_lshl_b32 s70, s60, 7
s_add_u32 s70, s70, s76
s_lshl_b32 s73, s58, 5
s_add_u32 s70, s70, s73
v_lshrrev_b32 v7, 1, v7
s_add_u32 s35, s34, 5
tw_104:
ds_read_b32 v5, v2 offset:16
s_waitcnt lgkmcnt(0)
v_cmp_gt_i32 vcc, s35, v5
s_cbranch_vccz twd_105
v_readfirstlane_b32 s54, v5
s_sub_u32 s55, s35, s54
s_cmp_lt_i32 s55, 2
s_cbranch_scc1 tws_106
s_add_u32 s54, s54, 2
s_or_b32 s54, s54, 1
s_cmp_eq_u32 s54, s52
s_cbranch_scc1 tws_106
s_bitcmp1_b32 s54, 4
s_cbranch_scc1 tws_106
s_mov_b32 s52, s54
s_add_u32 s54, s54, s53
s_and_b32 s54, s54, 15
s_mul_i32 s54, s54, 393216
s_add_u32 s54, s54, s56
s_buffer_load_dwordx2 s[46:47], s[48:51], s54 offset:4096
s_buffer_load_dwordx2 s[46:47], s[48:51], s54 offset:10240
s_buffer_load_dwordx2 s[46:47], s[48:51], s54 offset:16384
s_buffer_load_dwordx2 s[46:47], s[48:51], s54 offset:22528
tws_106:
s_sleep 4
s_sub_u32 s32, s32, 1
s_cmp_gt_i32 s32, 0
s_cbranch_scc1 tw_104
twd_105:
poll_107:
buffer_load_dword v12, v9, s[4:7], 0 offen sc1
pchk_108:
s_waitcnt vmcnt(0)
v_cmp_gt_u32 vcc, 64, v12
s_cbranch_vccz pdone_109
s_sleep 16
s_sub_u32 s32, s32, 1
s_cmp_gt_i32 s32, 0
s_cbranch_scc1 poll_107
pdone_109:
s_mov_b32 exec_lo, 0x00100001
s_mov_b32 exec_hi, 0x10000100
buffer_store_dwordx2 v[16:17], v7, s[24:27], s70 offen sc1
s_getreg_b32 s73, hwreg(HW_REG_XCC_ID)
s_mov_b64 exec, 1
v_add_u32 v12, s73, 1
buffer_store_dword v12, off, s[24:27], s70 offset:64 sc1
s_mov_b64 exec, -1
s_branch fsb_41
fg_47:
s_lshl1_add_u32 s35, s2, s58
s_lshl_b32 s35, s35, 12
s_add_u32 s44, s40, s35
s_addc_u32 s45, s41, 0
s_mov_b32 s35, 4
ft_110:
s_load_dwordx2 s[42:43], s[44:45], 60
s_load_dwordx2 s[42:43], s[44:45], 188
s_load_dwordx2 s[42:43], s[44:45], 316
s_load_dwordx2 s[42:43], s[44:45], 444
s_load_dwordx2 s[42:43], s[44:45], 572
s_load_dwordx2 s[42:43], s[44:45], 700
s_load_dwordx2 s[42:43], s[44:45], 828
s_load_dwordx2 s[42:43], s[44:45], 956
s_add_u32 s44, s44, 1024
s_addc_u32 s45, s45, 0
s_sub_u32 s35, s35, 1
s_cmp_eq_u32 s35, 0
s_cbranch_scc0 ft_110
v_lshrrev_b32 v250, 3, v0
v_mul_u32_u24 v250, 16256, v250
v_add_u32 v250, v250, v4
s_add_u32 s35, s66, 131072
buffer_load_dwordx4 v[184:187], v250, s[12:15], s35 offen nt
s_add_u32 s35, s66, 133120
buffer_load_dwordx4 v[188:191], v250, s[12:15], s35 offen nt
s_add_u32 s35, s66, 135168
buffer_load_dwordx4 v[192:195], v250, s[12:15], s35 offen nt
s_add_u32 s35, s66, 137216
buffer_load_dwordx4 v[196:199], v250, s[12:15], s35 offen nt
s_add_u32 s35, s66, 139264
buffer_load_dwordx4 v[200:203], v250, s[12:15], s35 offen nt
s_add_u32 s35, s66, 141312
buffer_load_dwordx4 v[204:207], v250, s[12:15], s35 offen nt
s_add_u32 s35, s66, 143360
buffer_load_dwordx4 v[208:211], v250, s[12:15], s35 offen nt
s_add_u32 s35, s66, 145408
buffer_load_dwordx4 v[212:215], v250, s[12:15], s35 offen nt
v_lshrrev_b32 v250, 3, v0
v_mul_u32_u24 v250, 16256, v250
v_add_u32 v250, v250, v4
s_add_u32 s35, s66, 0
buffer_load_dwordx4 v[152:155], v250, s[12:15], s35 offen nt
s_add_u32 s35, s66, 2048
buffer_load_dwordx4 v[156:159], v250, s[12:15], s35 offen nt
s_add_u32 s35, s66, 4096
buffer_load_dwordx4 v[160:163], v250, s[12:15], s35 offen nt
s_add_u32 s35, s66, 6144
buffer_load_dwordx4 v[164:167], v250, s[12:15], s35 offen nt
s_add_u32 s35, s66, 8192
buffer_load_dwordx4 v[168:171], v250, s[12:15], s35 offen nt
s_add_u32 s35, s66, 10240
buffer_load_dwordx4 v[172:175], v250, s[12:15], s35 offen nt
s_add_u32 s35, s66, 12288
buffer_load_dwordx4 v[176:179], v250, s[12:15], s35 offen nt
s_add_u32 s35, s66, 14336
buffer_load_dwordx4 v[180:183], v250, s[12:15], s35 offen nt
s_add_u32 s35, s34, 10
tw_111:
ds_read_b32 v5, v2 offset:16
s_waitcnt lgkmcnt(0)
v_cmp_gt_i32 vcc, s35, v5
s_cbranch_vccz twd_112
v_readfirstlane_b32 s54, v5
s_sub_u32 s55, s35, s54
s_cmp_lt_i32 s55, 2
s_cbranch_scc1 tws_113
s_add_u32 s54, s54, 2
s_or_b32 s54, s54, 1
s_cmp_eq_u32 s54, s52
s_cbranch_scc1 tws_113
s_bitcmp1_b32 s54, 4
s_cbranch_scc1 tws_113
s_mov_b32 s52, s54
s_add_u32 s54, s54, s53
s_and_b32 s54, s54, 15
s_mul_i32 s54, s54, 393216
s_add_u32 s54, s54, s56
s_buffer_load_dwordx2 s[46:47], s[48:51], s54 offset:4096
s_buffer_load_dwordx2 s[46:47], s[48:51], s54 offset:10240
s_buffer_load_dwordx2 s[46:47], s[48:51], s54 offset:16384
s_buffer_load_dwordx2 s[46:47], s[48:51], s54 offset:22528
tws_113:
s_sleep 4
s_sub_u32 s32, s32, 1
s_cmp_gt_i32 s32, 0
s_cbranch_scc1 tw_111
twd_112:
v_and_b32 v10, 0x7a0, v7
s_getreg_b32 s70, hwreg(HW_REG_XCC_ID)
s_add_u32 s70, s70, 1
poll_114:
buffer_load_dword v12, v10, s[24:27], s76 offen offset:64 sc1
pchk_115:
s_waitcnt vmcnt(0)
v_cmp_eq_u32 vcc, 0, v12
s_cbranch_vccz pdone_116
s_sub_u32 s32, s32, 1
s_cmp_gt_i32 s32, 0
s_cbranch_scc1 poll_114
pdone_116:
v_cmp_eq_u32 vcc, s70, v12
s_cmp_eq_u64 vcc, exec
s_cselect_b32 s70, 1, 0
v_mov_b32 v12, s70
v_mov_b32 v10, 0
s_mov_b64 exec, 1
ds_write_b32 v10, v12 offset:56
s_mov_b64 exec, -1
s_branch fg_48
fnw_58:
s_waitcnt lgkmcnt(0)
v_mov_b32 v252, 0
v_mov_b32 v253, 0
v_mov_b32 v254, 0
v_mov_b32 v255, 0
s_mul_i32 s42, s58, 1409024
s_mul_i32 s35, s78, 2048
s_add_u32 s35, s35, s42
s_add_u32 s35, s35, 524288
buffer_store_dwordx4 v[252:255], v4, s[24:27], s35 offen offset:0 sc1
buffer_store_dwordx4 v[252:255], v4, s[24:27], s35 offen offset:1024 sc1
s_mul_i32 s35, s78, 1408
s_add_u32 s35, s35, s42
s_add_u32 s35, s35, 1048576
buffer_store_dwordx4 v[252:255], v4, s[24:27], s35 offen offset:0 sc1
buffer_store_dwordx4 v[252:255], v4, s[24:27], s35 offen offset:384 sc1
s_lshl_b32 s35, s78, 10
s_add_u32 s35, s35, 1409024
s_cmp_eq_u32 s58, 1
s_cselect_b64 exec, -1, 0
buffer_store_dwordx4 v[252:255], v4, s[24:27], s35 offen offset:0 sc1
s_add_u32 s35, s35, 262144
buffer_store_dwordx4 v[252:255], v4, s[24:27], s35 offen offset:0 sc1
s_mov_b64 exec, -1
s_waitcnt vmcnt(0)
v_add_u32 v5, s34, 3
s_mov_b64 exec, 1
ds_write_b32 v3, v5
s_mov_b64 exec, -1
s_add_u32 s35, s34, 17
tw_117:
ds_read_b32 v5, v2 offset:16
s_waitcnt lgkmcnt(0)
v_cmp_gt_i32 vcc, s35, v5
s_cbranch_vccz twd_118
v_readfirstlane_b32 s54, v5
s_sub_u32 s55, s35, s54
s_cmp_lt_i32 s55, 2
s_cbranch_scc1 tws_119
s_add_u32 s54, s54, 2
s_or_b32 s54, s54, 1
s_cmp_eq_u32 s54, s52
s_cbranch_scc1 tws_119
s_bitcmp1_b32 s54, 4
s_cbranch_scc1 tws_119
s_mov_b32 s52, s54
s_add_u32 s54, s54, s53
s_and_b32 s54, s54, 15
s_mul_i32 s54, s54, 393216
s_add_u32 s54, s54, s56
s_buffer_load_dwordx2 s[46:47], s[48:51], s54 offset:4096
s_buffer_load_dwordx2 s[46:47], s[48:51], s54 offset:10240
s_buffer_load_dwordx2 s[46:47], s[48:51], s54 offset:16384
s_buffer_load_dwordx2 s[46:47], s[48:51], s54 offset:22528
tws_119:
s_sleep 4
s_sub_u32 s32, s32, 1
s_cmp_gt_i32 s32, 0
s_cbranch_scc1 tw_117
twd_118:
v_lshrrev_b32 v250, 4, v0
v_mul_u32_u24 v250, 28416, v250
v_add_u32 v250, v250, v4
s_add_u32 s35, s77, 688128
buffer_load_dwordx4 v[120:123], v250, s[16:19], s35 offen nt
s_add_u32 s35, s77, 695296
buffer_load_dwordx4 v[124:127], v250, s[16:19], s35 offen nt
s_add_u32 s35, s77, 702464
buffer_load_dwordx4 v[128:131], v250, s[16:19], s35 offen nt
s_add_u32 s35, s77, 709632
buffer_load_dwordx4 v[132:135], v250, s[16:19], s35 offen nt
s_add_u32 s35, s77, 802816
buffer_load_dwordx4 v[136:139], v250, s[16:19], s35 offen nt
s_add_u32 s35, s77, 809984
buffer_load_dwordx4 v[140:143], v250, s[16:19], s35 offen nt
s_add_u32 s35, s77, 817152
buffer_load_dwordx4 v[144:147], v250, s[16:19], s35 offen nt
s_add_u32 s35, s77, 824320
buffer_load_dwordx4 v[148:151], v250, s[16:19], s35 offen nt
v_lshrrev_b32 v250, 4, v0
v_mul_u32_u24 v250, 28416, v250
v_add_u32 v250, v250, v4
s_add_u32 s35, s77, 458752
buffer_load_dwordx4 v[88:91], v250, s[16:19], s35 offen nt
s_add_u32 s35, s77, 465920
buffer_load_dwordx4 v[92:95], v250, s[16:19], s35 offen nt
s_add_u32 s35, s77, 473088
buffer_load_dwordx4 v[96:99], v250, s[16:19], s35 offen nt
s_add_u32 s35, s77, 480256
buffer_load_dwordx4 v[100:103], v250, s[16:19], s35 offen nt
s_add_u32 s35, s77, 573440
buffer_load_dwordx4 v[104:107], v250, s[16:19], s35 offen nt
s_add_u32 s35, s77, 580608
buffer_load_dwordx4 v[108:111], v250, s[16:19], s35 offen nt
s_add_u32 s35, s77, 587776
buffer_load_dwordx4 v[112:115], v250, s[16:19], s35 offen nt
s_add_u32 s35, s77, 594944
buffer_load_dwordx4 v[116:119], v250, s[16:19], s35 offen nt
v_lshrrev_b32 v250, 4, v0
v_mul_u32_u24 v250, 28416, v250
v_add_u32 v250, v250, v4
s_add_u32 s35, s77, 229376
buffer_load_dwordx4 v[56:59], v250, s[16:19], s35 offen nt
s_add_u32 s35, s77, 236544
buffer_load_dwordx4 v[60:63], v250, s[16:19], s35 offen nt
s_add_u32 s35, s77, 243712
buffer_load_dwordx4 v[64:67], v250, s[16:19], s35 offen nt
s_add_u32 s35, s77, 250880
buffer_load_dwordx4 v[68:71], v250, s[16:19], s35 offen nt
s_add_u32 s35, s77, 344064
buffer_load_dwordx4 v[72:75], v250, s[16:19], s35 offen nt
s_add_u32 s35, s77, 351232
buffer_load_dwordx4 v[76:79], v250, s[16:19], s35 offen nt
s_add_u32 s35, s77, 358400
buffer_load_dwordx4 v[80:83], v250, s[16:19], s35 offen nt
s_add_u32 s35, s77, 365568
buffer_load_dwordx4 v[84:87], v250, s[16:19], s35 offen nt
v_lshrrev_b32 v250, 4, v0
v_mul_u32_u24 v250, 28416, v250
v_add_u32 v250, v250, v4
s_add_u32 s35, s77, 0
buffer_load_dwordx4 v[24:27], v250, s[16:19], s35 offen nt
s_add_u32 s35, s77, 7168
buffer_load_dwordx4 v[28:31], v250, s[16:19], s35 offen nt
s_add_u32 s35, s77, 14336
buffer_load_dwordx4 v[32:35], v250, s[16:19], s35 offen nt
s_add_u32 s35, s77, 21504
buffer_load_dwordx4 v[36:39], v250, s[16:19], s35 offen nt
s_add_u32 s35, s77, 114688
buffer_load_dwordx4 v[40:43], v250, s[16:19], s35 offen nt
s_add_u32 s35, s77, 121856
buffer_load_dwordx4 v[44:47], v250, s[16:19], s35 offen nt
s_add_u32 s35, s77, 129024
buffer_load_dwordx4 v[48:51], v250, s[16:19], s35 offen nt
s_add_u32 s35, s77, 136192
buffer_load_dwordx4 v[52:55], v250, s[16:19], s35 offen nt
s_waitcnt lgkmcnt(0)
s_mov_b32 s42, 0x05040100
s_mov_b32 s43, 0x07060302
s_cmp_eq_u32 s65, 0
s_cbranch_scc0 fq_120
v_perm_b32 v216, v188, v184, s42
v_perm_b32 v220, v188, v184, s43
v_perm_b32 v224, v189, v185, s42
v_perm_b32 v228, v189, v185, s43
v_perm_b32 v232, v190, v186, s42
v_perm_b32 v236, v190, v186, s43
v_perm_b32 v240, v191, v187, s42
v_perm_b32 v244, v191, v187, s43
v_perm_b32 v217, v196, v192, s42
v_perm_b32 v221, v196, v192, s43
v_perm_b32 v225, v197, v193, s42
v_perm_b32 v229, v197, v193, s43
v_perm_b32 v233, v198, v194, s42
v_perm_b32 v237, v198, v194, s43
v_perm_b32 v241, v199, v195, s42
v_perm_b32 v245, v199, v195, s43
v_perm_b32 v218, v204, v200, s42
v_perm_b32 v222, v204, v200, s43
v_perm_b32 v226, v205, v201, s42
v_perm_b32 v230, v205, v201, s43
v_perm_b32 v234, v206, v202, s42
v_perm_b32 v238, v206, v202, s43
v_perm_b32 v242, v207, v203, s42
v_perm_b32 v246, v207, v203, s43
v_perm_b32 v219, v212, v208, s42
v_perm_b32 v223, v212, v208, s43
v_perm_b32 v227, v213, v209, s42
v_perm_b32 v231, v213, v209, s43
v_perm_b32 v235, v214, v210, s42
v_perm_b32 v239, v214, v210, s43
v_perm_b32 v243, v215, v211, s42
v_perm_b32 v247, v215, v211, s43
v_perm_b32 v184, v156, v152, s42
v_perm_b32 v188, v156, v152, s43
v_perm_b32 v192, v157, v153, s42
v_perm_b32 v196, v157, v153, s43
v_perm_b32 v200, v158, v154, s42
v_perm_b32 v204, v158, v154, s43
v_perm_b32 v208, v159, v155, s42
v_perm_b32 v212, v159, v155, s43
v_perm_b32 v185, v164, v160, s42
v_perm_b32 v189, v164, v160, s43
v_perm_b32 v193, v165, v161, s42
v_perm_b32 v197, v165, v161, s43
v_perm_b32 v201, v166, v162, s42
v_perm_b32 v205, v166, v162, s43
v_perm_b32 v209, v167, v163, s42
v_perm_b32 v213, v167, v163, s43
v_perm_b32 v186, v172, v168, s42
v_perm_b32 v190, v172, v168, s43
v_perm_b32 v194, v173, v169, s42
v_perm_b32 v198, v173, v169, s43
v_perm_b32 v202, v174, v170, s42
v_perm_b32 v206, v174, v170, s43
v_perm_b32 v210, v175, v171, s42
v_perm_b32 v214, v175, v171, s43
v_perm_b32 v187, v180, v176, s42
v_perm_b32 v191, v180, v176, s43
v_perm_b32 v195, v181, v177, s42
v_perm_b32 v199, v181, v177, s43
v_perm_b32 v203, v182, v178, s42
v_perm_b32 v207, v182, v178, s43
v_perm_b32 v211, v183, v179, s42
v_perm_b32 v215, v183, v179, s43
s_waitcnt vmcnt(30)
v_perm_b32 v152, v124, v120, s42
v_perm_b32 v156, v124, v120, s43
v_perm_b32 v160, v125, v121, s42
v_perm_b32 v164, v125, v121, s43
v_perm_b32 v168, v126, v122, s42
v_perm_b32 v172, v126, v122, s43
v_perm_b32 v176, v127, v123, s42
v_perm_b32 v180, v127, v123, s43
s_waitcnt vmcnt(28)
v_perm_b32 v153, v132, v128, s42
v_perm_b32 v157, v132, v128, s43
v_perm_b32 v161, v133, v129, s42
v_perm_b32 v165, v133, v129, s43
v_perm_b32 v169, v134, v130, s42
v_perm_b32 v173, v134, v130, s43
v_perm_b32 v177, v135, v131, s42
v_perm_b32 v181, v135, v131, s43
s_waitcnt vmcnt(26)
v_perm_b32 v154, v140, v136, s42
v_perm_b32 v158, v140, v136, s43
v_perm_b32 v162, v141, v137, s42
v_perm_b32 v166, v141, v137, s43
v_perm_b32 v170, v142, v138, s42
v_perm_b32 v174, v142, v138, s43
v_perm_b32 v178, v143, v139, s42
v_perm_b32 v182, v143, v139, s43
s_waitcnt vmcnt(24)
v_perm_b32 v155, v148, v144, s42
v_perm_b32 v159, v148, v144, s43
v_perm_b32 v163, v149, v145, s42
v_perm_b32 v167, v149, v145, s43
v_perm_b32 v171, v150, v146, s42
v_perm_b32 v175, v150, v146, s43
v_perm_b32 v179, v151, v147, s42
v_perm_b32 v183, v151, v147, s43
s_waitcnt vmcnt(22)
v_perm_b32 v120, v92, v88, s42
v_perm_b32 v124, v92, v88, s43
v_perm_b32 v128, v93, v89, s42
v_perm_b32 v132, v93, v89, s43
v_perm_b32 v136, v94, v90, s42
v_perm_b32 v140, v94, v90, s43
v_perm_b32 v144, v95, v91, s42
v_perm_b32 v148, v95, v91, s43
s_waitcnt vmcnt(20)
v_perm_b32 v121, v100, v96, s42
v_perm_b32 v125, v100, v96, s43
v_perm_b32 v129, v101, v97, s42
v_perm_b32 v133, v101, v97, s43
v_perm_b32 v137, v102, v98, s42
v_perm_b32 v141, v102, v98, s43
v_perm_b32 v145, v103, v99, s42
v_perm_b32 v149, v103, v99, s43
s_waitcnt vmcnt(18)
v_perm_b32 v122, v108, v104, s42
v_perm_b32 v126, v108, v104, s43
v_perm_b32 v130, v109, v105, s42
v_perm_b32 v134, v109, v105, s43
v_perm_b32 v138, v110, v106, s42
v_perm_b32 v142, v110, v106, s43
v_perm_b32 v146, v111, v107, s42
v_perm_b32 v150, v111, v107, s43
s_waitcnt vmcnt(16)
v_perm_b32 v123, v116, v112, s42
v_perm_b32 v127, v116, v112, s43
v_perm_b32 v131, v117, v113, s42
v_perm_b32 v135, v117, v113, s43
v_perm_b32 v139, v118, v114, s42
v_perm_b32 v143, v118, v114, s43
v_perm_b32 v147, v119, v115, s42
v_perm_b32 v151, v119, v115, s43
s_waitcnt vmcnt(14)
v_perm_b32 v88, v60, v56, s42
v_perm_b32 v92, v60, v56, s43
v_perm_b32 v96, v61, v57, s42
v_perm_b32 v100, v61, v57, s43
v_perm_b32 v104, v62, v58, s42
v_perm_b32 v108, v62, v58, s43
v_perm_b32 v112, v63, v59, s42
v_perm_b32 v116, v63, v59, s43
s_waitcnt vmcnt(12)
v_perm_b32 v89, v68, v64, s42
v_perm_b32 v93, v68, v64, s43
v_perm_b32 v97, v69, v65, s42
v_perm_b32 v101, v69, v65, s43
v_perm_b32 v105, v70, v66, s42
v_perm_b32 v109, v70, v66, s43
v_perm_b32 v113, v71, v67, s42
v_perm_b32 v117, v71, v67, s43
s_waitcnt vmcnt(10)
v_perm_b32 v90, v76, v72, s42
v_perm_b32 v94, v76, v72, s43
v_perm_b32 v98, v77, v73, s42
v_perm_b32 v102, v77, v73, s43
v_perm_b32 v106, v78, v74, s42
v_perm_b32 v110, v78, v74, s43
v_perm_b32 v114, v79, v75, s42
v_perm_b32 v118, v79, v75, s43
s_waitcnt vmcnt(8)
v_perm_b32 v91, v84, v80, s42
v_perm_b32 v95, v84, v80, s43
v_perm_b32 v99, v85, v81, s42
v_perm_b32 v103, v85, v81, s43
v_perm_b32 v107, v86, v82, s42
v_perm_b32 v111, v86, v82, s43
v_perm_b32 v115, v87, v83, s42
v_perm_b32 v119, v87, v83, s43
s_waitcnt vmcnt(6)
v_perm_b32 v56, v28, v24, s42
v_perm_b32 v60, v28, v24, s43
v_perm_b32 v64, v29, v25, s42
v_perm_b32 v68, v29, v25, s43
v_perm_b32 v72, v30, v26, s42
v_perm_b32 v76, v30, v26, s43
v_perm_b32 v80, v31, v27, s42
v_perm_b32 v84, v31, v27, s43
s_waitcnt vmcnt(4)
v_perm_b32 v57, v36, v32, s42
v_perm_b32 v61, v36, v32, s43
v_perm_b32 v65, v37, v33, s42
v_perm_b32 v69, v37, v33, s43
v_perm_b32 v73, v38, v34, s42
v_perm_b32 v77, v38, v34, s43
v_perm_b32 v81, v39, v35, s42
v_perm_b32 v85, v39, v35, s43
s_waitcnt vmcnt(2)
v_perm_b32 v58, v44, v40, s42
v_perm_b32 v62, v44, v40, s43
v_perm_b32 v66, v45, v41, s42
v_perm_b32 v70, v45, v41, s43
v_perm_b32 v74, v46, v42, s42
v_perm_b32 v78, v46, v42, s43
v_perm_b32 v82, v47, v43, s42
v_perm_b32 v86, v47, v43, s43
s_waitcnt vmcnt(0)
v_perm_b32 v59, v52, v48, s42
v_perm_b32 v63, v52, v48, s43
v_perm_b32 v67, v53, v49, s42
v_perm_b32 v71, v53, v49, s43
v_perm_b32 v75, v54, v50, s42
v_perm_b32 v79, v54, v50, s43
v_perm_b32 v83, v55, v51, s42
v_perm_b32 v87, v55, v51, s43
fq_120:
s_and_b32 s54, s59, 1
s_lshl_b32 s54, s54, 1
s_sub_u32 s54, s53, s54
s_and_b32 s54, s54, 15
s_mul_i32 s54, s54, 393216
s_add_u32 s54, s54, s56
s_buffer_load_dwordx2 s[46:47], s[48:51], s54 offset:4096
s_buffer_load_dwordx2 s[46:47], s[48:51], s54 offset:10240
s_buffer_load_dwordx2 s[46:47], s[48:51], s54 offset:16384
s_buffer_load_dwordx2 s[46:47], s[48:51], s54 offset:22528
s_buffer_load_dwordx2 s[46:47], s[48:51], s54 offset:2048
s_buffer_load_dwordx2 s[46:47], s[48:51], s54 offset:8192
s_buffer_load_dwordx2 s[46:47], s[48:51], s54 offset:14336
s_buffer_load_dwordx2 s[46:47], s[48:51], s54 offset:20480
s_buffer_load_dwordx2 s[46:47], s[48:51], s54 offset:0
s_buffer_load_dwordx2 s[46:47], s[48:51], s54 offset:6144
s_buffer_load_dwordx2 s[46:47], s[48:51], s54 offset:12288
s_buffer_load_dwordx2 s[46:47], s[48:51], s54 offset:18432
s_add_u32 s54, s53, 1
s_and_b32 s54, s54, 15
s_mul_i32 s54, s54, 393216
s_add_u32 s54, s54, s56
s_buffer_load_dwordx2 s[46:47], s[48:51], s54 offset:4096
s_buffer_load_dwordx2 s[46:47], s[48:51], s54 offset:10240
s_buffer_load_dwordx2 s[46:47], s[48:51], s54 offset:16384
s_buffer_load_dwordx2 s[46:47], s[48:51], s54 offset:22528
s_buffer_load_dwordx2 s[46:47], s[48:51], s54 offset:2048
s_buffer_load_dwordx2 s[46:47], s[48:51], s54 offset:8192
s_buffer_load_dwordx2 s[46:47], s[48:51], s54 offset:14336
s_buffer_load_dwordx2 s[46:47], s[48:51], s54 offset:20480
s_buffer_load_dwordx2 s[46:47], s[48:51], s54 offset:0
s_buffer_load_dwordx2 s[46:47], s[48:51], s54 offset:6144
s_buffer_load_dwordx2 s[46:47], s[48:51], s54 offset:12288
s_buffer_load_dwordx2 s[46:47], s[48:51], s54 offset:18432
s_add_u32 s54, s53, 3
s_and_b32 s54, s54, 15
s_mul_i32 s54, s54, 393216
s_add_u32 s54, s54, s56
s_buffer_load_dwordx2 s[46:47], s[48:51], s54 offset:4096
s_buffer_load_dwordx2 s[46:47], s[48:51], s54 offset:10240
s_buffer_load_dwordx2 s[46:47], s[48:51], s54 offset:16384
s_buffer_load_dwordx2 s[46:47], s[48:51], s54 offset:22528
s_buffer_load_dwordx2 s[46:47], s[48:51], s54 offset:2048
s_buffer_load_dwordx2 s[46:47], s[48:51], s54 offset:8192
s_buffer_load_dwordx2 s[46:47], s[48:51], s54 offset:14336
s_buffer_load_dwordx2 s[46:47], s[48:51], s54 offset:20480
s_buffer_load_dwordx2 s[46:47], s[48:51], s54 offset:0
s_buffer_load_dwordx2 s[46:47], s[48:51], s54 offset:6144
s_buffer_load_dwordx2 s[46:47], s[48:51], s54 offset:12288
s_buffer_load_dwordx2 s[46:47], s[48:51], s54 offset:18432
s_add_u32 s54, s53, 5
s_and_b32 s54, s54, 15
s_mul_i32 s54, s54, 393216
s_add_u32 s54, s54, s56
s_buffer_load_dwordx2 s[46:47], s[48:51], s54 offset:4096
s_buffer_load_dwordx2 s[46:47], s[48:51], s54 offset:10240
s_buffer_load_dwordx2 s[46:47], s[48:51], s54 offset:16384
s_buffer_load_dwordx2 s[46:47], s[48:51], s54 offset:22528
s_buffer_load_dwordx2 s[46:47], s[48:51], s54 offset:2048
s_buffer_load_dwordx2 s[46:47], s[48:51], s54 offset:8192
s_buffer_load_dwordx2 s[46:47], s[48:51], s54 offset:14336
s_buffer_load_dwordx2 s[46:47], s[48:51], s54 offset:20480
s_buffer_load_dwordx2 s[46:47], s[48:51], s54 offset:0
s_buffer_load_dwordx2 s[46:47], s[48:51], s54 offset:6144
s_buffer_load_dwordx2 s[46:47], s[48:51], s54 offset:12288
s_buffer_load_dwordx2 s[46:47], s[48:51], s54 offset:18432
s_add_u32 s54, s53, 7
s_and_b32 s54, s54, 15
s_mul_i32 s54, s54, 393216
s_add_u32 s54, s54, s56
s_buffer_load_dwordx2 s[46:47], s[48:51], s54 offset:4096
s_buffer_load_dwordx2 s[46:47], s[48:51], s54 offset:10240
s_buffer_load_dwordx2 s[46:47], s[48:51], s54 offset:16384
s_buffer_load_dwordx2 s[46:47], s[48:51], s54 offset:22528
s_buffer_load_dwordx2 s[46:47], s[48:51], s54 offset:2048
s_buffer_load_dwordx2 s[46:47], s[48:51], s54 offset:8192
s_buffer_load_dwordx2 s[46:47], s[48:51], s54 offset:14336
s_buffer_load_dwordx2 s[46:47], s[48:51], s54 offset:20480
s_buffer_load_dwordx2 s[46:47], s[48:51], s54 offset:0
s_buffer_load_dwordx2 s[46:47], s[48:51], s54 offset:6144
s_buffer_load_dwordx2 s[46:47], s[48:51], s54 offset:12288
s_buffer_load_dwordx2 s[46:47], s[48:51], s54 offset:18432
s_add_u32 s54, s53, 9
s_and_b32 s54, s54, 15
s_mul_i32 s54, s54, 393216
s_add_u32 s54, s54, s56
s_buffer_load_dwordx2 s[46:47], s[48:51], s54 offset:4096
s_buffer_load_dwordx2 s[46:47], s[48:51], s54 offset:10240
s_buffer_load_dwordx2 s[46:47], s[48:51], s54 offset:16384
s_buffer_load_dwordx2 s[46:47], s[48:51], s54 offset:22528
s_buffer_load_dwordx2 s[46:47], s[48:51], s54 offset:2048
s_buffer_load_dwordx2 s[46:47], s[48:51], s54 offset:8192
s_buffer_load_dwordx2 s[46:47], s[48:51], s54 offset:14336
s_buffer_load_dwordx2 s[46:47], s[48:51], s54 offset:20480
s_buffer_load_dwordx2 s[46:47], s[48:51], s54 offset:0
s_buffer_load_dwordx2 s[46:47], s[48:51], s54 offset:6144
s_buffer_load_dwordx2 s[46:47], s[48:51], s54 offset:12288
s_buffer_load_dwordx2 s[46:47], s[48:51], s54 offset:18432
s_waitcnt lgkmcnt(0)
s_branch fnw_59
fnd_68:
poll_121:
buffer_load_dwordx2 v[248:249], v6, s[24:27], s73 offen sc1
pchk_122:
s_waitcnt vmcnt(0)
v_min_u32 v5, v248, v249
v_cmp_eq_u32 vcc, 0, v5
s_cbranch_vccz pdone_123
s_sleep 1
s_sub_u32 s32, s32, 1
s_cmp_gt_i32 s32, 0
s_cbranch_scc1 poll_121
pdone_123:
v_mov_b32 v250, v248
s_nop 1
v_max_f32_dpp v250, v250, v250 row_ror:1 row_mask:0xf bank_mask:0xf
s_nop 1
v_max_f32_dpp v250, v250, v250 row_ror:2 row_mask:0xf bank_mask:0xf
s_nop 1
v_max_f32_dpp v250, v250, v250 row_ror:4 row_mask:0xf bank_mask:0xf
s_nop 1
v_max_f32_dpp v250, v250, v250 row_ror:8 row_mask:0xf bank_mask:0xf
v_cmp_eq_f32 vcc, v250, v248
s_ff1_i32_b64 s68, vcc
s_and_b32 s68, s68, 15
v_readlane_b32 s33, v249, s68
v_readlane_b32 s67, v248, s68
v_add_u32 v5, s34, 4
v_mov_b32 v250, s33
s_mov_b64 exec, 1
ds_write2_b32 v3, v5, v250 offset1:2
s_mov_b64 exec, -1
s_sub_u32 s33, s33, 1
s_and_b32 s33, s33, 2047
s_branch fnd_67
fpre_90:
poll_124:
buffer_load_dwordx4 v[24:27], v4, s[24:27], s72 offen offset:0 sc1
pchk_125:
s_waitcnt vmcnt(0)
v_min3_u32 v5, v24, v25, v26
v_min_u32 v5, v5, v27
v_cmp_eq_u32 vcc, 0, v5
s_cbranch_vccz pdone_126
s_sleep 8
s_sub_u32 s32, s32, 1
s_cmp_gt_i32 s32, 0
s_cbranch_scc1 poll_124
pdone_126:
s_branch fpre_91
L_m:
s_setprio 2
v_mov_b32 v6, 0
v_mov_b32 v7, 0
v_lshlrev_b32 v8, 3, v0
ds_write_b64 v8, v[6:7]
s_waitcnt lgkmcnt(0)
s_barrier
s_lshr_b32 s64, s58, 1
s_and_b32 s65, s58, 1
v_and_b32 v1, 3, v0
v_lshlrev_b32 v1, 2, v1
v_and_b32 v2, 4, v1
s_lshl2_add_u32 s35, s58, 0
v_mov_b32 v3, s35
s_mov_b32 s4, s44
s_mov_b32 s5, s45
s_mov_b32 s6, 0x800
s_mov_b32 s7, 0x00020000
v_lshrrev_b32 v6, 4, v0
v_lshlrev_b32 v6, 3, v6
s_lshl_b32 s66, s62, 7
buffer_load_dwordx2 v[232:233], v6, s[4:7], s66 offen offset:0
buffer_load_dwordx2 v[234:235], v6, s[4:7], s66 offen offset:32
buffer_load_dwordx2 v[236:237], v6, s[4:7], s66 offen offset:64
buffer_load_dwordx2 v[238:239], v6, s[4:7], s66 offen offset:96
v_and_b32 v6, 31, v0
v_lshrrev_b32 v7, 5, v0
v_lshlrev_b32 v7, 3, v7
v_sub_u32 v6, v6, v7
v_mov_b32 v7, 0xf149f2ca
v_cmp_le_i32 vcc, 0, v6
s_nop 1
v_cndmask_b32 v216, 0, v7, vcc
v_cmp_le_i32 vcc, 1, v6
s_nop 1
v_cndmask_b32 v217, 0, v7, vcc
v_cmp_le_i32 vcc, 2, v6
s_nop 1
v_cndmask_b32 v218, 0, v7, vcc
v_cmp_le_i32 vcc, 3, v6
s_nop 1
v_cndmask_b32 v219, 0, v7, vcc
v_cmp_le_i32 vcc, 16, v6
s_nop 1
v_cndmask_b32 v220, 0, v7, vcc
v_cmp_le_i32 vcc, 17, v6
s_nop 1
v_cndmask_b32 v221, 0, v7, vcc
v_cmp_le_i32 vcc, 18, v6
s_nop 1
v_cndmask_b32 v222, 0, v7, vcc
v_cmp_le_i32 vcc, 19, v6
s_nop 1
v_cndmask_b32 v223, 0, v7, vcc
v_cmp_le_i32 vcc, 4, v6
s_nop 1
v_cndmask_b32 v224, 0, v7, vcc
v_cmp_le_i32 vcc, 5, v6
s_nop 1
v_cndmask_b32 v225, 0, v7, vcc
v_cmp_le_i32 vcc, 6, v6
s_nop 1
v_cndmask_b32 v226, 0, v7, vcc
v_cmp_le_i32 vcc, 7, v6
s_nop 1
v_cndmask_b32 v227, 0, v7, vcc
v_cmp_le_i32 vcc, 20, v6
s_nop 1
v_cndmask_b32 v228, 0, v7, vcc
v_cmp_le_i32 vcc, 21, v6
s_nop 1
v_cndmask_b32 v229, 0, v7, vcc
v_cmp_le_i32 vcc, 22, v6
s_nop 1
v_cndmask_b32 v230, 0, v7, vcc
v_cmp_le_i32 vcc, 23, v6
s_nop 1
v_cndmask_b32 v231, 0, v7, vcc
v_lshrrev_b32 v6, 2, v0
v_xor_b32 v6, v6, v0
v_and_b32 v6, 4, v6
v_mov_b32 v7, 0x3f803f80
v_cmp_eq_u32 vcc, 0, v6
s_nop 1
v_cndmask_b32 v212, 0, v7, vcc
v_cndmask_b32 v213, 0, v7, vcc
v_cndmask_b32 v214, 0, v7, vcc
v_cndmask_b32 v215, 0, v7, vcc
v_lshrrev_b32 v196, 4, v0
s_cmp_eq_u32 0, 0
s_cbranch_scc0 mq_127
v_bfe_u32 v197, v0, 1, 3
v_xor_b32 v197, v197, v196
v_lshlrev_b32 v197, 4, v197
v_and_b32 v198, 15, v0
v_lshl_add_u32 v192, v198, 7, v197
v_xor_b32 v193, 64, v192
s_branch mq_128
mq_127:
v_lshlrev_b32 v192, 4, v0
v_add_u32 v193, 1024, v192
mq_128:
s_lshl_b32 s46, s65, 13
s_add_u32 s46, s46, 86016
v_add_u32 v192, s46, v192
v_add_u32 v193, s46, v193
v_bfe_u32 v197, v0, 2, 2
v_lshl_add_u32 v197, v196, 3, v197
v_bfe_u32 v198, v0, 3, 2
s_lshl_b32 s46, s64, 1
v_xor_b32 v198, s46, v198
v_lshlrev_b32 v198, 5, v198
v_lshl_add_u32 v197, v197, 7, v198
v_and_b32 v198, 3, v0
v_lshl_add_u32 v197, v198, 3, v197
v_add_u32 v194, 102400, v197
v_xor_b32 v195, 32, v194
v_mov_b32 v197, 0xf149f2ca
v_xor_b32 v216, v197, v216
v_xor_b32 v217, v197, v217
v_xor_b32 v218, v197, v218
v_xor_b32 v219, v197, v219
v_xor_b32 v220, v197, v220
v_xor_b32 v221, v197, v221
v_xor_b32 v222, v197, v222
v_xor_b32 v223, v197, v223
v_xor_b32 v224, v197, v224
v_xor_b32 v225, v197, v225
v_xor_b32 v226, v197, v226
v_xor_b32 v227, v197, v227
v_xor_b32 v228, v197, v228
v_xor_b32 v229, v197, v229
v_xor_b32 v230, v197, v230
v_xor_b32 v231, v197, v231
v_and_b32 v196, 15, v0
v_lshrrev_b32 v197, 4, v0
s_lshl_b32 s46, s65, 8
s_add_u32 s46, s46, 1280
s_mul_i32 s47, s64, 384
v_lshl_add_u32 v208, v196, 2, s46
v_lshl_add_u32 v209, v197, 4, s46
v_lshl_add_u32 v210, v196, 2, s47
v_lshl_add_u32 v211, v197, 4, s47
v_and_b32 v198, 1, v197
v_lshrrev_b32 v197, 1, v197
v_lshlrev_b32 v197, 9, v197
v_lshl_add_u32 v197, v198, 10, v197
s_lshl_b32 s46, s64, 12
s_lshl_b32 s47, s65, 13
s_add_u32 s46, s46, 131072
s_add_u32 s48, s46, 24576
s_sub_u32 s48, s48, s47
s_add_u32 s47, s46, s47
v_lshl_add_u32 v200, v196, 4, v197
v_and_b32 v198, 3, v0
v_lshl_add_u32 v197, v198, 4, v197
v_bfe_u32 v198, v0, 3, 1
v_lshl_add_u32 v197, v198, 6, v197
v_bfe_u32 v198, v0, 2, 1
v_lshl_add_u32 v198, v198, 8, v197
v_add_u32 v199, s48, v198
v_add_u32 v198, s47, v198
v_add_u32 v201, s48, v200
v_add_u32 v200, s47, v200
s_lshl_b32 s46, s59, 4
s_add_u32 s46, s46, s60
s_lshl_b32 s50, s59, 7
s_add_u32 s50, s50, s60
s_lshl_b32 s50, s50, 7
s_lshl_b32 s46, s46, 15
s_lshl_b32 s47, 0, 23
s_add_u32 s46, s46, s47
s_add_u32 s49, s46, 917504
L_mtop:
v_mov_b32 v6, v192
v_mov_b32 v7, v193
v_mov_b32 v8, v194
v_mov_b32 v9, v195
v_mov_b32 v12, v198
v_mov_b32 v13, v199
v_mov_b32 v14, v200
v_mov_b32 v15, v201
s_mov_b32 s71, s49
s_mov_b32 s72, s50
v_add_u32 v4, s34, 1
s_mov_b32 s66, 14
s_mov_b32 s67, -40960
s_mov_b32 s68, -40960
s_mov_b32 s69, 81920
s_add_u32 s35, s34, 1
lw_129:
ds_read_b32 v5, v2 offset:16
s_waitcnt lgkmcnt(0)
v_cmp_gt_i32 vcc, s35, v5
s_cbranch_vccz lwd_130
s_sub_u32 s32, s32, 1
s_cmp_gt_i32 s32, 0
s_cbranch_scc1 lw_129
lwd_130:
ds_read_b64_tr_b16 v[144:145], v8 offset:8192
ds_read_b64_tr_b16 v[146:147], v8 offset:8704
ds_read_b64_tr_b16 v[148:149], v8 offset:12288
ds_read_b64_tr_b16 v[150:151], v8 offset:12800
ds_read_b128 v[112:115], v6 offset:0
ds_read_b128 v[116:119], v7 offset:0
ds_read_b64_tr_b16 v[152:153], v9 offset:8192
ds_read_b64_tr_b16 v[154:155], v9 offset:8704
ds_read_b64_tr_b16 v[156:157], v9 offset:12288
ds_read_b64_tr_b16 v[158:159], v9 offset:12800
ds_read_b128 v[120:123], v6 offset:2048
ds_read_b128 v[124:127], v7 offset:2048
ds_read_b128 v[128:131], v6 offset:4096
ds_read_b128 v[132:135], v7 offset:4096
ds_read_b128 v[136:139], v6 offset:6144
ds_read_b128 v[140:143], v7 offset:6144
s_waitcnt lgkmcnt(11)
v_mfma_f32_16x16x32_bf16 v[16:19], v[144:147], v[112:115], 0
ds_read_b64_tr_b16 v[160:161], v8 offset:16384
s_waitcnt lgkmcnt(11)
v_mfma_f32_16x16x32_bf16 v[16:19], v[148:151], v[116:119], v[16:19]
ds_read_b64_tr_b16 v[162:163], v8 offset:16896
s_waitcnt lgkmcnt(10)
v_mfma_f32_16x16x32_bf16 v[20:23], v[152:155], v[112:115], 0
ds_read_b64_tr_b16 v[164:165], v8 offset:20480
s_waitcnt lgkmcnt(9)
v_mfma_f32_16x16x32_bf16 v[20:23], v[156:159], v[116:119], v[20:23]
ds_read_b64_tr_b16 v[166:167], v8 offset:20992
s_waitcnt lgkmcnt(9)
v_mfma_f32_16x16x32_bf16 v[24:27], v[144:147], v[120:123], 0
ds_read_b64_tr_b16 v[168:169], v9 offset:16384
s_waitcnt lgkmcnt(9)
v_mfma_f32_16x16x32_bf16 v[24:27], v[148:151], v[124:127], v[24:27]
ds_read_b64_tr_b16 v[170:171], v9 offset:16896
v_mfma_f32_16x16x32_bf16 v[28:31], v[152:155], v[120:123], 0
ds_read_b64_tr_b16 v[172:173], v9 offset:20480
v_mfma_f32_16x16x32_bf16 v[28:31], v[156:159], v[124:127], v[28:31]
ds_read_b64_tr_b16 v[174:175], v9 offset:20992
s_waitcnt lgkmcnt(11)
v_mfma_f32_16x16x32_bf16 v[32:35], v[144:147], v[128:131], 0
ds_read_b64_tr_b16 v[176:177], v8 offset:0
s_waitcnt lgkmcnt(11)
v_mfma_f32_16x16x32_bf16 v[32:35], v[148:151], v[132:135], v[32:35]
ds_read_b64_tr_b16 v[178:179], v8 offset:512
v_mfma_f32_16x16x32_bf16 v[36:39], v[152:155], v[128:131], 0
ds_read_b64_tr_b16 v[180:181], v8 offset:4096
v_mfma_f32_16x16x32_bf16 v[36:39], v[156:159], v[132:135], v[36:39]
ds_read_b64_tr_b16 v[182:183], v8 offset:4608
s_waitcnt lgkmcnt(13)
v_mfma_f32_16x16x32_bf16 v[40:43], v[144:147], v[136:139], 0
ds_read_b64_tr_b16 v[184:185], v9 offset:0
s_waitcnt lgkmcnt(13)
v_mfma_f32_16x16x32_bf16 v[40:43], v[148:151], v[140:143], v[40:43]
ds_read_b64_tr_b16 v[186:187], v9 offset:512
v_mfma_f32_16x16x32_bf16 v[44:47], v[152:155], v[136:139], 0
ds_read_b64_tr_b16 v[188:189], v9 offset:4096
v_mfma_f32_16x16x32_bf16 v[44:47], v[156:159], v[140:143], v[44:47]
ds_read_b64_tr_b16 v[190:191], v9 offset:4608
s_waitcnt lgkmcnt(14)
v_mfma_f32_16x16x32_bf16 v[48:51], v[112:115], v[160:163], 0
s_mov_b64 exec, 1
ds_write_b32 v3, v4
s_mov_b64 exec, -1
s_waitcnt lgkmcnt(13)
v_mfma_f32_16x16x32_bf16 v[48:51], v[116:119], v[164:167], v[48:51]
v_add_u32 v8, s67, v8
v_add_u32 v9, s67, v9
s_waitcnt lgkmcnt(11)
v_mfma_f32_16x16x32_bf16 v[52:55], v[112:115], v[168:171], 0
v_add_u32 v6, s67, v6
v_add_u32 v7, s67, v7
s_waitcnt lgkmcnt(9)
v_mfma_f32_16x16x32_bf16 v[52:55], v[116:119], v[172:175], v[52:55]
s_mov_b32 s70, s67
s_mov_b32 s67, s68
s_mov_b32 s68, s69
s_mov_b32 s69, s70
v_mfma_f32_16x16x32_bf16 v[56:59], v[120:123], v[160:163], 0
ds_read_b32 v5, v2 offset:16
v_mfma_f32_16x16x32_bf16 v[56:59], v[124:127], v[164:167], v[56:59]
v_mfma_f32_16x16x32_bf16 v[60:63], v[120:123], v[168:171], 0
v_mfma_f32_16x16x32_bf16 v[60:63], v[124:127], v[172:175], v[60:63]
v_mfma_f32_16x16x32_bf16 v[64:67], v[128:131], v[160:163], 0
s_waitcnt lgkmcnt(0)
v_cmp_ge_u32 vcc, v4, v5
s_cbranch_vccnz mspin_134
mback_135:
v_add_u32 v4, 1, v4
v_mfma_f32_16x16x32_bf16 v[64:67], v[132:135], v[164:167], v[64:67]
ds_read_b64_tr_b16 v[144:145], v8 offset:8192
v_mfma_f32_16x16x32_bf16 v[68:71], v[128:131], v[168:171], 0
ds_read_b64_tr_b16 v[146:147], v8 offset:8704
v_mfma_f32_16x16x32_bf16 v[68:71], v[132:135], v[172:175], v[68:71]
ds_read_b64_tr_b16 v[148:149], v8 offset:12288
v_mfma_f32_16x16x32_bf16 v[72:75], v[136:139], v[160:163], 0
ds_read_b64_tr_b16 v[150:151], v8 offset:12800
v_mfma_f32_16x16x32_bf16 v[72:75], v[140:143], v[164:167], v[72:75]
ds_read_b64_tr_b16 v[152:153], v9 offset:8192
v_mfma_f32_16x16x32_bf16 v[76:79], v[136:139], v[168:171], 0
ds_read_b64_tr_b16 v[154:155], v9 offset:8704
v_mfma_f32_16x16x32_bf16 v[76:79], v[140:143], v[172:175], v[76:79]
ds_read_b64_tr_b16 v[156:157], v9 offset:12288
v_mfma_f32_16x16x32_bf16 v[80:83], v[176:179], v[112:115], 0
ds_read_b64_tr_b16 v[158:159], v9 offset:12800
v_mfma_f32_16x16x32_bf16 v[80:83], v[180:183], v[116:119], v[80:83]
v_mfma_f32_16x16x32_bf16 v[84:87], v[184:187], v[112:115], 0
v_mfma_f32_16x16x32_bf16 v[84:87], v[188:191], v[116:119], v[84:87]
ds_read_b128 v[112:115], v6 offset:0
ds_read_b128 v[116:119], v7 offset:0
v_mfma_f32_16x16x32_bf16 v[88:91], v[176:179], v[120:123], 0
v_mfma_f32_16x16x32_bf16 v[88:91], v[180:183], v[124:127], v[88:91]
v_mfma_f32_16x16x32_bf16 v[92:95], v[184:187], v[120:123], 0
v_mfma_f32_16x16x32_bf16 v[92:95], v[188:191], v[124:127], v[92:95]
ds_read_b128 v[120:123], v6 offset:2048
ds_read_b128 v[124:127], v7 offset:2048
v_mfma_f32_16x16x32_bf16 v[96:99], v[176:179], v[128:131], 0
v_mfma_f32_16x16x32_bf16 v[96:99], v[180:183], v[132:135], v[96:99]
v_mfma_f32_16x16x32_bf16 v[100:103], v[184:187], v[128:131], 0
v_mfma_f32_16x16x32_bf16 v[100:103], v[188:191], v[132:135], v[100:103]
ds_read_b128 v[128:131], v6 offset:4096
ds_read_b128 v[132:135], v7 offset:4096
v_mfma_f32_16x16x32_bf16 v[104:107], v[176:179], v[136:139], 0
v_mfma_f32_16x16x32_bf16 v[104:107], v[180:183], v[140:143], v[104:107]
v_mfma_f32_16x16x32_bf16 v[108:111], v[184:187], v[136:139], 0
v_mfma_f32_16x16x32_bf16 v[108:111], v[188:191], v[140:143], v[108:111]
ds_read_b128 v[136:139], v6 offset:6144
ds_read_b128 v[140:143], v7 offset:6144
.p2align 6
mqkv_131:
s_waitcnt lgkmcnt(7)
v_mfma_f32_16x16x32_bf16 v[16:19], v[144:147], v[112:115], v[16:19]
ds_read_b64_tr_b16 v[160:161], v8 offset:16384
s_waitcnt lgkmcnt(7)
v_mfma_f32_16x16x32_bf16 v[16:19], v[148:151], v[116:119], v[16:19]
ds_read_b64_tr_b16 v[162:163], v8 offset:16896
v_mfma_f32_16x16x32_bf16 v[20:23], v[152:155], v[112:115], v[20:23]
ds_read_b64_tr_b16 v[164:165], v8 offset:20480
v_mfma_f32_16x16x32_bf16 v[20:23], v[156:159], v[116:119], v[20:23]
ds_read_b64_tr_b16 v[166:167], v8 offset:20992
s_waitcnt lgkmcnt(9)
v_mfma_f32_16x16x32_bf16 v[24:27], v[144:147], v[120:123], v[24:27]
ds_read_b64_tr_b16 v[168:169], v9 offset:16384
s_waitcnt lgkmcnt(9)
v_mfma_f32_16x16x32_bf16 v[24:27], v[148:151], v[124:127], v[24:27]
ds_read_b64_tr_b16 v[170:171], v9 offset:16896
v_mfma_f32_16x16x32_bf16 v[28:31], v[152:155], v[120:123], v[28:31]
ds_read_b64_tr_b16 v[172:173], v9 offset:20480
v_mfma_f32_16x16x32_bf16 v[28:31], v[156:159], v[124:127], v[28:31]
ds_read_b64_tr_b16 v[174:175], v9 offset:20992
s_waitcnt lgkmcnt(11)
v_mfma_f32_16x16x32_bf16 v[32:35], v[144:147], v[128:131], v[32:35]
ds_read_b64_tr_b16 v[176:177], v8 offset:0
s_waitcnt lgkmcnt(11)
v_mfma_f32_16x16x32_bf16 v[32:35], v[148:151], v[132:135], v[32:35]
ds_read_b64_tr_b16 v[178:179], v8 offset:512
v_mfma_f32_16x16x32_bf16 v[36:39], v[152:155], v[128:131], v[36:39]
ds_read_b64_tr_b16 v[180:181], v8 offset:4096
v_mfma_f32_16x16x32_bf16 v[36:39], v[156:159], v[132:135], v[36:39]
ds_read_b64_tr_b16 v[182:183], v8 offset:4608
s_waitcnt lgkmcnt(13)
v_mfma_f32_16x16x32_bf16 v[40:43], v[144:147], v[136:139], v[40:43]
ds_read_b64_tr_b16 v[184:185], v9 offset:0
s_waitcnt lgkmcnt(13)
v_mfma_f32_16x16x32_bf16 v[40:43], v[148:151], v[140:143], v[40:43]
ds_read_b64_tr_b16 v[186:187], v9 offset:512
v_mfma_f32_16x16x32_bf16 v[44:47], v[152:155], v[136:139], v[44:47]
ds_read_b64_tr_b16 v[188:189], v9 offset:4096
v_mfma_f32_16x16x32_bf16 v[44:47], v[156:159], v[140:143], v[44:47]
ds_read_b64_tr_b16 v[190:191], v9 offset:4608
s_waitcnt lgkmcnt(14)
v_mfma_f32_16x16x32_bf16 v[48:51], v[112:115], v[160:163], v[48:51]
s_mov_b64 exec, 1
ds_write_b32 v3, v4
s_mov_b64 exec, -1
s_waitcnt lgkmcnt(13)
v_mfma_f32_16x16x32_bf16 v[48:51], v[116:119], v[164:167], v[48:51]
v_add_u32 v8, s67, v8
v_add_u32 v9, s67, v9
s_waitcnt lgkmcnt(11)
v_mfma_f32_16x16x32_bf16 v[52:55], v[112:115], v[168:171], v[52:55]
v_add_u32 v6, s67, v6
v_add_u32 v7, s67, v7
s_waitcnt lgkmcnt(9)
v_mfma_f32_16x16x32_bf16 v[52:55], v[116:119], v[172:175], v[52:55]
s_mov_b32 s70, s67
s_mov_b32 s67, s68
s_mov_b32 s68, s69
s_mov_b32 s69, s70
v_mfma_f32_16x16x32_bf16 v[56:59], v[120:123], v[160:163], v[56:59]
ds_read_b32 v5, v2 offset:16
v_mfma_f32_16x16x32_bf16 v[56:59], v[124:127], v[164:167], v[56:59]
v_mfma_f32_16x16x32_bf16 v[60:63], v[120:123], v[168:171], v[60:63]
v_mfma_f32_16x16x32_bf16 v[60:63], v[124:127], v[172:175], v[60:63]
v_mfma_f32_16x16x32_bf16 v[64:67], v[128:131], v[160:163], v[64:67]
s_waitcnt lgkmcnt(0)
v_cmp_ge_u32 vcc, v4, v5
s_cbranch_vccnz mspin_132
mback_133:
v_add_u32 v4, 1, v4
v_mfma_f32_16x16x32_bf16 v[64:67], v[132:135], v[164:167], v[64:67]
ds_read_b64_tr_b16 v[144:145], v8 offset:8192
v_mfma_f32_16x16x32_bf16 v[68:71], v[128:131], v[168:171], v[68:71]
ds_read_b64_tr_b16 v[146:147], v8 offset:8704
v_mfma_f32_16x16x32_bf16 v[68:71], v[132:135], v[172:175], v[68:71]
ds_read_b64_tr_b16 v[148:149], v8 offset:12288
v_mfma_f32_16x16x32_bf16 v[72:75], v[136:139], v[160:163], v[72:75]
ds_read_b64_tr_b16 v[150:151], v8 offset:12800
v_mfma_f32_16x16x32_bf16 v[72:75], v[140:143], v[164:167], v[72:75]
ds_read_b64_tr_b16 v[152:153], v9 offset:8192
v_mfma_f32_16x16x32_bf16 v[76:79], v[136:139], v[168:171], v[76:79]
ds_read_b64_tr_b16 v[154:155], v9 offset:8704
v_mfma_f32_16x16x32_bf16 v[76:79], v[140:143], v[172:175], v[76:79]
ds_read_b64_tr_b16 v[156:157], v9 offset:12288
v_mfma_f32_16x16x32_bf16 v[80:83], v[176:179], v[112:115], v[80:83]
ds_read_b64_tr_b16 v[158:159], v9 offset:12800
v_mfma_f32_16x16x32_bf16 v[80:83], v[180:183], v[116:119], v[80:83]
v_mfma_f32_16x16x32_bf16 v[84:87], v[184:187], v[112:115], v[84:87]
v_mfma_f32_16x16x32_bf16 v[84:87], v[188:191], v[116:119], v[84:87]
ds_read_b128 v[112:115], v6 offset:0
ds_read_b128 v[116:119], v7 offset:0
v_mfma_f32_16x16x32_bf16 v[88:91], v[176:179], v[120:123], v[88:91]
v_mfma_f32_16x16x32_bf16 v[88:91], v[180:183], v[124:127], v[88:91]
v_mfma_f32_16x16x32_bf16 v[92:95], v[184:187], v[120:123], v[92:95]
v_mfma_f32_16x16x32_bf16 v[92:95], v[188:191], v[124:127], v[92:95]
ds_read_b128 v[120:123], v6 offset:2048
ds_read_b128 v[124:127], v7 offset:2048
v_mfma_f32_16x16x32_bf16 v[96:99], v[176:179], v[128:131], v[96:99]
v_mfma_f32_16x16x32_bf16 v[96:99], v[180:183], v[132:135], v[96:99]
v_mfma_f32_16x16x32_bf16 v[100:103], v[184:187], v[128:131], v[100:103]
v_mfma_f32_16x16x32_bf16 v[100:103], v[188:191], v[132:135], v[100:103]
ds_read_b128 v[128:131], v6 offset:4096
ds_read_b128 v[132:135], v7 offset:4096
v_mfma_f32_16x16x32_bf16 v[104:107], v[176:179], v[136:139], v[104:107]
v_mfma_f32_16x16x32_bf16 v[104:107], v[180:183], v[140:143], v[104:107]
s_sub_u32 s66, s66, 1
s_cmp_eq_u32 s66, 0
v_mfma_f32_16x16x32_bf16 v[108:111], v[184:187], v[136:139], v[108:111]
v_mfma_f32_16x16x32_bf16 v[108:111], v[188:191], v[140:143], v[108:111]
ds_read_b128 v[136:139], v6 offset:6144
ds_read_b128 v[140:143], v7 offset:6144
s_cbranch_scc0 mqkv_131
s_waitcnt lgkmcnt(7)
v_mfma_f32_16x16x32_bf16 v[16:19], v[144:147], v[112:115], v[16:19]
ds_read_b32 v5, v2 offset:24
s_add_u32 s35, s34, 2
v_mov_b32 v6, 0
ds_read_b64_tr_b16 v[160:161], v8 offset:16384
s_waitcnt lgkmcnt(8)
v_mfma_f32_16x16x32_bf16 v[16:19], v[148:151], v[116:119], v[16:19]
ds_read_b64_tr_b16 v[162:163], v8 offset:16896
v_mfma_f32_16x16x32_bf16 v[20:23], v[152:155], v[112:115], v[20:23]
ds_read_b64_tr_b16 v[164:165], v8 offset:20480
v_mfma_f32_16x16x32_bf16 v[20:23], v[156:159], v[116:119], v[20:23]
ds_read_b64_tr_b16 v[166:167], v8 offset:20992
s_waitcnt lgkmcnt(10)
v_mfma_f32_16x16x32_bf16 v[24:27], v[144:147], v[120:123], v[24:27]
ds_read_b64_tr_b16 v[168:169], v9 offset:16384
s_waitcnt lgkmcnt(10)
v_mfma_f32_16x16x32_bf16 v[24:27], v[148:151], v[124:127], v[24:27]
ds_read_b64_tr_b16 v[170:171], v9 offset:16896
v_mfma_f32_16x16x32_bf16 v[28:31], v[152:155], v[120:123], v[28:31]
ds_read_b64_tr_b16 v[172:173], v9 offset:20480
s_waitcnt lgkmcnt(7)
v_cmp_gt_i32 vcc, s35, v5
s_cbranch_vccnz lspin_136
lback_137:
ds_read2_b32 v[6:7], v6 offset0:8 offset1:14
ds_read_b128 v[200:203], v211 offset:2432
v_mfma_f32_16x16x32_bf16 v[28:31], v[156:159], v[124:127], v[28:31]
ds_read_b64_tr_b16 v[174:175], v9 offset:20992
ds_read_b128 v[204:207], v211 offset:2496
ds_read2_b32 v[192:193], v208 offset0:0 offset1:128
v_mfma_f32_16x16x32_bf16 v[32:35], v[144:147], v[128:131], v[32:35]
ds_read2_b32 v[194:195], v208 offset0:16 offset1:144
v_mfma_f32_16x16x32_bf16 v[32:35], v[148:151], v[132:135], v[32:35]
ds_read2_b32 v[196:197], v208 offset0:32 offset1:160
ds_read2_b32 v[198:199], v208 offset0:48 offset1:176
v_mfma_f32_16x16x32_bf16 v[36:39], v[152:155], v[128:131], v[36:39]
ds_read_b64_tr_b16 v[176:177], v8 offset:0
ds_read_b64_tr_b16 v[178:179], v8 offset:512
v_mfma_f32_16x16x32_bf16 v[36:39], v[156:159], v[132:135], v[36:39]
ds_read_b64_tr_b16 v[180:181], v8 offset:4096
v_mfma_f32_16x16x32_bf16 v[40:43], v[144:147], v[136:139], v[40:43]
ds_read_b64_tr_b16 v[182:183], v8 offset:4608
ds_read_b64_tr_b16 v[184:185], v9 offset:0
v_mfma_f32_16x16x32_bf16 v[40:43], v[148:151], v[140:143], v[40:43]
ds_read_b64_tr_b16 v[186:187], v9 offset:512
ds_read_b64_tr_b16 v[188:189], v9 offset:4096
v_mfma_f32_16x16x32_bf16 v[44:47], v[152:155], v[136:139], v[44:47]
ds_read_b64_tr_b16 v[190:191], v9 offset:4608
v_mfma_f32_16x16x32_bf16 v[44:47], v[156:159], v[140:143], v[44:47]
s_mov_b64 exec, 1
ds_write_b32 v3, v4
s_mov_b64 exec, -1
s_waitcnt lgkmcnt(14)
v_readfirstlane_b32 s33, v6
v_readfirstlane_b32 s57, v7
s_sub_u32 s33, s33, 1
s_lshr_b32 s66, s33, 7
s_mov_b32 s73, -1
v_mfma_f32_16x16x32_bf16 v[48:51], v[112:115], v[160:163], v[48:51]
s_cmp_eq_u32 s66, s59
s_cbranch_scc1 patch_138
pback_139:
v_mfma_f32_16x16x32_bf16 v[48:51], v[116:119], v[164:167], v[48:51]
ds_read_b32 v10, v210 offset:2560
ds_read_b32 v11, v210 offset:2624
s_waitcnt lgkmcnt(14)
v_mul_f32 v16, v16, v192
v_mul_f32 v17, v17, v192
v_mul_f32 v18, v18, v192
v_mfma_f32_16x16x32_bf16 v[52:55], v[112:115], v[168:171], v[52:55]
v_mul_f32 v19, v19, v192
v_mul_f32 v20, v20, v192
v_mul_f32 v21, v21, v192
v_mul_f32 v22, v22, v192
v_mul_f32 v23, v23, v192
v_mfma_f32_16x16x32_bf16 v[52:55], v[116:119], v[172:175], v[52:55]
v_fmac_f32 v16, v200, v193
v_fmac_f32 v17, v201, v193
v_fmac_f32 v18, v202, v193
v_fmac_f32 v19, v203, v193
v_fmac_f32 v20, v204, v193
v_mfma_f32_16x16x32_bf16 v[56:59], v[120:123], v[160:163], v[56:59]
v_fmac_f32 v21, v205, v193
v_fmac_f32 v22, v206, v193
v_fmac_f32 v23, v207, v193
v_cvt_pk_bf16_f32 v16, v16, v17
v_cvt_pk_bf16_f32 v17, v18, v19
v_mfma_f32_16x16x32_bf16 v[56:59], v[124:127], v[164:167], v[56:59]
v_cvt_pk_bf16_f32 v18, v20, v21
v_cvt_pk_bf16_f32 v19, v22, v23
buffer_store_dwordx4 v[16:19], v12, s[20:23], s71 offen offset:0 sc1
ds_write_b128 v12, v[16:19] offset:0
ds_read_b128 v[144:147], v209 offset:0
v_mfma_f32_16x16x32_bf16 v[60:63], v[120:123], v[168:171], v[60:63]
ds_read_b128 v[20:23], v209 offset:512
s_waitcnt lgkmcnt(14)
v_mul_f32 v24, v24, v194
v_mul_f32 v25, v25, v194
v_mul_f32 v26, v26, v194
v_mul_f32 v27, v27, v194
v_mfma_f32_16x16x32_bf16 v[60:63], v[124:127], v[172:175], v[60:63]
v_mul_f32 v28, v28, v194
v_mul_f32 v29, v29, v194
v_mul_f32 v30, v30, v194
v_mul_f32 v31, v31, v194
v_fmac_f32 v24, v200, v195
v_mfma_f32_16x16x32_bf16 v[64:67], v[128:131], v[160:163], v[64:67]
v_fmac_f32 v25, v201, v195
v_fmac_f32 v26, v202, v195
v_fmac_f32 v27, v203, v195
v_fmac_f32 v28, v204, v195
v_mfma_f32_16x16x32_bf16 v[64:67], v[132:135], v[164:167], v[64:67]
v_fmac_f32 v29, v205, v195
v_fmac_f32 v30, v206, v195
v_fmac_f32 v31, v207, v195
v_cvt_pk_bf16_f32 v24, v24, v25
v_cvt_pk_bf16_f32 v25, v26, v27
v_mfma_f32_16x16x32_bf16 v[68:71], v[128:131], v[168:171], v[68:71]
v_cvt_pk_bf16_f32 v26, v28, v29
v_cvt_pk_bf16_f32 v27, v30, v31
buffer_store_dwordx4 v[24:27], v12, s[20:23], s71 offen offset:128 sc1
ds_write_b128 v12, v[24:27] offset:128
ds_read_b128 v[148:151], v209 offset:64
v_mfma_f32_16x16x32_bf16 v[68:71], v[132:135], v[172:175], v[68:71]
ds_read_b128 v[28:31], v209 offset:576
v_mul_f32 v32, v32, v196
v_mul_f32 v33, v33, v196
v_mul_f32 v34, v34, v196
v_mul_f32 v35, v35, v196
v_mfma_f32_16x16x32_bf16 v[72:75], v[136:139], v[160:163], v[72:75]
v_mul_f32 v36, v36, v196
v_mul_f32 v37, v37, v196
v_mul_f32 v38, v38, v196
v_mul_f32 v39, v39, v196
v_fmac_f32 v32, v200, v197
v_mfma_f32_16x16x32_bf16 v[72:75], v[140:143], v[164:167], v[72:75]
v_fmac_f32 v33, v201, v197
v_fmac_f32 v34, v202, v197
v_fmac_f32 v35, v203, v197
v_fmac_f32 v36, v204, v197
v_fmac_f32 v37, v205, v197
v_mfma_f32_16x16x32_bf16 v[76:79], v[136:139], v[168:171], v[76:79]
v_fmac_f32 v38, v206, v197
v_fmac_f32 v39, v207, v197
v_cvt_pk_bf16_f32 v32, v32, v33
v_cvt_pk_bf16_f32 v33, v34, v35
v_cvt_pk_bf16_f32 v34, v36, v37
v_mfma_f32_16x16x32_bf16 v[76:79], v[140:143], v[172:175], v[76:79]
v_cvt_pk_bf16_f32 v35, v38, v39
buffer_store_dwordx4 v[32:35], v13, s[20:23], s71 offen offset:0 sc1
ds_write_b128 v13, v[32:35] offset:0
ds_read_b128 v[152:155], v209 offset:128
ds_read_b128 v[36:39], v209 offset:640
v_mul_f32 v40, v40, v198
v_mul_f32 v41, v41, v198
v_mul_f32 v42, v42, v198
v_mul_f32 v43, v43, v198
v_mul_f32 v44, v44, v198
v_mul_f32 v45, v45, v198
v_mul_f32 v46, v46, v198
v_mul_f32 v47, v47, v198
v_fmac_f32 v40, v200, v199
v_fmac_f32 v41, v201, v199
v_fmac_f32 v42, v202, v199
v_fmac_f32 v43, v203, v199
v_fmac_f32 v44, v204, v199
v_fmac_f32 v45, v205, v199
v_fmac_f32 v46, v206, v199
v_fmac_f32 v47, v207, v199
v_cvt_pk_bf16_f32 v40, v40, v41
v_cvt_pk_bf16_f32 v41, v42, v43
v_cvt_pk_bf16_f32 v42, v44, v45
v_cvt_pk_bf16_f32 v43, v46, v47
buffer_store_dwordx4 v[40:43], v13, s[20:23], s71 offen offset:128 sc1
ds_write_b128 v13, v[40:43] offset:128
ds_read_b128 v[156:159], v209 offset:192
ds_read_b128 v[44:47], v209 offset:704
s_cmp_ge_i32 s73, 0
s_cbranch_scc1 patch_140
pback_141:
ds_read_b128 v[160:163], v211 offset:2304
ds_read_b128 v[164:167], v211 offset:2368
s_waitcnt lgkmcnt(12)
v_pk_mul_f32 v[48:49], v[48:49], v[144:145]
v_pk_mul_f32 v[50:51], v[50:51], v[146:147]
s_waitcnt lgkmcnt(11)
v_pk_fma_f32 v[48:49], v[20:21], v[10:11], v[48:49] op_sel:[0,0,0] op_sel_hi:[1,0,1]
v_pk_fma_f32 v[50:51], v[22:23], v[10:11], v[50:51] op_sel:[0,0,0] op_sel_hi:[1,0,1]
s_waitcnt lgkmcnt(9)
v_pk_mul_f32 v[56:57], v[56:57], v[148:149]
v_pk_mul_f32 v[58:59], v[58:59], v[150:151]
s_waitcnt lgkmcnt(8)
v_pk_fma_f32 v[56:57], v[28:29], v[10:11], v[56:57] op_sel:[0,0,0] op_sel_hi:[1,0,1]
v_pk_fma_f32 v[58:59], v[30:31], v[10:11], v[58:59] op_sel:[0,0,0] op_sel_hi:[1,0,1]
v_cvt_pk_bf16_f32 v48, v48, v49
v_cvt_pk_bf16_f32 v49, v50, v51
v_cvt_pk_bf16_f32 v50, v56, v57
v_cvt_pk_bf16_f32 v51, v58, v59
buffer_store_dwordx4 v[48:51], v14, s[20:23], s71 offen offset:2048 sc1
ds_write_b128 v14, v[48:51] offset:2048
v_pk_mul_f32 v[52:53], v[52:53], v[144:145]
v_pk_mul_f32 v[54:55], v[54:55], v[146:147]
v_pk_fma_f32 v[52:53], v[20:21], v[10:11], v[52:53] op_sel:[0,1,0] op_sel_hi:[1,1,1]
v_pk_fma_f32 v[54:55], v[22:23], v[10:11], v[54:55] op_sel:[0,1,0] op_sel_hi:[1,1,1]
v_pk_mul_f32 v[60:61], v[60:61], v[148:149]
v_pk_mul_f32 v[62:63], v[62:63], v[150:151]
v_pk_fma_f32 v[60:61], v[28:29], v[10:11], v[60:61] op_sel:[0,1,0] op_sel_hi:[1,1,1]
v_pk_fma_f32 v[62:63], v[30:31], v[10:11], v[62:63] op_sel:[0,1,0] op_sel_hi:[1,1,1]
v_cvt_pk_bf16_f32 v52, v52, v53
v_cvt_pk_bf16_f32 v53, v54, v55
v_cvt_pk_bf16_f32 v54, v60, v61
v_cvt_pk_bf16_f32 v55, v62, v63
buffer_store_dwordx4 v[52:55], v14, s[20:23], s71 offen offset:2304 sc1
ds_write_b128 v14, v[52:55] offset:2304
s_waitcnt lgkmcnt(8)
v_pk_mul_f32 v[64:65], v[64:65], v[152:153]
v_pk_mul_f32 v[66:67], v[66:67], v[154:155]
s_waitcnt lgkmcnt(7)
v_pk_fma_f32 v[64:65], v[36:37], v[10:11], v[64:65] op_sel:[0,0,0] op_sel_hi:[1,0,1]
v_pk_fma_f32 v[66:67], v[38:39], v[10:11], v[66:67] op_sel:[0,0,0] op_sel_hi:[1,0,1]
s_waitcnt lgkmcnt(5)
v_pk_mul_f32 v[72:73], v[72:73], v[156:157]
v_pk_mul_f32 v[74:75], v[74:75], v[158:159]
s_waitcnt lgkmcnt(4)
v_pk_fma_f32 v[72:73], v[44:45], v[10:11], v[72:73] op_sel:[0,0,0] op_sel_hi:[1,0,1]
v_pk_fma_f32 v[74:75], v[46:47], v[10:11], v[74:75] op_sel:[0,0,0] op_sel_hi:[1,0,1]
v_cvt_pk_bf16_f32 v64, v64, v65
v_cvt_pk_bf16_f32 v65, v66, v67
v_cvt_pk_bf16_f32 v66, v72, v73
v_cvt_pk_bf16_f32 v67, v74, v75
buffer_store_dwordx4 v[64:67], v15, s[20:23], s71 offen offset:2048 sc1
ds_write_b128 v15, v[64:67] offset:2048
v_pk_mul_f32 v[68:69], v[68:69], v[152:153]
v_pk_mul_f32 v[70:71], v[70:71], v[154:155]
v_pk_fma_f32 v[68:69], v[36:37], v[10:11], v[68:69] op_sel:[0,1,0] op_sel_hi:[1,1,1]
v_pk_fma_f32 v[70:71], v[38:39], v[10:11], v[70:71] op_sel:[0,1,0] op_sel_hi:[1,1,1]
v_pk_mul_f32 v[76:77], v[76:77], v[156:157]
v_pk_mul_f32 v[78:79], v[78:79], v[158:159]
v_pk_fma_f32 v[76:77], v[44:45], v[10:11], v[76:77] op_sel:[0,1,0] op_sel_hi:[1,1,1]
v_pk_fma_f32 v[78:79], v[46:47], v[10:11], v[78:79] op_sel:[0,1,0] op_sel_hi:[1,1,1]
v_cvt_pk_bf16_f32 v68, v68, v69
v_cvt_pk_bf16_f32 v69, v70, v71
v_cvt_pk_bf16_f32 v70, v76, v77
v_cvt_pk_bf16_f32 v71, v78, v79
buffer_store_dwordx4 v[68:71], v15, s[20:23], s71 offen offset:2304 sc1
ds_write_b128 v15, v[68:71] offset:2304
v_add_u32 v5, s34, 17
s_mov_b64 exec, 1
ds_write_b32 v3, v5
s_mov_b64 exec, -1
s_mov_b32 s66, 0x3e8293ee
v_mfma_f32_16x16x32_bf16 v[96:99], v[176:179], v[128:131], v[96:99]
v_mul_f32 v192, s66, v192
v_mfma_f32_16x16x32_bf16 v[96:99], v[180:183], v[132:135], v[96:99]
v_mfma_f32_16x16x32_bf16 v[100:103], v[184:187], v[128:131], v[100:103]
v_mul_f32 v193, s66, v193
v_mfma_f32_16x16x32_bf16 v[100:103], v[188:191], v[132:135], v[100:103]
v_mfma_f32_16x16x32_bf16 v[104:107], v[176:179], v[136:139], v[104:107]
v_mul_f32 v194, s66, v194
v_mfma_f32_16x16x32_bf16 v[104:107], v[180:183], v[140:143], v[104:107]
v_mfma_f32_16x16x32_bf16 v[108:111], v[184:187], v[136:139], v[108:111]
v_mul_f32 v195, s66, v195
v_mfma_f32_16x16x32_bf16 v[108:111], v[188:191], v[140:143], v[108:111]
v_mfma_f32_16x16x32_bf16 v[80:83], v[176:179], v[112:115], v[80:83]
v_mul_f32 v196, s66, v196
v_mfma_f32_16x16x32_bf16 v[80:83], v[180:183], v[116:119], v[80:83]
v_mfma_f32_16x16x32_bf16 v[84:87], v[184:187], v[112:115], v[84:87]
v_mul_f32 v197, s66, v197
v_mfma_f32_16x16x32_bf16 v[84:87], v[188:191], v[116:119], v[84:87]
v_mfma_f32_16x16x32_bf16 v[88:91], v[176:179], v[120:123], v[88:91]
v_mul_f32 v198, s66, v198
v_mfma_f32_16x16x32_bf16 v[88:91], v[180:183], v[124:127], v[88:91]
v_mfma_f32_16x16x32_bf16 v[92:95], v[184:187], v[120:123], v[92:95]
v_mul_f32 v199, s66, v199
v_mfma_f32_16x16x32_bf16 v[92:95], v[188:191], v[124:127], v[92:95]
s_cmp_ge_i32 s73, 0
s_cbranch_scc1 patch_142
pback_143:
v_mov_b32 v200, 0
v_mov_b32 v201, 0
v_mov_b32 v202, 0
v_mov_b32 v203, 0
v_mov_b32 v204, 0
v_mov_b32 v205, 0
v_mov_b32 v206, 0
v_mov_b32 v207, 0
v_mov_b32 v208, 0
v_mov_b32 v209, 0
v_mov_b32 v210, 0
v_mov_b32 v211, 0
v_pk_mul_f32 v[96:97], v[96:97], v[196:197] op_sel:[0,0] op_sel_hi:[1,0]
v_pk_mul_f32 v[98:99], v[98:99], v[196:197] op_sel:[0,0] op_sel_hi:[1,0]
v_pk_mul_f32 v[100:101], v[100:101], v[196:197] op_sel:[0,0] op_sel_hi:[1,0]
v_pk_mul_f32 v[102:103], v[102:103], v[196:197] op_sel:[0,0] op_sel_hi:[1,0]
s_waitcnt lgkmcnt(6)
v_pk_fma_f32 v[96:97], v[160:161], v[196:197], v[96:97] op_sel:[0,1,0] op_sel_hi:[1,1,1]
v_pk_fma_f32 v[98:99], v[162:163], v[196:197], v[98:99] op_sel:[0,1,0] op_sel_hi:[1,1,1]
s_waitcnt lgkmcnt(5)
v_pk_fma_f32 v[100:101], v[164:165], v[196:197], v[100:101] op_sel:[0,1,0] op_sel_hi:[1,1,1]
v_pk_fma_f32 v[102:103], v[166:167], v[196:197], v[102:103] op_sel:[0,1,0] op_sel_hi:[1,1,1]
v_cvt_pk_bf16_f32 v96, v96, v97
v_cvt_pk_bf16_f32 v97, v98, v99
v_cvt_pk_bf16_f32 v98, v100, v101
v_cvt_pk_bf16_f32 v99, v102, v103
v_pk_mul_f32 v[104:105], v[104:105], v[198:199] op_sel:[0,0] op_sel_hi:[1,0]
v_pk_mul_f32 v[106:107], v[106:107], v[198:199] op_sel:[0,0] op_sel_hi:[1,0]
v_pk_mul_f32 v[108:109], v[108:109], v[198:199] op_sel:[0,0] op_sel_hi:[1,0]
v_pk_mul_f32 v[110:111], v[110:111], v[198:199] op_sel:[0,0] op_sel_hi:[1,0]
v_pk_fma_f32 v[104:105], v[160:161], v[198:199], v[104:105] op_sel:[0,1,0] op_sel_hi:[1,1,1]
v_pk_fma_f32 v[106:107], v[162:163], v[198:199], v[106:107] op_sel:[0,1,0] op_sel_hi:[1,1,1]
v_pk_fma_f32 v[108:109], v[164:165], v[198:199], v[108:109] op_sel:[0,1,0] op_sel_hi:[1,1,1]
v_pk_fma_f32 v[110:111], v[166:167], v[198:199], v[110:111] op_sel:[0,1,0] op_sel_hi:[1,1,1]
v_cvt_pk_bf16_f32 v104, v104, v105
v_cvt_pk_bf16_f32 v105, v106, v107
v_cvt_pk_bf16_f32 v106, v108, v109
v_cvt_pk_bf16_f32 v107, v110, v111
v_pk_mul_f32 v[80:81], v[80:81], v[192:193] op_sel:[0,0] op_sel_hi:[1,0]
v_pk_mul_f32 v[82:83], v[82:83], v[192:193] op_sel:[0,0] op_sel_hi:[1,0]
v_pk_mul_f32 v[84:85], v[84:85], v[192:193] op_sel:[0,0] op_sel_hi:[1,0]
v_pk_mul_f32 v[86:87], v[86:87], v[192:193] op_sel:[0,0] op_sel_hi:[1,0]
v_pk_fma_f32 v[80:81], v[160:161], v[192:193], v[80:81] op_sel:[0,1,0] op_sel_hi:[1,1,1]
v_pk_fma_f32 v[82:83], v[162:163], v[192:193], v[82:83] op_sel:[0,1,0] op_sel_hi:[1,1,1]
v_pk_fma_f32 v[84:85], v[164:165], v[192:193], v[84:85] op_sel:[0,1,0] op_sel_hi:[1,1,1]
v_pk_fma_f32 v[86:87], v[166:167], v[192:193], v[86:87] op_sel:[0,1,0] op_sel_hi:[1,1,1]
v_cvt_pk_bf16_f32 v80, v80, v81
v_cvt_pk_bf16_f32 v81, v82, v83
v_cvt_pk_bf16_f32 v82, v84, v85
v_cvt_pk_bf16_f32 v83, v86, v87
v_pk_mul_f32 v[88:89], v[88:89], v[194:195] op_sel:[0,0] op_sel_hi:[1,0]
v_pk_mul_f32 v[90:91], v[90:91], v[194:195] op_sel:[0,0] op_sel_hi:[1,0]
v_pk_mul_f32 v[92:93], v[92:93], v[194:195] op_sel:[0,0] op_sel_hi:[1,0]
v_pk_mul_f32 v[94:95], v[94:95], v[194:195] op_sel:[0,0] op_sel_hi:[1,0]
v_pk_fma_f32 v[88:89], v[160:161], v[194:195], v[88:89] op_sel:[0,1,0] op_sel_hi:[1,1,1]
v_pk_fma_f32 v[90:91], v[162:163], v[194:195], v[90:91] op_sel:[0,1,0] op_sel_hi:[1,1,1]
v_pk_fma_f32 v[92:93], v[164:165], v[194:195], v[92:93] op_sel:[0,1,0] op_sel_hi:[1,1,1]
v_pk_fma_f32 v[94:95], v[166:167], v[194:195], v[94:95] op_sel:[0,1,0] op_sel_hi:[1,1,1]
v_cvt_pk_bf16_f32 v88, v88, v89
v_cvt_pk_bf16_f32 v89, v90, v91
v_cvt_pk_bf16_f32 v90, v92, v93
v_cvt_pk_bf16_f32 v91, v94, v95
v_permlane16_swap_b32 v96, v104
v_permlane16_swap_b32 v97, v105
v_permlane16_swap_b32 v98, v106
v_permlane16_swap_b32 v99, v107
v_permlane16_swap_b32 v80, v88
v_permlane16_swap_b32 v81, v89
v_permlane16_swap_b32 v82, v90
v_permlane16_swap_b32 v83, v91
v_mov_b32 v192, 0
v_mov_b32 v193, 0
v_mov_b32 v194, 0
v_mov_b32 v195, 0
v_mov_b32 v196, 0
v_mov_b32 v197, 0
v_mov_b32 v198, 0
v_mov_b32 v199, 0
s_lshl_b32 s69, s64, 12
v_lshl_add_u32 v6, v0, 4, s69
v_add_u32 v7, 131072, v6
s_lshl_b32 s69, s65, 13
s_add_u32 s66, s69, 131072
s_sub_u32 s69, 147456, s69
v_add_u32 v8, s69, v6
ds_read_b128 v[152:155], v8 offset:8192
ds_read_b128 v[156:159], v8 offset:9216
s_mov_b32 s67, 122880
s_min_u32 s69, s59, 1
s_lshl2_add_u32 s68, s69, s65
s_cmp_ge_u32 s59, 2
s_cselect_b32 s69, s65, 0
s_add_u32 s68, s68, s69
ds_read_b128 v[160:163], v8 offset:10240
ds_read_b128 v[164:167], v8 offset:11264
s_waitcnt lgkmcnt(3)
v_mfma_f32_32x32x16_bf16 v[112:127], v[152:155], v[96:99], v[216:231]
s_waitcnt lgkmcnt(2)
v_mfma_f32_32x32x16_bf16 v[112:127], v[156:159], v[104:107], v[112:127]
s_add_u32 s35, s34, 17
lw_144:
ds_read_b32 v5, v1 offset:0
s_waitcnt lgkmcnt(0)
v_cmp_gt_i32 vcc, s35, v5
s_cbranch_vccz lwd_145
s_sub_u32 s32, s32, 1
s_cmp_gt_i32 s32, 0
s_cbranch_scc1 lw_144
lwd_145:
ds_read_b128 v[152:155], v8 offset:0
ds_read_b128 v[156:159], v8 offset:1024
s_add_u32 s70, s72, 270336
s_mov_b64 exec, 1
s_waitcnt vmcnt(0)
buffer_store_dword v7, v3, s[24:27], s70 offen sc1
s_mov_b64 exec, -1
.p2align 3
v_exp_f32 v112, v112
v_exp_f32 v113, v113
v_exp_f32 v114, v114
v_exp_f32 v115, v115
v_exp_f32 v116, v116
v_exp_f32 v117, v117
s_waitcnt lgkmcnt(1)
v_mfma_f32_32x32x16_bf16 v[128:143], v[152:155], v[96:99], 0
v_exp_f32 v118, v118
v_exp_f32 v119, v119
v_cvt_pk_bf16_f32 v144, v112, v113
v_cvt_pk_bf16_f32 v145, v114, v115
s_waitcnt lgkmcnt(0)
v_mfma_f32_32x32x16_bf16 v[128:143], v[156:159], v[104:107], v[128:143]
ds_read_b128 v[152:155], v7 offset:8192
ds_read_b128 v[156:159], v7 offset:9216
v_cvt_pk_bf16_f32 v146, v116, v117
v_cvt_pk_bf16_f32 v147, v118, v119
v_exp_f32 v120, v120
v_exp_f32 v121, v121
v_mfma_f32_32x32x16_bf16 v[16:31], v[160:163], v[144:147], 0
ds_read_b128 v[160:163], v8 offset:2048
v_exp_f32 v122, v122
v_exp_f32 v123, v123
v_exp_f32 v124, v124
v_mfma_f32_16x16x32_bf16 v[32:35], v[212:215], v[144:147], 0
s_cmp_eq_u32 s65, 1
v_exp_f32 v125, v125
v_exp_f32 v126, v126
v_exp_f32 v127, v127
v_cvt_pk_bf16_f32 v148, v120, v121
v_cvt_pk_bf16_f32 v149, v122, v123
v_cvt_pk_bf16_f32 v150, v124, v125
v_cvt_pk_bf16_f32 v151, v126, v127
s_cbranch_scc1 at_146
v_exp_f32 v128, v128
v_exp_f32 v129, v129
v_mfma_f32_32x32x16_bf16 v[16:31], v[164:167], v[148:151], v[16:31]
ds_read_b128 v[164:167], v8 offset:3072
v_exp_f32 v130, v130
v_exp_f32 v131, v131
v_exp_f32 v132, v132
v_mfma_f32_16x16x32_bf16 v[32:35], v[212:215], v[148:151], v[32:35]
v_exp_f32 v133, v133
s_waitcnt lgkmcnt(3)
v_mfma_f32_32x32x16_bf16 v[112:127], v[152:155], v[96:99], 0
v_exp_f32 v134, v134
v_exp_f32 v135, v135
v_cvt_pk_bf16_f32 v144, v128, v129
v_cvt_pk_bf16_f32 v145, v130, v131
s_waitcnt lgkmcnt(2)
v_mfma_f32_32x32x16_bf16 v[112:127], v[156:159], v[104:107], v[112:127]
ds_read_b128 v[152:155], v7 offset:0
ds_read_b128 v[156:159], v7 offset:1024
v_cvt_pk_bf16_f32 v146, v132, v133
v_cvt_pk_bf16_f32 v147, v134, v135
v_exp_f32 v136, v136
v_exp_f32 v137, v137
s_waitcnt lgkmcnt(3)
v_mfma_f32_32x32x16_bf16 v[16:31], v[160:163], v[144:147], v[16:31]
ds_read_b128 v[160:163], v7 offset:10240
v_exp_f32 v138, v138
v_exp_f32 v139, v139
v_exp_f32 v140, v140
v_mfma_f32_16x16x32_bf16 v[32:35], v[212:215], v[144:147], v[32:35]
v_exp_f32 v141, v141
v_exp_f32 v142, v142
v_exp_f32 v143, v143
v_cvt_pk_bf16_f32 v148, v136, v137
v_cvt_pk_bf16_f32 v149, v138, v139
v_cvt_pk_bf16_f32 v150, v140, v141
v_cvt_pk_bf16_f32 v151, v142, v143
v_exp_f32 v112, v112
v_exp_f32 v113, v113
s_waitcnt lgkmcnt(3)
v_mfma_f32_32x32x16_bf16 v[16:31], v[164:167], v[148:151], v[16:31]
ds_read_b128 v[164:167], v7 offset:11264
v_exp_f32 v114, v114
v_exp_f32 v115, v115
v_exp_f32 v116, v116
v_mfma_f32_16x16x32_bf16 v[32:35], v[212:215], v[148:151], v[32:35]
v_exp_f32 v117, v117
s_waitcnt lgkmcnt(3)
v_mfma_f32_32x32x16_bf16 v[128:143], v[152:155], v[96:99], 0
v_exp_f32 v118, v118
v_exp_f32 v119, v119
v_cvt_pk_bf16_f32 v144, v112, v113
v_cvt_pk_bf16_f32 v145, v114, v115
s_waitcnt lgkmcnt(2)
v_mfma_f32_32x32x16_bf16 v[128:143], v[156:159], v[104:107], v[128:143]
v_cvt_pk_bf16_f32 v146, v116, v117
v_cvt_pk_bf16_f32 v147, v118, v119
v_exp_f32 v120, v120
v_exp_f32 v121, v121
s_waitcnt lgkmcnt(1)
v_mfma_f32_32x32x16_bf16 v[16:31], v[160:163], v[144:147], v[16:31]
ds_read_b128 v[160:163], v7 offset:2048
v_exp_f32 v122, v122
v_exp_f32 v123, v123
v_exp_f32 v124, v124
v_mfma_f32_16x16x32_bf16 v[32:35], v[212:215], v[144:147], v[32:35]
v_mov_b32 v8, v7
v_exp_f32 v125, v125
v_exp_f32 v126, v126
v_exp_f32 v127, v127
v_cvt_pk_bf16_f32 v148, v120, v121
v_cvt_pk_bf16_f32 v149, v122, v123
v_cvt_pk_bf16_f32 v150, v124, v125
v_cvt_pk_bf16_f32 v151, v126, v127
.p2align 3
at_146:
v_exp_f32 v128, v128
v_exp_f32 v129, v129
s_waitcnt lgkmcnt(1)
v_mfma_f32_32x32x16_bf16 v[16:31], v[164:167], v[148:151], v[16:31]
ds_read_b128 v[164:167], v8 offset:3072
v_exp_f32 v130, v130
v_exp_f32 v131, v131
v_exp_f32 v132, v132
v_mfma_f32_16x16x32_bf16 v[32:35], v[212:215], v[148:151], v[32:35]
v_exp_f32 v133, v133
v_mfma_f32_32x32x16_bf16 v[112:127], v[152:155], v[80:83], v[216:231]
v_exp_f32 v134, v134
v_exp_f32 v135, v135
v_cvt_pk_bf16_f32 v144, v128, v129
v_cvt_pk_bf16_f32 v145, v130, v131
v_mfma_f32_32x32x16_bf16 v[112:127], v[156:159], v[88:91], v[112:127]
s_sub_u32 s66, s66, 8192
s_cmp_eq_u32 s66, s67
s_cbranch_scc1 cross_153
cback_154:
v_add_u32 v8, s66, v6
ds_read_b128 v[152:155], v8 offset:0
ds_read_b128 v[156:159], v8 offset:1024
v_cvt_pk_bf16_f32 v146, v132, v133
v_cvt_pk_bf16_f32 v147, v134, v135
v_exp_f32 v136, v136
v_exp_f32 v137, v137
s_waitcnt lgkmcnt(3)
v_mfma_f32_32x32x16_bf16 v[16:31], v[160:163], v[144:147], v[16:31]
v_exp_f32 v138, v138
v_exp_f32 v139, v139
v_exp_f32 v140, v140
v_mfma_f32_16x16x32_bf16 v[32:35], v[212:215], v[144:147], v[32:35]
s_cmp_eq_u32 s68, 0
v_exp_f32 v141, v141
v_exp_f32 v142, v142
v_exp_f32 v143, v143
v_cvt_pk_bf16_f32 v148, v136, v137
v_cvt_pk_bf16_f32 v149, v138, v139
v_cvt_pk_bf16_f32 v150, v140, v141
v_cvt_pk_bf16_f32 v151, v142, v143
s_cbranch_scc1 at_150
.p2align 3
at_147:
v_exp_f32 v112, v112
v_exp_f32 v113, v113
s_waitcnt lgkmcnt(2)
v_mfma_f32_32x32x16_bf16 v[16:31], v[164:167], v[148:151], v[16:31]
v_exp_f32 v114, v114
v_exp_f32 v115, v115
v_exp_f32 v116, v116
v_mfma_f32_16x16x32_bf16 v[32:35], v[212:215], v[148:151], v[32:35]
v_exp_f32 v117, v117
s_waitcnt lgkmcnt(1)
v_mfma_f32_32x32x16_bf16 v[128:143], v[152:155], v[96:99], 0
v_exp_f32 v118, v118
v_exp_f32 v119, v119
v_cvt_pk_bf16_f32 v144, v112, v113
v_cvt_pk_bf16_f32 v145, v114, v115
s_waitcnt lgkmcnt(0)
v_mfma_f32_32x32x16_bf16 v[128:143], v[156:159], v[104:107], v[128:143]
v_cvt_pk_bf16_f32 v146, v116, v117
v_cvt_pk_bf16_f32 v147, v118, v119
v_exp_f32 v120, v120
v_exp_f32 v121, v121
v_mfma_f32_32x32x16_bf16 v[192:207], v[160:163], v[144:147], v[192:207]
ds_read_b128 v[160:163], v8 offset:2048
v_exp_f32 v122, v122
v_exp_f32 v123, v123
v_exp_f32 v124, v124
v_mfma_f32_16x16x32_bf16 v[208:211], v[212:215], v[144:147], v[208:211]
ds_read_b32 v5, v2 offset:16
s_add_u32 s35, s34, 21
v_exp_f32 v125, v125
v_exp_f32 v126, v126
v_exp_f32 v127, v127
v_cvt_pk_bf16_f32 v148, v120, v121
v_cvt_pk_bf16_f32 v149, v122, v123
v_cvt_pk_bf16_f32 v150, v124, v125
v_cvt_pk_bf16_f32 v151, v126, v127
v_exp_f32 v128, v128
v_exp_f32 v129, v129
v_mfma_f32_32x32x16_bf16 v[192:207], v[164:167], v[148:151], v[192:207]
ds_read_b128 v[164:167], v8 offset:3072
v_exp_f32 v130, v130
v_exp_f32 v131, v131
v_exp_f32 v132, v132
v_mfma_f32_16x16x32_bf16 v[208:211], v[212:215], v[148:151], v[208:211]
v_exp_f32 v133, v133
v_mfma_f32_32x32x16_bf16 v[112:127], v[152:155], v[80:83], 0
v_exp_f32 v134, v134
v_exp_f32 v135, v135
v_cvt_pk_bf16_f32 v144, v128, v129
v_cvt_pk_bf16_f32 v145, v130, v131
v_mfma_f32_32x32x16_bf16 v[112:127], v[156:159], v[88:91], v[112:127]
s_sub_u32 s66, s66, 8192
s_cmp_eq_u32 s66, s67
s_cbranch_scc1 cross_155
cback_156:
v_add_u32 v8, s66, v6
ds_read_b128 v[152:155], v8 offset:0
ds_read_b128 v[156:159], v8 offset:1024
v_cvt_pk_bf16_f32 v146, v132, v133
v_cvt_pk_bf16_f32 v147, v134, v135
v_exp_f32 v136, v136
v_exp_f32 v137, v137
s_waitcnt lgkmcnt(4)
v_mfma_f32_32x32x16_bf16 v[16:31], v[160:163], v[144:147], v[16:31]
v_exp_f32 v138, v138
v_exp_f32 v139, v139
v_exp_f32 v140, v140
v_mfma_f32_16x16x32_bf16 v[32:35], v[212:215], v[144:147], v[32:35]
s_sub_u32 s68, s68, 1
s_cmp_eq_u32 s68, 0
v_exp_f32 v141, v141
v_exp_f32 v142, v142
v_exp_f32 v143, v143
v_cvt_pk_bf16_f32 v148, v136, v137
v_cvt_pk_bf16_f32 v149, v138, v139
v_cvt_pk_bf16_f32 v150, v140, v141
v_cvt_pk_bf16_f32 v151, v142, v143
s_cbranch_scc0 at_147
s_cmp_lt_u32 s59, 2
s_cbranch_scc1 at_150
.p2align 3
v_exp_f32 v112, v112
v_exp_f32 v113, v113
s_waitcnt lgkmcnt(2)
v_mfma_f32_32x32x16_bf16 v[16:31], v[164:167], v[148:151], v[16:31]
v_exp_f32 v114, v114
v_exp_f32 v115, v115
v_exp_f32 v116, v116
v_mfma_f32_16x16x32_bf16 v[32:35], v[212:215], v[148:151], v[32:35]
v_exp_f32 v117, v117
s_waitcnt lgkmcnt(1)
v_mfma_f32_32x32x16_bf16 v[128:143], v[152:155], v[96:99], v[216:231]
v_exp_f32 v118, v118
v_exp_f32 v119, v119
v_cvt_pk_bf16_f32 v144, v112, v113
v_cvt_pk_bf16_f32 v145, v114, v115
s_waitcnt lgkmcnt(0)
v_mfma_f32_32x32x16_bf16 v[128:143], v[156:159], v[104:107], v[128:143]
v_cvt_pk_bf16_f32 v146, v116, v117
v_cvt_pk_bf16_f32 v147, v118, v119
v_exp_f32 v120, v120
v_exp_f32 v121, v121
v_mfma_f32_32x32x16_bf16 v[192:207], v[160:163], v[144:147], v[192:207]
ds_read_b128 v[160:163], v8 offset:2048
v_exp_f32 v122, v122
v_exp_f32 v123, v123
v_exp_f32 v124, v124
v_mfma_f32_16x16x32_bf16 v[208:211], v[212:215], v[144:147], v[208:211]
v_exp_f32 v125, v125
v_exp_f32 v126, v126
v_exp_f32 v127, v127
v_cvt_pk_bf16_f32 v148, v120, v121
v_cvt_pk_bf16_f32 v149, v122, v123
v_cvt_pk_bf16_f32 v150, v124, v125
v_cvt_pk_bf16_f32 v151, v126, v127
v_exp_f32 v128, v128
v_exp_f32 v129, v129
v_mfma_f32_32x32x16_bf16 v[192:207], v[164:167], v[148:151], v[192:207]
ds_read_b128 v[164:167], v8 offset:3072
v_exp_f32 v130, v130
v_exp_f32 v131, v131
v_exp_f32 v132, v132
v_mfma_f32_16x16x32_bf16 v[208:211], v[212:215], v[148:151], v[208:211]
v_exp_f32 v133, v133
v_mfma_f32_32x32x16_bf16 v[112:127], v[152:155], v[80:83], 0
v_exp_f32 v134, v134
v_exp_f32 v135, v135
v_cvt_pk_bf16_f32 v144, v128, v129
v_cvt_pk_bf16_f32 v145, v130, v131
v_mfma_f32_32x32x16_bf16 v[112:127], v[156:159], v[88:91], v[112:127]
v_subrev_u32 v8, 8192, v8
ds_read_b128 v[152:155], v8 offset:0
ds_read_b128 v[156:159], v8 offset:1024
v_cvt_pk_bf16_f32 v146, v132, v133
v_cvt_pk_bf16_f32 v147, v134, v135
v_exp_f32 v136, v136
v_exp_f32 v137, v137
s_waitcnt lgkmcnt(3)
v_mfma_f32_32x32x16_bf16 v[16:31], v[160:163], v[144:147], v[16:31]
v_exp_f32 v138, v138
v_exp_f32 v139, v139
v_exp_f32 v140, v140
v_mfma_f32_16x16x32_bf16 v[32:35], v[212:215], v[144:147], v[32:35]
s_cmp_eq_u32 s65, 1
v_exp_f32 v141, v141
v_exp_f32 v142, v142
v_exp_f32 v143, v143
v_cvt_pk_bf16_f32 v148, v136, v137
v_cvt_pk_bf16_f32 v149, v138, v139
v_cvt_pk_bf16_f32 v150, v140, v141
v_cvt_pk_bf16_f32 v151, v142, v143
s_cbranch_scc1 at_149
.p2align 3
v_exp_f32 v112, v112
v_exp_f32 v113, v113
s_waitcnt lgkmcnt(2)
v_mfma_f32_32x32x16_bf16 v[16:31], v[164:167], v[148:151], v[16:31]
v_exp_f32 v114, v114
v_exp_f32 v115, v115
v_exp_f32 v116, v116
v_mfma_f32_16x16x32_bf16 v[32:35], v[212:215], v[148:151], v[32:35]
v_exp_f32 v117, v117
s_waitcnt lgkmcnt(1)
v_mfma_f32_32x32x16_bf16 v[128:143], v[152:155], v[80:83], 0
v_exp_f32 v118, v118
v_exp_f32 v119, v119
v_cvt_pk_bf16_f32 v144, v112, v113
v_cvt_pk_bf16_f32 v145, v114, v115
s_waitcnt lgkmcnt(0)
v_mfma_f32_32x32x16_bf16 v[128:143], v[156:159], v[88:91], v[128:143]
v_subrev_u32 v8, 8192, v8
ds_read_b128 v[152:155], v8 offset:0
ds_read_b128 v[156:159], v8 offset:1024
v_cvt_pk_bf16_f32 v146, v116, v117
v_cvt_pk_bf16_f32 v147, v118, v119
v_exp_f32 v120, v120
v_exp_f32 v121, v121
v_mfma_f32_32x32x16_bf16 v[192:207], v[160:163], v[144:147], v[192:207]
ds_read_b128 v[160:163], v8 offset:10240
v_exp_f32 v122, v122
v_exp_f32 v123, v123
v_exp_f32 v124, v124
v_mfma_f32_16x16x32_bf16 v[208:211], v[212:215], v[144:147], v[208:211]
v_exp_f32 v125, v125
v_exp_f32 v126, v126
v_exp_f32 v127, v127
v_cvt_pk_bf16_f32 v148, v120, v121
v_cvt_pk_bf16_f32 v149, v122, v123
v_cvt_pk_bf16_f32 v150, v124, v125
v_cvt_pk_bf16_f32 v151, v126, v127
v_exp_f32 v128, v128
v_exp_f32 v129, v129
v_mfma_f32_32x32x16_bf16 v[192:207], v[164:167], v[148:151], v[192:207]
ds_read_b128 v[164:167], v8 offset:11264
v_exp_f32 v130, v130
v_exp_f32 v131, v131
v_exp_f32 v132, v132
v_mfma_f32_16x16x32_bf16 v[208:211], v[212:215], v[148:151], v[208:211]
v_exp_f32 v133, v133
s_waitcnt lgkmcnt(3)
v_mfma_f32_32x32x16_bf16 v[112:127], v[152:155], v[80:83], 0
v_exp_f32 v134, v134
v_exp_f32 v135, v135
v_cvt_pk_bf16_f32 v144, v128, v129
v_cvt_pk_bf16_f32 v145, v130, v131
s_waitcnt lgkmcnt(2)
v_mfma_f32_32x32x16_bf16 v[112:127], v[156:159], v[88:91], v[112:127]
v_subrev_u32 v8, 8192, v8
ds_read_b128 v[152:155], v8 offset:0
ds_read_b128 v[156:159], v8 offset:1024
v_cvt_pk_bf16_f32 v146, v132, v133
v_cvt_pk_bf16_f32 v147, v134, v135
v_exp_f32 v136, v136
v_exp_f32 v137, v137
s_waitcnt lgkmcnt(3)
v_mfma_f32_32x32x16_bf16 v[192:207], v[160:163], v[144:147], v[192:207]
ds_read_b128 v[160:163], v8 offset:10240
v_exp_f32 v138, v138
v_exp_f32 v139, v139
v_exp_f32 v140, v140
v_mfma_f32_16x16x32_bf16 v[208:211], v[212:215], v[144:147], v[208:211]
v_exp_f32 v141, v141
v_exp_f32 v142, v142
v_exp_f32 v143, v143
v_cvt_pk_bf16_f32 v148, v136, v137
v_cvt_pk_bf16_f32 v149, v138, v139
v_cvt_pk_bf16_f32 v150, v140, v141
v_cvt_pk_bf16_f32 v151, v142, v143
v_exp_f32 v112, v112
v_exp_f32 v113, v113
s_waitcnt lgkmcnt(3)
v_mfma_f32_32x32x16_bf16 v[192:207], v[164:167], v[148:151], v[192:207]
ds_read_b128 v[164:167], v8 offset:11264
v_exp_f32 v114, v114
v_exp_f32 v115, v115
v_exp_f32 v116, v116
v_mfma_f32_16x16x32_bf16 v[208:211], v[212:215], v[148:151], v[208:211]
v_exp_f32 v117, v117
s_waitcnt lgkmcnt(3)
v_mfma_f32_32x32x16_bf16 v[128:143], v[152:155], v[80:83], v[216:231]
v_exp_f32 v118, v118
v_exp_f32 v119, v119
v_cvt_pk_bf16_f32 v144, v112, v113
v_cvt_pk_bf16_f32 v145, v114, v115
s_waitcnt lgkmcnt(2)
v_mfma_f32_32x32x16_bf16 v[128:143], v[156:159], v[88:91], v[128:143]
v_cvt_pk_bf16_f32 v146, v116, v117
v_cvt_pk_bf16_f32 v147, v118, v119
v_exp_f32 v120, v120
v_exp_f32 v121, v121
s_waitcnt lgkmcnt(1)
v_mfma_f32_32x32x16_bf16 v[192:207], v[160:163], v[144:147], v[192:207]
ds_read_b128 v[160:163], v8 offset:2048
v_exp_f32 v122, v122
v_exp_f32 v123, v123
v_exp_f32 v124, v124
v_mfma_f32_16x16x32_bf16 v[208:211], v[212:215], v[144:147], v[208:211]
v_exp_f32 v125, v125
v_exp_f32 v126, v126
v_exp_f32 v127, v127
v_cvt_pk_bf16_f32 v148, v120, v121
v_cvt_pk_bf16_f32 v149, v122, v123
v_cvt_pk_bf16_f32 v150, v124, v125
v_cvt_pk_bf16_f32 v151, v126, v127
s_branch at_151
.p2align 3
at_150:
s_waitcnt lgkmcnt(3)
v_add_u32 v5, s34, 20
s_mov_b64 exec, 1
ds_write_b32 v3, v5
s_mov_b64 exec, -1
v_exp_f32 v112, v112
v_exp_f32 v113, v113
s_waitcnt lgkmcnt(3)
v_mfma_f32_32x32x16_bf16 v[16:31], v[164:167], v[148:151], v[16:31]
v_exp_f32 v114, v114
v_exp_f32 v115, v115
v_exp_f32 v116, v116
v_mfma_f32_16x16x32_bf16 v[32:35], v[212:215], v[148:151], v[32:35]
v_exp_f32 v117, v117
v_exp_f32 v118, v118
v_exp_f32 v119, v119
v_cvt_pk_bf16_f32 v144, v112, v113
v_cvt_pk_bf16_f32 v145, v114, v115
v_cvt_pk_bf16_f32 v146, v116, v117
v_cvt_pk_bf16_f32 v147, v118, v119
v_exp_f32 v120, v120
v_exp_f32 v121, v121
v_mfma_f32_32x32x16_bf16 v[192:207], v[160:163], v[144:147], v[192:207]
v_exp_f32 v122, v122
v_exp_f32 v123, v123
v_exp_f32 v124, v124
v_mfma_f32_16x16x32_bf16 v[208:211], v[212:215], v[144:147], v[208:211]
v_exp_f32 v125, v125
v_exp_f32 v126, v126
v_exp_f32 v127, v127
v_cvt_pk_bf16_f32 v148, v120, v121
v_cvt_pk_bf16_f32 v149, v122, v123
v_cvt_pk_bf16_f32 v150, v124, v125
v_cvt_pk_bf16_f32 v151, v126, v127
s_branch at_152
.p2align 3
at_149:
v_exp_f32 v112, v112
v_exp_f32 v113, v113
s_waitcnt lgkmcnt(2)
v_mfma_f32_32x32x16_bf16 v[16:31], v[164:167], v[148:151], v[16:31]
v_exp_f32 v114, v114
v_exp_f32 v115, v115
v_exp_f32 v116, v116
v_mfma_f32_16x16x32_bf16 v[32:35], v[212:215], v[148:151], v[32:35]
v_exp_f32 v117, v117
s_waitcnt lgkmcnt(1)
v_mfma_f32_32x32x16_bf16 v[128:143], v[152:155], v[80:83], v[216:231]
v_exp_f32 v118, v118
v_exp_f32 v119, v119
v_cvt_pk_bf16_f32 v144, v112, v113
v_cvt_pk_bf16_f32 v145, v114, v115
s_waitcnt lgkmcnt(0)
v_mfma_f32_32x32x16_bf16 v[128:143], v[156:159], v[88:91], v[128:143]
v_cvt_pk_bf16_f32 v146, v116, v117
v_cvt_pk_bf16_f32 v147, v118, v119
v_exp_f32 v120, v120
v_exp_f32 v121, v121
v_mfma_f32_32x32x16_bf16 v[192:207], v[160:163], v[144:147], v[192:207]
ds_read_b128 v[160:163], v8 offset:2048
v_exp_f32 v122, v122
v_exp_f32 v123, v123
v_exp_f32 v124, v124
v_mfma_f32_16x16x32_bf16 v[208:211], v[212:215], v[144:147], v[208:211]
v_exp_f32 v125, v125
v_exp_f32 v126, v126
v_exp_f32 v127, v127
v_cvt_pk_bf16_f32 v148, v120, v121
v_cvt_pk_bf16_f32 v149, v122, v123
v_cvt_pk_bf16_f32 v150, v124, v125
v_cvt_pk_bf16_f32 v151, v126, v127
.p2align 3
at_151:
v_exp_f32 v128, v128
v_exp_f32 v129, v129
s_waitcnt lgkmcnt(1)
v_mfma_f32_32x32x16_bf16 v[192:207], v[164:167], v[148:151], v[192:207]
ds_read_b128 v[164:167], v8 offset:3072
v_exp_f32 v130, v130
v_exp_f32 v131, v131
v_exp_f32 v132, v132
v_mfma_f32_16x16x32_bf16 v[208:211], v[212:215], v[148:151], v[208:211]
v_exp_f32 v133, v133
v_exp_f32 v134, v134
v_exp_f32 v135, v135
v_cvt_pk_bf16_f32 v144, v128, v129
v_cvt_pk_bf16_f32 v145, v130, v131
v_add_u32 v5, s34, 20
s_mov_b64 exec, 1
ds_write_b32 v3, v5
s_mov_b64 exec, -1
v_cvt_pk_bf16_f32 v146, v132, v133
v_cvt_pk_bf16_f32 v147, v134, v135
v_exp_f32 v136, v136
v_exp_f32 v137, v137
s_waitcnt lgkmcnt(2)
v_mfma_f32_32x32x16_bf16 v[192:207], v[160:163], v[144:147], v[192:207]
v_exp_f32 v138, v138
v_exp_f32 v139, v139
v_exp_f32 v140, v140
v_mfma_f32_16x16x32_bf16 v[208:211], v[212:215], v[144:147], v[208:211]
v_exp_f32 v141, v141
v_exp_f32 v142, v142
v_exp_f32 v143, v143
v_cvt_pk_bf16_f32 v148, v136, v137
v_cvt_pk_bf16_f32 v149, v138, v139
v_cvt_pk_bf16_f32 v150, v140, v141
v_cvt_pk_bf16_f32 v151, v142, v143
at_152:
s_lshl_b32 s66, s59, 18
s_lshl_b32 s67, s63, 22
v_mfma_f32_16x16x32_bf16 v[208:211], v[212:215], v[148:151], v[208:211]
s_add_u32 s66, s66, s67
s_lshl1_add_u32 s67, s60, s64
s_waitcnt lgkmcnt(1)
v_mfma_f32_32x32x16_bf16 v[192:207], v[164:167], v[148:151], v[192:207]
s_lshl_b32 s67, s67, 11
s_add_u32 s66, s66, s67
s_lshl_b32 s68, s65, 16
s_add_u32 s67, s66, 18022400
s_sub_u32 s67, s67, s68
s_add_u32 s66, s66, s68
s_add_u32 s66, s66, 17825792
v_lshlrev_b32 v9, 4, v0
v_subrev_u32 v10, 0x2f800000, v32
v_subrev_u32 v11, 0x2f800000, v208
v_max_u32 v10, v10, v11
v_cmp_lt_u32 vcc, 0x20000000, v10
s_cbranch_vccnz slow_157
sback_158:
s_nop 1
v_rcp_f32 v12, v32
s_nop 1
v_pk_mul_f32 v[16:17], v[16:17], v[12:13] op_sel:[0,0] op_sel_hi:[1,0]
v_pk_mul_f32 v[18:19], v[18:19], v[12:13] op_sel:[0,0] op_sel_hi:[1,0]
v_pk_mul_f32 v[20:21], v[20:21], v[12:13] op_sel:[0,0] op_sel_hi:[1,0]
v_pk_mul_f32 v[22:23], v[22:23], v[12:13] op_sel:[0,0] op_sel_hi:[1,0]
v_pk_mul_f32 v[24:25], v[24:25], v[12:13] op_sel:[0,0] op_sel_hi:[1,0]
v_pk_mul_f32 v[26:27], v[26:27], v[12:13] op_sel:[0,0] op_sel_hi:[1,0]
v_pk_mul_f32 v[28:29], v[28:29], v[12:13] op_sel:[0,0] op_sel_hi:[1,0]
v_pk_mul_f32 v[30:31], v[30:31], v[12:13] op_sel:[0,0] op_sel_hi:[1,0]
v_cvt_pk_bf16_f32 v16, v16, v17
v_cvt_pk_bf16_f32 v17, v18, v19
v_cvt_pk_bf16_f32 v18, v20, v21
v_cvt_pk_bf16_f32 v19, v22, v23
v_cvt_pk_bf16_f32 v20, v24, v25
v_cvt_pk_bf16_f32 v21, v26, v27
v_cvt_pk_bf16_f32 v22, v28, v29
v_cvt_pk_bf16_f32 v23, v30, v31
s_cmp_eq_u32 s57, 0
s_cbranch_scc1 far_159
buffer_store_dwordx4 v[16:19], v9, s[20:23], s67 offen offset:0
buffer_store_dwordx4 v[20:23], v9, s[20:23], s67 offen offset:1024
near_160:
v_rcp_f32 v12, v208
s_nop 0
v_pk_mul_f32 v[192:193], v[192:193], v[12:13] op_sel:[0,0] op_sel_hi:[1,0]
v_pk_mul_f32 v[194:195], v[194:195], v[12:13] op_sel:[0,0] op_sel_hi:[1,0]
v_pk_mul_f32 v[196:197], v[196:197], v[12:13] op_sel:[0,0] op_sel_hi:[1,0]
v_pk_mul_f32 v[198:199], v[198:199], v[12:13] op_sel:[0,0] op_sel_hi:[1,0]
v_pk_mul_f32 v[200:201], v[200:201], v[12:13] op_sel:[0,0] op_sel_hi:[1,0]
v_pk_mul_f32 v[202:203], v[202:203], v[12:13] op_sel:[0,0] op_sel_hi:[1,0]
v_pk_mul_f32 v[204:205], v[204:205], v[12:13] op_sel:[0,0] op_sel_hi:[1,0]
v_pk_mul_f32 v[206:207], v[206:207], v[12:13] op_sel:[0,0] op_sel_hi:[1,0]
v_cvt_pk_bf16_f32 v192, v192, v193
v_cvt_pk_bf16_f32 v193, v194, v195
v_cvt_pk_bf16_f32 v194, v196, v197
v_cvt_pk_bf16_f32 v195, v198, v199
v_cvt_pk_bf16_f32 v196, v200, v201
v_cvt_pk_bf16_f32 v197, v202, v203
v_cvt_pk_bf16_f32 v198, v204, v205
v_cvt_pk_bf16_f32 v199, v206, v207
s_cmp_eq_u32 s57, 0
s_cbranch_scc1 far_161
buffer_store_dwordx4 v[192:195], v9, s[20:23], s66 offen offset:0
buffer_store_dwordx4 v[196:199], v9, s[20:23], s66 offen offset:1024
near_162:
v_bfe_u32 v48, v0, 2, 3
v_lshrrev_b32 v49, 5, v0
v_lshl_add_u32 v48, v49, 4, v48
v_lshlrev_b32 v48, 7, v48
v_bfe_u32 v49, v0, 3, 2
v_lshl_add_u32 v48, v49, 5, v48
v_and_b32 v49, 3, v0
v_lshl_add_u32 v48, v49, 3, v48
v_add_u32 v8, 32768, v48
v_xor_b32 v9, 32, v8
v_xor_b32 v10, 64, v8
v_xor_b32 v11, 96, v8
v_add_u32 v12, 0x10000, v8
v_add_u32 v13, 0x10000, v9
v_add_u32 v14, 0x10000, v10
v_add_u32 v15, 0x10000, v11
v_and_b32 v48, 15, v0
v_lshrrev_b32 v49, 4, v0
s_lshl2_add_u32 s66, s61, s58
s_lshl_b32 s67, s66, 16
s_lshl_b32 s68, s63, 22
s_add_u32 s67, s67, s68
s_add_u32 s67, s67, 17825792
v_lshl_add_u32 v6, v48, 4, s67
v_lshl_add_u32 v6, v49, 9, v6
s_add_u32 s70, s72, 268288
s_add_u32 s35, s34, 3
lw_163:
ds_read_b32 v5, v2 offset:24
s_waitcnt lgkmcnt(0)
v_cmp_gt_i32 vcc, s35, v5
s_cbranch_vccz lwd_164
s_sub_u32 s32, s32, 1
s_cmp_gt_i32 s32, 0
s_cbranch_scc1 lw_163
lwd_164:
s_mov_b64 exec, 1
s_waitcnt vmcnt(0)
s_cmp_eq_u32 s57, 0
s_cbranch_scc1 far_165
buffer_store_dword v212, v3, s[24:27], s70 offen
near_166:
s_mov_b64 exec, -1
v_add_u32 v5, s34, 21
s_mov_b64 exec, 1
ds_write_b32 v3, v5
s_mov_b64 exec, -1
s_cmp_eq_u32 s63, 0
s_cbranch_scc0 mo_167
v_permlane16_swap_b32 v240, v242
v_permlane16_swap_b32 v241, v243
v_permlane16_swap_b32 v244, v246
v_permlane16_swap_b32 v245, v247
v_permlane16_swap_b32 v248, v250
v_permlane16_swap_b32 v249, v251
v_permlane16_swap_b32 v252, v254
v_permlane16_swap_b32 v253, v255
mo_168:
v_lshlrev_b32 v16, 16, v240
v_and_b32 v17, 0xffff0000, v240
v_lshlrev_b32 v18, 16, v241
v_and_b32 v19, 0xffff0000, v241
v_lshlrev_b32 v20, 16, v242
v_and_b32 v21, 0xffff0000, v242
v_lshlrev_b32 v22, 16, v243
v_and_b32 v23, 0xffff0000, v243
v_lshlrev_b32 v24, 16, v244
v_and_b32 v25, 0xffff0000, v244
v_lshlrev_b32 v26, 16, v245
v_and_b32 v27, 0xffff0000, v245
v_lshlrev_b32 v28, 16, v246
v_and_b32 v29, 0xffff0000, v246
v_lshlrev_b32 v30, 16, v247
v_and_b32 v31, 0xffff0000, v247
v_lshlrev_b32 v32, 16, v248
v_and_b32 v33, 0xffff0000, v248
v_lshlrev_b32 v34, 16, v249
v_and_b32 v35, 0xffff0000, v249
v_lshlrev_b32 v36, 16, v250
v_and_b32 v37, 0xffff0000, v250
v_lshlrev_b32 v38, 16, v251
v_and_b32 v39, 0xffff0000, v251
v_lshlrev_b32 v40, 16, v252
v_and_b32 v41, 0xffff0000, v252
v_lshlrev_b32 v42, 16, v253
v_and_b32 v43, 0xffff0000, v253
v_lshlrev_b32 v44, 16, v254
v_and_b32 v45, 0xffff0000, v254
v_lshlrev_b32 v46, 16, v255
v_and_b32 v47, 0xffff0000, v255
s_add_u32 s66, s61, s62
s_and_b32 s66, s66, 15
s_lshl_b32 s66, s66, 12
s_mov_b32 s69, 0x3f803f80
v_mov_b32 v208, 0
v_dot2c_f32_bf16 v208, s69, v232
v_dot2c_f32_bf16 v208, s69, v233
v_dot2c_f32_bf16 v208, s69, v234
v_dot2c_f32_bf16 v208, s69, v235
v_dot2c_f32_bf16 v208, s69, v236
v_dot2c_f32_bf16 v208, s69, v237
v_dot2c_f32_bf16 v208, s69, v238
v_dot2c_f32_bf16 v208, s69, v239
s_add_u32 s35, s34, 22
lw_169:
ds_read_b32 v5, v2 offset:16
s_waitcnt lgkmcnt(0)
v_cmp_gt_i32 vcc, s35, v5
s_cbranch_vccz lwd_170
s_sub_u32 s32, s32, 1
s_cmp_gt_i32 s32, 0
s_cbranch_scc1 lw_169
lwd_170:
buffer_load_dwordx4 v[80:83], v6, s[20:23], s66 offen offset:0 sc1
buffer_load_dwordx4 v[88:91], v6, s[20:23], s66 offen offset:2048 sc1
buffer_load_dwordx4 v[84:87], v6, s[20:23], s66 offen offset:256 sc1
buffer_load_dwordx4 v[92:95], v6, s[20:23], s66 offen offset:2304 sc1
s_add_u32 s66, s66, 4096
s_and_b32 s66, s66, 0xffff
ds_read_b64_tr_b16 v[48:49], v8 offset:0
ds_read_b64_tr_b16 v[50:51], v8 offset:1024
ds_read_b64_tr_b16 v[52:53], v8 offset:4096
ds_read_b64_tr_b16 v[54:55], v8 offset:5120
buffer_load_dwordx4 v[96:99], v6, s[20:23], s66 offen offset:0 sc1
buffer_load_dwordx4 v[104:107], v6, s[20:23], s66 offen offset:2048 sc1
buffer_load_dwordx4 v[100:103], v6, s[20:23], s66 offen offset:256 sc1
buffer_load_dwordx4 v[108:111], v6, s[20:23], s66 offen offset:2304 sc1
s_add_u32 s66, s66, 4096
s_and_b32 s66, s66, 0xffff
ds_read_b64_tr_b16 v[56:57], v9 offset:0
ds_read_b64_tr_b16 v[58:59], v9 offset:1024
ds_read_b64_tr_b16 v[60:61], v9 offset:4096
ds_read_b64_tr_b16 v[62:63], v9 offset:5120
buffer_load_dwordx4 v[112:115], v6, s[20:23], s66 offen offset:0 sc1
buffer_load_dwordx4 v[120:123], v6, s[20:23], s66 offen offset:2048 sc1
buffer_load_dwordx4 v[116:119], v6, s[20:23], s66 offen offset:256 sc1
buffer_load_dwordx4 v[124:127], v6, s[20:23], s66 offen offset:2304 sc1
s_add_u32 s66, s66, 4096
s_and_b32 s66, s66, 0xffff
ds_read_b64_tr_b16 v[64:65], v10 offset:0
ds_read_b64_tr_b16 v[66:67], v10 offset:1024
ds_read_b64_tr_b16 v[68:69], v10 offset:4096
ds_read_b64_tr_b16 v[70:71], v10 offset:5120
.p2align 3
s_waitcnt vmcnt(11) lgkmcnt(10)
v_mfma_f32_16x16x32_bf16 v[16:19], v[48:51], v[80:83], v[16:19]
ds_read_b64_tr_b16 v[72:73], v11 offset:0
buffer_load_dwordx4 v[128:131], v6, s[20:23], s66 offen offset:0 sc1
s_waitcnt vmcnt(11) lgkmcnt(9)
v_mfma_f32_16x16x32_bf16 v[16:19], v[52:55], v[88:91], v[16:19]
ds_read_b64_tr_b16 v[74:75], v11 offset:1024
s_waitcnt vmcnt(10)
v_mfma_f32_16x16x32_bf16 v[32:35], v[48:51], v[84:87], v[32:35]
ds_read_b64_tr_b16 v[76:77], v11 offset:4096
buffer_load_dwordx4 v[136:139], v6, s[20:23], s66 offen offset:2048 sc1
s_waitcnt vmcnt(10)
v_mfma_f32_16x16x32_bf16 v[32:35], v[52:55], v[92:95], v[32:35]
ds_read_b64_tr_b16 v[78:79], v11 offset:5120
s_waitcnt lgkmcnt(10)
v_mfma_f32_16x16x32_bf16 v[20:23], v[56:59], v[80:83], v[20:23]
ds_read_b64_tr_b16 v[48:49], v8 offset:8192
buffer_load_dwordx4 v[132:135], v6, s[20:23], s66 offen offset:256 sc1
s_waitcnt lgkmcnt(9)
v_mfma_f32_16x16x32_bf16 v[20:23], v[60:63], v[88:91], v[20:23]
ds_read_b64_tr_b16 v[50:51], v8 offset:9216
v_mfma_f32_16x16x32_bf16 v[36:39], v[56:59], v[84:87], v[36:39]
ds_read_b64_tr_b16 v[52:53], v8 offset:12288
buffer_load_dwordx4 v[140:143], v6, s[20:23], s66 offen offset:2304 sc1
s_add_u32 s66, s66, 4096
s_and_b32 s66, s66, 0xffff
v_mfma_f32_16x16x32_bf16 v[36:39], v[60:63], v[92:95], v[36:39]
ds_read_b64_tr_b16 v[54:55], v8 offset:13312
s_waitcnt lgkmcnt(10)
v_mfma_f32_16x16x32_bf16 v[24:27], v[64:67], v[80:83], v[24:27]
ds_read_b64_tr_b16 v[56:57], v9 offset:8192
s_waitcnt lgkmcnt(9)
v_mfma_f32_16x16x32_bf16 v[24:27], v[68:71], v[88:91], v[24:27]
ds_read_b64_tr_b16 v[58:59], v9 offset:9216
v_mfma_f32_16x16x32_bf16 v[40:43], v[64:67], v[84:87], v[40:43]
ds_read_b64_tr_b16 v[60:61], v9 offset:12288
v_mfma_f32_16x16x32_bf16 v[40:43], v[68:71], v[92:95], v[40:43]
ds_read_b64_tr_b16 v[62:63], v9 offset:13312
s_waitcnt lgkmcnt(10)
v_mfma_f32_16x16x32_bf16 v[28:31], v[72:75], v[80:83], v[28:31]
ds_read_b64_tr_b16 v[64:65], v10 offset:8192
s_waitcnt lgkmcnt(9)
v_mfma_f32_16x16x32_bf16 v[28:31], v[76:79], v[88:91], v[28:31]
ds_read_b64_tr_b16 v[66:67], v10 offset:9216
v_mfma_f32_16x16x32_bf16 v[44:47], v[72:75], v[84:87], v[44:47]
ds_read_b64_tr_b16 v[68:69], v10 offset:12288
v_mfma_f32_16x16x32_bf16 v[44:47], v[76:79], v[92:95], v[44:47]
ds_read_b64_tr_b16 v[70:71], v10 offset:13312
s_waitcnt vmcnt(11) lgkmcnt(10)
v_mfma_f32_16x16x32_bf16 v[16:19], v[48:51], v[96:99], v[16:19]
ds_read_b64_tr_b16 v[72:73], v11 offset:8192
buffer_load_dwordx4 v[144:147], v6, s[20:23], s66 offen offset:0 sc1
s_waitcnt vmcnt(11) lgkmcnt(9)
v_mfma_f32_16x16x32_bf16 v[16:19], v[52:55], v[104:107], v[16:19]
ds_read_b64_tr_b16 v[74:75], v11 offset:9216
s_waitcnt vmcnt(10)
v_mfma_f32_16x16x32_bf16 v[32:35], v[48:51], v[100:103], v[32:35]
ds_read_b64_tr_b16 v[76:77], v11 offset:12288
buffer_load_dwordx4 v[152:155], v6, s[20:23], s66 offen offset:2048 sc1
s_waitcnt vmcnt(10)
v_mfma_f32_16x16x32_bf16 v[32:35], v[52:55], v[108:111], v[32:35]
ds_read_b64_tr_b16 v[78:79], v11 offset:13312
s_waitcnt lgkmcnt(10)
v_mfma_f32_16x16x32_bf16 v[20:23], v[56:59], v[96:99], v[20:23]
ds_read_b64_tr_b16 v[48:49], v8 offset:16384
buffer_load_dwordx4 v[148:151], v6, s[20:23], s66 offen offset:256 sc1
s_waitcnt lgkmcnt(9)
v_mfma_f32_16x16x32_bf16 v[20:23], v[60:63], v[104:107], v[20:23]
ds_read_b64_tr_b16 v[50:51], v8 offset:17408
v_mfma_f32_16x16x32_bf16 v[36:39], v[56:59], v[100:103], v[36:39]
ds_read_b64_tr_b16 v[52:53], v8 offset:20480
buffer_load_dwordx4 v[156:159], v6, s[20:23], s66 offen offset:2304 sc1
s_add_u32 s66, s66, 4096
s_and_b32 s66, s66, 0xffff
v_mfma_f32_16x16x32_bf16 v[36:39], v[60:63], v[108:111], v[36:39]
ds_read_b64_tr_b16 v[54:55], v8 offset:21504
s_waitcnt lgkmcnt(10)
v_mfma_f32_16x16x32_bf16 v[24:27], v[64:67], v[96:99], v[24:27]
ds_read_b64_tr_b16 v[56:57], v9 offset:16384
s_waitcnt lgkmcnt(9)
v_mfma_f32_16x16x32_bf16 v[24:27], v[68:71], v[104:107], v[24:27]
ds_read_b64_tr_b16 v[58:59], v9 offset:17408
v_mfma_f32_16x16x32_bf16 v[40:43], v[64:67], v[100:103], v[40:43]
ds_read_b64_tr_b16 v[60:61], v9 offset:20480
v_mfma_f32_16x16x32_bf16 v[40:43], v[68:71], v[108:111], v[40:43]
ds_read_b64_tr_b16 v[62:63], v9 offset:21504
s_waitcnt lgkmcnt(10)
v_mfma_f32_16x16x32_bf16 v[28:31], v[72:75], v[96:99], v[28:31]
ds_read_b64_tr_b16 v[64:65], v10 offset:16384
s_waitcnt lgkmcnt(9)
v_mfma_f32_16x16x32_bf16 v[28:31], v[76:79], v[104:107], v[28:31]
ds_read_b64_tr_b16 v[66:67], v10 offset:17408
v_mfma_f32_16x16x32_bf16 v[44:47], v[72:75], v[100:103], v[44:47]
ds_read_b64_tr_b16 v[68:69], v10 offset:20480
v_mfma_f32_16x16x32_bf16 v[44:47], v[76:79], v[108:111], v[44:47]
ds_read_b64_tr_b16 v[70:71], v10 offset:21504
s_waitcnt vmcnt(11) lgkmcnt(10)
v_mfma_f32_16x16x32_bf16 v[16:19], v[48:51], v[112:115], v[16:19]
ds_read_b64_tr_b16 v[72:73], v11 offset:16384
buffer_load_dwordx4 v[160:163], v6, s[20:23], s66 offen offset:0 sc1
s_waitcnt vmcnt(11) lgkmcnt(9)
v_mfma_f32_16x16x32_bf16 v[16:19], v[52:55], v[120:123], v[16:19]
ds_read_b64_tr_b16 v[74:75], v11 offset:17408
s_waitcnt vmcnt(10)
v_mfma_f32_16x16x32_bf16 v[32:35], v[48:51], v[116:119], v[32:35]
ds_read_b64_tr_b16 v[76:77], v11 offset:20480
buffer_load_dwordx4 v[168:171], v6, s[20:23], s66 offen offset:2048 sc1
s_waitcnt vmcnt(10)
v_mfma_f32_16x16x32_bf16 v[32:35], v[52:55], v[124:127], v[32:35]
ds_read_b64_tr_b16 v[78:79], v11 offset:21504
s_waitcnt lgkmcnt(10)
v_mfma_f32_16x16x32_bf16 v[20:23], v[56:59], v[112:115], v[20:23]
ds_read_b64_tr_b16 v[48:49], v8 offset:24576
buffer_load_dwordx4 v[164:167], v6, s[20:23], s66 offen offset:256 sc1
s_waitcnt lgkmcnt(9)
v_mfma_f32_16x16x32_bf16 v[20:23], v[60:63], v[120:123], v[20:23]
ds_read_b64_tr_b16 v[50:51], v8 offset:25600
v_mfma_f32_16x16x32_bf16 v[36:39], v[56:59], v[116:119], v[36:39]
ds_read_b64_tr_b16 v[52:53], v8 offset:28672
buffer_load_dwordx4 v[172:175], v6, s[20:23], s66 offen offset:2304 sc1
s_add_u32 s66, s66, 4096
s_and_b32 s66, s66, 0xffff
v_mfma_f32_16x16x32_bf16 v[36:39], v[60:63], v[124:127], v[36:39]
ds_read_b64_tr_b16 v[54:55], v8 offset:29696
s_waitcnt lgkmcnt(10)
v_mfma_f32_16x16x32_bf16 v[24:27], v[64:67], v[112:115], v[24:27]
ds_read_b64_tr_b16 v[56:57], v9 offset:24576
s_waitcnt lgkmcnt(9)
v_mfma_f32_16x16x32_bf16 v[24:27], v[68:71], v[120:123], v[24:27]
ds_read_b64_tr_b16 v[58:59], v9 offset:25600
v_mfma_f32_16x16x32_bf16 v[40:43], v[64:67], v[116:119], v[40:43]
ds_read_b64_tr_b16 v[60:61], v9 offset:28672
v_mfma_f32_16x16x32_bf16 v[40:43], v[68:71], v[124:127], v[40:43]
ds_read_b64_tr_b16 v[62:63], v9 offset:29696
s_waitcnt lgkmcnt(10)
v_mfma_f32_16x16x32_bf16 v[28:31], v[72:75], v[112:115], v[28:31]
ds_read_b64_tr_b16 v[64:65], v10 offset:24576
s_waitcnt lgkmcnt(9)
v_mfma_f32_16x16x32_bf16 v[28:31], v[76:79], v[120:123], v[28:31]
ds_read_b64_tr_b16 v[66:67], v10 offset:25600
v_mfma_f32_16x16x32_bf16 v[44:47], v[72:75], v[116:119], v[44:47]
ds_read_b64_tr_b16 v[68:69], v10 offset:28672
v_mfma_f32_16x16x32_bf16 v[44:47], v[76:79], v[124:127], v[44:47]
ds_read_b64_tr_b16 v[70:71], v10 offset:29696
s_waitcnt vmcnt(11) lgkmcnt(10)
v_mfma_f32_16x16x32_bf16 v[16:19], v[48:51], v[128:131], v[16:19]
ds_read_b64_tr_b16 v[72:73], v11 offset:24576
buffer_load_dwordx4 v[176:179], v6, s[20:23], s66 offen offset:0 sc1
s_waitcnt vmcnt(11) lgkmcnt(9)
v_mfma_f32_16x16x32_bf16 v[16:19], v[52:55], v[136:139], v[16:19]
ds_read_b64_tr_b16 v[74:75], v11 offset:25600
s_waitcnt vmcnt(10)
v_mfma_f32_16x16x32_bf16 v[32:35], v[48:51], v[132:135], v[32:35]
ds_read_b64_tr_b16 v[76:77], v11 offset:28672
buffer_load_dwordx4 v[184:187], v6, s[20:23], s66 offen offset:2048 sc1
s_waitcnt vmcnt(10)
v_mfma_f32_16x16x32_bf16 v[32:35], v[52:55], v[140:143], v[32:35]
ds_read_b64_tr_b16 v[78:79], v11 offset:29696
s_waitcnt lgkmcnt(10)
v_mfma_f32_16x16x32_bf16 v[20:23], v[56:59], v[128:131], v[20:23]
ds_read_b64_tr_b16 v[48:49], v8 offset:32768
buffer_load_dwordx4 v[180:183], v6, s[20:23], s66 offen offset:256 sc1
s_waitcnt lgkmcnt(9)
v_mfma_f32_16x16x32_bf16 v[20:23], v[60:63], v[136:139], v[20:23]
ds_read_b64_tr_b16 v[50:51], v8 offset:33792
v_mfma_f32_16x16x32_bf16 v[36:39], v[56:59], v[132:135], v[36:39]
ds_read_b64_tr_b16 v[52:53], v8 offset:36864
buffer_load_dwordx4 v[188:191], v6, s[20:23], s66 offen offset:2304 sc1
s_add_u32 s66, s66, 4096
s_and_b32 s66, s66, 0xffff
v_mfma_f32_16x16x32_bf16 v[36:39], v[60:63], v[140:143], v[36:39]
ds_read_b64_tr_b16 v[54:55], v8 offset:37888
s_waitcnt lgkmcnt(10)
v_mfma_f32_16x16x32_bf16 v[24:27], v[64:67], v[128:131], v[24:27]
ds_read_b64_tr_b16 v[56:57], v9 offset:32768
s_waitcnt lgkmcnt(9)
v_mfma_f32_16x16x32_bf16 v[24:27], v[68:71], v[136:139], v[24:27]
ds_read_b64_tr_b16 v[58:59], v9 offset:33792
v_mfma_f32_16x16x32_bf16 v[40:43], v[64:67], v[132:135], v[40:43]
ds_read_b64_tr_b16 v[60:61], v9 offset:36864
v_mfma_f32_16x16x32_bf16 v[40:43], v[68:71], v[140:143], v[40:43]
ds_read_b64_tr_b16 v[62:63], v9 offset:37888
s_waitcnt lgkmcnt(10)
v_mfma_f32_16x16x32_bf16 v[28:31], v[72:75], v[128:131], v[28:31]
ds_read_b64_tr_b16 v[64:65], v10 offset:32768
s_waitcnt lgkmcnt(9)
v_mfma_f32_16x16x32_bf16 v[28:31], v[76:79], v[136:139], v[28:31]
ds_read_b64_tr_b16 v[66:67], v10 offset:33792
v_mfma_f32_16x16x32_bf16 v[44:47], v[72:75], v[132:135], v[44:47]
ds_read_b64_tr_b16 v[68:69], v10 offset:36864
v_mfma_f32_16x16x32_bf16 v[44:47], v[76:79], v[140:143], v[44:47]
ds_read_b64_tr_b16 v[70:71], v10 offset:37888
s_waitcnt vmcnt(11) lgkmcnt(10)
v_mfma_f32_16x16x32_bf16 v[16:19], v[48:51], v[144:147], v[16:19]
ds_read_b64_tr_b16 v[72:73], v11 offset:32768
buffer_load_dwordx4 v[192:195], v6, s[20:23], s66 offen offset:0 sc1
s_waitcnt vmcnt(11) lgkmcnt(9)
v_mfma_f32_16x16x32_bf16 v[16:19], v[52:55], v[152:155], v[16:19]
ds_read_b64_tr_b16 v[74:75], v11 offset:33792
s_waitcnt vmcnt(10)
v_mfma_f32_16x16x32_bf16 v[32:35], v[48:51], v[148:151], v[32:35]
ds_read_b64_tr_b16 v[76:77], v11 offset:36864
buffer_load_dwordx4 v[200:203], v6, s[20:23], s66 offen offset:2048 sc1
s_waitcnt vmcnt(10)
v_mfma_f32_16x16x32_bf16 v[32:35], v[52:55], v[156:159], v[32:35]
ds_read_b64_tr_b16 v[78:79], v11 offset:37888
s_waitcnt lgkmcnt(10)
v_mfma_f32_16x16x32_bf16 v[20:23], v[56:59], v[144:147], v[20:23]
ds_read_b64_tr_b16 v[48:49], v8 offset:40960
buffer_load_dwordx4 v[196:199], v6, s[20:23], s66 offen offset:256 sc1
s_waitcnt lgkmcnt(9)
v_mfma_f32_16x16x32_bf16 v[20:23], v[60:63], v[152:155], v[20:23]
ds_read_b64_tr_b16 v[50:51], v8 offset:41984
v_mfma_f32_16x16x32_bf16 v[36:39], v[56:59], v[148:151], v[36:39]
ds_read_b64_tr_b16 v[52:53], v8 offset:45056
buffer_load_dwordx4 v[204:207], v6, s[20:23], s66 offen offset:2304 sc1
s_add_u32 s66, s66, 4096
s_and_b32 s66, s66, 0xffff
v_mfma_f32_16x16x32_bf16 v[36:39], v[60:63], v[156:159], v[36:39]
ds_read_b64_tr_b16 v[54:55], v8 offset:46080
s_waitcnt lgkmcnt(10)
v_mfma_f32_16x16x32_bf16 v[24:27], v[64:67], v[144:147], v[24:27]
ds_read_b64_tr_b16 v[56:57], v9 offset:40960
s_waitcnt lgkmcnt(9)
v_mfma_f32_16x16x32_bf16 v[24:27], v[68:71], v[152:155], v[24:27]
ds_read_b64_tr_b16 v[58:59], v9 offset:41984
v_mfma_f32_16x16x32_bf16 v[40:43], v[64:67], v[148:151], v[40:43]
ds_read_b64_tr_b16 v[60:61], v9 offset:45056
v_mfma_f32_16x16x32_bf16 v[40:43], v[68:71], v[156:159], v[40:43]
ds_read_b64_tr_b16 v[62:63], v9 offset:46080
s_waitcnt lgkmcnt(10)
v_mfma_f32_16x16x32_bf16 v[28:31], v[72:75], v[144:147], v[28:31]
ds_read_b64_tr_b16 v[64:65], v10 offset:40960
s_waitcnt lgkmcnt(9)
v_mfma_f32_16x16x32_bf16 v[28:31], v[76:79], v[152:155], v[28:31]
ds_read_b64_tr_b16 v[66:67], v10 offset:41984
v_mfma_f32_16x16x32_bf16 v[44:47], v[72:75], v[148:151], v[44:47]
ds_read_b64_tr_b16 v[68:69], v10 offset:45056
v_mfma_f32_16x16x32_bf16 v[44:47], v[76:79], v[156:159], v[44:47]
ds_read_b64_tr_b16 v[70:71], v10 offset:46080
s_waitcnt vmcnt(11) lgkmcnt(10)
v_mfma_f32_16x16x32_bf16 v[16:19], v[48:51], v[160:163], v[16:19]
ds_read_b64_tr_b16 v[72:73], v11 offset:40960
buffer_load_dwordx4 v[80:83], v6, s[20:23], s66 offen offset:0 sc1
s_waitcnt vmcnt(11) lgkmcnt(9)
v_mfma_f32_16x16x32_bf16 v[16:19], v[52:55], v[168:171], v[16:19]
ds_read_b64_tr_b16 v[74:75], v11 offset:41984
s_waitcnt vmcnt(10)
v_mfma_f32_16x16x32_bf16 v[32:35], v[48:51], v[164:167], v[32:35]
ds_read_b64_tr_b16 v[76:77], v11 offset:45056
buffer_load_dwordx4 v[88:91], v6, s[20:23], s66 offen offset:2048 sc1
s_waitcnt vmcnt(10)
v_mfma_f32_16x16x32_bf16 v[32:35], v[52:55], v[172:175], v[32:35]
ds_read_b64_tr_b16 v[78:79], v11 offset:46080
s_waitcnt lgkmcnt(10)
v_mfma_f32_16x16x32_bf16 v[20:23], v[56:59], v[160:163], v[20:23]
ds_read_b64_tr_b16 v[48:49], v8 offset:49152
buffer_load_dwordx4 v[84:87], v6, s[20:23], s66 offen offset:256 sc1
s_waitcnt lgkmcnt(9)
v_mfma_f32_16x16x32_bf16 v[20:23], v[60:63], v[168:171], v[20:23]
ds_read_b64_tr_b16 v[50:51], v8 offset:50176
v_mfma_f32_16x16x32_bf16 v[36:39], v[56:59], v[164:167], v[36:39]
ds_read_b64_tr_b16 v[52:53], v8 offset:53248
buffer_load_dwordx4 v[92:95], v6, s[20:23], s66 offen offset:2304 sc1
s_add_u32 s66, s66, 4096
s_and_b32 s66, s66, 0xffff
v_mfma_f32_16x16x32_bf16 v[36:39], v[60:63], v[172:175], v[36:39]
ds_read_b64_tr_b16 v[54:55], v8 offset:54272
s_waitcnt lgkmcnt(10)
v_mfma_f32_16x16x32_bf16 v[24:27], v[64:67], v[160:163], v[24:27]
ds_read_b64_tr_b16 v[56:57], v9 offset:49152
s_waitcnt lgkmcnt(9)
v_mfma_f32_16x16x32_bf16 v[24:27], v[68:71], v[168:171], v[24:27]
ds_read_b64_tr_b16 v[58:59], v9 offset:50176
v_mfma_f32_16x16x32_bf16 v[40:43], v[64:67], v[164:167], v[40:43]
ds_read_b64_tr_b16 v[60:61], v9 offset:53248
v_mfma_f32_16x16x32_bf16 v[40:43], v[68:71], v[172:175], v[40:43]
ds_read_b64_tr_b16 v[62:63], v9 offset:54272
s_waitcnt lgkmcnt(10)
v_mfma_f32_16x16x32_bf16 v[28:31], v[72:75], v[160:163], v[28:31]
ds_read_b64_tr_b16 v[64:65], v10 offset:49152
s_waitcnt lgkmcnt(9)
v_mfma_f32_16x16x32_bf16 v[28:31], v[76:79], v[168:171], v[28:31]
ds_read_b64_tr_b16 v[66:67], v10 offset:50176
v_mfma_f32_16x16x32_bf16 v[44:47], v[72:75], v[164:167], v[44:47]
ds_read_b64_tr_b16 v[68:69], v10 offset:53248
v_mfma_f32_16x16x32_bf16 v[44:47], v[76:79], v[172:175], v[44:47]
ds_read_b64_tr_b16 v[70:71], v10 offset:54272
s_waitcnt vmcnt(11) lgkmcnt(10)
v_mfma_f32_16x16x32_bf16 v[16:19], v[48:51], v[176:179], v[16:19]
ds_read_b64_tr_b16 v[72:73], v11 offset:49152
buffer_load_dwordx4 v[96:99], v6, s[20:23], s66 offen offset:0 sc1
s_waitcnt vmcnt(11) lgkmcnt(9)
v_mfma_f32_16x16x32_bf16 v[16:19], v[52:55], v[184:187], v[16:19]
ds_read_b64_tr_b16 v[74:75], v11 offset:50176
s_waitcnt vmcnt(10)
v_mfma_f32_16x16x32_bf16 v[32:35], v[48:51], v[180:183], v[32:35]
ds_read_b64_tr_b16 v[76:77], v11 offset:53248
buffer_load_dwordx4 v[104:107], v6, s[20:23], s66 offen offset:2048 sc1
s_waitcnt vmcnt(10)
v_mfma_f32_16x16x32_bf16 v[32:35], v[52:55], v[188:191], v[32:35]
ds_read_b64_tr_b16 v[78:79], v11 offset:54272
s_waitcnt lgkmcnt(10)
v_mfma_f32_16x16x32_bf16 v[20:23], v[56:59], v[176:179], v[20:23]
ds_read_b64_tr_b16 v[48:49], v8 offset:57344
buffer_load_dwordx4 v[100:103], v6, s[20:23], s66 offen offset:256 sc1
s_waitcnt lgkmcnt(9)
v_mfma_f32_16x16x32_bf16 v[20:23], v[60:63], v[184:187], v[20:23]
ds_read_b64_tr_b16 v[50:51], v8 offset:58368
v_mfma_f32_16x16x32_bf16 v[36:39], v[56:59], v[180:183], v[36:39]
ds_read_b64_tr_b16 v[52:53], v8 offset:61440
buffer_load_dwordx4 v[108:111], v6, s[20:23], s66 offen offset:2304 sc1
s_add_u32 s66, s66, 4096
s_and_b32 s66, s66, 0xffff
v_mfma_f32_16x16x32_bf16 v[36:39], v[60:63], v[188:191], v[36:39]
ds_read_b64_tr_b16 v[54:55], v8 offset:62464
s_waitcnt lgkmcnt(10)
v_mfma_f32_16x16x32_bf16 v[24:27], v[64:67], v[176:179], v[24:27]
ds_read_b64_tr_b16 v[56:57], v9 offset:57344
s_waitcnt lgkmcnt(9)
v_mfma_f32_16x16x32_bf16 v[24:27], v[68:71], v[184:187], v[24:27]
ds_read_b64_tr_b16 v[58:59], v9 offset:58368
v_mfma_f32_16x16x32_bf16 v[40:43], v[64:67], v[180:183], v[40:43]
ds_read_b64_tr_b16 v[60:61], v9 offset:61440
v_mfma_f32_16x16x32_bf16 v[40:43], v[68:71], v[188:191], v[40:43]
ds_read_b64_tr_b16 v[62:63], v9 offset:62464
s_waitcnt lgkmcnt(10)
v_mfma_f32_16x16x32_bf16 v[28:31], v[72:75], v[176:179], v[28:31]
ds_read_b64_tr_b16 v[64:65], v10 offset:57344
s_waitcnt lgkmcnt(9)
v_mfma_f32_16x16x32_bf16 v[28:31], v[76:79], v[184:187], v[28:31]
ds_read_b64_tr_b16 v[66:67], v10 offset:58368
v_mfma_f32_16x16x32_bf16 v[44:47], v[72:75], v[180:183], v[44:47]
ds_read_b64_tr_b16 v[68:69], v10 offset:61440
v_mfma_f32_16x16x32_bf16 v[44:47], v[76:79], v[188:191], v[44:47]
ds_read_b64_tr_b16 v[70:71], v10 offset:62464
s_waitcnt vmcnt(11) lgkmcnt(10)
v_mfma_f32_16x16x32_bf16 v[16:19], v[48:51], v[192:195], v[16:19]
ds_read_b64_tr_b16 v[72:73], v11 offset:57344
buffer_load_dwordx4 v[112:115], v6, s[20:23], s66 offen offset:0 sc1
s_waitcnt vmcnt(11) lgkmcnt(9)
v_mfma_f32_16x16x32_bf16 v[16:19], v[52:55], v[200:203], v[16:19]
ds_read_b64_tr_b16 v[74:75], v11 offset:58368
s_waitcnt vmcnt(10)
v_mfma_f32_16x16x32_bf16 v[32:35], v[48:51], v[196:199], v[32:35]
ds_read_b64_tr_b16 v[76:77], v11 offset:61440
buffer_load_dwordx4 v[120:123], v6, s[20:23], s66 offen offset:2048 sc1
s_waitcnt vmcnt(10)
v_mfma_f32_16x16x32_bf16 v[32:35], v[52:55], v[204:207], v[32:35]
ds_read_b64_tr_b16 v[78:79], v11 offset:62464
s_waitcnt lgkmcnt(10)
v_mfma_f32_16x16x32_bf16 v[20:23], v[56:59], v[192:195], v[20:23]
ds_read_b64_tr_b16 v[48:49], v12 offset:0
buffer_load_dwordx4 v[116:119], v6, s[20:23], s66 offen offset:256 sc1
s_waitcnt lgkmcnt(9)
v_mfma_f32_16x16x32_bf16 v[20:23], v[60:63], v[200:203], v[20:23]
ds_read_b64_tr_b16 v[50:51], v12 offset:1024
v_mfma_f32_16x16x32_bf16 v[36:39], v[56:59], v[196:199], v[36:39]
ds_read_b64_tr_b16 v[52:53], v12 offset:4096
buffer_load_dwordx4 v[124:127], v6, s[20:23], s66 offen offset:2304 sc1
s_add_u32 s66, s66, 4096
s_and_b32 s66, s66, 0xffff
v_mfma_f32_16x16x32_bf16 v[36:39], v[60:63], v[204:207], v[36:39]
ds_read_b64_tr_b16 v[54:55], v12 offset:5120
s_waitcnt lgkmcnt(10)
v_mfma_f32_16x16x32_bf16 v[24:27], v[64:67], v[192:195], v[24:27]
ds_read_b64_tr_b16 v[56:57], v13 offset:0
s_waitcnt lgkmcnt(9)
v_mfma_f32_16x16x32_bf16 v[24:27], v[68:71], v[200:203], v[24:27]
ds_read_b64_tr_b16 v[58:59], v13 offset:1024
v_mfma_f32_16x16x32_bf16 v[40:43], v[64:67], v[196:199], v[40:43]
ds_read_b64_tr_b16 v[60:61], v13 offset:4096
v_mfma_f32_16x16x32_bf16 v[40:43], v[68:71], v[204:207], v[40:43]
ds_read_b64_tr_b16 v[62:63], v13 offset:5120
s_waitcnt lgkmcnt(10)
v_mfma_f32_16x16x32_bf16 v[28:31], v[72:75], v[192:195], v[28:31]
ds_read_b64_tr_b16 v[64:65], v14 offset:0
s_waitcnt lgkmcnt(9)
v_mfma_f32_16x16x32_bf16 v[28:31], v[76:79], v[200:203], v[28:31]
ds_read_b64_tr_b16 v[66:67], v14 offset:1024
v_mfma_f32_16x16x32_bf16 v[44:47], v[72:75], v[196:199], v[44:47]
ds_read_b64_tr_b16 v[68:69], v14 offset:4096
v_mfma_f32_16x16x32_bf16 v[44:47], v[76:79], v[204:207], v[44:47]
ds_read_b64_tr_b16 v[70:71], v14 offset:5120
s_waitcnt vmcnt(11) lgkmcnt(10)
v_mfma_f32_16x16x32_bf16 v[16:19], v[48:51], v[80:83], v[16:19]
ds_read_b64_tr_b16 v[72:73], v15 offset:0
buffer_load_dwordx4 v[128:131], v6, s[20:23], s66 offen offset:0 sc1
s_waitcnt vmcnt(11) lgkmcnt(9)
v_mfma_f32_16x16x32_bf16 v[16:19], v[52:55], v[88:91], v[16:19]
ds_read_b64_tr_b16 v[74:75], v15 offset:1024
s_waitcnt vmcnt(10)
v_mfma_f32_16x16x32_bf16 v[32:35], v[48:51], v[84:87], v[32:35]
ds_read_b64_tr_b16 v[76:77], v15 offset:4096
buffer_load_dwordx4 v[136:139], v6, s[20:23], s66 offen offset:2048 sc1
s_waitcnt vmcnt(10)
v_mfma_f32_16x16x32_bf16 v[32:35], v[52:55], v[92:95], v[32:35]
ds_read_b64_tr_b16 v[78:79], v15 offset:5120
s_waitcnt lgkmcnt(10)
v_mfma_f32_16x16x32_bf16 v[20:23], v[56:59], v[80:83], v[20:23]
ds_read_b64_tr_b16 v[48:49], v12 offset:8192
buffer_load_dwordx4 v[132:135], v6, s[20:23], s66 offen offset:256 sc1
s_waitcnt lgkmcnt(9)
v_mfma_f32_16x16x32_bf16 v[20:23], v[60:63], v[88:91], v[20:23]
ds_read_b64_tr_b16 v[50:51], v12 offset:9216
v_mfma_f32_16x16x32_bf16 v[36:39], v[56:59], v[84:87], v[36:39]
ds_read_b64_tr_b16 v[52:53], v12 offset:12288
buffer_load_dwordx4 v[140:143], v6, s[20:23], s66 offen offset:2304 sc1
s_add_u32 s66, s66, 4096
s_and_b32 s66, s66, 0xffff
v_mfma_f32_16x16x32_bf16 v[36:39], v[60:63], v[92:95], v[36:39]
ds_read_b64_tr_b16 v[54:55], v12 offset:13312
s_waitcnt lgkmcnt(10)
v_mfma_f32_16x16x32_bf16 v[24:27], v[64:67], v[80:83], v[24:27]
ds_read_b64_tr_b16 v[56:57], v13 offset:8192
s_waitcnt lgkmcnt(9)
v_mfma_f32_16x16x32_bf16 v[24:27], v[68:71], v[88:91], v[24:27]
ds_read_b64_tr_b16 v[58:59], v13 offset:9216
v_mfma_f32_16x16x32_bf16 v[40:43], v[64:67], v[84:87], v[40:43]
ds_read_b64_tr_b16 v[60:61], v13 offset:12288
v_mfma_f32_16x16x32_bf16 v[40:43], v[68:71], v[92:95], v[40:43]
ds_read_b64_tr_b16 v[62:63], v13 offset:13312
s_waitcnt lgkmcnt(10)
v_mfma_f32_16x16x32_bf16 v[28:31], v[72:75], v[80:83], v[28:31]
ds_read_b64_tr_b16 v[64:65], v14 offset:8192
s_waitcnt lgkmcnt(9)
v_mfma_f32_16x16x32_bf16 v[28:31], v[76:79], v[88:91], v[28:31]
ds_read_b64_tr_b16 v[66:67], v14 offset:9216
v_mfma_f32_16x16x32_bf16 v[44:47], v[72:75], v[84:87], v[44:47]
ds_read_b64_tr_b16 v[68:69], v14 offset:12288
v_mfma_f32_16x16x32_bf16 v[44:47], v[76:79], v[92:95], v[44:47]
ds_read_b64_tr_b16 v[70:71], v14 offset:13312
s_waitcnt vmcnt(11) lgkmcnt(10)
v_mfma_f32_16x16x32_bf16 v[16:19], v[48:51], v[96:99], v[16:19]
ds_read_b64_tr_b16 v[72:73], v15 offset:8192
buffer_load_dwordx4 v[144:147], v6, s[20:23], s66 offen offset:0 sc1
s_waitcnt vmcnt(11) lgkmcnt(9)
v_mfma_f32_16x16x32_bf16 v[16:19], v[52:55], v[104:107], v[16:19]
ds_read_b64_tr_b16 v[74:75], v15 offset:9216
s_waitcnt vmcnt(10)
v_mfma_f32_16x16x32_bf16 v[32:35], v[48:51], v[100:103], v[32:35]
ds_read_b64_tr_b16 v[76:77], v15 offset:12288
buffer_load_dwordx4 v[152:155], v6, s[20:23], s66 offen offset:2048 sc1
s_waitcnt vmcnt(10)
v_mfma_f32_16x16x32_bf16 v[32:35], v[52:55], v[108:111], v[32:35]
ds_read_b64_tr_b16 v[78:79], v15 offset:13312
s_waitcnt lgkmcnt(10)
v_mfma_f32_16x16x32_bf16 v[20:23], v[56:59], v[96:99], v[20:23]
ds_read_b64_tr_b16 v[48:49], v12 offset:16384
buffer_load_dwordx4 v[148:151], v6, s[20:23], s66 offen offset:256 sc1
s_waitcnt lgkmcnt(9)
v_mfma_f32_16x16x32_bf16 v[20:23], v[60:63], v[104:107], v[20:23]
ds_read_b64_tr_b16 v[50:51], v12 offset:17408
v_mfma_f32_16x16x32_bf16 v[36:39], v[56:59], v[100:103], v[36:39]
ds_read_b64_tr_b16 v[52:53], v12 offset:20480
buffer_load_dwordx4 v[156:159], v6, s[20:23], s66 offen offset:2304 sc1
s_add_u32 s66, s66, 4096
s_and_b32 s66, s66, 0xffff
v_mfma_f32_16x16x32_bf16 v[36:39], v[60:63], v[108:111], v[36:39]
ds_read_b64_tr_b16 v[54:55], v12 offset:21504
s_waitcnt lgkmcnt(10)
v_mfma_f32_16x16x32_bf16 v[24:27], v[64:67], v[96:99], v[24:27]
ds_read_b64_tr_b16 v[56:57], v13 offset:16384
s_waitcnt lgkmcnt(9)
v_mfma_f32_16x16x32_bf16 v[24:27], v[68:71], v[104:107], v[24:27]
ds_read_b64_tr_b16 v[58:59], v13 offset:17408
v_mfma_f32_16x16x32_bf16 v[40:43], v[64:67], v[100:103], v[40:43]
ds_read_b64_tr_b16 v[60:61], v13 offset:20480
v_mfma_f32_16x16x32_bf16 v[40:43], v[68:71], v[108:111], v[40:43]
ds_read_b64_tr_b16 v[62:63], v13 offset:21504
s_waitcnt lgkmcnt(10)
v_mfma_f32_16x16x32_bf16 v[28:31], v[72:75], v[96:99], v[28:31]
ds_read_b64_tr_b16 v[64:65], v14 offset:16384
s_waitcnt lgkmcnt(9)
v_mfma_f32_16x16x32_bf16 v[28:31], v[76:79], v[104:107], v[28:31]
ds_read_b64_tr_b16 v[66:67], v14 offset:17408
v_mfma_f32_16x16x32_bf16 v[44:47], v[72:75], v[100:103], v[44:47]
ds_read_b64_tr_b16 v[68:69], v14 offset:20480
v_mfma_f32_16x16x32_bf16 v[44:47], v[76:79], v[108:111], v[44:47]
ds_read_b64_tr_b16 v[70:71], v14 offset:21504
s_waitcnt vmcnt(11) lgkmcnt(10)
v_mfma_f32_16x16x32_bf16 v[16:19], v[48:51], v[112:115], v[16:19]
ds_read_b64_tr_b16 v[72:73], v15 offset:16384
buffer_load_dwordx4 v[160:163], v6, s[20:23], s66 offen offset:0 sc1
s_waitcnt vmcnt(11) lgkmcnt(9)
v_mfma_f32_16x16x32_bf16 v[16:19], v[52:55], v[120:123], v[16:19]
ds_read_b64_tr_b16 v[74:75], v15 offset:17408
s_waitcnt vmcnt(10)
v_mfma_f32_16x16x32_bf16 v[32:35], v[48:51], v[116:119], v[32:35]
ds_read_b64_tr_b16 v[76:77], v15 offset:20480
buffer_load_dwordx4 v[168:171], v6, s[20:23], s66 offen offset:2048 sc1
s_waitcnt vmcnt(10)
v_mfma_f32_16x16x32_bf16 v[32:35], v[52:55], v[124:127], v[32:35]
ds_read_b64_tr_b16 v[78:79], v15 offset:21504
s_waitcnt lgkmcnt(10)
v_mfma_f32_16x16x32_bf16 v[20:23], v[56:59], v[112:115], v[20:23]
ds_read_b64_tr_b16 v[48:49], v12 offset:24576
buffer_load_dwordx4 v[164:167], v6, s[20:23], s66 offen offset:256 sc1
s_waitcnt lgkmcnt(9)
v_mfma_f32_16x16x32_bf16 v[20:23], v[60:63], v[120:123], v[20:23]
ds_read_b64_tr_b16 v[50:51], v12 offset:25600
v_mfma_f32_16x16x32_bf16 v[36:39], v[56:59], v[116:119], v[36:39]
ds_read_b64_tr_b16 v[52:53], v12 offset:28672
buffer_load_dwordx4 v[172:175], v6, s[20:23], s66 offen offset:2304 sc1
s_add_u32 s66, s66, 4096
s_and_b32 s66, s66, 0xffff
v_mfma_f32_16x16x32_bf16 v[36:39], v[60:63], v[124:127], v[36:39]
ds_read_b64_tr_b16 v[54:55], v12 offset:29696
s_waitcnt lgkmcnt(10)
v_mfma_f32_16x16x32_bf16 v[24:27], v[64:67], v[112:115], v[24:27]
ds_read_b64_tr_b16 v[56:57], v13 offset:24576
s_waitcnt lgkmcnt(9)
v_mfma_f32_16x16x32_bf16 v[24:27], v[68:71], v[120:123], v[24:27]
ds_read_b64_tr_b16 v[58:59], v13 offset:25600
v_mfma_f32_16x16x32_bf16 v[40:43], v[64:67], v[116:119], v[40:43]
ds_read_b64_tr_b16 v[60:61], v13 offset:28672
v_mfma_f32_16x16x32_bf16 v[40:43], v[68:71], v[124:127], v[40:43]
ds_read_b64_tr_b16 v[62:63], v13 offset:29696
s_waitcnt lgkmcnt(10)
v_mfma_f32_16x16x32_bf16 v[28:31], v[72:75], v[112:115], v[28:31]
ds_read_b64_tr_b16 v[64:65], v14 offset:24576
s_waitcnt lgkmcnt(9)
v_mfma_f32_16x16x32_bf16 v[28:31], v[76:79], v[120:123], v[28:31]
ds_read_b64_tr_b16 v[66:67], v14 offset:25600
v_mfma_f32_16x16x32_bf16 v[44:47], v[72:75], v[116:119], v[44:47]
ds_read_b64_tr_b16 v[68:69], v14 offset:28672
v_mfma_f32_16x16x32_bf16 v[44:47], v[76:79], v[124:127], v[44:47]
ds_read_b64_tr_b16 v[70:71], v14 offset:29696
s_waitcnt vmcnt(11) lgkmcnt(10)
v_mfma_f32_16x16x32_bf16 v[16:19], v[48:51], v[128:131], v[16:19]
ds_read_b64_tr_b16 v[72:73], v15 offset:24576
buffer_load_dwordx4 v[176:179], v6, s[20:23], s66 offen offset:0 sc1
s_waitcnt vmcnt(11) lgkmcnt(9)
v_mfma_f32_16x16x32_bf16 v[16:19], v[52:55], v[136:139], v[16:19]
ds_read_b64_tr_b16 v[74:75], v15 offset:25600
s_waitcnt vmcnt(10)
v_mfma_f32_16x16x32_bf16 v[32:35], v[48:51], v[132:135], v[32:35]
ds_read_b64_tr_b16 v[76:77], v15 offset:28672
buffer_load_dwordx4 v[184:187], v6, s[20:23], s66 offen offset:2048 sc1
s_waitcnt vmcnt(10)
v_mfma_f32_16x16x32_bf16 v[32:35], v[52:55], v[140:143], v[32:35]
ds_read_b64_tr_b16 v[78:79], v15 offset:29696
s_waitcnt lgkmcnt(10)
v_mfma_f32_16x16x32_bf16 v[20:23], v[56:59], v[128:131], v[20:23]
ds_read_b64_tr_b16 v[48:49], v12 offset:32768
buffer_load_dwordx4 v[180:183], v6, s[20:23], s66 offen offset:256 sc1
s_waitcnt lgkmcnt(9)
v_mfma_f32_16x16x32_bf16 v[20:23], v[60:63], v[136:139], v[20:23]
ds_read_b64_tr_b16 v[50:51], v12 offset:33792
v_mfma_f32_16x16x32_bf16 v[36:39], v[56:59], v[132:135], v[36:39]
ds_read_b64_tr_b16 v[52:53], v12 offset:36864
buffer_load_dwordx4 v[188:191], v6, s[20:23], s66 offen offset:2304 sc1
s_add_u32 s66, s66, 4096
s_and_b32 s66, s66, 0xffff
v_mfma_f32_16x16x32_bf16 v[36:39], v[60:63], v[140:143], v[36:39]
ds_read_b64_tr_b16 v[54:55], v12 offset:37888
s_waitcnt lgkmcnt(10)
v_mfma_f32_16x16x32_bf16 v[24:27], v[64:67], v[128:131], v[24:27]
ds_read_b64_tr_b16 v[56:57], v13 offset:32768
s_waitcnt lgkmcnt(9)
v_mfma_f32_16x16x32_bf16 v[24:27], v[68:71], v[136:139], v[24:27]
ds_read_b64_tr_b16 v[58:59], v13 offset:33792
v_mfma_f32_16x16x32_bf16 v[40:43], v[64:67], v[132:135], v[40:43]
ds_read_b64_tr_b16 v[60:61], v13 offset:36864
v_mfma_f32_16x16x32_bf16 v[40:43], v[68:71], v[140:143], v[40:43]
ds_read_b64_tr_b16 v[62:63], v13 offset:37888
s_waitcnt lgkmcnt(10)
v_mfma_f32_16x16x32_bf16 v[28:31], v[72:75], v[128:131], v[28:31]
ds_read_b64_tr_b16 v[64:65], v14 offset:32768
s_waitcnt lgkmcnt(9)
v_mfma_f32_16x16x32_bf16 v[28:31], v[76:79], v[136:139], v[28:31]
ds_read_b64_tr_b16 v[66:67], v14 offset:33792
v_mfma_f32_16x16x32_bf16 v[44:47], v[72:75], v[132:135], v[44:47]
ds_read_b64_tr_b16 v[68:69], v14 offset:36864
v_mfma_f32_16x16x32_bf16 v[44:47], v[76:79], v[140:143], v[44:47]
ds_read_b64_tr_b16 v[70:71], v14 offset:37888
s_waitcnt vmcnt(11) lgkmcnt(10)
v_mfma_f32_16x16x32_bf16 v[16:19], v[48:51], v[144:147], v[16:19]
ds_read_b64_tr_b16 v[72:73], v15 offset:32768
buffer_load_dwordx4 v[192:195], v6, s[20:23], s66 offen offset:0 sc1
s_waitcnt vmcnt(11) lgkmcnt(9)
v_mfma_f32_16x16x32_bf16 v[16:19], v[52:55], v[152:155], v[16:19]
ds_read_b64_tr_b16 v[74:75], v15 offset:33792
s_waitcnt vmcnt(10)
v_mfma_f32_16x16x32_bf16 v[32:35], v[48:51], v[148:151], v[32:35]
ds_read_b64_tr_b16 v[76:77], v15 offset:36864
buffer_load_dwordx4 v[200:203], v6, s[20:23], s66 offen offset:2048 sc1
s_waitcnt vmcnt(10)
v_mfma_f32_16x16x32_bf16 v[32:35], v[52:55], v[156:159], v[32:35]
ds_read_b64_tr_b16 v[78:79], v15 offset:37888
s_waitcnt lgkmcnt(10)
v_mfma_f32_16x16x32_bf16 v[20:23], v[56:59], v[144:147], v[20:23]
ds_read_b64_tr_b16 v[48:49], v12 offset:40960
buffer_load_dwordx4 v[196:199], v6, s[20:23], s66 offen offset:256 sc1
s_waitcnt lgkmcnt(9)
v_mfma_f32_16x16x32_bf16 v[20:23], v[60:63], v[152:155], v[20:23]
ds_read_b64_tr_b16 v[50:51], v12 offset:41984
v_mfma_f32_16x16x32_bf16 v[36:39], v[56:59], v[148:151], v[36:39]
ds_read_b64_tr_b16 v[52:53], v12 offset:45056
buffer_load_dwordx4 v[204:207], v6, s[20:23], s66 offen offset:2304 sc1
s_add_u32 s66, s66, 4096
s_and_b32 s66, s66, 0xffff
v_mfma_f32_16x16x32_bf16 v[36:39], v[60:63], v[156:159], v[36:39]
ds_read_b64_tr_b16 v[54:55], v12 offset:46080
s_waitcnt lgkmcnt(10)
v_mfma_f32_16x16x32_bf16 v[24:27], v[64:67], v[144:147], v[24:27]
ds_read_b64_tr_b16 v[56:57], v13 offset:40960
s_waitcnt lgkmcnt(9)
v_mfma_f32_16x16x32_bf16 v[24:27], v[68:71], v[152:155], v[24:27]
ds_read_b64_tr_b16 v[58:59], v13 offset:41984
v_mfma_f32_16x16x32_bf16 v[40:43], v[64:67], v[148:151], v[40:43]
ds_read_b64_tr_b16 v[60:61], v13 offset:45056
v_mfma_f32_16x16x32_bf16 v[40:43], v[68:71], v[156:159], v[40:43]
ds_read_b64_tr_b16 v[62:63], v13 offset:46080
s_waitcnt lgkmcnt(10)
v_mfma_f32_16x16x32_bf16 v[28:31], v[72:75], v[144:147], v[28:31]
ds_read_b64_tr_b16 v[64:65], v14 offset:40960
s_waitcnt lgkmcnt(9)
v_mfma_f32_16x16x32_bf16 v[28:31], v[76:79], v[152:155], v[28:31]
ds_read_b64_tr_b16 v[66:67], v14 offset:41984
v_mfma_f32_16x16x32_bf16 v[44:47], v[72:75], v[148:151], v[44:47]
ds_read_b64_tr_b16 v[68:69], v14 offset:45056
v_mfma_f32_16x16x32_bf16 v[44:47], v[76:79], v[156:159], v[44:47]
ds_read_b64_tr_b16 v[70:71], v14 offset:46080
s_waitcnt vmcnt(11) lgkmcnt(10)
v_mfma_f32_16x16x32_bf16 v[16:19], v[48:51], v[160:163], v[16:19]
ds_read_b64_tr_b16 v[72:73], v15 offset:40960
s_waitcnt vmcnt(10) lgkmcnt(9)
v_mfma_f32_16x16x32_bf16 v[16:19], v[52:55], v[168:171], v[16:19]
ds_read_b64_tr_b16 v[74:75], v15 offset:41984
s_waitcnt vmcnt(9)
v_mfma_f32_16x16x32_bf16 v[32:35], v[48:51], v[164:167], v[32:35]
ds_read_b64_tr_b16 v[76:77], v15 offset:45056
s_waitcnt vmcnt(8)
v_mfma_f32_16x16x32_bf16 v[32:35], v[52:55], v[172:175], v[32:35]
ds_read_b64_tr_b16 v[78:79], v15 offset:46080
s_waitcnt lgkmcnt(10)
v_mfma_f32_16x16x32_bf16 v[20:23], v[56:59], v[160:163], v[20:23]
ds_read_b64_tr_b16 v[48:49], v12 offset:49152
s_waitcnt lgkmcnt(9)
v_mfma_f32_16x16x32_bf16 v[20:23], v[60:63], v[168:171], v[20:23]
ds_read_b64_tr_b16 v[50:51], v12 offset:50176
v_mfma_f32_16x16x32_bf16 v[36:39], v[56:59], v[164:167], v[36:39]
ds_read_b64_tr_b16 v[52:53], v12 offset:53248
v_mfma_f32_16x16x32_bf16 v[36:39], v[60:63], v[172:175], v[36:39]
ds_read_b64_tr_b16 v[54:55], v12 offset:54272
s_waitcnt lgkmcnt(10)
v_mfma_f32_16x16x32_bf16 v[24:27], v[64:67], v[160:163], v[24:27]
ds_read_b64_tr_b16 v[56:57], v13 offset:49152
s_waitcnt lgkmcnt(9)
v_mfma_f32_16x16x32_bf16 v[24:27], v[68:71], v[168:171], v[24:27]
ds_read_b64_tr_b16 v[58:59], v13 offset:50176
v_mfma_f32_16x16x32_bf16 v[40:43], v[64:67], v[164:167], v[40:43]
ds_read_b64_tr_b16 v[60:61], v13 offset:53248
v_mfma_f32_16x16x32_bf16 v[40:43], v[68:71], v[172:175], v[40:43]
ds_read_b64_tr_b16 v[62:63], v13 offset:54272
s_waitcnt lgkmcnt(10)
v_mfma_f32_16x16x32_bf16 v[28:31], v[72:75], v[160:163], v[28:31]
ds_read_b64_tr_b16 v[64:65], v14 offset:49152
s_waitcnt lgkmcnt(9)
v_mfma_f32_16x16x32_bf16 v[28:31], v[76:79], v[168:171], v[28:31]
ds_read_b64_tr_b16 v[66:67], v14 offset:50176
v_mfma_f32_16x16x32_bf16 v[44:47], v[72:75], v[164:167], v[44:47]
ds_read_b64_tr_b16 v[68:69], v14 offset:53248
v_mfma_f32_16x16x32_bf16 v[44:47], v[76:79], v[172:175], v[44:47]
ds_read_b64_tr_b16 v[70:71], v14 offset:54272
s_waitcnt vmcnt(7) lgkmcnt(10)
v_mfma_f32_16x16x32_bf16 v[16:19], v[48:51], v[176:179], v[16:19]
ds_read_b64_tr_b16 v[72:73], v15 offset:49152
s_waitcnt vmcnt(6) lgkmcnt(9)
v_mfma_f32_16x16x32_bf16 v[16:19], v[52:55], v[184:187], v[16:19]
ds_read_b64_tr_b16 v[74:75], v15 offset:50176
s_waitcnt vmcnt(5)
v_mfma_f32_16x16x32_bf16 v[32:35], v[48:51], v[180:183], v[32:35]
ds_read_b64_tr_b16 v[76:77], v15 offset:53248
s_waitcnt vmcnt(4)
v_mfma_f32_16x16x32_bf16 v[32:35], v[52:55], v[188:191], v[32:35]
ds_read_b64_tr_b16 v[78:79], v15 offset:54272
s_waitcnt lgkmcnt(10)
v_mfma_f32_16x16x32_bf16 v[20:23], v[56:59], v[176:179], v[20:23]
ds_read_b64_tr_b16 v[48:49], v12 offset:57344
s_waitcnt lgkmcnt(9)
v_mfma_f32_16x16x32_bf16 v[20:23], v[60:63], v[184:187], v[20:23]
ds_read_b64_tr_b16 v[50:51], v12 offset:58368
v_mfma_f32_16x16x32_bf16 v[36:39], v[56:59], v[180:183], v[36:39]
ds_read_b64_tr_b16 v[52:53], v12 offset:61440
v_mfma_f32_16x16x32_bf16 v[36:39], v[60:63], v[188:191], v[36:39]
ds_read_b64_tr_b16 v[54:55], v12 offset:62464
s_waitcnt lgkmcnt(10)
v_mfma_f32_16x16x32_bf16 v[24:27], v[64:67], v[176:179], v[24:27]
ds_read_b64_tr_b16 v[56:57], v13 offset:57344
s_waitcnt lgkmcnt(9)
v_mfma_f32_16x16x32_bf16 v[24:27], v[68:71], v[184:187], v[24:27]
ds_read_b64_tr_b16 v[58:59], v13 offset:58368
v_mfma_f32_16x16x32_bf16 v[40:43], v[64:67], v[180:183], v[40:43]
ds_read_b64_tr_b16 v[60:61], v13 offset:61440
v_mfma_f32_16x16x32_bf16 v[40:43], v[68:71], v[188:191], v[40:43]
ds_read_b64_tr_b16 v[62:63], v13 offset:62464
s_waitcnt lgkmcnt(10)
v_mfma_f32_16x16x32_bf16 v[28:31], v[72:75], v[176:179], v[28:31]
ds_read_b64_tr_b16 v[64:65], v14 offset:57344
s_waitcnt lgkmcnt(9)
v_mfma_f32_16x16x32_bf16 v[28:31], v[76:79], v[184:187], v[28:31]
ds_read_b64_tr_b16 v[66:67], v14 offset:58368
v_mfma_f32_16x16x32_bf16 v[44:47], v[72:75], v[180:183], v[44:47]
ds_read_b64_tr_b16 v[68:69], v14 offset:61440
v_mfma_f32_16x16x32_bf16 v[44:47], v[76:79], v[188:191], v[44:47]
ds_read_b64_tr_b16 v[70:71], v14 offset:62464
s_waitcnt vmcnt(3) lgkmcnt(10)
v_mfma_f32_16x16x32_bf16 v[16:19], v[48:51], v[192:195], v[16:19]
ds_read_b64_tr_b16 v[72:73], v15 offset:57344
s_waitcnt vmcnt(2) lgkmcnt(9)
v_mfma_f32_16x16x32_bf16 v[16:19], v[52:55], v[200:203], v[16:19]
ds_read_b64_tr_b16 v[74:75], v15 offset:58368
s_waitcnt vmcnt(1)
v_mfma_f32_16x16x32_bf16 v[32:35], v[48:51], v[196:199], v[32:35]
ds_read_b64_tr_b16 v[76:77], v15 offset:61440
s_waitcnt vmcnt(0)
v_mfma_f32_16x16x32_bf16 v[32:35], v[52:55], v[204:207], v[32:35]
ds_read_b64_tr_b16 v[78:79], v15 offset:62464
s_waitcnt lgkmcnt(10)
v_mfma_f32_16x16x32_bf16 v[20:23], v[56:59], v[192:195], v[20:23]
v_add_u32 v5, s34, 22
s_mov_b64 exec, 1
ds_write_b32 v3, v5
s_mov_b64 exec, -1
s_waitcnt lgkmcnt(9)
v_mfma_f32_16x16x32_bf16 v[20:23], v[60:63], v[200:203], v[20:23]
s_lshl2_add_u32 s73, s61, s58
s_lshl4_add_u32 s66, s61, s62
s_lshl2_add_u32 s68, s66, s58
v_mfma_f32_16x16x32_bf16 v[36:39], v[56:59], v[196:199], v[36:39]
s_lshl_b32 s68, s68, 12
s_add_u32 s68, s68, 26214400
s_lshl_b32 s66, s61, 7
v_mfma_f32_16x16x32_bf16 v[36:39], v[60:63], v[204:207], v[36:39]
s_add_u32 s66, s66, s62
s_lshl_b32 s66, s66, 7
s_add_u32 s66, s66, 274432
s_waitcnt lgkmcnt(7)
v_mfma_f32_16x16x32_bf16 v[24:27], v[64:67], v[192:195], v[24:27]
s_lshl_b32 s74, s73, 13
s_add_u32 s74, s74, 524288
s_lshl_b32 s67, s62, 9
s_waitcnt lgkmcnt(5)
v_mfma_f32_16x16x32_bf16 v[24:27], v[68:71], v[200:203], v[24:27]
s_add_u32 s67, s67, s74
v_lshlrev_b32 v6, 4, v0
s_mov_b32 s69, 0x3f803f80
v_mfma_f32_16x16x32_bf16 v[40:43], v[64:67], v[196:199], v[40:43]
v_mov_b32 v8, 0
v_mov_b32 v9, 0
v_mov_b32 v10, 0
v_mfma_f32_16x16x32_bf16 v[40:43], v[68:71], v[204:207], v[40:43]
v_mov_b32 v12, 0
v_mov_b32 v13, 0
v_mov_b32 v14, 0
s_waitcnt lgkmcnt(3)
v_mfma_f32_16x16x32_bf16 v[28:31], v[72:75], v[192:195], v[28:31]
v_mov_b32 v11, v208
v_cvt_pk_bf16_f32 v240, v16, v17
v_cvt_pk_bf16_f32 v241, v18, v19
s_waitcnt lgkmcnt(1)
v_mfma_f32_16x16x32_bf16 v[28:31], v[76:79], v[200:203], v[28:31]
v_cvt_pk_bf16_f32 v248, v32, v33
v_cvt_pk_bf16_f32 v249, v34, v35
v_cvt_pk_bf16_f32 v242, v20, v21
v_mfma_f32_16x16x32_bf16 v[44:47], v[72:75], v[196:199], v[44:47]
v_cvt_pk_bf16_f32 v243, v22, v23
v_cvt_pk_bf16_f32 v250, v36, v37
v_cvt_pk_bf16_f32 v251, v38, v39
v_mfma_f32_16x16x32_bf16 v[44:47], v[76:79], v[204:207], v[44:47]
s_cmp_eq_u32 s63, 0
v_cvt_pk_bf16_f32 v244, v24, v25
v_cvt_pk_bf16_f32 v245, v26, v27
v_cvt_pk_bf16_f32 v252, v40, v41
v_cvt_pk_bf16_f32 v253, v42, v43
v_cvt_pk_bf16_f32 v246, v28, v29
v_cvt_pk_bf16_f32 v247, v30, v31
s_nop 0
v_cvt_pk_bf16_f32 v254, v44, v45
v_cvt_pk_bf16_f32 v255, v46, v47
s_cselect_b64 exec, -1, 0
s_cmp_eq_u32 s57, 0
s_cbranch_scc1 far_171
buffer_store_dwordx4 v[240:243], v6, s[20:23], s68 offen offset:0
buffer_store_dwordx4 v[244:247], v6, s[20:23], s68 offen offset:1024
buffer_store_dwordx4 v[248:251], v6, s[20:23], s68 offen offset:2048
buffer_store_dwordx4 v[252:255], v6, s[20:23], s68 offen offset:3072
near_172:
s_mov_b64 exec, -1
v_dot2c_f32_bf16 v8, s69, v240
v_dot2c_f32_bf16 v9, v240, v240
v_dot2c_f32_bf16 v10, v232, v240
v_dot2c_f32_bf16 v12, s69, v248
v_dot2c_f32_bf16 v13, v248, v248
v_dot2c_f32_bf16 v14, v232, v248
v_dot2c_f32_bf16 v8, s69, v241
v_dot2c_f32_bf16 v9, v241, v241
v_dot2c_f32_bf16 v10, v233, v241
v_dot2c_f32_bf16 v12, s69, v249
v_dot2c_f32_bf16 v13, v249, v249
v_dot2c_f32_bf16 v14, v233, v249
v_dot2c_f32_bf16 v8, s69, v242
v_dot2c_f32_bf16 v9, v242, v242
v_dot2c_f32_bf16 v10, v234, v242
v_dot2c_f32_bf16 v12, s69, v250
v_dot2c_f32_bf16 v13, v250, v250
v_dot2c_f32_bf16 v14, v234, v250
v_dot2c_f32_bf16 v8, s69, v243
v_dot2c_f32_bf16 v9, v243, v243
v_dot2c_f32_bf16 v10, v235, v243
v_dot2c_f32_bf16 v12, s69, v251
v_dot2c_f32_bf16 v13, v251, v251
v_dot2c_f32_bf16 v14, v235, v251
v_dot2c_f32_bf16 v8, s69, v244
v_dot2c_f32_bf16 v9, v244, v244
v_dot2c_f32_bf16 v10, v236, v244
v_dot2c_f32_bf16 v12, s69, v252
v_dot2c_f32_bf16 v13, v252, v252
v_dot2c_f32_bf16 v14, v236, v252
v_dot2c_f32_bf16 v8, s69, v245
v_dot2c_f32_bf16 v9, v245, v245
v_dot2c_f32_bf16 v10, v237, v245
v_dot2c_f32_bf16 v12, s69, v253
v_dot2c_f32_bf16 v13, v253, v253
v_dot2c_f32_bf16 v14, v237, v253
v_dot2c_f32_bf16 v8, s69, v246
v_dot2c_f32_bf16 v9, v246, v246
v_dot2c_f32_bf16 v10, v238, v246
v_dot2c_f32_bf16 v12, s69, v254
v_dot2c_f32_bf16 v13, v254, v254
v_dot2c_f32_bf16 v14, v238, v254
v_dot2c_f32_bf16 v8, s69, v247
v_dot2c_f32_bf16 v9, v247, v247
v_dot2c_f32_bf16 v10, v239, v247
v_dot2c_f32_bf16 v12, s69, v255
v_dot2c_f32_bf16 v13, v255, v255
v_dot2c_f32_bf16 v14, v239, v255
v_mov_b32 v15, v11
v_lshrrev_b32 v7, 5, v0
v_mul_u32_u24 v7, 3584, v7
v_permlane16_swap_b32 v8, v12
v_permlane16_swap_b32 v9, v13
v_permlane16_swap_b32 v10, v14
v_permlane16_swap_b32 v11, v15
v_pk_add_f32 v[8:9], v[8:9], v[12:13]
v_pk_add_f32 v[10:11], v[10:11], v[14:15]
v_mov_b32 v12, v8
v_mov_b32 v13, v9
v_mov_b32 v14, v10
v_mov_b32 v15, v11
v_permlane32_swap_b32 v12, v8
v_permlane32_swap_b32 v13, v9
v_permlane32_swap_b32 v14, v10
v_permlane32_swap_b32 v15, v11
v_pk_add_f32 v[8:9], v[8:9], v[12:13]
v_pk_add_f32 v[10:11], v[10:11], v[14:15]
v_add_u32 v7, v6, v7
v_max_u32 v8, 1, v8
v_max_u32 v9, 1, v9
v_max_u32 v10, 1, v10
v_max_u32 v11, 1, v11
s_mov_b32 exec_hi, 0
s_cmp_eq_u32 s57, 0
s_cbranch_scc1 far_173
buffer_store_dwordx4 v[8:11], v6, s[24:27], s67 offen
near_174:
s_mov_b32 exec_hi, -1
v_lshlrev_b32 v16, 16, v240
v_and_b32 v17, 0xffff0000, v240
v_lshlrev_b32 v18, 16, v241
v_and_b32 v19, 0xffff0000, v241
v_lshlrev_b32 v20, 16, v242
v_and_b32 v21, 0xffff0000, v242
v_lshlrev_b32 v22, 16, v243
v_and_b32 v23, 0xffff0000, v243
v_lshlrev_b32 v24, 16, v244
v_and_b32 v25, 0xffff0000, v244
v_lshlrev_b32 v26, 16, v245
v_and_b32 v27, 0xffff0000, v245
v_lshlrev_b32 v28, 16, v246
v_and_b32 v29, 0xffff0000, v246
v_lshlrev_b32 v30, 16, v247
v_and_b32 v31, 0xffff0000, v247
v_lshlrev_b32 v32, 16, v248
v_and_b32 v33, 0xffff0000, v248
v_lshlrev_b32 v34, 16, v249
v_and_b32 v35, 0xffff0000, v249
v_lshlrev_b32 v36, 16, v250
v_and_b32 v37, 0xffff0000, v250
v_lshlrev_b32 v38, 16, v251
v_and_b32 v39, 0xffff0000, v251
v_lshlrev_b32 v40, 16, v252
v_and_b32 v41, 0xffff0000, v252
v_lshlrev_b32 v42, 16, v253
v_and_b32 v43, 0xffff0000, v253
v_lshlrev_b32 v44, 16, v254
v_and_b32 v45, 0xffff0000, v254
v_lshlrev_b32 v46, 16, v255
v_and_b32 v47, 0xffff0000, v255
v_and_b32 v14, 15, v0
v_lshlrev_b32 v14, 11, v14
v_bfe_u32 v15, v0, 4, 1
v_lshl_add_u32 v14, v15, 5, v14
v_lshrrev_b32 v15, 5, v0
v_lshl_add_u32 v14, v15, 4, v14
s_lshl2_add_u32 s70, s61, s58
s_lshl_b32 s70, s70, 16
s_lshl_b32 s71, s62, 7
s_add_u32 s70, s70, s71
s_add_u32 s71, s70, 0x8000
s_lshl_b32 s67, s62, 6
s_sub_u32 s68, s66, 2048
s_lshl1_add_u32 s69, s67, s68
s_sub_u32 s69, s69, 10240
s_sub_u32 s72, s68, s67
s_add_u32 s72, s72, 4096
s_lshl_b32 s75, s73, 5
s_add_u32 s75, s75, 1
v_and_b32 v15, 48, v0
v_add_u32 v13, s75, v0
v_lshlrev_b32 v4, 1, v15
s_mov_b64 exec, 1
s_waitcnt vmcnt(1)
s_cmp_eq_u32 s57, 0
s_cbranch_scc1 far_175
buffer_store_dword v212, v3, s[24:27], s66 offen
near_176:
s_mov_b64 exec, -1
v_add_u32 v5, s34, 23
s_mov_b64 exec, 1
ds_write_b32 v3, v5
s_mov_b64 exec, -1
s_waitcnt vmcnt(1)
buffer_load_dwordx4 v[80:83], v7, s[24:27], s74 offen offset:0 sc1
buffer_load_dwordx4 v[84:87], v7, s[24:27], s74 offen offset:512 sc1
buffer_load_dwordx4 v[88:91], v7, s[24:27], s74 offen offset:1024 sc1
buffer_load_dwordx4 v[92:95], v7, s[24:27], s74 offen offset:1536 sc1
buffer_load_dwordx4 v[96:99], v7, s[24:27], s74 offen offset:2048 sc1
buffer_load_dwordx4 v[100:103], v7, s[24:27], s74 offen offset:2560 sc1
buffer_load_dwordx4 v[104:107], v7, s[24:27], s74 offen offset:3072 sc1
buffer_load_dwordx4 v[108:111], v7, s[24:27], s74 offen offset:3584 sc1
s_cmp_eq_u32 s63, 0
s_cbranch_scc0 mhz_177
v_lshrrev_b32 v196, 4, v0
s_cmp_eq_u32 1, 0
s_cbranch_scc0 mq_178
v_bfe_u32 v197, v0, 1, 3
v_xor_b32 v197, v197, v196
v_lshlrev_b32 v197, 4, v197
v_and_b32 v198, 15, v0
v_lshl_add_u32 v192, v198, 7, v197
v_xor_b32 v193, 64, v192
s_branch mq_179
mq_178:
v_lshlrev_b32 v192, 4, v0
v_add_u32 v193, 1024, v192
mq_179:
s_lshl_b32 s46, s65, 13
s_add_u32 s46, s46, 86016
v_add_u32 v192, s46, v192
v_add_u32 v193, s46, v193
v_bfe_u32 v197, v0, 2, 2
v_lshl_add_u32 v197, v196, 3, v197
v_bfe_u32 v198, v0, 3, 2
s_lshl_b32 s46, s64, 1
v_xor_b32 v198, s46, v198
v_lshlrev_b32 v198, 5, v198
v_lshl_add_u32 v197, v197, 7, v198
v_and_b32 v198, 3, v0
v_lshl_add_u32 v197, v198, 3, v197
v_add_u32 v194, 102400, v197
v_xor_b32 v195, 32, v194
v_mov_b32 v197, 0xf149f2ca
v_xor_b32 v216, v197, v216
v_xor_b32 v217, v197, v217
v_xor_b32 v218, v197, v218
v_xor_b32 v219, v197, v219
v_xor_b32 v220, v197, v220
v_xor_b32 v221, v197, v221
v_xor_b32 v222, v197, v222
v_xor_b32 v223, v197, v223
v_xor_b32 v224, v197, v224
v_xor_b32 v225, v197, v225
v_xor_b32 v226, v197, v226
v_xor_b32 v227, v197, v227
v_xor_b32 v228, v197, v228
v_xor_b32 v229, v197, v229
v_xor_b32 v230, v197, v230
v_xor_b32 v231, v197, v231
v_and_b32 v196, 15, v0
v_lshrrev_b32 v197, 4, v0
s_lshl_b32 s46, s65, 8
s_add_u32 s46, s46, 1280
s_mul_i32 s47, s64, 384
v_lshl_add_u32 v208, v196, 2, s46
v_lshl_add_u32 v209, v197, 4, s46
v_lshl_add_u32 v210, v196, 2, s47
v_lshl_add_u32 v211, v197, 4, s47
v_and_b32 v198, 1, v197
v_lshrrev_b32 v197, 1, v197
v_lshlrev_b32 v197, 9, v197
v_lshl_add_u32 v197, v198, 10, v197
s_lshl_b32 s46, s64, 12
s_lshl_b32 s47, s65, 13
s_add_u32 s46, s46, 131072
s_add_u32 s48, s46, 24576
s_sub_u32 s48, s48, s47
s_add_u32 s47, s46, s47
v_lshl_add_u32 v200, v196, 4, v197
v_and_b32 v198, 3, v0
v_lshl_add_u32 v197, v198, 4, v197
v_bfe_u32 v198, v0, 3, 1
v_lshl_add_u32 v197, v198, 6, v197
v_bfe_u32 v198, v0, 2, 1
v_lshl_add_u32 v198, v198, 8, v197
v_add_u32 v199, s48, v198
v_add_u32 v198, s47, v198
v_add_u32 v201, s48, v200
v_add_u32 v200, s47, v200
s_lshl_b32 s46, s59, 4
s_add_u32 s46, s46, s60
s_lshl_b32 s50, s59, 7
s_add_u32 s50, s50, s60
s_lshl_b32 s50, s50, 7
s_lshl_b32 s46, s46, 15
s_lshl_b32 s47, 1, 23
s_add_u32 s46, s46, s47
s_add_u32 s49, s46, 917504
mhz_177:
s_branch pchk_181
poll_180:
buffer_load_dwordx4 v[80:83], v7, s[24:27], s74 offen offset:0 sc1
buffer_load_dwordx4 v[84:87], v7, s[24:27], s74 offen offset:512 sc1
buffer_load_dwordx4 v[88:91], v7, s[24:27], s74 offen offset:1024 sc1
buffer_load_dwordx4 v[92:95], v7, s[24:27], s74 offen offset:1536 sc1
buffer_load_dwordx4 v[96:99], v7, s[24:27], s74 offen offset:2048 sc1
buffer_load_dwordx4 v[100:103], v7, s[24:27], s74 offen offset:2560 sc1
buffer_load_dwordx4 v[104:107], v7, s[24:27], s74 offen offset:3072 sc1
buffer_load_dwordx4 v[108:111], v7, s[24:27], s74 offen offset:3584 sc1
pchk_181:
s_waitcnt vmcnt(7)
v_min3_u32 v8, v80, v81, v82
s_waitcnt vmcnt(6)
v_min3_u32 v8, v8, v83, v84
v_min3_u32 v8, v8, v85, v86
s_waitcnt vmcnt(5)
v_min3_u32 v8, v8, v87, v88
v_min3_u32 v8, v8, v89, v90
s_waitcnt vmcnt(4)
v_min3_u32 v8, v8, v91, v92
v_min3_u32 v8, v8, v93, v94
s_waitcnt vmcnt(3)
v_min3_u32 v8, v8, v95, v96
v_min3_u32 v8, v8, v97, v98
s_waitcnt vmcnt(2)
v_min3_u32 v8, v8, v99, v100
v_min3_u32 v8, v8, v101, v102
s_waitcnt vmcnt(1)
v_min3_u32 v8, v8, v103, v104
v_min3_u32 v8, v8, v105, v106
s_waitcnt vmcnt(0)
v_min3_u32 v8, v8, v107, v108
v_min3_u32 v8, v8, v109, v110
v_min_u32 v8, v8, v111
v_cmp_eq_u32 vcc, 0, v8
s_mov_b64 exec, vcc
s_cbranch_vccz pdone_182
s_sleep 1
s_sub_u32 s32, s32, 1
s_cmp_gt_i32 s32, 0
s_cbranch_scc1 poll_180
pdone_182:
s_mov_b64 exec, -1
v_pk_add_f32 v[80:81], v[80:81], v[96:97]
v_pk_add_f32 v[82:83], v[82:83], v[98:99]
v_pk_add_f32 v[84:85], v[84:85], v[100:101]
v_pk_add_f32 v[86:87], v[86:87], v[102:103]
v_pk_add_f32 v[88:89], v[88:89], v[104:105]
v_pk_add_f32 v[90:91], v[90:91], v[106:107]
v_pk_add_f32 v[92:93], v[92:93], v[108:109]
v_pk_add_f32 v[94:95], v[94:95], v[110:111]
v_pk_add_f32 v[80:81], v[80:81], v[88:89]
v_pk_add_f32 v[82:83], v[82:83], v[90:91]
v_pk_add_f32 v[84:85], v[84:85], v[92:93]
v_pk_add_f32 v[86:87], v[86:87], v[94:95]
v_pk_add_f32 v[80:81], v[80:81], v[84:85]
v_pk_add_f32 v[82:83], v[82:83], v[86:87]
v_mov_b32 v8, v80
v_mov_b32 v9, v81
v_mov_b32 v10, v82
v_mov_b32 v11, v83
v_permlane32_swap_b32 v8, v80
v_permlane32_swap_b32 v9, v81
v_permlane32_swap_b32 v10, v82
v_permlane32_swap_b32 v11, v83
v_pk_add_f32 v[8:9], v[8:9], v[80:81]
v_pk_add_f32 v[10:11], v[10:11], v[82:83]
v_mul_f32 v8, 0xba800000, v8
v_mul_f32 v9, 0x3a800000, v9
v_fma_f32 v9, -v8, v8, v9
v_max_f32 v9, 0, v9
v_add_f32 v12, 0x3727c5ac, v9
v_rsq_f32 v80, v12
v_fma_f32 v10, v8, v11, v10
v_mul_f32 v12, v80, v10
v_max_u32 v12, 1, v12
v_add_u32 v7, s34, v3
v_mov_b32 v6, v12
s_nop 1
v_max_f32_dpp v6, v6, v6 row_ror:1 row_mask:0xf bank_mask:0xf
s_nop 1
v_max_f32_dpp v6, v6, v6 row_ror:2 row_mask:0xf bank_mask:0xf
s_nop 1
v_max_f32_dpp v6, v6, v6 row_ror:4 row_mask:0xf bank_mask:0xf
s_nop 1
v_max_f32_dpp v6, v6, v6 row_ror:8 row_mask:0xf bank_mask:0xf
v_mov_b32 v11, v6
s_nop 1
v_permlane16_swap_b32 v11, v6
v_max_f32 v6, v6, v11
v_cmp_eq_f32 vcc, v6, v12
s_ff1_i32_b64 s66, vcc
s_and_b32 s66, s66, 31
s_mov_b64 exec, 1
ds_write_b32 v7, v6 offset:256
s_mov_b64 exec, -1
v_add_u32 v7, s34, v1
v_mul_f32 v81, v8, v80
v_add_f32 v10, 1.0, v80
v_mov_b32 v82, v80
v_mov_b32 v83, v81
s_and_b32 s67, s66, 15
s_lshl_b32 s67, 0x10001, s67
s_bitcmp0_b32 s66, 4
v_permlane16_swap_b32 v80, v82
v_permlane16_swap_b32 v81, v83
s_cselect_b32 s76, s67, 0
s_cselect_b32 s78, 0, s67
s_cselect_b32 s77, s67, 0
s_cselect_b32 s79, 0, s67
s_add_u32 s75, s75, s66
s_bitcmp0_b32 s66, 4
s_cbranch_scc0 mu_183
v_pk_fma_f32 v[48:49], v[16:17], v[80:81], v[80:81] op_sel:[0,0,1] op_sel_hi:[1,0,1]
v_pk_fma_f32 v[50:51], v[18:19], v[80:81], v[80:81] op_sel:[0,0,1] op_sel_hi:[1,0,1]
v_pk_fma_f32 v[52:53], v[20:21], v[80:81], v[80:81] op_sel:[0,0,1] op_sel_hi:[1,0,1]
v_pk_fma_f32 v[54:55], v[22:23], v[80:81], v[80:81] op_sel:[0,0,1] op_sel_hi:[1,0,1]
v_pk_fma_f32 v[56:57], v[24:25], v[80:81], v[80:81] op_sel:[0,0,1] op_sel_hi:[1,0,1]
v_pk_fma_f32 v[58:59], v[26:27], v[80:81], v[80:81] op_sel:[0,0,1] op_sel_hi:[1,0,1]
v_pk_fma_f32 v[60:61], v[28:29], v[80:81], v[80:81] op_sel:[0,0,1] op_sel_hi:[1,0,1]
v_pk_fma_f32 v[62:63], v[30:31], v[80:81], v[80:81] op_sel:[0,0,1] op_sel_hi:[1,0,1]
v_cvt_pk_bf16_f32 v84, v48, v49
v_cvt_pk_bf16_f32 v85, v50, v51
v_cvt_pk_bf16_f32 v86, v52, v53
v_cvt_pk_bf16_f32 v87, v54, v55
v_cvt_pk_bf16_f32 v88, v56, v57
v_cvt_pk_bf16_f32 v89, v58, v59
v_cvt_pk_bf16_f32 v90, v60, v61
v_cvt_pk_bf16_f32 v91, v62, v63
ds_read_b32 v11, v7 offset:256
v_max_u32 v84, 1, v84
v_max_u32 v85, 1, v85
v_max_u32 v86, 1, v86
v_max_u32 v87, 1, v87
v_max_u32 v88, 1, v88
v_max_u32 v89, 1, v89
v_max_u32 v90, 1, v90
v_max_u32 v91, 1, v91
s_branch pchk_186
poll_185:
ds_read_b32 v11, v7 offset:256
pchk_186:
s_waitcnt lgkmcnt(0)
v_cmp_eq_u32 vcc, 0, v11
s_cbranch_vccz pdone_187
s_sub_u32 s32, s32, 1
s_cmp_gt_i32 s32, 0
s_cbranch_scc1 poll_185
pdone_187:
v_cmp_eq_f32 vcc, v11, v6
s_bfm_b32 s67, s58, 0
s_and_b32 s67, s67, vcc_lo
v_cmp_gt_f32 vcc, v11, v6
s_lshl_b32 s66, 1, s66
s_or_b32 s67, s67, vcc_lo
s_cselect_b64 s[76:77], 0, s[76:77]
s_cselect_b64 s[78:79], 0, s[78:79]
s_cselect_b64 exec, 0, s[66:67]
s_bitcmp0_b32 s62, 0
s_cselect_b64 exec, exec, 0
buffer_store_dwordx2 v[12:13], off, s[24:27], s72 sc1
s_mov_b64 exec, s[76:77]
buffer_store_dwordx4 v[84:87], v4, s[24:27], s68 offen offset:0 sc1
buffer_store_dwordx4 v[88:91], v4, s[24:27], s68 offen offset:16 sc1
s_mov_b64 exec, -1
v_add_u32 v5, s34, 24
s_mov_b64 exec, 1
ds_write_b32 v3, v5
s_mov_b64 exec, -1
v_pk_fma_f32 v[64:65], v[32:33], v[82:83], v[82:83] op_sel:[0,0,1] op_sel_hi:[1,0,1]
v_pk_fma_f32 v[66:67], v[34:35], v[82:83], v[82:83] op_sel:[0,0,1] op_sel_hi:[1,0,1]
v_pk_fma_f32 v[68:69], v[36:37], v[82:83], v[82:83] op_sel:[0,0,1] op_sel_hi:[1,0,1]
v_pk_fma_f32 v[70:71], v[38:39], v[82:83], v[82:83] op_sel:[0,0,1] op_sel_hi:[1,0,1]
v_pk_fma_f32 v[72:73], v[40:41], v[82:83], v[82:83] op_sel:[0,0,1] op_sel_hi:[1,0,1]
v_pk_fma_f32 v[74:75], v[42:43], v[82:83], v[82:83] op_sel:[0,0,1] op_sel_hi:[1,0,1]
v_pk_fma_f32 v[76:77], v[44:45], v[82:83], v[82:83] op_sel:[0,0,1] op_sel_hi:[1,0,1]
v_pk_fma_f32 v[78:79], v[46:47], v[82:83], v[82:83] op_sel:[0,0,1] op_sel_hi:[1,0,1]
v_pk_add_f32 v[16:17], v[16:17], v[48:49]
v_pk_add_f32 v[18:19], v[18:19], v[50:51]
v_pk_add_f32 v[20:21], v[20:21], v[52:53]
v_pk_add_f32 v[22:23], v[22:23], v[54:55]
v_pk_add_f32 v[24:25], v[24:25], v[56:57]
v_pk_add_f32 v[26:27], v[26:27], v[58:59]
v_pk_add_f32 v[28:29], v[28:29], v[60:61]
v_pk_add_f32 v[30:31], v[30:31], v[62:63]
v_pk_add_f32 v[32:33], v[32:33], v[64:65]
v_pk_add_f32 v[34:35], v[34:35], v[66:67]
v_pk_add_f32 v[36:37], v[36:37], v[68:69]
v_pk_add_f32 v[38:39], v[38:39], v[70:71]
v_pk_add_f32 v[40:41], v[40:41], v[72:73]
v_pk_add_f32 v[42:43], v[42:43], v[74:75]
v_pk_add_f32 v[44:45], v[44:45], v[76:77]
v_pk_add_f32 v[46:47], v[46:47], v[78:79]
v_cvt_pk_bf16_f32 v240, v16, v17
v_cvt_pk_bf16_f32 v241, v18, v19
v_cvt_pk_bf16_f32 v242, v20, v21
v_cvt_pk_bf16_f32 v243, v22, v23
v_cvt_pk_bf16_f32 v244, v24, v25
v_cvt_pk_bf16_f32 v245, v26, v27
v_cvt_pk_bf16_f32 v246, v28, v29
v_cvt_pk_bf16_f32 v247, v30, v31
v_cvt_pk_bf16_f32 v248, v32, v33
v_cvt_pk_bf16_f32 v249, v34, v35
v_cvt_pk_bf16_f32 v250, v36, v37
v_cvt_pk_bf16_f32 v251, v38, v39
v_cvt_pk_bf16_f32 v252, v40, v41
v_cvt_pk_bf16_f32 v253, v42, v43
v_cvt_pk_bf16_f32 v254, v44, v45
v_cvt_pk_bf16_f32 v255, v46, v47
v_max_u32 v16, 1, v16
v_max_u32 v17, 1, v17
v_max_u32 v18, 1, v18
v_max_u32 v19, 1, v19
v_max_u32 v20, 1, v20
v_max_u32 v21, 1, v21
v_max_u32 v22, 1, v22
v_max_u32 v23, 1, v23
v_max_u32 v24, 1, v24
v_max_u32 v25, 1, v25
v_max_u32 v26, 1, v26
v_max_u32 v27, 1, v27
v_max_u32 v28, 1, v28
v_max_u32 v29, 1, v29
v_max_u32 v30, 1, v30
v_max_u32 v31, 1, v31
s_mov_b64 exec, s[76:77]
buffer_store_dwordx4 v[16:19], v15, s[24:27], s69 offen offset:0 sc1
buffer_store_dwordx4 v[20:23], v15, s[24:27], s69 offen offset:64 sc1
buffer_store_dwordx4 v[24:27], v15, s[24:27], s69 offen offset:128 sc1
buffer_store_dwordx4 v[28:31], v15, s[24:27], s69 offen offset:192 sc1
s_mov_b64 exec, -1
mu_184:
s_cmp_eq_u32 s63, 0
s_cbranch_scc0 mout_188
v_mul_f32 v11, v10, v10
v_mov_b32 v12, 0x3727c5ac
v_fma_f32 v11, v11, v9, v12
v_rsq_f32 v11, v11
v_lshrrev_b32 v12, 3, v0
v_lshlrev_b32 v12, 6, v12
v_lshl_add_u32 v12, v0, 3, v12
v_mul_f32 v10, v10, v11
v_mul_f32 v11, v8, v10
s_lshl_b32 s66, s61, 5
s_add_u32 s66, s66, s58
s_lshl_b32 s66, s66, 9
s_add_u32 s66, s66, 1675264
v_max_u32 v11, 1, v11
s_cmp_eq_u32 s62, 8
s_cselect_b32 exec_lo, -1, 0
s_mov_b32 exec_hi, 0
s_cmp_eq_u32 s57, 0
s_cbranch_scc1 far_189
buffer_store_dwordx2 v[10:11], v12, s[24:27], s66 offen
near_190:
s_mov_b64 exec, -1
s_mov_b32 s63, 1
s_mov_b32 s34, 32
s_add_u32 s24, s24, 1409024
s_addc_u32 s25, s25, 0
s_mov_b32 s26, 1409024
s_branch L_mtop
mout_188:
v_permlane16_swap_b32 v240, v242
v_permlane16_swap_b32 v241, v243
v_permlane16_swap_b32 v244, v246
v_permlane16_swap_b32 v245, v247
v_permlane16_swap_b32 v248, v250
v_permlane16_swap_b32 v249, v251
v_permlane16_swap_b32 v252, v254
v_permlane16_swap_b32 v253, v255
s_not_b64 exec, s[76:77]
buffer_store_dwordx4 v[240:243], v14, s[28:31], s70 offen offset:0
buffer_store_dwordx4 v[244:247], v14, s[28:31], s70 offen offset:64
s_not_b64 exec, s[78:79]
buffer_store_dwordx4 v[248:251], v14, s[28:31], s71 offen offset:0
buffer_store_dwordx4 v[252:255], v14, s[28:31], s71 offen offset:64
s_mov_b64 exec, -1
s_or_b32 s66, s76, s78
s_cbranch_scc0 L_end
v_mov_b32 v11, 0
s_add_u32 s35, s34, 4
lw_191:
ds_read_b32 v5, v2 offset:24
s_waitcnt lgkmcnt(0)
v_cmp_gt_i32 vcc, s35, v5
s_cbranch_vccz lwd_192
s_sleep 2
s_sub_u32 s32, s32, 1
s_cmp_gt_i32 s32, 0
s_cbranch_scc1 lw_191
lwd_192:
ds_read_b32 v11, v11 offset:32
s_waitcnt lgkmcnt(0)
v_cmp_eq_u32 vcc, s75, v11
s_cbranch_vccnz L_end
s_mov_b64 exec, s[76:77]
buffer_store_dwordx4 v[240:243], v14, s[28:31], s70 offen offset:0
buffer_store_dwordx4 v[244:247], v14, s[28:31], s70 offen offset:64
s_mov_b64 exec, s[78:79]
buffer_store_dwordx4 v[248:251], v14, s[28:31], s71 offen offset:0
buffer_store_dwordx4 v[252:255], v14, s[28:31], s71 offen offset:64
s_mov_b64 exec, -1
s_branch L_end
mspin_134:
ds_read_b32 v5, v2 offset:16
s_waitcnt lgkmcnt(0)
v_cmp_ge_u32 vcc, v4, v5
s_cbranch_vccz mback_135
s_sub_u32 s32, s32, 1
s_cmp_gt_i32 s32, 0
s_cbranch_scc1 mspin_134
s_branch mback_135
mspin_132:
msp_193:
ds_read_b32 v5, v2 offset:16
s_waitcnt lgkmcnt(0)
v_cmp_ge_u32 vcc, v4, v5
s_cbranch_vccz mback_133
s_sub_u32 s32, s32, 1
s_cmp_gt_i32 s32, 0
s_cbranch_scc1 msp_193
s_branch mback_133
lspin_136:
s_add_u32 s35, s34, 2
lw_194:
ds_read_b32 v5, v2 offset:24
s_waitcnt lgkmcnt(0)
v_cmp_gt_i32 vcc, s35, v5
s_cbranch_vccz lwd_195
s_sub_u32 s32, s32, 1
s_cmp_gt_i32 s32, 0
s_cbranch_scc1 lw_194
lwd_195:
s_branch lback_137
patch_138:
s_bfe_u32 s66, s33, 0x20005
s_lshr_b32 s67, s66, 1
s_xor_b32 s66, s66, s67
s_and_b32 s66, s66, 1
s_cmp_eq_u32 s66, s65
s_cbranch_scc0 pback_139
s_bfe_u32 s66, s33, 0x10004
s_lshl1_add_u32 s73, s67, s66
s_and_b32 s66, s33, 15
s_mov_b32 s74, 0x10001
s_mov_b32 s75, s74
s_lshl_b64 s[74:75], s[74:75], s66
s_and_b32 s66, s66, 12
s_lshl_b32 s66, s66, 2
s_bfm_b64 s[76:77], 16, s66
s_nop 7
s_mov_b64 exec, s[74:75]
s_cmp_eq_u32 s73, 0
s_cbranch_scc0 pnx_197
ds_read_b128 v[16:19], v211 offset:3456
ds_read_b128 v[20:23], v211 offset:3520
s_branch pdn_196
pnx_197:
s_cmp_eq_u32 s73, 1
s_cbranch_scc0 pnx_198
ds_read_b128 v[24:27], v211 offset:3456
ds_read_b128 v[28:31], v211 offset:3520
s_branch pdn_196
pnx_198:
s_cmp_eq_u32 s73, 2
s_cbranch_scc0 pnx_199
ds_read_b128 v[32:35], v211 offset:3456
ds_read_b128 v[36:39], v211 offset:3520
s_branch pdn_196
pnx_199:
ds_read_b128 v[40:43], v211 offset:3456
ds_read_b128 v[44:47], v211 offset:3520
pdn_196:
s_mov_b64 exec, -1
s_waitcnt lgkmcnt(0)
s_branch pback_139
patch_140:
s_nop 7
s_nop 7
s_and_b32 s66, s33, 3
s_lshl2_add_u32 s66, s73, s66
s_mov_b64 exec, s[76:77]
s_cmp_eq_u32 s66, 0
s_cbranch_scc0 pnx_202
ds_read_b32 v48, v210 offset:3584
ds_read_b32 v52, v210 offset:3648
s_branch pdn_201
pnx_202:
s_cmp_eq_u32 s66, 1
s_cbranch_scc0 pnx_203
ds_read_b32 v49, v210 offset:3584
ds_read_b32 v53, v210 offset:3648
s_branch pdn_201
pnx_203:
s_cmp_eq_u32 s66, 2
s_cbranch_scc0 pnx_204
ds_read_b32 v50, v210 offset:3584
ds_read_b32 v54, v210 offset:3648
s_branch pdn_201
pnx_204:
s_cmp_eq_u32 s66, 3
s_cbranch_scc0 pnx_205
ds_read_b32 v51, v210 offset:3584
ds_read_b32 v55, v210 offset:3648
s_branch pdn_201
pnx_205:
s_cmp_eq_u32 s66, 4
s_cbranch_scc0 pnx_206
ds_read_b32 v56, v210 offset:3584
ds_read_b32 v60, v210 offset:3648
s_branch pdn_201
pnx_206:
s_cmp_eq_u32 s66, 5
s_cbranch_scc0 pnx_207
ds_read_b32 v57, v210 offset:3584
ds_read_b32 v61, v210 offset:3648
s_branch pdn_201
pnx_207:
s_cmp_eq_u32 s66, 6
s_cbranch_scc0 pnx_208
ds_read_b32 v58, v210 offset:3584
ds_read_b32 v62, v210 offset:3648
s_branch pdn_201
pnx_208:
s_cmp_eq_u32 s66, 7
s_cbranch_scc0 pnx_209
ds_read_b32 v59, v210 offset:3584
ds_read_b32 v63, v210 offset:3648
s_branch pdn_201
pnx_209:
s_cmp_eq_u32 s66, 8
s_cbranch_scc0 pnx_210
ds_read_b32 v64, v210 offset:3584
ds_read_b32 v68, v210 offset:3648
s_branch pdn_201
pnx_210:
s_cmp_eq_u32 s66, 9
s_cbranch_scc0 pnx_211
ds_read_b32 v65, v210 offset:3584
ds_read_b32 v69, v210 offset:3648
s_branch pdn_201
pnx_211:
s_cmp_eq_u32 s66, 10
s_cbranch_scc0 pnx_212
ds_read_b32 v66, v210 offset:3584
ds_read_b32 v70, v210 offset:3648
s_branch pdn_201
pnx_212:
s_cmp_eq_u32 s66, 11
s_cbranch_scc0 pnx_213
ds_read_b32 v67, v210 offset:3584
ds_read_b32 v71, v210 offset:3648
s_branch pdn_201
pnx_213:
s_cmp_eq_u32 s66, 12
s_cbranch_scc0 pnx_214
ds_read_b32 v72, v210 offset:3584
ds_read_b32 v76, v210 offset:3648
s_branch pdn_201
pnx_214:
s_cmp_eq_u32 s66, 13
s_cbranch_scc0 pnx_215
ds_read_b32 v73, v210 offset:3584
ds_read_b32 v77, v210 offset:3648
s_branch pdn_201
pnx_215:
s_cmp_eq_u32 s66, 14
s_cbranch_scc0 pnx_216
ds_read_b32 v74, v210 offset:3584
ds_read_b32 v78, v210 offset:3648
s_branch pdn_201
pnx_216:
ds_read_b32 v75, v210 offset:3584
ds_read_b32 v79, v210 offset:3648
pdn_201:
s_mov_b64 exec, -1
s_waitcnt lgkmcnt(0)
s_branch pback_141
patch_142:
s_nop 7
s_nop 7
s_mov_b64 exec, s[74:75]
s_cmp_eq_u32 s73, 0
s_cbranch_scc0 pnx_219
ds_read_b128 v[80:83], v211 offset:3328
ds_read_b128 v[84:87], v211 offset:3392
s_branch pdn_218
pnx_219:
s_cmp_eq_u32 s73, 1
s_cbranch_scc0 pnx_220
ds_read_b128 v[88:91], v211 offset:3328
ds_read_b128 v[92:95], v211 offset:3392
s_branch pdn_218
pnx_220:
s_cmp_eq_u32 s73, 2
s_cbranch_scc0 pnx_221
ds_read_b128 v[96:99], v211 offset:3328
ds_read_b128 v[100:103], v211 offset:3392
s_branch pdn_218
pnx_221:
ds_read_b128 v[104:107], v211 offset:3328
ds_read_b128 v[108:111], v211 offset:3392
pdn_218:
s_mov_b64 exec, -1
s_waitcnt lgkmcnt(0)
s_branch pback_143
cross_153:
s_cmp_eq_u32 s67, 122880
s_cbranch_scc0 cr2_223
v_add_u32 v5, s34, 18
s_mov_b64 exec, 1
ds_write_b32 v3, v5
s_mov_b64 exec, -1
v_mov_b32 v9, 0xf149f2ca
v_xor_b32 v216, v9, v216
v_xor_b32 v217, v9, v217
v_xor_b32 v218, v9, v218
v_xor_b32 v219, v9, v219
v_xor_b32 v220, v9, v220
v_xor_b32 v221, v9, v221
v_xor_b32 v222, v9, v222
v_xor_b32 v223, v9, v223
v_xor_b32 v224, v9, v224
v_xor_b32 v225, v9, v225
v_xor_b32 v226, v9, v226
v_xor_b32 v227, v9, v227
v_xor_b32 v228, v9, v228
v_xor_b32 v229, v9, v229
v_xor_b32 v230, v9, v230
v_xor_b32 v231, v9, v231
s_mov_b32 s67, 114688
s_cmp_eq_u32 s63, 0
s_cbranch_scc0 cr3_224
v_and_b32 v9, 15, v0
v_lshlrev_b32 v9, 11, v9
v_bfe_u32 v10, v0, 4, 1
v_lshl_add_u32 v9, v10, 5, v9
v_lshrrev_b32 v10, 5, v0
v_lshl_add_u32 v9, v10, 4, v9
s_lshl2_add_u32 s70, s61, s58
s_lshl_b32 s70, s70, 16
s_lshl_b32 s71, s62, 7
s_add_u32 s70, s70, s71
s_add_u32 s71, s70, 0x8000
buffer_load_dwordx4 v[240:243], v9, s[8:11], s70 offen offset:0
buffer_load_dwordx4 v[244:247], v9, s[8:11], s70 offen offset:64
buffer_load_dwordx4 v[248:251], v9, s[8:11], s71 offen offset:0
buffer_load_dwordx4 v[252:255], v9, s[8:11], s71 offen offset:64
cr3_224:
s_cmp_eq_u32 s59, 0
s_cbranch_scc1 cback_154
v_mov_b32 v9, 0
s_add_u32 s35, s34, 18
lw_225:
ds_read_b32 v5, v9 offset:16
s_waitcnt lgkmcnt(0)
v_cmp_gt_i32 vcc, s35, v5
s_cbranch_vccz lwd_226
s_sub_u32 s32, s32, 1
s_cmp_gt_i32 s32, 0
s_cbranch_scc1 lw_225
lwd_226:
s_branch cback_154
cr2_223:
s_cmp_eq_u32 s67, 114688
s_cbranch_scc0 cr4_227
s_mov_b32 s67, 90112
s_add_u32 s35, s34, 21
lw_228:
ds_read_b32 v5, v9 offset:16
s_waitcnt lgkmcnt(0)
v_cmp_gt_i32 vcc, s35, v5
s_cbranch_vccz lwd_229
s_sub_u32 s32, s32, 1
s_cmp_gt_i32 s32, 0
s_cbranch_scc1 lw_228
lwd_229:
s_branch cback_154
cr4_227:
v_add_u32 v5, s34, 19
s_mov_b64 exec, 1
ds_write_b32 v3, v5
s_mov_b64 exec, -1
s_mov_b32 s66, 28672
s_cmp_lt_u32 s59, 2
s_cbranch_scc1 cback_154
s_add_u32 s35, s34, 21
lw_230:
ds_read_b32 v5, v2 offset:16
s_waitcnt lgkmcnt(0)
v_cmp_gt_i32 vcc, s35, v5
s_cbranch_vccz lwd_231
s_sub_u32 s32, s32, 1
s_cmp_gt_i32 s32, 0
s_cbranch_scc1 lw_230
lwd_231:
s_branch cback_154
cross_155:
s_cmp_eq_u32 s67, 122880
s_cbranch_scc0 cr2_232
s_waitcnt lgkmcnt(1)
v_add_u32 v5, s34, 18
s_mov_b64 exec, 1
ds_write_b32 v3, v5
s_mov_b64 exec, -1
v_mov_b32 v9, 0xf149f2ca
v_xor_b32 v216, v9, v216
v_xor_b32 v217, v9, v217
v_xor_b32 v218, v9, v218
v_xor_b32 v219, v9, v219
v_xor_b32 v220, v9, v220
v_xor_b32 v221, v9, v221
v_xor_b32 v222, v9, v222
v_xor_b32 v223, v9, v223
v_xor_b32 v224, v9, v224
v_xor_b32 v225, v9, v225
v_xor_b32 v226, v9, v226
v_xor_b32 v227, v9, v227
v_xor_b32 v228, v9, v228
v_xor_b32 v229, v9, v229
v_xor_b32 v230, v9, v230
v_xor_b32 v231, v9, v231
s_mov_b32 s67, 114688
s_cmp_eq_u32 s63, 0
s_cbranch_scc0 cr3_233
v_and_b32 v9, 15, v0
v_lshlrev_b32 v9, 11, v9
v_bfe_u32 v10, v0, 4, 1
v_lshl_add_u32 v9, v10, 5, v9
v_lshrrev_b32 v10, 5, v0
v_lshl_add_u32 v9, v10, 4, v9
s_lshl2_add_u32 s70, s61, s58
s_lshl_b32 s70, s70, 16
s_lshl_b32 s71, s62, 7
s_add_u32 s70, s70, s71
s_add_u32 s71, s70, 0x8000
buffer_load_dwordx4 v[240:243], v9, s[8:11], s70 offen offset:0
buffer_load_dwordx4 v[244:247], v9, s[8:11], s70 offen offset:64
buffer_load_dwordx4 v[248:251], v9, s[8:11], s71 offen offset:0
buffer_load_dwordx4 v[252:255], v9, s[8:11], s71 offen offset:64
cr3_233:
s_cmp_eq_u32 s59, 0
s_cbranch_scc1 cback_156
v_mov_b32 v9, 0
s_add_u32 s35, s34, 18
lw_234:
ds_read_b32 v5, v9 offset:16
s_waitcnt lgkmcnt(0)
v_cmp_gt_i32 vcc, s35, v5
s_cbranch_vccz lwd_235
s_sub_u32 s32, s32, 1
s_cmp_gt_i32 s32, 0
s_cbranch_scc1 lw_234
lwd_235:
s_branch cback_156
cr2_232:
s_waitcnt lgkmcnt(1)
v_cmp_gt_i32 vcc, s35, v5
s_cmp_eq_u32 s67, 114688
s_cbranch_scc0 cr4_236
s_mov_b32 s67, 90112
s_bitcmp0_b32 vcc_lo, 0
s_cbranch_scc1 cback_156
s_add_u32 s35, s34, 21
lw_237:
ds_read_b32 v5, v9 offset:16
s_waitcnt lgkmcnt(0)
v_cmp_gt_i32 vcc, s35, v5
s_cbranch_vccz lwd_238
s_sub_u32 s32, s32, 1
s_cmp_gt_i32 s32, 0
s_cbranch_scc1 lw_237
lwd_238:
s_branch cback_156
cr4_236:
v_add_u32 v5, s34, 19
s_mov_b64 exec, 1
ds_write_b32 v3, v5
s_mov_b64 exec, -1
s_mov_b32 s66, 28672
s_cmp_lt_u32 s59, 2
s_cbranch_scc1 cback_156
s_cbranch_vccz cback_156
s_add_u32 s35, s34, 21
lw_239:
ds_read_b32 v5, v2 offset:16
s_waitcnt lgkmcnt(0)
v_cmp_gt_i32 vcc, s35, v5
s_cbranch_vccz lwd_240
s_sub_u32 s32, s32, 1
s_cmp_gt_i32 s32, 0
s_cbranch_scc1 lw_239
lwd_240:
s_branch cback_156
slow_157:
s_add_u32 s70, s72, 270336
poll_241:
buffer_load_dword v10, v1, s[24:27], s70 offen sc1
pchk_242:
s_waitcnt vmcnt(0)
v_cmp_eq_u32 vcc, 0, v10
s_cbranch_vccz pdone_243
s_sub_u32 s32, s32, 1
s_cmp_gt_i32 s32, 0
s_cbranch_scc1 poll_241
pdone_243:
s_lshl_b32 s73, s60, 15
s_lshl_b32 s74, s63, 23
s_add_u32 s73, s73, s74
s_add_u32 s73, s73, 1048576
v_mov_b32 v10, 0xf149f2ca
v_mov_b32 v11, 0
v_mov_b32 v192, 0
v_mov_b32 v193, 0
v_mov_b32 v194, 0
v_mov_b32 v195, 0
v_mov_b32 v196, 0
v_mov_b32 v197, 0
v_mov_b32 v198, 0
v_mov_b32 v199, 0
v_mov_b32 v200, 0
v_mov_b32 v201, 0
v_mov_b32 v202, 0
v_mov_b32 v203, 0
v_mov_b32 v204, 0
v_mov_b32 v205, 0
v_mov_b32 v206, 0
v_mov_b32 v207, 0
v_mov_b32 v208, 0
v_mov_b32 v209, 0
v_mov_b32 v210, 0
v_mov_b32 v211, 0
s_lshl2_add_u32 s74, s59, s65
s_mov_b32 s75, 0
sl_244:
s_lshr_b32 s76, s74, 2
s_lshl_b32 s76, s76, 19
s_and_b32 s77, s74, 3
s_lshl_b32 s77, s77, 13
s_add_u32 s76, s76, s77
s_add_u32 s76, s76, s73
buffer_load_dwordx4 v[152:155], v6, s[20:23], s76 offen offset:0 sc1
buffer_load_dwordx4 v[156:159], v6, s[20:23], s76 offen offset:1024 sc1
s_cmp_eq_u32 s75, 0
s_cselect_b32 s76, 0xf149f2ca, 0
s_and_b32 s77, s75, 7
s_cselect_b32 s77, 0, -1
v_xor_b32 v112, s76, v216
v_and_b32 v112, s77, v112
v_xor_b32 v113, s76, v217
v_and_b32 v113, s77, v113
v_xor_b32 v114, s76, v218
v_and_b32 v114, s77, v114
v_xor_b32 v115, s76, v219
v_and_b32 v115, s77, v115
v_xor_b32 v116, s76, v220
v_and_b32 v116, s77, v116
v_xor_b32 v117, s76, v221
v_and_b32 v117, s77, v117
v_xor_b32 v118, s76, v222
v_and_b32 v118, s77, v118
v_xor_b32 v119, s76, v223
v_and_b32 v119, s77, v119
v_xor_b32 v120, s76, v224
v_and_b32 v120, s77, v120
v_xor_b32 v121, s76, v225
v_and_b32 v121, s77, v121
v_xor_b32 v122, s76, v226
v_and_b32 v122, s77, v122
v_xor_b32 v123, s76, v227
v_and_b32 v123, s77, v123
v_xor_b32 v124, s76, v228
v_and_b32 v124, s77, v124
v_xor_b32 v125, s76, v229
v_and_b32 v125, s77, v125
v_xor_b32 v126, s76, v230
v_and_b32 v126, s77, v126
v_xor_b32 v127, s76, v231
v_and_b32 v127, s77, v127
s_waitcnt vmcnt(1)
s_nop 0
v_mfma_f32_32x32x16_bf16 v[112:127], v[152:155], v[80:83], v[112:127]
s_waitcnt vmcnt(0)
v_mfma_f32_32x32x16_bf16 v[112:127], v[156:159], v[88:91], v[112:127]
s_nop 11
v_max3_f32 v10, v10, v112, v113
v_max3_f32 v10, v10, v114, v115
v_max3_f32 v10, v10, v116, v117
v_max3_f32 v10, v10, v118, v119
v_max3_f32 v10, v10, v120, v121
v_max3_f32 v10, v10, v122, v123
v_max3_f32 v10, v10, v124, v125
v_max3_f32 v10, v10, v126, v127
s_add_u32 s75, s75, 1
s_sub_u32 s74, s74, 1
s_cselect_b32 s75, 9, s75
s_cmp_lt_u32 s75, 9
s_cbranch_scc1 sl_244
v_mov_b32 v11, v10
s_nop 1
v_permlane32_swap_b32 v11, v10
v_max_f32 v10, v10, v11
s_lshl2_add_u32 s74, s59, s65
s_mov_b32 s75, 0
sl_245:
s_lshr_b32 s76, s74, 2
s_lshl_b32 s76, s76, 19
s_and_b32 s77, s74, 3
s_lshl_b32 s77, s77, 13
s_add_u32 s76, s76, s77
s_add_u32 s76, s76, s73
buffer_load_dwordx4 v[152:155], v6, s[20:23], s76 offen offset:0 sc1
buffer_load_dwordx4 v[156:159], v6, s[20:23], s76 offen offset:1024 sc1
buffer_load_dwordx4 v[160:163], v6, s[20:23], s76 offen offset:2048 sc1
buffer_load_dwordx4 v[164:167], v6, s[20:23], s76 offen offset:3072 sc1
s_cmp_eq_u32 s75, 0
s_cselect_b32 s76, 0xf149f2ca, 0
s_and_b32 s77, s75, 7
s_cselect_b32 s77, 0, -1
v_xor_b32 v112, s76, v216
v_and_b32 v112, s77, v112
v_sub_f32 v112, v112, v10
v_xor_b32 v113, s76, v217
v_and_b32 v113, s77, v113
v_sub_f32 v113, v113, v10
v_xor_b32 v114, s76, v218
v_and_b32 v114, s77, v114
v_sub_f32 v114, v114, v10
v_xor_b32 v115, s76, v219
v_and_b32 v115, s77, v115
v_sub_f32 v115, v115, v10
v_xor_b32 v116, s76, v220
v_and_b32 v116, s77, v116
v_sub_f32 v116, v116, v10
v_xor_b32 v117, s76, v221
v_and_b32 v117, s77, v117
v_sub_f32 v117, v117, v10
v_xor_b32 v118, s76, v222
v_and_b32 v118, s77, v118
v_sub_f32 v118, v118, v10
v_xor_b32 v119, s76, v223
v_and_b32 v119, s77, v119
v_sub_f32 v119, v119, v10
v_xor_b32 v120, s76, v224
v_and_b32 v120, s77, v120
v_sub_f32 v120, v120, v10
v_xor_b32 v121, s76, v225
v_and_b32 v121, s77, v121
v_sub_f32 v121, v121, v10
v_xor_b32 v122, s76, v226
v_and_b32 v122, s77, v122
v_sub_f32 v122, v122, v10
v_xor_b32 v123, s76, v227
v_and_b32 v123, s77, v123
v_sub_f32 v123, v123, v10
v_xor_b32 v124, s76, v228
v_and_b32 v124, s77, v124
v_sub_f32 v124, v124, v10
v_xor_b32 v125, s76, v229
v_and_b32 v125, s77, v125
v_sub_f32 v125, v125, v10
v_xor_b32 v126, s76, v230
v_and_b32 v126, s77, v126
v_sub_f32 v126, v126, v10
v_xor_b32 v127, s76, v231
v_and_b32 v127, s77, v127
v_sub_f32 v127, v127, v10
s_waitcnt vmcnt(3)
s_nop 0
v_mfma_f32_32x32x16_bf16 v[112:127], v[152:155], v[80:83], v[112:127]
s_waitcnt vmcnt(2)
v_mfma_f32_32x32x16_bf16 v[112:127], v[156:159], v[88:91], v[112:127]
s_nop 11
v_exp_f32 v112, v112
v_exp_f32 v113, v113
v_exp_f32 v114, v114
v_exp_f32 v115, v115
v_exp_f32 v116, v116
v_exp_f32 v117, v117
v_exp_f32 v118, v118
v_exp_f32 v119, v119
v_exp_f32 v120, v120
v_exp_f32 v121, v121
v_exp_f32 v122, v122
v_exp_f32 v123, v123
v_exp_f32 v124, v124
v_exp_f32 v125, v125
v_exp_f32 v126, v126
v_exp_f32 v127, v127
v_cvt_pk_bf16_f32 v144, v112, v113
v_cvt_pk_bf16_f32 v145, v114, v115
v_cvt_pk_bf16_f32 v146, v116, v117
v_cvt_pk_bf16_f32 v147, v118, v119
v_cvt_pk_bf16_f32 v148, v120, v121
v_cvt_pk_bf16_f32 v149, v122, v123
v_cvt_pk_bf16_f32 v150, v124, v125
v_cvt_pk_bf16_f32 v151, v126, v127
s_waitcnt vmcnt(1)
v_mfma_f32_32x32x16_bf16 v[192:207], v[160:163], v[144:147], v[192:207]
v_mfma_f32_16x16x32_bf16 v[208:211], v[212:215], v[144:147], v[208:211]
s_waitcnt vmcnt(0)
v_mfma_f32_32x32x16_bf16 v[192:207], v[164:167], v[148:151], v[192:207]
v_mfma_f32_16x16x32_bf16 v[208:211], v[212:215], v[148:151], v[208:211]
s_add_u32 s75, s75, 1
s_sub_u32 s74, s74, 1
s_cselect_b32 s75, 9, s75
s_cmp_lt_u32 s75, 9
s_cbranch_scc1 sl_245
v_mov_b32 v10, 0xf149f2ca
v_mov_b32 v11, 0
v_mov_b32 v16, 0
v_mov_b32 v17, 0
v_mov_b32 v18, 0
v_mov_b32 v19, 0
v_mov_b32 v20, 0
v_mov_b32 v21, 0
v_mov_b32 v22, 0
v_mov_b32 v23, 0
v_mov_b32 v24, 0
v_mov_b32 v25, 0
v_mov_b32 v26, 0
v_mov_b32 v27, 0
v_mov_b32 v28, 0
v_mov_b32 v29, 0
v_mov_b32 v30, 0
v_mov_b32 v31, 0
v_mov_b32 v32, 0
v_mov_b32 v33, 0
v_mov_b32 v34, 0
v_mov_b32 v35, 0
s_sub_u32 s74, 3, s65
s_lshl2_add_u32 s74, s59, s74
s_mov_b32 s75, 0
sl_246:
s_lshr_b32 s76, s74, 2
s_lshl_b32 s76, s76, 19
s_and_b32 s77, s74, 3
s_lshl_b32 s77, s77, 13
s_add_u32 s76, s76, s77
s_add_u32 s76, s76, s73
buffer_load_dwordx4 v[152:155], v6, s[20:23], s76 offen offset:0 sc1
buffer_load_dwordx4 v[156:159], v6, s[20:23], s76 offen offset:1024 sc1
s_cmp_eq_u32 s75, 0
s_cselect_b32 s76, 0xf149f2ca, 0
s_and_b32 s77, s75, 7
s_cselect_b32 s77, 0, -1
v_xor_b32 v112, s76, v216
v_and_b32 v112, s77, v112
v_xor_b32 v113, s76, v217
v_and_b32 v113, s77, v113
v_xor_b32 v114, s76, v218
v_and_b32 v114, s77, v114
v_xor_b32 v115, s76, v219
v_and_b32 v115, s77, v115
v_xor_b32 v116, s76, v220
v_and_b32 v116, s77, v116
v_xor_b32 v117, s76, v221
v_and_b32 v117, s77, v117
v_xor_b32 v118, s76, v222
v_and_b32 v118, s77, v118
v_xor_b32 v119, s76, v223
v_and_b32 v119, s77, v119
v_xor_b32 v120, s76, v224
v_and_b32 v120, s77, v120
v_xor_b32 v121, s76, v225
v_and_b32 v121, s77, v121
v_xor_b32 v122, s76, v226
v_and_b32 v122, s77, v122
v_xor_b32 v123, s76, v227
v_and_b32 v123, s77, v123
v_xor_b32 v124, s76, v228
v_and_b32 v124, s77, v124
v_xor_b32 v125, s76, v229
v_and_b32 v125, s77, v125
v_xor_b32 v126, s76, v230
v_and_b32 v126, s77, v126
v_xor_b32 v127, s76, v231
v_and_b32 v127, s77, v127
s_waitcnt vmcnt(1)
s_nop 0
v_mfma_f32_32x32x16_bf16 v[112:127], v[152:155], v[96:99], v[112:127]
s_waitcnt vmcnt(0)
v_mfma_f32_32x32x16_bf16 v[112:127], v[156:159], v[104:107], v[112:127]
s_nop 11
v_max3_f32 v10, v10, v112, v113
v_max3_f32 v10, v10, v114, v115
v_max3_f32 v10, v10, v116, v117
v_max3_f32 v10, v10, v118, v119
v_max3_f32 v10, v10, v120, v121
v_max3_f32 v10, v10, v122, v123
v_max3_f32 v10, v10, v124, v125
v_max3_f32 v10, v10, v126, v127
s_add_u32 s75, s75, 1
s_sub_u32 s74, s74, 1
s_cselect_b32 s75, 9, s75
s_cmp_lt_u32 s75, 9
s_cbranch_scc1 sl_246
v_mov_b32 v11, v10
s_nop 1
v_permlane32_swap_b32 v11, v10
v_max_f32 v10, v10, v11
s_sub_u32 s74, 3, s65
s_lshl2_add_u32 s74, s59, s74
s_mov_b32 s75, 0
sl_247:
s_lshr_b32 s76, s74, 2
s_lshl_b32 s76, s76, 19
s_and_b32 s77, s74, 3
s_lshl_b32 s77, s77, 13
s_add_u32 s76, s76, s77
s_add_u32 s76, s76, s73
buffer_load_dwordx4 v[152:155], v6, s[20:23], s76 offen offset:0 sc1
buffer_load_dwordx4 v[156:159], v6, s[20:23], s76 offen offset:1024 sc1
buffer_load_dwordx4 v[160:163], v6, s[20:23], s76 offen offset:2048 sc1
buffer_load_dwordx4 v[164:167], v6, s[20:23], s76 offen offset:3072 sc1
s_cmp_eq_u32 s75, 0
s_cselect_b32 s76, 0xf149f2ca, 0
s_and_b32 s77, s75, 7
s_cselect_b32 s77, 0, -1
v_xor_b32 v112, s76, v216
v_and_b32 v112, s77, v112
v_sub_f32 v112, v112, v10
v_xor_b32 v113, s76, v217
v_and_b32 v113, s77, v113
v_sub_f32 v113, v113, v10
v_xor_b32 v114, s76, v218
v_and_b32 v114, s77, v114
v_sub_f32 v114, v114, v10
v_xor_b32 v115, s76, v219
v_and_b32 v115, s77, v115
v_sub_f32 v115, v115, v10
v_xor_b32 v116, s76, v220
v_and_b32 v116, s77, v116
v_sub_f32 v116, v116, v10
v_xor_b32 v117, s76, v221
v_and_b32 v117, s77, v117
v_sub_f32 v117, v117, v10
v_xor_b32 v118, s76, v222
v_and_b32 v118, s77, v118
v_sub_f32 v118, v118, v10
v_xor_b32 v119, s76, v223
v_and_b32 v119, s77, v119
v_sub_f32 v119, v119, v10
v_xor_b32 v120, s76, v224
v_and_b32 v120, s77, v120
v_sub_f32 v120, v120, v10
v_xor_b32 v121, s76, v225
v_and_b32 v121, s77, v121
v_sub_f32 v121, v121, v10
v_xor_b32 v122, s76, v226
v_and_b32 v122, s77, v122
v_sub_f32 v122, v122, v10
v_xor_b32 v123, s76, v227
v_and_b32 v123, s77, v123
v_sub_f32 v123, v123, v10
v_xor_b32 v124, s76, v228
v_and_b32 v124, s77, v124
v_sub_f32 v124, v124, v10
v_xor_b32 v125, s76, v229
v_and_b32 v125, s77, v125
v_sub_f32 v125, v125, v10
v_xor_b32 v126, s76, v230
v_and_b32 v126, s77, v126
v_sub_f32 v126, v126, v10
v_xor_b32 v127, s76, v231
v_and_b32 v127, s77, v127
v_sub_f32 v127, v127, v10
s_waitcnt vmcnt(3)
s_nop 0
v_mfma_f32_32x32x16_bf16 v[112:127], v[152:155], v[96:99], v[112:127]
s_waitcnt vmcnt(2)
v_mfma_f32_32x32x16_bf16 v[112:127], v[156:159], v[104:107], v[112:127]
s_nop 11
v_exp_f32 v112, v112
v_exp_f32 v113, v113
v_exp_f32 v114, v114
v_exp_f32 v115, v115
v_exp_f32 v116, v116
v_exp_f32 v117, v117
v_exp_f32 v118, v118
v_exp_f32 v119, v119
v_exp_f32 v120, v120
v_exp_f32 v121, v121
v_exp_f32 v122, v122
v_exp_f32 v123, v123
v_exp_f32 v124, v124
v_exp_f32 v125, v125
v_exp_f32 v126, v126
v_exp_f32 v127, v127
v_cvt_pk_bf16_f32 v144, v112, v113
v_cvt_pk_bf16_f32 v145, v114, v115
v_cvt_pk_bf16_f32 v146, v116, v117
v_cvt_pk_bf16_f32 v147, v118, v119
v_cvt_pk_bf16_f32 v148, v120, v121
v_cvt_pk_bf16_f32 v149, v122, v123
v_cvt_pk_bf16_f32 v150, v124, v125
v_cvt_pk_bf16_f32 v151, v126, v127
s_waitcnt vmcnt(1)
v_mfma_f32_32x32x16_bf16 v[16:31], v[160:163], v[144:147], v[16:31]
v_mfma_f32_16x16x32_bf16 v[32:35], v[212:215], v[144:147], v[32:35]
s_waitcnt vmcnt(0)
v_mfma_f32_32x32x16_bf16 v[16:31], v[164:167], v[148:151], v[16:31]
v_mfma_f32_16x16x32_bf16 v[32:35], v[212:215], v[148:151], v[32:35]
s_add_u32 s75, s75, 1
s_sub_u32 s74, s74, 1
s_cselect_b32 s75, 9, s75
s_cmp_lt_u32 s75, 9
s_cbranch_scc1 sl_247
s_branch sback_158
far_159:
buffer_store_dwordx4 v[16:19], v9, s[20:23], s67 offen offset:0 sc1
buffer_store_dwordx4 v[20:23], v9, s[20:23], s67 offen offset:1024 sc1
s_branch near_160
far_161:
buffer_store_dwordx4 v[192:195], v9, s[20:23], s66 offen offset:0 sc1
buffer_store_dwordx4 v[196:199], v9, s[20:23], s66 offen offset:1024 sc1
s_branch near_162
far_165:
buffer_store_dword v212, v3, s[24:27], s70 offen sc1
s_branch near_166
mo_167:
s_lshr_b32 s67, s33, 5
s_cmp_eq_u32 s67, s66
s_cbranch_scc0 mo_168
s_and_b32 s67, s33, 31
v_sub_u32 v48, s67, v48
v_lshlrev_b32 v49, 4, v49
s_lshl_b32 s67, s62, 14
s_add_u32 s67, s67, 30686208
poll_248:
buffer_load_dwordx4 v[56:59], v49, s[20:23], s67 offen offset:0 sc1
buffer_load_dwordx4 v[60:63], v49, s[20:23], s67 offen offset:64 sc1
pchk_249:
s_waitcnt vmcnt(1)
v_min3_u32 v50, v56, v57, v58
s_waitcnt vmcnt(0)
v_min3_u32 v50, v50, v59, v60
v_min3_u32 v50, v50, v61, v62
v_min_u32 v50, v50, v63
v_cmp_eq_u32 vcc, 0, v50
s_cbranch_vccz pdone_250
s_sub_u32 s32, s32, 1
s_cmp_gt_i32 s32, 0
s_cbranch_scc1 poll_248
pdone_250:
v_cmp_eq_u32 vcc, 0, v48
s_nop 1
v_cndmask_b32 v240, v240, v56, vcc
v_cndmask_b32 v241, v241, v57, vcc
v_cndmask_b32 v242, v242, v58, vcc
v_cndmask_b32 v243, v243, v59, vcc
v_cndmask_b32 v244, v244, v60, vcc
v_cndmask_b32 v245, v245, v61, vcc
v_cndmask_b32 v246, v246, v62, vcc
v_cndmask_b32 v247, v247, v63, vcc
v_cmp_eq_u32 vcc, 16, v48
s_nop 1
v_cndmask_b32 v248, v248, v56, vcc
v_cndmask_b32 v249, v249, v57, vcc
v_cndmask_b32 v250, v250, v58, vcc
v_cndmask_b32 v251, v251, v59, vcc
v_cndmask_b32 v252, v252, v60, vcc
v_cndmask_b32 v253, v253, v61, vcc
v_cndmask_b32 v254, v254, v62, vcc
v_cndmask_b32 v255, v255, v63, vcc
s_branch mo_168
far_171:
buffer_store_dwordx4 v[240:243], v6, s[20:23], s68 offen offset:0 sc1
buffer_store_dwordx4 v[244:247], v6, s[20:23], s68 offen offset:1024 sc1
buffer_store_dwordx4 v[248:251], v6, s[20:23], s68 offen offset:2048 sc1
buffer_store_dwordx4 v[252:255], v6, s[20:23], s68 offen offset:3072 sc1
s_branch near_172
far_173:
buffer_store_dwordx4 v[8:11], v6, s[24:27], s67 offen sc1
s_branch near_174
far_175:
buffer_store_dword v212, v3, s[24:27], s66 offen sc1
s_branch near_176
mu_183:
v_pk_fma_f32 v[64:65], v[32:33], v[82:83], v[82:83] op_sel:[0,0,1] op_sel_hi:[1,0,1]
v_pk_fma_f32 v[66:67], v[34:35], v[82:83], v[82:83] op_sel:[0,0,1] op_sel_hi:[1,0,1]
v_pk_fma_f32 v[68:69], v[36:37], v[82:83], v[82:83] op_sel:[0,0,1] op_sel_hi:[1,0,1]
v_pk_fma_f32 v[70:71], v[38:39], v[82:83], v[82:83] op_sel:[0,0,1] op_sel_hi:[1,0,1]
v_pk_fma_f32 v[72:73], v[40:41], v[82:83], v[82:83] op_sel:[0,0,1] op_sel_hi:[1,0,1]
v_pk_fma_f32 v[74:75], v[42:43], v[82:83], v[82:83] op_sel:[0,0,1] op_sel_hi:[1,0,1]
v_pk_fma_f32 v[76:77], v[44:45], v[82:83], v[82:83] op_sel:[0,0,1] op_sel_hi:[1,0,1]
v_pk_fma_f32 v[78:79], v[46:47], v[82:83], v[82:83] op_sel:[0,0,1] op_sel_hi:[1,0,1]
v_cvt_pk_bf16_f32 v92, v64, v65
v_cvt_pk_bf16_f32 v93, v66, v67
v_cvt_pk_bf16_f32 v94, v68, v69
v_cvt_pk_bf16_f32 v95, v70, v71
v_cvt_pk_bf16_f32 v96, v72, v73
v_cvt_pk_bf16_f32 v97, v74, v75
v_cvt_pk_bf16_f32 v98, v76, v77
v_cvt_pk_bf16_f32 v99, v78, v79
ds_read_b32 v11, v7 offset:256
v_max_u32 v92, 1, v92
v_max_u32 v93, 1, v93
v_max_u32 v94, 1, v94
v_max_u32 v95, 1, v95
v_max_u32 v96, 1, v96
v_max_u32 v97, 1, v97
v_max_u32 v98, 1, v98
v_max_u32 v99, 1, v99
s_branch pchk_252
poll_251:
ds_read_b32 v11, v7 offset:256
pchk_252:
s_waitcnt lgkmcnt(0)
v_cmp_eq_u32 vcc, 0, v11
s_cbranch_vccz pdone_253
s_sub_u32 s32, s32, 1
s_cmp_gt_i32 s32, 0
s_cbranch_scc1 poll_251
pdone_253:
v_cmp_eq_f32 vcc, v11, v6
s_bfm_b32 s67, s58, 0
s_and_b32 s67, s67, vcc_lo
v_cmp_gt_f32 vcc, v11, v6
s_lshl_b32 s66, 1, s66
s_or_b32 s67, s67, vcc_lo
s_cselect_b64 s[76:77], 0, s[76:77]
s_cselect_b64 s[78:79], 0, s[78:79]
s_cselect_b64 exec, 0, s[66:67]
s_bitcmp0_b32 s62, 0
s_cselect_b64 exec, exec, 0
buffer_store_dwordx2 v[12:13], off, s[24:27], s72 sc1
s_mov_b64 exec, s[78:79]
buffer_store_dwordx4 v[92:95], v4, s[24:27], s68 offen offset:0 sc1
buffer_store_dwordx4 v[96:99], v4, s[24:27], s68 offen offset:16 sc1
s_mov_b64 exec, -1
v_add_u32 v5, s34, 24
s_mov_b64 exec, 1
ds_write_b32 v3, v5
s_mov_b64 exec, -1
v_pk_fma_f32 v[48:49], v[16:17], v[80:81], v[80:81] op_sel:[0,0,1] op_sel_hi:[1,0,1]
v_pk_fma_f32 v[50:51], v[18:19], v[80:81], v[80:81] op_sel:[0,0,1] op_sel_hi:[1,0,1]
v_pk_fma_f32 v[52:53], v[20:21], v[80:81], v[80:81] op_sel:[0,0,1] op_sel_hi:[1,0,1]
v_pk_fma_f32 v[54:55], v[22:23], v[80:81], v[80:81] op_sel:[0,0,1] op_sel_hi:[1,0,1]
v_pk_fma_f32 v[56:57], v[24:25], v[80:81], v[80:81] op_sel:[0,0,1] op_sel_hi:[1,0,1]
v_pk_fma_f32 v[58:59], v[26:27], v[80:81], v[80:81] op_sel:[0,0,1] op_sel_hi:[1,0,1]
v_pk_fma_f32 v[60:61], v[28:29], v[80:81], v[80:81] op_sel:[0,0,1] op_sel_hi:[1,0,1]
v_pk_fma_f32 v[62:63], v[30:31], v[80:81], v[80:81] op_sel:[0,0,1] op_sel_hi:[1,0,1]
v_pk_add_f32 v[16:17], v[16:17], v[48:49]
v_pk_add_f32 v[18:19], v[18:19], v[50:51]
v_pk_add_f32 v[20:21], v[20:21], v[52:53]
v_pk_add_f32 v[22:23], v[22:23], v[54:55]
v_pk_add_f32 v[24:25], v[24:25], v[56:57]
v_pk_add_f32 v[26:27], v[26:27], v[58:59]
v_pk_add_f32 v[28:29], v[28:29], v[60:61]
v_pk_add_f32 v[30:31], v[30:31], v[62:63]
v_pk_add_f32 v[32:33], v[32:33], v[64:65]
v_pk_add_f32 v[34:35], v[34:35], v[66:67]
v_pk_add_f32 v[36:37], v[36:37], v[68:69]
v_pk_add_f32 v[38:39], v[38:39], v[70:71]
v_pk_add_f32 v[40:41], v[40:41], v[72:73]
v_pk_add_f32 v[42:43], v[42:43], v[74:75]
v_pk_add_f32 v[44:45], v[44:45], v[76:77]
v_pk_add_f32 v[46:47], v[46:47], v[78:79]
v_cvt_pk_bf16_f32 v240, v16, v17
v_cvt_pk_bf16_f32 v241, v18, v19
v_cvt_pk_bf16_f32 v242, v20, v21
v_cvt_pk_bf16_f32 v243, v22, v23
v_cvt_pk_bf16_f32 v244, v24, v25
v_cvt_pk_bf16_f32 v245, v26, v27
v_cvt_pk_bf16_f32 v246, v28, v29
v_cvt_pk_bf16_f32 v247, v30, v31
v_cvt_pk_bf16_f32 v248, v32, v33
v_cvt_pk_bf16_f32 v249, v34, v35
v_cvt_pk_bf16_f32 v250, v36, v37
v_cvt_pk_bf16_f32 v251, v38, v39
v_cvt_pk_bf16_f32 v252, v40, v41
v_cvt_pk_bf16_f32 v253, v42, v43
v_cvt_pk_bf16_f32 v254, v44, v45
v_cvt_pk_bf16_f32 v255, v46, v47
v_max_u32 v32, 1, v32
v_max_u32 v33, 1, v33
v_max_u32 v34, 1, v34
v_max_u32 v35, 1, v35
v_max_u32 v36, 1, v36
v_max_u32 v37, 1, v37
v_max_u32 v38, 1, v38
v_max_u32 v39, 1, v39
v_max_u32 v40, 1, v40
v_max_u32 v41, 1, v41
v_max_u32 v42, 1, v42
v_max_u32 v43, 1, v43
v_max_u32 v44, 1, v44
v_max_u32 v45, 1, v45
v_max_u32 v46, 1, v46
v_max_u32 v47, 1, v47
s_mov_b64 exec, s[78:79]
buffer_store_dwordx4 v[32:35], v15, s[24:27], s69 offen offset:0 sc1
buffer_store_dwordx4 v[36:39], v15, s[24:27], s69 offen offset:64 sc1
buffer_store_dwordx4 v[40:43], v15, s[24:27], s69 offen offset:128 sc1
buffer_store_dwordx4 v[44:47], v15, s[24:27], s69 offen offset:192 sc1
s_mov_b64 exec, -1
s_branch mu_184
far_189:
buffer_store_dwordx2 v[10:11], v12, s[24:27], s66 offen sc1
s_branch near_190
L_end:
L_fin:
s_endpgm
.section .rodata,"a"
.p2align 6
.amdhsa_kernel interleave_layers__sliding_block__moe_arch_mod__prompt_kernel
  .amdhsa_next_free_vgpr 256
  .amdhsa_next_free_sgpr 102
  .amdhsa_accum_offset 256
  .amdhsa_group_segment_fixed_size 0
  .amdhsa_kernarg_size 88
  .amdhsa_user_sgpr_count 2
  .amdhsa_user_sgpr_kernarg_segment_ptr 1
  .amdhsa_system_sgpr_workgroup_id_x 1
  .amdhsa_float_denorm_mode_32 3
.end_amdhsa_kernel
```

```asm
; @launch grid=(256,1,1) block=(512,1,1) lds=163840
.amdgcn_target "amdgcn-amd-amdhsa--gfx950"
.text
.globl interleave_layers__sliding_block__moe_arch_mod__prompt_kernel
.p2align 8
.type interleave_layers__sliding_block__moe_arch_mod__prompt_kernel,@function
interleave_layers__sliding_block__moe_arch_mod__prompt_kernel:
s_cmp_ge_u32 s2, 256
s_cbranch_scc1 L_fin
s_load_dwordx16 s[36:51], s[0:1], 0
s_load_dwordx4 s[52:55], s[0:1], 64
s_load_dwordx2 s[56:57], s[0:1], 80
v_lshrrev_b32 v1, 6, v0
v_and_b32 v0, 63, v0
s_and_b32 s64, s2, 7
v_readfirstlane_b32 s3, v1
s_lshr_b32 s65, s2, 3
s_and_b32 s66, s65, 7
s_and_b32 s67, s64, 1
s_lshl3_add_u32 s59, s67, s66
s_lshr_b32 s66, s65, 3
s_lshr_b32 s67, s64, 1
s_lshl2_add_u32 s60, s67, s66
s_and_b32 s66, s65, 1
s_lshl1_add_u32 s61, s64, s66
s_lshr_b32 s62, s65, 1
s_mov_b32 s59, s61
s_xor_b32 s60, s62, 0
s_mov_b32 s63, 0
s_mov_b32 s34, 0
s_mov_b32 s32, 200000
s_mov_b32 s33, -1
s_cmp_ge_u32 s3, 4
s_cselect_b32 s66, 3, 1
s_and_b32 s58, s3, s66
s_waitcnt lgkmcnt(0)
s_mov_b32 s8, s36
s_mov_b32 s9, s37
s_mov_b32 s10, 0x400000
s_mov_b32 s11, 0x00020000
s_mov_b32 s12, s38
s_mov_b32 s13, s39
s_mov_b32 s14, 0x600000
s_mov_b32 s15, 0x00020000
s_mov_b32 s16, s40
s_mov_b32 s17, s41
s_mov_b32 s18, 0x200000
s_mov_b32 s19, 0x00020000
s_mov_b32 s20, s56
s_mov_b32 s21, s57
s_mov_b32 s22, 0x2500000
s_mov_b32 s23, 0x00020000
s_add_u32 s24, s56, 30408704
s_addc_u32 s25, s57, 0
s_mov_b32 s26, 2818048
s_mov_b32 s27, 0x00020000
s_mov_b32 s28, s52
s_mov_b32 s29, s53
s_mov_b32 s30, 0x400000
s_mov_b32 s31, 0x00020000
s_cmp_ge_u32 s3, 4
s_cbranch_scc1 L_m
s_cmp_ge_u32 s3, 2
s_cbranch_scc1 L_f
s_setprio 1
v_and_b32 v22, 7, v0
v_lshrrev_b32 v23, 4, v0
v_lshrrev_b32 v6, 3, v0
v_xor_b32 v7, v22, v23
v_lshlrev_b32 v7, 4, v7
v_lshl_add_u32 v8, v6, 11, v7
v_xor_b32 v7, 64, v8
v_add_u32 v9, 15360, v7
v_add_u32 v10, 30720, v8
v_add_u32 v11, 46080, v7
s_lshl_b32 s70, s59, 18
s_lshl_b32 s71, s58, 16
s_add_u32 s68, s70, s71
s_sub_u32 s69, s70, s71
s_add_u32 s69, s69, 196608
s_mov_b32 s67, 128
s_lshl_b32 s75, s58, 13
s_mov_b32 s65, 86016
s_and_b32 s79, s59, 1
s_mul_i32 s70, s60, 1
s_and_b32 s71, s59, 14
s_add_u32 s70, s70, s71
s_and_b32 s70, s70, 15
s_xor_b32 s64, s70, s79
s_mul_i32 s70, s64, s67
s_add_u32 m0, s65, s75
s_add_u32 s71, s70, s68
buffer_load_dwordx4 v8, s[8:11], s71 offen offset:0 lds
buffer_load_dwordx4 v9, s[8:11], s71 offen offset:1024 lds
buffer_load_dwordx4 v10, s[8:11], s71 offen offset:2048 lds
buffer_load_dwordx4 v11, s[8:11], s71 offen offset:3072 lds
s_add_u32 m0, m0, 4096
s_add_u32 s71, s70, s69
buffer_load_dwordx4 v8, s[8:11], s71 offen offset:0 lds
buffer_load_dwordx4 v9, s[8:11], s71 offen offset:1024 lds
buffer_load_dwordx4 v10, s[8:11], s71 offen offset:2048 lds
buffer_load_dwordx4 v11, s[8:11], s71 offen offset:3072 lds
v_and_b32 v7, 2, v6
v_xor_b32 v7, v7, v22
v_mul_u32_u24 v6, 6144, v6
v_lshl_add_u32 v12, v7, 4, v6
v_xor_b32 v6, 64, v12
v_add_u32 v13, 48128, v6
v_add_u32 v14, 96256, v12
v_add_u32 v15, 144384, v6
s_mul_i32 s76, s58, 12288
s_add_u32 s76, s76, 16384
s_lshl_b32 s70, s60, 7
s_cmp_eq_u32 s58, 0
s_mov_b32 s71, 198656
s_cselect_b32 s72, 0, s71
s_mov_b32 s71, 4096
s_cselect_b32 s73, 196608, s71
s_mov_b32 s71, 200704
s_cselect_b32 s74, 2048, s71
s_add_u32 s72, s72, s70
s_add_u32 s73, s73, s70
s_add_u32 s74, s74, s70
s_mul_i32 s70, s64, 393216
s_add_u32 m0, s65, s76
s_add_u32 s71, s70, s72
buffer_load_dwordx4 v12, s[12:15], s71 offen offset:0 lds
buffer_load_dwordx4 v13, s[12:15], s71 offen offset:1024 lds
buffer_load_dwordx4 v14, s[12:15], s71 offen offset:2048 lds
buffer_load_dwordx4 v15, s[12:15], s71 offen offset:3072 lds
s_add_u32 m0, m0, 4096
s_add_u32 s71, s70, s73
buffer_load_dwordx4 v12, s[12:15], s71 offen offset:0 lds
buffer_load_dwordx4 v13, s[12:15], s71 offen offset:1024 lds
buffer_load_dwordx4 v14, s[12:15], s71 offen offset:2048 lds
buffer_load_dwordx4 v15, s[12:15], s71 offen offset:3072 lds
s_add_u32 m0, m0, 4096
s_add_u32 s71, s70, s74
buffer_load_dwordx4 v12, s[12:15], s71 offen offset:0 lds
buffer_load_dwordx4 v13, s[12:15], s71 offen offset:1024 lds
buffer_load_dwordx4 v14, s[12:15], s71 offen offset:2048 lds
buffer_load_dwordx4 v15, s[12:15], s71 offen offset:3072 lds
s_xor_b32 s64, s64, s79
s_add_u32 s64, s64, 1
s_and_b32 s64, s64, 15
s_xor_b32 s64, s64, s79
s_sub_u32 s65, s65, 40960
s_cselect_b32 s65, 86016, s65
v_and_b32 v1, 3, v0
v_lshlrev_b32 v1, 2, v1
v_and_b32 v2, 4, v1
s_lshl2_add_u32 s35, s58, 16
v_mov_b32 v3, s35
v_lshlrev_b32 v20, 4, v0
v_lshrrev_b32 v6, 2, v0
v_lshl_add_u32 v21, v6, 7, v1
v_lshrrev_b32 v6, 3, v0
v_lshlrev_b32 v23, 1, v23
v_xor_b32 v23, v23, v22
v_lshlrev_b32 v23, 4, v23
v_lshl_add_u32 v23, v6, 11, v23
s_lshl_b32 s70, s62, 7
s_lshl_b32 s71, s58, 16
s_add_u32 s70, s70, s71
v_add_u32 v16, s70, v23
v_add_u32 v17, 15360, v16
v_add_u32 v18, 30720, v16
v_add_u32 v19, 46080, v16
s_add_u32 s77, s61, s62
s_lshl_b32 s77, s77, 17
s_lshl_b32 s78, s58, 12
s_mov_b32 s66, -2
s_barrier
.p2align 4
lq_1:
s_add_u32 s35, s66, 1
lw_4:
ds_read_b32 v5, v1 offset:0
s_waitcnt lgkmcnt(0)
v_cmp_gt_i32 vcc, s35, v5
s_cbranch_vccz lwd_5
s_sub_u32 s32, s32, 1
s_cmp_gt_i32 s32, 0
s_cbranch_scc1 lw_4
lwd_5:
s_cmp_eq_u32 s66, 0
s_cbranch_scc1 lcs_2
lcb_3:
s_mul_i32 s70, s64, s67
s_add_u32 m0, s65, s75
s_add_u32 s71, s70, s68
buffer_load_dwordx4 v8, s[8:11], s71 offen offset:0 sc1 lds
buffer_load_dwordx4 v9, s[8:11], s71 offen offset:1024 sc1 lds
buffer_load_dwordx4 v10, s[8:11], s71 offen offset:2048 sc1 lds
buffer_load_dwordx4 v11, s[8:11], s71 offen offset:3072 sc1 lds
buffer_load_dword v30, off, s[12:15], 0
s_add_u32 m0, m0, 4096
s_add_u32 s71, s70, s69
buffer_load_dwordx4 v8, s[8:11], s71 offen offset:0 sc1 lds
buffer_load_dwordx4 v9, s[8:11], s71 offen offset:1024 sc1 lds
buffer_load_dwordx4 v10, s[8:11], s71 offen offset:2048 sc1 lds
buffer_load_dwordx4 v11, s[8:11], s71 offen offset:3072 sc1 lds
buffer_load_dword v30, off, s[12:15], 0
s_mul_i32 s70, s64, 393216
s_add_u32 m0, s65, s76
s_add_u32 s71, s70, s72
buffer_load_dwordx4 v12, s[12:15], s71 offen offset:0 lds
buffer_load_dwordx4 v13, s[12:15], s71 offen offset:1024 lds
buffer_load_dwordx4 v14, s[12:15], s71 offen offset:2048 lds
buffer_load_dwordx4 v15, s[12:15], s71 offen offset:3072 lds
buffer_load_dword v30, off, s[12:15], 0
v_add_u32 v5, s66, 3
s_mov_b64 exec, 1
s_waitcnt vmcnt(15)
ds_write_b32 v3, v5
s_mov_b64 exec, -1
s_mul_i32 s70, s64, 393216
s_add_u32 m0, m0, 4096
s_add_u32 s71, s70, s73
buffer_load_dwordx4 v12, s[12:15], s71 offen offset:0 lds
buffer_load_dwordx4 v13, s[12:15], s71 offen offset:1024 lds
buffer_load_dwordx4 v14, s[12:15], s71 offen offset:2048 lds
buffer_load_dwordx4 v15, s[12:15], s71 offen offset:3072 lds
buffer_load_dword v30, off, s[12:15], 0
s_mul_i32 s70, s64, 393216
s_add_u32 m0, m0, 4096
s_add_u32 s71, s70, s74
buffer_load_dwordx4 v12, s[12:15], s71 offen offset:0 lds
buffer_load_dwordx4 v13, s[12:15], s71 offen offset:1024 lds
buffer_load_dwordx4 v14, s[12:15], s71 offen offset:2048 lds
buffer_load_dwordx4 v15, s[12:15], s71 offen offset:3072 lds
buffer_load_dword v30, off, s[12:15], 0
s_xor_b32 s64, s64, s79
s_add_u32 s64, s64, 1
s_and_b32 s64, s64, 15
s_xor_b32 s64, s64, s79
s_sub_u32 s65, s65, 40960
s_cselect_b32 s65, 86016, s65
s_add_u32 s66, s66, 1
s_and_b32 s70, s66, 31
s_cmp_eq_u32 s70, 13
s_cbranch_scc0 lq_1
s_waitcnt vmcnt(0)
v_add_u32 v5, s34, 16
s_mov_b64 exec, 1
ds_write_b32 v3, v5
s_mov_b64 exec, -1
s_add_u32 s35, s34, 14
lw_6:
ds_read_b32 v5, v1 offset:0
s_waitcnt lgkmcnt(0)
v_cmp_gt_i32 vcc, s35, v5
s_cbranch_vccz lwd_7
s_sleep 1
s_sub_u32 s32, s32, 1
s_cmp_gt_i32 s32, 0
s_cbranch_scc1 lw_6
lwd_7:
s_add_u32 s70, s77, 262144
s_add_u32 m0, s78, 49152
s_and_b32 s70, s70, 0x1fffff
buffer_load_dwordx4 v16, s[16:19], s70 offen offset:0 lds
buffer_load_dwordx4 v17, s[16:19], s70 offen offset:1024 lds
buffer_load_dwordx4 v18, s[16:19], s70 offen offset:2048 lds
buffer_load_dwordx4 v19, s[16:19], s70 offen offset:3072 lds
buffer_load_dword v30, off, s[12:15], 0
s_add_u32 s70, s77, 393216
s_add_u32 m0, s78, 57344
s_and_b32 s70, s70, 0x1fffff
buffer_load_dwordx4 v16, s[16:19], s70 offen offset:0 lds
buffer_load_dwordx4 v17, s[16:19], s70 offen offset:1024 lds
buffer_load_dwordx4 v18, s[16:19], s70 offen offset:2048 lds
buffer_load_dwordx4 v19, s[16:19], s70 offen offset:3072 lds
buffer_load_dword v30, off, s[12:15], 0
s_add_u32 s70, s77, 524288
s_add_u32 m0, s78, 65536
s_and_b32 s70, s70, 0x1fffff
buffer_load_dwordx4 v16, s[16:19], s70 offen offset:0 lds
buffer_load_dwordx4 v17, s[16:19], s70 offen offset:1024 lds
buffer_load_dwordx4 v18, s[16:19], s70 offen offset:2048 lds
buffer_load_dwordx4 v19, s[16:19], s70 offen offset:3072 lds
buffer_load_dword v30, off, s[12:15], 0
s_add_u32 s70, s77, 655360
s_add_u32 m0, s78, 73728
s_and_b32 s70, s70, 0x1fffff
buffer_load_dwordx4 v16, s[16:19], s70 offen offset:0 lds
buffer_load_dwordx4 v17, s[16:19], s70 offen offset:1024 lds
buffer_load_dwordx4 v18, s[16:19], s70 offen offset:2048 lds
buffer_load_dwordx4 v19, s[16:19], s70 offen offset:3072 lds
buffer_load_dword v30, off, s[12:15], 0
s_sub_u32 s70, s59, s58
s_lshl_b32 s71, s70, 7
s_add_u32 s71, s71, s60
s_lshl4_add_u32 s70, s70, s60
s_sub_u32 s70, s70, 16
s_lshl_b32 s66, s71, 7
s_add_u32 s66, s66, 253952
s_lshl_b32 s70, s70, 15
s_lshl_b32 s71, s63, 23
s_add_u32 s70, s70, s71
s_add_u32 s64, s70, 1077248
s_mul_i32 s65, s58, -94208
s_add_u32 s35, s34, 16
lw_8:
ds_read_b32 v5, v1 offset:0
s_waitcnt lgkmcnt(0)
v_cmp_gt_i32 vcc, s35, v5
s_cbranch_vccz lwd_9
s_sleep 1
s_sub_u32 s32, s32, 1
s_cmp_gt_i32 s32, 0
s_cbranch_scc1 lw_8
lwd_9:
s_add_u32 s35, s34, 17
lw_11:
ds_read_b32 v5, v1 offset:0
s_waitcnt lgkmcnt(0)
v_cmp_gt_i32 vcc, s35, v5
s_cbranch_vccz lwd_12
s_sleep 1
s_sub_u32 s32, s32, 1
s_cmp_gt_i32 s32, 0
s_cbranch_scc1 lw_11
lwd_12:
s_cmp_gt_u32 s59, s58
s_cbranch_scc0 nokv_10
poll_13:
buffer_load_dword v6, v1, s[24:27], s66 offen sc1
pchk_14:
s_waitcnt vmcnt(0)
v_cmp_eq_u32 vcc, 0, v6
s_cbranch_vccz pdone_15
s_sub_u32 s32, s32, 1
s_cmp_gt_i32 s32, 0
s_cbranch_scc1 poll_13
pdone_15:
s_cmp_eq_u32 s58, 0
s_cbranch_scc1 kd_16
v_mov_b32 v7, 0
s_add_u32 s35, s34, 17
lw_17:
ds_read_b32 v5, v7 offset:16
s_waitcnt lgkmcnt(0)
v_cmp_gt_i32 vcc, s35, v5
s_cbranch_vccz lwd_18
s_sleep 1
s_sub_u32 s32, s32, 1
s_cmp_gt_i32 s32, 0
s_cbranch_scc1 lw_17
lwd_18:
kd_16:
s_add_u32 m0, s65, 126976
s_nop 0
buffer_load_dwordx4 v20, s[20:23], s64 offen offset:0 sc1 lds
buffer_load_dwordx4 v20, s[20:23], s64 offen offset:1024 sc1 lds
buffer_load_dwordx4 v20, s[20:23], s64 offen offset:2048 sc1 lds
buffer_load_dwordx4 v20, s[20:23], s64 offen offset:3072 sc1 lds
buffer_load_dword v30, off, s[12:15], 0
s_add_u32 m0, s65, 122880
s_sub_u32 s64, s64, 4096
buffer_load_dwordx4 v20, s[20:23], s64 offen offset:0 sc1 lds
buffer_load_dwordx4 v20, s[20:23], s64 offen offset:1024 sc1 lds
buffer_load_dwordx4 v20, s[20:23], s64 offen offset:2048 sc1 lds
buffer_load_dwordx4 v20, s[20:23], s64 offen offset:3072 sc1 lds
buffer_load_dword v30, off, s[12:15], 0
s_add_u32 m0, s65, 118784
s_sub_u32 s64, s64, 4096
buffer_load_dwordx4 v20, s[20:23], s64 offen offset:0 sc1 lds
buffer_load_dwordx4 v20, s[20:23], s64 offen offset:1024 sc1 lds
buffer_load_dwordx4 v20, s[20:23], s64 offen offset:2048 sc1 lds
buffer_load_dwordx4 v20, s[20:23], s64 offen offset:3072 sc1 lds
buffer_load_dword v30, off, s[12:15], 0
s_add_u32 m0, s65, 114688
s_sub_u32 s64, s64, 4096
buffer_load_dwordx4 v20, s[20:23], s64 offen offset:0 sc1 lds
buffer_load_dwordx4 v20, s[20:23], s64 offen offset:1024 sc1 lds
buffer_load_dwordx4 v20, s[20:23], s64 offen offset:2048 sc1 lds
buffer_load_dwordx4 v20, s[20:23], s64 offen offset:3072 sc1 lds
buffer_load_dword v30, off, s[12:15], 0
s_add_u32 m0, s65, 110592
s_sub_u32 s64, s64, 4096
buffer_load_dwordx4 v20, s[20:23], s64 offen offset:0 sc1 lds
buffer_load_dwordx4 v20, s[20:23], s64 offen offset:1024 sc1 lds
buffer_load_dwordx4 v20, s[20:23], s64 offen offset:2048 sc1 lds
buffer_load_dwordx4 v20, s[20:23], s64 offen offset:3072 sc1 lds
buffer_load_dword v30, off, s[12:15], 0
s_add_u32 m0, s65, 106496
s_sub_u32 s64, s64, 4096
buffer_load_dwordx4 v20, s[20:23], s64 offen offset:0 sc1 lds
buffer_load_dwordx4 v20, s[20:23], s64 offen offset:1024 sc1 lds
buffer_load_dwordx4 v20, s[20:23], s64 offen offset:2048 sc1 lds
buffer_load_dwordx4 v20, s[20:23], s64 offen offset:3072 sc1 lds
buffer_load_dword v30, off, s[12:15], 0
s_add_u32 m0, s65, 102400
s_sub_u32 s64, s64, 4096
buffer_load_dwordx4 v20, s[20:23], s64 offen offset:0 sc1 lds
buffer_load_dwordx4 v20, s[20:23], s64 offen offset:1024 sc1 lds
buffer_load_dwordx4 v20, s[20:23], s64 offen offset:2048 sc1 lds
buffer_load_dwordx4 v20, s[20:23], s64 offen offset:3072 sc1 lds
buffer_load_dword v30, off, s[12:15], 0
s_add_u32 m0, s65, 98304
s_sub_u32 s64, s64, 4096
buffer_load_dwordx4 v20, s[20:23], s64 offen offset:0 sc1 lds
buffer_load_dwordx4 v20, s[20:23], s64 offen offset:1024 sc1 lds
buffer_load_dwordx4 v20, s[20:23], s64 offen offset:2048 sc1 lds
buffer_load_dwordx4 v20, s[20:23], s64 offen offset:3072 sc1 lds
buffer_load_dword v30, off, s[12:15], 0
v_add_u32 v5, s34, 17
s_mov_b64 exec, 1
ds_write_b32 v3, v5
s_mov_b64 exec, -1
s_waitcnt vmcnt(30)
v_add_u32 v5, s34, 18
s_mov_b64 exec, 1
ds_write_b32 v3, v5
s_mov_b64 exec, -1
nokv_10:
s_lshl_b32 s66, s61, 14
s_add_u32 s66, s66, 268288
s_waitcnt vmcnt(0)
v_add_u32 v5, s34, 21
s_mov_b64 exec, 1
ds_write_b32 v3, v5
s_mov_b64 exec, -1
s_add_u32 s70, s77, 131072
s_add_u32 m0, s78, 40960
s_and_b32 s70, s70, 0x1fffff
buffer_load_dwordx4 v16, s[16:19], s70 offen offset:0 lds
buffer_load_dwordx4 v17, s[16:19], s70 offen offset:1024 lds
buffer_load_dwordx4 v18, s[16:19], s70 offen offset:2048 lds
buffer_load_dwordx4 v19, s[16:19], s70 offen offset:3072 lds
buffer_load_dword v30, off, s[12:15], 0
s_add_u32 s70, s77, 786432
s_add_u32 m0, s78, 81920
s_and_b32 s70, s70, 0x1fffff
buffer_load_dwordx4 v16, s[16:19], s70 offen offset:0 lds
buffer_load_dwordx4 v17, s[16:19], s70 offen offset:1024 lds
buffer_load_dwordx4 v18, s[16:19], s70 offen offset:2048 lds
buffer_load_dwordx4 v19, s[16:19], s70 offen offset:3072 lds
buffer_load_dword v30, off, s[12:15], 0
s_add_u32 s70, s77, 917504
s_add_u32 m0, s78, 90112
s_and_b32 s70, s70, 0x1fffff
buffer_load_dwordx4 v16, s[16:19], s70 offen offset:0 lds
buffer_load_dwordx4 v17, s[16:19], s70 offen offset:1024 lds
buffer_load_dwordx4 v18, s[16:19], s70 offen offset:2048 lds
buffer_load_dwordx4 v19, s[16:19], s70 offen offset:3072 lds
buffer_load_dword v30, off, s[12:15], 0
s_add_u32 s35, s34, 18
lw_20:
ds_read_b32 v5, v1 offset:0
s_waitcnt lgkmcnt(0)
v_cmp_gt_i32 vcc, s35, v5
s_cbranch_vccz lwd_21
s_sleep 1
s_sub_u32 s32, s32, 1
s_cmp_gt_i32 s32, 0
s_cbranch_scc1 lw_20
lwd_21:
s_add_u32 s70, s77, 1572864
s_add_u32 m0, s78, 131072
s_and_b32 s70, s70, 0x1fffff
buffer_load_dwordx4 v16, s[16:19], s70 offen offset:0 lds
buffer_load_dwordx4 v17, s[16:19], s70 offen offset:1024 lds
buffer_load_dwordx4 v18, s[16:19], s70 offen offset:2048 lds
buffer_load_dwordx4 v19, s[16:19], s70 offen offset:3072 lds
buffer_load_dword v30, off, s[12:15], 0
s_add_u32 s70, s77, 1703936
s_add_u32 m0, s78, 139264
s_and_b32 s70, s70, 0x1fffff
buffer_load_dwordx4 v16, s[16:19], s70 offen offset:0 lds
buffer_load_dwordx4 v17, s[16:19], s70 offen offset:1024 lds
buffer_load_dwordx4 v18, s[16:19], s70 offen offset:2048 lds
buffer_load_dwordx4 v19, s[16:19], s70 offen offset:3072 lds
buffer_load_dword v30, off, s[12:15], 0
s_add_u32 s70, s77, 1835008
s_add_u32 m0, s78, 147456
s_and_b32 s70, s70, 0x1fffff
buffer_load_dwordx4 v16, s[16:19], s70 offen offset:0 lds
buffer_load_dwordx4 v17, s[16:19], s70 offen offset:1024 lds
buffer_load_dwordx4 v18, s[16:19], s70 offen offset:2048 lds
buffer_load_dwordx4 v19, s[16:19], s70 offen offset:3072 lds
buffer_load_dword v30, off, s[12:15], 0
s_add_u32 s70, s77, 1966080
s_add_u32 m0, s78, 155648
s_and_b32 s70, s70, 0x1fffff
buffer_load_dwordx4 v16, s[16:19], s70 offen offset:0 lds
buffer_load_dwordx4 v17, s[16:19], s70 offen offset:1024 lds
buffer_load_dwordx4 v18, s[16:19], s70 offen offset:2048 lds
buffer_load_dwordx4 v19, s[16:19], s70 offen offset:3072 lds
buffer_load_dword v30, off, s[12:15], 0
s_add_u32 s35, s34, 19
lw_22:
ds_read_b32 v5, v1 offset:0
s_waitcnt lgkmcnt(0)
v_cmp_gt_i32 vcc, s35, v5
s_cbranch_vccz lwd_23
s_sleep 2
s_sub_u32 s32, s32, 1
s_cmp_gt_i32 s32, 0
s_cbranch_scc1 lw_22
lwd_23:
s_add_u32 s70, s77, 1048576
s_add_u32 m0, s78, 98304
s_and_b32 s70, s70, 0x1fffff
buffer_load_dwordx4 v16, s[16:19], s70 offen offset:0 lds
buffer_load_dwordx4 v17, s[16:19], s70 offen offset:1024 lds
buffer_load_dwordx4 v18, s[16:19], s70 offen offset:2048 lds
buffer_load_dwordx4 v19, s[16:19], s70 offen offset:3072 lds
buffer_load_dword v30, off, s[12:15], 0
s_add_u32 s70, s77, 1179648
s_add_u32 m0, s78, 106496
s_and_b32 s70, s70, 0x1fffff
buffer_load_dwordx4 v16, s[16:19], s70 offen offset:0 lds
buffer_load_dwordx4 v17, s[16:19], s70 offen offset:1024 lds
buffer_load_dwordx4 v18, s[16:19], s70 offen offset:2048 lds
buffer_load_dwordx4 v19, s[16:19], s70 offen offset:3072 lds
buffer_load_dword v30, off, s[12:15], 0
s_add_u32 s70, s77, 1310720
s_add_u32 m0, s78, 114688
s_and_b32 s70, s70, 0x1fffff
buffer_load_dwordx4 v16, s[16:19], s70 offen offset:0 lds
buffer_load_dwordx4 v17, s[16:19], s70 offen offset:1024 lds
buffer_load_dwordx4 v18, s[16:19], s70 offen offset:2048 lds
buffer_load_dwordx4 v19, s[16:19], s70 offen offset:3072 lds
buffer_load_dword v30, off, s[12:15], 0
s_add_u32 s70, s77, 1441792
s_add_u32 m0, s78, 122880
s_and_b32 s70, s70, 0x1fffff
buffer_load_dwordx4 v16, s[16:19], s70 offen offset:0 lds
buffer_load_dwordx4 v17, s[16:19], s70 offen offset:1024 lds
buffer_load_dwordx4 v18, s[16:19], s70 offen offset:2048 lds
buffer_load_dwordx4 v19, s[16:19], s70 offen offset:3072 lds
buffer_load_dword v30, off, s[12:15], 0
s_add_u32 s35, s34, 20
lw_24:
ds_read_b32 v5, v1 offset:0
s_waitcnt lgkmcnt(0)
v_cmp_gt_i32 vcc, s35, v5
s_cbranch_vccz lwd_25
s_sleep 2
s_sub_u32 s32, s32, 1
s_cmp_gt_i32 s32, 0
s_cbranch_scc1 lw_24
lwd_25:
s_add_u32 s70, s77, 0
s_add_u32 m0, s78, 32768
s_and_b32 s70, s70, 0x1fffff
buffer_load_dwordx4 v16, s[16:19], s70 offen offset:0 lds
buffer_load_dwordx4 v17, s[16:19], s70 offen offset:1024 lds
buffer_load_dwordx4 v18, s[16:19], s70 offen offset:2048 lds
buffer_load_dwordx4 v19, s[16:19], s70 offen offset:3072 lds
buffer_load_dword v30, off, s[12:15], 0
s_cmp_eq_u32 s58, 0
s_cbranch_scc0 nofo_19
s_add_u32 s35, s34, 21
lw_26:
ds_read_b32 v5, v1 offset:0
s_waitcnt lgkmcnt(0)
v_cmp_gt_i32 vcc, s35, v5
s_cbranch_vccz lwd_27
s_sleep 1
s_sub_u32 s32, s32, 1
s_cmp_gt_i32 s32, 0
s_cbranch_scc1 lw_26
lwd_27:
poll_28:
buffer_load_dword v6, v21, s[24:27], s66 offen sc1
pchk_29:
s_waitcnt vmcnt(0)
v_cmp_eq_u32 vcc, 0, v6
s_mov_b64 exec, vcc
s_cbranch_vccz pdone_30
s_sleep 1
s_sub_u32 s32, s32, 1
s_cmp_gt_i32 s32, 0
s_cbranch_scc1 poll_28
pdone_30:
s_mov_b64 exec, -1
nofo_19:
s_waitcnt vmcnt(0)
v_add_u32 v5, s34, 22
s_mov_b64 exec, 1
ds_write_b32 v3, v5
s_mov_b64 exec, -1
s_cmp_eq_u32 s63, 0
s_cbranch_scc0 L_end
v_bfe_u32 v6, v0, 3, 2
v_and_b32 v7, 2, v6
v_xor_b32 v7, v7, v22
v_lshrrev_b32 v23, 5, v0
v_lshl_add_u32 v6, v23, 4, v6
v_mul_u32_u24 v6, 6144, v6
v_lshl_add_u32 v12, v7, 4, v6
v_xor_b32 v6, 64, v12
v_add_u32 v13, 23552, v6
v_add_u32 v14, 47104, v12
v_add_u32 v15, 70656, v6
v_mov_b32 v8, v20
v_mov_b32 v9, v20
v_mov_b32 v10, v20
v_mov_b32 v11, v20
s_mov_b32 s8, s56
s_mov_b32 s9, s57
s_mov_b32 s10, 0x2500000
s_mov_b32 s11, 0x00020000
s_lshl_b32 s70, s59, 18
s_add_u32 s70, s70, 26214400
s_add_u32 s68, s70, s78
s_sub_u32 s69, s70, s78
s_add_u32 s69, s69, 12288
s_mov_b32 s67, 16384
s_lshl_b32 s66, s59, 14
s_add_u32 s66, s66, 274432
s_and_b32 s79, s59, 1
s_mul_i32 s79, s79, 1
s_mul_i32 s70, s60, 1
s_and_b32 s71, s59, 14
s_add_u32 s70, s70, s71
s_and_b32 s70, s70, 15
s_xor_b32 s64, s70, s79
s_mov_b32 s65, 86016
s_add_u32 s35, s34, 22
lw_31:
ds_read_b32 v5, v1 offset:0
s_waitcnt lgkmcnt(0)
v_cmp_gt_i32 vcc, s35, v5
s_cbranch_vccz lwd_32
s_sleep 2
s_sub_u32 s32, s32, 1
s_cmp_gt_i32 s32, 0
s_cbranch_scc1 lw_31
lwd_32:
s_mul_i32 s70, s64, 393216
s_add_u32 m0, s65, s76
s_add_u32 s71, s70, s72
buffer_load_dwordx4 v12, s[12:15], s71 offen offset:0 lds
buffer_load_dwordx4 v13, s[12:15], s71 offen offset:1024 lds
buffer_load_dwordx4 v14, s[12:15], s71 offen offset:2048 lds
buffer_load_dwordx4 v15, s[12:15], s71 offen offset:3072 lds
buffer_load_dword v30, off, s[12:15], 0
s_add_u32 m0, m0, 4096
s_add_u32 s71, s70, s73
buffer_load_dwordx4 v12, s[12:15], s71 offen offset:0 lds
buffer_load_dwordx4 v13, s[12:15], s71 offen offset:1024 lds
buffer_load_dwordx4 v14, s[12:15], s71 offen offset:2048 lds
buffer_load_dwordx4 v15, s[12:15], s71 offen offset:3072 lds
buffer_load_dword v30, off, s[12:15], 0
s_add_u32 m0, m0, 4096
s_add_u32 s71, s70, s74
buffer_load_dwordx4 v12, s[12:15], s71 offen offset:0 lds
buffer_load_dwordx4 v13, s[12:15], s71 offen offset:1024 lds
buffer_load_dwordx4 v14, s[12:15], s71 offen offset:2048 lds
buffer_load_dwordx4 v15, s[12:15], s71 offen offset:3072 lds
buffer_load_dword v30, off, s[12:15], 0
s_xor_b32 s64, s64, s79
s_add_u32 s64, s64, 1
s_and_b32 s64, s64, 15
s_xor_b32 s64, s64, s79
s_sub_u32 s65, s65, 40960
s_cselect_b32 s65, 86016, s65
s_add_u32 s35, s34, 23
lw_33:
ds_read_b32 v5, v1 offset:0
s_waitcnt lgkmcnt(0)
v_cmp_gt_i32 vcc, s35, v5
s_cbranch_vccz lwd_34
s_sleep 1
s_sub_u32 s32, s32, 1
s_cmp_gt_i32 s32, 0
s_cbranch_scc1 lw_33
lwd_34:
s_mul_i32 s70, s64, 393216
s_add_u32 m0, s65, s76
s_add_u32 s71, s70, s72
buffer_load_dwordx4 v12, s[12:15], s71 offen offset:0 lds
buffer_load_dwordx4 v13, s[12:15], s71 offen offset:1024 lds
buffer_load_dwordx4 v14, s[12:15], s71 offen offset:2048 lds
buffer_load_dwordx4 v15, s[12:15], s71 offen offset:3072 lds
buffer_load_dword v30, off, s[12:15], 0
s_add_u32 m0, m0, 4096
s_add_u32 s71, s70, s73
buffer_load_dwordx4 v12, s[12:15], s71 offen offset:0 lds
buffer_load_dwordx4 v13, s[12:15], s71 offen offset:1024 lds
buffer_load_dwordx4 v14, s[12:15], s71 offen offset:2048 lds
buffer_load_dwordx4 v15, s[12:15], s71 offen offset:3072 lds
buffer_load_dword v30, off, s[12:15], 0
s_add_u32 m0, m0, 4096
s_add_u32 s71, s70, s74
buffer_load_dwordx4 v12, s[12:15], s71 offen offset:0 lds
buffer_load_dwordx4 v13, s[12:15], s71 offen offset:1024 lds
buffer_load_dwordx4 v14, s[12:15], s71 offen offset:2048 lds
buffer_load_dwordx4 v15, s[12:15], s71 offen offset:3072 lds
buffer_load_dword v30, off, s[12:15], 0
s_and_b32 s79, s59, 1
s_mul_i32 s79, s79, 1
s_mul_i32 s70, s60, 1
s_and_b32 s71, s59, 14
s_add_u32 s70, s70, s71
s_and_b32 s70, s70, 15
s_xor_b32 s64, s70, s79
s_mov_b32 s65, 86016
poll_35:
buffer_load_dword v6, v21, s[24:27], s66 offen sc1
pchk_36:
s_waitcnt vmcnt(0)
v_cmp_eq_u32 vcc, 0, v6
s_mov_b64 exec, vcc
s_cbranch_vccz pdone_37
s_sleep 1
s_sub_u32 s32, s32, 1
s_cmp_gt_i32 s32, 0
s_cbranch_scc1 poll_35
pdone_37:
s_mov_b64 exec, -1
s_mul_i32 s70, s64, s67
s_add_u32 m0, s65, s75
s_add_u32 s71, s70, s68
buffer_load_dwordx4 v8, s[8:11], s71 offen offset:0 sc1 lds
buffer_load_dwordx4 v9, s[8:11], s71 offen offset:1024 sc1 lds
buffer_load_dwordx4 v10, s[8:11], s71 offen offset:2048 sc1 lds
buffer_load_dwordx4 v11, s[8:11], s71 offen offset:3072 sc1 lds
buffer_load_dword v30, off, s[12:15], 0
s_add_u32 m0, m0, 4096
s_add_u32 s71, s70, s69
buffer_load_dwordx4 v8, s[8:11], s71 offen offset:0 sc1 lds
buffer_load_dwordx4 v9, s[8:11], s71 offen offset:1024 sc1 lds
buffer_load_dwordx4 v10, s[8:11], s71 offen offset:2048 sc1 lds
buffer_load_dwordx4 v11, s[8:11], s71 offen offset:3072 sc1 lds
buffer_load_dword v30, off, s[12:15], 0
s_xor_b32 s64, s64, s79
s_add_u32 s64, s64, 1
s_and_b32 s64, s64, 15
s_xor_b32 s64, s64, s79
s_sub_u32 s65, s65, 40960
s_cselect_b32 s65, 86016, s65
s_mul_i32 s70, s64, s67
s_add_u32 m0, s65, s75
s_add_u32 s71, s70, s68
buffer_load_dwordx4 v8, s[8:11], s71 offen offset:0 sc1 lds
buffer_load_dwordx4 v9, s[8:11], s71 offen offset:1024 sc1 lds
buffer_load_dwordx4 v10, s[8:11], s71 offen offset:2048 sc1 lds
buffer_load_dwordx4 v11, s[8:11], s71 offen offset:3072 sc1 lds
buffer_load_dword v30, off, s[12:15], 0
s_add_u32 m0, m0, 4096
s_add_u32 s71, s70, s69
buffer_load_dwordx4 v8, s[8:11], s71 offen offset:0 sc1 lds
buffer_load_dwordx4 v9, s[8:11], s71 offen offset:1024 sc1 lds
buffer_load_dwordx4 v10, s[8:11], s71 offen offset:2048 sc1 lds
buffer_load_dwordx4 v11, s[8:11], s71 offen offset:3072 sc1 lds
buffer_load_dword v30, off, s[12:15], 0
s_waitcnt vmcnt(10)
v_add_u32 v5, s34, 33
s_mov_b64 exec, 1
ds_write_b32 v3, v5
s_mov_b64 exec, -1
s_xor_b32 s64, s64, s79
s_add_u32 s64, s64, 1
s_and_b32 s64, s64, 15
s_xor_b32 s64, s64, s79
s_sub_u32 s65, s65, 40960
s_cselect_b32 s65, 86016, s65
s_mul_i32 s70, s64, 393216
s_add_u32 m0, s65, s76
s_add_u32 s71, s70, s72
buffer_load_dwordx4 v12, s[12:15], s71 offen offset:0 lds
buffer_load_dwordx4 v13, s[12:15], s71 offen offset:1024 lds
buffer_load_dwordx4 v14, s[12:15], s71 offen offset:2048 lds
buffer_load_dwordx4 v15, s[12:15], s71 offen offset:3072 lds
buffer_load_dword v30, off, s[12:15], 0
s_add_u32 m0, m0, 4096
s_add_u32 s71, s70, s73
buffer_load_dwordx4 v12, s[12:15], s71 offen offset:0 lds
buffer_load_dwordx4 v13, s[12:15], s71 offen offset:1024 lds
buffer_load_dwordx4 v14, s[12:15], s71 offen offset:2048 lds
buffer_load_dwordx4 v15, s[12:15], s71 offen offset:3072 lds
buffer_load_dword v30, off, s[12:15], 0
s_add_u32 m0, m0, 4096
s_add_u32 s71, s70, s74
buffer_load_dwordx4 v12, s[12:15], s71 offen offset:0 lds
buffer_load_dwordx4 v13, s[12:15], s71 offen offset:1024 lds
buffer_load_dwordx4 v14, s[12:15], s71 offen offset:2048 lds
buffer_load_dwordx4 v15, s[12:15], s71 offen offset:3072 lds
buffer_load_dword v30, off, s[12:15], 0
s_mul_i32 s70, s64, s67
s_add_u32 m0, s65, s75
s_add_u32 s71, s70, s68
buffer_load_dwordx4 v8, s[8:11], s71 offen offset:0 sc1 lds
buffer_load_dwordx4 v9, s[8:11], s71 offen offset:1024 sc1 lds
buffer_load_dwordx4 v10, s[8:11], s71 offen offset:2048 sc1 lds
buffer_load_dwordx4 v11, s[8:11], s71 offen offset:3072 sc1 lds
buffer_load_dword v30, off, s[12:15], 0
s_add_u32 m0, m0, 4096
s_add_u32 s71, s70, s69
buffer_load_dwordx4 v8, s[8:11], s71 offen offset:0 sc1 lds
buffer_load_dwordx4 v9, s[8:11], s71 offen offset:1024 sc1 lds
buffer_load_dwordx4 v10, s[8:11], s71 offen offset:2048 sc1 lds
buffer_load_dwordx4 v11, s[8:11], s71 offen offset:3072 sc1 lds
buffer_load_dword v30, off, s[12:15], 0
s_waitcnt vmcnt(25)
v_add_u32 v5, s34, 34
s_mov_b64 exec, 1
ds_write_b32 v3, v5
s_mov_b64 exec, -1
s_xor_b32 s64, s64, s79
s_add_u32 s64, s64, 1
s_and_b32 s64, s64, 15
s_xor_b32 s64, s64, s79
s_sub_u32 s65, s65, 40960
s_cselect_b32 s65, 86016, s65
s_mov_b32 s36, s64
s_mov_b32 s37, s65
s_mov_b32 s64, s59
s_mov_b32 s65, 114688
s_mul_i32 s70, s64, 393216
s_add_u32 m0, s65, s76
s_add_u32 s71, s70, s72
buffer_load_dwordx4 v12, s[12:15], s71 offen offset:0 lds
buffer_load_dwordx4 v13, s[12:15], s71 offen offset:1024 lds
buffer_load_dwordx4 v14, s[12:15], s71 offen offset:2048 lds
buffer_load_dwordx4 v15, s[12:15], s71 offen offset:3072 lds
buffer_load_dword v30, off, s[12:15], 0
s_add_u32 m0, m0, 4096
s_add_u32 s71, s70, s73
buffer_load_dwordx4 v12, s[12:15], s71 offen offset:0 lds
buffer_load_dwordx4 v13, s[12:15], s71 offen offset:1024 lds
buffer_load_dwordx4 v14, s[12:15], s71 offen offset:2048 lds
buffer_load_dwordx4 v15, s[12:15], s71 offen offset:3072 lds
buffer_load_dword v30, off, s[12:15], 0
s_add_u32 m0, m0, 4096
s_add_u32 s71, s70, s74
buffer_load_dwordx4 v12, s[12:15], s71 offen offset:0 lds
buffer_load_dwordx4 v13, s[12:15], s71 offen offset:1024 lds
buffer_load_dwordx4 v14, s[12:15], s71 offen offset:2048 lds
buffer_load_dwordx4 v15, s[12:15], s71 offen offset:3072 lds
buffer_load_dword v30, off, s[12:15], 0
s_mov_b32 s64, s36
s_mov_b32 s65, s37
s_mov_b32 s63, 1
s_mov_b32 s34, 32
s_add_u32 s24, s24, 1409024
s_addc_u32 s25, s25, 0
s_mov_b32 s26, 1409024
s_mov_b32 s66, 32
s_branch lq_1
lcs_2:
s_add_u32 s35, s34, 1
lw_38:
ds_read_b32 v5, v2 offset:24
s_waitcnt lgkmcnt(0)
v_cmp_gt_i32 vcc, s35, v5
s_cbranch_vccz lwd_39
s_sub_u32 s32, s32, 1
s_cmp_gt_i32 s32, 0
s_cbranch_scc1 lw_38
lwd_39:
s_branch lcb_3
L_f:
v_lshlrev_b32 v4, 4, v0
s_lshl4_add_u32 s78, s59, s60
v_mov_b32 v252, 0
v_mov_b32 v253, 0
v_mov_b32 v254, 0
v_mov_b32 v255, 0
s_lshl_b32 s35, s78, 10
s_cmp_eq_u32 s58, 0
s_cselect_b64 exec, -1, 0
buffer_store_dwordx4 v[252:255], v4, s[24:27], s35 offen offset:0 sc1
s_add_u32 s35, s35, 262144
buffer_store_dwordx4 v[252:255], v4, s[24:27], s35 offen offset:0 sc1
s_mov_b64 exec, -1
s_setprio 3
v_and_b32 v1, 3, v0
v_lshlrev_b32 v1, 2, v1
v_and_b32 v2, 4, v1
s_lshl2_add_u32 s35, s58, 24
v_mov_b32 v3, s35
s_mov_b32 s4, s54
s_mov_b32 s5, s55
s_mov_b32 s6, 0x100
s_mov_b32 s7, 0x00020000
s_add_u32 s70, s60, 4
s_lshr_b32 s70, s70, 3
s_sub_u32 s70, s60, s70
s_lshl4_add_u32 s64, s70, s59
s_and_b32 s70, s60, 7
s_cmp_eq_u32 s70, 3
s_cselect_b32 s65, 1, 0
s_mov_b32 s69, 0x3f803f80
s_barrier
s_cmp_eq_u32 s58, 0
s_cselect_b32 s16, s46, s48
s_cselect_b32 s17, s47, s49
s_mov_b32 s12, s50
s_mov_b32 s13, s51
s_mov_b32 s14, 0x0
s_mov_b32 s15, 0x00020000
s_cmp_eq_u32 s65, 0
s_cselect_b32 s18, 7340032, 0
s_mov_b32 s14, s18
s_lshr_b32 s70, s64, 3
s_and_b32 s71, s64, 7
s_lshl_b32 s66, s70, 10
s_add_u32 s66, s66, s71
s_lshl1_add_u32 s66, s66, s58
s_lshl_b32 s66, s66, 7
s_mul_i32 s71, s71, 917504
s_lshl_b32 s70, s70, 8
s_add_u32 s77, s71, s70
s_mov_b32 s48, s38
s_mov_b32 s49, s39
s_mov_b32 s50, 0x600000
s_mov_b32 s51, 0x00020000
s_mov_b32 s52, 0
s_and_b32 s54, s60, 8
s_add_u32 s54, s54, 3
s_add_u32 s53, s54, s59
s_and_b32 s55, s60, 7
s_lshl1_add_u32 s55, s55, s58
s_mul_i32 s55, s55, 24576
s_lshl_b32 s54, s54, 7
s_add_u32 s56, s54, s55
s_add_u32 s56, s56, 60
s_and_b32 s73, s2, 3
s_lshl_b32 s73, s73, 6
v_mov_b32 v14, 1
s_sub_u32 exec_lo, 1, s58
s_mov_b32 exec_hi, 0
s_waitcnt vmcnt(0)
buffer_atomic_add v14, off, s[4:7], s73 sc1
s_mov_b64 exec, -1
v_mov_b32 v8, s69
v_mov_b32 v9, s69
v_mov_b32 v10, s69
v_mov_b32 v11, s69
v_mov_b32 v12, s69
v_mov_b32 v13, s69
v_mov_b32 v14, s69
v_mov_b32 v15, s69
s_mov_b32 s70, 102400
ftop_42:
v_lshrrev_b32 v6, 4, v0
v_bfe_u32 v7, v0, 2, 2
v_lshl_add_u32 v6, v6, 3, v7
v_bfe_u32 v7, v0, 3, 2
s_lshl_b32 s71, s58, 1
v_xor_b32 v7, s71, v7
v_lshl_add_u32 v7, v7, 5, s70
v_lshl_add_u32 v6, v6, 7, v7
v_lshl_add_u32 v6, v1, 1, v6
v_xor_b32 v7, 32, v6
s_mul_i32 s71, s63, 34
s_add_u32 s35, s71, 1
lw_43:
ds_read_b32 v5, v2 offset:16
s_waitcnt lgkmcnt(0)
v_cmp_gt_i32 vcc, s35, v5
s_cbranch_vccz lwd_44
s_sleep 1
s_sub_u32 s32, s32, 1
s_cmp_gt_i32 s32, 0
s_cbranch_scc1 lw_43
lwd_44:
ds_read_b64_tr_b16 v[24:25], v6 offset:0
ds_read_b64_tr_b16 v[26:27], v6 offset:512
ds_read_b64_tr_b16 v[28:29], v6 offset:4096
ds_read_b64_tr_b16 v[30:31], v6 offset:4608
ds_read_b64_tr_b16 v[32:33], v7 offset:0
ds_read_b64_tr_b16 v[34:35], v7 offset:512
ds_read_b64_tr_b16 v[36:37], v7 offset:4096
ds_read_b64_tr_b16 v[38:39], v7 offset:4608
ds_read_b64_tr_b16 v[40:41], v6 offset:8192
ds_read_b64_tr_b16 v[42:43], v6 offset:8704
ds_read_b64_tr_b16 v[44:45], v6 offset:12288
ds_read_b64_tr_b16 v[46:47], v6 offset:12800
ds_read_b64_tr_b16 v[48:49], v7 offset:8192
ds_read_b64_tr_b16 v[50:51], v7 offset:8704
ds_read_b64_tr_b16 v[52:53], v7 offset:12288
ds_read_b64_tr_b16 v[54:55], v7 offset:12800
s_lshl_b32 s72, s60, 14
s_lshl_b32 s70, s58, 9
s_add_u32 s72, s72, s70
s_lshl_b32 s70, s59, 10
s_add_u32 s71, s72, s70
s_lshl_b32 s76, s59, 14
s_add_u32 s73, s76, 30686208
s_add_u32 s76, s76, 266240
s_waitcnt lgkmcnt(14)
v_mfma_f32_16x16x32_bf16 v[248:251], v[8:11], v[24:27], 0
s_waitcnt lgkmcnt(10)
v_mfma_f32_16x16x32_bf16 v[252:255], v[8:11], v[32:35], 0
v_mfma_f32_16x16x32_bf16 v[248:251], v[12:15], v[28:31], v[248:251]
s_waitcnt lgkmcnt(8)
v_mfma_f32_16x16x32_bf16 v[252:255], v[12:15], v[36:39], v[252:255]
ds_read_b64_tr_b16 v[24:25], v6 offset:16384
ds_read_b64_tr_b16 v[26:27], v6 offset:16896
ds_read_b64_tr_b16 v[28:29], v6 offset:20480
ds_read_b64_tr_b16 v[30:31], v6 offset:20992
ds_read_b64_tr_b16 v[32:33], v7 offset:16384
ds_read_b64_tr_b16 v[34:35], v7 offset:16896
ds_read_b64_tr_b16 v[36:37], v7 offset:20480
ds_read_b64_tr_b16 v[38:39], v7 offset:20992
v_add_u32 v5, s34, 1
s_mov_b64 exec, 1
ds_write_b32 v3, v5
s_mov_b64 exec, -1
s_waitcnt lgkmcnt(14)
v_mfma_f32_16x16x32_bf16 v[16:19], v[8:11], v[40:43], 0
s_waitcnt lgkmcnt(11)
v_mfma_f32_16x16x32_bf16 v[20:23], v[8:11], v[48:51], 0
v_mfma_f32_16x16x32_bf16 v[16:19], v[12:15], v[44:47], v[16:19]
s_waitcnt lgkmcnt(9)
v_mfma_f32_16x16x32_bf16 v[20:23], v[12:15], v[52:55], v[20:23]
v_mov_b32 v249, v252
v_mov_b32 v252, s69
v_mov_b32 v253, s69
v_mov_b32 v254, s69
v_mov_b32 v255, s69
v_mfma_f32_16x16x32_bf16 v[52:55], v[8:11], v[8:11], 0
s_nop 0
v_mfma_f32_16x16x32_bf16 v[48:51], v[8:11], v[252:255], 0
v_mfma_f32_16x16x32_bf16 v[52:55], v[12:15], v[12:15], v[52:55]
v_mfma_f32_16x16x32_bf16 v[48:51], v[12:15], v[252:255], v[48:51]
s_waitcnt lgkmcnt(7)
v_mfma_f32_16x16x32_bf16 v[40:43], v[8:11], v[24:27], 0
s_waitcnt lgkmcnt(3)
v_mfma_f32_16x16x32_bf16 v[44:47], v[8:11], v[32:35], 0
v_mfma_f32_16x16x32_bf16 v[40:43], v[12:15], v[28:31], v[40:43]
s_waitcnt lgkmcnt(1)
v_mfma_f32_16x16x32_bf16 v[44:47], v[12:15], v[36:39], v[44:47]
v_lshlrev_b32 v6, 3, v0
v_and_b32 v7, 48, v0
v_mov_b32_dpp v248, v16 quad_perm:[0,1,2,3] row_mask:0x2 bank_mask:0xf
v_mov_b32_dpp v249, v20 quad_perm:[0,1,2,3] row_mask:0x2 bank_mask:0xf
s_nop 0
v_mov_b32_dpp v248, v48 quad_perm:[0,1,2,3] row_mask:0x8 bank_mask:0xf
v_mov_b32_dpp v249, v52 quad_perm:[0,1,2,3] row_mask:0x8 bank_mask:0xf
s_nop 0
v_mov_b32_dpp v248, v40 quad_perm:[0,1,2,3] row_mask:0x4 bank_mask:0xf
v_mov_b32_dpp v249, v44 quad_perm:[0,1,2,3] row_mask:0x4 bank_mask:0xf
v_max_u32 v248, 1, v248
v_max_u32 v249, 1, v249
s_cmp_eq_u32 s63, 0
s_cbranch_scc1 fst_40
fsb_41:
buffer_store_dwordx2 v[248:249], v6, s[24:27], s71 offen sc1
s_lshl4_add_u32 s70, s58, s60
s_add_u32 s70, s70, s34
s_cmp_eq_u32 s70, 51
s_cbranch_scc1 fxt_45
fxb_46:
s_add_u32 s73, s72, 4096
s_add_u32 s74, s72, 8192
s_add_u32 s75, s72, 12288
v_lshrrev_b32 v7, 2, v0
v_lshlrev_b32 v7, 7, v7
v_lshl_add_u32 v7, v1, 2, v7
v_lshrrev_b32 v8, 5, v0
v_lshrrev_b32 v9, 4, v0
v_xor_b32 v10, v8, v9
v_and_b32 v10, 1, v10
v_lshl_add_u32 v8, v10, 1, v8
v_and_b32 v10, 15, v0
v_lshlrev_b32 v8, 7, v8
v_lshl_add_u32 v8, v10, 3, v8
v_add_u32 v8, 1280, v8
s_mul_i32 s70, s58, 384
s_lshl_b32 s71, s63, 10
s_add_u32 s70, s70, s71
s_add_u32 s70, s70, 2304
v_lshl_add_u32 v9, v9, 7, s70
v_lshl_add_u32 v9, v10, 2, v9
s_cmp_eq_u32 s63, 0
s_cbranch_scc1 fg_47
fg_48:
poll_49:
buffer_load_dwordx4 v[12:15], v7, s[24:27], s76 offen sc1
pchk_50:
s_waitcnt vmcnt(0)
v_min3_u32 v10, v12, v13, v14
v_min_u32 v10, v10, v15
v_cmp_eq_u32 vcc, 0, v10
s_cbranch_vccz pdone_51
s_sub_u32 s32, s32, 1
s_cmp_gt_i32 s32, 0
s_cbranch_scc1 poll_49
pdone_51:
s_lshr_b32 s70, s33, 7
s_sub_u32 s70, s70, s59
s_mul_i32 s70, s70, s63
s_cmp_eq_u32 s70, 0
s_cbranch_scc0 fng_52
s_lshl1_add_u32 s70, s34, -32
s_add_u32 s35, s70, 15
lw_53:
ds_read_b32 v5, v2 offset:16
s_waitcnt lgkmcnt(0)
v_cmp_gt_i32 vcc, s35, v5
s_cbranch_vccz lwd_54
s_sleep 4
s_sub_u32 s32, s32, 1
s_cmp_gt_i32 s32, 0
s_cbranch_scc1 lw_53
lwd_54:
poll_55:
buffer_load_dwordx2 v[24:25], v6, s[24:27], s72 offen offset:0 sc1
buffer_load_dwordx2 v[26:27], v6, s[24:27], s72 offen offset:1024 sc1
buffer_load_dwordx2 v[28:29], v6, s[24:27], s72 offen offset:2048 sc1
buffer_load_dwordx2 v[30:31], v6, s[24:27], s72 offen offset:3072 sc1
buffer_load_dwordx2 v[32:33], v6, s[24:27], s73 offen offset:0 sc1
buffer_load_dwordx2 v[34:35], v6, s[24:27], s73 offen offset:1024 sc1
buffer_load_dwordx2 v[36:37], v6, s[24:27], s73 offen offset:2048 sc1
buffer_load_dwordx2 v[38:39], v6, s[24:27], s73 offen offset:3072 sc1
buffer_load_dwordx2 v[40:41], v6, s[24:27], s74 offen offset:0 sc1
buffer_load_dwordx2 v[42:43], v6, s[24:27], s74 offen offset:1024 sc1
buffer_load_dwordx2 v[44:45], v6, s[24:27], s74 offen offset:2048 sc1
buffer_load_dwordx2 v[46:47], v6, s[24:27], s74 offen offset:3072 sc1
buffer_load_dwordx2 v[48:49], v6, s[24:27], s75 offen offset:0 sc1
buffer_load_dwordx2 v[50:51], v6, s[24:27], s75 offen offset:1024 sc1
buffer_load_dwordx2 v[52:53], v6, s[24:27], s75 offen offset:2048 sc1
buffer_load_dwordx2 v[54:55], v6, s[24:27], s75 offen offset:3072 sc1
pchk_56:
s_waitcnt vmcnt(14)
v_min3_u32 v10, v24, v25, v26
s_waitcnt vmcnt(13)
v_min3_u32 v10, v10, v27, v28
s_waitcnt vmcnt(12)
v_min3_u32 v10, v10, v29, v30
s_waitcnt vmcnt(11)
v_min3_u32 v10, v10, v31, v32
s_waitcnt vmcnt(10)
v_min3_u32 v10, v10, v33, v34
s_waitcnt vmcnt(9)
v_min3_u32 v10, v10, v35, v36
s_waitcnt vmcnt(8)
v_min3_u32 v10, v10, v37, v38
s_waitcnt vmcnt(7)
v_min3_u32 v10, v10, v39, v40
s_waitcnt vmcnt(6)
v_min3_u32 v10, v10, v41, v42
s_waitcnt vmcnt(5)
v_min3_u32 v10, v10, v43, v44
s_waitcnt vmcnt(4)
v_min3_u32 v10, v10, v45, v46
s_waitcnt vmcnt(3)
v_min3_u32 v10, v10, v47, v48
s_waitcnt vmcnt(2)
v_min3_u32 v10, v10, v49, v50
s_waitcnt vmcnt(1)
v_min3_u32 v10, v10, v51, v52
s_waitcnt vmcnt(0)
v_min3_u32 v10, v10, v53, v54
v_min_u32 v10, v10, v55
v_cmp_eq_u32 vcc, 0, v10
s_cbranch_vccz pdone_57
s_sub_u32 s32, s32, 1
s_cmp_gt_i32 s32, 0
s_cbranch_scc1 poll_55
pdone_57:
v_add_f32 v24, v24, v40
v_add_f32 v25, v25, v41
v_add_f32 v26, v26, v42
v_add_f32 v27, v27, v43
v_add_f32 v28, v28, v44
v_add_f32 v29, v29, v45
v_add_f32 v30, v30, v46
v_add_f32 v31, v31, v47
v_add_f32 v32, v32, v48
v_add_f32 v33, v33, v49
v_add_f32 v34, v34, v50
v_add_f32 v35, v35, v51
v_add_f32 v36, v36, v52
v_add_f32 v37, v37, v53
v_add_f32 v38, v38, v54
v_add_f32 v39, v39, v55
v_add_f32 v24, v24, v32
v_add_f32 v25, v25, v33
v_add_f32 v26, v26, v34
v_add_f32 v27, v27, v35
v_add_f32 v28, v28, v36
v_add_f32 v29, v29, v37
v_add_f32 v30, v30, v38
v_add_f32 v31, v31, v39
v_add_f32 v24, v24, v28
v_add_f32 v25, v25, v29
v_add_f32 v26, v26, v30
v_add_f32 v27, v27, v31
v_add_f32 v24, v24, v26
v_add_f32 v25, v25, v27
s_mov_b32 exec_hi, 0xffff
ds_write2_b32 v9, v24, v25 offset1:16
s_mov_b32 exec_hi, -1
v_mul_f32 v5, 0xba800000, v24
v_mul_f32 v25, 0x3a800000, v25
v_fma_f32 v25, -v5, v5, v25
v_max_f32 v25, 0, v25
v_add_f32 v25, 0x3727c5ac, v25
v_rsq_f32 v24, v25
s_nop 0
v_mul_f32 v25, v5, v24
s_lshl_b32 s70, s59, 7
s_sub_u32 s70, s33, s70
v_lshlrev_b32 v10, 1, v0
v_sub_u32 v10, s70, v10
v_readlane_b32 s70, v24, 48
v_readlane_b32 s71, v25, 48
v_cmp_eq_u32 vcc, 0, v10
s_mov_b64 exec, vcc
v_mov_b32 v12, s70
v_mov_b32 v13, s71
s_mov_b64 exec, -1
v_cmp_eq_u32 vcc, 1, v10
s_mov_b64 exec, vcc
v_mov_b32 v14, s70
v_mov_b32 v15, s71
s_mov_b64 exec, -1
fng_52:
ds_write2_b32 v8, v12, v14 offset1:1
ds_write2_b32 v8, v13, v15 offset0:128 offset1:129
s_add_u32 s71, s34, s63
v_add_u32 v5, s71, 2
s_mov_b64 exec, 1
ds_write_b32 v3, v5
s_mov_b64 exec, -1
s_setprio 0
s_cmp_eq_u32 s63, 0
s_cbranch_scc1 fnw_58
fnw_59:
s_and_b32 s70, s64, 7
s_lshl_b32 s70, s70, 7
s_add_u32 s73, s70, 276480
s_lshl1_add_u32 s72, s70, 272384
s_lshr_b32 s71, s64, 3
s_lshl_b32 s76, s71, 13
s_add_u32 s76, s76, 1048576
s_lshl2_add_u32 s74, s70, s76
s_lshl_b32 s70, s58, 8
s_add_u32 s74, s74, s70
s_add_u32 s75, s74, 4096
s_lshl4_add_u32 s76, s70, s76
v_and_b32 v251, 15, v0
v_lshlrev_b32 v6, 14, v251
v_lshrrev_b32 v252, 4, v0
v_lshl_add_u32 v7, v252, 5, v6
v_lshlrev_b32 v251, 4, v251
s_lshl_b32 s70, s58, 3
v_lshl_add_u32 v253, v252, 1, s70
v_add_u32 v253, v253, v251
v_lshlrev_b32 v254, 5, v252
v_lshl_add_u32 v254, v2, 2, v254
v_and_b32 v255, 7, v0
v_lshl_add_u32 v255, v255, 2, v252
v_lshlrev_b32 v255, 3, v255
s_add_u32 s35, s34, 22
lw_60:
ds_read_b32 v5, v1 offset:0
s_waitcnt lgkmcnt(0)
v_cmp_gt_i32 vcc, s35, v5
s_cbranch_vccz lwd_61
s_sleep 4
s_sub_u32 s32, s32, 1
s_cmp_gt_i32 s32, 0
s_cbranch_scc1 lw_60
lwd_61:
s_setprio 3
s_add_u32 s35, s34, 24
lw_62:
ds_read_b32 v5, v1 offset:0
s_waitcnt lgkmcnt(0)
v_cmp_gt_i32 vcc, s35, v5
s_cbranch_vccz lwd_63
s_sleep 2
s_sub_u32 s32, s32, 1
s_cmp_gt_i32 s32, 0
s_cbranch_scc1 lw_62
lwd_63:
s_mul_i32 s79, s63, 64
s_sub_u32 s79, 32, s79
s_add_u32 s35, s79, 3
tw_64:
ds_read_b32 v5, v2 offset:16
s_waitcnt lgkmcnt(0)
v_cmp_gt_i32 vcc, s35, v5
s_cbranch_vccz twd_65
v_readfirstlane_b32 s54, v5
s_sub_u32 s55, s35, s54
s_cmp_lt_i32 s55, 2
s_cbranch_scc1 tws_66
s_add_u32 s54, s54, 2
s_or_b32 s54, s54, 1
s_cmp_eq_u32 s54, s52
s_cbranch_scc1 tws_66
s_bitcmp1_b32 s54, 4
s_cbranch_scc1 tws_66
s_mov_b32 s52, s54
s_add_u32 s54, s54, s53
s_and_b32 s54, s54, 15
s_mul_i32 s54, s54, 393216
s_add_u32 s54, s54, s56
s_buffer_load_dwordx2 s[46:47], s[48:51], s54 offset:4096
s_buffer_load_dwordx2 s[46:47], s[48:51], s54 offset:10240
s_buffer_load_dwordx2 s[46:47], s[48:51], s54 offset:16384
s_buffer_load_dwordx2 s[46:47], s[48:51], s54 offset:22528
tws_66:
s_sleep 4
s_sub_u32 s32, s32, 1
s_cmp_gt_i32 s32, 0
s_cbranch_scc1 tw_64
twd_65:
s_cmp_eq_u32 s65, 0
s_cbranch_scc0 fnd_68
poll_69:
buffer_load_dwordx2 v[248:249], v6, s[24:27], s73 offen sc1
buffer_load_dwordx4 v[8:11], v7, s[24:27], s72 offen offset:0 sc1
buffer_load_dwordx4 v[12:15], v7, s[24:27], s72 offen offset:16 sc1
buffer_load_dwordx4 v[16:19], v7, s[24:27], s72 offen offset:128 sc1
buffer_load_dwordx4 v[20:23], v7, s[24:27], s72 offen offset:144 sc1
pchk_70:
s_waitcnt vmcnt(3)
v_min3_u32 v5, v248, v249, v8
v_min3_u32 v5, v5, v9, v10
s_waitcnt vmcnt(2)
v_min3_u32 v5, v5, v11, v12
v_min3_u32 v5, v5, v13, v14
s_waitcnt vmcnt(1)
v_min3_u32 v5, v5, v15, v16
v_min3_u32 v5, v5, v17, v18
s_waitcnt vmcnt(0)
v_min3_u32 v5, v5, v19, v20
v_min3_u32 v5, v5, v21, v22
v_min_u32 v5, v5, v23
v_cmp_eq_u32 vcc, 0, v5
s_mov_b64 exec, vcc
s_cbranch_vccz pdone_71
s_sleep 3
s_sub_u32 s32, s32, 1
s_cmp_gt_i32 s32, 0
s_cbranch_scc1 poll_69
pdone_71:
s_mov_b64 exec, -1
v_mfma_f32_16x16x32_bf16 v[24:27], v[8:11], v[56:59], 0
v_mov_b32 v250, v248
v_mfma_f32_16x16x32_bf16 v[28:31], v[8:11], v[60:63], 0
s_nop 0
v_max_f32_dpp v250, v250, v250 row_ror:1 row_mask:0xf bank_mask:0xf
v_mfma_f32_16x16x32_bf16 v[32:35], v[8:11], v[64:67], 0
s_nop 0
v_max_f32_dpp v250, v250, v250 row_ror:2 row_mask:0xf bank_mask:0xf
v_mfma_f32_16x16x32_bf16 v[36:39], v[8:11], v[68:71], 0
s_nop 0
v_max_f32_dpp v250, v250, v250 row_ror:4 row_mask:0xf bank_mask:0xf
v_mfma_f32_16x16x32_bf16 v[40:43], v[8:11], v[72:75], 0
s_nop 0
v_max_f32_dpp v250, v250, v250 row_ror:8 row_mask:0xf bank_mask:0xf
v_mfma_f32_16x16x32_bf16 v[44:47], v[8:11], v[76:79], 0
v_cmp_eq_f32 vcc, v250, v248
v_mfma_f32_16x16x32_bf16 v[48:51], v[8:11], v[80:83], 0
s_ff1_i32_b64 s68, vcc
v_mfma_f32_16x16x32_bf16 v[52:55], v[8:11], v[84:87], 0
s_and_b32 s68, s68, 15
v_mfma_f32_16x16x32_bf16 v[24:27], v[12:15], v[88:91], v[24:27]
v_readlane_b32 s33, v249, s68
v_mfma_f32_16x16x32_bf16 v[28:31], v[12:15], v[92:95], v[28:31]
v_readlane_b32 s67, v248, s68
v_mfma_f32_16x16x32_bf16 v[32:35], v[12:15], v[96:99], v[32:35]
v_add_u32 v5, s34, 4
v_mfma_f32_16x16x32_bf16 v[36:39], v[12:15], v[100:103], v[36:39]
v_mov_b32 v250, s33
v_mfma_f32_16x16x32_bf16 v[40:43], v[12:15], v[104:107], v[40:43]
s_mov_b64 exec, 1
ds_write2_b32 v3, v5, v250 offset1:2
s_mov_b64 exec, -1
v_mfma_f32_16x16x32_bf16 v[44:47], v[12:15], v[108:111], v[44:47]
s_sub_u32 s33, s33, 1
v_mfma_f32_16x16x32_bf16 v[48:51], v[12:15], v[112:115], v[48:51]
s_and_b32 s33, s33, 2047
v_mfma_f32_16x16x32_bf16 v[52:55], v[12:15], v[116:119], v[52:55]
v_mfma_f32_16x16x32_bf16 v[24:27], v[16:19], v[120:123], v[24:27]
v_mfma_f32_16x16x32_bf16 v[28:31], v[16:19], v[124:127], v[28:31]
v_mfma_f32_16x16x32_bf16 v[32:35], v[16:19], v[128:131], v[32:35]
v_mfma_f32_16x16x32_bf16 v[36:39], v[16:19], v[132:135], v[36:39]
v_mfma_f32_16x16x32_bf16 v[40:43], v[16:19], v[136:139], v[40:43]
v_mfma_f32_16x16x32_bf16 v[44:47], v[16:19], v[140:143], v[44:47]
v_mfma_f32_16x16x32_bf16 v[48:51], v[16:19], v[144:147], v[48:51]
v_mfma_f32_16x16x32_bf16 v[52:55], v[16:19], v[148:151], v[52:55]
v_mfma_f32_16x16x32_bf16 v[24:27], v[20:23], v[152:155], v[24:27]
s_and_b32 s70, s68, 12
s_lshl_b32 s70, s70, 2
s_bitcmp1_b32 s68, 1
v_mfma_f32_16x16x32_bf16 v[28:31], v[20:23], v[156:159], v[28:31]
v_mfma_f32_16x16x32_bf16 v[32:35], v[20:23], v[160:163], v[32:35]
v_mfma_f32_16x16x32_bf16 v[36:39], v[20:23], v[164:167], v[36:39]
v_mfma_f32_16x16x32_bf16 v[40:43], v[20:23], v[168:171], v[40:43]
v_mfma_f32_16x16x32_bf16 v[44:47], v[20:23], v[172:175], v[44:47]
v_mfma_f32_16x16x32_bf16 v[48:51], v[20:23], v[176:179], v[48:51]
v_mfma_f32_16x16x32_bf16 v[52:55], v[20:23], v[180:183], v[52:55]
s_cbranch_scc1 fsel_74
fsel_72:
s_bitcmp1_b32 s68, 0
s_cbranch_scc1 fsel_73
v_max_u32 v8, 1, v24
v_max_u32 v9, 1, v28
v_max_u32 v10, 1, v32
v_max_u32 v11, 1, v36
v_max_u32 v12, 1, v40
v_max_u32 v13, 1, v44
v_max_u32 v14, 1, v48
v_max_u32 v15, 1, v52
s_branch fsel_76
fsel_73:
v_max_u32 v8, 1, v25
v_max_u32 v9, 1, v29
v_max_u32 v10, 1, v33
v_max_u32 v11, 1, v37
v_max_u32 v12, 1, v41
v_max_u32 v13, 1, v45
v_max_u32 v14, 1, v49
v_max_u32 v15, 1, v53
s_branch fsel_76
fsel_74:
s_bitcmp1_b32 s68, 0
s_cbranch_scc1 fsel_75
v_max_u32 v8, 1, v26
v_max_u32 v9, 1, v30
v_max_u32 v10, 1, v34
v_max_u32 v11, 1, v38
v_max_u32 v12, 1, v42
v_max_u32 v13, 1, v46
v_max_u32 v14, 1, v50
v_max_u32 v15, 1, v54
s_branch fsel_76
fsel_75:
v_max_u32 v8, 1, v27
v_max_u32 v9, 1, v31
v_max_u32 v10, 1, v35
v_max_u32 v11, 1, v39
v_max_u32 v12, 1, v43
v_max_u32 v13, 1, v47
v_max_u32 v14, 1, v51
v_max_u32 v15, 1, v55
fsel_76:
s_bfm_b64 exec, 16, s70
buffer_store_dwordx4 v[8:11], v251, s[24:27], s74 offen sc1
buffer_store_dwordx4 v[12:15], v251, s[24:27], s75 offen sc1
s_mov_b64 exec, -1
s_and_b32 s70, s64, 7
s_lshl1_add_u32 s70, s70, s58
s_mul_i32 s70, s70, 28
s_add_u32 s70, s70, s71
s_lshl_b32 s70, s70, 8
s_add_u32 s70, s70, 1277952
s_waitcnt vmcnt(0)
s_mul_i32 s79, s63, 64
s_sub_u32 s79, 32, s79
s_add_u32 s35, s79, 7
tw_78:
ds_read_b32 v5, v2 offset:16
s_waitcnt lgkmcnt(0)
v_cmp_gt_i32 vcc, s35, v5
s_cbranch_vccz twd_79
v_readfirstlane_b32 s54, v5
s_sub_u32 s55, s35, s54
s_cmp_lt_i32 s55, 2
s_cbranch_scc1 tws_80
s_add_u32 s54, s54, 2
s_or_b32 s54, s54, 1
s_cmp_eq_u32 s54, s52
s_cbranch_scc1 tws_80
s_bitcmp1_b32 s54, 4
s_cbranch_scc1 tws_80
s_mov_b32 s52, s54
s_add_u32 s54, s54, s53
s_and_b32 s54, s54, 15
s_mul_i32 s54, s54, 393216
s_add_u32 s54, s54, s56
s_buffer_load_dwordx2 s[46:47], s[48:51], s54 offset:4096
s_buffer_load_dwordx2 s[46:47], s[48:51], s54 offset:10240
s_buffer_load_dwordx2 s[46:47], s[48:51], s54 offset:16384
s_buffer_load_dwordx2 s[46:47], s[48:51], s54 offset:22528
tws_80:
s_sleep 4
s_sub_u32 s32, s32, 1
s_cmp_gt_i32 s32, 0
s_cbranch_scc1 tw_78
twd_79:
poll_81:
buffer_load_dwordx4 v[24:27], v4, s[24:27], s76 offen offset:0 sc1
buffer_load_dwordx4 v[28:31], v4, s[24:27], s76 offen offset:1024 sc1
buffer_load_dwordx4 v[32:35], v4, s[24:27], s76 offen offset:2048 sc1
buffer_load_dwordx4 v[36:39], v4, s[24:27], s76 offen offset:3072 sc1
pchk_82:
s_waitcnt vmcnt(3)
v_min3_u32 v5, v24, v25, v26
s_waitcnt vmcnt(2)
v_min3_u32 v5, v5, v27, v28
v_min3_u32 v5, v5, v29, v30
s_waitcnt vmcnt(1)
v_min3_u32 v5, v5, v31, v32
v_min3_u32 v5, v5, v33, v34
s_waitcnt vmcnt(0)
v_min3_u32 v5, v5, v35, v36
v_min3_u32 v5, v5, v37, v38
v_min_u32 v5, v5, v39
v_cmp_eq_u32 vcc, 0, v5
s_cbranch_vccz pdone_83
s_sub_u32 s32, s32, 1
s_cmp_gt_i32 s32, 0
s_cbranch_scc1 poll_81
pdone_83:
v_add_f32 v24, v24, v32
v_add_f32 v25, v25, v33
v_add_f32 v26, v26, v34
v_add_f32 v27, v27, v35
v_add_f32 v28, v28, v36
v_add_f32 v29, v29, v37
v_add_f32 v30, v30, v38
v_add_f32 v31, v31, v39
fj_77:
v_add_f32 v24, v24, v28
v_add_f32 v25, v25, v29
v_add_f32 v26, v26, v30
v_add_f32 v27, v27, v31
s_nop 0
v_permlane32_swap_b32 v24, v26
v_permlane32_swap_b32 v25, v27
v_add_f32 v24, v24, v26
v_add_f32 v25, v25, v27
s_nop 1
v_permlane16_swap_b32 v24, v25
v_mul_f32 v26, 0xbfb8aa3b, v24
v_exp_f32 v26, v26
v_mul_f32 v24, v24, v25
v_add_f32 v26, 1.0, v26
v_rcp_f32 v26, v26
v_add_u32 v5, s34, 5
v_mul_f32 v24, v24, v26
v_cvt_pk_bf16_f32 v24, v24, v24
ds_write_b16 v253, v24 offset:512
s_mov_b64 exec, 1
ds_write_b32 v3, v5
s_mov_b64 exec, -1
s_add_u32 s35, s34, 5
poll_84:
ds_read_b32 v5, v2 offset:24
ds_read_b128 v[8:11], v254 offset:512
ds_read_b128 v[12:15], v254 offset:640
pchk_85:
s_waitcnt lgkmcnt(2)
v_cmp_gt_i32 vcc, s35, v5
s_cbranch_vccz pdone_86
s_sleep 1
s_sub_u32 s32, s32, 1
s_cmp_gt_i32 s32, 0
s_cbranch_scc1 poll_84
pdone_86:
s_waitcnt lgkmcnt(1)
v_mfma_f32_16x16x32_bf16 v[24:27], v[8:11], v[184:187], 0
v_mfma_f32_16x16x32_bf16 v[28:31], v[8:11], v[188:191], 0
v_mfma_f32_16x16x32_bf16 v[32:35], v[8:11], v[192:195], 0
v_mfma_f32_16x16x32_bf16 v[36:39], v[8:11], v[196:199], 0
v_mfma_f32_16x16x32_bf16 v[40:43], v[8:11], v[200:203], 0
v_mfma_f32_16x16x32_bf16 v[44:47], v[8:11], v[204:207], 0
v_mfma_f32_16x16x32_bf16 v[48:51], v[8:11], v[208:211], 0
v_mfma_f32_16x16x32_bf16 v[52:55], v[8:11], v[212:215], 0
s_waitcnt lgkmcnt(0)
v_mfma_f32_16x16x32_bf16 v[24:27], v[12:15], v[216:219], v[24:27]
v_mfma_f32_16x16x32_bf16 v[28:31], v[12:15], v[220:223], v[28:31]
v_mfma_f32_16x16x32_bf16 v[32:35], v[12:15], v[224:227], v[32:35]
v_mfma_f32_16x16x32_bf16 v[36:39], v[12:15], v[228:231], v[36:39]
v_mfma_f32_16x16x32_bf16 v[40:43], v[12:15], v[232:235], v[40:43]
v_mfma_f32_16x16x32_bf16 v[44:47], v[12:15], v[236:239], v[44:47]
v_mfma_f32_16x16x32_bf16 v[48:51], v[12:15], v[240:243], v[48:51]
v_mfma_f32_16x16x32_bf16 v[52:55], v[12:15], v[244:247], v[52:55]
s_nop 0
v_add_f32_dpp v16, v25, v24 row_ror:8 row_mask:0x1 bank_mask:0xf
v_add_f32_dpp v17, v29, v28 row_ror:8 row_mask:0x1 bank_mask:0xf
s_nop 0
v_add_f32_dpp v16, v33, v32 row_ror:8 row_mask:0x2 bank_mask:0xf
v_add_f32_dpp v17, v37, v36 row_ror:8 row_mask:0x2 bank_mask:0xf
s_nop 0
v_add_f32_dpp v16, v41, v40 row_ror:8 row_mask:0x4 bank_mask:0xf
v_add_f32_dpp v17, v45, v44 row_ror:8 row_mask:0x4 bank_mask:0xf
s_nop 0
v_add_f32_dpp v16, v49, v48 row_ror:8 row_mask:0x8 bank_mask:0xf
v_add_f32_dpp v17, v53, v52 row_ror:8 row_mask:0x8 bank_mask:0xf
v_max_u32 v16, 1, v16
v_max_u32 v17, 1, v17
s_mov_b32 exec_lo, 0x00ff00ff
s_mov_b32 exec_hi, 0x00ff00ff
buffer_store_dwordx2 v[16:17], v255, s[24:27], s70 offen sc1
s_mov_b64 exec, -1
fnd_67:
s_sub_u32 s70, s60, 3
s_mul_i32 s70, s70, s63
s_or_b32 s70, s70, s58
s_cbranch_scc1 fnr_87
s_mul_i32 s72, s59, 7168
s_add_u32 s72, s72, 1277952
s_add_u32 s73, s72, 4096
s_lshl_b32 s70, s68, 6
s_add_u32 s70, s70, s59
s_lshl_b32 s70, s70, 8
s_add_u32 s76, s70, 262144
v_mov_b32 v12, s67
v_mul_f32 v12, 0xbfb8aa3b, v12
v_exp_f32 v12, v12
v_lshl_add_u32 v6, v252, 2, v251
v_add_f32 v12, 1.0, v12
v_rcp_f32 v12, v12
v_lshrrev_b32 v7, 1, v6
s_lshl4_add_u32 s70, s33, s59
s_lshl_b32 s70, s70, 7
v_and_b32 v8, 0x46, v7
v_lshl_add_u32 v8, v1, 2, v8
v_and_b32 v9, 4, v0
v_lshl_add_u32 v8, v9, 1, v8
s_waitcnt vmcnt(0)
s_cmp_gt_u32 s65, s63
s_cbranch_scc1 fpre_90
fpre_91:
s_mul_i32 s79, s63, 64
s_sub_u32 s79, 32, s79
s_add_u32 s35, s79, 11
tw_92:
ds_read_b32 v5, v2 offset:16
s_waitcnt lgkmcnt(0)
v_cmp_gt_i32 vcc, s35, v5
s_cbranch_vccz twd_93
v_readfirstlane_b32 s54, v5
s_sub_u32 s55, s35, s54
s_cmp_lt_i32 s55, 2
s_cbranch_scc1 tws_94
s_add_u32 s54, s54, 2
s_or_b32 s54, s54, 1
s_cmp_eq_u32 s54, s52
s_cbranch_scc1 tws_94
s_bitcmp1_b32 s54, 4
s_cbranch_scc1 tws_94
s_mov_b32 s52, s54
s_add_u32 s54, s54, s53
s_and_b32 s54, s54, 15
s_mul_i32 s54, s54, 393216
s_add_u32 s54, s54, s56
s_buffer_load_dwordx2 s[46:47], s[48:51], s54 offset:4096
s_buffer_load_dwordx2 s[46:47], s[48:51], s54 offset:10240
s_buffer_load_dwordx2 s[46:47], s[48:51], s54 offset:16384
s_buffer_load_dwordx2 s[46:47], s[48:51], s54 offset:22528
tws_94:
s_sleep 4
s_sub_u32 s32, s32, 1
s_cmp_gt_i32 s32, 0
s_cbranch_scc1 tw_92
twd_93:
poll_95:
buffer_load_dword v52, v6, s[24:27], s76 offen sc1
buffer_load_dwordx4 v[24:27], v4, s[24:27], s72 offen offset:0 sc1
buffer_load_dwordx4 v[28:31], v4, s[24:27], s72 offen offset:1024 sc1
buffer_load_dwordx4 v[32:35], v4, s[24:27], s72 offen offset:2048 sc1
buffer_load_dwordx4 v[36:39], v4, s[24:27], s72 offen offset:3072 sc1
buffer_load_dwordx4 v[40:43], v4, s[24:27], s73 offen offset:0 sc1
buffer_load_dwordx4 v[44:47], v4, s[24:27], s73 offen offset:1024 sc1
buffer_load_dwordx4 v[48:51], v4, s[24:27], s73 offen offset:2048 sc1
pchk_96:
s_waitcnt vmcnt(6)
v_min3_u32 v5, v24, v25, v26
s_waitcnt vmcnt(5)
v_min3_u32 v5, v5, v27, v28
v_min3_u32 v5, v5, v29, v30
s_waitcnt vmcnt(4)
v_min3_u32 v5, v5, v31, v32
v_min3_u32 v5, v5, v33, v34
s_waitcnt vmcnt(3)
v_min3_u32 v5, v5, v35, v36
v_min3_u32 v5, v5, v37, v38
s_waitcnt vmcnt(2)
v_min3_u32 v5, v5, v39, v40
v_min3_u32 v5, v5, v41, v42
s_waitcnt vmcnt(1)
v_min3_u32 v5, v5, v43, v44
v_min3_u32 v5, v5, v45, v46
s_waitcnt vmcnt(0)
v_min3_u32 v5, v5, v47, v48
v_min3_u32 v5, v5, v49, v50
v_min3_u32 v5, v5, v51, v52
v_cmp_eq_u32 vcc, 0, v5
s_cbranch_vccz pdone_97
s_sub_u32 s32, s32, 1
s_cmp_gt_i32 s32, 0
s_cbranch_scc1 poll_95
pdone_97:
v_add_f32 v24, v24, v40
v_add_f32 v25, v25, v41
v_add_f32 v26, v26, v42
v_add_f32 v27, v27, v43
v_add_f32 v28, v28, v44
v_add_f32 v29, v29, v45
v_add_f32 v30, v30, v46
v_add_f32 v31, v31, v47
v_add_f32 v32, v32, v48
v_add_f32 v33, v33, v49
v_add_f32 v34, v34, v50
v_add_f32 v35, v35, v51
fj_89:
v_add_f32 v24, v24, v32
v_add_f32 v25, v25, v33
v_add_f32 v26, v26, v34
v_add_f32 v27, v27, v35
v_add_f32 v28, v28, v36
v_add_f32 v29, v29, v37
v_add_f32 v30, v30, v38
v_add_f32 v31, v31, v39
v_add_f32 v24, v24, v28
v_add_f32 v25, v25, v29
v_add_f32 v26, v26, v30
v_add_f32 v27, v27, v31
s_nop 0
v_permlane32_swap_b32 v24, v26
v_permlane32_swap_b32 v25, v27
v_add_f32 v24, v24, v26
v_add_f32 v25, v25, v27
s_nop 1
v_permlane16_swap_b32 v24, v25
v_add_f32 v24, v24, v25
v_fma_f32 v24, v24, v12, v52
v_cvt_pk_bf16_f32 v24, v24, v24
s_cmp_eq_u32 s63, 0
s_cbranch_scc1 fl0_88
buffer_store_short v24, v7, s[28:31], s70 offen
s_branch L_end
fl0_88:
ds_write_b16 v8, v24 offset:384
fnr_87:
s_cmp_eq_u32 s63, 0
s_cbranch_scc0 L_end
v_add_u32 v5, s34, 6
s_mov_b64 exec, 1
ds_write_b32 v3, v5
s_mov_b64 exec, -1
s_mul_i32 s79, s63, 64
s_sub_u32 s79, 32, s79
s_add_u32 s35, s79, 11
tw_98:
ds_read_b32 v5, v2 offset:16
s_waitcnt lgkmcnt(0)
v_cmp_gt_i32 vcc, s35, v5
s_cbranch_vccz twd_99
v_readfirstlane_b32 s54, v5
s_sub_u32 s55, s35, s54
s_cmp_lt_i32 s55, 2
s_cbranch_scc1 tws_100
s_add_u32 s54, s54, 2
s_or_b32 s54, s54, 1
s_cmp_eq_u32 s54, s52
s_cbranch_scc1 tws_100
s_bitcmp1_b32 s54, 4
s_cbranch_scc1 tws_100
s_mov_b32 s52, s54
s_add_u32 s54, s54, s53
s_and_b32 s54, s54, 15
s_mul_i32 s54, s54, 393216
s_add_u32 s54, s54, s56
s_buffer_load_dwordx2 s[46:47], s[48:51], s54 offset:4096
s_buffer_load_dwordx2 s[46:47], s[48:51], s54 offset:10240
s_buffer_load_dwordx2 s[46:47], s[48:51], s54 offset:16384
s_buffer_load_dwordx2 s[46:47], s[48:51], s54 offset:22528
tws_100:
s_sleep 4
s_sub_u32 s32, s32, 1
s_cmp_gt_i32 s32, 0
s_cbranch_scc1 tw_98
twd_99:
v_and_b32 v6, 48, v0
s_add_u32 s35, s34, 6
poll_101:
ds_read_b32 v5, v2 offset:24
ds_read_b128 v[8:11], v6 offset:384
ds_read_b128 v[12:15], v6 offset:448
pchk_102:
s_waitcnt lgkmcnt(2)
v_cmp_gt_i32 vcc, s35, v5
s_cbranch_vccz pdone_103
s_sleep 1
s_sub_u32 s32, s32, 1
s_cmp_gt_i32 s32, 0
s_cbranch_scc1 poll_101
pdone_103:
s_mov_b32 s63, 1
s_mov_b32 s34, 32
s_add_u32 s24, s24, 1409024
s_addc_u32 s25, s25, 0
s_mov_b32 s26, 1409024
s_mov_b32 s70, 131072
s_mov_b32 s79, 34
s_branch ftop_42
fxt_45:
v_max_u32 v8, 1, v8
v_max_u32 v9, 1, v9
v_max_u32 v10, 1, v10
v_max_u32 v11, 1, v11
v_max_u32 v12, 1, v12
v_max_u32 v13, 1, v13
v_max_u32 v14, 1, v14
v_max_u32 v15, 1, v15
s_mov_b32 exec_lo, 0x10001
s_mov_b32 exec_hi, 0x10001
buffer_store_dwordx4 v[8:11], v7, s[20:23], s73 offen offset:0 sc1
buffer_store_dwordx4 v[12:15], v7, s[20:23], s73 offen offset:64 sc1
s_mov_b64 exec, -1
s_branch fxb_46
fst_40:
s_lshl1_add_u32 s70, s78, s58
s_lshl_b32 s70, s70, 13
v_bfe_u32 v8, v0, 2, 2
v_lshl_add_u32 v8, v8, 9, v7
v_add_u32 v8, v8, v1
v_lshlrev_b32 v8, 2, v8
buffer_load_dwordx4 v[24:27], v8, s[8:11], s70 offen offset:0
buffer_load_dwordx4 v[28:31], v8, s[8:11], s70 offen offset:256
buffer_load_dwordx4 v[32:35], v8, s[8:11], s70 offen offset:512
buffer_load_dwordx4 v[36:39], v8, s[8:11], s70 offen offset:768
buffer_load_dwordx4 v[40:43], v8, s[8:11], s70 offen offset:1024
buffer_load_dwordx4 v[44:47], v8, s[8:11], s70 offen offset:1280
buffer_load_dwordx4 v[48:51], v8, s[8:11], s70 offen offset:1536
buffer_load_dwordx4 v[52:55], v8, s[8:11], s70 offen offset:1792
v_lshlrev_b32 v9, 4, v1
s_waitcnt vmcnt(7)
v_mfma_f32_16x16x32_bf16 v[16:19], v[24:27], v[252:255], 0
v_mfma_f32_16x16x32_bf16 v[20:23], v[24:27], v[24:27], 0
s_waitcnt vmcnt(6)
v_mfma_f32_16x16x32_bf16 v[16:19], v[28:31], v[252:255], v[16:19]
v_mfma_f32_16x16x32_bf16 v[20:23], v[28:31], v[28:31], v[20:23]
s_waitcnt vmcnt(5)
v_mfma_f32_16x16x32_bf16 v[16:19], v[32:35], v[252:255], v[16:19]
v_mfma_f32_16x16x32_bf16 v[20:23], v[32:35], v[32:35], v[20:23]
s_waitcnt vmcnt(4)
v_mfma_f32_16x16x32_bf16 v[16:19], v[36:39], v[252:255], v[16:19]
v_mfma_f32_16x16x32_bf16 v[20:23], v[36:39], v[36:39], v[20:23]
s_waitcnt vmcnt(3)
v_mfma_f32_16x16x32_bf16 v[16:19], v[40:43], v[252:255], v[16:19]
v_mfma_f32_16x16x32_bf16 v[20:23], v[40:43], v[40:43], v[20:23]
s_waitcnt vmcnt(2)
v_mfma_f32_16x16x32_bf16 v[16:19], v[44:47], v[252:255], v[16:19]
v_mfma_f32_16x16x32_bf16 v[20:23], v[44:47], v[44:47], v[20:23]
s_waitcnt vmcnt(1)
v_mfma_f32_16x16x32_bf16 v[16:19], v[48:51], v[252:255], v[16:19]
v_mfma_f32_16x16x32_bf16 v[20:23], v[48:51], v[48:51], v[20:23]
s_waitcnt vmcnt(0)
v_mfma_f32_16x16x32_bf16 v[16:19], v[52:55], v[252:255], v[16:19]
v_mfma_f32_16x16x32_bf16 v[20:23], v[52:55], v[52:55], v[20:23]
s_nop 6
v_add_f32 v16, v16, v18
v_add_f32 v17, v17, v19
v_add_f32 v16, v16, v17
s_nop 0
v_mov_b32_dpp v17, v20 quad_perm:[0,0,0,0] row_mask:0xf bank_mask:0xf
s_nop 1
v_add_f32_dpp v17, v21, v17 quad_perm:[1,1,1,1] row_mask:0xf bank_mask:0xf
s_nop 1
v_add_f32_dpp v17, v22, v17 quad_perm:[2,2,2,2] row_mask:0xf bank_mask:0xf
s_nop 1
v_add_f32_dpp v17, v23, v17 quad_perm:[3,3,3,3] row_mask:0xf bank_mask:0xf
v_mul_f32 v5, 0xba800000, v16
v_mul_f32 v17, 0x3a800000, v17
v_fma_f32 v17, -v5, v5, v17
v_max_f32 v17, 0, v17
v_add_f32 v17, 0x3727c5ac, v17
v_rsq_f32 v16, v17
s_nop 0
v_mul_f32 v17, v5, v16
v_max_u32 v17, 1, v17
s_lshl_b32 s70, s60, 7
s_add_u32 s70, s70, s76
s_lshl_b32 s73, s58, 5
s_add_u32 s70, s70, s73
v_lshrrev_b32 v7, 1, v7
s_add_u32 s35, s34, 5
tw_104:
ds_read_b32 v5, v2 offset:16
s_waitcnt lgkmcnt(0)
v_cmp_gt_i32 vcc, s35, v5
s_cbranch_vccz twd_105
v_readfirstlane_b32 s54, v5
s_sub_u32 s55, s35, s54
s_cmp_lt_i32 s55, 2
s_cbranch_scc1 tws_106
s_add_u32 s54, s54, 2
s_or_b32 s54, s54, 1
s_cmp_eq_u32 s54, s52
s_cbranch_scc1 tws_106
s_bitcmp1_b32 s54, 4
s_cbranch_scc1 tws_106
s_mov_b32 s52, s54
s_add_u32 s54, s54, s53
s_and_b32 s54, s54, 15
s_mul_i32 s54, s54, 393216
s_add_u32 s54, s54, s56
s_buffer_load_dwordx2 s[46:47], s[48:51], s54 offset:4096
s_buffer_load_dwordx2 s[46:47], s[48:51], s54 offset:10240
s_buffer_load_dwordx2 s[46:47], s[48:51], s54 offset:16384
s_buffer_load_dwordx2 s[46:47], s[48:51], s54 offset:22528
tws_106:
s_sleep 4
s_sub_u32 s32, s32, 1
s_cmp_gt_i32 s32, 0
s_cbranch_scc1 tw_104
twd_105:
poll_107:
buffer_load_dword v12, v9, s[4:7], 0 offen sc1
pchk_108:
s_waitcnt vmcnt(0)
v_cmp_gt_u32 vcc, 64, v12
s_cbranch_vccz pdone_109
s_sleep 16
s_sub_u32 s32, s32, 1
s_cmp_gt_i32 s32, 0
s_cbranch_scc1 poll_107
pdone_109:
s_mov_b32 exec_lo, 0x00100001
s_mov_b32 exec_hi, 0x10000100
buffer_store_dwordx2 v[16:17], v7, s[24:27], s70 offen sc1
s_getreg_b32 s73, hwreg(HW_REG_XCC_ID)
s_mov_b64 exec, 1
v_add_u32 v12, s73, 1
buffer_store_dword v12, off, s[24:27], s70 offset:64 sc1
s_mov_b64 exec, -1
s_branch fsb_41
fg_47:
s_lshl1_add_u32 s35, s2, s58
s_lshl_b32 s35, s35, 12
s_add_u32 s44, s40, s35
s_addc_u32 s45, s41, 0
s_mov_b32 s35, 4
ft_110:
s_load_dwordx2 s[42:43], s[44:45], 60
s_load_dwordx2 s[42:43], s[44:45], 188
s_load_dwordx2 s[42:43], s[44:45], 316
s_load_dwordx2 s[42:43], s[44:45], 444
s_load_dwordx2 s[42:43], s[44:45], 572
s_load_dwordx2 s[42:43], s[44:45], 700
s_load_dwordx2 s[42:43], s[44:45], 828
s_load_dwordx2 s[42:43], s[44:45], 956
s_add_u32 s44, s44, 1024
s_addc_u32 s45, s45, 0
s_sub_u32 s35, s35, 1
s_cmp_eq_u32 s35, 0
s_cbranch_scc0 ft_110
v_lshrrev_b32 v250, 3, v0
v_mul_u32_u24 v250, 16256, v250
v_add_u32 v250, v250, v4
s_add_u32 s35, s66, 131072
buffer_load_dwordx4 v[184:187], v250, s[12:15], s35 offen nt
s_add_u32 s35, s66, 133120
buffer_load_dwordx4 v[188:191], v250, s[12:15], s35 offen nt
s_add_u32 s35, s66, 135168
buffer_load_dwordx4 v[192:195], v250, s[12:15], s35 offen nt
s_add_u32 s35, s66, 137216
buffer_load_dwordx4 v[196:199], v250, s[12:15], s35 offen nt
s_add_u32 s35, s66, 139264
buffer_load_dwordx4 v[200:203], v250, s[12:15], s35 offen nt
s_add_u32 s35, s66, 141312
buffer_load_dwordx4 v[204:207], v250, s[12:15], s35 offen nt
s_add_u32 s35, s66, 143360
buffer_load_dwordx4 v[208:211], v250, s[12:15], s35 offen nt
s_add_u32 s35, s66, 145408
buffer_load_dwordx4 v[212:215], v250, s[12:15], s35 offen nt
v_lshrrev_b32 v250, 3, v0
v_mul_u32_u24 v250, 16256, v250
v_add_u32 v250, v250, v4
s_add_u32 s35, s66, 0
buffer_load_dwordx4 v[152:155], v250, s[12:15], s35 offen nt
s_add_u32 s35, s66, 2048
buffer_load_dwordx4 v[156:159], v250, s[12:15], s35 offen nt
s_add_u32 s35, s66, 4096
buffer_load_dwordx4 v[160:163], v250, s[12:15], s35 offen nt
s_add_u32 s35, s66, 6144
buffer_load_dwordx4 v[164:167], v250, s[12:15], s35 offen nt
s_add_u32 s35, s66, 8192
buffer_load_dwordx4 v[168:171], v250, s[12:15], s35 offen nt
s_add_u32 s35, s66, 10240
buffer_load_dwordx4 v[172:175], v250, s[12:15], s35 offen nt
s_add_u32 s35, s66, 12288
buffer_load_dwordx4 v[176:179], v250, s[12:15], s35 offen nt
s_add_u32 s35, s66, 14336
buffer_load_dwordx4 v[180:183], v250, s[12:15], s35 offen nt
s_add_u32 s35, s34, 10
tw_111:
ds_read_b32 v5, v2 offset:16
s_waitcnt lgkmcnt(0)
v_cmp_gt_i32 vcc, s35, v5
s_cbranch_vccz twd_112
v_readfirstlane_b32 s54, v5
s_sub_u32 s55, s35, s54
s_cmp_lt_i32 s55, 2
s_cbranch_scc1 tws_113
s_add_u32 s54, s54, 2
s_or_b32 s54, s54, 1
s_cmp_eq_u32 s54, s52
s_cbranch_scc1 tws_113
s_bitcmp1_b32 s54, 4
s_cbranch_scc1 tws_113
s_mov_b32 s52, s54
s_add_u32 s54, s54, s53
s_and_b32 s54, s54, 15
s_mul_i32 s54, s54, 393216
s_add_u32 s54, s54, s56
s_buffer_load_dwordx2 s[46:47], s[48:51], s54 offset:4096
s_buffer_load_dwordx2 s[46:47], s[48:51], s54 offset:10240
s_buffer_load_dwordx2 s[46:47], s[48:51], s54 offset:16384
s_buffer_load_dwordx2 s[46:47], s[48:51], s54 offset:22528
tws_113:
s_sleep 4
s_sub_u32 s32, s32, 1
s_cmp_gt_i32 s32, 0
s_cbranch_scc1 tw_111
twd_112:
v_and_b32 v10, 0x7a0, v7
s_getreg_b32 s70, hwreg(HW_REG_XCC_ID)
s_add_u32 s70, s70, 1
poll_114:
buffer_load_dword v12, v10, s[24:27], s76 offen offset:64 sc1
pchk_115:
s_waitcnt vmcnt(0)
v_cmp_eq_u32 vcc, 0, v12
s_cbranch_vccz pdone_116
s_sub_u32 s32, s32, 1
s_cmp_gt_i32 s32, 0
s_cbranch_scc1 poll_114
pdone_116:
v_cmp_eq_u32 vcc, s70, v12
s_cmp_eq_u64 vcc, exec
s_cselect_b32 s70, 1, 0
v_mov_b32 v12, s70
v_mov_b32 v10, 0
s_mov_b64 exec, 1
ds_write_b32 v10, v12 offset:56
s_mov_b64 exec, -1
s_branch fg_48
fnw_58:
s_waitcnt lgkmcnt(0)
v_mov_b32 v252, 0
v_mov_b32 v253, 0
v_mov_b32 v254, 0
v_mov_b32 v255, 0
s_mul_i32 s42, s58, 1409024
s_mul_i32 s35, s78, 2048
s_add_u32 s35, s35, s42
s_add_u32 s35, s35, 524288
buffer_store_dwordx4 v[252:255], v4, s[24:27], s35 offen offset:0 sc1
buffer_store_dwordx4 v[252:255], v4, s[24:27], s35 offen offset:1024 sc1
s_mul_i32 s35, s78, 1408
s_add_u32 s35, s35, s42
s_add_u32 s35, s35, 1048576
buffer_store_dwordx4 v[252:255], v4, s[24:27], s35 offen offset:0 sc1
buffer_store_dwordx4 v[252:255], v4, s[24:27], s35 offen offset:384 sc1
s_lshl_b32 s35, s78, 10
s_add_u32 s35, s35, 1409024
s_cmp_eq_u32 s58, 1
s_cselect_b64 exec, -1, 0
buffer_store_dwordx4 v[252:255], v4, s[24:27], s35 offen offset:0 sc1
s_add_u32 s35, s35, 262144
buffer_store_dwordx4 v[252:255], v4, s[24:27], s35 offen offset:0 sc1
s_mov_b64 exec, -1
s_waitcnt vmcnt(0)
v_add_u32 v5, s34, 3
s_mov_b64 exec, 1
ds_write_b32 v3, v5
s_mov_b64 exec, -1
s_add_u32 s35, s34, 17
tw_117:
ds_read_b32 v5, v2 offset:16
s_waitcnt lgkmcnt(0)
v_cmp_gt_i32 vcc, s35, v5
s_cbranch_vccz twd_118
v_readfirstlane_b32 s54, v5
s_sub_u32 s55, s35, s54
s_cmp_lt_i32 s55, 2
s_cbranch_scc1 tws_119
s_add_u32 s54, s54, 2
s_or_b32 s54, s54, 1
s_cmp_eq_u32 s54, s52
s_cbranch_scc1 tws_119
s_bitcmp1_b32 s54, 4
s_cbranch_scc1 tws_119
s_mov_b32 s52, s54
s_add_u32 s54, s54, s53
s_and_b32 s54, s54, 15
s_mul_i32 s54, s54, 393216
s_add_u32 s54, s54, s56
s_buffer_load_dwordx2 s[46:47], s[48:51], s54 offset:4096
s_buffer_load_dwordx2 s[46:47], s[48:51], s54 offset:10240
s_buffer_load_dwordx2 s[46:47], s[48:51], s54 offset:16384
s_buffer_load_dwordx2 s[46:47], s[48:51], s54 offset:22528
tws_119:
s_sleep 4
s_sub_u32 s32, s32, 1
s_cmp_gt_i32 s32, 0
s_cbranch_scc1 tw_117
twd_118:
v_lshrrev_b32 v250, 4, v0
v_mul_u32_u24 v250, 28416, v250
v_add_u32 v250, v250, v4
s_add_u32 s35, s77, 688128
buffer_load_dwordx4 v[120:123], v250, s[16:19], s35 offen nt
s_add_u32 s35, s77, 695296
buffer_load_dwordx4 v[124:127], v250, s[16:19], s35 offen nt
s_add_u32 s35, s77, 702464
buffer_load_dwordx4 v[128:131], v250, s[16:19], s35 offen nt
s_add_u32 s35, s77, 709632
buffer_load_dwordx4 v[132:135], v250, s[16:19], s35 offen nt
s_add_u32 s35, s77, 802816
buffer_load_dwordx4 v[136:139], v250, s[16:19], s35 offen nt
s_add_u32 s35, s77, 809984
buffer_load_dwordx4 v[140:143], v250, s[16:19], s35 offen nt
s_add_u32 s35, s77, 817152
buffer_load_dwordx4 v[144:147], v250, s[16:19], s35 offen nt
s_add_u32 s35, s77, 824320
buffer_load_dwordx4 v[148:151], v250, s[16:19], s35 offen nt
v_lshrrev_b32 v250, 4, v0
v_mul_u32_u24 v250, 28416, v250
v_add_u32 v250, v250, v4
s_add_u32 s35, s77, 458752
buffer_load_dwordx4 v[88:91], v250, s[16:19], s35 offen nt
s_add_u32 s35, s77, 465920
buffer_load_dwordx4 v[92:95], v250, s[16:19], s35 offen nt
s_add_u32 s35, s77, 473088
buffer_load_dwordx4 v[96:99], v250, s[16:19], s35 offen nt
s_add_u32 s35, s77, 480256
buffer_load_dwordx4 v[100:103], v250, s[16:19], s35 offen nt
s_add_u32 s35, s77, 573440
buffer_load_dwordx4 v[104:107], v250, s[16:19], s35 offen nt
s_add_u32 s35, s77, 580608
buffer_load_dwordx4 v[108:111], v250, s[16:19], s35 offen nt
s_add_u32 s35, s77, 587776
buffer_load_dwordx4 v[112:115], v250, s[16:19], s35 offen nt
s_add_u32 s35, s77, 594944
buffer_load_dwordx4 v[116:119], v250, s[16:19], s35 offen nt
v_lshrrev_b32 v250, 4, v0
v_mul_u32_u24 v250, 28416, v250
v_add_u32 v250, v250, v4
s_add_u32 s35, s77, 229376
buffer_load_dwordx4 v[56:59], v250, s[16:19], s35 offen nt
s_add_u32 s35, s77, 236544
buffer_load_dwordx4 v[60:63], v250, s[16:19], s35 offen nt
s_add_u32 s35, s77, 243712
buffer_load_dwordx4 v[64:67], v250, s[16:19], s35 offen nt
s_add_u32 s35, s77, 250880
buffer_load_dwordx4 v[68:71], v250, s[16:19], s35 offen nt
s_add_u32 s35, s77, 344064
buffer_load_dwordx4 v[72:75], v250, s[16:19], s35 offen nt
s_add_u32 s35, s77, 351232
buffer_load_dwordx4 v[76:79], v250, s[16:19], s35 offen nt
s_add_u32 s35, s77, 358400
buffer_load_dwordx4 v[80:83], v250, s[16:19], s35 offen nt
s_add_u32 s35, s77, 365568
buffer_load_dwordx4 v[84:87], v250, s[16:19], s35 offen nt
v_lshrrev_b32 v250, 4, v0
v_mul_u32_u24 v250, 28416, v250
v_add_u32 v250, v250, v4
s_add_u32 s35, s77, 0
buffer_load_dwordx4 v[24:27], v250, s[16:19], s35 offen nt
s_add_u32 s35, s77, 7168
buffer_load_dwordx4 v[28:31], v250, s[16:19], s35 offen nt
s_add_u32 s35, s77, 14336
buffer_load_dwordx4 v[32:35], v250, s[16:19], s35 offen nt
s_add_u32 s35, s77, 21504
buffer_load_dwordx4 v[36:39], v250, s[16:19], s35 offen nt
s_add_u32 s35, s77, 114688
buffer_load_dwordx4 v[40:43], v250, s[16:19], s35 offen nt
s_add_u32 s35, s77, 121856
buffer_load_dwordx4 v[44:47], v250, s[16:19], s35 offen nt
s_add_u32 s35, s77, 129024
buffer_load_dwordx4 v[48:51], v250, s[16:19], s35 offen nt
s_add_u32 s35, s77, 136192
buffer_load_dwordx4 v[52:55], v250, s[16:19], s35 offen nt
s_waitcnt lgkmcnt(0)
s_mov_b32 s42, 0x05040100
s_mov_b32 s43, 0x07060302
s_cmp_eq_u32 s65, 0
s_cbranch_scc0 fq_120
v_perm_b32 v216, v188, v184, s42
v_perm_b32 v220, v188, v184, s43
v_perm_b32 v224, v189, v185, s42
v_perm_b32 v228, v189, v185, s43
v_perm_b32 v232, v190, v186, s42
v_perm_b32 v236, v190, v186, s43
v_perm_b32 v240, v191, v187, s42
v_perm_b32 v244, v191, v187, s43
v_perm_b32 v217, v196, v192, s42
v_perm_b32 v221, v196, v192, s43
v_perm_b32 v225, v197, v193, s42
v_perm_b32 v229, v197, v193, s43
v_perm_b32 v233, v198, v194, s42
v_perm_b32 v237, v198, v194, s43
v_perm_b32 v241, v199, v195, s42
v_perm_b32 v245, v199, v195, s43
v_perm_b32 v218, v204, v200, s42
v_perm_b32 v222, v204, v200, s43
v_perm_b32 v226, v205, v201, s42
v_perm_b32 v230, v205, v201, s43
v_perm_b32 v234, v206, v202, s42
v_perm_b32 v238, v206, v202, s43
v_perm_b32 v242, v207, v203, s42
v_perm_b32 v246, v207, v203, s43
v_perm_b32 v219, v212, v208, s42
v_perm_b32 v223, v212, v208, s43
v_perm_b32 v227, v213, v209, s42
v_perm_b32 v231, v213, v209, s43
v_perm_b32 v235, v214, v210, s42
v_perm_b32 v239, v214, v210, s43
v_perm_b32 v243, v215, v211, s42
v_perm_b32 v247, v215, v211, s43
v_perm_b32 v184, v156, v152, s42
v_perm_b32 v188, v156, v152, s43
v_perm_b32 v192, v157, v153, s42
v_perm_b32 v196, v157, v153, s43
v_perm_b32 v200, v158, v154, s42
v_perm_b32 v204, v158, v154, s43
v_perm_b32 v208, v159, v155, s42
v_perm_b32 v212, v159, v155, s43
v_perm_b32 v185, v164, v160, s42
v_perm_b32 v189, v164, v160, s43
v_perm_b32 v193, v165, v161, s42
v_perm_b32 v197, v165, v161, s43
v_perm_b32 v201, v166, v162, s42
v_perm_b32 v205, v166, v162, s43
v_perm_b32 v209, v167, v163, s42
v_perm_b32 v213, v167, v163, s43
v_perm_b32 v186, v172, v168, s42
v_perm_b32 v190, v172, v168, s43
v_perm_b32 v194, v173, v169, s42
v_perm_b32 v198, v173, v169, s43
v_perm_b32 v202, v174, v170, s42
v_perm_b32 v206, v174, v170, s43
v_perm_b32 v210, v175, v171, s42
v_perm_b32 v214, v175, v171, s43
v_perm_b32 v187, v180, v176, s42
v_perm_b32 v191, v180, v176, s43
v_perm_b32 v195, v181, v177, s42
v_perm_b32 v199, v181, v177, s43
v_perm_b32 v203, v182, v178, s42
v_perm_b32 v207, v182, v178, s43
v_perm_b32 v211, v183, v179, s42
v_perm_b32 v215, v183, v179, s43
s_waitcnt vmcnt(30)
v_perm_b32 v152, v124, v120, s42
v_perm_b32 v156, v124, v120, s43
v_perm_b32 v160, v125, v121, s42
v_perm_b32 v164, v125, v121, s43
v_perm_b32 v168, v126, v122, s42
v_perm_b32 v172, v126, v122, s43
v_perm_b32 v176, v127, v123, s42
v_perm_b32 v180, v127, v123, s43
s_waitcnt vmcnt(28)
v_perm_b32 v153, v132, v128, s42
v_perm_b32 v157, v132, v128, s43
v_perm_b32 v161, v133, v129, s42
v_perm_b32 v165, v133, v129, s43
v_perm_b32 v169, v134, v130, s42
v_perm_b32 v173, v134, v130, s43
v_perm_b32 v177, v135, v131, s42
v_perm_b32 v181, v135, v131, s43
s_waitcnt vmcnt(26)
v_perm_b32 v154, v140, v136, s42
v_perm_b32 v158, v140, v136, s43
v_perm_b32 v162, v141, v137, s42
v_perm_b32 v166, v141, v137, s43
v_perm_b32 v170, v142, v138, s42
v_perm_b32 v174, v142, v138, s43
v_perm_b32 v178, v143, v139, s42
v_perm_b32 v182, v143, v139, s43
s_waitcnt vmcnt(24)
v_perm_b32 v155, v148, v144, s42
v_perm_b32 v159, v148, v144, s43
v_perm_b32 v163, v149, v145, s42
v_perm_b32 v167, v149, v145, s43
v_perm_b32 v171, v150, v146, s42
v_perm_b32 v175, v150, v146, s43
v_perm_b32 v179, v151, v147, s42
v_perm_b32 v183, v151, v147, s43
s_waitcnt vmcnt(22)
v_perm_b32 v120, v92, v88, s42
v_perm_b32 v124, v92, v88, s43
v_perm_b32 v128, v93, v89, s42
v_perm_b32 v132, v93, v89, s43
v_perm_b32 v136, v94, v90, s42
v_perm_b32 v140, v94, v90, s43
v_perm_b32 v144, v95, v91, s42
v_perm_b32 v148, v95, v91, s43
s_waitcnt vmcnt(20)
v_perm_b32 v121, v100, v96, s42
v_perm_b32 v125, v100, v96, s43
v_perm_b32 v129, v101, v97, s42
v_perm_b32 v133, v101, v97, s43
v_perm_b32 v137, v102, v98, s42
v_perm_b32 v141, v102, v98, s43
v_perm_b32 v145, v103, v99, s42
v_perm_b32 v149, v103, v99, s43
s_waitcnt vmcnt(18)
v_perm_b32 v122, v108, v104, s42
v_perm_b32 v126, v108, v104, s43
v_perm_b32 v130, v109, v105, s42
v_perm_b32 v134, v109, v105, s43
v_perm_b32 v138, v110, v106, s42
v_perm_b32 v142, v110, v106, s43
v_perm_b32 v146, v111, v107, s42
v_perm_b32 v150, v111, v107, s43
s_waitcnt vmcnt(16)
v_perm_b32 v123, v116, v112, s42
v_perm_b32 v127, v116, v112, s43
v_perm_b32 v131, v117, v113, s42
v_perm_b32 v135, v117, v113, s43
v_perm_b32 v139, v118, v114, s42
v_perm_b32 v143, v118, v114, s43
v_perm_b32 v147, v119, v115, s42
v_perm_b32 v151, v119, v115, s43
s_waitcnt vmcnt(14)
v_perm_b32 v88, v60, v56, s42
v_perm_b32 v92, v60, v56, s43
v_perm_b32 v96, v61, v57, s42
v_perm_b32 v100, v61, v57, s43
v_perm_b32 v104, v62, v58, s42
v_perm_b32 v108, v62, v58, s43
v_perm_b32 v112, v63, v59, s42
v_perm_b32 v116, v63, v59, s43
s_waitcnt vmcnt(12)
v_perm_b32 v89, v68, v64, s42
v_perm_b32 v93, v68, v64, s43
v_perm_b32 v97, v69, v65, s42
v_perm_b32 v101, v69, v65, s43
v_perm_b32 v105, v70, v66, s42
v_perm_b32 v109, v70, v66, s43
v_perm_b32 v113, v71, v67, s42
v_perm_b32 v117, v71, v67, s43
s_waitcnt vmcnt(10)
v_perm_b32 v90, v76, v72, s42
v_perm_b32 v94, v76, v72, s43
v_perm_b32 v98, v77, v73, s42
v_perm_b32 v102, v77, v73, s43
v_perm_b32 v106, v78, v74, s42
v_perm_b32 v110, v78, v74, s43
v_perm_b32 v114, v79, v75, s42
v_perm_b32 v118, v79, v75, s43
s_waitcnt vmcnt(8)
v_perm_b32 v91, v84, v80, s42
v_perm_b32 v95, v84, v80, s43
v_perm_b32 v99, v85, v81, s42
v_perm_b32 v103, v85, v81, s43
v_perm_b32 v107, v86, v82, s42
v_perm_b32 v111, v86, v82, s43
v_perm_b32 v115, v87, v83, s42
v_perm_b32 v119, v87, v83, s43
s_waitcnt vmcnt(6)
v_perm_b32 v56, v28, v24, s42
v_perm_b32 v60, v28, v24, s43
v_perm_b32 v64, v29, v25, s42
v_perm_b32 v68, v29, v25, s43
v_perm_b32 v72, v30, v26, s42
v_perm_b32 v76, v30, v26, s43
v_perm_b32 v80, v31, v27, s42
v_perm_b32 v84, v31, v27, s43
s_waitcnt vmcnt(4)
v_perm_b32 v57, v36, v32, s42
v_perm_b32 v61, v36, v32, s43
v_perm_b32 v65, v37, v33, s42
v_perm_b32 v69, v37, v33, s43
v_perm_b32 v73, v38, v34, s42
v_perm_b32 v77, v38, v34, s43
v_perm_b32 v81, v39, v35, s42
v_perm_b32 v85, v39, v35, s43
s_waitcnt vmcnt(2)
v_perm_b32 v58, v44, v40, s42
v_perm_b32 v62, v44, v40, s43
v_perm_b32 v66, v45, v41, s42
v_perm_b32 v70, v45, v41, s43
v_perm_b32 v74, v46, v42, s42
v_perm_b32 v78, v46, v42, s43
v_perm_b32 v82, v47, v43, s42
v_perm_b32 v86, v47, v43, s43
s_waitcnt vmcnt(0)
v_perm_b32 v59, v52, v48, s42
v_perm_b32 v63, v52, v48, s43
v_perm_b32 v67, v53, v49, s42
v_perm_b32 v71, v53, v49, s43
v_perm_b32 v75, v54, v50, s42
v_perm_b32 v79, v54, v50, s43
v_perm_b32 v83, v55, v51, s42
v_perm_b32 v87, v55, v51, s43
fq_120:
s_and_b32 s54, s59, 1
s_lshl_b32 s54, s54, 1
s_sub_u32 s54, s53, s54
s_and_b32 s54, s54, 15
s_mul_i32 s54, s54, 393216
s_add_u32 s54, s54, s56
s_buffer_load_dwordx2 s[46:47], s[48:51], s54 offset:4096
s_buffer_load_dwordx2 s[46:47], s[48:51], s54 offset:10240
s_buffer_load_dwordx2 s[46:47], s[48:51], s54 offset:16384
s_buffer_load_dwordx2 s[46:47], s[48:51], s54 offset:22528
s_buffer_load_dwordx2 s[46:47], s[48:51], s54 offset:2048
s_buffer_load_dwordx2 s[46:47], s[48:51], s54 offset:8192
s_buffer_load_dwordx2 s[46:47], s[48:51], s54 offset:14336
s_buffer_load_dwordx2 s[46:47], s[48:51], s54 offset:20480
s_buffer_load_dwordx2 s[46:47], s[48:51], s54 offset:0
s_buffer_load_dwordx2 s[46:47], s[48:51], s54 offset:6144
s_buffer_load_dwordx2 s[46:47], s[48:51], s54 offset:12288
s_buffer_load_dwordx2 s[46:47], s[48:51], s54 offset:18432
s_add_u32 s54, s53, 1
s_and_b32 s54, s54, 15
s_mul_i32 s54, s54, 393216
s_add_u32 s54, s54, s56
s_buffer_load_dwordx2 s[46:47], s[48:51], s54 offset:4096
s_buffer_load_dwordx2 s[46:47], s[48:51], s54 offset:10240
s_buffer_load_dwordx2 s[46:47], s[48:51], s54 offset:16384
s_buffer_load_dwordx2 s[46:47], s[48:51], s54 offset:22528
s_buffer_load_dwordx2 s[46:47], s[48:51], s54 offset:2048
s_buffer_load_dwordx2 s[46:47], s[48:51], s54 offset:8192
s_buffer_load_dwordx2 s[46:47], s[48:51], s54 offset:14336
s_buffer_load_dwordx2 s[46:47], s[48:51], s54 offset:20480
s_buffer_load_dwordx2 s[46:47], s[48:51], s54 offset:0
s_buffer_load_dwordx2 s[46:47], s[48:51], s54 offset:6144
s_buffer_load_dwordx2 s[46:47], s[48:51], s54 offset:12288
s_buffer_load_dwordx2 s[46:47], s[48:51], s54 offset:18432
s_add_u32 s54, s53, 3
s_and_b32 s54, s54, 15
s_mul_i32 s54, s54, 393216
s_add_u32 s54, s54, s56
s_buffer_load_dwordx2 s[46:47], s[48:51], s54 offset:4096
s_buffer_load_dwordx2 s[46:47], s[48:51], s54 offset:10240
s_buffer_load_dwordx2 s[46:47], s[48:51], s54 offset:16384
s_buffer_load_dwordx2 s[46:47], s[48:51], s54 offset:22528
s_buffer_load_dwordx2 s[46:47], s[48:51], s54 offset:2048
s_buffer_load_dwordx2 s[46:47], s[48:51], s54 offset:8192
s_buffer_load_dwordx2 s[46:47], s[48:51], s54 offset:14336
s_buffer_load_dwordx2 s[46:47], s[48:51], s54 offset:20480
s_buffer_load_dwordx2 s[46:47], s[48:51], s54 offset:0
s_buffer_load_dwordx2 s[46:47], s[48:51], s54 offset:6144
s_buffer_load_dwordx2 s[46:47], s[48:51], s54 offset:12288
s_buffer_load_dwordx2 s[46:47], s[48:51], s54 offset:18432
s_add_u32 s54, s53, 5
s_and_b32 s54, s54, 15
s_mul_i32 s54, s54, 393216
s_add_u32 s54, s54, s56
s_buffer_load_dwordx2 s[46:47], s[48:51], s54 offset:4096
s_buffer_load_dwordx2 s[46:47], s[48:51], s54 offset:10240
s_buffer_load_dwordx2 s[46:47], s[48:51], s54 offset:16384
s_buffer_load_dwordx2 s[46:47], s[48:51], s54 offset:22528
s_buffer_load_dwordx2 s[46:47], s[48:51], s54 offset:2048
s_buffer_load_dwordx2 s[46:47], s[48:51], s54 offset:8192
s_buffer_load_dwordx2 s[46:47], s[48:51], s54 offset:14336
s_buffer_load_dwordx2 s[46:47], s[48:51], s54 offset:20480
s_buffer_load_dwordx2 s[46:47], s[48:51], s54 offset:0
s_buffer_load_dwordx2 s[46:47], s[48:51], s54 offset:6144
s_buffer_load_dwordx2 s[46:47], s[48:51], s54 offset:12288
s_buffer_load_dwordx2 s[46:47], s[48:51], s54 offset:18432
s_add_u32 s54, s53, 7
s_and_b32 s54, s54, 15
s_mul_i32 s54, s54, 393216
s_add_u32 s54, s54, s56
s_buffer_load_dwordx2 s[46:47], s[48:51], s54 offset:4096
s_buffer_load_dwordx2 s[46:47], s[48:51], s54 offset:10240
s_buffer_load_dwordx2 s[46:47], s[48:51], s54 offset:16384
s_buffer_load_dwordx2 s[46:47], s[48:51], s54 offset:22528
s_buffer_load_dwordx2 s[46:47], s[48:51], s54 offset:2048
s_buffer_load_dwordx2 s[46:47], s[48:51], s54 offset:8192
s_buffer_load_dwordx2 s[46:47], s[48:51], s54 offset:14336
s_buffer_load_dwordx2 s[46:47], s[48:51], s54 offset:20480
s_buffer_load_dwordx2 s[46:47], s[48:51], s54 offset:0
s_buffer_load_dwordx2 s[46:47], s[48:51], s54 offset:6144
s_buffer_load_dwordx2 s[46:47], s[48:51], s54 offset:12288
s_buffer_load_dwordx2 s[46:47], s[48:51], s54 offset:18432
s_add_u32 s54, s53, 9
s_and_b32 s54, s54, 15
s_mul_i32 s54, s54, 393216
s_add_u32 s54, s54, s56
s_buffer_load_dwordx2 s[46:47], s[48:51], s54 offset:4096
s_buffer_load_dwordx2 s[46:47], s[48:51], s54 offset:10240
s_buffer_load_dwordx2 s[46:47], s[48:51], s54 offset:16384
s_buffer_load_dwordx2 s[46:47], s[48:51], s54 offset:22528
s_buffer_load_dwordx2 s[46:47], s[48:51], s54 offset:2048
s_buffer_load_dwordx2 s[46:47], s[48:51], s54 offset:8192
s_buffer_load_dwordx2 s[46:47], s[48:51], s54 offset:14336
s_buffer_load_dwordx2 s[46:47], s[48:51], s54 offset:20480
s_buffer_load_dwordx2 s[46:47], s[48:51], s54 offset:0
s_buffer_load_dwordx2 s[46:47], s[48:51], s54 offset:6144
s_buffer_load_dwordx2 s[46:47], s[48:51], s54 offset:12288
s_buffer_load_dwordx2 s[46:47], s[48:51], s54 offset:18432
s_waitcnt lgkmcnt(0)
s_branch fnw_59
fnd_68:
poll_121:
buffer_load_dwordx2 v[248:249], v6, s[24:27], s73 offen sc1
pchk_122:
s_waitcnt vmcnt(0)
v_min_u32 v5, v248, v249
v_cmp_eq_u32 vcc, 0, v5
s_cbranch_vccz pdone_123
s_sleep 1
s_sub_u32 s32, s32, 1
s_cmp_gt_i32 s32, 0
s_cbranch_scc1 poll_121
pdone_123:
v_mov_b32 v250, v248
s_nop 1
v_max_f32_dpp v250, v250, v250 row_ror:1 row_mask:0xf bank_mask:0xf
s_nop 1
v_max_f32_dpp v250, v250, v250 row_ror:2 row_mask:0xf bank_mask:0xf
s_nop 1
v_max_f32_dpp v250, v250, v250 row_ror:4 row_mask:0xf bank_mask:0xf
s_nop 1
v_max_f32_dpp v250, v250, v250 row_ror:8 row_mask:0xf bank_mask:0xf
v_cmp_eq_f32 vcc, v250, v248
s_ff1_i32_b64 s68, vcc
s_and_b32 s68, s68, 15
v_readlane_b32 s33, v249, s68
v_readlane_b32 s67, v248, s68
v_add_u32 v5, s34, 4
v_mov_b32 v250, s33
s_mov_b64 exec, 1
ds_write2_b32 v3, v5, v250 offset1:2
s_mov_b64 exec, -1
s_sub_u32 s33, s33, 1
s_and_b32 s33, s33, 2047
s_branch fnd_67
fpre_90:
poll_124:
buffer_load_dwordx4 v[24:27], v4, s[24:27], s72 offen offset:0 sc1
pchk_125:
s_waitcnt vmcnt(0)
v_min3_u32 v5, v24, v25, v26
v_min_u32 v5, v5, v27
v_cmp_eq_u32 vcc, 0, v5
s_cbranch_vccz pdone_126
s_sleep 8
s_sub_u32 s32, s32, 1
s_cmp_gt_i32 s32, 0
s_cbranch_scc1 poll_124
pdone_126:
s_branch fpre_91
L_m:
s_setprio 2
v_mov_b32 v6, 0
v_mov_b32 v7, 0
v_lshlrev_b32 v8, 3, v0
ds_write_b64 v8, v[6:7]
s_waitcnt lgkmcnt(0)
s_barrier
s_lshr_b32 s64, s58, 1
s_and_b32 s65, s58, 1
v_and_b32 v1, 3, v0
v_lshlrev_b32 v1, 2, v1
v_and_b32 v2, 4, v1
s_lshl2_add_u32 s35, s58, 0
v_mov_b32 v3, s35
s_mov_b32 s4, s44
s_mov_b32 s5, s45
s_mov_b32 s6, 0x800
s_mov_b32 s7, 0x00020000
v_lshrrev_b32 v6, 4, v0
v_lshlrev_b32 v6, 3, v6
s_lshl_b32 s66, s62, 7
buffer_load_dwordx2 v[232:233], v6, s[4:7], s66 offen offset:0
buffer_load_dwordx2 v[234:235], v6, s[4:7], s66 offen offset:32
buffer_load_dwordx2 v[236:237], v6, s[4:7], s66 offen offset:64
buffer_load_dwordx2 v[238:239], v6, s[4:7], s66 offen offset:96
v_and_b32 v6, 31, v0
v_lshrrev_b32 v7, 5, v0
v_lshlrev_b32 v7, 3, v7
v_sub_u32 v6, v6, v7
v_mov_b32 v7, 0xf149f2ca
v_cmp_le_i32 vcc, 0, v6
s_nop 1
v_cndmask_b32 v216, 0, v7, vcc
v_cmp_le_i32 vcc, 1, v6
s_nop 1
v_cndmask_b32 v217, 0, v7, vcc
v_cmp_le_i32 vcc, 2, v6
s_nop 1
v_cndmask_b32 v218, 0, v7, vcc
v_cmp_le_i32 vcc, 3, v6
s_nop 1
v_cndmask_b32 v219, 0, v7, vcc
v_cmp_le_i32 vcc, 16, v6
s_nop 1
v_cndmask_b32 v220, 0, v7, vcc
v_cmp_le_i32 vcc, 17, v6
s_nop 1
v_cndmask_b32 v221, 0, v7, vcc
v_cmp_le_i32 vcc, 18, v6
s_nop 1
v_cndmask_b32 v222, 0, v7, vcc
v_cmp_le_i32 vcc, 19, v6
s_nop 1
v_cndmask_b32 v223, 0, v7, vcc
v_cmp_le_i32 vcc, 4, v6
s_nop 1
v_cndmask_b32 v224, 0, v7, vcc
v_cmp_le_i32 vcc, 5, v6
s_nop 1
v_cndmask_b32 v225, 0, v7, vcc
v_cmp_le_i32 vcc, 6, v6
s_nop 1
v_cndmask_b32 v226, 0, v7, vcc
v_cmp_le_i32 vcc, 7, v6
s_nop 1
v_cndmask_b32 v227, 0, v7, vcc
v_cmp_le_i32 vcc, 20, v6
s_nop 1
v_cndmask_b32 v228, 0, v7, vcc
v_cmp_le_i32 vcc, 21, v6
s_nop 1
v_cndmask_b32 v229, 0, v7, vcc
v_cmp_le_i32 vcc, 22, v6
s_nop 1
v_cndmask_b32 v230, 0, v7, vcc
v_cmp_le_i32 vcc, 23, v6
s_nop 1
v_cndmask_b32 v231, 0, v7, vcc
v_lshrrev_b32 v6, 2, v0
v_xor_b32 v6, v6, v0
v_and_b32 v6, 4, v6
v_mov_b32 v7, 0x3f803f80
v_cmp_eq_u32 vcc, 0, v6
s_nop 1
v_cndmask_b32 v212, 0, v7, vcc
v_cndmask_b32 v213, 0, v7, vcc
v_cndmask_b32 v214, 0, v7, vcc
v_cndmask_b32 v215, 0, v7, vcc
v_lshrrev_b32 v196, 4, v0
s_cmp_eq_u32 0, 0
s_cbranch_scc0 mq_127
v_bfe_u32 v197, v0, 1, 3
v_xor_b32 v197, v197, v196
v_lshlrev_b32 v197, 4, v197
v_and_b32 v198, 15, v0
v_lshl_add_u32 v192, v198, 7, v197
v_xor_b32 v193, 64, v192
s_branch mq_128
mq_127:
v_lshlrev_b32 v192, 4, v0
v_add_u32 v193, 1024, v192
mq_128:
s_lshl_b32 s46, s65, 13
s_add_u32 s46, s46, 86016
v_add_u32 v192, s46, v192
v_add_u32 v193, s46, v193
v_bfe_u32 v197, v0, 2, 2
v_lshl_add_u32 v197, v196, 3, v197
v_bfe_u32 v198, v0, 3, 2
s_lshl_b32 s46, s64, 1
v_xor_b32 v198, s46, v198
v_lshlrev_b32 v198, 5, v198
v_lshl_add_u32 v197, v197, 7, v198
v_and_b32 v198, 3, v0
v_lshl_add_u32 v197, v198, 3, v197
v_add_u32 v194, 102400, v197
v_xor_b32 v195, 32, v194
v_mov_b32 v197, 0xf149f2ca
v_xor_b32 v216, v197, v216
v_xor_b32 v217, v197, v217
v_xor_b32 v218, v197, v218
v_xor_b32 v219, v197, v219
v_xor_b32 v220, v197, v220
v_xor_b32 v221, v197, v221
v_xor_b32 v222, v197, v222
v_xor_b32 v223, v197, v223
v_xor_b32 v224, v197, v224
v_xor_b32 v225, v197, v225
v_xor_b32 v226, v197, v226
v_xor_b32 v227, v197, v227
v_xor_b32 v228, v197, v228
v_xor_b32 v229, v197, v229
v_xor_b32 v230, v197, v230
v_xor_b32 v231, v197, v231
v_and_b32 v196, 15, v0
v_lshrrev_b32 v197, 4, v0
s_lshl_b32 s46, s65, 8
s_add_u32 s46, s46, 1280
s_mul_i32 s47, s64, 384
v_lshl_add_u32 v208, v196, 2, s46
v_lshl_add_u32 v209, v197, 4, s46
v_lshl_add_u32 v210, v196, 2, s47
v_lshl_add_u32 v211, v197, 4, s47
v_and_b32 v198, 1, v197
v_lshrrev_b32 v197, 1, v197
v_lshlrev_b32 v197, 9, v197
v_lshl_add_u32 v197, v198, 10, v197
s_lshl_b32 s46, s64, 12
s_lshl_b32 s47, s65, 13
s_add_u32 s46, s46, 131072
s_add_u32 s48, s46, 24576
s_sub_u32 s48, s48, s47
s_add_u32 s47, s46, s47
v_lshl_add_u32 v200, v196, 4, v197
v_and_b32 v198, 3, v0
v_lshl_add_u32 v197, v198, 4, v197
v_bfe_u32 v198, v0, 3, 1
v_lshl_add_u32 v197, v198, 6, v197
v_bfe_u32 v198, v0, 2, 1
v_lshl_add_u32 v198, v198, 8, v197
v_add_u32 v199, s48, v198
v_add_u32 v198, s47, v198
v_add_u32 v201, s48, v200
v_add_u32 v200, s47, v200
s_lshl_b32 s46, s59, 4
s_add_u32 s46, s46, s60
s_lshl_b32 s50, s59, 7
s_add_u32 s50, s50, s60
s_lshl_b32 s50, s50, 7
s_lshl_b32 s46, s46, 15
s_lshl_b32 s47, 0, 23
s_add_u32 s46, s46, s47
s_add_u32 s49, s46, 917504
L_mtop:
v_mov_b32 v6, v192
v_mov_b32 v7, v193
v_mov_b32 v8, v194
v_mov_b32 v9, v195
v_mov_b32 v12, v198
v_mov_b32 v13, v199
v_mov_b32 v14, v200
v_mov_b32 v15, v201
s_mov_b32 s71, s49
s_mov_b32 s72, s50
v_add_u32 v4, s34, 1
s_mov_b32 s66, 14
s_mov_b32 s67, -40960
s_mov_b32 s68, -40960
s_mov_b32 s69, 81920
s_add_u32 s35, s34, 1
lw_129:
ds_read_b32 v5, v2 offset:16
s_waitcnt lgkmcnt(0)
v_cmp_gt_i32 vcc, s35, v5
s_cbranch_vccz lwd_130
s_sub_u32 s32, s32, 1
s_cmp_gt_i32 s32, 0
s_cbranch_scc1 lw_129
lwd_130:
ds_read_b64_tr_b16 v[144:145], v8 offset:8192
ds_read_b64_tr_b16 v[146:147], v8 offset:8704
ds_read_b64_tr_b16 v[148:149], v8 offset:12288
ds_read_b64_tr_b16 v[150:151], v8 offset:12800
ds_read_b128 v[112:115], v6 offset:0
ds_read_b128 v[116:119], v7 offset:0
ds_read_b64_tr_b16 v[152:153], v9 offset:8192
ds_read_b64_tr_b16 v[154:155], v9 offset:8704
ds_read_b64_tr_b16 v[156:157], v9 offset:12288
ds_read_b64_tr_b16 v[158:159], v9 offset:12800
ds_read_b128 v[120:123], v6 offset:2048
ds_read_b128 v[124:127], v7 offset:2048
ds_read_b128 v[128:131], v6 offset:4096
ds_read_b128 v[132:135], v7 offset:4096
ds_read_b128 v[136:139], v6 offset:6144
ds_read_b128 v[140:143], v7 offset:6144
s_waitcnt lgkmcnt(11)
v_mfma_f32_16x16x32_bf16 v[16:19], v[144:147], v[112:115], 0
ds_read_b64_tr_b16 v[160:161], v8 offset:16384
s_waitcnt lgkmcnt(11)
v_mfma_f32_16x16x32_bf16 v[16:19], v[148:151], v[116:119], v[16:19]
ds_read_b64_tr_b16 v[162:163], v8 offset:16896
s_waitcnt lgkmcnt(10)
v_mfma_f32_16x16x32_bf16 v[20:23], v[152:155], v[112:115], 0
ds_read_b64_tr_b16 v[164:165], v8 offset:20480
s_waitcnt lgkmcnt(9)
v_mfma_f32_16x16x32_bf16 v[20:23], v[156:159], v[116:119], v[20:23]
ds_read_b64_tr_b16 v[166:167], v8 offset:20992
s_waitcnt lgkmcnt(9)
v_mfma_f32_16x16x32_bf16 v[24:27], v[144:147], v[120:123], 0
ds_read_b64_tr_b16 v[168:169], v9 offset:16384
s_waitcnt lgkmcnt(9)
v_mfma_f32_16x16x32_bf16 v[24:27], v[148:151], v[124:127], v[24:27]
ds_read_b64_tr_b16 v[170:171], v9 offset:16896
v_mfma_f32_16x16x32_bf16 v[28:31], v[152:155], v[120:123], 0
ds_read_b64_tr_b16 v[172:173], v9 offset:20480
v_mfma_f32_16x16x32_bf16 v[28:31], v[156:159], v[124:127], v[28:31]
ds_read_b64_tr_b16 v[174:175], v9 offset:20992
s_waitcnt lgkmcnt(11)
v_mfma_f32_16x16x32_bf16 v[32:35], v[144:147], v[128:131], 0
ds_read_b64_tr_b16 v[176:177], v8 offset:0
s_waitcnt lgkmcnt(11)
v_mfma_f32_16x16x32_bf16 v[32:35], v[148:151], v[132:135], v[32:35]
ds_read_b64_tr_b16 v[178:179], v8 offset:512
v_mfma_f32_16x16x32_bf16 v[36:39], v[152:155], v[128:131], 0
ds_read_b64_tr_b16 v[180:181], v8 offset:4096
v_mfma_f32_16x16x32_bf16 v[36:39], v[156:159], v[132:135], v[36:39]
ds_read_b64_tr_b16 v[182:183], v8 offset:4608
s_waitcnt lgkmcnt(13)
v_mfma_f32_16x16x32_bf16 v[40:43], v[144:147], v[136:139], 0
ds_read_b64_tr_b16 v[184:185], v9 offset:0
s_waitcnt lgkmcnt(13)
v_mfma_f32_16x16x32_bf16 v[40:43], v[148:151], v[140:143], v[40:43]
ds_read_b64_tr_b16 v[186:187], v9 offset:512
v_mfma_f32_16x16x32_bf16 v[44:47], v[152:155], v[136:139], 0
ds_read_b64_tr_b16 v[188:189], v9 offset:4096
v_mfma_f32_16x16x32_bf16 v[44:47], v[156:159], v[140:143], v[44:47]
ds_read_b64_tr_b16 v[190:191], v9 offset:4608
s_waitcnt lgkmcnt(14)
v_mfma_f32_16x16x32_bf16 v[48:51], v[112:115], v[160:163], 0
s_mov_b64 exec, 1
ds_write_b32 v3, v4
s_mov_b64 exec, -1
s_waitcnt lgkmcnt(13)
v_mfma_f32_16x16x32_bf16 v[48:51], v[116:119], v[164:167], v[48:51]
v_add_u32 v8, s67, v8
v_add_u32 v9, s67, v9
s_waitcnt lgkmcnt(11)
v_mfma_f32_16x16x32_bf16 v[52:55], v[112:115], v[168:171], 0
v_add_u32 v6, s67, v6
v_add_u32 v7, s67, v7
s_waitcnt lgkmcnt(9)
v_mfma_f32_16x16x32_bf16 v[52:55], v[116:119], v[172:175], v[52:55]
s_mov_b32 s70, s67
s_mov_b32 s67, s68
s_mov_b32 s68, s69
s_mov_b32 s69, s70
v_mfma_f32_16x16x32_bf16 v[56:59], v[120:123], v[160:163], 0
ds_read_b32 v5, v2 offset:16
v_mfma_f32_16x16x32_bf16 v[56:59], v[124:127], v[164:167], v[56:59]
v_mfma_f32_16x16x32_bf16 v[60:63], v[120:123], v[168:171], 0
v_mfma_f32_16x16x32_bf16 v[60:63], v[124:127], v[172:175], v[60:63]
v_mfma_f32_16x16x32_bf16 v[64:67], v[128:131], v[160:163], 0
s_waitcnt lgkmcnt(0)
v_cmp_ge_u32 vcc, v4, v5
s_cbranch_vccnz mspin_134
mback_135:
v_add_u32 v4, 1, v4
v_mfma_f32_16x16x32_bf16 v[64:67], v[132:135], v[164:167], v[64:67]
ds_read_b64_tr_b16 v[144:145], v8 offset:8192
v_mfma_f32_16x16x32_bf16 v[68:71], v[128:131], v[168:171], 0
ds_read_b64_tr_b16 v[146:147], v8 offset:8704
v_mfma_f32_16x16x32_bf16 v[68:71], v[132:135], v[172:175], v[68:71]
ds_read_b64_tr_b16 v[148:149], v8 offset:12288
v_mfma_f32_16x16x32_bf16 v[72:75], v[136:139], v[160:163], 0
ds_read_b64_tr_b16 v[150:151], v8 offset:12800
v_mfma_f32_16x16x32_bf16 v[72:75], v[140:143], v[164:167], v[72:75]
ds_read_b64_tr_b16 v[152:153], v9 offset:8192
v_mfma_f32_16x16x32_bf16 v[76:79], v[136:139], v[168:171], 0
ds_read_b64_tr_b16 v[154:155], v9 offset:8704
v_mfma_f32_16x16x32_bf16 v[76:79], v[140:143], v[172:175], v[76:79]
ds_read_b64_tr_b16 v[156:157], v9 offset:12288
v_mfma_f32_16x16x32_bf16 v[80:83], v[176:179], v[112:115], 0
ds_read_b64_tr_b16 v[158:159], v9 offset:12800
v_mfma_f32_16x16x32_bf16 v[80:83], v[180:183], v[116:119], v[80:83]
v_mfma_f32_16x16x32_bf16 v[84:87], v[184:187], v[112:115], 0
v_mfma_f32_16x16x32_bf16 v[84:87], v[188:191], v[116:119], v[84:87]
ds_read_b128 v[112:115], v6 offset:0
ds_read_b128 v[116:119], v7 offset:0
v_mfma_f32_16x16x32_bf16 v[88:91], v[176:179], v[120:123], 0
v_mfma_f32_16x16x32_bf16 v[88:91], v[180:183], v[124:127], v[88:91]
v_mfma_f32_16x16x32_bf16 v[92:95], v[184:187], v[120:123], 0
v_mfma_f32_16x16x32_bf16 v[92:95], v[188:191], v[124:127], v[92:95]
ds_read_b128 v[120:123], v6 offset:2048
ds_read_b128 v[124:127], v7 offset:2048
v_mfma_f32_16x16x32_bf16 v[96:99], v[176:179], v[128:131], 0
v_mfma_f32_16x16x32_bf16 v[96:99], v[180:183], v[132:135], v[96:99]
v_mfma_f32_16x16x32_bf16 v[100:103], v[184:187], v[128:131], 0
v_mfma_f32_16x16x32_bf16 v[100:103], v[188:191], v[132:135], v[100:103]
ds_read_b128 v[128:131], v6 offset:4096
ds_read_b128 v[132:135], v7 offset:4096
v_mfma_f32_16x16x32_bf16 v[104:107], v[176:179], v[136:139], 0
v_mfma_f32_16x16x32_bf16 v[104:107], v[180:183], v[140:143], v[104:107]
v_mfma_f32_16x16x32_bf16 v[108:111], v[184:187], v[136:139], 0
v_mfma_f32_16x16x32_bf16 v[108:111], v[188:191], v[140:143], v[108:111]
ds_read_b128 v[136:139], v6 offset:6144
ds_read_b128 v[140:143], v7 offset:6144
.p2align 6
mqkv_131:
s_waitcnt lgkmcnt(7)
v_mfma_f32_16x16x32_bf16 v[16:19], v[144:147], v[112:115], v[16:19]
ds_read_b64_tr_b16 v[160:161], v8 offset:16384
s_waitcnt lgkmcnt(7)
v_mfma_f32_16x16x32_bf16 v[16:19], v[148:151], v[116:119], v[16:19]
ds_read_b64_tr_b16 v[162:163], v8 offset:16896
v_mfma_f32_16x16x32_bf16 v[20:23], v[152:155], v[112:115], v[20:23]
ds_read_b64_tr_b16 v[164:165], v8 offset:20480
v_mfma_f32_16x16x32_bf16 v[20:23], v[156:159], v[116:119], v[20:23]
ds_read_b64_tr_b16 v[166:167], v8 offset:20992
s_waitcnt lgkmcnt(9)
v_mfma_f32_16x16x32_bf16 v[24:27], v[144:147], v[120:123], v[24:27]
ds_read_b64_tr_b16 v[168:169], v9 offset:16384
s_waitcnt lgkmcnt(9)
v_mfma_f32_16x16x32_bf16 v[24:27], v[148:151], v[124:127], v[24:27]
ds_read_b64_tr_b16 v[170:171], v9 offset:16896
v_mfma_f32_16x16x32_bf16 v[28:31], v[152:155], v[120:123], v[28:31]
ds_read_b64_tr_b16 v[172:173], v9 offset:20480
v_mfma_f32_16x16x32_bf16 v[28:31], v[156:159], v[124:127], v[28:31]
ds_read_b64_tr_b16 v[174:175], v9 offset:20992
s_waitcnt lgkmcnt(11)
v_mfma_f32_16x16x32_bf16 v[32:35], v[144:147], v[128:131], v[32:35]
ds_read_b64_tr_b16 v[176:177], v8 offset:0
s_waitcnt lgkmcnt(11)
v_mfma_f32_16x16x32_bf16 v[32:35], v[148:151], v[132:135], v[32:35]
ds_read_b64_tr_b16 v[178:179], v8 offset:512
v_mfma_f32_16x16x32_bf16 v[36:39], v[152:155], v[128:131], v[36:39]
ds_read_b64_tr_b16 v[180:181], v8 offset:4096
v_mfma_f32_16x16x32_bf16 v[36:39], v[156:159], v[132:135], v[36:39]
ds_read_b64_tr_b16 v[182:183], v8 offset:4608
s_waitcnt lgkmcnt(13)
v_mfma_f32_16x16x32_bf16 v[40:43], v[144:147], v[136:139], v[40:43]
ds_read_b64_tr_b16 v[184:185], v9 offset:0
s_waitcnt lgkmcnt(13)
v_mfma_f32_16x16x32_bf16 v[40:43], v[148:151], v[140:143], v[40:43]
ds_read_b64_tr_b16 v[186:187], v9 offset:512
v_mfma_f32_16x16x32_bf16 v[44:47], v[152:155], v[136:139], v[44:47]
ds_read_b64_tr_b16 v[188:189], v9 offset:4096
v_mfma_f32_16x16x32_bf16 v[44:47], v[156:159], v[140:143], v[44:47]
ds_read_b64_tr_b16 v[190:191], v9 offset:4608
s_waitcnt lgkmcnt(14)
v_mfma_f32_16x16x32_bf16 v[48:51], v[112:115], v[160:163], v[48:51]
s_mov_b64 exec, 1
ds_write_b32 v3, v4
s_mov_b64 exec, -1
s_waitcnt lgkmcnt(13)
v_mfma_f32_16x16x32_bf16 v[48:51], v[116:119], v[164:167], v[48:51]
v_add_u32 v8, s67, v8
v_add_u32 v9, s67, v9
s_waitcnt lgkmcnt(11)
v_mfma_f32_16x16x32_bf16 v[52:55], v[112:115], v[168:171], v[52:55]
v_add_u32 v6, s67, v6
v_add_u32 v7, s67, v7
s_waitcnt lgkmcnt(9)
v_mfma_f32_16x16x32_bf16 v[52:55], v[116:119], v[172:175], v[52:55]
s_mov_b32 s70, s67
s_mov_b32 s67, s68
s_mov_b32 s68, s69
s_mov_b32 s69, s70
v_mfma_f32_16x16x32_bf16 v[56:59], v[120:123], v[160:163], v[56:59]
ds_read_b32 v5, v2 offset:16
v_mfma_f32_16x16x32_bf16 v[56:59], v[124:127], v[164:167], v[56:59]
v_mfma_f32_16x16x32_bf16 v[60:63], v[120:123], v[168:171], v[60:63]
v_mfma_f32_16x16x32_bf16 v[60:63], v[124:127], v[172:175], v[60:63]
v_mfma_f32_16x16x32_bf16 v[64:67], v[128:131], v[160:163], v[64:67]
s_waitcnt lgkmcnt(0)
v_cmp_ge_u32 vcc, v4, v5
s_cbranch_vccnz mspin_132
mback_133:
v_add_u32 v4, 1, v4
v_mfma_f32_16x16x32_bf16 v[64:67], v[132:135], v[164:167], v[64:67]
ds_read_b64_tr_b16 v[144:145], v8 offset:8192
v_mfma_f32_16x16x32_bf16 v[68:71], v[128:131], v[168:171], v[68:71]
ds_read_b64_tr_b16 v[146:147], v8 offset:8704
v_mfma_f32_16x16x32_bf16 v[68:71], v[132:135], v[172:175], v[68:71]
ds_read_b64_tr_b16 v[148:149], v8 offset:12288
v_mfma_f32_16x16x32_bf16 v[72:75], v[136:139], v[160:163], v[72:75]
ds_read_b64_tr_b16 v[150:151], v8 offset:12800
v_mfma_f32_16x16x32_bf16 v[72:75], v[140:143], v[164:167], v[72:75]
ds_read_b64_tr_b16 v[152:153], v9 offset:8192
v_mfma_f32_16x16x32_bf16 v[76:79], v[136:139], v[168:171], v[76:79]
ds_read_b64_tr_b16 v[154:155], v9 offset:8704
v_mfma_f32_16x16x32_bf16 v[76:79], v[140:143], v[172:175], v[76:79]
ds_read_b64_tr_b16 v[156:157], v9 offset:12288
v_mfma_f32_16x16x32_bf16 v[80:83], v[176:179], v[112:115], v[80:83]
ds_read_b64_tr_b16 v[158:159], v9 offset:12800
v_mfma_f32_16x16x32_bf16 v[80:83], v[180:183], v[116:119], v[80:83]
v_mfma_f32_16x16x32_bf16 v[84:87], v[184:187], v[112:115], v[84:87]
v_mfma_f32_16x16x32_bf16 v[84:87], v[188:191], v[116:119], v[84:87]
ds_read_b128 v[112:115], v6 offset:0
ds_read_b128 v[116:119], v7 offset:0
v_mfma_f32_16x16x32_bf16 v[88:91], v[176:179], v[120:123], v[88:91]
v_mfma_f32_16x16x32_bf16 v[88:91], v[180:183], v[124:127], v[88:91]
v_mfma_f32_16x16x32_bf16 v[92:95], v[184:187], v[120:123], v[92:95]
v_mfma_f32_16x16x32_bf16 v[92:95], v[188:191], v[124:127], v[92:95]
ds_read_b128 v[120:123], v6 offset:2048
ds_read_b128 v[124:127], v7 offset:2048
v_mfma_f32_16x16x32_bf16 v[96:99], v[176:179], v[128:131], v[96:99]
v_mfma_f32_16x16x32_bf16 v[96:99], v[180:183], v[132:135], v[96:99]
v_mfma_f32_16x16x32_bf16 v[100:103], v[184:187], v[128:131], v[100:103]
v_mfma_f32_16x16x32_bf16 v[100:103], v[188:191], v[132:135], v[100:103]
ds_read_b128 v[128:131], v6 offset:4096
ds_read_b128 v[132:135], v7 offset:4096
v_mfma_f32_16x16x32_bf16 v[104:107], v[176:179], v[136:139], v[104:107]
v_mfma_f32_16x16x32_bf16 v[104:107], v[180:183], v[140:143], v[104:107]
s_sub_u32 s66, s66, 1
s_cmp_eq_u32 s66, 0
v_mfma_f32_16x16x32_bf16 v[108:111], v[184:187], v[136:139], v[108:111]
v_mfma_f32_16x16x32_bf16 v[108:111], v[188:191], v[140:143], v[108:111]
ds_read_b128 v[136:139], v6 offset:6144
ds_read_b128 v[140:143], v7 offset:6144
s_cbranch_scc0 mqkv_131
s_waitcnt lgkmcnt(7)
v_mfma_f32_16x16x32_bf16 v[16:19], v[144:147], v[112:115], v[16:19]
ds_read_b32 v5, v2 offset:24
s_add_u32 s35, s34, 2
v_mov_b32 v6, 0
ds_read_b64_tr_b16 v[160:161], v8 offset:16384
s_waitcnt lgkmcnt(8)
v_mfma_f32_16x16x32_bf16 v[16:19], v[148:151], v[116:119], v[16:19]
ds_read_b64_tr_b16 v[162:163], v8 offset:16896
v_mfma_f32_16x16x32_bf16 v[20:23], v[152:155], v[112:115], v[20:23]
ds_read_b64_tr_b16 v[164:165], v8 offset:20480
v_mfma_f32_16x16x32_bf16 v[20:23], v[156:159], v[116:119], v[20:23]
ds_read_b64_tr_b16 v[166:167], v8 offset:20992
s_waitcnt lgkmcnt(10)
v_mfma_f32_16x16x32_bf16 v[24:27], v[144:147], v[120:123], v[24:27]
ds_read_b64_tr_b16 v[168:169], v9 offset:16384
s_waitcnt lgkmcnt(10)
v_mfma_f32_16x16x32_bf16 v[24:27], v[148:151], v[124:127], v[24:27]
ds_read_b64_tr_b16 v[170:171], v9 offset:16896
v_mfma_f32_16x16x32_bf16 v[28:31], v[152:155], v[120:123], v[28:31]
ds_read_b64_tr_b16 v[172:173], v9 offset:20480
s_waitcnt lgkmcnt(7)
v_cmp_gt_i32 vcc, s35, v5
s_cbranch_vccnz lspin_136
lback_137:
ds_read2_b32 v[6:7], v6 offset0:8 offset1:14
ds_read_b128 v[200:203], v211 offset:2432
v_mfma_f32_16x16x32_bf16 v[28:31], v[156:159], v[124:127], v[28:31]
ds_read_b64_tr_b16 v[174:175], v9 offset:20992
ds_read_b128 v[204:207], v211 offset:2496
ds_read2_b32 v[192:193], v208 offset0:0 offset1:128
v_mfma_f32_16x16x32_bf16 v[32:35], v[144:147], v[128:131], v[32:35]
ds_read2_b32 v[194:195], v208 offset0:16 offset1:144
v_mfma_f32_16x16x32_bf16 v[32:35], v[148:151], v[132:135], v[32:35]
ds_read2_b32 v[196:197], v208 offset0:32 offset1:160
ds_read2_b32 v[198:199], v208 offset0:48 offset1:176
v_mfma_f32_16x16x32_bf16 v[36:39], v[152:155], v[128:131], v[36:39]
ds_read_b64_tr_b16 v[176:177], v8 offset:0
ds_read_b64_tr_b16 v[178:179], v8 offset:512
v_mfma_f32_16x16x32_bf16 v[36:39], v[156:159], v[132:135], v[36:39]
ds_read_b64_tr_b16 v[180:181], v8 offset:4096
v_mfma_f32_16x16x32_bf16 v[40:43], v[144:147], v[136:139], v[40:43]
ds_read_b64_tr_b16 v[182:183], v8 offset:4608
ds_read_b64_tr_b16 v[184:185], v9 offset:0
v_mfma_f32_16x16x32_bf16 v[40:43], v[148:151], v[140:143], v[40:43]
ds_read_b64_tr_b16 v[186:187], v9 offset:512
ds_read_b64_tr_b16 v[188:189], v9 offset:4096
v_mfma_f32_16x16x32_bf16 v[44:47], v[152:155], v[136:139], v[44:47]
ds_read_b64_tr_b16 v[190:191], v9 offset:4608
v_mfma_f32_16x16x32_bf16 v[44:47], v[156:159], v[140:143], v[44:47]
s_mov_b64 exec, 1
ds_write_b32 v3, v4
s_mov_b64 exec, -1
s_waitcnt lgkmcnt(14)
v_readfirstlane_b32 s33, v6
v_readfirstlane_b32 s57, v7
s_sub_u32 s33, s33, 1
s_lshr_b32 s66, s33, 7
s_mov_b32 s73, -1
v_mfma_f32_16x16x32_bf16 v[48:51], v[112:115], v[160:163], v[48:51]
s_cmp_eq_u32 s66, s59
s_cbranch_scc1 patch_138
pback_139:
v_mfma_f32_16x16x32_bf16 v[48:51], v[116:119], v[164:167], v[48:51]
ds_read_b32 v10, v210 offset:2560
ds_read_b32 v11, v210 offset:2624
s_waitcnt lgkmcnt(14)
v_mul_f32 v16, v16, v192
v_mul_f32 v17, v17, v192
v_mul_f32 v18, v18, v192
v_mfma_f32_16x16x32_bf16 v[52:55], v[112:115], v[168:171], v[52:55]
v_mul_f32 v19, v19, v192
v_mul_f32 v20, v20, v192
v_mul_f32 v21, v21, v192
v_mul_f32 v22, v22, v192
v_mul_f32 v23, v23, v192
v_mfma_f32_16x16x32_bf16 v[52:55], v[116:119], v[172:175], v[52:55]
v_fmac_f32 v16, v200, v193
v_fmac_f32 v17, v201, v193
v_fmac_f32 v18, v202, v193
v_fmac_f32 v19, v203, v193
v_fmac_f32 v20, v204, v193
v_mfma_f32_16x16x32_bf16 v[56:59], v[120:123], v[160:163], v[56:59]
v_fmac_f32 v21, v205, v193
v_fmac_f32 v22, v206, v193
v_fmac_f32 v23, v207, v193
v_cvt_pk_bf16_f32 v16, v16, v17
v_cvt_pk_bf16_f32 v17, v18, v19
v_mfma_f32_16x16x32_bf16 v[56:59], v[124:127], v[164:167], v[56:59]
v_cvt_pk_bf16_f32 v18, v20, v21
v_cvt_pk_bf16_f32 v19, v22, v23
buffer_store_dwordx4 v[16:19], v12, s[20:23], s71 offen offset:0 sc1
ds_write_b128 v12, v[16:19] offset:0
ds_read_b128 v[144:147], v209 offset:0
v_mfma_f32_16x16x32_bf16 v[60:63], v[120:123], v[168:171], v[60:63]
ds_read_b128 v[20:23], v209 offset:512
s_waitcnt lgkmcnt(14)
v_mul_f32 v24, v24, v194
v_mul_f32 v25, v25, v194
v_mul_f32 v26, v26, v194
v_mul_f32 v27, v27, v194
v_mfma_f32_16x16x32_bf16 v[60:63], v[124:127], v[172:175], v[60:63]
v_mul_f32 v28, v28, v194
v_mul_f32 v29, v29, v194
v_mul_f32 v30, v30, v194
v_mul_f32 v31, v31, v194
v_fmac_f32 v24, v200, v195
v_mfma_f32_16x16x32_bf16 v[64:67], v[128:131], v[160:163], v[64:67]
v_fmac_f32 v25, v201, v195
v_fmac_f32 v26, v202, v195
v_fmac_f32 v27, v203, v195
v_fmac_f32 v28, v204, v195
v_mfma_f32_16x16x32_bf16 v[64:67], v[132:135], v[164:167], v[64:67]
v_fmac_f32 v29, v205, v195
v_fmac_f32 v30, v206, v195
v_fmac_f32 v31, v207, v195
v_cvt_pk_bf16_f32 v24, v24, v25
v_cvt_pk_bf16_f32 v25, v26, v27
v_mfma_f32_16x16x32_bf16 v[68:71], v[128:131], v[168:171], v[68:71]
v_cvt_pk_bf16_f32 v26, v28, v29
v_cvt_pk_bf16_f32 v27, v30, v31
buffer_store_dwordx4 v[24:27], v12, s[20:23], s71 offen offset:128 sc1
ds_write_b128 v12, v[24:27] offset:128
ds_read_b128 v[148:151], v209 offset:64
v_mfma_f32_16x16x32_bf16 v[68:71], v[132:135], v[172:175], v[68:71]
ds_read_b128 v[28:31], v209 offset:576
v_mul_f32 v32, v32, v196
v_mul_f32 v33, v33, v196
v_mul_f32 v34, v34, v196
v_mul_f32 v35, v35, v196
v_mfma_f32_16x16x32_bf16 v[72:75], v[136:139], v[160:163], v[72:75]
v_mul_f32 v36, v36, v196
v_mul_f32 v37, v37, v196
v_mul_f32 v38, v38, v196
v_mul_f32 v39, v39, v196
v_fmac_f32 v32, v200, v197
v_mfma_f32_16x16x32_bf16 v[72:75], v[140:143], v[164:167], v[72:75]
v_fmac_f32 v33, v201, v197
v_fmac_f32 v34, v202, v197
v_fmac_f32 v35, v203, v197
v_fmac_f32 v36, v204, v197
v_fmac_f32 v37, v205, v197
v_mfma_f32_16x16x32_bf16 v[76:79], v[136:139], v[168:171], v[76:79]
v_fmac_f32 v38, v206, v197
v_fmac_f32 v39, v207, v197
v_cvt_pk_bf16_f32 v32, v32, v33
v_cvt_pk_bf16_f32 v33, v34, v35
v_cvt_pk_bf16_f32 v34, v36, v37
v_mfma_f32_16x16x32_bf16 v[76:79], v[140:143], v[172:175], v[76:79]
v_cvt_pk_bf16_f32 v35, v38, v39
buffer_store_dwordx4 v[32:35], v13, s[20:23], s71 offen offset:0 sc1
ds_write_b128 v13, v[32:35] offset:0
ds_read_b128 v[152:155], v209 offset:128
ds_read_b128 v[36:39], v209 offset:640
v_mul_f32 v40, v40, v198
v_mul_f32 v41, v41, v198
v_mul_f32 v42, v42, v198
v_mul_f32 v43, v43, v198
v_mul_f32 v44, v44, v198
v_mul_f32 v45, v45, v198
v_mul_f32 v46, v46, v198
v_mul_f32 v47, v47, v198
v_fmac_f32 v40, v200, v199
v_fmac_f32 v41, v201, v199
v_fmac_f32 v42, v202, v199
v_fmac_f32 v43, v203, v199
v_fmac_f32 v44, v204, v199
v_fmac_f32 v45, v205, v199
v_fmac_f32 v46, v206, v199
v_fmac_f32 v47, v207, v199
v_cvt_pk_bf16_f32 v40, v40, v41
v_cvt_pk_bf16_f32 v41, v42, v43
v_cvt_pk_bf16_f32 v42, v44, v45
v_cvt_pk_bf16_f32 v43, v46, v47
buffer_store_dwordx4 v[40:43], v13, s[20:23], s71 offen offset:128 sc1
ds_write_b128 v13, v[40:43] offset:128
ds_read_b128 v[156:159], v209 offset:192
ds_read_b128 v[44:47], v209 offset:704
s_cmp_ge_i32 s73, 0
s_cbranch_scc1 patch_140
pback_141:
ds_read_b128 v[160:163], v211 offset:2304
ds_read_b128 v[164:167], v211 offset:2368
s_waitcnt lgkmcnt(12)
v_pk_mul_f32 v[48:49], v[48:49], v[144:145]
v_pk_mul_f32 v[50:51], v[50:51], v[146:147]
s_waitcnt lgkmcnt(11)
v_pk_fma_f32 v[48:49], v[20:21], v[10:11], v[48:49] op_sel:[0,0,0] op_sel_hi:[1,0,1]
v_pk_fma_f32 v[50:51], v[22:23], v[10:11], v[50:51] op_sel:[0,0,0] op_sel_hi:[1,0,1]
s_waitcnt lgkmcnt(9)
v_pk_mul_f32 v[56:57], v[56:57], v[148:149]
v_pk_mul_f32 v[58:59], v[58:59], v[150:151]
s_waitcnt lgkmcnt(8)
v_pk_fma_f32 v[56:57], v[28:29], v[10:11], v[56:57] op_sel:[0,0,0] op_sel_hi:[1,0,1]
v_pk_fma_f32 v[58:59], v[30:31], v[10:11], v[58:59] op_sel:[0,0,0] op_sel_hi:[1,0,1]
v_cvt_pk_bf16_f32 v48, v48, v49
v_cvt_pk_bf16_f32 v49, v50, v51
v_cvt_pk_bf16_f32 v50, v56, v57
v_cvt_pk_bf16_f32 v51, v58, v59
buffer_store_dwordx4 v[48:51], v14, s[20:23], s71 offen offset:2048 sc1
ds_write_b128 v14, v[48:51] offset:2048
v_pk_mul_f32 v[52:53], v[52:53], v[144:145]
v_pk_mul_f32 v[54:55], v[54:55], v[146:147]
v_pk_fma_f32 v[52:53], v[20:21], v[10:11], v[52:53] op_sel:[0,1,0] op_sel_hi:[1,1,1]
v_pk_fma_f32 v[54:55], v[22:23], v[10:11], v[54:55] op_sel:[0,1,0] op_sel_hi:[1,1,1]
v_pk_mul_f32 v[60:61], v[60:61], v[148:149]
v_pk_mul_f32 v[62:63], v[62:63], v[150:151]
v_pk_fma_f32 v[60:61], v[28:29], v[10:11], v[60:61] op_sel:[0,1,0] op_sel_hi:[1,1,1]
v_pk_fma_f32 v[62:63], v[30:31], v[10:11], v[62:63] op_sel:[0,1,0] op_sel_hi:[1,1,1]
v_cvt_pk_bf16_f32 v52, v52, v53
v_cvt_pk_bf16_f32 v53, v54, v55
v_cvt_pk_bf16_f32 v54, v60, v61
v_cvt_pk_bf16_f32 v55, v62, v63
buffer_store_dwordx4 v[52:55], v14, s[20:23], s71 offen offset:2304 sc1
ds_write_b128 v14, v[52:55] offset:2304
s_waitcnt lgkmcnt(8)
v_pk_mul_f32 v[64:65], v[64:65], v[152:153]
v_pk_mul_f32 v[66:67], v[66:67], v[154:155]
s_waitcnt lgkmcnt(7)
v_pk_fma_f32 v[64:65], v[36:37], v[10:11], v[64:65] op_sel:[0,0,0] op_sel_hi:[1,0,1]
v_pk_fma_f32 v[66:67], v[38:39], v[10:11], v[66:67] op_sel:[0,0,0] op_sel_hi:[1,0,1]
s_waitcnt lgkmcnt(5)
v_pk_mul_f32 v[72:73], v[72:73], v[156:157]
v_pk_mul_f32 v[74:75], v[74:75], v[158:159]
s_waitcnt lgkmcnt(4)
v_pk_fma_f32 v[72:73], v[44:45], v[10:11], v[72:73] op_sel:[0,0,0] op_sel_hi:[1,0,1]
v_pk_fma_f32 v[74:75], v[46:47], v[10:11], v[74:75] op_sel:[0,0,0] op_sel_hi:[1,0,1]
v_cvt_pk_bf16_f32 v64, v64, v65
v_cvt_pk_bf16_f32 v65, v66, v67
v_cvt_pk_bf16_f32 v66, v72, v73
v_cvt_pk_bf16_f32 v67, v74, v75
buffer_store_dwordx4 v[64:67], v15, s[20:23], s71 offen offset:2048 sc1
ds_write_b128 v15, v[64:67] offset:2048
v_pk_mul_f32 v[68:69], v[68:69], v[152:153]
v_pk_mul_f32 v[70:71], v[70:71], v[154:155]
v_pk_fma_f32 v[68:69], v[36:37], v[10:11], v[68:69] op_sel:[0,1,0] op_sel_hi:[1,1,1]
v_pk_fma_f32 v[70:71], v[38:39], v[10:11], v[70:71] op_sel:[0,1,0] op_sel_hi:[1,1,1]
v_pk_mul_f32 v[76:77], v[76:77], v[156:157]
v_pk_mul_f32 v[78:79], v[78:79], v[158:159]
v_pk_fma_f32 v[76:77], v[44:45], v[10:11], v[76:77] op_sel:[0,1,0] op_sel_hi:[1,1,1]
v_pk_fma_f32 v[78:79], v[46:47], v[10:11], v[78:79] op_sel:[0,1,0] op_sel_hi:[1,1,1]
v_cvt_pk_bf16_f32 v68, v68, v69
v_cvt_pk_bf16_f32 v69, v70, v71
v_cvt_pk_bf16_f32 v70, v76, v77
v_cvt_pk_bf16_f32 v71, v78, v79
buffer_store_dwordx4 v[68:71], v15, s[20:23], s71 offen offset:2304 sc1
ds_write_b128 v15, v[68:71] offset:2304
v_add_u32 v5, s34, 17
s_mov_b64 exec, 1
ds_write_b32 v3, v5
s_mov_b64 exec, -1
s_mov_b32 s66, 0x3e8293ee
v_mfma_f32_16x16x32_bf16 v[96:99], v[176:179], v[128:131], v[96:99]
v_mul_f32 v192, s66, v192
v_mfma_f32_16x16x32_bf16 v[96:99], v[180:183], v[132:135], v[96:99]
v_mfma_f32_16x16x32_bf16 v[100:103], v[184:187], v[128:131], v[100:103]
v_mul_f32 v193, s66, v193
v_mfma_f32_16x16x32_bf16 v[100:103], v[188:191], v[132:135], v[100:103]
v_mfma_f32_16x16x32_bf16 v[104:107], v[176:179], v[136:139], v[104:107]
v_mul_f32 v194, s66, v194
v_mfma_f32_16x16x32_bf16 v[104:107], v[180:183], v[140:143], v[104:107]
v_mfma_f32_16x16x32_bf16 v[108:111], v[184:187], v[136:139], v[108:111]
v_mul_f32 v195, s66, v195
v_mfma_f32_16x16x32_bf16 v[108:111], v[188:191], v[140:143], v[108:111]
v_mfma_f32_16x16x32_bf16 v[80:83], v[176:179], v[112:115], v[80:83]
v_mul_f32 v196, s66, v196
v_mfma_f32_16x16x32_bf16 v[80:83], v[180:183], v[116:119], v[80:83]
v_mfma_f32_16x16x32_bf16 v[84:87], v[184:187], v[112:115], v[84:87]
v_mul_f32 v197, s66, v197
v_mfma_f32_16x16x32_bf16 v[84:87], v[188:191], v[116:119], v[84:87]
v_mfma_f32_16x16x32_bf16 v[88:91], v[176:179], v[120:123], v[88:91]
v_mul_f32 v198, s66, v198
v_mfma_f32_16x16x32_bf16 v[88:91], v[180:183], v[124:127], v[88:91]
v_mfma_f32_16x16x32_bf16 v[92:95], v[184:187], v[120:123], v[92:95]
v_mul_f32 v199, s66, v199
v_mfma_f32_16x16x32_bf16 v[92:95], v[188:191], v[124:127], v[92:95]
s_cmp_ge_i32 s73, 0
s_cbranch_scc1 patch_142
pback_143:
v_mov_b32 v200, 0
v_mov_b32 v201, 0
v_mov_b32 v202, 0
v_mov_b32 v203, 0
v_mov_b32 v204, 0
v_mov_b32 v205, 0
v_mov_b32 v206, 0
v_mov_b32 v207, 0
v_mov_b32 v208, 0
v_mov_b32 v209, 0
v_mov_b32 v210, 0
v_mov_b32 v211, 0
v_pk_mul_f32 v[96:97], v[96:97], v[196:197] op_sel:[0,0] op_sel_hi:[1,0]
v_pk_mul_f32 v[98:99], v[98:99], v[196:197] op_sel:[0,0] op_sel_hi:[1,0]
v_pk_mul_f32 v[100:101], v[100:101], v[196:197] op_sel:[0,0] op_sel_hi:[1,0]
v_pk_mul_f32 v[102:103], v[102:103], v[196:197] op_sel:[0,0] op_sel_hi:[1,0]
s_waitcnt lgkmcnt(6)
v_pk_fma_f32 v[96:97], v[160:161], v[196:197], v[96:97] op_sel:[0,1,0] op_sel_hi:[1,1,1]
v_pk_fma_f32 v[98:99], v[162:163], v[196:197], v[98:99] op_sel:[0,1,0] op_sel_hi:[1,1,1]
s_waitcnt lgkmcnt(5)
v_pk_fma_f32 v[100:101], v[164:165], v[196:197], v[100:101] op_sel:[0,1,0] op_sel_hi:[1,1,1]
v_pk_fma_f32 v[102:103], v[166:167], v[196:197], v[102:103] op_sel:[0,1,0] op_sel_hi:[1,1,1]
v_cvt_pk_bf16_f32 v96, v96, v97
v_cvt_pk_bf16_f32 v97, v98, v99
v_cvt_pk_bf16_f32 v98, v100, v101
v_cvt_pk_bf16_f32 v99, v102, v103
v_pk_mul_f32 v[104:105], v[104:105], v[198:199] op_sel:[0,0] op_sel_hi:[1,0]
v_pk_mul_f32 v[106:107], v[106:107], v[198:199] op_sel:[0,0] op_sel_hi:[1,0]
v_pk_mul_f32 v[108:109], v[108:109], v[198:199] op_sel:[0,0] op_sel_hi:[1,0]
v_pk_mul_f32 v[110:111], v[110:111], v[198:199] op_sel:[0,0] op_sel_hi:[1,0]
v_pk_fma_f32 v[104:105], v[160:161], v[198:199], v[104:105] op_sel:[0,1,0] op_sel_hi:[1,1,1]
v_pk_fma_f32 v[106:107], v[162:163], v[198:199], v[106:107] op_sel:[0,1,0] op_sel_hi:[1,1,1]
v_pk_fma_f32 v[108:109], v[164:165], v[198:199], v[108:109] op_sel:[0,1,0] op_sel_hi:[1,1,1]
v_pk_fma_f32 v[110:111], v[166:167], v[198:199], v[110:111] op_sel:[0,1,0] op_sel_hi:[1,1,1]
v_cvt_pk_bf16_f32 v104, v104, v105
v_cvt_pk_bf16_f32 v105, v106, v107
v_cvt_pk_bf16_f32 v106, v108, v109
v_cvt_pk_bf16_f32 v107, v110, v111
v_pk_mul_f32 v[80:81], v[80:81], v[192:193] op_sel:[0,0] op_sel_hi:[1,0]
v_pk_mul_f32 v[82:83], v[82:83], v[192:193] op_sel:[0,0] op_sel_hi:[1,0]
v_pk_mul_f32 v[84:85], v[84:85], v[192:193] op_sel:[0,0] op_sel_hi:[1,0]
v_pk_mul_f32 v[86:87], v[86:87], v[192:193] op_sel:[0,0] op_sel_hi:[1,0]
v_pk_fma_f32 v[80:81], v[160:161], v[192:193], v[80:81] op_sel:[0,1,0] op_sel_hi:[1,1,1]
v_pk_fma_f32 v[82:83], v[162:163], v[192:193], v[82:83] op_sel:[0,1,0] op_sel_hi:[1,1,1]
v_pk_fma_f32 v[84:85], v[164:165], v[192:193], v[84:85] op_sel:[0,1,0] op_sel_hi:[1,1,1]
v_pk_fma_f32 v[86:87], v[166:167], v[192:193], v[86:87] op_sel:[0,1,0] op_sel_hi:[1,1,1]
v_cvt_pk_bf16_f32 v80, v80, v81
v_cvt_pk_bf16_f32 v81, v82, v83
v_cvt_pk_bf16_f32 v82, v84, v85
v_cvt_pk_bf16_f32 v83, v86, v87
v_pk_mul_f32 v[88:89], v[88:89], v[194:195] op_sel:[0,0] op_sel_hi:[1,0]
v_pk_mul_f32 v[90:91], v[90:91], v[194:195] op_sel:[0,0] op_sel_hi:[1,0]
v_pk_mul_f32 v[92:93], v[92:93], v[194:195] op_sel:[0,0] op_sel_hi:[1,0]
v_pk_mul_f32 v[94:95], v[94:95], v[194:195] op_sel:[0,0] op_sel_hi:[1,0]
v_pk_fma_f32 v[88:89], v[160:161], v[194:195], v[88:89] op_sel:[0,1,0] op_sel_hi:[1,1,1]
v_pk_fma_f32 v[90:91], v[162:163], v[194:195], v[90:91] op_sel:[0,1,0] op_sel_hi:[1,1,1]
v_pk_fma_f32 v[92:93], v[164:165], v[194:195], v[92:93] op_sel:[0,1,0] op_sel_hi:[1,1,1]
v_pk_fma_f32 v[94:95], v[166:167], v[194:195], v[94:95] op_sel:[0,1,0] op_sel_hi:[1,1,1]
v_cvt_pk_bf16_f32 v88, v88, v89
v_cvt_pk_bf16_f32 v89, v90, v91
v_cvt_pk_bf16_f32 v90, v92, v93
v_cvt_pk_bf16_f32 v91, v94, v95
v_permlane16_swap_b32 v96, v104
v_permlane16_swap_b32 v97, v105
v_permlane16_swap_b32 v98, v106
v_permlane16_swap_b32 v99, v107
v_permlane16_swap_b32 v80, v88
v_permlane16_swap_b32 v81, v89
v_permlane16_swap_b32 v82, v90
v_permlane16_swap_b32 v83, v91
v_mov_b32 v192, 0
v_mov_b32 v193, 0
v_mov_b32 v194, 0
v_mov_b32 v195, 0
v_mov_b32 v196, 0
v_mov_b32 v197, 0
v_mov_b32 v198, 0
v_mov_b32 v199, 0
s_lshl_b32 s69, s64, 12
v_lshl_add_u32 v6, v0, 4, s69
v_add_u32 v7, 131072, v6
s_lshl_b32 s69, s65, 13
s_add_u32 s66, s69, 131072
s_sub_u32 s69, 147456, s69
v_add_u32 v8, s69, v6
ds_read_b128 v[152:155], v8 offset:8192
ds_read_b128 v[156:159], v8 offset:9216
s_mov_b32 s67, 122880
s_min_u32 s69, s59, 1
s_lshl2_add_u32 s68, s69, s65
s_cmp_ge_u32 s59, 2
s_cselect_b32 s69, s65, 0
s_add_u32 s68, s68, s69
ds_read_b128 v[160:163], v8 offset:10240
ds_read_b128 v[164:167], v8 offset:11264
s_waitcnt lgkmcnt(3)
v_mfma_f32_32x32x16_bf16 v[112:127], v[152:155], v[96:99], v[216:231]
s_waitcnt lgkmcnt(2)
v_mfma_f32_32x32x16_bf16 v[112:127], v[156:159], v[104:107], v[112:127]
s_add_u32 s35, s34, 17
lw_144:
ds_read_b32 v5, v1 offset:0
s_waitcnt lgkmcnt(0)
v_cmp_gt_i32 vcc, s35, v5
s_cbranch_vccz lwd_145
s_sub_u32 s32, s32, 1
s_cmp_gt_i32 s32, 0
s_cbranch_scc1 lw_144
lwd_145:
ds_read_b128 v[152:155], v8 offset:0
ds_read_b128 v[156:159], v8 offset:1024
s_add_u32 s70, s72, 270336
s_mov_b64 exec, 1
s_waitcnt vmcnt(0)
buffer_store_dword v7, v3, s[24:27], s70 offen sc1
s_mov_b64 exec, -1
.p2align 3
v_exp_f32 v112, v112
v_exp_f32 v113, v113
v_exp_f32 v114, v114
v_exp_f32 v115, v115
v_exp_f32 v116, v116
v_exp_f32 v117, v117
s_waitcnt lgkmcnt(1)
v_mfma_f32_32x32x16_bf16 v[128:143], v[152:155], v[96:99], 0
v_exp_f32 v118, v118
v_exp_f32 v119, v119
v_cvt_pk_bf16_f32 v144, v112, v113
v_cvt_pk_bf16_f32 v145, v114, v115
s_waitcnt lgkmcnt(0)
v_mfma_f32_32x32x16_bf16 v[128:143], v[156:159], v[104:107], v[128:143]
ds_read_b128 v[152:155], v7 offset:8192
ds_read_b128 v[156:159], v7 offset:9216
v_cvt_pk_bf16_f32 v146, v116, v117
v_cvt_pk_bf16_f32 v147, v118, v119
v_exp_f32 v120, v120
v_exp_f32 v121, v121
v_mfma_f32_32x32x16_bf16 v[16:31], v[160:163], v[144:147], 0
ds_read_b128 v[160:163], v8 offset:2048
v_exp_f32 v122, v122
v_exp_f32 v123, v123
v_exp_f32 v124, v124
v_mfma_f32_16x16x32_bf16 v[32:35], v[212:215], v[144:147], 0
s_cmp_eq_u32 s65, 1
v_exp_f32 v125, v125
v_exp_f32 v126, v126
v_exp_f32 v127, v127
v_cvt_pk_bf16_f32 v148, v120, v121
v_cvt_pk_bf16_f32 v149, v122, v123
v_cvt_pk_bf16_f32 v150, v124, v125
v_cvt_pk_bf16_f32 v151, v126, v127
s_cbranch_scc1 at_146
v_exp_f32 v128, v128
v_exp_f32 v129, v129
v_mfma_f32_32x32x16_bf16 v[16:31], v[164:167], v[148:151], v[16:31]
ds_read_b128 v[164:167], v8 offset:3072
v_exp_f32 v130, v130
v_exp_f32 v131, v131
v_exp_f32 v132, v132
v_mfma_f32_16x16x32_bf16 v[32:35], v[212:215], v[148:151], v[32:35]
v_exp_f32 v133, v133
s_waitcnt lgkmcnt(3)
v_mfma_f32_32x32x16_bf16 v[112:127], v[152:155], v[96:99], 0
v_exp_f32 v134, v134
v_exp_f32 v135, v135
v_cvt_pk_bf16_f32 v144, v128, v129
v_cvt_pk_bf16_f32 v145, v130, v131
s_waitcnt lgkmcnt(2)
v_mfma_f32_32x32x16_bf16 v[112:127], v[156:159], v[104:107], v[112:127]
ds_read_b128 v[152:155], v7 offset:0
ds_read_b128 v[156:159], v7 offset:1024
v_cvt_pk_bf16_f32 v146, v132, v133
v_cvt_pk_bf16_f32 v147, v134, v135
v_exp_f32 v136, v136
v_exp_f32 v137, v137
s_waitcnt lgkmcnt(3)
v_mfma_f32_32x32x16_bf16 v[16:31], v[160:163], v[144:147], v[16:31]
ds_read_b128 v[160:163], v7 offset:10240
v_exp_f32 v138, v138
v_exp_f32 v139, v139
v_exp_f32 v140, v140
v_mfma_f32_16x16x32_bf16 v[32:35], v[212:215], v[144:147], v[32:35]
v_exp_f32 v141, v141
v_exp_f32 v142, v142
v_exp_f32 v143, v143
v_cvt_pk_bf16_f32 v148, v136, v137
v_cvt_pk_bf16_f32 v149, v138, v139
v_cvt_pk_bf16_f32 v150, v140, v141
v_cvt_pk_bf16_f32 v151, v142, v143
v_exp_f32 v112, v112
v_exp_f32 v113, v113
s_waitcnt lgkmcnt(3)
v_mfma_f32_32x32x16_bf16 v[16:31], v[164:167], v[148:151], v[16:31]
ds_read_b128 v[164:167], v7 offset:11264
v_exp_f32 v114, v114
v_exp_f32 v115, v115
v_exp_f32 v116, v116
v_mfma_f32_16x16x32_bf16 v[32:35], v[212:215], v[148:151], v[32:35]
v_exp_f32 v117, v117
s_waitcnt lgkmcnt(3)
v_mfma_f32_32x32x16_bf16 v[128:143], v[152:155], v[96:99], 0
v_exp_f32 v118, v118
v_exp_f32 v119, v119
v_cvt_pk_bf16_f32 v144, v112, v113
v_cvt_pk_bf16_f32 v145, v114, v115
s_waitcnt lgkmcnt(2)
v_mfma_f32_32x32x16_bf16 v[128:143], v[156:159], v[104:107], v[128:143]
v_cvt_pk_bf16_f32 v146, v116, v117
v_cvt_pk_bf16_f32 v147, v118, v119
v_exp_f32 v120, v120
v_exp_f32 v121, v121
s_waitcnt lgkmcnt(1)
v_mfma_f32_32x32x16_bf16 v[16:31], v[160:163], v[144:147], v[16:31]
ds_read_b128 v[160:163], v7 offset:2048
v_exp_f32 v122, v122
v_exp_f32 v123, v123
v_exp_f32 v124, v124
v_mfma_f32_16x16x32_bf16 v[32:35], v[212:215], v[144:147], v[32:35]
v_mov_b32 v8, v7
v_exp_f32 v125, v125
v_exp_f32 v126, v126
v_exp_f32 v127, v127
v_cvt_pk_bf16_f32 v148, v120, v121
v_cvt_pk_bf16_f32 v149, v122, v123
v_cvt_pk_bf16_f32 v150, v124, v125
v_cvt_pk_bf16_f32 v151, v126, v127
.p2align 3
at_146:
v_exp_f32 v128, v128
v_exp_f32 v129, v129
s_waitcnt lgkmcnt(1)
v_mfma_f32_32x32x16_bf16 v[16:31], v[164:167], v[148:151], v[16:31]
ds_read_b128 v[164:167], v8 offset:3072
v_exp_f32 v130, v130
v_exp_f32 v131, v131
v_exp_f32 v132, v132
v_mfma_f32_16x16x32_bf16 v[32:35], v[212:215], v[148:151], v[32:35]
v_exp_f32 v133, v133
v_mfma_f32_32x32x16_bf16 v[112:127], v[152:155], v[80:83], v[216:231]
v_exp_f32 v134, v134
v_exp_f32 v135, v135
v_cvt_pk_bf16_f32 v144, v128, v129
v_cvt_pk_bf16_f32 v145, v130, v131
v_mfma_f32_32x32x16_bf16 v[112:127], v[156:159], v[88:91], v[112:127]
s_sub_u32 s66, s66, 8192
s_cmp_eq_u32 s66, s67
s_cbranch_scc1 cross_153
cback_154:
v_add_u32 v8, s66, v6
ds_read_b128 v[152:155], v8 offset:0
ds_read_b128 v[156:159], v8 offset:1024
v_cvt_pk_bf16_f32 v146, v132, v133
v_cvt_pk_bf16_f32 v147, v134, v135
v_exp_f32 v136, v136
v_exp_f32 v137, v137
s_waitcnt lgkmcnt(3)
v_mfma_f32_32x32x16_bf16 v[16:31], v[160:163], v[144:147], v[16:31]
v_exp_f32 v138, v138
v_exp_f32 v139, v139
v_exp_f32 v140, v140
v_mfma_f32_16x16x32_bf16 v[32:35], v[212:215], v[144:147], v[32:35]
s_cmp_eq_u32 s68, 0
v_exp_f32 v141, v141
v_exp_f32 v142, v142
v_exp_f32 v143, v143
v_cvt_pk_bf16_f32 v148, v136, v137
v_cvt_pk_bf16_f32 v149, v138, v139
v_cvt_pk_bf16_f32 v150, v140, v141
v_cvt_pk_bf16_f32 v151, v142, v143
s_cbranch_scc1 at_150
.p2align 3
at_147:
v_exp_f32 v112, v112
v_exp_f32 v113, v113
s_waitcnt lgkmcnt(2)
v_mfma_f32_32x32x16_bf16 v[16:31], v[164:167], v[148:151], v[16:31]
v_exp_f32 v114, v114
v_exp_f32 v115, v115
v_exp_f32 v116, v116
v_mfma_f32_16x16x32_bf16 v[32:35], v[212:215], v[148:151], v[32:35]
v_exp_f32 v117, v117
s_waitcnt lgkmcnt(1)
v_mfma_f32_32x32x16_bf16 v[128:143], v[152:155], v[96:99], 0
v_exp_f32 v118, v118
v_exp_f32 v119, v119
v_cvt_pk_bf16_f32 v144, v112, v113
v_cvt_pk_bf16_f32 v145, v114, v115
s_waitcnt lgkmcnt(0)
v_mfma_f32_32x32x16_bf16 v[128:143], v[156:159], v[104:107], v[128:143]
v_cvt_pk_bf16_f32 v146, v116, v117
v_cvt_pk_bf16_f32 v147, v118, v119
v_exp_f32 v120, v120
v_exp_f32 v121, v121
v_mfma_f32_32x32x16_bf16 v[192:207], v[160:163], v[144:147], v[192:207]
ds_read_b128 v[160:163], v8 offset:2048
v_exp_f32 v122, v122
v_exp_f32 v123, v123
v_exp_f32 v124, v124
v_mfma_f32_16x16x32_bf16 v[208:211], v[212:215], v[144:147], v[208:211]
ds_read_b32 v5, v2 offset:16
s_add_u32 s35, s34, 21
v_exp_f32 v125, v125
v_exp_f32 v126, v126
v_exp_f32 v127, v127
v_cvt_pk_bf16_f32 v148, v120, v121
v_cvt_pk_bf16_f32 v149, v122, v123
v_cvt_pk_bf16_f32 v150, v124, v125
v_cvt_pk_bf16_f32 v151, v126, v127
v_exp_f32 v128, v128
v_exp_f32 v129, v129
v_mfma_f32_32x32x16_bf16 v[192:207], v[164:167], v[148:151], v[192:207]
ds_read_b128 v[164:167], v8 offset:3072
v_exp_f32 v130, v130
v_exp_f32 v131, v131
v_exp_f32 v132, v132
v_mfma_f32_16x16x32_bf16 v[208:211], v[212:215], v[148:151], v[208:211]
v_exp_f32 v133, v133
v_mfma_f32_32x32x16_bf16 v[112:127], v[152:155], v[80:83], 0
v_exp_f32 v134, v134
v_exp_f32 v135, v135
v_cvt_pk_bf16_f32 v144, v128, v129
v_cvt_pk_bf16_f32 v145, v130, v131
v_mfma_f32_32x32x16_bf16 v[112:127], v[156:159], v[88:91], v[112:127]
s_sub_u32 s66, s66, 8192
s_cmp_eq_u32 s66, s67
s_cbranch_scc1 cross_155
cback_156:
v_add_u32 v8, s66, v6
ds_read_b128 v[152:155], v8 offset:0
ds_read_b128 v[156:159], v8 offset:1024
v_cvt_pk_bf16_f32 v146, v132, v133
v_cvt_pk_bf16_f32 v147, v134, v135
v_exp_f32 v136, v136
v_exp_f32 v137, v137
s_waitcnt lgkmcnt(4)
v_mfma_f32_32x32x16_bf16 v[16:31], v[160:163], v[144:147], v[16:31]
v_exp_f32 v138, v138
v_exp_f32 v139, v139
v_exp_f32 v140, v140
v_mfma_f32_16x16x32_bf16 v[32:35], v[212:215], v[144:147], v[32:35]
s_sub_u32 s68, s68, 1
s_cmp_eq_u32 s68, 0
v_exp_f32 v141, v141
v_exp_f32 v142, v142
v_exp_f32 v143, v143
v_cvt_pk_bf16_f32 v148, v136, v137
v_cvt_pk_bf16_f32 v149, v138, v139
v_cvt_pk_bf16_f32 v150, v140, v141
v_cvt_pk_bf16_f32 v151, v142, v143
s_cbranch_scc0 at_147
s_cmp_lt_u32 s59, 2
s_cbranch_scc1 at_150
.p2align 3
v_exp_f32 v112, v112
v_exp_f32 v113, v113
s_waitcnt lgkmcnt(2)
v_mfma_f32_32x32x16_bf16 v[16:31], v[164:167], v[148:151], v[16:31]
v_exp_f32 v114, v114
v_exp_f32 v115, v115
v_exp_f32 v116, v116
v_mfma_f32_16x16x32_bf16 v[32:35], v[212:215], v[148:151], v[32:35]
v_exp_f32 v117, v117
s_waitcnt lgkmcnt(1)
v_mfma_f32_32x32x16_bf16 v[128:143], v[152:155], v[96:99], v[216:231]
v_exp_f32 v118, v118
v_exp_f32 v119, v119
v_cvt_pk_bf16_f32 v144, v112, v113
v_cvt_pk_bf16_f32 v145, v114, v115
s_waitcnt lgkmcnt(0)
v_mfma_f32_32x32x16_bf16 v[128:143], v[156:159], v[104:107], v[128:143]
v_cvt_pk_bf16_f32 v146, v116, v117
v_cvt_pk_bf16_f32 v147, v118, v119
v_exp_f32 v120, v120
v_exp_f32 v121, v121
v_mfma_f32_32x32x16_bf16 v[192:207], v[160:163], v[144:147], v[192:207]
ds_read_b128 v[160:163], v8 offset:2048
v_exp_f32 v122, v122
v_exp_f32 v123, v123
v_exp_f32 v124, v124
v_mfma_f32_16x16x32_bf16 v[208:211], v[212:215], v[144:147], v[208:211]
v_exp_f32 v125, v125
v_exp_f32 v126, v126
v_exp_f32 v127, v127
v_cvt_pk_bf16_f32 v148, v120, v121
v_cvt_pk_bf16_f32 v149, v122, v123
v_cvt_pk_bf16_f32 v150, v124, v125
v_cvt_pk_bf16_f32 v151, v126, v127
v_exp_f32 v128, v128
v_exp_f32 v129, v129
v_mfma_f32_32x32x16_bf16 v[192:207], v[164:167], v[148:151], v[192:207]
ds_read_b128 v[164:167], v8 offset:3072
v_exp_f32 v130, v130
v_exp_f32 v131, v131
v_exp_f32 v132, v132
v_mfma_f32_16x16x32_bf16 v[208:211], v[212:215], v[148:151], v[208:211]
v_exp_f32 v133, v133
v_mfma_f32_32x32x16_bf16 v[112:127], v[152:155], v[80:83], 0
v_exp_f32 v134, v134
v_exp_f32 v135, v135
v_cvt_pk_bf16_f32 v144, v128, v129
v_cvt_pk_bf16_f32 v145, v130, v131
v_mfma_f32_32x32x16_bf16 v[112:127], v[156:159], v[88:91], v[112:127]
v_subrev_u32 v8, 8192, v8
ds_read_b128 v[152:155], v8 offset:0
ds_read_b128 v[156:159], v8 offset:1024
v_cvt_pk_bf16_f32 v146, v132, v133
v_cvt_pk_bf16_f32 v147, v134, v135
v_exp_f32 v136, v136
v_exp_f32 v137, v137
s_waitcnt lgkmcnt(3)
v_mfma_f32_32x32x16_bf16 v[16:31], v[160:163], v[144:147], v[16:31]
v_exp_f32 v138, v138
v_exp_f32 v139, v139
v_exp_f32 v140, v140
v_mfma_f32_16x16x32_bf16 v[32:35], v[212:215], v[144:147], v[32:35]
s_cmp_eq_u32 s65, 1
v_exp_f32 v141, v141
v_exp_f32 v142, v142
v_exp_f32 v143, v143
v_cvt_pk_bf16_f32 v148, v136, v137
v_cvt_pk_bf16_f32 v149, v138, v139
v_cvt_pk_bf16_f32 v150, v140, v141
v_cvt_pk_bf16_f32 v151, v142, v143
s_cbranch_scc1 at_149
.p2align 3
v_exp_f32 v112, v112
v_exp_f32 v113, v113
s_waitcnt lgkmcnt(2)
v_mfma_f32_32x32x16_bf16 v[16:31], v[164:167], v[148:151], v[16:31]
v_exp_f32 v114, v114
v_exp_f32 v115, v115
v_exp_f32 v116, v116
v_mfma_f32_16x16x32_bf16 v[32:35], v[212:215], v[148:151], v[32:35]
v_exp_f32 v117, v117
s_waitcnt lgkmcnt(1)
v_mfma_f32_32x32x16_bf16 v[128:143], v[152:155], v[80:83], 0
v_exp_f32 v118, v118
v_exp_f32 v119, v119
v_cvt_pk_bf16_f32 v144, v112, v113
v_cvt_pk_bf16_f32 v145, v114, v115
s_waitcnt lgkmcnt(0)
v_mfma_f32_32x32x16_bf16 v[128:143], v[156:159], v[88:91], v[128:143]
v_subrev_u32 v8, 8192, v8
ds_read_b128 v[152:155], v8 offset:0
ds_read_b128 v[156:159], v8 offset:1024
v_cvt_pk_bf16_f32 v146, v116, v117
v_cvt_pk_bf16_f32 v147, v118, v119
v_exp_f32 v120, v120
v_exp_f32 v121, v121
v_mfma_f32_32x32x16_bf16 v[192:207], v[160:163], v[144:147], v[192:207]
ds_read_b128 v[160:163], v8 offset:10240
v_exp_f32 v122, v122
v_exp_f32 v123, v123
v_exp_f32 v124, v124
v_mfma_f32_16x16x32_bf16 v[208:211], v[212:215], v[144:147], v[208:211]
v_exp_f32 v125, v125
v_exp_f32 v126, v126
v_exp_f32 v127, v127
v_cvt_pk_bf16_f32 v148, v120, v121
v_cvt_pk_bf16_f32 v149, v122, v123
v_cvt_pk_bf16_f32 v150, v124, v125
v_cvt_pk_bf16_f32 v151, v126, v127
v_exp_f32 v128, v128
v_exp_f32 v129, v129
v_mfma_f32_32x32x16_bf16 v[192:207], v[164:167], v[148:151], v[192:207]
ds_read_b128 v[164:167], v8 offset:11264
v_exp_f32 v130, v130
v_exp_f32 v131, v131
v_exp_f32 v132, v132
v_mfma_f32_16x16x32_bf16 v[208:211], v[212:215], v[148:151], v[208:211]
v_exp_f32 v133, v133
s_waitcnt lgkmcnt(3)
v_mfma_f32_32x32x16_bf16 v[112:127], v[152:155], v[80:83], 0
v_exp_f32 v134, v134
v_exp_f32 v135, v135
v_cvt_pk_bf16_f32 v144, v128, v129
v_cvt_pk_bf16_f32 v145, v130, v131
s_waitcnt lgkmcnt(2)
v_mfma_f32_32x32x16_bf16 v[112:127], v[156:159], v[88:91], v[112:127]
v_subrev_u32 v8, 8192, v8
ds_read_b128 v[152:155], v8 offset:0
ds_read_b128 v[156:159], v8 offset:1024
v_cvt_pk_bf16_f32 v146, v132, v133
v_cvt_pk_bf16_f32 v147, v134, v135
v_exp_f32 v136, v136
v_exp_f32 v137, v137
s_waitcnt lgkmcnt(3)
v_mfma_f32_32x32x16_bf16 v[192:207], v[160:163], v[144:147], v[192:207]
ds_read_b128 v[160:163], v8 offset:10240
v_exp_f32 v138, v138
v_exp_f32 v139, v139
v_exp_f32 v140, v140
v_mfma_f32_16x16x32_bf16 v[208:211], v[212:215], v[144:147], v[208:211]
v_exp_f32 v141, v141
v_exp_f32 v142, v142
v_exp_f32 v143, v143
v_cvt_pk_bf16_f32 v148, v136, v137
v_cvt_pk_bf16_f32 v149, v138, v139
v_cvt_pk_bf16_f32 v150, v140, v141
v_cvt_pk_bf16_f32 v151, v142, v143
v_exp_f32 v112, v112
v_exp_f32 v113, v113
s_waitcnt lgkmcnt(3)
v_mfma_f32_32x32x16_bf16 v[192:207], v[164:167], v[148:151], v[192:207]
ds_read_b128 v[164:167], v8 offset:11264
v_exp_f32 v114, v114
v_exp_f32 v115, v115
v_exp_f32 v116, v116
v_mfma_f32_16x16x32_bf16 v[208:211], v[212:215], v[148:151], v[208:211]
v_exp_f32 v117, v117
s_waitcnt lgkmcnt(3)
v_mfma_f32_32x32x16_bf16 v[128:143], v[152:155], v[80:83], v[216:231]
v_exp_f32 v118, v118
v_exp_f32 v119, v119
v_cvt_pk_bf16_f32 v144, v112, v113
v_cvt_pk_bf16_f32 v145, v114, v115
s_waitcnt lgkmcnt(2)
v_mfma_f32_32x32x16_bf16 v[128:143], v[156:159], v[88:91], v[128:143]
v_cvt_pk_bf16_f32 v146, v116, v117
v_cvt_pk_bf16_f32 v147, v118, v119
v_exp_f32 v120, v120
v_exp_f32 v121, v121
s_waitcnt lgkmcnt(1)
v_mfma_f32_32x32x16_bf16 v[192:207], v[160:163], v[144:147], v[192:207]
ds_read_b128 v[160:163], v8 offset:2048
v_exp_f32 v122, v122
v_exp_f32 v123, v123
v_exp_f32 v124, v124
v_mfma_f32_16x16x32_bf16 v[208:211], v[212:215], v[144:147], v[208:211]
v_exp_f32 v125, v125
v_exp_f32 v126, v126
v_exp_f32 v127, v127
v_cvt_pk_bf16_f32 v148, v120, v121
v_cvt_pk_bf16_f32 v149, v122, v123
v_cvt_pk_bf16_f32 v150, v124, v125
v_cvt_pk_bf16_f32 v151, v126, v127
s_branch at_151
.p2align 3
at_150:
s_waitcnt lgkmcnt(3)
v_add_u32 v5, s34, 20
s_mov_b64 exec, 1
ds_write_b32 v3, v5
s_mov_b64 exec, -1
v_exp_f32 v112, v112
v_exp_f32 v113, v113
s_waitcnt lgkmcnt(3)
v_mfma_f32_32x32x16_bf16 v[16:31], v[164:167], v[148:151], v[16:31]
v_exp_f32 v114, v114
v_exp_f32 v115, v115
v_exp_f32 v116, v116
v_mfma_f32_16x16x32_bf16 v[32:35], v[212:215], v[148:151], v[32:35]
v_exp_f32 v117, v117
v_exp_f32 v118, v118
v_exp_f32 v119, v119
v_cvt_pk_bf16_f32 v144, v112, v113
v_cvt_pk_bf16_f32 v145, v114, v115
v_cvt_pk_bf16_f32 v146, v116, v117
v_cvt_pk_bf16_f32 v147, v118, v119
v_exp_f32 v120, v120
v_exp_f32 v121, v121
v_mfma_f32_32x32x16_bf16 v[192:207], v[160:163], v[144:147], v[192:207]
v_exp_f32 v122, v122
v_exp_f32 v123, v123
v_exp_f32 v124, v124
v_mfma_f32_16x16x32_bf16 v[208:211], v[212:215], v[144:147], v[208:211]
v_exp_f32 v125, v125
v_exp_f32 v126, v126
v_exp_f32 v127, v127
v_cvt_pk_bf16_f32 v148, v120, v121
v_cvt_pk_bf16_f32 v149, v122, v123
v_cvt_pk_bf16_f32 v150, v124, v125
v_cvt_pk_bf16_f32 v151, v126, v127
s_branch at_152
.p2align 3
at_149:
v_exp_f32 v112, v112
v_exp_f32 v113, v113
s_waitcnt lgkmcnt(2)
v_mfma_f32_32x32x16_bf16 v[16:31], v[164:167], v[148:151], v[16:31]
v_exp_f32 v114, v114
v_exp_f32 v115, v115
v_exp_f32 v116, v116
v_mfma_f32_16x16x32_bf16 v[32:35], v[212:215], v[148:151], v[32:35]
v_exp_f32 v117, v117
s_waitcnt lgkmcnt(1)
v_mfma_f32_32x32x16_bf16 v[128:143], v[152:155], v[80:83], v[216:231]
v_exp_f32 v118, v118
v_exp_f32 v119, v119
v_cvt_pk_bf16_f32 v144, v112, v113
v_cvt_pk_bf16_f32 v145, v114, v115
s_waitcnt lgkmcnt(0)
v_mfma_f32_32x32x16_bf16 v[128:143], v[156:159], v[88:91], v[128:143]
v_cvt_pk_bf16_f32 v146, v116, v117
v_cvt_pk_bf16_f32 v147, v118, v119
v_exp_f32 v120, v120
v_exp_f32 v121, v121
v_mfma_f32_32x32x16_bf16 v[192:207], v[160:163], v[144:147], v[192:207]
ds_read_b128 v[160:163], v8 offset:2048
v_exp_f32 v122, v122
v_exp_f32 v123, v123
v_exp_f32 v124, v124
v_mfma_f32_16x16x32_bf16 v[208:211], v[212:215], v[144:147], v[208:211]
v_exp_f32 v125, v125
v_exp_f32 v126, v126
v_exp_f32 v127, v127
v_cvt_pk_bf16_f32 v148, v120, v121
v_cvt_pk_bf16_f32 v149, v122, v123
v_cvt_pk_bf16_f32 v150, v124, v125
v_cvt_pk_bf16_f32 v151, v126, v127
.p2align 3
at_151:
v_exp_f32 v128, v128
v_exp_f32 v129, v129
s_waitcnt lgkmcnt(1)
v_mfma_f32_32x32x16_bf16 v[192:207], v[164:167], v[148:151], v[192:207]
ds_read_b128 v[164:167], v8 offset:3072
v_exp_f32 v130, v130
v_exp_f32 v131, v131
v_exp_f32 v132, v132
v_mfma_f32_16x16x32_bf16 v[208:211], v[212:215], v[148:151], v[208:211]
v_exp_f32 v133, v133
v_exp_f32 v134, v134
v_exp_f32 v135, v135
v_cvt_pk_bf16_f32 v144, v128, v129
v_cvt_pk_bf16_f32 v145, v130, v131
v_add_u32 v5, s34, 20
s_mov_b64 exec, 1
ds_write_b32 v3, v5
s_mov_b64 exec, -1
v_cvt_pk_bf16_f32 v146, v132, v133
v_cvt_pk_bf16_f32 v147, v134, v135
v_exp_f32 v136, v136
v_exp_f32 v137, v137
s_waitcnt lgkmcnt(2)
v_mfma_f32_32x32x16_bf16 v[192:207], v[160:163], v[144:147], v[192:207]
v_exp_f32 v138, v138
v_exp_f32 v139, v139
v_exp_f32 v140, v140
v_mfma_f32_16x16x32_bf16 v[208:211], v[212:215], v[144:147], v[208:211]
v_exp_f32 v141, v141
v_exp_f32 v142, v142
v_exp_f32 v143, v143
v_cvt_pk_bf16_f32 v148, v136, v137
v_cvt_pk_bf16_f32 v149, v138, v139
v_cvt_pk_bf16_f32 v150, v140, v141
v_cvt_pk_bf16_f32 v151, v142, v143
at_152:
s_lshl_b32 s66, s59, 18
s_lshl_b32 s67, s63, 22
v_mfma_f32_16x16x32_bf16 v[208:211], v[212:215], v[148:151], v[208:211]
s_add_u32 s66, s66, s67
s_lshl1_add_u32 s67, s60, s64
s_waitcnt lgkmcnt(1)
v_mfma_f32_32x32x16_bf16 v[192:207], v[164:167], v[148:151], v[192:207]
s_lshl_b32 s67, s67, 11
s_add_u32 s66, s66, s67
s_lshl_b32 s68, s65, 16
s_add_u32 s67, s66, 18022400
s_sub_u32 s67, s67, s68
s_add_u32 s66, s66, s68
s_add_u32 s66, s66, 17825792
v_lshlrev_b32 v9, 4, v0
v_subrev_u32 v10, 0x2f800000, v32
v_subrev_u32 v11, 0x2f800000, v208
v_max_u32 v10, v10, v11
v_cmp_lt_u32 vcc, 0x20000000, v10
s_cbranch_vccnz slow_157
sback_158:
s_nop 1
v_rcp_f32 v12, v32
s_nop 1
v_pk_mul_f32 v[16:17], v[16:17], v[12:13] op_sel:[0,0] op_sel_hi:[1,0]
v_pk_mul_f32 v[18:19], v[18:19], v[12:13] op_sel:[0,0] op_sel_hi:[1,0]
v_pk_mul_f32 v[20:21], v[20:21], v[12:13] op_sel:[0,0] op_sel_hi:[1,0]
v_pk_mul_f32 v[22:23], v[22:23], v[12:13] op_sel:[0,0] op_sel_hi:[1,0]
v_pk_mul_f32 v[24:25], v[24:25], v[12:13] op_sel:[0,0] op_sel_hi:[1,0]
v_pk_mul_f32 v[26:27], v[26:27], v[12:13] op_sel:[0,0] op_sel_hi:[1,0]
v_pk_mul_f32 v[28:29], v[28:29], v[12:13] op_sel:[0,0] op_sel_hi:[1,0]
v_pk_mul_f32 v[30:31], v[30:31], v[12:13] op_sel:[0,0] op_sel_hi:[1,0]
v_cvt_pk_bf16_f32 v16, v16, v17
v_cvt_pk_bf16_f32 v17, v18, v19
v_cvt_pk_bf16_f32 v18, v20, v21
v_cvt_pk_bf16_f32 v19, v22, v23
v_cvt_pk_bf16_f32 v20, v24, v25
v_cvt_pk_bf16_f32 v21, v26, v27
v_cvt_pk_bf16_f32 v22, v28, v29
v_cvt_pk_bf16_f32 v23, v30, v31
s_cmp_eq_u32 s57, 0
s_cbranch_scc1 far_159
buffer_store_dwordx4 v[16:19], v9, s[20:23], s67 offen offset:0
buffer_store_dwordx4 v[20:23], v9, s[20:23], s67 offen offset:1024
near_160:
v_rcp_f32 v12, v208
s_nop 0
v_pk_mul_f32 v[192:193], v[192:193], v[12:13] op_sel:[0,0] op_sel_hi:[1,0]
v_pk_mul_f32 v[194:195], v[194:195], v[12:13] op_sel:[0,0] op_sel_hi:[1,0]
v_pk_mul_f32 v[196:197], v[196:197], v[12:13] op_sel:[0,0] op_sel_hi:[1,0]
v_pk_mul_f32 v[198:199], v[198:199], v[12:13] op_sel:[0,0] op_sel_hi:[1,0]
v_pk_mul_f32 v[200:201], v[200:201], v[12:13] op_sel:[0,0] op_sel_hi:[1,0]
v_pk_mul_f32 v[202:203], v[202:203], v[12:13] op_sel:[0,0] op_sel_hi:[1,0]
v_pk_mul_f32 v[204:205], v[204:205], v[12:13] op_sel:[0,0] op_sel_hi:[1,0]
v_pk_mul_f32 v[206:207], v[206:207], v[12:13] op_sel:[0,0] op_sel_hi:[1,0]
v_cvt_pk_bf16_f32 v192, v192, v193
v_cvt_pk_bf16_f32 v193, v194, v195
v_cvt_pk_bf16_f32 v194, v196, v197
v_cvt_pk_bf16_f32 v195, v198, v199
v_cvt_pk_bf16_f32 v196, v200, v201
v_cvt_pk_bf16_f32 v197, v202, v203
v_cvt_pk_bf16_f32 v198, v204, v205
v_cvt_pk_bf16_f32 v199, v206, v207
s_cmp_eq_u32 s57, 0
s_cbranch_scc1 far_161
buffer_store_dwordx4 v[192:195], v9, s[20:23], s66 offen offset:0
buffer_store_dwordx4 v[196:199], v9, s[20:23], s66 offen offset:1024
near_162:
v_bfe_u32 v48, v0, 2, 3
v_lshrrev_b32 v49, 5, v0
v_lshl_add_u32 v48, v49, 4, v48
v_lshlrev_b32 v48, 7, v48
v_bfe_u32 v49, v0, 3, 2
v_lshl_add_u32 v48, v49, 5, v48
v_and_b32 v49, 3, v0
v_lshl_add_u32 v48, v49, 3, v48
v_add_u32 v8, 32768, v48
v_xor_b32 v9, 32, v8
v_xor_b32 v10, 64, v8
v_xor_b32 v11, 96, v8
v_add_u32 v12, 0x10000, v8
v_add_u32 v13, 0x10000, v9
v_add_u32 v14, 0x10000, v10
v_add_u32 v15, 0x10000, v11
v_and_b32 v48, 15, v0
v_lshrrev_b32 v49, 4, v0
s_lshl2_add_u32 s66, s61, s58
s_lshl_b32 s67, s66, 16
s_lshl_b32 s68, s63, 22
s_add_u32 s67, s67, s68
s_add_u32 s67, s67, 17825792
v_lshl_add_u32 v6, v48, 4, s67
v_lshl_add_u32 v6, v49, 9, v6
s_add_u32 s70, s72, 268288
s_add_u32 s35, s34, 3
lw_163:
ds_read_b32 v5, v2 offset:24
s_waitcnt lgkmcnt(0)
v_cmp_gt_i32 vcc, s35, v5
s_cbranch_vccz lwd_164
s_sub_u32 s32, s32, 1
s_cmp_gt_i32 s32, 0
s_cbranch_scc1 lw_163
lwd_164:
s_mov_b64 exec, 1
s_waitcnt vmcnt(0)
s_cmp_eq_u32 s57, 0
s_cbranch_scc1 far_165
buffer_store_dword v212, v3, s[24:27], s70 offen
near_166:
s_mov_b64 exec, -1
v_add_u32 v5, s34, 21
s_mov_b64 exec, 1
ds_write_b32 v3, v5
s_mov_b64 exec, -1
s_cmp_eq_u32 s63, 0
s_cbranch_scc0 mo_167
v_permlane16_swap_b32 v240, v242
v_permlane16_swap_b32 v241, v243
v_permlane16_swap_b32 v244, v246
v_permlane16_swap_b32 v245, v247
v_permlane16_swap_b32 v248, v250
v_permlane16_swap_b32 v249, v251
v_permlane16_swap_b32 v252, v254
v_permlane16_swap_b32 v253, v255
mo_168:
v_lshlrev_b32 v16, 16, v240
v_and_b32 v17, 0xffff0000, v240
v_lshlrev_b32 v18, 16, v241
v_and_b32 v19, 0xffff0000, v241
v_lshlrev_b32 v20, 16, v242
v_and_b32 v21, 0xffff0000, v242
v_lshlrev_b32 v22, 16, v243
v_and_b32 v23, 0xffff0000, v243
v_lshlrev_b32 v24, 16, v244
v_and_b32 v25, 0xffff0000, v244
v_lshlrev_b32 v26, 16, v245
v_and_b32 v27, 0xffff0000, v245
v_lshlrev_b32 v28, 16, v246
v_and_b32 v29, 0xffff0000, v246
v_lshlrev_b32 v30, 16, v247
v_and_b32 v31, 0xffff0000, v247
v_lshlrev_b32 v32, 16, v248
v_and_b32 v33, 0xffff0000, v248
v_lshlrev_b32 v34, 16, v249
v_and_b32 v35, 0xffff0000, v249
v_lshlrev_b32 v36, 16, v250
v_and_b32 v37, 0xffff0000, v250
v_lshlrev_b32 v38, 16, v251
v_and_b32 v39, 0xffff0000, v251
v_lshlrev_b32 v40, 16, v252
v_and_b32 v41, 0xffff0000, v252
v_lshlrev_b32 v42, 16, v253
v_and_b32 v43, 0xffff0000, v253
v_lshlrev_b32 v44, 16, v254
v_and_b32 v45, 0xffff0000, v254
v_lshlrev_b32 v46, 16, v255
v_and_b32 v47, 0xffff0000, v255
s_add_u32 s66, s61, s62
s_and_b32 s66, s66, 15
s_lshl_b32 s66, s66, 12
s_mov_b32 s69, 0x3f803f80
v_mov_b32 v208, 0
v_dot2c_f32_bf16 v208, s69, v232
v_dot2c_f32_bf16 v208, s69, v233
v_dot2c_f32_bf16 v208, s69, v234
v_dot2c_f32_bf16 v208, s69, v235
v_dot2c_f32_bf16 v208, s69, v236
v_dot2c_f32_bf16 v208, s69, v237
v_dot2c_f32_bf16 v208, s69, v238
v_dot2c_f32_bf16 v208, s69, v239
s_add_u32 s35, s34, 22
lw_169:
ds_read_b32 v5, v2 offset:16
s_waitcnt lgkmcnt(0)
v_cmp_gt_i32 vcc, s35, v5
s_cbranch_vccz lwd_170
s_sub_u32 s32, s32, 1
s_cmp_gt_i32 s32, 0
s_cbranch_scc1 lw_169
lwd_170:
buffer_load_dwordx4 v[80:83], v6, s[20:23], s66 offen offset:0 sc1
buffer_load_dwordx4 v[88:91], v6, s[20:23], s66 offen offset:2048 sc1
buffer_load_dwordx4 v[84:87], v6, s[20:23], s66 offen offset:256 sc1
buffer_load_dwordx4 v[92:95], v6, s[20:23], s66 offen offset:2304 sc1
s_add_u32 s66, s66, 4096
s_and_b32 s66, s66, 0xffff
ds_read_b64_tr_b16 v[48:49], v8 offset:0
ds_read_b64_tr_b16 v[50:51], v8 offset:1024
ds_read_b64_tr_b16 v[52:53], v8 offset:4096
ds_read_b64_tr_b16 v[54:55], v8 offset:5120
buffer_load_dwordx4 v[96:99], v6, s[20:23], s66 offen offset:0 sc1
buffer_load_dwordx4 v[104:107], v6, s[20:23], s66 offen offset:2048 sc1
buffer_load_dwordx4 v[100:103], v6, s[20:23], s66 offen offset:256 sc1
buffer_load_dwordx4 v[108:111], v6, s[20:23], s66 offen offset:2304 sc1
s_add_u32 s66, s66, 4096
s_and_b32 s66, s66, 0xffff
ds_read_b64_tr_b16 v[56:57], v9 offset:0
ds_read_b64_tr_b16 v[58:59], v9 offset:1024
ds_read_b64_tr_b16 v[60:61], v9 offset:4096
ds_read_b64_tr_b16 v[62:63], v9 offset:5120
buffer_load_dwordx4 v[112:115], v6, s[20:23], s66 offen offset:0 sc1
buffer_load_dwordx4 v[120:123], v6, s[20:23], s66 offen offset:2048 sc1
buffer_load_dwordx4 v[116:119], v6, s[20:23], s66 offen offset:256 sc1
buffer_load_dwordx4 v[124:127], v6, s[20:23], s66 offen offset:2304 sc1
s_add_u32 s66, s66, 4096
s_and_b32 s66, s66, 0xffff
ds_read_b64_tr_b16 v[64:65], v10 offset:0
ds_read_b64_tr_b16 v[66:67], v10 offset:1024
ds_read_b64_tr_b16 v[68:69], v10 offset:4096
ds_read_b64_tr_b16 v[70:71], v10 offset:5120
.p2align 3
s_waitcnt vmcnt(11) lgkmcnt(10)
v_mfma_f32_16x16x32_bf16 v[16:19], v[48:51], v[80:83], v[16:19]
ds_read_b64_tr_b16 v[72:73], v11 offset:0
buffer_load_dwordx4 v[128:131], v6, s[20:23], s66 offen offset:0 sc1
s_waitcnt vmcnt(11) lgkmcnt(9)
v_mfma_f32_16x16x32_bf16 v[16:19], v[52:55], v[88:91], v[16:19]
ds_read_b64_tr_b16 v[74:75], v11 offset:1024
s_waitcnt vmcnt(10)
v_mfma_f32_16x16x32_bf16 v[32:35], v[48:51], v[84:87], v[32:35]
ds_read_b64_tr_b16 v[76:77], v11 offset:4096
buffer_load_dwordx4 v[136:139], v6, s[20:23], s66 offen offset:2048 sc1
s_waitcnt vmcnt(10)
v_mfma_f32_16x16x32_bf16 v[32:35], v[52:55], v[92:95], v[32:35]
ds_read_b64_tr_b16 v[78:79], v11 offset:5120
s_waitcnt lgkmcnt(10)
v_mfma_f32_16x16x32_bf16 v[20:23], v[56:59], v[80:83], v[20:23]
ds_read_b64_tr_b16 v[48:49], v8 offset:8192
buffer_load_dwordx4 v[132:135], v6, s[20:23], s66 offen offset:256 sc1
s_waitcnt lgkmcnt(9)
v_mfma_f32_16x16x32_bf16 v[20:23], v[60:63], v[88:91], v[20:23]
ds_read_b64_tr_b16 v[50:51], v8 offset:9216
v_mfma_f32_16x16x32_bf16 v[36:39], v[56:59], v[84:87], v[36:39]
ds_read_b64_tr_b16 v[52:53], v8 offset:12288
buffer_load_dwordx4 v[140:143], v6, s[20:23], s66 offen offset:2304 sc1
s_add_u32 s66, s66, 4096
s_and_b32 s66, s66, 0xffff
v_mfma_f32_16x16x32_bf16 v[36:39], v[60:63], v[92:95], v[36:39]
ds_read_b64_tr_b16 v[54:55], v8 offset:13312
s_waitcnt lgkmcnt(10)
v_mfma_f32_16x16x32_bf16 v[24:27], v[64:67], v[80:83], v[24:27]
ds_read_b64_tr_b16 v[56:57], v9 offset:8192
s_waitcnt lgkmcnt(9)
v_mfma_f32_16x16x32_bf16 v[24:27], v[68:71], v[88:91], v[24:27]
ds_read_b64_tr_b16 v[58:59], v9 offset:9216
v_mfma_f32_16x16x32_bf16 v[40:43], v[64:67], v[84:87], v[40:43]
ds_read_b64_tr_b16 v[60:61], v9 offset:12288
v_mfma_f32_16x16x32_bf16 v[40:43], v[68:71], v[92:95], v[40:43]
ds_read_b64_tr_b16 v[62:63], v9 offset:13312
s_waitcnt lgkmcnt(10)
v_mfma_f32_16x16x32_bf16 v[28:31], v[72:75], v[80:83], v[28:31]
ds_read_b64_tr_b16 v[64:65], v10 offset:8192
s_waitcnt lgkmcnt(9)
v_mfma_f32_16x16x32_bf16 v[28:31], v[76:79], v[88:91], v[28:31]
ds_read_b64_tr_b16 v[66:67], v10 offset:9216
v_mfma_f32_16x16x32_bf16 v[44:47], v[72:75], v[84:87], v[44:47]
ds_read_b64_tr_b16 v[68:69], v10 offset:12288
v_mfma_f32_16x16x32_bf16 v[44:47], v[76:79], v[92:95], v[44:47]
ds_read_b64_tr_b16 v[70:71], v10 offset:13312
s_waitcnt vmcnt(11) lgkmcnt(10)
v_mfma_f32_16x16x32_bf16 v[16:19], v[48:51], v[96:99], v[16:19]
ds_read_b64_tr_b16 v[72:73], v11 offset:8192
buffer_load_dwordx4 v[144:147], v6, s[20:23], s66 offen offset:0 sc1
s_waitcnt vmcnt(11) lgkmcnt(9)
v_mfma_f32_16x16x32_bf16 v[16:19], v[52:55], v[104:107], v[16:19]
ds_read_b64_tr_b16 v[74:75], v11 offset:9216
s_waitcnt vmcnt(10)
v_mfma_f32_16x16x32_bf16 v[32:35], v[48:51], v[100:103], v[32:35]
ds_read_b64_tr_b16 v[76:77], v11 offset:12288
buffer_load_dwordx4 v[152:155], v6, s[20:23], s66 offen offset:2048 sc1
s_waitcnt vmcnt(10)
v_mfma_f32_16x16x32_bf16 v[32:35], v[52:55], v[108:111], v[32:35]
ds_read_b64_tr_b16 v[78:79], v11 offset:13312
s_waitcnt lgkmcnt(10)
v_mfma_f32_16x16x32_bf16 v[20:23], v[56:59], v[96:99], v[20:23]
ds_read_b64_tr_b16 v[48:49], v8 offset:16384
buffer_load_dwordx4 v[148:151], v6, s[20:23], s66 offen offset:256 sc1
s_waitcnt lgkmcnt(9)
v_mfma_f32_16x16x32_bf16 v[20:23], v[60:63], v[104:107], v[20:23]
ds_read_b64_tr_b16 v[50:51], v8 offset:17408
v_mfma_f32_16x16x32_bf16 v[36:39], v[56:59], v[100:103], v[36:39]
ds_read_b64_tr_b16 v[52:53], v8 offset:20480
buffer_load_dwordx4 v[156:159], v6, s[20:23], s66 offen offset:2304 sc1
s_add_u32 s66, s66, 4096
s_and_b32 s66, s66, 0xffff
v_mfma_f32_16x16x32_bf16 v[36:39], v[60:63], v[108:111], v[36:39]
ds_read_b64_tr_b16 v[54:55], v8 offset:21504
s_waitcnt lgkmcnt(10)
v_mfma_f32_16x16x32_bf16 v[24:27], v[64:67], v[96:99], v[24:27]
ds_read_b64_tr_b16 v[56:57], v9 offset:16384
s_waitcnt lgkmcnt(9)
v_mfma_f32_16x16x32_bf16 v[24:27], v[68:71], v[104:107], v[24:27]
ds_read_b64_tr_b16 v[58:59], v9 offset:17408
v_mfma_f32_16x16x32_bf16 v[40:43], v[64:67], v[100:103], v[40:43]
ds_read_b64_tr_b16 v[60:61], v9 offset:20480
v_mfma_f32_16x16x32_bf16 v[40:43], v[68:71], v[108:111], v[40:43]
ds_read_b64_tr_b16 v[62:63], v9 offset:21504
s_waitcnt lgkmcnt(10)
v_mfma_f32_16x16x32_bf16 v[28:31], v[72:75], v[96:99], v[28:31]
ds_read_b64_tr_b16 v[64:65], v10 offset:16384
s_waitcnt lgkmcnt(9)
v_mfma_f32_16x16x32_bf16 v[28:31], v[76:79], v[104:107], v[28:31]
ds_read_b64_tr_b16 v[66:67], v10 offset:17408
v_mfma_f32_16x16x32_bf16 v[44:47], v[72:75], v[100:103], v[44:47]
ds_read_b64_tr_b16 v[68:69], v10 offset:20480
v_mfma_f32_16x16x32_bf16 v[44:47], v[76:79], v[108:111], v[44:47]
ds_read_b64_tr_b16 v[70:71], v10 offset:21504
s_waitcnt vmcnt(11) lgkmcnt(10)
v_mfma_f32_16x16x32_bf16 v[16:19], v[48:51], v[112:115], v[16:19]
ds_read_b64_tr_b16 v[72:73], v11 offset:16384
buffer_load_dwordx4 v[160:163], v6, s[20:23], s66 offen offset:0 sc1
s_waitcnt vmcnt(11) lgkmcnt(9)
v_mfma_f32_16x16x32_bf16 v[16:19], v[52:55], v[120:123], v[16:19]
ds_read_b64_tr_b16 v[74:75], v11 offset:17408
s_waitcnt vmcnt(10)
v_mfma_f32_16x16x32_bf16 v[32:35], v[48:51], v[116:119], v[32:35]
ds_read_b64_tr_b16 v[76:77], v11 offset:20480
buffer_load_dwordx4 v[168:171], v6, s[20:23], s66 offen offset:2048 sc1
s_waitcnt vmcnt(10)
v_mfma_f32_16x16x32_bf16 v[32:35], v[52:55], v[124:127], v[32:35]
ds_read_b64_tr_b16 v[78:79], v11 offset:21504
s_waitcnt lgkmcnt(10)
v_mfma_f32_16x16x32_bf16 v[20:23], v[56:59], v[112:115], v[20:23]
ds_read_b64_tr_b16 v[48:49], v8 offset:24576
buffer_load_dwordx4 v[164:167], v6, s[20:23], s66 offen offset:256 sc1
s_waitcnt lgkmcnt(9)
v_mfma_f32_16x16x32_bf16 v[20:23], v[60:63], v[120:123], v[20:23]
ds_read_b64_tr_b16 v[50:51], v8 offset:25600
v_mfma_f32_16x16x32_bf16 v[36:39], v[56:59], v[116:119], v[36:39]
ds_read_b64_tr_b16 v[52:53], v8 offset:28672
buffer_load_dwordx4 v[172:175], v6, s[20:23], s66 offen offset:2304 sc1
s_add_u32 s66, s66, 4096
s_and_b32 s66, s66, 0xffff
v_mfma_f32_16x16x32_bf16 v[36:39], v[60:63], v[124:127], v[36:39]
ds_read_b64_tr_b16 v[54:55], v8 offset:29696
s_waitcnt lgkmcnt(10)
v_mfma_f32_16x16x32_bf16 v[24:27], v[64:67], v[112:115], v[24:27]
ds_read_b64_tr_b16 v[56:57], v9 offset:24576
s_waitcnt lgkmcnt(9)
v_mfma_f32_16x16x32_bf16 v[24:27], v[68:71], v[120:123], v[24:27]
ds_read_b64_tr_b16 v[58:59], v9 offset:25600
v_mfma_f32_16x16x32_bf16 v[40:43], v[64:67], v[116:119], v[40:43]
ds_read_b64_tr_b16 v[60:61], v9 offset:28672
v_mfma_f32_16x16x32_bf16 v[40:43], v[68:71], v[124:127], v[40:43]
ds_read_b64_tr_b16 v[62:63], v9 offset:29696
s_waitcnt lgkmcnt(10)
v_mfma_f32_16x16x32_bf16 v[28:31], v[72:75], v[112:115], v[28:31]
ds_read_b64_tr_b16 v[64:65], v10 offset:24576
s_waitcnt lgkmcnt(9)
v_mfma_f32_16x16x32_bf16 v[28:31], v[76:79], v[120:123], v[28:31]
ds_read_b64_tr_b16 v[66:67], v10 offset:25600
v_mfma_f32_16x16x32_bf16 v[44:47], v[72:75], v[116:119], v[44:47]
ds_read_b64_tr_b16 v[68:69], v10 offset:28672
v_mfma_f32_16x16x32_bf16 v[44:47], v[76:79], v[124:127], v[44:47]
ds_read_b64_tr_b16 v[70:71], v10 offset:29696
s_waitcnt vmcnt(11) lgkmcnt(10)
v_mfma_f32_16x16x32_bf16 v[16:19], v[48:51], v[128:131], v[16:19]
ds_read_b64_tr_b16 v[72:73], v11 offset:24576
buffer_load_dwordx4 v[176:179], v6, s[20:23], s66 offen offset:0 sc1
s_waitcnt vmcnt(11) lgkmcnt(9)
v_mfma_f32_16x16x32_bf16 v[16:19], v[52:55], v[136:139], v[16:19]
ds_read_b64_tr_b16 v[74:75], v11 offset:25600
s_waitcnt vmcnt(10)
v_mfma_f32_16x16x32_bf16 v[32:35], v[48:51], v[132:135], v[32:35]
ds_read_b64_tr_b16 v[76:77], v11 offset:28672
buffer_load_dwordx4 v[184:187], v6, s[20:23], s66 offen offset:2048 sc1
s_waitcnt vmcnt(10)
v_mfma_f32_16x16x32_bf16 v[32:35], v[52:55], v[140:143], v[32:35]
ds_read_b64_tr_b16 v[78:79], v11 offset:29696
s_waitcnt lgkmcnt(10)
v_mfma_f32_16x16x32_bf16 v[20:23], v[56:59], v[128:131], v[20:23]
ds_read_b64_tr_b16 v[48:49], v8 offset:32768
buffer_load_dwordx4 v[180:183], v6, s[20:23], s66 offen offset:256 sc1
s_waitcnt lgkmcnt(9)
v_mfma_f32_16x16x32_bf16 v[20:23], v[60:63], v[136:139], v[20:23]
ds_read_b64_tr_b16 v[50:51], v8 offset:33792
v_mfma_f32_16x16x32_bf16 v[36:39], v[56:59], v[132:135], v[36:39]
ds_read_b64_tr_b16 v[52:53], v8 offset:36864
buffer_load_dwordx4 v[188:191], v6, s[20:23], s66 offen offset:2304 sc1
s_add_u32 s66, s66, 4096
s_and_b32 s66, s66, 0xffff
v_mfma_f32_16x16x32_bf16 v[36:39], v[60:63], v[140:143], v[36:39]
ds_read_b64_tr_b16 v[54:55], v8 offset:37888
s_waitcnt lgkmcnt(10)
v_mfma_f32_16x16x32_bf16 v[24:27], v[64:67], v[128:131], v[24:27]
ds_read_b64_tr_b16 v[56:57], v9 offset:32768
s_waitcnt lgkmcnt(9)
v_mfma_f32_16x16x32_bf16 v[24:27], v[68:71], v[136:139], v[24:27]
ds_read_b64_tr_b16 v[58:59], v9 offset:33792
v_mfma_f32_16x16x32_bf16 v[40:43], v[64:67], v[132:135], v[40:43]
ds_read_b64_tr_b16 v[60:61], v9 offset:36864
v_mfma_f32_16x16x32_bf16 v[40:43], v[68:71], v[140:143], v[40:43]
ds_read_b64_tr_b16 v[62:63], v9 offset:37888
s_waitcnt lgkmcnt(10)
v_mfma_f32_16x16x32_bf16 v[28:31], v[72:75], v[128:131], v[28:31]
ds_read_b64_tr_b16 v[64:65], v10 offset:32768
s_waitcnt lgkmcnt(9)
v_mfma_f32_16x16x32_bf16 v[28:31], v[76:79], v[136:139], v[28:31]
ds_read_b64_tr_b16 v[66:67], v10 offset:33792
v_mfma_f32_16x16x32_bf16 v[44:47], v[72:75], v[132:135], v[44:47]
ds_read_b64_tr_b16 v[68:69], v10 offset:36864
v_mfma_f32_16x16x32_bf16 v[44:47], v[76:79], v[140:143], v[44:47]
ds_read_b64_tr_b16 v[70:71], v10 offset:37888
s_waitcnt vmcnt(11) lgkmcnt(10)
v_mfma_f32_16x16x32_bf16 v[16:19], v[48:51], v[144:147], v[16:19]
ds_read_b64_tr_b16 v[72:73], v11 offset:32768
buffer_load_dwordx4 v[192:195], v6, s[20:23], s66 offen offset:0 sc1
s_waitcnt vmcnt(11) lgkmcnt(9)
v_mfma_f32_16x16x32_bf16 v[16:19], v[52:55], v[152:155], v[16:19]
ds_read_b64_tr_b16 v[74:75], v11 offset:33792
s_waitcnt vmcnt(10)
v_mfma_f32_16x16x32_bf16 v[32:35], v[48:51], v[148:151], v[32:35]
ds_read_b64_tr_b16 v[76:77], v11 offset:36864
buffer_load_dwordx4 v[200:203], v6, s[20:23], s66 offen offset:2048 sc1
s_waitcnt vmcnt(10)
v_mfma_f32_16x16x32_bf16 v[32:35], v[52:55], v[156:159], v[32:35]
ds_read_b64_tr_b16 v[78:79], v11 offset:37888
s_waitcnt lgkmcnt(10)
v_mfma_f32_16x16x32_bf16 v[20:23], v[56:59], v[144:147], v[20:23]
ds_read_b64_tr_b16 v[48:49], v8 offset:40960
buffer_load_dwordx4 v[196:199], v6, s[20:23], s66 offen offset:256 sc1
s_waitcnt lgkmcnt(9)
v_mfma_f32_16x16x32_bf16 v[20:23], v[60:63], v[152:155], v[20:23]
ds_read_b64_tr_b16 v[50:51], v8 offset:41984
v_mfma_f32_16x16x32_bf16 v[36:39], v[56:59], v[148:151], v[36:39]
ds_read_b64_tr_b16 v[52:53], v8 offset:45056
buffer_load_dwordx4 v[204:207], v6, s[20:23], s66 offen offset:2304 sc1
s_add_u32 s66, s66, 4096
s_and_b32 s66, s66, 0xffff
v_mfma_f32_16x16x32_bf16 v[36:39], v[60:63], v[156:159], v[36:39]
ds_read_b64_tr_b16 v[54:55], v8 offset:46080
s_waitcnt lgkmcnt(10)
v_mfma_f32_16x16x32_bf16 v[24:27], v[64:67], v[144:147], v[24:27]
ds_read_b64_tr_b16 v[56:57], v9 offset:40960
s_waitcnt lgkmcnt(9)
v_mfma_f32_16x16x32_bf16 v[24:27], v[68:71], v[152:155], v[24:27]
ds_read_b64_tr_b16 v[58:59], v9 offset:41984
v_mfma_f32_16x16x32_bf16 v[40:43], v[64:67], v[148:151], v[40:43]
ds_read_b64_tr_b16 v[60:61], v9 offset:45056
v_mfma_f32_16x16x32_bf16 v[40:43], v[68:71], v[156:159], v[40:43]
ds_read_b64_tr_b16 v[62:63], v9 offset:46080
s_waitcnt lgkmcnt(10)
v_mfma_f32_16x16x32_bf16 v[28:31], v[72:75], v[144:147], v[28:31]
ds_read_b64_tr_b16 v[64:65], v10 offset:40960
s_waitcnt lgkmcnt(9)
v_mfma_f32_16x16x32_bf16 v[28:31], v[76:79], v[152:155], v[28:31]
ds_read_b64_tr_b16 v[66:67], v10 offset:41984
v_mfma_f32_16x16x32_bf16 v[44:47], v[72:75], v[148:151], v[44:47]
ds_read_b64_tr_b16 v[68:69], v10 offset:45056
v_mfma_f32_16x16x32_bf16 v[44:47], v[76:79], v[156:159], v[44:47]
ds_read_b64_tr_b16 v[70:71], v10 offset:46080
s_waitcnt vmcnt(11) lgkmcnt(10)
v_mfma_f32_16x16x32_bf16 v[16:19], v[48:51], v[160:163], v[16:19]
ds_read_b64_tr_b16 v[72:73], v11 offset:40960
buffer_load_dwordx4 v[80:83], v6, s[20:23], s66 offen offset:0 sc1
s_waitcnt vmcnt(11) lgkmcnt(9)
v_mfma_f32_16x16x32_bf16 v[16:19], v[52:55], v[168:171], v[16:19]
ds_read_b64_tr_b16 v[74:75], v11 offset:41984
s_waitcnt vmcnt(10)
v_mfma_f32_16x16x32_bf16 v[32:35], v[48:51], v[164:167], v[32:35]
ds_read_b64_tr_b16 v[76:77], v11 offset:45056
buffer_load_dwordx4 v[88:91], v6, s[20:23], s66 offen offset:2048 sc1
s_waitcnt vmcnt(10)
v_mfma_f32_16x16x32_bf16 v[32:35], v[52:55], v[172:175], v[32:35]
ds_read_b64_tr_b16 v[78:79], v11 offset:46080
s_waitcnt lgkmcnt(10)
v_mfma_f32_16x16x32_bf16 v[20:23], v[56:59], v[160:163], v[20:23]
ds_read_b64_tr_b16 v[48:49], v8 offset:49152
buffer_load_dwordx4 v[84:87], v6, s[20:23], s66 offen offset:256 sc1
s_waitcnt lgkmcnt(9)
v_mfma_f32_16x16x32_bf16 v[20:23], v[60:63], v[168:171], v[20:23]
ds_read_b64_tr_b16 v[50:51], v8 offset:50176
v_mfma_f32_16x16x32_bf16 v[36:39], v[56:59], v[164:167], v[36:39]
ds_read_b64_tr_b16 v[52:53], v8 offset:53248
buffer_load_dwordx4 v[92:95], v6, s[20:23], s66 offen offset:2304 sc1
s_add_u32 s66, s66, 4096
s_and_b32 s66, s66, 0xffff
v_mfma_f32_16x16x32_bf16 v[36:39], v[60:63], v[172:175], v[36:39]
ds_read_b64_tr_b16 v[54:55], v8 offset:54272
s_waitcnt lgkmcnt(10)
v_mfma_f32_16x16x32_bf16 v[24:27], v[64:67], v[160:163], v[24:27]
ds_read_b64_tr_b16 v[56:57], v9 offset:49152
s_waitcnt lgkmcnt(9)
v_mfma_f32_16x16x32_bf16 v[24:27], v[68:71], v[168:171], v[24:27]
ds_read_b64_tr_b16 v[58:59], v9 offset:50176
v_mfma_f32_16x16x32_bf16 v[40:43], v[64:67], v[164:167], v[40:43]
ds_read_b64_tr_b16 v[60:61], v9 offset:53248
v_mfma_f32_16x16x32_bf16 v[40:43], v[68:71], v[172:175], v[40:43]
ds_read_b64_tr_b16 v[62:63], v9 offset:54272
s_waitcnt lgkmcnt(10)
v_mfma_f32_16x16x32_bf16 v[28:31], v[72:75], v[160:163], v[28:31]
ds_read_b64_tr_b16 v[64:65], v10 offset:49152
s_waitcnt lgkmcnt(9)
v_mfma_f32_16x16x32_bf16 v[28:31], v[76:79], v[168:171], v[28:31]
ds_read_b64_tr_b16 v[66:67], v10 offset:50176
v_mfma_f32_16x16x32_bf16 v[44:47], v[72:75], v[164:167], v[44:47]
ds_read_b64_tr_b16 v[68:69], v10 offset:53248
v_mfma_f32_16x16x32_bf16 v[44:47], v[76:79], v[172:175], v[44:47]
ds_read_b64_tr_b16 v[70:71], v10 offset:54272
s_waitcnt vmcnt(11) lgkmcnt(10)
v_mfma_f32_16x16x32_bf16 v[16:19], v[48:51], v[176:179], v[16:19]
ds_read_b64_tr_b16 v[72:73], v11 offset:49152
buffer_load_dwordx4 v[96:99], v6, s[20:23], s66 offen offset:0 sc1
s_waitcnt vmcnt(11) lgkmcnt(9)
v_mfma_f32_16x16x32_bf16 v[16:19], v[52:55], v[184:187], v[16:19]
ds_read_b64_tr_b16 v[74:75], v11 offset:50176
s_waitcnt vmcnt(10)
v_mfma_f32_16x16x32_bf16 v[32:35], v[48:51], v[180:183], v[32:35]
ds_read_b64_tr_b16 v[76:77], v11 offset:53248
buffer_load_dwordx4 v[104:107], v6, s[20:23], s66 offen offset:2048 sc1
s_waitcnt vmcnt(10)
v_mfma_f32_16x16x32_bf16 v[32:35], v[52:55], v[188:191], v[32:35]
ds_read_b64_tr_b16 v[78:79], v11 offset:54272
s_waitcnt lgkmcnt(10)
v_mfma_f32_16x16x32_bf16 v[20:23], v[56:59], v[176:179], v[20:23]
ds_read_b64_tr_b16 v[48:49], v8 offset:57344
buffer_load_dwordx4 v[100:103], v6, s[20:23], s66 offen offset:256 sc1
s_waitcnt lgkmcnt(9)
v_mfma_f32_16x16x32_bf16 v[20:23], v[60:63], v[184:187], v[20:23]
ds_read_b64_tr_b16 v[50:51], v8 offset:58368
v_mfma_f32_16x16x32_bf16 v[36:39], v[56:59], v[180:183], v[36:39]
ds_read_b64_tr_b16 v[52:53], v8 offset:61440
buffer_load_dwordx4 v[108:111], v6, s[20:23], s66 offen offset:2304 sc1
s_add_u32 s66, s66, 4096
s_and_b32 s66, s66, 0xffff
v_mfma_f32_16x16x32_bf16 v[36:39], v[60:63], v[188:191], v[36:39]
ds_read_b64_tr_b16 v[54:55], v8 offset:62464
s_waitcnt lgkmcnt(10)
v_mfma_f32_16x16x32_bf16 v[24:27], v[64:67], v[176:179], v[24:27]
ds_read_b64_tr_b16 v[56:57], v9 offset:57344
s_waitcnt lgkmcnt(9)
v_mfma_f32_16x16x32_bf16 v[24:27], v[68:71], v[184:187], v[24:27]
ds_read_b64_tr_b16 v[58:59], v9 offset:58368
v_mfma_f32_16x16x32_bf16 v[40:43], v[64:67], v[180:183], v[40:43]
ds_read_b64_tr_b16 v[60:61], v9 offset:61440
v_mfma_f32_16x16x32_bf16 v[40:43], v[68:71], v[188:191], v[40:43]
ds_read_b64_tr_b16 v[62:63], v9 offset:62464
s_waitcnt lgkmcnt(10)
v_mfma_f32_16x16x32_bf16 v[28:31], v[72:75], v[176:179], v[28:31]
ds_read_b64_tr_b16 v[64:65], v10 offset:57344
s_waitcnt lgkmcnt(9)
v_mfma_f32_16x16x32_bf16 v[28:31], v[76:79], v[184:187], v[28:31]
ds_read_b64_tr_b16 v[66:67], v10 offset:58368
v_mfma_f32_16x16x32_bf16 v[44:47], v[72:75], v[180:183], v[44:47]
ds_read_b64_tr_b16 v[68:69], v10 offset:61440
v_mfma_f32_16x16x32_bf16 v[44:47], v[76:79], v[188:191], v[44:47]
ds_read_b64_tr_b16 v[70:71], v10 offset:62464
s_waitcnt vmcnt(11) lgkmcnt(10)
v_mfma_f32_16x16x32_bf16 v[16:19], v[48:51], v[192:195], v[16:19]
ds_read_b64_tr_b16 v[72:73], v11 offset:57344
buffer_load_dwordx4 v[112:115], v6, s[20:23], s66 offen offset:0 sc1
s_waitcnt vmcnt(11) lgkmcnt(9)
v_mfma_f32_16x16x32_bf16 v[16:19], v[52:55], v[200:203], v[16:19]
ds_read_b64_tr_b16 v[74:75], v11 offset:58368
s_waitcnt vmcnt(10)
v_mfma_f32_16x16x32_bf16 v[32:35], v[48:51], v[196:199], v[32:35]
ds_read_b64_tr_b16 v[76:77], v11 offset:61440
buffer_load_dwordx4 v[120:123], v6, s[20:23], s66 offen offset:2048 sc1
s_waitcnt vmcnt(10)
v_mfma_f32_16x16x32_bf16 v[32:35], v[52:55], v[204:207], v[32:35]
ds_read_b64_tr_b16 v[78:79], v11 offset:62464
s_waitcnt lgkmcnt(10)
v_mfma_f32_16x16x32_bf16 v[20:23], v[56:59], v[192:195], v[20:23]
ds_read_b64_tr_b16 v[48:49], v12 offset:0
buffer_load_dwordx4 v[116:119], v6, s[20:23], s66 offen offset:256 sc1
s_waitcnt lgkmcnt(9)
v_mfma_f32_16x16x32_bf16 v[20:23], v[60:63], v[200:203], v[20:23]
ds_read_b64_tr_b16 v[50:51], v12 offset:1024
v_mfma_f32_16x16x32_bf16 v[36:39], v[56:59], v[196:199], v[36:39]
ds_read_b64_tr_b16 v[52:53], v12 offset:4096
buffer_load_dwordx4 v[124:127], v6, s[20:23], s66 offen offset:2304 sc1
s_add_u32 s66, s66, 4096
s_and_b32 s66, s66, 0xffff
v_mfma_f32_16x16x32_bf16 v[36:39], v[60:63], v[204:207], v[36:39]
ds_read_b64_tr_b16 v[54:55], v12 offset:5120
s_waitcnt lgkmcnt(10)
v_mfma_f32_16x16x32_bf16 v[24:27], v[64:67], v[192:195], v[24:27]
ds_read_b64_tr_b16 v[56:57], v13 offset:0
s_waitcnt lgkmcnt(9)
v_mfma_f32_16x16x32_bf16 v[24:27], v[68:71], v[200:203], v[24:27]
ds_read_b64_tr_b16 v[58:59], v13 offset:1024
v_mfma_f32_16x16x32_bf16 v[40:43], v[64:67], v[196:199], v[40:43]
ds_read_b64_tr_b16 v[60:61], v13 offset:4096
v_mfma_f32_16x16x32_bf16 v[40:43], v[68:71], v[204:207], v[40:43]
ds_read_b64_tr_b16 v[62:63], v13 offset:5120
s_waitcnt lgkmcnt(10)
v_mfma_f32_16x16x32_bf16 v[28:31], v[72:75], v[192:195], v[28:31]
ds_read_b64_tr_b16 v[64:65], v14 offset:0
s_waitcnt lgkmcnt(9)
v_mfma_f32_16x16x32_bf16 v[28:31], v[76:79], v[200:203], v[28:31]
ds_read_b64_tr_b16 v[66:67], v14 offset:1024
v_mfma_f32_16x16x32_bf16 v[44:47], v[72:75], v[196:199], v[44:47]
ds_read_b64_tr_b16 v[68:69], v14 offset:4096
v_mfma_f32_16x16x32_bf16 v[44:47], v[76:79], v[204:207], v[44:47]
ds_read_b64_tr_b16 v[70:71], v14 offset:5120
s_waitcnt vmcnt(11) lgkmcnt(10)
v_mfma_f32_16x16x32_bf16 v[16:19], v[48:51], v[80:83], v[16:19]
ds_read_b64_tr_b16 v[72:73], v15 offset:0
buffer_load_dwordx4 v[128:131], v6, s[20:23], s66 offen offset:0 sc1
s_waitcnt vmcnt(11) lgkmcnt(9)
v_mfma_f32_16x16x32_bf16 v[16:19], v[52:55], v[88:91], v[16:19]
ds_read_b64_tr_b16 v[74:75], v15 offset:1024
s_waitcnt vmcnt(10)
v_mfma_f32_16x16x32_bf16 v[32:35], v[48:51], v[84:87], v[32:35]
ds_read_b64_tr_b16 v[76:77], v15 offset:4096
buffer_load_dwordx4 v[136:139], v6, s[20:23], s66 offen offset:2048 sc1
s_waitcnt vmcnt(10)
v_mfma_f32_16x16x32_bf16 v[32:35], v[52:55], v[92:95], v[32:35]
ds_read_b64_tr_b16 v[78:79], v15 offset:5120
s_waitcnt lgkmcnt(10)
v_mfma_f32_16x16x32_bf16 v[20:23], v[56:59], v[80:83], v[20:23]
ds_read_b64_tr_b16 v[48:49], v12 offset:8192
buffer_load_dwordx4 v[132:135], v6, s[20:23], s66 offen offset:256 sc1
s_waitcnt lgkmcnt(9)
v_mfma_f32_16x16x32_bf16 v[20:23], v[60:63], v[88:91], v[20:23]
ds_read_b64_tr_b16 v[50:51], v12 offset:9216
v_mfma_f32_16x16x32_bf16 v[36:39], v[56:59], v[84:87], v[36:39]
ds_read_b64_tr_b16 v[52:53], v12 offset:12288
buffer_load_dwordx4 v[140:143], v6, s[20:23], s66 offen offset:2304 sc1
s_add_u32 s66, s66, 4096
s_and_b32 s66, s66, 0xffff
v_mfma_f32_16x16x32_bf16 v[36:39], v[60:63], v[92:95], v[36:39]
ds_read_b64_tr_b16 v[54:55], v12 offset:13312
s_waitcnt lgkmcnt(10)
v_mfma_f32_16x16x32_bf16 v[24:27], v[64:67], v[80:83], v[24:27]
ds_read_b64_tr_b16 v[56:57], v13 offset:8192
s_waitcnt lgkmcnt(9)
v_mfma_f32_16x16x32_bf16 v[24:27], v[68:71], v[88:91], v[24:27]
ds_read_b64_tr_b16 v[58:59], v13 offset:9216
v_mfma_f32_16x16x32_bf16 v[40:43], v[64:67], v[84:87], v[40:43]
ds_read_b64_tr_b16 v[60:61], v13 offset:12288
v_mfma_f32_16x16x32_bf16 v[40:43], v[68:71], v[92:95], v[40:43]
ds_read_b64_tr_b16 v[62:63], v13 offset:13312
s_waitcnt lgkmcnt(10)
v_mfma_f32_16x16x32_bf16 v[28:31], v[72:75], v[80:83], v[28:31]
ds_read_b64_tr_b16 v[64:65], v14 offset:8192
s_waitcnt lgkmcnt(9)
v_mfma_f32_16x16x32_bf16 v[28:31], v[76:79], v[88:91], v[28:31]
ds_read_b64_tr_b16 v[66:67], v14 offset:9216
v_mfma_f32_16x16x32_bf16 v[44:47], v[72:75], v[84:87], v[44:47]
ds_read_b64_tr_b16 v[68:69], v14 offset:12288
v_mfma_f32_16x16x32_bf16 v[44:47], v[76:79], v[92:95], v[44:47]
ds_read_b64_tr_b16 v[70:71], v14 offset:13312
s_waitcnt vmcnt(11) lgkmcnt(10)
v_mfma_f32_16x16x32_bf16 v[16:19], v[48:51], v[96:99], v[16:19]
ds_read_b64_tr_b16 v[72:73], v15 offset:8192
buffer_load_dwordx4 v[144:147], v6, s[20:23], s66 offen offset:0 sc1
s_waitcnt vmcnt(11) lgkmcnt(9)
v_mfma_f32_16x16x32_bf16 v[16:19], v[52:55], v[104:107], v[16:19]
ds_read_b64_tr_b16 v[74:75], v15 offset:9216
s_waitcnt vmcnt(10)
v_mfma_f32_16x16x32_bf16 v[32:35], v[48:51], v[100:103], v[32:35]
ds_read_b64_tr_b16 v[76:77], v15 offset:12288
buffer_load_dwordx4 v[152:155], v6, s[20:23], s66 offen offset:2048 sc1
s_waitcnt vmcnt(10)
v_mfma_f32_16x16x32_bf16 v[32:35], v[52:55], v[108:111], v[32:35]
ds_read_b64_tr_b16 v[78:79], v15 offset:13312
s_waitcnt lgkmcnt(10)
v_mfma_f32_16x16x32_bf16 v[20:23], v[56:59], v[96:99], v[20:23]
ds_read_b64_tr_b16 v[48:49], v12 offset:16384
buffer_load_dwordx4 v[148:151], v6, s[20:23], s66 offen offset:256 sc1
s_waitcnt lgkmcnt(9)
v_mfma_f32_16x16x32_bf16 v[20:23], v[60:63], v[104:107], v[20:23]
ds_read_b64_tr_b16 v[50:51], v12 offset:17408
v_mfma_f32_16x16x32_bf16 v[36:39], v[56:59], v[100:103], v[36:39]
ds_read_b64_tr_b16 v[52:53], v12 offset:20480
buffer_load_dwordx4 v[156:159], v6, s[20:23], s66 offen offset:2304 sc1
s_add_u32 s66, s66, 4096
s_and_b32 s66, s66, 0xffff
v_mfma_f32_16x16x32_bf16 v[36:39], v[60:63], v[108:111], v[36:39]
ds_read_b64_tr_b16 v[54:55], v12 offset:21504
s_waitcnt lgkmcnt(10)
v_mfma_f32_16x16x32_bf16 v[24:27], v[64:67], v[96:99], v[24:27]
ds_read_b64_tr_b16 v[56:57], v13 offset:16384
s_waitcnt lgkmcnt(9)
v_mfma_f32_16x16x32_bf16 v[24:27], v[68:71], v[104:107], v[24:27]
ds_read_b64_tr_b16 v[58:59], v13 offset:17408
v_mfma_f32_16x16x32_bf16 v[40:43], v[64:67], v[100:103], v[40:43]
ds_read_b64_tr_b16 v[60:61], v13 offset:20480
v_mfma_f32_16x16x32_bf16 v[40:43], v[68:71], v[108:111], v[40:43]
ds_read_b64_tr_b16 v[62:63], v13 offset:21504
s_waitcnt lgkmcnt(10)
v_mfma_f32_16x16x32_bf16 v[28:31], v[72:75], v[96:99], v[28:31]
ds_read_b64_tr_b16 v[64:65], v14 offset:16384
s_waitcnt lgkmcnt(9)
v_mfma_f32_16x16x32_bf16 v[28:31], v[76:79], v[104:107], v[28:31]
ds_read_b64_tr_b16 v[66:67], v14 offset:17408
v_mfma_f32_16x16x32_bf16 v[44:47], v[72:75], v[100:103], v[44:47]
ds_read_b64_tr_b16 v[68:69], v14 offset:20480
v_mfma_f32_16x16x32_bf16 v[44:47], v[76:79], v[108:111], v[44:47]
ds_read_b64_tr_b16 v[70:71], v14 offset:21504
s_waitcnt vmcnt(11) lgkmcnt(10)
v_mfma_f32_16x16x32_bf16 v[16:19], v[48:51], v[112:115], v[16:19]
ds_read_b64_tr_b16 v[72:73], v15 offset:16384
buffer_load_dwordx4 v[160:163], v6, s[20:23], s66 offen offset:0 sc1
s_waitcnt vmcnt(11) lgkmcnt(9)
v_mfma_f32_16x16x32_bf16 v[16:19], v[52:55], v[120:123], v[16:19]
ds_read_b64_tr_b16 v[74:75], v15 offset:17408
s_waitcnt vmcnt(10)
v_mfma_f32_16x16x32_bf16 v[32:35], v[48:51], v[116:119], v[32:35]
ds_read_b64_tr_b16 v[76:77], v15 offset:20480
buffer_load_dwordx4 v[168:171], v6, s[20:23], s66 offen offset:2048 sc1
s_waitcnt vmcnt(10)
v_mfma_f32_16x16x32_bf16 v[32:35], v[52:55], v[124:127], v[32:35]
ds_read_b64_tr_b16 v[78:79], v15 offset:21504
s_waitcnt lgkmcnt(10)
v_mfma_f32_16x16x32_bf16 v[20:23], v[56:59], v[112:115], v[20:23]
ds_read_b64_tr_b16 v[48:49], v12 offset:24576
buffer_load_dwordx4 v[164:167], v6, s[20:23], s66 offen offset:256 sc1
s_waitcnt lgkmcnt(9)
v_mfma_f32_16x16x32_bf16 v[20:23], v[60:63], v[120:123], v[20:23]
ds_read_b64_tr_b16 v[50:51], v12 offset:25600
v_mfma_f32_16x16x32_bf16 v[36:39], v[56:59], v[116:119], v[36:39]
ds_read_b64_tr_b16 v[52:53], v12 offset:28672
buffer_load_dwordx4 v[172:175], v6, s[20:23], s66 offen offset:2304 sc1
s_add_u32 s66, s66, 4096
s_and_b32 s66, s66, 0xffff
v_mfma_f32_16x16x32_bf16 v[36:39], v[60:63], v[124:127], v[36:39]
ds_read_b64_tr_b16 v[54:55], v12 offset:29696
s_waitcnt lgkmcnt(10)
v_mfma_f32_16x16x32_bf16 v[24:27], v[64:67], v[112:115], v[24:27]
ds_read_b64_tr_b16 v[56:57], v13 offset:24576
s_waitcnt lgkmcnt(9)
v_mfma_f32_16x16x32_bf16 v[24:27], v[68:71], v[120:123], v[24:27]
ds_read_b64_tr_b16 v[58:59], v13 offset:25600
v_mfma_f32_16x16x32_bf16 v[40:43], v[64:67], v[116:119], v[40:43]
ds_read_b64_tr_b16 v[60:61], v13 offset:28672
v_mfma_f32_16x16x32_bf16 v[40:43], v[68:71], v[124:127], v[40:43]
ds_read_b64_tr_b16 v[62:63], v13 offset:29696
s_waitcnt lgkmcnt(10)
v_mfma_f32_16x16x32_bf16 v[28:31], v[72:75], v[112:115], v[28:31]
ds_read_b64_tr_b16 v[64:65], v14 offset:24576
s_waitcnt lgkmcnt(9)
v_mfma_f32_16x16x32_bf16 v[28:31], v[76:79], v[120:123], v[28:31]
ds_read_b64_tr_b16 v[66:67], v14 offset:25600
v_mfma_f32_16x16x32_bf16 v[44:47], v[72:75], v[116:119], v[44:47]
ds_read_b64_tr_b16 v[68:69], v14 offset:28672
v_mfma_f32_16x16x32_bf16 v[44:47], v[76:79], v[124:127], v[44:47]
ds_read_b64_tr_b16 v[70:71], v14 offset:29696
s_waitcnt vmcnt(11) lgkmcnt(10)
v_mfma_f32_16x16x32_bf16 v[16:19], v[48:51], v[128:131], v[16:19]
ds_read_b64_tr_b16 v[72:73], v15 offset:24576
buffer_load_dwordx4 v[176:179], v6, s[20:23], s66 offen offset:0 sc1
s_waitcnt vmcnt(11) lgkmcnt(9)
v_mfma_f32_16x16x32_bf16 v[16:19], v[52:55], v[136:139], v[16:19]
ds_read_b64_tr_b16 v[74:75], v15 offset:25600
s_waitcnt vmcnt(10)
v_mfma_f32_16x16x32_bf16 v[32:35], v[48:51], v[132:135], v[32:35]
ds_read_b64_tr_b16 v[76:77], v15 offset:28672
buffer_load_dwordx4 v[184:187], v6, s[20:23], s66 offen offset:2048 sc1
s_waitcnt vmcnt(10)
v_mfma_f32_16x16x32_bf16 v[32:35], v[52:55], v[140:143], v[32:35]
ds_read_b64_tr_b16 v[78:79], v15 offset:29696
s_waitcnt lgkmcnt(10)
v_mfma_f32_16x16x32_bf16 v[20:23], v[56:59], v[128:131], v[20:23]
ds_read_b64_tr_b16 v[48:49], v12 offset:32768
buffer_load_dwordx4 v[180:183], v6, s[20:23], s66 offen offset:256 sc1
s_waitcnt lgkmcnt(9)
v_mfma_f32_16x16x32_bf16 v[20:23], v[60:63], v[136:139], v[20:23]
ds_read_b64_tr_b16 v[50:51], v12 offset:33792
v_mfma_f32_16x16x32_bf16 v[36:39], v[56:59], v[132:135], v[36:39]
ds_read_b64_tr_b16 v[52:53], v12 offset:36864
buffer_load_dwordx4 v[188:191], v6, s[20:23], s66 offen offset:2304 sc1
s_add_u32 s66, s66, 4096
s_and_b32 s66, s66, 0xffff
v_mfma_f32_16x16x32_bf16 v[36:39], v[60:63], v[140:143], v[36:39]
ds_read_b64_tr_b16 v[54:55], v12 offset:37888
s_waitcnt lgkmcnt(10)
v_mfma_f32_16x16x32_bf16 v[24:27], v[64:67], v[128:131], v[24:27]
ds_read_b64_tr_b16 v[56:57], v13 offset:32768
s_waitcnt lgkmcnt(9)
v_mfma_f32_16x16x32_bf16 v[24:27], v[68:71], v[136:139], v[24:27]
ds_read_b64_tr_b16 v[58:59], v13 offset:33792
v_mfma_f32_16x16x32_bf16 v[40:43], v[64:67], v[132:135], v[40:43]
ds_read_b64_tr_b16 v[60:61], v13 offset:36864
v_mfma_f32_16x16x32_bf16 v[40:43], v[68:71], v[140:143], v[40:43]
ds_read_b64_tr_b16 v[62:63], v13 offset:37888
s_waitcnt lgkmcnt(10)
v_mfma_f32_16x16x32_bf16 v[28:31], v[72:75], v[128:131], v[28:31]
ds_read_b64_tr_b16 v[64:65], v14 offset:32768
s_waitcnt lgkmcnt(9)
v_mfma_f32_16x16x32_bf16 v[28:31], v[76:79], v[136:139], v[28:31]
ds_read_b64_tr_b16 v[66:67], v14 offset:33792
v_mfma_f32_16x16x32_bf16 v[44:47], v[72:75], v[132:135], v[44:47]
ds_read_b64_tr_b16 v[68:69], v14 offset:36864
v_mfma_f32_16x16x32_bf16 v[44:47], v[76:79], v[140:143], v[44:47]
ds_read_b64_tr_b16 v[70:71], v14 offset:37888
s_waitcnt vmcnt(11) lgkmcnt(10)
v_mfma_f32_16x16x32_bf16 v[16:19], v[48:51], v[144:147], v[16:19]
ds_read_b64_tr_b16 v[72:73], v15 offset:32768
buffer_load_dwordx4 v[192:195], v6, s[20:23], s66 offen offset:0 sc1
s_waitcnt vmcnt(11) lgkmcnt(9)
v_mfma_f32_16x16x32_bf16 v[16:19], v[52:55], v[152:155], v[16:19]
ds_read_b64_tr_b16 v[74:75], v15 offset:33792
s_waitcnt vmcnt(10)
v_mfma_f32_16x16x32_bf16 v[32:35], v[48:51], v[148:151], v[32:35]
ds_read_b64_tr_b16 v[76:77], v15 offset:36864
buffer_load_dwordx4 v[200:203], v6, s[20:23], s66 offen offset:2048 sc1
s_waitcnt vmcnt(10)
v_mfma_f32_16x16x32_bf16 v[32:35], v[52:55], v[156:159], v[32:35]
ds_read_b64_tr_b16 v[78:79], v15 offset:37888
s_waitcnt lgkmcnt(10)
v_mfma_f32_16x16x32_bf16 v[20:23], v[56:59], v[144:147], v[20:23]
ds_read_b64_tr_b16 v[48:49], v12 offset:40960
buffer_load_dwordx4 v[196:199], v6, s[20:23], s66 offen offset:256 sc1
s_waitcnt lgkmcnt(9)
v_mfma_f32_16x16x32_bf16 v[20:23], v[60:63], v[152:155], v[20:23]
ds_read_b64_tr_b16 v[50:51], v12 offset:41984
v_mfma_f32_16x16x32_bf16 v[36:39], v[56:59], v[148:151], v[36:39]
ds_read_b64_tr_b16 v[52:53], v12 offset:45056
buffer_load_dwordx4 v[204:207], v6, s[20:23], s66 offen offset:2304 sc1
s_add_u32 s66, s66, 4096
s_and_b32 s66, s66, 0xffff
v_mfma_f32_16x16x32_bf16 v[36:39], v[60:63], v[156:159], v[36:39]
ds_read_b64_tr_b16 v[54:55], v12 offset:46080
s_waitcnt lgkmcnt(10)
v_mfma_f32_16x16x32_bf16 v[24:27], v[64:67], v[144:147], v[24:27]
ds_read_b64_tr_b16 v[56:57], v13 offset:40960
s_waitcnt lgkmcnt(9)
v_mfma_f32_16x16x32_bf16 v[24:27], v[68:71], v[152:155], v[24:27]
ds_read_b64_tr_b16 v[58:59], v13 offset:41984
v_mfma_f32_16x16x32_bf16 v[40:43], v[64:67], v[148:151], v[40:43]
ds_read_b64_tr_b16 v[60:61], v13 offset:45056
v_mfma_f32_16x16x32_bf16 v[40:43], v[68:71], v[156:159], v[40:43]
ds_read_b64_tr_b16 v[62:63], v13 offset:46080
s_waitcnt lgkmcnt(10)
v_mfma_f32_16x16x32_bf16 v[28:31], v[72:75], v[144:147], v[28:31]
ds_read_b64_tr_b16 v[64:65], v14 offset:40960
s_waitcnt lgkmcnt(9)
v_mfma_f32_16x16x32_bf16 v[28:31], v[76:79], v[152:155], v[28:31]
ds_read_b64_tr_b16 v[66:67], v14 offset:41984
v_mfma_f32_16x16x32_bf16 v[44:47], v[72:75], v[148:151], v[44:47]
ds_read_b64_tr_b16 v[68:69], v14 offset:45056
v_mfma_f32_16x16x32_bf16 v[44:47], v[76:79], v[156:159], v[44:47]
ds_read_b64_tr_b16 v[70:71], v14 offset:46080
s_waitcnt vmcnt(11) lgkmcnt(10)
v_mfma_f32_16x16x32_bf16 v[16:19], v[48:51], v[160:163], v[16:19]
ds_read_b64_tr_b16 v[72:73], v15 offset:40960
s_waitcnt vmcnt(10) lgkmcnt(9)
v_mfma_f32_16x16x32_bf16 v[16:19], v[52:55], v[168:171], v[16:19]
ds_read_b64_tr_b16 v[74:75], v15 offset:41984
s_waitcnt vmcnt(9)
v_mfma_f32_16x16x32_bf16 v[32:35], v[48:51], v[164:167], v[32:35]
ds_read_b64_tr_b16 v[76:77], v15 offset:45056
s_waitcnt vmcnt(8)
v_mfma_f32_16x16x32_bf16 v[32:35], v[52:55], v[172:175], v[32:35]
ds_read_b64_tr_b16 v[78:79], v15 offset:46080
s_waitcnt lgkmcnt(10)
v_mfma_f32_16x16x32_bf16 v[20:23], v[56:59], v[160:163], v[20:23]
ds_read_b64_tr_b16 v[48:49], v12 offset:49152
s_waitcnt lgkmcnt(9)
v_mfma_f32_16x16x32_bf16 v[20:23], v[60:63], v[168:171], v[20:23]
ds_read_b64_tr_b16 v[50:51], v12 offset:50176
v_mfma_f32_16x16x32_bf16 v[36:39], v[56:59], v[164:167], v[36:39]
ds_read_b64_tr_b16 v[52:53], v12 offset:53248
v_mfma_f32_16x16x32_bf16 v[36:39], v[60:63], v[172:175], v[36:39]
ds_read_b64_tr_b16 v[54:55], v12 offset:54272
s_waitcnt lgkmcnt(10)
v_mfma_f32_16x16x32_bf16 v[24:27], v[64:67], v[160:163], v[24:27]
ds_read_b64_tr_b16 v[56:57], v13 offset:49152
s_waitcnt lgkmcnt(9)
v_mfma_f32_16x16x32_bf16 v[24:27], v[68:71], v[168:171], v[24:27]
ds_read_b64_tr_b16 v[58:59], v13 offset:50176
v_mfma_f32_16x16x32_bf16 v[40:43], v[64:67], v[164:167], v[40:43]
ds_read_b64_tr_b16 v[60:61], v13 offset:53248
v_mfma_f32_16x16x32_bf16 v[40:43], v[68:71], v[172:175], v[40:43]
ds_read_b64_tr_b16 v[62:63], v13 offset:54272
s_waitcnt lgkmcnt(10)
v_mfma_f32_16x16x32_bf16 v[28:31], v[72:75], v[160:163], v[28:31]
ds_read_b64_tr_b16 v[64:65], v14 offset:49152
s_waitcnt lgkmcnt(9)
v_mfma_f32_16x16x32_bf16 v[28:31], v[76:79], v[168:171], v[28:31]
ds_read_b64_tr_b16 v[66:67], v14 offset:50176
v_mfma_f32_16x16x32_bf16 v[44:47], v[72:75], v[164:167], v[44:47]
ds_read_b64_tr_b16 v[68:69], v14 offset:53248
v_mfma_f32_16x16x32_bf16 v[44:47], v[76:79], v[172:175], v[44:47]
ds_read_b64_tr_b16 v[70:71], v14 offset:54272
s_waitcnt vmcnt(7) lgkmcnt(10)
v_mfma_f32_16x16x32_bf16 v[16:19], v[48:51], v[176:179], v[16:19]
ds_read_b64_tr_b16 v[72:73], v15 offset:49152
s_waitcnt vmcnt(6) lgkmcnt(9)
v_mfma_f32_16x16x32_bf16 v[16:19], v[52:55], v[184:187], v[16:19]
ds_read_b64_tr_b16 v[74:75], v15 offset:50176
s_waitcnt vmcnt(5)
v_mfma_f32_16x16x32_bf16 v[32:35], v[48:51], v[180:183], v[32:35]
ds_read_b64_tr_b16 v[76:77], v15 offset:53248
s_waitcnt vmcnt(4)
v_mfma_f32_16x16x32_bf16 v[32:35], v[52:55], v[188:191], v[32:35]
ds_read_b64_tr_b16 v[78:79], v15 offset:54272
s_waitcnt lgkmcnt(10)
v_mfma_f32_16x16x32_bf16 v[20:23], v[56:59], v[176:179], v[20:23]
ds_read_b64_tr_b16 v[48:49], v12 offset:57344
s_waitcnt lgkmcnt(9)
v_mfma_f32_16x16x32_bf16 v[20:23], v[60:63], v[184:187], v[20:23]
ds_read_b64_tr_b16 v[50:51], v12 offset:58368
v_mfma_f32_16x16x32_bf16 v[36:39], v[56:59], v[180:183], v[36:39]
ds_read_b64_tr_b16 v[52:53], v12 offset:61440
v_mfma_f32_16x16x32_bf16 v[36:39], v[60:63], v[188:191], v[36:39]
ds_read_b64_tr_b16 v[54:55], v12 offset:62464
s_waitcnt lgkmcnt(10)
v_mfma_f32_16x16x32_bf16 v[24:27], v[64:67], v[176:179], v[24:27]
ds_read_b64_tr_b16 v[56:57], v13 offset:57344
s_waitcnt lgkmcnt(9)
v_mfma_f32_16x16x32_bf16 v[24:27], v[68:71], v[184:187], v[24:27]
ds_read_b64_tr_b16 v[58:59], v13 offset:58368
v_mfma_f32_16x16x32_bf16 v[40:43], v[64:67], v[180:183], v[40:43]
ds_read_b64_tr_b16 v[60:61], v13 offset:61440
v_mfma_f32_16x16x32_bf16 v[40:43], v[68:71], v[188:191], v[40:43]
ds_read_b64_tr_b16 v[62:63], v13 offset:62464
s_waitcnt lgkmcnt(10)
v_mfma_f32_16x16x32_bf16 v[28:31], v[72:75], v[176:179], v[28:31]
ds_read_b64_tr_b16 v[64:65], v14 offset:57344
s_waitcnt lgkmcnt(9)
v_mfma_f32_16x16x32_bf16 v[28:31], v[76:79], v[184:187], v[28:31]
ds_read_b64_tr_b16 v[66:67], v14 offset:58368
v_mfma_f32_16x16x32_bf16 v[44:47], v[72:75], v[180:183], v[44:47]
ds_read_b64_tr_b16 v[68:69], v14 offset:61440
v_mfma_f32_16x16x32_bf16 v[44:47], v[76:79], v[188:191], v[44:47]
ds_read_b64_tr_b16 v[70:71], v14 offset:62464
s_waitcnt vmcnt(3) lgkmcnt(10)
v_mfma_f32_16x16x32_bf16 v[16:19], v[48:51], v[192:195], v[16:19]
ds_read_b64_tr_b16 v[72:73], v15 offset:57344
s_waitcnt vmcnt(2) lgkmcnt(9)
v_mfma_f32_16x16x32_bf16 v[16:19], v[52:55], v[200:203], v[16:19]
ds_read_b64_tr_b16 v[74:75], v15 offset:58368
s_waitcnt vmcnt(1)
v_mfma_f32_16x16x32_bf16 v[32:35], v[48:51], v[196:199], v[32:35]
ds_read_b64_tr_b16 v[76:77], v15 offset:61440
s_waitcnt vmcnt(0)
v_mfma_f32_16x16x32_bf16 v[32:35], v[52:55], v[204:207], v[32:35]
ds_read_b64_tr_b16 v[78:79], v15 offset:62464
s_waitcnt lgkmcnt(10)
v_mfma_f32_16x16x32_bf16 v[20:23], v[56:59], v[192:195], v[20:23]
v_add_u32 v5, s34, 22
s_mov_b64 exec, 1
ds_write_b32 v3, v5
s_mov_b64 exec, -1
s_waitcnt lgkmcnt(9)
v_mfma_f32_16x16x32_bf16 v[20:23], v[60:63], v[200:203], v[20:23]
s_lshl2_add_u32 s73, s61, s58
s_lshl4_add_u32 s66, s61, s62
s_lshl2_add_u32 s68, s66, s58
v_mfma_f32_16x16x32_bf16 v[36:39], v[56:59], v[196:199], v[36:39]
s_lshl_b32 s68, s68, 12
s_add_u32 s68, s68, 26214400
s_lshl_b32 s66, s61, 7
v_mfma_f32_16x16x32_bf16 v[36:39], v[60:63], v[204:207], v[36:39]
s_add_u32 s66, s66, s62
s_lshl_b32 s66, s66, 7
s_add_u32 s66, s66, 274432
s_waitcnt lgkmcnt(7)
v_mfma_f32_16x16x32_bf16 v[24:27], v[64:67], v[192:195], v[24:27]
s_lshl_b32 s74, s73, 13
s_add_u32 s74, s74, 524288
s_lshl_b32 s67, s62, 9
s_waitcnt lgkmcnt(5)
v_mfma_f32_16x16x32_bf16 v[24:27], v[68:71], v[200:203], v[24:27]
s_add_u32 s67, s67, s74
v_lshlrev_b32 v6, 4, v0
s_mov_b32 s69, 0x3f803f80
v_mfma_f32_16x16x32_bf16 v[40:43], v[64:67], v[196:199], v[40:43]
v_mov_b32 v8, 0
v_mov_b32 v9, 0
v_mov_b32 v10, 0
v_mfma_f32_16x16x32_bf16 v[40:43], v[68:71], v[204:207], v[40:43]
v_mov_b32 v12, 0
v_mov_b32 v13, 0
v_mov_b32 v14, 0
s_waitcnt lgkmcnt(3)
v_mfma_f32_16x16x32_bf16 v[28:31], v[72:75], v[192:195], v[28:31]
v_mov_b32 v11, v208
v_cvt_pk_bf16_f32 v240, v16, v17
v_cvt_pk_bf16_f32 v241, v18, v19
s_waitcnt lgkmcnt(1)
v_mfma_f32_16x16x32_bf16 v[28:31], v[76:79], v[200:203], v[28:31]
v_cvt_pk_bf16_f32 v248, v32, v33
v_cvt_pk_bf16_f32 v249, v34, v35
v_cvt_pk_bf16_f32 v242, v20, v21
v_mfma_f32_16x16x32_bf16 v[44:47], v[72:75], v[196:199], v[44:47]
v_cvt_pk_bf16_f32 v243, v22, v23
v_cvt_pk_bf16_f32 v250, v36, v37
v_cvt_pk_bf16_f32 v251, v38, v39
v_mfma_f32_16x16x32_bf16 v[44:47], v[76:79], v[204:207], v[44:47]
s_cmp_eq_u32 s63, 0
v_cvt_pk_bf16_f32 v244, v24, v25
v_cvt_pk_bf16_f32 v245, v26, v27
v_cvt_pk_bf16_f32 v252, v40, v41
v_cvt_pk_bf16_f32 v253, v42, v43
v_cvt_pk_bf16_f32 v246, v28, v29
v_cvt_pk_bf16_f32 v247, v30, v31
s_nop 0
v_cvt_pk_bf16_f32 v254, v44, v45
v_cvt_pk_bf16_f32 v255, v46, v47
s_cselect_b64 exec, -1, 0
s_cmp_eq_u32 s57, 0
s_cbranch_scc1 far_171
buffer_store_dwordx4 v[240:243], v6, s[20:23], s68 offen offset:0
buffer_store_dwordx4 v[244:247], v6, s[20:23], s68 offen offset:1024
buffer_store_dwordx4 v[248:251], v6, s[20:23], s68 offen offset:2048
buffer_store_dwordx4 v[252:255], v6, s[20:23], s68 offen offset:3072
near_172:
s_mov_b64 exec, -1
v_dot2c_f32_bf16 v8, s69, v240
v_dot2c_f32_bf16 v9, v240, v240
v_dot2c_f32_bf16 v10, v232, v240
v_dot2c_f32_bf16 v12, s69, v248
v_dot2c_f32_bf16 v13, v248, v248
v_dot2c_f32_bf16 v14, v232, v248
v_dot2c_f32_bf16 v8, s69, v241
v_dot2c_f32_bf16 v9, v241, v241
v_dot2c_f32_bf16 v10, v233, v241
v_dot2c_f32_bf16 v12, s69, v249
v_dot2c_f32_bf16 v13, v249, v249
v_dot2c_f32_bf16 v14, v233, v249
v_dot2c_f32_bf16 v8, s69, v242
v_dot2c_f32_bf16 v9, v242, v242
v_dot2c_f32_bf16 v10, v234, v242
v_dot2c_f32_bf16 v12, s69, v250
v_dot2c_f32_bf16 v13, v250, v250
v_dot2c_f32_bf16 v14, v234, v250
v_dot2c_f32_bf16 v8, s69, v243
v_dot2c_f32_bf16 v9, v243, v243
v_dot2c_f32_bf16 v10, v235, v243
v_dot2c_f32_bf16 v12, s69, v251
v_dot2c_f32_bf16 v13, v251, v251
v_dot2c_f32_bf16 v14, v235, v251
v_dot2c_f32_bf16 v8, s69, v244
v_dot2c_f32_bf16 v9, v244, v244
v_dot2c_f32_bf16 v10, v236, v244
v_dot2c_f32_bf16 v12, s69, v252
v_dot2c_f32_bf16 v13, v252, v252
v_dot2c_f32_bf16 v14, v236, v252
v_dot2c_f32_bf16 v8, s69, v245
v_dot2c_f32_bf16 v9, v245, v245
v_dot2c_f32_bf16 v10, v237, v245
v_dot2c_f32_bf16 v12, s69, v253
v_dot2c_f32_bf16 v13, v253, v253
v_dot2c_f32_bf16 v14, v237, v253
v_dot2c_f32_bf16 v8, s69, v246
v_dot2c_f32_bf16 v9, v246, v246
v_dot2c_f32_bf16 v10, v238, v246
v_dot2c_f32_bf16 v12, s69, v254
v_dot2c_f32_bf16 v13, v254, v254
v_dot2c_f32_bf16 v14, v238, v254
v_dot2c_f32_bf16 v8, s69, v247
v_dot2c_f32_bf16 v9, v247, v247
v_dot2c_f32_bf16 v10, v239, v247
v_dot2c_f32_bf16 v12, s69, v255
v_dot2c_f32_bf16 v13, v255, v255
v_dot2c_f32_bf16 v14, v239, v255
v_mov_b32 v15, v11
v_lshrrev_b32 v7, 5, v0
v_mul_u32_u24 v7, 3584, v7
v_permlane16_swap_b32 v8, v12
v_permlane16_swap_b32 v9, v13
v_permlane16_swap_b32 v10, v14
v_permlane16_swap_b32 v11, v15
v_pk_add_f32 v[8:9], v[8:9], v[12:13]
v_pk_add_f32 v[10:11], v[10:11], v[14:15]
v_mov_b32 v12, v8
v_mov_b32 v13, v9
v_mov_b32 v14, v10
v_mov_b32 v15, v11
v_permlane32_swap_b32 v12, v8
v_permlane32_swap_b32 v13, v9
v_permlane32_swap_b32 v14, v10
v_permlane32_swap_b32 v15, v11
v_pk_add_f32 v[8:9], v[8:9], v[12:13]
v_pk_add_f32 v[10:11], v[10:11], v[14:15]
v_add_u32 v7, v6, v7
v_max_u32 v8, 1, v8
v_max_u32 v9, 1, v9
v_max_u32 v10, 1, v10
v_max_u32 v11, 1, v11
s_mov_b32 exec_hi, 0
s_cmp_eq_u32 s57, 0
s_cbranch_scc1 far_173
buffer_store_dwordx4 v[8:11], v6, s[24:27], s67 offen
near_174:
s_mov_b32 exec_hi, -1
v_lshlrev_b32 v16, 16, v240
v_and_b32 v17, 0xffff0000, v240
v_lshlrev_b32 v18, 16, v241
v_and_b32 v19, 0xffff0000, v241
v_lshlrev_b32 v20, 16, v242
v_and_b32 v21, 0xffff0000, v242
v_lshlrev_b32 v22, 16, v243
v_and_b32 v23, 0xffff0000, v243
v_lshlrev_b32 v24, 16, v244
v_and_b32 v25, 0xffff0000, v244
v_lshlrev_b32 v26, 16, v245
v_and_b32 v27, 0xffff0000, v245
v_lshlrev_b32 v28, 16, v246
v_and_b32 v29, 0xffff0000, v246
v_lshlrev_b32 v30, 16, v247
v_and_b32 v31, 0xffff0000, v247
v_lshlrev_b32 v32, 16, v248
v_and_b32 v33, 0xffff0000, v248
v_lshlrev_b32 v34, 16, v249
v_and_b32 v35, 0xffff0000, v249
v_lshlrev_b32 v36, 16, v250
v_and_b32 v37, 0xffff0000, v250
v_lshlrev_b32 v38, 16, v251
v_and_b32 v39, 0xffff0000, v251
v_lshlrev_b32 v40, 16, v252
v_and_b32 v41, 0xffff0000, v252
v_lshlrev_b32 v42, 16, v253
v_and_b32 v43, 0xffff0000, v253
v_lshlrev_b32 v44, 16, v254
v_and_b32 v45, 0xffff0000, v254
v_lshlrev_b32 v46, 16, v255
v_and_b32 v47, 0xffff0000, v255
v_and_b32 v14, 15, v0
v_lshlrev_b32 v14, 11, v14
v_bfe_u32 v15, v0, 4, 1
v_lshl_add_u32 v14, v15, 5, v14
v_lshrrev_b32 v15, 5, v0
v_lshl_add_u32 v14, v15, 4, v14
s_lshl2_add_u32 s70, s61, s58
s_lshl_b32 s70, s70, 16
s_lshl_b32 s71, s62, 7
s_add_u32 s70, s70, s71
s_add_u32 s71, s70, 0x8000
s_lshl_b32 s67, s62, 6
s_sub_u32 s68, s66, 2048
s_lshl1_add_u32 s69, s67, s68
s_sub_u32 s69, s69, 10240
s_sub_u32 s72, s68, s67
s_add_u32 s72, s72, 4096
s_lshl_b32 s75, s73, 5
s_add_u32 s75, s75, 1
v_and_b32 v15, 48, v0
v_add_u32 v13, s75, v0
v_lshlrev_b32 v4, 1, v15
s_mov_b64 exec, 1
s_waitcnt vmcnt(1)
s_cmp_eq_u32 s57, 0
s_cbranch_scc1 far_175
buffer_store_dword v212, v3, s[24:27], s66 offen
near_176:
s_mov_b64 exec, -1
v_add_u32 v5, s34, 23
s_mov_b64 exec, 1
ds_write_b32 v3, v5
s_mov_b64 exec, -1
s_waitcnt vmcnt(1)
buffer_load_dwordx4 v[80:83], v7, s[24:27], s74 offen offset:0 sc1
buffer_load_dwordx4 v[84:87], v7, s[24:27], s74 offen offset:512 sc1
buffer_load_dwordx4 v[88:91], v7, s[24:27], s74 offen offset:1024 sc1
buffer_load_dwordx4 v[92:95], v7, s[24:27], s74 offen offset:1536 sc1
buffer_load_dwordx4 v[96:99], v7, s[24:27], s74 offen offset:2048 sc1
buffer_load_dwordx4 v[100:103], v7, s[24:27], s74 offen offset:2560 sc1
buffer_load_dwordx4 v[104:107], v7, s[24:27], s74 offen offset:3072 sc1
buffer_load_dwordx4 v[108:111], v7, s[24:27], s74 offen offset:3584 sc1
s_cmp_eq_u32 s63, 0
s_cbranch_scc0 mhz_177
v_lshrrev_b32 v196, 4, v0
s_cmp_eq_u32 1, 0
s_cbranch_scc0 mq_178
v_bfe_u32 v197, v0, 1, 3
v_xor_b32 v197, v197, v196
v_lshlrev_b32 v197, 4, v197
v_and_b32 v198, 15, v0
v_lshl_add_u32 v192, v198, 7, v197
v_xor_b32 v193, 64, v192
s_branch mq_179
mq_178:
v_lshlrev_b32 v192, 4, v0
v_add_u32 v193, 1024, v192
mq_179:
s_lshl_b32 s46, s65, 13
s_add_u32 s46, s46, 86016
v_add_u32 v192, s46, v192
v_add_u32 v193, s46, v193
v_bfe_u32 v197, v0, 2, 2
v_lshl_add_u32 v197, v196, 3, v197
v_bfe_u32 v198, v0, 3, 2
s_lshl_b32 s46, s64, 1
v_xor_b32 v198, s46, v198
v_lshlrev_b32 v198, 5, v198
v_lshl_add_u32 v197, v197, 7, v198
v_and_b32 v198, 3, v0
v_lshl_add_u32 v197, v198, 3, v197
v_add_u32 v194, 102400, v197
v_xor_b32 v195, 32, v194
v_mov_b32 v197, 0xf149f2ca
v_xor_b32 v216, v197, v216
v_xor_b32 v217, v197, v217
v_xor_b32 v218, v197, v218
v_xor_b32 v219, v197, v219
v_xor_b32 v220, v197, v220
v_xor_b32 v221, v197, v221
v_xor_b32 v222, v197, v222
v_xor_b32 v223, v197, v223
v_xor_b32 v224, v197, v224
v_xor_b32 v225, v197, v225
v_xor_b32 v226, v197, v226
v_xor_b32 v227, v197, v227
v_xor_b32 v228, v197, v228
v_xor_b32 v229, v197, v229
v_xor_b32 v230, v197, v230
v_xor_b32 v231, v197, v231
v_and_b32 v196, 15, v0
v_lshrrev_b32 v197, 4, v0
s_lshl_b32 s46, s65, 8
s_add_u32 s46, s46, 1280
s_mul_i32 s47, s64, 384
v_lshl_add_u32 v208, v196, 2, s46
v_lshl_add_u32 v209, v197, 4, s46
v_lshl_add_u32 v210, v196, 2, s47
v_lshl_add_u32 v211, v197, 4, s47
v_and_b32 v198, 1, v197
v_lshrrev_b32 v197, 1, v197
v_lshlrev_b32 v197, 9, v197
v_lshl_add_u32 v197, v198, 10, v197
s_lshl_b32 s46, s64, 12
s_lshl_b32 s47, s65, 13
s_add_u32 s46, s46, 131072
s_add_u32 s48, s46, 24576
s_sub_u32 s48, s48, s47
s_add_u32 s47, s46, s47
v_lshl_add_u32 v200, v196, 4, v197
v_and_b32 v198, 3, v0
v_lshl_add_u32 v197, v198, 4, v197
v_bfe_u32 v198, v0, 3, 1
v_lshl_add_u32 v197, v198, 6, v197
v_bfe_u32 v198, v0, 2, 1
v_lshl_add_u32 v198, v198, 8, v197
v_add_u32 v199, s48, v198
v_add_u32 v198, s47, v198
v_add_u32 v201, s48, v200
v_add_u32 v200, s47, v200
s_lshl_b32 s46, s59, 4
s_add_u32 s46, s46, s60
s_lshl_b32 s50, s59, 7
s_add_u32 s50, s50, s60
s_lshl_b32 s50, s50, 7
s_lshl_b32 s46, s46, 15
s_lshl_b32 s47, 1, 23
s_add_u32 s46, s46, s47
s_add_u32 s49, s46, 917504
mhz_177:
s_branch pchk_181
poll_180:
buffer_load_dwordx4 v[80:83], v7, s[24:27], s74 offen offset:0 sc1
buffer_load_dwordx4 v[84:87], v7, s[24:27], s74 offen offset:512 sc1
buffer_load_dwordx4 v[88:91], v7, s[24:27], s74 offen offset:1024 sc1
buffer_load_dwordx4 v[92:95], v7, s[24:27], s74 offen offset:1536 sc1
buffer_load_dwordx4 v[96:99], v7, s[24:27], s74 offen offset:2048 sc1
buffer_load_dwordx4 v[100:103], v7, s[24:27], s74 offen offset:2560 sc1
buffer_load_dwordx4 v[104:107], v7, s[24:27], s74 offen offset:3072 sc1
buffer_load_dwordx4 v[108:111], v7, s[24:27], s74 offen offset:3584 sc1
pchk_181:
s_waitcnt vmcnt(7)
v_min3_u32 v8, v80, v81, v82
s_waitcnt vmcnt(6)
v_min3_u32 v8, v8, v83, v84
v_min3_u32 v8, v8, v85, v86
s_waitcnt vmcnt(5)
v_min3_u32 v8, v8, v87, v88
v_min3_u32 v8, v8, v89, v90
s_waitcnt vmcnt(4)
v_min3_u32 v8, v8, v91, v92
v_min3_u32 v8, v8, v93, v94
s_waitcnt vmcnt(3)
v_min3_u32 v8, v8, v95, v96
v_min3_u32 v8, v8, v97, v98
s_waitcnt vmcnt(2)
v_min3_u32 v8, v8, v99, v100
v_min3_u32 v8, v8, v101, v102
s_waitcnt vmcnt(1)
v_min3_u32 v8, v8, v103, v104
v_min3_u32 v8, v8, v105, v106
s_waitcnt vmcnt(0)
v_min3_u32 v8, v8, v107, v108
v_min3_u32 v8, v8, v109, v110
v_min_u32 v8, v8, v111
v_cmp_eq_u32 vcc, 0, v8
s_mov_b64 exec, vcc
s_cbranch_vccz pdone_182
s_sleep 1
s_sub_u32 s32, s32, 1
s_cmp_gt_i32 s32, 0
s_cbranch_scc1 poll_180
pdone_182:
s_mov_b64 exec, -1
v_pk_add_f32 v[80:81], v[80:81], v[96:97]
v_pk_add_f32 v[82:83], v[82:83], v[98:99]
v_pk_add_f32 v[84:85], v[84:85], v[100:101]
v_pk_add_f32 v[86:87], v[86:87], v[102:103]
v_pk_add_f32 v[88:89], v[88:89], v[104:105]
v_pk_add_f32 v[90:91], v[90:91], v[106:107]
v_pk_add_f32 v[92:93], v[92:93], v[108:109]
v_pk_add_f32 v[94:95], v[94:95], v[110:111]
v_pk_add_f32 v[80:81], v[80:81], v[88:89]
v_pk_add_f32 v[82:83], v[82:83], v[90:91]
v_pk_add_f32 v[84:85], v[84:85], v[92:93]
v_pk_add_f32 v[86:87], v[86:87], v[94:95]
v_pk_add_f32 v[80:81], v[80:81], v[84:85]
v_pk_add_f32 v[82:83], v[82:83], v[86:87]
v_mov_b32 v8, v80
v_mov_b32 v9, v81
v_mov_b32 v10, v82
v_mov_b32 v11, v83
v_permlane32_swap_b32 v8, v80
v_permlane32_swap_b32 v9, v81
v_permlane32_swap_b32 v10, v82
v_permlane32_swap_b32 v11, v83
v_pk_add_f32 v[8:9], v[8:9], v[80:81]
v_pk_add_f32 v[10:11], v[10:11], v[82:83]
v_mul_f32 v8, 0xba800000, v8
v_mul_f32 v9, 0x3a800000, v9
v_fma_f32 v9, -v8, v8, v9
v_max_f32 v9, 0, v9
v_add_f32 v12, 0x3727c5ac, v9
v_rsq_f32 v80, v12
v_fma_f32 v10, v8, v11, v10
v_mul_f32 v12, v80, v10
v_max_u32 v12, 1, v12
v_add_u32 v7, s34, v3
v_mov_b32 v6, v12
s_nop 1
v_max_f32_dpp v6, v6, v6 row_ror:1 row_mask:0xf bank_mask:0xf
s_nop 1
v_max_f32_dpp v6, v6, v6 row_ror:2 row_mask:0xf bank_mask:0xf
s_nop 1
v_max_f32_dpp v6, v6, v6 row_ror:4 row_mask:0xf bank_mask:0xf
s_nop 1
v_max_f32_dpp v6, v6, v6 row_ror:8 row_mask:0xf bank_mask:0xf
v_mov_b32 v11, v6
s_nop 1
v_permlane16_swap_b32 v11, v6
v_max_f32 v6, v6, v11
v_cmp_eq_f32 vcc, v6, v12
s_ff1_i32_b64 s66, vcc
s_and_b32 s66, s66, 31
s_mov_b64 exec, 1
ds_write_b32 v7, v6 offset:256
s_mov_b64 exec, -1
v_add_u32 v7, s34, v1
v_mul_f32 v81, v8, v80
v_add_f32 v10, 1.0, v80
v_mov_b32 v82, v80
v_mov_b32 v83, v81
s_and_b32 s67, s66, 15
s_lshl_b32 s67, 0x10001, s67
s_bitcmp0_b32 s66, 4
v_permlane16_swap_b32 v80, v82
v_permlane16_swap_b32 v81, v83
s_cselect_b32 s76, s67, 0
s_cselect_b32 s78, 0, s67
s_cselect_b32 s77, s67, 0
s_cselect_b32 s79, 0, s67
s_add_u32 s75, s75, s66
s_bitcmp0_b32 s66, 4
s_cbranch_scc0 mu_183
v_pk_fma_f32 v[48:49], v[16:17], v[80:81], v[80:81] op_sel:[0,0,1] op_sel_hi:[1,0,1]
v_pk_fma_f32 v[50:51], v[18:19], v[80:81], v[80:81] op_sel:[0,0,1] op_sel_hi:[1,0,1]
v_pk_fma_f32 v[52:53], v[20:21], v[80:81], v[80:81] op_sel:[0,0,1] op_sel_hi:[1,0,1]
v_pk_fma_f32 v[54:55], v[22:23], v[80:81], v[80:81] op_sel:[0,0,1] op_sel_hi:[1,0,1]
v_pk_fma_f32 v[56:57], v[24:25], v[80:81], v[80:81] op_sel:[0,0,1] op_sel_hi:[1,0,1]
v_pk_fma_f32 v[58:59], v[26:27], v[80:81], v[80:81] op_sel:[0,0,1] op_sel_hi:[1,0,1]
v_pk_fma_f32 v[60:61], v[28:29], v[80:81], v[80:81] op_sel:[0,0,1] op_sel_hi:[1,0,1]
v_pk_fma_f32 v[62:63], v[30:31], v[80:81], v[80:81] op_sel:[0,0,1] op_sel_hi:[1,0,1]
v_cvt_pk_bf16_f32 v84, v48, v49
v_cvt_pk_bf16_f32 v85, v50, v51
v_cvt_pk_bf16_f32 v86, v52, v53
v_cvt_pk_bf16_f32 v87, v54, v55
v_cvt_pk_bf16_f32 v88, v56, v57
v_cvt_pk_bf16_f32 v89, v58, v59
v_cvt_pk_bf16_f32 v90, v60, v61
v_cvt_pk_bf16_f32 v91, v62, v63
ds_read_b32 v11, v7 offset:256
v_max_u32 v84, 1, v84
v_max_u32 v85, 1, v85
v_max_u32 v86, 1, v86
v_max_u32 v87, 1, v87
v_max_u32 v88, 1, v88
v_max_u32 v89, 1, v89
v_max_u32 v90, 1, v90
v_max_u32 v91, 1, v91
s_branch pchk_186
poll_185:
ds_read_b32 v11, v7 offset:256
pchk_186:
s_waitcnt lgkmcnt(0)
v_cmp_eq_u32 vcc, 0, v11
s_cbranch_vccz pdone_187
s_sub_u32 s32, s32, 1
s_cmp_gt_i32 s32, 0
s_cbranch_scc1 poll_185
pdone_187:
v_cmp_eq_f32 vcc, v11, v6
s_bfm_b32 s67, s58, 0
s_and_b32 s67, s67, vcc_lo
v_cmp_gt_f32 vcc, v11, v6
s_lshl_b32 s66, 1, s66
s_or_b32 s67, s67, vcc_lo
s_cselect_b64 s[76:77], 0, s[76:77]
s_cselect_b64 s[78:79], 0, s[78:79]
s_cselect_b64 exec, 0, s[66:67]
s_bitcmp0_b32 s62, 0
s_cselect_b64 exec, exec, 0
buffer_store_dwordx2 v[12:13], off, s[24:27], s72 sc1
s_mov_b64 exec, s[76:77]
buffer_store_dwordx4 v[84:87], v4, s[24:27], s68 offen offset:0 sc1
buffer_store_dwordx4 v[88:91], v4, s[24:27], s68 offen offset:16 sc1
s_mov_b64 exec, -1
v_add_u32 v5, s34, 24
s_mov_b64 exec, 1
ds_write_b32 v3, v5
s_mov_b64 exec, -1
v_pk_fma_f32 v[64:65], v[32:33], v[82:83], v[82:83] op_sel:[0,0,1] op_sel_hi:[1,0,1]
v_pk_fma_f32 v[66:67], v[34:35], v[82:83], v[82:83] op_sel:[0,0,1] op_sel_hi:[1,0,1]
v_pk_fma_f32 v[68:69], v[36:37], v[82:83], v[82:83] op_sel:[0,0,1] op_sel_hi:[1,0,1]
v_pk_fma_f32 v[70:71], v[38:39], v[82:83], v[82:83] op_sel:[0,0,1] op_sel_hi:[1,0,1]
v_pk_fma_f32 v[72:73], v[40:41], v[82:83], v[82:83] op_sel:[0,0,1] op_sel_hi:[1,0,1]
v_pk_fma_f32 v[74:75], v[42:43], v[82:83], v[82:83] op_sel:[0,0,1] op_sel_hi:[1,0,1]
v_pk_fma_f32 v[76:77], v[44:45], v[82:83], v[82:83] op_sel:[0,0,1] op_sel_hi:[1,0,1]
v_pk_fma_f32 v[78:79], v[46:47], v[82:83], v[82:83] op_sel:[0,0,1] op_sel_hi:[1,0,1]
v_pk_add_f32 v[16:17], v[16:17], v[48:49]
v_pk_add_f32 v[18:19], v[18:19], v[50:51]
v_pk_add_f32 v[20:21], v[20:21], v[52:53]
v_pk_add_f32 v[22:23], v[22:23], v[54:55]
v_pk_add_f32 v[24:25], v[24:25], v[56:57]
v_pk_add_f32 v[26:27], v[26:27], v[58:59]
v_pk_add_f32 v[28:29], v[28:29], v[60:61]
v_pk_add_f32 v[30:31], v[30:31], v[62:63]
v_pk_add_f32 v[32:33], v[32:33], v[64:65]
v_pk_add_f32 v[34:35], v[34:35], v[66:67]
v_pk_add_f32 v[36:37], v[36:37], v[68:69]
v_pk_add_f32 v[38:39], v[38:39], v[70:71]
v_pk_add_f32 v[40:41], v[40:41], v[72:73]
v_pk_add_f32 v[42:43], v[42:43], v[74:75]
v_pk_add_f32 v[44:45], v[44:45], v[76:77]
v_pk_add_f32 v[46:47], v[46:47], v[78:79]
v_cvt_pk_bf16_f32 v240, v16, v17
v_cvt_pk_bf16_f32 v241, v18, v19
v_cvt_pk_bf16_f32 v242, v20, v21
v_cvt_pk_bf16_f32 v243, v22, v23
v_cvt_pk_bf16_f32 v244, v24, v25
v_cvt_pk_bf16_f32 v245, v26, v27
v_cvt_pk_bf16_f32 v246, v28, v29
v_cvt_pk_bf16_f32 v247, v30, v31
v_cvt_pk_bf16_f32 v248, v32, v33
v_cvt_pk_bf16_f32 v249, v34, v35
v_cvt_pk_bf16_f32 v250, v36, v37
v_cvt_pk_bf16_f32 v251, v38, v39
v_cvt_pk_bf16_f32 v252, v40, v41
v_cvt_pk_bf16_f32 v253, v42, v43
v_cvt_pk_bf16_f32 v254, v44, v45
v_cvt_pk_bf16_f32 v255, v46, v47
v_max_u32 v16, 1, v16
v_max_u32 v17, 1, v17
v_max_u32 v18, 1, v18
v_max_u32 v19, 1, v19
v_max_u32 v20, 1, v20
v_max_u32 v21, 1, v21
v_max_u32 v22, 1, v22
v_max_u32 v23, 1, v23
v_max_u32 v24, 1, v24
v_max_u32 v25, 1, v25
v_max_u32 v26, 1, v26
v_max_u32 v27, 1, v27
v_max_u32 v28, 1, v28
v_max_u32 v29, 1, v29
v_max_u32 v30, 1, v30
v_max_u32 v31, 1, v31
s_mov_b64 exec, s[76:77]
buffer_store_dwordx4 v[16:19], v15, s[24:27], s69 offen offset:0 sc1
buffer_store_dwordx4 v[20:23], v15, s[24:27], s69 offen offset:64 sc1
buffer_store_dwordx4 v[24:27], v15, s[24:27], s69 offen offset:128 sc1
buffer_store_dwordx4 v[28:31], v15, s[24:27], s69 offen offset:192 sc1
s_mov_b64 exec, -1
mu_184:
s_cmp_eq_u32 s63, 0
s_cbranch_scc0 mout_188
v_mul_f32 v11, v10, v10
v_mov_b32 v12, 0x3727c5ac
v_fma_f32 v11, v11, v9, v12
v_rsq_f32 v11, v11
v_lshrrev_b32 v12, 3, v0
v_lshlrev_b32 v12, 6, v12
v_lshl_add_u32 v12, v0, 3, v12
v_mul_f32 v10, v10, v11
v_mul_f32 v11, v8, v10
s_lshl_b32 s66, s61, 5
s_add_u32 s66, s66, s58
s_lshl_b32 s66, s66, 9
s_add_u32 s66, s66, 1675264
v_max_u32 v11, 1, v11
s_cmp_eq_u32 s62, 8
s_cselect_b32 exec_lo, -1, 0
s_mov_b32 exec_hi, 0
s_cmp_eq_u32 s57, 0
s_cbranch_scc1 far_189
buffer_store_dwordx2 v[10:11], v12, s[24:27], s66 offen
near_190:
s_mov_b64 exec, -1
s_mov_b32 s63, 1
s_mov_b32 s34, 32
s_add_u32 s24, s24, 1409024
s_addc_u32 s25, s25, 0
s_mov_b32 s26, 1409024
s_branch L_mtop
mout_188:
v_permlane16_swap_b32 v240, v242
v_permlane16_swap_b32 v241, v243
v_permlane16_swap_b32 v244, v246
v_permlane16_swap_b32 v245, v247
v_permlane16_swap_b32 v248, v250
v_permlane16_swap_b32 v249, v251
v_permlane16_swap_b32 v252, v254
v_permlane16_swap_b32 v253, v255
s_not_b64 exec, s[76:77]
buffer_store_dwordx4 v[240:243], v14, s[28:31], s70 offen offset:0
buffer_store_dwordx4 v[244:247], v14, s[28:31], s70 offen offset:64
s_not_b64 exec, s[78:79]
buffer_store_dwordx4 v[248:251], v14, s[28:31], s71 offen offset:0
buffer_store_dwordx4 v[252:255], v14, s[28:31], s71 offen offset:64
s_mov_b64 exec, -1
s_or_b32 s66, s76, s78
s_cbranch_scc0 L_end
v_mov_b32 v11, 0
s_add_u32 s35, s34, 4
lw_191:
ds_read_b32 v5, v2 offset:24
s_waitcnt lgkmcnt(0)
v_cmp_gt_i32 vcc, s35, v5
s_cbranch_vccz lwd_192
s_sleep 2
s_sub_u32 s32, s32, 1
s_cmp_gt_i32 s32, 0
s_cbranch_scc1 lw_191
lwd_192:
ds_read_b32 v11, v11 offset:32
s_waitcnt lgkmcnt(0)
v_cmp_eq_u32 vcc, s75, v11
s_cbranch_vccnz L_end
s_mov_b64 exec, s[76:77]
buffer_store_dwordx4 v[240:243], v14, s[28:31], s70 offen offset:0
buffer_store_dwordx4 v[244:247], v14, s[28:31], s70 offen offset:64
s_mov_b64 exec, s[78:79]
buffer_store_dwordx4 v[248:251], v14, s[28:31], s71 offen offset:0
buffer_store_dwordx4 v[252:255], v14, s[28:31], s71 offen offset:64
s_mov_b64 exec, -1
s_branch L_end
mspin_134:
ds_read_b32 v5, v2 offset:16
s_waitcnt lgkmcnt(0)
v_cmp_ge_u32 vcc, v4, v5
s_cbranch_vccz mback_135
s_sub_u32 s32, s32, 1
s_cmp_gt_i32 s32, 0
s_cbranch_scc1 mspin_134
s_branch mback_135
mspin_132:
msp_193:
ds_read_b32 v5, v2 offset:16
s_waitcnt lgkmcnt(0)
v_cmp_ge_u32 vcc, v4, v5
s_cbranch_vccz mback_133
s_sub_u32 s32, s32, 1
s_cmp_gt_i32 s32, 0
s_cbranch_scc1 msp_193
s_branch mback_133
lspin_136:
s_add_u32 s35, s34, 2
lw_194:
ds_read_b32 v5, v2 offset:24
s_waitcnt lgkmcnt(0)
v_cmp_gt_i32 vcc, s35, v5
s_cbranch_vccz lwd_195
s_sub_u32 s32, s32, 1
s_cmp_gt_i32 s32, 0
s_cbranch_scc1 lw_194
lwd_195:
s_branch lback_137
patch_138:
s_bfe_u32 s66, s33, 0x20005
s_lshr_b32 s67, s66, 1
s_xor_b32 s66, s66, s67
s_and_b32 s66, s66, 1
s_cmp_eq_u32 s66, s65
s_cbranch_scc0 pback_139
s_bfe_u32 s66, s33, 0x10004
s_lshl1_add_u32 s73, s67, s66
s_and_b32 s66, s33, 15
s_mov_b32 s74, 0x10001
s_mov_b32 s75, s74
s_lshl_b64 s[74:75], s[74:75], s66
s_and_b32 s66, s66, 12
s_lshl_b32 s66, s66, 2
s_bfm_b64 s[76:77], 16, s66
s_nop 7
s_mov_b64 exec, s[74:75]
s_cmp_eq_u32 s73, 0
s_cbranch_scc0 pnx_197
ds_read_b128 v[16:19], v211 offset:3456
ds_read_b128 v[20:23], v211 offset:3520
s_branch pdn_196
pnx_197:
s_cmp_eq_u32 s73, 1
s_cbranch_scc0 pnx_198
ds_read_b128 v[24:27], v211 offset:3456
ds_read_b128 v[28:31], v211 offset:3520
s_branch pdn_196
pnx_198:
s_cmp_eq_u32 s73, 2
s_cbranch_scc0 pnx_199
ds_read_b128 v[32:35], v211 offset:3456
ds_read_b128 v[36:39], v211 offset:3520
s_branch pdn_196
pnx_199:
ds_read_b128 v[40:43], v211 offset:3456
ds_read_b128 v[44:47], v211 offset:3520
pdn_196:
s_mov_b64 exec, -1
s_waitcnt lgkmcnt(0)
s_branch pback_139
patch_140:
s_nop 7
s_nop 7
s_and_b32 s66, s33, 3
s_lshl2_add_u32 s66, s73, s66
s_mov_b64 exec, s[76:77]
s_cmp_eq_u32 s66, 0
s_cbranch_scc0 pnx_202
ds_read_b32 v48, v210 offset:3584
ds_read_b32 v52, v210 offset:3648
s_branch pdn_201
pnx_202:
s_cmp_eq_u32 s66, 1
s_cbranch_scc0 pnx_203
ds_read_b32 v49, v210 offset:3584
ds_read_b32 v53, v210 offset:3648
s_branch pdn_201
pnx_203:
s_cmp_eq_u32 s66, 2
s_cbranch_scc0 pnx_204
ds_read_b32 v50, v210 offset:3584
ds_read_b32 v54, v210 offset:3648
s_branch pdn_201
pnx_204:
s_cmp_eq_u32 s66, 3
s_cbranch_scc0 pnx_205
ds_read_b32 v51, v210 offset:3584
ds_read_b32 v55, v210 offset:3648
s_branch pdn_201
pnx_205:
s_cmp_eq_u32 s66, 4
s_cbranch_scc0 pnx_206
ds_read_b32 v56, v210 offset:3584
ds_read_b32 v60, v210 offset:3648
s_branch pdn_201
pnx_206:
s_cmp_eq_u32 s66, 5
s_cbranch_scc0 pnx_207
ds_read_b32 v57, v210 offset:3584
ds_read_b32 v61, v210 offset:3648
s_branch pdn_201
pnx_207:
s_cmp_eq_u32 s66, 6
s_cbranch_scc0 pnx_208
ds_read_b32 v58, v210 offset:3584
ds_read_b32 v62, v210 offset:3648
s_branch pdn_201
pnx_208:
s_cmp_eq_u32 s66, 7
s_cbranch_scc0 pnx_209
ds_read_b32 v59, v210 offset:3584
ds_read_b32 v63, v210 offset:3648
s_branch pdn_201
pnx_209:
s_cmp_eq_u32 s66, 8
s_cbranch_scc0 pnx_210
ds_read_b32 v64, v210 offset:3584
ds_read_b32 v68, v210 offset:3648
s_branch pdn_201
pnx_210:
s_cmp_eq_u32 s66, 9
s_cbranch_scc0 pnx_211
ds_read_b32 v65, v210 offset:3584
ds_read_b32 v69, v210 offset:3648
s_branch pdn_201
pnx_211:
s_cmp_eq_u32 s66, 10
s_cbranch_scc0 pnx_212
ds_read_b32 v66, v210 offset:3584
ds_read_b32 v70, v210 offset:3648
s_branch pdn_201
pnx_212:
s_cmp_eq_u32 s66, 11
s_cbranch_scc0 pnx_213
ds_read_b32 v67, v210 offset:3584
ds_read_b32 v71, v210 offset:3648
s_branch pdn_201
pnx_213:
s_cmp_eq_u32 s66, 12
s_cbranch_scc0 pnx_214
ds_read_b32 v72, v210 offset:3584
ds_read_b32 v76, v210 offset:3648
s_branch pdn_201
pnx_214:
s_cmp_eq_u32 s66, 13
s_cbranch_scc0 pnx_215
ds_read_b32 v73, v210 offset:3584
ds_read_b32 v77, v210 offset:3648
s_branch pdn_201
pnx_215:
s_cmp_eq_u32 s66, 14
s_cbranch_scc0 pnx_216
ds_read_b32 v74, v210 offset:3584
ds_read_b32 v78, v210 offset:3648
s_branch pdn_201
pnx_216:
ds_read_b32 v75, v210 offset:3584
ds_read_b32 v79, v210 offset:3648
pdn_201:
s_mov_b64 exec, -1
s_waitcnt lgkmcnt(0)
s_branch pback_141
patch_142:
s_nop 7
s_nop 7
s_mov_b64 exec, s[74:75]
s_cmp_eq_u32 s73, 0
s_cbranch_scc0 pnx_219
ds_read_b128 v[80:83], v211 offset:3328
ds_read_b128 v[84:87], v211 offset:3392
s_branch pdn_218
pnx_219:
s_cmp_eq_u32 s73, 1
s_cbranch_scc0 pnx_220
ds_read_b128 v[88:91], v211 offset:3328
ds_read_b128 v[92:95], v211 offset:3392
s_branch pdn_218
pnx_220:
s_cmp_eq_u32 s73, 2
s_cbranch_scc0 pnx_221
ds_read_b128 v[96:99], v211 offset:3328
ds_read_b128 v[100:103], v211 offset:3392
s_branch pdn_218
pnx_221:
ds_read_b128 v[104:107], v211 offset:3328
ds_read_b128 v[108:111], v211 offset:3392
pdn_218:
s_mov_b64 exec, -1
s_waitcnt lgkmcnt(0)
s_branch pback_143
cross_153:
s_cmp_eq_u32 s67, 122880
s_cbranch_scc0 cr2_223
v_add_u32 v5, s34, 18
s_mov_b64 exec, 1
ds_write_b32 v3, v5
s_mov_b64 exec, -1
v_mov_b32 v9, 0xf149f2ca
v_xor_b32 v216, v9, v216
v_xor_b32 v217, v9, v217
v_xor_b32 v218, v9, v218
v_xor_b32 v219, v9, v219
v_xor_b32 v220, v9, v220
v_xor_b32 v221, v9, v221
v_xor_b32 v222, v9, v222
v_xor_b32 v223, v9, v223
v_xor_b32 v224, v9, v224
v_xor_b32 v225, v9, v225
v_xor_b32 v226, v9, v226
v_xor_b32 v227, v9, v227
v_xor_b32 v228, v9, v228
v_xor_b32 v229, v9, v229
v_xor_b32 v230, v9, v230
v_xor_b32 v231, v9, v231
s_mov_b32 s67, 114688
s_cmp_eq_u32 s63, 0
s_cbranch_scc0 cr3_224
v_and_b32 v9, 15, v0
v_lshlrev_b32 v9, 11, v9
v_bfe_u32 v10, v0, 4, 1
v_lshl_add_u32 v9, v10, 5, v9
v_lshrrev_b32 v10, 5, v0
v_lshl_add_u32 v9, v10, 4, v9
s_lshl2_add_u32 s70, s61, s58
s_lshl_b32 s70, s70, 16
s_lshl_b32 s71, s62, 7
s_add_u32 s70, s70, s71
s_add_u32 s71, s70, 0x8000
buffer_load_dwordx4 v[240:243], v9, s[8:11], s70 offen offset:0
buffer_load_dwordx4 v[244:247], v9, s[8:11], s70 offen offset:64
buffer_load_dwordx4 v[248:251], v9, s[8:11], s71 offen offset:0
buffer_load_dwordx4 v[252:255], v9, s[8:11], s71 offen offset:64
cr3_224:
s_cmp_eq_u32 s59, 0
s_cbranch_scc1 cback_154
v_mov_b32 v9, 0
s_add_u32 s35, s34, 18
lw_225:
ds_read_b32 v5, v9 offset:16
s_waitcnt lgkmcnt(0)
v_cmp_gt_i32 vcc, s35, v5
s_cbranch_vccz lwd_226
s_sub_u32 s32, s32, 1
s_cmp_gt_i32 s32, 0
s_cbranch_scc1 lw_225
lwd_226:
s_branch cback_154
cr2_223:
s_cmp_eq_u32 s67, 114688
s_cbranch_scc0 cr4_227
s_mov_b32 s67, 90112
s_add_u32 s35, s34, 21
lw_228:
ds_read_b32 v5, v9 offset:16
s_waitcnt lgkmcnt(0)
v_cmp_gt_i32 vcc, s35, v5
s_cbranch_vccz lwd_229
s_sub_u32 s32, s32, 1
s_cmp_gt_i32 s32, 0
s_cbranch_scc1 lw_228
lwd_229:
s_branch cback_154
cr4_227:
v_add_u32 v5, s34, 19
s_mov_b64 exec, 1
ds_write_b32 v3, v5
s_mov_b64 exec, -1
s_mov_b32 s66, 28672
s_cmp_lt_u32 s59, 2
s_cbranch_scc1 cback_154
s_add_u32 s35, s34, 21
lw_230:
ds_read_b32 v5, v2 offset:16
s_waitcnt lgkmcnt(0)
v_cmp_gt_i32 vcc, s35, v5
s_cbranch_vccz lwd_231
s_sub_u32 s32, s32, 1
s_cmp_gt_i32 s32, 0
s_cbranch_scc1 lw_230
lwd_231:
s_branch cback_154
cross_155:
s_cmp_eq_u32 s67, 122880
s_cbranch_scc0 cr2_232
s_waitcnt lgkmcnt(1)
v_add_u32 v5, s34, 18
s_mov_b64 exec, 1
ds_write_b32 v3, v5
s_mov_b64 exec, -1
v_mov_b32 v9, 0xf149f2ca
v_xor_b32 v216, v9, v216
v_xor_b32 v217, v9, v217
v_xor_b32 v218, v9, v218
v_xor_b32 v219, v9, v219
v_xor_b32 v220, v9, v220
v_xor_b32 v221, v9, v221
v_xor_b32 v222, v9, v222
v_xor_b32 v223, v9, v223
v_xor_b32 v224, v9, v224
v_xor_b32 v225, v9, v225
v_xor_b32 v226, v9, v226
v_xor_b32 v227, v9, v227
v_xor_b32 v228, v9, v228
v_xor_b32 v229, v9, v229
v_xor_b32 v230, v9, v230
v_xor_b32 v231, v9, v231
s_mov_b32 s67, 114688
s_cmp_eq_u32 s63, 0
s_cbranch_scc0 cr3_233
v_and_b32 v9, 15, v0
v_lshlrev_b32 v9, 11, v9
v_bfe_u32 v10, v0, 4, 1
v_lshl_add_u32 v9, v10, 5, v9
v_lshrrev_b32 v10, 5, v0
v_lshl_add_u32 v9, v10, 4, v9
s_lshl2_add_u32 s70, s61, s58
s_lshl_b32 s70, s70, 16
s_lshl_b32 s71, s62, 7
s_add_u32 s70, s70, s71
s_add_u32 s71, s70, 0x8000
buffer_load_dwordx4 v[240:243], v9, s[8:11], s70 offen offset:0
buffer_load_dwordx4 v[244:247], v9, s[8:11], s70 offen offset:64
buffer_load_dwordx4 v[248:251], v9, s[8:11], s71 offen offset:0
buffer_load_dwordx4 v[252:255], v9, s[8:11], s71 offen offset:64
cr3_233:
s_cmp_eq_u32 s59, 0
s_cbranch_scc1 cback_156
v_mov_b32 v9, 0
s_add_u32 s35, s34, 18
lw_234:
ds_read_b32 v5, v9 offset:16
s_waitcnt lgkmcnt(0)
v_cmp_gt_i32 vcc, s35, v5
s_cbranch_vccz lwd_235
s_sub_u32 s32, s32, 1
s_cmp_gt_i32 s32, 0
s_cbranch_scc1 lw_234
lwd_235:
s_branch cback_156
cr2_232:
s_waitcnt lgkmcnt(1)
v_cmp_gt_i32 vcc, s35, v5
s_cmp_eq_u32 s67, 114688
s_cbranch_scc0 cr4_236
s_mov_b32 s67, 90112
s_bitcmp0_b32 vcc_lo, 0
s_cbranch_scc1 cback_156
s_add_u32 s35, s34, 21
lw_237:
ds_read_b32 v5, v9 offset:16
s_waitcnt lgkmcnt(0)
v_cmp_gt_i32 vcc, s35, v5
s_cbranch_vccz lwd_238
s_sub_u32 s32, s32, 1
s_cmp_gt_i32 s32, 0
s_cbranch_scc1 lw_237
lwd_238:
s_branch cback_156
cr4_236:
v_add_u32 v5, s34, 19
s_mov_b64 exec, 1
ds_write_b32 v3, v5
s_mov_b64 exec, -1
s_mov_b32 s66, 28672
s_cmp_lt_u32 s59, 2
s_cbranch_scc1 cback_156
s_cbranch_vccz cback_156
s_add_u32 s35, s34, 21
lw_239:
ds_read_b32 v5, v2 offset:16
s_waitcnt lgkmcnt(0)
v_cmp_gt_i32 vcc, s35, v5
s_cbranch_vccz lwd_240
s_sub_u32 s32, s32, 1
s_cmp_gt_i32 s32, 0
s_cbranch_scc1 lw_239
lwd_240:
s_branch cback_156
slow_157:
s_add_u32 s70, s72, 270336
poll_241:
buffer_load_dword v10, v1, s[24:27], s70 offen sc1
pchk_242:
s_waitcnt vmcnt(0)
v_cmp_eq_u32 vcc, 0, v10
s_cbranch_vccz pdone_243
s_sub_u32 s32, s32, 1
s_cmp_gt_i32 s32, 0
s_cbranch_scc1 poll_241
pdone_243:
s_lshl_b32 s73, s60, 15
s_lshl_b32 s74, s63, 23
s_add_u32 s73, s73, s74
s_add_u32 s73, s73, 1048576
v_mov_b32 v10, 0xf149f2ca
v_mov_b32 v11, 0
v_mov_b32 v192, 0
v_mov_b32 v193, 0
v_mov_b32 v194, 0
v_mov_b32 v195, 0
v_mov_b32 v196, 0
v_mov_b32 v197, 0
v_mov_b32 v198, 0
v_mov_b32 v199, 0
v_mov_b32 v200, 0
v_mov_b32 v201, 0
v_mov_b32 v202, 0
v_mov_b32 v203, 0
v_mov_b32 v204, 0
v_mov_b32 v205, 0
v_mov_b32 v206, 0
v_mov_b32 v207, 0
v_mov_b32 v208, 0
v_mov_b32 v209, 0
v_mov_b32 v210, 0
v_mov_b32 v211, 0
s_lshl2_add_u32 s74, s59, s65
s_mov_b32 s75, 0
sl_244:
s_lshr_b32 s76, s74, 2
s_lshl_b32 s76, s76, 19
s_and_b32 s77, s74, 3
s_lshl_b32 s77, s77, 13
s_add_u32 s76, s76, s77
s_add_u32 s76, s76, s73
buffer_load_dwordx4 v[152:155], v6, s[20:23], s76 offen offset:0 sc1
buffer_load_dwordx4 v[156:159], v6, s[20:23], s76 offen offset:1024 sc1
s_cmp_eq_u32 s75, 0
s_cselect_b32 s76, 0xf149f2ca, 0
s_and_b32 s77, s75, 7
s_cselect_b32 s77, 0, -1
v_xor_b32 v112, s76, v216
v_and_b32 v112, s77, v112
v_xor_b32 v113, s76, v217
v_and_b32 v113, s77, v113
v_xor_b32 v114, s76, v218
v_and_b32 v114, s77, v114
v_xor_b32 v115, s76, v219
v_and_b32 v115, s77, v115
v_xor_b32 v116, s76, v220
v_and_b32 v116, s77, v116
v_xor_b32 v117, s76, v221
v_and_b32 v117, s77, v117
v_xor_b32 v118, s76, v222
v_and_b32 v118, s77, v118
v_xor_b32 v119, s76, v223
v_and_b32 v119, s77, v119
v_xor_b32 v120, s76, v224
v_and_b32 v120, s77, v120
v_xor_b32 v121, s76, v225
v_and_b32 v121, s77, v121
v_xor_b32 v122, s76, v226
v_and_b32 v122, s77, v122
v_xor_b32 v123, s76, v227
v_and_b32 v123, s77, v123
v_xor_b32 v124, s76, v228
v_and_b32 v124, s77, v124
v_xor_b32 v125, s76, v229
v_and_b32 v125, s77, v125
v_xor_b32 v126, s76, v230
v_and_b32 v126, s77, v126
v_xor_b32 v127, s76, v231
v_and_b32 v127, s77, v127
s_waitcnt vmcnt(1)
s_nop 0
v_mfma_f32_32x32x16_bf16 v[112:127], v[152:155], v[80:83], v[112:127]
s_waitcnt vmcnt(0)
v_mfma_f32_32x32x16_bf16 v[112:127], v[156:159], v[88:91], v[112:127]
s_nop 11
v_max3_f32 v10, v10, v112, v113
v_max3_f32 v10, v10, v114, v115
v_max3_f32 v10, v10, v116, v117
v_max3_f32 v10, v10, v118, v119
v_max3_f32 v10, v10, v120, v121
v_max3_f32 v10, v10, v122, v123
v_max3_f32 v10, v10, v124, v125
v_max3_f32 v10, v10, v126, v127
s_add_u32 s75, s75, 1
s_sub_u32 s74, s74, 1
s_cselect_b32 s75, 9, s75
s_cmp_lt_u32 s75, 9
s_cbranch_scc1 sl_244
v_mov_b32 v11, v10
s_nop 1
v_permlane32_swap_b32 v11, v10
v_max_f32 v10, v10, v11
s_lshl2_add_u32 s74, s59, s65
s_mov_b32 s75, 0
sl_245:
s_lshr_b32 s76, s74, 2
s_lshl_b32 s76, s76, 19
s_and_b32 s77, s74, 3
s_lshl_b32 s77, s77, 13
s_add_u32 s76, s76, s77
s_add_u32 s76, s76, s73
buffer_load_dwordx4 v[152:155], v6, s[20:23], s76 offen offset:0 sc1
buffer_load_dwordx4 v[156:159], v6, s[20:23], s76 offen offset:1024 sc1
buffer_load_dwordx4 v[160:163], v6, s[20:23], s76 offen offset:2048 sc1
buffer_load_dwordx4 v[164:167], v6, s[20:23], s76 offen offset:3072 sc1
s_cmp_eq_u32 s75, 0
s_cselect_b32 s76, 0xf149f2ca, 0
s_and_b32 s77, s75, 7
s_cselect_b32 s77, 0, -1
v_xor_b32 v112, s76, v216
v_and_b32 v112, s77, v112
v_sub_f32 v112, v112, v10
v_xor_b32 v113, s76, v217
v_and_b32 v113, s77, v113
v_sub_f32 v113, v113, v10
v_xor_b32 v114, s76, v218
v_and_b32 v114, s77, v114
v_sub_f32 v114, v114, v10
v_xor_b32 v115, s76, v219
v_and_b32 v115, s77, v115
v_sub_f32 v115, v115, v10
v_xor_b32 v116, s76, v220
v_and_b32 v116, s77, v116
v_sub_f32 v116, v116, v10
v_xor_b32 v117, s76, v221
v_and_b32 v117, s77, v117
v_sub_f32 v117, v117, v10
v_xor_b32 v118, s76, v222
v_and_b32 v118, s77, v118
v_sub_f32 v118, v118, v10
v_xor_b32 v119, s76, v223
v_and_b32 v119, s77, v119
v_sub_f32 v119, v119, v10
v_xor_b32 v120, s76, v224
v_and_b32 v120, s77, v120
v_sub_f32 v120, v120, v10
v_xor_b32 v121, s76, v225
v_and_b32 v121, s77, v121
v_sub_f32 v121, v121, v10
v_xor_b32 v122, s76, v226
v_and_b32 v122, s77, v122
v_sub_f32 v122, v122, v10
v_xor_b32 v123, s76, v227
v_and_b32 v123, s77, v123
v_sub_f32 v123, v123, v10
v_xor_b32 v124, s76, v228
v_and_b32 v124, s77, v124
v_sub_f32 v124, v124, v10
v_xor_b32 v125, s76, v229
v_and_b32 v125, s77, v125
v_sub_f32 v125, v125, v10
v_xor_b32 v126, s76, v230
v_and_b32 v126, s77, v126
v_sub_f32 v126, v126, v10
v_xor_b32 v127, s76, v231
v_and_b32 v127, s77, v127
v_sub_f32 v127, v127, v10
s_waitcnt vmcnt(3)
s_nop 0
v_mfma_f32_32x32x16_bf16 v[112:127], v[152:155], v[80:83], v[112:127]
s_waitcnt vmcnt(2)
v_mfma_f32_32x32x16_bf16 v[112:127], v[156:159], v[88:91], v[112:127]
s_nop 11
v_exp_f32 v112, v112
v_exp_f32 v113, v113
v_exp_f32 v114, v114
v_exp_f32 v115, v115
v_exp_f32 v116, v116
v_exp_f32 v117, v117
v_exp_f32 v118, v118
v_exp_f32 v119, v119
v_exp_f32 v120, v120
v_exp_f32 v121, v121
v_exp_f32 v122, v122
v_exp_f32 v123, v123
v_exp_f32 v124, v124
v_exp_f32 v125, v125
v_exp_f32 v126, v126
v_exp_f32 v127, v127
v_cvt_pk_bf16_f32 v144, v112, v113
v_cvt_pk_bf16_f32 v145, v114, v115
v_cvt_pk_bf16_f32 v146, v116, v117
v_cvt_pk_bf16_f32 v147, v118, v119
v_cvt_pk_bf16_f32 v148, v120, v121
v_cvt_pk_bf16_f32 v149, v122, v123
v_cvt_pk_bf16_f32 v150, v124, v125
v_cvt_pk_bf16_f32 v151, v126, v127
s_waitcnt vmcnt(1)
v_mfma_f32_32x32x16_bf16 v[192:207], v[160:163], v[144:147], v[192:207]
v_mfma_f32_16x16x32_bf16 v[208:211], v[212:215], v[144:147], v[208:211]
s_waitcnt vmcnt(0)
v_mfma_f32_32x32x16_bf16 v[192:207], v[164:167], v[148:151], v[192:207]
v_mfma_f32_16x16x32_bf16 v[208:211], v[212:215], v[148:151], v[208:211]
s_add_u32 s75, s75, 1
s_sub_u32 s74, s74, 1
s_cselect_b32 s75, 9, s75
s_cmp_lt_u32 s75, 9
s_cbranch_scc1 sl_245
v_mov_b32 v10, 0xf149f2ca
v_mov_b32 v11, 0
v_mov_b32 v16, 0
v_mov_b32 v17, 0
v_mov_b32 v18, 0
v_mov_b32 v19, 0
v_mov_b32 v20, 0
v_mov_b32 v21, 0
v_mov_b32 v22, 0
v_mov_b32 v23, 0
v_mov_b32 v24, 0
v_mov_b32 v25, 0
v_mov_b32 v26, 0
v_mov_b32 v27, 0
v_mov_b32 v28, 0
v_mov_b32 v29, 0
v_mov_b32 v30, 0
v_mov_b32 v31, 0
v_mov_b32 v32, 0
v_mov_b32 v33, 0
v_mov_b32 v34, 0
v_mov_b32 v35, 0
s_sub_u32 s74, 3, s65
s_lshl2_add_u32 s74, s59, s74
s_mov_b32 s75, 0
sl_246:
s_lshr_b32 s76, s74, 2
s_lshl_b32 s76, s76, 19
s_and_b32 s77, s74, 3
s_lshl_b32 s77, s77, 13
s_add_u32 s76, s76, s77
s_add_u32 s76, s76, s73
buffer_load_dwordx4 v[152:155], v6, s[20:23], s76 offen offset:0 sc1
buffer_load_dwordx4 v[156:159], v6, s[20:23], s76 offen offset:1024 sc1
s_cmp_eq_u32 s75, 0
s_cselect_b32 s76, 0xf149f2ca, 0
s_and_b32 s77, s75, 7
s_cselect_b32 s77, 0, -1
v_xor_b32 v112, s76, v216
v_and_b32 v112, s77, v112
v_xor_b32 v113, s76, v217
v_and_b32 v113, s77, v113
v_xor_b32 v114, s76, v218
v_and_b32 v114, s77, v114
v_xor_b32 v115, s76, v219
v_and_b32 v115, s77, v115
v_xor_b32 v116, s76, v220
v_and_b32 v116, s77, v116
v_xor_b32 v117, s76, v221
v_and_b32 v117, s77, v117
v_xor_b32 v118, s76, v222
v_and_b32 v118, s77, v118
v_xor_b32 v119, s76, v223
v_and_b32 v119, s77, v119
v_xor_b32 v120, s76, v224
v_and_b32 v120, s77, v120
v_xor_b32 v121, s76, v225
v_and_b32 v121, s77, v121
v_xor_b32 v122, s76, v226
v_and_b32 v122, s77, v122
v_xor_b32 v123, s76, v227
v_and_b32 v123, s77, v123
v_xor_b32 v124, s76, v228
v_and_b32 v124, s77, v124
v_xor_b32 v125, s76, v229
v_and_b32 v125, s77, v125
v_xor_b32 v126, s76, v230
v_and_b32 v126, s77, v126
v_xor_b32 v127, s76, v231
v_and_b32 v127, s77, v127
s_waitcnt vmcnt(1)
s_nop 0
v_mfma_f32_32x32x16_bf16 v[112:127], v[152:155], v[96:99], v[112:127]
s_waitcnt vmcnt(0)
v_mfma_f32_32x32x16_bf16 v[112:127], v[156:159], v[104:107], v[112:127]
s_nop 11
v_max3_f32 v10, v10, v112, v113
v_max3_f32 v10, v10, v114, v115
v_max3_f32 v10, v10, v116, v117
v_max3_f32 v10, v10, v118, v119
v_max3_f32 v10, v10, v120, v121
v_max3_f32 v10, v10, v122, v123
v_max3_f32 v10, v10, v124, v125
v_max3_f32 v10, v10, v126, v127
s_add_u32 s75, s75, 1
s_sub_u32 s74, s74, 1
s_cselect_b32 s75, 9, s75
s_cmp_lt_u32 s75, 9
s_cbranch_scc1 sl_246
v_mov_b32 v11, v10
s_nop 1
v_permlane32_swap_b32 v11, v10
v_max_f32 v10, v10, v11
s_sub_u32 s74, 3, s65
s_lshl2_add_u32 s74, s59, s74
s_mov_b32 s75, 0
sl_247:
s_lshr_b32 s76, s74, 2
s_lshl_b32 s76, s76, 19
s_and_b32 s77, s74, 3
s_lshl_b32 s77, s77, 13
s_add_u32 s76, s76, s77
s_add_u32 s76, s76, s73
buffer_load_dwordx4 v[152:155], v6, s[20:23], s76 offen offset:0 sc1
buffer_load_dwordx4 v[156:159], v6, s[20:23], s76 offen offset:1024 sc1
buffer_load_dwordx4 v[160:163], v6, s[20:23], s76 offen offset:2048 sc1
buffer_load_dwordx4 v[164:167], v6, s[20:23], s76 offen offset:3072 sc1
s_cmp_eq_u32 s75, 0
s_cselect_b32 s76, 0xf149f2ca, 0
s_and_b32 s77, s75, 7
s_cselect_b32 s77, 0, -1
v_xor_b32 v112, s76, v216
v_and_b32 v112, s77, v112
v_sub_f32 v112, v112, v10
v_xor_b32 v113, s76, v217
v_and_b32 v113, s77, v113
v_sub_f32 v113, v113, v10
v_xor_b32 v114, s76, v218
v_and_b32 v114, s77, v114
v_sub_f32 v114, v114, v10
v_xor_b32 v115, s76, v219
v_and_b32 v115, s77, v115
v_sub_f32 v115, v115, v10
v_xor_b32 v116, s76, v220
v_and_b32 v116, s77, v116
v_sub_f32 v116, v116, v10
v_xor_b32 v117, s76, v221
v_and_b32 v117, s77, v117
v_sub_f32 v117, v117, v10
v_xor_b32 v118, s76, v222
v_and_b32 v118, s77, v118
v_sub_f32 v118, v118, v10
v_xor_b32 v119, s76, v223
v_and_b32 v119, s77, v119
v_sub_f32 v119, v119, v10
v_xor_b32 v120, s76, v224
v_and_b32 v120, s77, v120
v_sub_f32 v120, v120, v10
v_xor_b32 v121, s76, v225
v_and_b32 v121, s77, v121
v_sub_f32 v121, v121, v10
v_xor_b32 v122, s76, v226
v_and_b32 v122, s77, v122
v_sub_f32 v122, v122, v10
v_xor_b32 v123, s76, v227
v_and_b32 v123, s77, v123
v_sub_f32 v123, v123, v10
v_xor_b32 v124, s76, v228
v_and_b32 v124, s77, v124
v_sub_f32 v124, v124, v10
v_xor_b32 v125, s76, v229
v_and_b32 v125, s77, v125
v_sub_f32 v125, v125, v10
v_xor_b32 v126, s76, v230
v_and_b32 v126, s77, v126
v_sub_f32 v126, v126, v10
v_xor_b32 v127, s76, v231
v_and_b32 v127, s77, v127
v_sub_f32 v127, v127, v10
s_waitcnt vmcnt(3)
s_nop 0
v_mfma_f32_32x32x16_bf16 v[112:127], v[152:155], v[96:99], v[112:127]
s_waitcnt vmcnt(2)
v_mfma_f32_32x32x16_bf16 v[112:127], v[156:159], v[104:107], v[112:127]
s_nop 11
v_exp_f32 v112, v112
v_exp_f32 v113, v113
v_exp_f32 v114, v114
v_exp_f32 v115, v115
v_exp_f32 v116, v116
v_exp_f32 v117, v117
v_exp_f32 v118, v118
v_exp_f32 v119, v119
v_exp_f32 v120, v120
v_exp_f32 v121, v121
v_exp_f32 v122, v122
v_exp_f32 v123, v123
v_exp_f32 v124, v124
v_exp_f32 v125, v125
v_exp_f32 v126, v126
v_exp_f32 v127, v127
v_cvt_pk_bf16_f32 v144, v112, v113
v_cvt_pk_bf16_f32 v145, v114, v115
v_cvt_pk_bf16_f32 v146, v116, v117
v_cvt_pk_bf16_f32 v147, v118, v119
v_cvt_pk_bf16_f32 v148, v120, v121
v_cvt_pk_bf16_f32 v149, v122, v123
v_cvt_pk_bf16_f32 v150, v124, v125
v_cvt_pk_bf16_f32 v151, v126, v127
s_waitcnt vmcnt(1)
v_mfma_f32_32x32x16_bf16 v[16:31], v[160:163], v[144:147], v[16:31]
v_mfma_f32_16x16x32_bf16 v[32:35], v[212:215], v[144:147], v[32:35]
s_waitcnt vmcnt(0)
v_mfma_f32_32x32x16_bf16 v[16:31], v[164:167], v[148:151], v[16:31]
v_mfma_f32_16x16x32_bf16 v[32:35], v[212:215], v[148:151], v[32:35]
s_add_u32 s75, s75, 1
s_sub_u32 s74, s74, 1
s_cselect_b32 s75, 9, s75
s_cmp_lt_u32 s75, 9
s_cbranch_scc1 sl_247
s_branch sback_158
far_159:
buffer_store_dwordx4 v[16:19], v9, s[20:23], s67 offen offset:0 sc1
buffer_store_dwordx4 v[20:23], v9, s[20:23], s67 offen offset:1024 sc1
s_branch near_160
far_161:
buffer_store_dwordx4 v[192:195], v9, s[20:23], s66 offen offset:0 sc1
buffer_store_dwordx4 v[196:199], v9, s[20:23], s66 offen offset:1024 sc1
s_branch near_162
far_165:
buffer_store_dword v212, v3, s[24:27], s70 offen sc1
s_branch near_166
mo_167:
s_lshr_b32 s67, s33, 5
s_cmp_eq_u32 s67, s66
s_cbranch_scc0 mo_168
s_and_b32 s67, s33, 31
v_sub_u32 v48, s67, v48
v_lshlrev_b32 v49, 4, v49
s_lshl_b32 s67, s62, 14
s_add_u32 s67, s67, 30686208
poll_248:
buffer_load_dwordx4 v[56:59], v49, s[20:23], s67 offen offset:0 sc1
buffer_load_dwordx4 v[60:63], v49, s[20:23], s67 offen offset:64 sc1
pchk_249:
s_waitcnt vmcnt(1)
v_min3_u32 v50, v56, v57, v58
s_waitcnt vmcnt(0)
v_min3_u32 v50, v50, v59, v60
v_min3_u32 v50, v50, v61, v62
v_min_u32 v50, v50, v63
v_cmp_eq_u32 vcc, 0, v50
s_cbranch_vccz pdone_250
s_sub_u32 s32, s32, 1
s_cmp_gt_i32 s32, 0
s_cbranch_scc1 poll_248
pdone_250:
v_cmp_eq_u32 vcc, 0, v48
s_nop 1
v_cndmask_b32 v240, v240, v56, vcc
v_cndmask_b32 v241, v241, v57, vcc
v_cndmask_b32 v242, v242, v58, vcc
v_cndmask_b32 v243, v243, v59, vcc
v_cndmask_b32 v244, v244, v60, vcc
v_cndmask_b32 v245, v245, v61, vcc
v_cndmask_b32 v246, v246, v62, vcc
v_cndmask_b32 v247, v247, v63, vcc
v_cmp_eq_u32 vcc, 16, v48
s_nop 1
v_cndmask_b32 v248, v248, v56, vcc
v_cndmask_b32 v249, v249, v57, vcc
v_cndmask_b32 v250, v250, v58, vcc
v_cndmask_b32 v251, v251, v59, vcc
v_cndmask_b32 v252, v252, v60, vcc
v_cndmask_b32 v253, v253, v61, vcc
v_cndmask_b32 v254, v254, v62, vcc
v_cndmask_b32 v255, v255, v63, vcc
s_branch mo_168
far_171:
buffer_store_dwordx4 v[240:243], v6, s[20:23], s68 offen offset:0 sc1
buffer_store_dwordx4 v[244:247], v6, s[20:23], s68 offen offset:1024 sc1
buffer_store_dwordx4 v[248:251], v6, s[20:23], s68 offen offset:2048 sc1
buffer_store_dwordx4 v[252:255], v6, s[20:23], s68 offen offset:3072 sc1
s_branch near_172
far_173:
buffer_store_dwordx4 v[8:11], v6, s[24:27], s67 offen sc1
s_branch near_174
far_175:
buffer_store_dword v212, v3, s[24:27], s66 offen sc1
s_branch near_176
mu_183:
v_pk_fma_f32 v[64:65], v[32:33], v[82:83], v[82:83] op_sel:[0,0,1] op_sel_hi:[1,0,1]
v_pk_fma_f32 v[66:67], v[34:35], v[82:83], v[82:83] op_sel:[0,0,1] op_sel_hi:[1,0,1]
v_pk_fma_f32 v[68:69], v[36:37], v[82:83], v[82:83] op_sel:[0,0,1] op_sel_hi:[1,0,1]
v_pk_fma_f32 v[70:71], v[38:39], v[82:83], v[82:83] op_sel:[0,0,1] op_sel_hi:[1,0,1]
v_pk_fma_f32 v[72:73], v[40:41], v[82:83], v[82:83] op_sel:[0,0,1] op_sel_hi:[1,0,1]
v_pk_fma_f32 v[74:75], v[42:43], v[82:83], v[82:83] op_sel:[0,0,1] op_sel_hi:[1,0,1]
v_pk_fma_f32 v[76:77], v[44:45], v[82:83], v[82:83] op_sel:[0,0,1] op_sel_hi:[1,0,1]
v_pk_fma_f32 v[78:79], v[46:47], v[82:83], v[82:83] op_sel:[0,0,1] op_sel_hi:[1,0,1]
v_cvt_pk_bf16_f32 v92, v64, v65
v_cvt_pk_bf16_f32 v93, v66, v67
v_cvt_pk_bf16_f32 v94, v68, v69
v_cvt_pk_bf16_f32 v95, v70, v71
v_cvt_pk_bf16_f32 v96, v72, v73
v_cvt_pk_bf16_f32 v97, v74, v75
v_cvt_pk_bf16_f32 v98, v76, v77
v_cvt_pk_bf16_f32 v99, v78, v79
ds_read_b32 v11, v7 offset:256
v_max_u32 v92, 1, v92
v_max_u32 v93, 1, v93
v_max_u32 v94, 1, v94
v_max_u32 v95, 1, v95
v_max_u32 v96, 1, v96
v_max_u32 v97, 1, v97
v_max_u32 v98, 1, v98
v_max_u32 v99, 1, v99
s_branch pchk_252
poll_251:
ds_read_b32 v11, v7 offset:256
pchk_252:
s_waitcnt lgkmcnt(0)
v_cmp_eq_u32 vcc, 0, v11
s_cbranch_vccz pdone_253
s_sub_u32 s32, s32, 1
s_cmp_gt_i32 s32, 0
s_cbranch_scc1 poll_251
pdone_253:
v_cmp_eq_f32 vcc, v11, v6
s_bfm_b32 s67, s58, 0
s_and_b32 s67, s67, vcc_lo
v_cmp_gt_f32 vcc, v11, v6
s_lshl_b32 s66, 1, s66
s_or_b32 s67, s67, vcc_lo
s_cselect_b64 s[76:77], 0, s[76:77]
s_cselect_b64 s[78:79], 0, s[78:79]
s_cselect_b64 exec, 0, s[66:67]
s_bitcmp0_b32 s62, 0
s_cselect_b64 exec, exec, 0
buffer_store_dwordx2 v[12:13], off, s[24:27], s72 sc1
s_mov_b64 exec, s[78:79]
buffer_store_dwordx4 v[92:95], v4, s[24:27], s68 offen offset:0 sc1
buffer_store_dwordx4 v[96:99], v4, s[24:27], s68 offen offset:16 sc1
s_mov_b64 exec, -1
v_add_u32 v5, s34, 24
s_mov_b64 exec, 1
ds_write_b32 v3, v5
s_mov_b64 exec, -1
v_pk_fma_f32 v[48:49], v[16:17], v[80:81], v[80:81] op_sel:[0,0,1] op_sel_hi:[1,0,1]
v_pk_fma_f32 v[50:51], v[18:19], v[80:81], v[80:81] op_sel:[0,0,1] op_sel_hi:[1,0,1]
v_pk_fma_f32 v[52:53], v[20:21], v[80:81], v[80:81] op_sel:[0,0,1] op_sel_hi:[1,0,1]
v_pk_fma_f32 v[54:55], v[22:23], v[80:81], v[80:81] op_sel:[0,0,1] op_sel_hi:[1,0,1]
v_pk_fma_f32 v[56:57], v[24:25], v[80:81], v[80:81] op_sel:[0,0,1] op_sel_hi:[1,0,1]
v_pk_fma_f32 v[58:59], v[26:27], v[80:81], v[80:81] op_sel:[0,0,1] op_sel_hi:[1,0,1]
v_pk_fma_f32 v[60:61], v[28:29], v[80:81], v[80:81] op_sel:[0,0,1] op_sel_hi:[1,0,1]
v_pk_fma_f32 v[62:63], v[30:31], v[80:81], v[80:81] op_sel:[0,0,1] op_sel_hi:[1,0,1]
v_pk_add_f32 v[16:17], v[16:17], v[48:49]
v_pk_add_f32 v[18:19], v[18:19], v[50:51]
v_pk_add_f32 v[20:21], v[20:21], v[52:53]
v_pk_add_f32 v[22:23], v[22:23], v[54:55]
v_pk_add_f32 v[24:25], v[24:25], v[56:57]
v_pk_add_f32 v[26:27], v[26:27], v[58:59]
v_pk_add_f32 v[28:29], v[28:29], v[60:61]
v_pk_add_f32 v[30:31], v[30:31], v[62:63]
v_pk_add_f32 v[32:33], v[32:33], v[64:65]
v_pk_add_f32 v[34:35], v[34:35], v[66:67]
v_pk_add_f32 v[36:37], v[36:37], v[68:69]
v_pk_add_f32 v[38:39], v[38:39], v[70:71]
v_pk_add_f32 v[40:41], v[40:41], v[72:73]
v_pk_add_f32 v[42:43], v[42:43], v[74:75]
v_pk_add_f32 v[44:45], v[44:45], v[76:77]
v_pk_add_f32 v[46:47], v[46:47], v[78:79]
v_cvt_pk_bf16_f32 v240, v16, v17
v_cvt_pk_bf16_f32 v241, v18, v19
v_cvt_pk_bf16_f32 v242, v20, v21
v_cvt_pk_bf16_f32 v243, v22, v23
v_cvt_pk_bf16_f32 v244, v24, v25
v_cvt_pk_bf16_f32 v245, v26, v27
v_cvt_pk_bf16_f32 v246, v28, v29
v_cvt_pk_bf16_f32 v247, v30, v31
v_cvt_pk_bf16_f32 v248, v32, v33
v_cvt_pk_bf16_f32 v249, v34, v35
v_cvt_pk_bf16_f32 v250, v36, v37
v_cvt_pk_bf16_f32 v251, v38, v39
v_cvt_pk_bf16_f32 v252, v40, v41
v_cvt_pk_bf16_f32 v253, v42, v43
v_cvt_pk_bf16_f32 v254, v44, v45
v_cvt_pk_bf16_f32 v255, v46, v47
v_max_u32 v32, 1, v32
v_max_u32 v33, 1, v33
v_max_u32 v34, 1, v34
v_max_u32 v35, 1, v35
v_max_u32 v36, 1, v36
v_max_u32 v37, 1, v37
v_max_u32 v38, 1, v38
v_max_u32 v39, 1, v39
v_max_u32 v40, 1, v40
v_max_u32 v41, 1, v41
v_max_u32 v42, 1, v42
v_max_u32 v43, 1, v43
v_max_u32 v44, 1, v44
v_max_u32 v45, 1, v45
v_max_u32 v46, 1, v46
v_max_u32 v47, 1, v47
s_mov_b64 exec, s[78:79]
buffer_store_dwordx4 v[32:35], v15, s[24:27], s69 offen offset:0 sc1
buffer_store_dwordx4 v[36:39], v15, s[24:27], s69 offen offset:64 sc1
buffer_store_dwordx4 v[40:43], v15, s[24:27], s69 offen offset:128 sc1
buffer_store_dwordx4 v[44:47], v15, s[24:27], s69 offen offset:192 sc1
s_mov_b64 exec, -1
s_branch mu_184
far_189:
buffer_store_dwordx2 v[10:11], v12, s[24:27], s66 offen sc1
s_branch near_190
L_end:
L_fin:
s_endpgm
.section .rodata,"a"
.p2align 6
.amdhsa_kernel interleave_layers__sliding_block__moe_arch_mod__prompt_kernel
  .amdhsa_next_free_vgpr 256
  .amdhsa_next_free_sgpr 102
  .amdhsa_accum_offset 256
  .amdhsa_group_segment_fixed_size 0
  .amdhsa_kernarg_size 88
  .amdhsa_user_sgpr_count 2
  .amdhsa_user_sgpr_kernarg_segment_ptr 1
  .amdhsa_system_sgpr_workgroup_id_x 1
  .amdhsa_float_denorm_mode_32 3
.end_amdhsa_kernel
```
